```python
import torch

def _softmax(x, axis=-1):
    return torch.softmax(x, dim=axis)
def _gelu(x):
    return torch.nn.functional.gelu(x, approximate="tanh")
def _silu(x):
    return torch.nn.functional.silu(x)
def _sigmoid(x):
    return torch.sigmoid(x)
def _layernorm(x, axis=-1, eps=1e-5):
    m = x.mean(dim=axis, keepdim=True)
    v = x.var(dim=axis, keepdim=True, unbiased=False)
    return (x - m) / torch.sqrt(v + eps)
def _scatter_add(tgt, idx, src, axis=0):
    return tgt.clone().index_add_(axis, idx, src)
def _segment_sum(src, seg, n):
    out = torch.zeros((n,) + src.shape[1:], dtype=src.dtype)
    return out.index_add_(0, seg, src)
def _pad(x, pw):
    flat = tuple(v for pair in reversed(pw) for v in pair)
    return torch.nn.functional.pad(x, flat)

kernel_name = 'parallel_sum__compressed_kv_cla__mixer_channel_mlp__prompt'

def setup_inputs():

    _w = (lambda a: (lambda t: t.to(torch.bfloat16) if t.is_floating_point() else t)(torch.as_tensor(a)))
    def _A_setup():
        B, H, Sq, Sk, D, M = 1, 32, 2048, 2048, 128, 640
        Dc = 4 * D
        return {
            "x": _w((lambda *s: torch.randn(*s, dtype=torch.bfloat16) * 0.05)(B, Sq, M)),
            "c_kv": _w((lambda *s: torch.randn(*s, dtype=torch.bfloat16) * 0.4)(B, Sk, Dc)),
            "w_q": _w((lambda *s: torch.randn(*s, dtype=torch.bfloat16) * 3.2)(M, H, D) * (M ** -0.5)),
            "w_uk": _w((lambda *s: torch.randn(*s, dtype=torch.bfloat16) * 3.2)(Dc, H, D) * (Dc ** -0.5)),
            "w_uv": _w((lambda *s: torch.randn(*s, dtype=torch.bfloat16) * 0.4)(Dc, H, D) * (Dc ** -0.5)),
            "w_o": _w((lambda *s: torch.randn(*s, dtype=torch.bfloat16) * 0.4)(H, D, M) * ((H * D) ** -0.5)),
        }
    _A_in = _A_setup()

    def _B_setup():
        B, S, D, F = 1, 2048, 640, 1728
        return {
            "x": _w((lambda *s: torch.randn(*s, dtype=torch.bfloat16) * 0.05)(B, S, D)),
            "w1": _w((lambda *s: torch.randn(*s, dtype=torch.bfloat16) * 0.8)(D, F) * (D ** -0.5)),
            "b1": _w((lambda *s: torch.randn(*s, dtype=torch.bfloat16) * 0.4)(F)),
            "w2": _w((lambda *s: torch.randn(*s, dtype=torch.bfloat16) * 0.05)(F, D) * (F ** -0.5)),
            "b2": _w((lambda *s: torch.randn(*s, dtype=torch.bfloat16) * 0.05)(D)),
        }
    _B_in = _B_setup()

    return {
        "A_x": _A_in["x"],
        "A_c_kv": _A_in["c_kv"],
        "A_w_q": _A_in["w_q"],
        "A_w_uk": _A_in["w_uk"],
        "A_w_uv": _A_in["w_uv"],
        "A_w_o": _A_in["w_o"],
        "B_x": _B_in["x"],
        "B_w1": _B_in["w1"],
        "B_b1": _B_in["b1"],
        "B_w2": _B_in["w2"],
        "B_b2": _B_in["b2"],
    }

def reference(A_x, A_c_kv, A_w_q, A_w_uk, A_w_uv, A_w_o, B_x, B_w1, B_b1, B_w2, B_b2):
    def _A_ref(x, c_kv, w_q, w_uk, w_uv, w_o):
        B, Sq, M = x.shape[0], x.shape[1], x.shape[2]
        Sk = c_kv.shape[1]
        H, D = w_q.shape[1], w_q.shape[2]
        q = torch.einsum("bqm,mhd->bhqd", x, w_q)
        k = torch.einsum("bkc,chd->bhkd", c_kv, w_uk)
        v = torch.einsum("bkc,chd->bhkd", c_kv, w_uv)
        scores = torch.einsum("bhqd,bhkd->bhqk", q, k) * (D ** -0.5)
        off = Sk - Sq
        qi = torch.arange(Sq)[:, None]
        kj = torch.arange(Sk)[None, :]
        cmask = kj <= (qi + off)
        scores = torch.where(cmask[None, None], scores, -1e9)
        p = _softmax(scores, axis=-1)
        ctx = torch.einsum("bhqk,bhkd->bhqd", p, v)
        return torch.einsum("bhqd,hdm->bqm", ctx, w_o)

    def _B_ref(x, w1, b1, w2, b2):
        y = _layernorm(x, axis=-1)
        h = _gelu(torch.einsum("bsd,df->bsf", y, w1) + b1)
        return torch.einsum("bsf,fd->bsd", h, w2) + b2

    x = A_x
    xn = _layernorm(x, axis=-1)
    return x + _A_ref(xn, A_c_kv, A_w_q, A_w_uk, A_w_uv, A_w_o) + _B_ref(xn, B_w1, B_b1, B_w2, B_b2)
```

```asm
; @launch grid=(256,1,1) block=(256,1,1) lds=163840
.amdgcn_target "amdgcn-amd-amdhsa--gfx950"
.text
.p2align 8
.globl parallel_sum__compressed_kv_cla__mixer_channel_mlp__prompt_kernel
.type parallel_sum__compressed_kv_cla__mixer_channel_mlp__prompt_kernel,@function
parallel_sum__compressed_kv_cla__mixer_channel_mlp__prompt_kernel:
 s_cmp_ge_u32 s2, 256
 s_cbranch_scc1 L_end
 s_load_dwordx2 s[12:13], s[0:1], 8
 s_load_dwordx2 s[16:17], s[0:1], 24
 s_load_dwordx2 s[24:25], s[0:1], 0
 s_load_dwordx2 s[4:5], s[0:1], 104
 s_getpc_b64 s[96:97]
L_pc0:
 s_bfe_u32 s58, s2, 262147
 s_lshl_b32 s58, s58, 13
 v_min_u32 v25, 63, v0
 v_lshl_add_u32 v25, v25, 7, s58
 v_min_u32 v25, L_safe-L_pc0, v25
 global_load_dword v25, v25, s[96:97]
 s_load_dwordx2 s[20:21], s[0:1], 32
 s_load_dwordx2 s[28:29], s[0:1], 16
 s_load_dwordx2 s[32:33], s[0:1], 56
 s_load_dwordx2 s[36:37], s[0:1], 64
 s_load_dwordx2 s[40:41], s[0:1], 40
 s_load_dwordx2 s[44:45], s[0:1], 72
 s_load_dwordx2 s[48:49], s[0:1], 80
 s_load_dwordx2 s[52:53], s[0:1], 88
 v_lshrrev_b32 v28, 6, v0
 s_nop 0
 v_readfirstlane_b32 s3, v28
 v_lshrrev_b32 v26, 5, v0
 v_min_u32 v26, 1, v26
 v_lshlrev_b32 v26, 28, v26
 v_lshl_add_u32 v26, v0, 2, v26
 v_and_b32 v0, 63, v0
 s_mov_b32 s14, 2097152
 s_mov_b32 s15, 0x00020000
 s_mov_b32 s18, 4194304
 s_mov_b32 s19, 0x00020000
 s_mov_b32 s26, 2621440
 s_mov_b32 s27, 0x00020000
 s_mov_b32 s6, 268435456
 s_mov_b32 s7, 0x00020000
 s_and_b32 s56, s2, 7
 s_lshr_b32 s57, s2, 3
 s_lshr_b32 s60, s57, 2
 s_and_b32 s61, s57, 3
 s_lshr_b32 s57, s56, 1
 s_lshl_b32 s57, s57, 3
 s_add_u32 s60, s60, s57
 s_and_b32 s56, s56, 1
 s_lshl_b32 s56, s56, 2
 s_add_u32 s61, s61, s56
 s_lshl_b32 s56, s61, 2
 s_add_u32 s56, s56, s3
 s_lshl_b32 s62, s56, 16
 s_lshl_b32 s66, s56, 15
 s_lshl_b32 s57, s60, 20
 s_add_u32 s66, s66, s57
 s_lshl_b32 s63, s3, 17
 s_lshl_b32 s57, s60, 8
 s_add_u32 s63, s63, s57
 s_lshl_b32 s64, s3, 13
 s_lshl_b32 s65, s3, 12
 s_lshl_b32 s68, s61, 0
 s_add_u32 s68, s68, s60
 s_mul_i32 s68, s68, 2
 s_and_b32 s68, s68, 7
 s_lshl_b32 s69, s68, 7
 s_lshl_b32 s68, s68, 19
 v_lshrrev_b32 v28, 3, v0
 v_and_b32 v29, 7, v0
 v_lshrrev_b32 v30, 1, v28
 v_xor_b32 v29, v29, v30
 v_lshlrev_b32 v29, 4, v29
 v_lshl_add_u32 v29, v28, 10, v29
 v_xor_b32 v30, 64, v29
 v_add_u32 v15, 0, v29
 v_add_u32 v16, 15360, v30
 v_add_u32 v17, 6144, v29
 v_add_u32 v18, 21504, v30
 v_lshrrev_b32 v28, 4, v0
 v_bfe_u32 v29, v0, 1, 3
 v_xor_b32 v29, v29, v28
 v_lshlrev_b32 v29, 5, v29
 v_and_b32 v30, 1, v0
 v_lshl_add_u32 v29, v30, 4, v29
 v_lshl_add_u32 v29, v28, 13, v29
 v_xor_b32 v30, 128, v29
 v_add_u32 v2, 0, v29
 v_add_u32 v3, 31744, v29
 v_add_u32 v4, 63488, v30
 v_add_u32 v5, 95232, v30
 s_lshl_b32 s70, s2, 2
 s_add_u32 s70, s70, s3
 s_mul_i32 s58, s70, 2560
 v_lshrrev_b32 v200, 5, v0
 v_and_b32 v201, 31, v0
 v_mul_u32_u24 v202, 1280, v200
 v_lshl_add_u32 v202, v201, 3, v202
 s_waitcnt lgkmcnt(0)
 buffer_load_dwordx2 v[160:161], v202, s[24:27], s58 offen offset:0
 buffer_load_dwordx2 v[162:163], v202, s[24:27], s58 offen offset:256
 buffer_load_dwordx2 v[164:165], v202, s[24:27], s58 offen offset:512
 buffer_load_dwordx2 v[166:167], v202, s[24:27], s58 offen offset:768
 buffer_load_dwordx2 v[168:169], v202, s[24:27], s58 offen offset:1024
 v_mov_b32 v27, 0
 s_mov_b32 s58, 39419904
 buffer_load_dword v27, v27, s[4:7], s58 offen sc1
 s_add_u32 m0, s65, 0
 s_add_u32 s56, s68, 0
 s_and_b32 s56, s56, 4194303
 s_add_u32 s56, s56, s63
 buffer_load_dwordx4 v2, s[16:19], s56 offen offset:0 lds
 buffer_load_dwordx4 v3, s[16:19], s56 offen offset:1024 lds
 buffer_load_dwordx4 v4, s[16:19], s56 offen offset:2048 lds
 buffer_load_dwordx4 v5, s[16:19], s56 offen offset:3072 lds
 s_add_u32 m0, s64, 65536
 s_add_u32 s57, s69, 0
 s_and_b32 s57, s57, 1023
 s_add_u32 s57, s57, s62
 buffer_load_dwordx4 v15, s[12:15], s57 offen offset:0 lds
 buffer_load_dwordx4 v16, s[12:15], s57 offen offset:1024 lds
 buffer_load_dwordx4 v17, s[12:15], s57 offen offset:2048 lds
 buffer_load_dwordx4 v18, s[12:15], s57 offen offset:3072 lds
 s_add_u32 m0, s64, 69632
 s_add_u32 s57, s57, 32768
 buffer_load_dwordx4 v15, s[12:15], s57 offen offset:0 lds
 buffer_load_dwordx4 v16, s[12:15], s57 offen offset:1024 lds
 buffer_load_dwordx4 v17, s[12:15], s57 offen offset:2048 lds
 buffer_load_dwordx4 v18, s[12:15], s57 offen offset:3072 lds
 s_mov_b32 s22, 4194304
 s_mov_b32 s23, 0x00020000
 s_mov_b32 s30, 5242880
 s_mov_b32 s31, 0x00020000
 s_mov_b32 s34, 2211840
 s_mov_b32 s35, 0x00020000
 s_mov_b32 s38, 3456
 s_mov_b32 s39, 0x00020000
 s_mov_b32 s42, 5242880
 s_mov_b32 s43, 0x00020000
 s_mov_b32 s46, 2211840
 s_mov_b32 s47, 0x00020000
 s_mov_b32 s50, 1280
 s_mov_b32 s51, 0x00020000
 s_mov_b32 s54, 2621440
 s_mov_b32 s55, 0x00020000
 s_mov_b32 s67, 0x3e0293ee
 v_lshlrev_b32 v14, 4, v0
 v_bfe_u32 v29, v0, 2, 2
 v_lshl_add_u32 v30, v28, 3, v29
 v_lshlrev_b32 v30, 8, v30
 v_and_b32 v31, 3, v0
 v_lshl_add_u32 v30, v31, 3, v30
 v_and_b32 v31, 1, v28
 v_lshl_add_u32 v29, v31, 2, v29
 v_lshl_add_u32 v30, v29, 5, v30
 v_xor_b32 v6, 0, v30
 v_xor_b32 v7, 32, v30
 v_xor_b32 v8, 64, v30
 v_xor_b32 v9, 96, v30
 v_xor_b32 v10, 128, v30
 v_xor_b32 v11, 160, v30
 v_xor_b32 v12, 192, v30
 v_xor_b32 v13, 224, v30
 v_bfe_u32 v29, v0, 1, 3
 v_xor_b32 v29, v29, v28
 v_lshlrev_b32 v29, 4, v29
 v_and_b32 v30, 15, v0
 v_lshl_add_u32 v29, v30, 7, v29
 v_add_u32 v29, s64, v29
 v_add_u32 v19, 65536, v29
 v_xor_b32 v20, 64, v19
 v_add_u32 v21, 131072, v29
 v_xor_b32 v22, 64, v21
 v_and_b32 v29, 7, v0
 v_bfe_u32 v30, v0, 3, 1
 v_lshl_add_u32 v29, v30, 4, v29
 v_lshrrev_b32 v30, 5, v0
 v_lshl_add_u32 v29, v30, 5, v29
 v_lshlrev_b32 v29, 4, v29
 v_bfe_u32 v30, v0, 4, 1
 v_lshl_add_u32 v23, v30, 10, v29
 v_and_b32 v29, 15, v0
 v_lshl_add_u32 v29, v30, 5, v29
 v_lshlrev_b32 v29, 4, v29
 v_lshrrev_b32 v30, 5, v0
 v_lshl_add_u32 v24, v30, 12, v29
 s_add_u32 m0, s65, 16384
 s_waitcnt vmcnt(17)
 v_lshlrev_b32 v170, 16, v160
 v_and_b32 v171, 0xffff0000, v160
 v_lshlrev_b32 v172, 16, v161
 v_and_b32 v173, 0xffff0000, v161
 s_waitcnt vmcnt(16)
 v_lshlrev_b32 v174, 16, v162
 v_and_b32 v175, 0xffff0000, v162
 v_lshlrev_b32 v176, 16, v163
 v_and_b32 v177, 0xffff0000, v163
 s_waitcnt vmcnt(15)
 v_lshlrev_b32 v178, 16, v164
 v_and_b32 v179, 0xffff0000, v164
 v_lshlrev_b32 v180, 16, v165
 v_and_b32 v181, 0xffff0000, v165
 s_waitcnt vmcnt(14)
 v_lshlrev_b32 v182, 16, v166
 v_and_b32 v183, 0xffff0000, v166
 v_lshlrev_b32 v184, 16, v167
 v_and_b32 v185, 0xffff0000, v167
 s_waitcnt vmcnt(13)
 v_lshlrev_b32 v186, 16, v168
 v_and_b32 v187, 0xffff0000, v168
 v_lshlrev_b32 v188, 16, v169
 v_and_b32 v189, 0xffff0000, v169
 v_pk_add_f32 v[190:191], v[170:171], v[172:173]
 v_pk_add_f32 v[190:191], v[190:191], v[174:175]
 v_pk_add_f32 v[190:191], v[190:191], v[176:177]
 v_pk_add_f32 v[190:191], v[190:191], v[178:179]
 v_pk_add_f32 v[190:191], v[190:191], v[180:181]
 v_pk_add_f32 v[190:191], v[190:191], v[182:183]
 v_pk_add_f32 v[190:191], v[190:191], v[184:185]
 v_pk_add_f32 v[190:191], v[190:191], v[186:187]
 v_pk_add_f32 v[190:191], v[190:191], v[188:189]
 v_add_f32 v203, v190, v191
 s_nop 1
 v_add_f32_dpp v203, v203, v203 row_ror:8 row_mask:0xf bank_mask:0xf
 s_nop 1
 v_add_f32_dpp v203, v203, v203 row_ror:4 row_mask:0xf bank_mask:0xf
 s_nop 1
 v_add_f32_dpp v203, v203, v203 row_ror:2 row_mask:0xf bank_mask:0xf
 s_nop 1
 v_add_f32_dpp v203, v203, v203 row_ror:1 row_mask:0xf bank_mask:0xf
 v_mov_b32 v204, v203
 s_nop 1
 v_permlane16_swap_b32 v203, v204
 v_add_f32 v203, v203, v204
 v_mul_f32 v206, 0x3acccccd, v203
 v_pk_add_f32 v[192:193], v[170:171], v[206:207] op_sel_hi:[1,0] neg_lo:[0,1] neg_hi:[0,1]
 v_pk_add_f32 v[194:195], v[172:173], v[206:207] op_sel_hi:[1,0] neg_lo:[0,1] neg_hi:[0,1]
 v_pk_mul_f32 v[190:191], v[192:193], v[192:193]
 v_pk_add_f32 v[192:193], v[174:175], v[206:207] op_sel_hi:[1,0] neg_lo:[0,1] neg_hi:[0,1]
 v_pk_fma_f32 v[190:191], v[194:195], v[194:195], v[190:191]
 v_pk_add_f32 v[194:195], v[176:177], v[206:207] op_sel_hi:[1,0] neg_lo:[0,1] neg_hi:[0,1]
 v_pk_fma_f32 v[190:191], v[192:193], v[192:193], v[190:191]
 v_pk_add_f32 v[192:193], v[178:179], v[206:207] op_sel_hi:[1,0] neg_lo:[0,1] neg_hi:[0,1]
 v_pk_fma_f32 v[190:191], v[194:195], v[194:195], v[190:191]
 v_pk_add_f32 v[194:195], v[180:181], v[206:207] op_sel_hi:[1,0] neg_lo:[0,1] neg_hi:[0,1]
 v_pk_fma_f32 v[190:191], v[192:193], v[192:193], v[190:191]
 v_pk_add_f32 v[192:193], v[182:183], v[206:207] op_sel_hi:[1,0] neg_lo:[0,1] neg_hi:[0,1]
 v_pk_fma_f32 v[190:191], v[194:195], v[194:195], v[190:191]
 v_pk_add_f32 v[194:195], v[184:185], v[206:207] op_sel_hi:[1,0] neg_lo:[0,1] neg_hi:[0,1]
 v_pk_fma_f32 v[190:191], v[192:193], v[192:193], v[190:191]
 v_pk_add_f32 v[192:193], v[186:187], v[206:207] op_sel_hi:[1,0] neg_lo:[0,1] neg_hi:[0,1]
 v_pk_fma_f32 v[190:191], v[194:195], v[194:195], v[190:191]
 v_pk_add_f32 v[194:195], v[188:189], v[206:207] op_sel_hi:[1,0] neg_lo:[0,1] neg_hi:[0,1]
 v_pk_fma_f32 v[190:191], v[192:193], v[192:193], v[190:191]
 v_pk_fma_f32 v[190:191], v[194:195], v[194:195], v[190:191]
 v_add_f32 v203, v190, v191
 s_nop 1
 v_add_f32_dpp v203, v203, v203 row_ror:8 row_mask:0xf bank_mask:0xf
 s_nop 1
 v_add_f32_dpp v203, v203, v203 row_ror:4 row_mask:0xf bank_mask:0xf
 s_nop 1
 v_add_f32_dpp v203, v203, v203 row_ror:2 row_mask:0xf bank_mask:0xf
 s_nop 1
 v_add_f32_dpp v203, v203, v203 row_ror:1 row_mask:0xf bank_mask:0xf
 v_mov_b32 v204, v203
 s_nop 1
 v_permlane16_swap_b32 v203, v204
 v_add_f32 v203, v203, v204
 v_mul_f32 v203, 0x3acccccd, v203
 v_cvt_pk_bf16_f32 v203, v203, v203
 v_and_b32 v203, 0xffff0000, v203
 v_add_f32 v203, 0x3727c5ac, v203
 v_cvt_pk_bf16_f32 v203, v203, v203
 v_and_b32 v203, 0xffff0000, v203
 v_sqrt_f32 v203, v203
 s_nop 0
 v_cvt_pk_bf16_f32 v203, v203, v203
 v_and_b32 v203, 0xffff0000, v203
 v_rcp_f32 v208, v203
 v_cvt_pk_bf16_f32 v206, v206, v206
 v_and_b32 v206, 0xffff0000, v206
 v_pk_add_f32 v[170:171], v[170:171], v[206:207] op_sel_hi:[1,0] neg_lo:[0,1] neg_hi:[0,1]
 v_pk_add_f32 v[172:173], v[172:173], v[206:207] op_sel_hi:[1,0] neg_lo:[0,1] neg_hi:[0,1]
 v_pk_add_f32 v[174:175], v[174:175], v[206:207] op_sel_hi:[1,0] neg_lo:[0,1] neg_hi:[0,1]
 v_pk_add_f32 v[176:177], v[176:177], v[206:207] op_sel_hi:[1,0] neg_lo:[0,1] neg_hi:[0,1]
 v_pk_add_f32 v[178:179], v[178:179], v[206:207] op_sel_hi:[1,0] neg_lo:[0,1] neg_hi:[0,1]
 v_pk_add_f32 v[180:181], v[180:181], v[206:207] op_sel_hi:[1,0] neg_lo:[0,1] neg_hi:[0,1]
 v_pk_add_f32 v[182:183], v[182:183], v[206:207] op_sel_hi:[1,0] neg_lo:[0,1] neg_hi:[0,1]
 v_pk_add_f32 v[184:185], v[184:185], v[206:207] op_sel_hi:[1,0] neg_lo:[0,1] neg_hi:[0,1]
 v_pk_add_f32 v[186:187], v[186:187], v[206:207] op_sel_hi:[1,0] neg_lo:[0,1] neg_hi:[0,1]
 v_pk_add_f32 v[188:189], v[188:189], v[206:207] op_sel_hi:[1,0] neg_lo:[0,1] neg_hi:[0,1]
 v_cvt_pk_bf16_f32 v160, v170, v171
 v_cvt_pk_bf16_f32 v161, v172, v173
 v_cvt_pk_bf16_f32 v162, v174, v175
 v_cvt_pk_bf16_f32 v163, v176, v177
 v_cvt_pk_bf16_f32 v164, v178, v179
 v_cvt_pk_bf16_f32 v165, v180, v181
 v_cvt_pk_bf16_f32 v166, v182, v183
 v_cvt_pk_bf16_f32 v167, v184, v185
 v_cvt_pk_bf16_f32 v168, v186, v187
 v_cvt_pk_bf16_f32 v169, v188, v189
 v_lshlrev_b32 v170, 16, v160
 v_and_b32 v171, 0xffff0000, v160
 v_lshlrev_b32 v172, 16, v161
 v_and_b32 v173, 0xffff0000, v161
 v_lshlrev_b32 v174, 16, v162
 v_and_b32 v175, 0xffff0000, v162
 v_lshlrev_b32 v176, 16, v163
 v_and_b32 v177, 0xffff0000, v163
 v_lshlrev_b32 v178, 16, v164
 v_and_b32 v179, 0xffff0000, v164
 v_lshlrev_b32 v180, 16, v165
 v_and_b32 v181, 0xffff0000, v165
 v_lshlrev_b32 v182, 16, v166
 v_and_b32 v183, 0xffff0000, v166
 v_lshlrev_b32 v184, 16, v167
 v_and_b32 v185, 0xffff0000, v167
 v_lshlrev_b32 v186, 16, v168
 v_and_b32 v187, 0xffff0000, v168
 v_lshlrev_b32 v188, 16, v169
 v_and_b32 v189, 0xffff0000, v169
 v_pk_mul_f32 v[170:171], v[170:171], v[208:209] op_sel_hi:[1,0]
 v_pk_mul_f32 v[172:173], v[172:173], v[208:209] op_sel_hi:[1,0]
 v_pk_mul_f32 v[174:175], v[174:175], v[208:209] op_sel_hi:[1,0]
 v_pk_mul_f32 v[176:177], v[176:177], v[208:209] op_sel_hi:[1,0]
 v_pk_mul_f32 v[178:179], v[178:179], v[208:209] op_sel_hi:[1,0]
 v_pk_mul_f32 v[180:181], v[180:181], v[208:209] op_sel_hi:[1,0]
 v_pk_mul_f32 v[182:183], v[182:183], v[208:209] op_sel_hi:[1,0]
 v_pk_mul_f32 v[184:185], v[184:185], v[208:209] op_sel_hi:[1,0]
 v_pk_mul_f32 v[186:187], v[186:187], v[208:209] op_sel_hi:[1,0]
 v_pk_mul_f32 v[188:189], v[188:189], v[208:209] op_sel_hi:[1,0]
 v_cvt_pk_bf16_f32 v160, v170, v171
 v_cvt_pk_bf16_f32 v161, v172, v173
 v_cvt_pk_bf16_f32 v162, v174, v175
 v_cvt_pk_bf16_f32 v163, v176, v177
 v_cvt_pk_bf16_f32 v164, v178, v179
 v_cvt_pk_bf16_f32 v165, v180, v181
 v_cvt_pk_bf16_f32 v166, v182, v183
 v_cvt_pk_bf16_f32 v167, v184, v185
 v_cvt_pk_bf16_f32 v168, v186, v187
 v_cvt_pk_bf16_f32 v169, v188, v189
 v_lshrrev_b32 v196, 1, v201
 v_lshlrev_b32 v196, 7, v196
 v_and_b32 v197, 1, v201
 v_lshl_add_u32 v196, v197, 3, v196
 v_lshl_add_u32 v196, v200, 4, v196
 s_lshl_b32 s58, s3, 5
 v_add_u32 v196, s58, v196
 s_lshl_b32 s58, s3, 4
 v_lshl_add_u32 v197, v200, 3, s58
 ds_write_b64 v196, v[160:161] offset:49152
 ds_write_b64 v196, v[162:163] offset:51200
 ds_write_b64 v196, v[164:165] offset:53248
 ds_write_b64 v196, v[166:167] offset:55296
 ds_write_b64 v196, v[168:169] offset:57344
 v_lshlrev_b32 v170, 16, v160
 v_and_b32 v171, 0xffff0000, v160
 v_lshlrev_b32 v172, 16, v161
 v_and_b32 v173, 0xffff0000, v161
 v_lshlrev_b32 v174, 16, v162
 v_and_b32 v175, 0xffff0000, v162
 v_lshlrev_b32 v176, 16, v163
 v_and_b32 v177, 0xffff0000, v163
 v_lshlrev_b32 v178, 16, v164
 v_and_b32 v179, 0xffff0000, v164
 v_lshlrev_b32 v180, 16, v165
 v_and_b32 v181, 0xffff0000, v165
 v_lshlrev_b32 v182, 16, v166
 v_and_b32 v183, 0xffff0000, v166
 v_lshlrev_b32 v184, 16, v167
 v_and_b32 v185, 0xffff0000, v167
 v_lshlrev_b32 v186, 16, v168
 v_and_b32 v187, 0xffff0000, v168
 v_lshlrev_b32 v188, 16, v169
 v_and_b32 v189, 0xffff0000, v169
 v_pk_add_f32 v[190:191], v[170:171], v[172:173]
 v_pk_add_f32 v[190:191], v[190:191], v[174:175]
 v_pk_add_f32 v[190:191], v[190:191], v[176:177]
 v_pk_add_f32 v[190:191], v[190:191], v[178:179]
 v_pk_add_f32 v[190:191], v[190:191], v[180:181]
 v_pk_add_f32 v[190:191], v[190:191], v[182:183]
 v_pk_add_f32 v[190:191], v[190:191], v[184:185]
 v_pk_add_f32 v[190:191], v[190:191], v[186:187]
 v_pk_add_f32 v[190:191], v[190:191], v[188:189]
 v_add_f32 v203, v190, v191
 s_nop 1
 v_add_f32_dpp v203, v203, v203 row_ror:8 row_mask:0xf bank_mask:0xf
 s_nop 1
 v_add_f32_dpp v203, v203, v203 row_ror:4 row_mask:0xf bank_mask:0xf
 s_nop 1
 v_add_f32_dpp v203, v203, v203 row_ror:2 row_mask:0xf bank_mask:0xf
 s_nop 1
 v_add_f32_dpp v203, v203, v203 row_ror:1 row_mask:0xf bank_mask:0xf
 v_mov_b32 v204, v203
 s_nop 1
 v_permlane16_swap_b32 v203, v204
 v_add_f32 v203, v203, v204
 v_mul_f32 v206, 0x3acccccd, v203
 v_pk_add_f32 v[192:193], v[170:171], v[206:207] op_sel_hi:[1,0] neg_lo:[0,1] neg_hi:[0,1]
 v_pk_add_f32 v[194:195], v[172:173], v[206:207] op_sel_hi:[1,0] neg_lo:[0,1] neg_hi:[0,1]
 v_pk_mul_f32 v[190:191], v[192:193], v[192:193]
 v_pk_add_f32 v[192:193], v[174:175], v[206:207] op_sel_hi:[1,0] neg_lo:[0,1] neg_hi:[0,1]
 v_pk_fma_f32 v[190:191], v[194:195], v[194:195], v[190:191]
 v_pk_add_f32 v[194:195], v[176:177], v[206:207] op_sel_hi:[1,0] neg_lo:[0,1] neg_hi:[0,1]
 v_pk_fma_f32 v[190:191], v[192:193], v[192:193], v[190:191]
 v_pk_add_f32 v[192:193], v[178:179], v[206:207] op_sel_hi:[1,0] neg_lo:[0,1] neg_hi:[0,1]
 v_pk_fma_f32 v[190:191], v[194:195], v[194:195], v[190:191]
 v_pk_add_f32 v[194:195], v[180:181], v[206:207] op_sel_hi:[1,0] neg_lo:[0,1] neg_hi:[0,1]
 v_pk_fma_f32 v[190:191], v[192:193], v[192:193], v[190:191]
 v_pk_add_f32 v[192:193], v[182:183], v[206:207] op_sel_hi:[1,0] neg_lo:[0,1] neg_hi:[0,1]
 v_pk_fma_f32 v[190:191], v[194:195], v[194:195], v[190:191]
 v_pk_add_f32 v[194:195], v[184:185], v[206:207] op_sel_hi:[1,0] neg_lo:[0,1] neg_hi:[0,1]
 v_pk_fma_f32 v[190:191], v[192:193], v[192:193], v[190:191]
 v_pk_add_f32 v[192:193], v[186:187], v[206:207] op_sel_hi:[1,0] neg_lo:[0,1] neg_hi:[0,1]
 v_pk_fma_f32 v[190:191], v[194:195], v[194:195], v[190:191]
 v_pk_add_f32 v[194:195], v[188:189], v[206:207] op_sel_hi:[1,0] neg_lo:[0,1] neg_hi:[0,1]
 v_pk_fma_f32 v[190:191], v[192:193], v[192:193], v[190:191]
 v_pk_fma_f32 v[190:191], v[194:195], v[194:195], v[190:191]
 v_add_f32 v203, v190, v191
 s_nop 1
 v_add_f32_dpp v203, v203, v203 row_ror:8 row_mask:0xf bank_mask:0xf
 s_nop 1
 v_add_f32_dpp v203, v203, v203 row_ror:4 row_mask:0xf bank_mask:0xf
 s_nop 1
 v_add_f32_dpp v203, v203, v203 row_ror:2 row_mask:0xf bank_mask:0xf
 s_nop 1
 v_add_f32_dpp v203, v203, v203 row_ror:1 row_mask:0xf bank_mask:0xf
 v_mov_b32 v204, v203
 s_nop 1
 v_permlane16_swap_b32 v203, v204
 v_add_f32 v203, v203, v204
 v_mul_f32 v203, 0x3acccccd, v203
 v_cvt_pk_bf16_f32 v203, v203, v203
 v_and_b32 v203, 0xffff0000, v203
 v_add_f32 v203, 0x3727c5ac, v203
 v_cvt_pk_bf16_f32 v203, v203, v203
 v_and_b32 v203, 0xffff0000, v203
 v_sqrt_f32 v203, v203
 s_nop 0
 v_cvt_pk_bf16_f32 v203, v203, v203
 v_and_b32 v203, 0xffff0000, v203
 v_rcp_f32 v208, v203
 v_cvt_pk_bf16_f32 v206, v206, v206
 v_and_b32 v206, 0xffff0000, v206
 v_mov_b32 v209, v206
 ds_write_b64 v197, v[208:209] offset:59392
 s_waitcnt vmcnt(12)
 v_add_u32 v27, 0x9e3779b9, v27
 s_nop 0
 v_readfirstlane_b32 s98, v27
 v_lshrrev_b32 v190, 5, v0
 v_bfe_u32 v191, v0, 3, 2
 v_lshlrev_b32 v190, 10, v190
 v_lshl_add_u32 v190, v191, 8, v190
 v_and_b32 v191, 7, v0
 v_lshl_add_u32 v195, v191, 4, v190
 s_lshl_b32 s58, s3, 10
 v_add_u32 v196, s58, v14
 s_lshr_b32 s58, s2, 1
 s_mul_i32 s58, s58, 20480
 s_and_b32 s59, s2, 1
 s_lshl_b32 s59, s59, 7
 s_add_u32 s58, s58, s59
 s_lshl_b32 s59, s3, 11
 s_add_u32 s58, s58, s59
 s_add_u32 s58, s58, 35651584
 s_lshl_b32 s71, s2, 7
 s_add_u32 s71, s71, 39321600
 s_add_u32 s56, s68, 524288
 s_and_b32 s56, s56, 4194303
 s_add_u32 s56, s56, s63
 buffer_load_dwordx4 v2, s[16:19], s56 offen offset:0 lds
 buffer_load_dwordx4 v3, s[16:19], s56 offen offset:1024 lds
 buffer_load_dwordx4 v4, s[16:19], s56 offen offset:2048 lds
 buffer_load_dwordx4 v5, s[16:19], s56 offen offset:3072 lds
 s_add_u32 m0, s64, 98304
 s_add_u32 s57, s69, 128
 s_and_b32 s57, s57, 1023
 s_add_u32 s57, s57, s62
 buffer_load_dwordx4 v15, s[12:15], s57 offen offset:0 lds
 buffer_load_dwordx4 v16, s[12:15], s57 offen offset:1024 lds
 buffer_load_dwordx4 v17, s[12:15], s57 offen offset:2048 lds
 buffer_load_dwordx4 v18, s[12:15], s57 offen offset:3072 lds
 s_add_u32 m0, s64, 102400
 s_add_u32 s57, s57, 32768
 buffer_load_dwordx4 v15, s[12:15], s57 offen offset:0 lds
 buffer_load_dwordx4 v16, s[12:15], s57 offen offset:1024 lds
 buffer_load_dwordx4 v17, s[12:15], s57 offen offset:2048 lds
 buffer_load_dwordx4 v18, s[12:15], s57 offen offset:3072 lds
 s_waitcnt vmcnt(12)
 s_waitcnt lgkmcnt(0)
 s_barrier
 ds_read_b64_tr_b16 v[224:225], v6 offset:0
 ds_read_b64_tr_b16 v[226:227], v6 offset:1024
 ds_read_b64_tr_b16 v[228:229], v7 offset:0
 ds_read_b64_tr_b16 v[230:231], v7 offset:1024
 ds_read_b64_tr_b16 v[232:233], v8 offset:0
 ds_read_b64_tr_b16 v[234:235], v8 offset:1024
 ds_read_b128 a[0:3], v19 offset:0
 ds_read_b128 a[4:7], v19 offset:2048
 ds_read_b64_tr_b16 v[236:237], v9 offset:0
 ds_read_b128 a[8:11], v19 offset:4096
 ds_read_b64_tr_b16 v[238:239], v9 offset:1024
 ds_read_b128 a[12:15], v19 offset:6144
 ds_read_b64_tr_b16 v[240:241], v10 offset:0
 ds_read_b64_tr_b16 v[242:243], v10 offset:1024
 ds_read_b128 a[16:19], v20 offset:0
 ds_read_b128 a[20:23], v20 offset:2048
 s_waitcnt lgkmcnt(9)
 v_mfma_f32_16x16x32_bf16 v[32:35], v[224:227], a[0:3], 0
 ds_read_b64_tr_b16 v[244:245], v11 offset:0
 s_waitcnt lgkmcnt(9)
 v_mfma_f32_16x16x32_bf16 v[64:67], v[224:227], a[4:7], 0
 ds_read_b128 a[24:27], v20 offset:4096
 s_waitcnt lgkmcnt(8)
 v_mfma_f32_16x16x32_bf16 v[96:99], v[224:227], a[8:11], 0
 s_add_u32 m0, s65, 32768
 s_waitcnt lgkmcnt(6)
 v_mfma_f32_16x16x32_bf16 v[128:131], v[224:227], a[12:15], 0
 ds_read_b64_tr_b16 v[246:247], v11 offset:1024
 ds_read_b128 a[28:31], v20 offset:6144
 v_mfma_f32_16x16x32_bf16 v[36:39], v[228:231], a[0:3], 0
 s_add_u32 s56, s68, 1048576
 ds_read_b64_tr_b16 v[248:249], v12 offset:0
 v_mfma_f32_16x16x32_bf16 v[68:71], v[228:231], a[4:7], 0
 s_and_b32 s56, s56, 4194303
 ds_read_b64_tr_b16 v[250:251], v12 offset:1024
 v_mfma_f32_16x16x32_bf16 v[100:103], v[228:231], a[8:11], 0
 s_add_u32 s56, s56, s63
 ds_read_b128 v[160:163], v196 offset:49152
 v_mfma_f32_16x16x32_bf16 v[132:135], v[228:231], a[12:15], 0
 ds_read_b128 v[164:167], v196 offset:53248
 ds_read_b128 v[168:171], v196 offset:57344
 v_mfma_f32_16x16x32_bf16 v[40:43], v[232:235], a[0:3], 0
 ds_read_b64_tr_b16 v[252:253], v13 offset:0
 v_mfma_f32_16x16x32_bf16 v[72:75], v[232:235], a[4:7], 0
 buffer_load_dwordx4 v2, s[16:19], s56 offen offset:0 lds
 v_mfma_f32_16x16x32_bf16 v[104:107], v[232:235], a[8:11], 0
 ds_read_b64_tr_b16 v[254:255], v13 offset:1024
 v_mfma_f32_16x16x32_bf16 v[136:139], v[232:235], a[12:15], 0
 buffer_load_dwordx4 v3, s[16:19], s56 offen offset:1024 lds
 v_mfma_f32_16x16x32_bf16 v[44:47], v[236:239], a[0:3], 0
 ds_read_b64_tr_b16 v[224:225], v6 offset:8192
 v_mfma_f32_16x16x32_bf16 v[76:79], v[236:239], a[4:7], 0
 buffer_load_dwordx4 v4, s[16:19], s56 offen offset:2048 lds
 v_mfma_f32_16x16x32_bf16 v[108:111], v[236:239], a[8:11], 0
 ds_read_b64_tr_b16 v[226:227], v6 offset:9216
 v_mfma_f32_16x16x32_bf16 v[140:143], v[236:239], a[12:15], 0
 s_waitcnt lgkmcnt(8)
 v_mfma_f32_16x16x32_bf16 v[48:51], v[240:243], a[0:3], 0
 buffer_load_dwordx4 v5, s[16:19], s56 offen offset:3072 lds
 v_mfma_f32_16x16x32_bf16 v[80:83], v[240:243], a[4:7], 0
 ds_read_b64_tr_b16 v[228:229], v7 offset:8192
 s_add_u32 m0, s64, 131072
 v_mfma_f32_16x16x32_bf16 v[112:115], v[240:243], a[8:11], 0
 ds_read_b64_tr_b16 v[230:231], v7 offset:9216
 s_add_u32 s57, s69, 256
 v_mfma_f32_16x16x32_bf16 v[144:147], v[240:243], a[12:15], 0
 v_mfma_f32_16x16x32_bf16 v[52:55], v[244:247], a[0:3], 0
 ds_read_b64_tr_b16 v[232:233], v8 offset:8192
 s_and_b32 s57, s57, 1023
 v_mfma_f32_16x16x32_bf16 v[84:87], v[244:247], a[4:7], 0
 ds_read_b64_tr_b16 v[234:235], v8 offset:9216
 v_mfma_f32_16x16x32_bf16 v[116:119], v[244:247], a[8:11], 0
 s_add_u32 s57, s57, s62
 v_mfma_f32_16x16x32_bf16 v[148:151], v[244:247], a[12:15], 0
 s_waitcnt lgkmcnt(5)
 v_mfma_f32_16x16x32_bf16 v[56:59], v[248:251], a[0:3], 0
 ds_read_b64_tr_b16 v[236:237], v9 offset:8192
 v_mfma_f32_16x16x32_bf16 v[88:91], v[248:251], a[4:7], 0
 buffer_load_dwordx4 v15, s[12:15], s57 offen offset:0 lds
 v_mfma_f32_16x16x32_bf16 v[120:123], v[248:251], a[8:11], 0
 ds_read_b64_tr_b16 v[238:239], v9 offset:9216
 v_mfma_f32_16x16x32_bf16 v[152:155], v[248:251], a[12:15], 0
 buffer_load_dwordx4 v16, s[12:15], s57 offen offset:1024 lds
 v_mfma_f32_16x16x32_bf16 v[60:63], v[252:255], a[0:3], 0
 ds_read_b64_tr_b16 v[240:241], v10 offset:8192
 v_mfma_f32_16x16x32_bf16 v[92:95], v[252:255], a[4:7], 0
 buffer_load_dwordx4 v17, s[12:15], s57 offen offset:2048 lds
 v_mfma_f32_16x16x32_bf16 v[124:127], v[252:255], a[8:11], 0
 ds_read_b64_tr_b16 v[242:243], v10 offset:9216
 v_mfma_f32_16x16x32_bf16 v[156:159], v[252:255], a[12:15], 0
 s_waitcnt lgkmcnt(4)
 v_mfma_f32_16x16x32_bf16 v[32:35], v[224:227], a[16:19], v[32:35]
 buffer_load_dwordx4 v18, s[12:15], s57 offen offset:3072 lds
 v_mfma_f32_16x16x32_bf16 v[64:67], v[224:227], a[20:23], v[64:67]
 ds_read_b64_tr_b16 v[244:245], v11 offset:8192
 s_add_u32 m0, s64, 135168
 v_mfma_f32_16x16x32_bf16 v[96:99], v[224:227], a[24:27], v[96:99]
 ds_read_b64_tr_b16 v[246:247], v11 offset:9216
 s_add_u32 s57, s57, 32768
 v_mfma_f32_16x16x32_bf16 v[128:131], v[224:227], a[28:31], v[128:131]
 v_mfma_f32_16x16x32_bf16 v[36:39], v[228:231], a[16:19], v[36:39]
 ds_read_b64_tr_b16 v[248:249], v12 offset:8192
 v_mfma_f32_16x16x32_bf16 v[68:71], v[228:231], a[20:23], v[68:71]
 buffer_load_dwordx4 v15, s[12:15], s57 offen offset:0 lds
 v_mfma_f32_16x16x32_bf16 v[100:103], v[228:231], a[24:27], v[100:103]
 ds_read_b64_tr_b16 v[250:251], v12 offset:9216
 v_mfma_f32_16x16x32_bf16 v[132:135], v[228:231], a[28:31], v[132:135]
 buffer_load_dwordx4 v16, s[12:15], s57 offen offset:1024 lds
 v_mfma_f32_16x16x32_bf16 v[40:43], v[232:235], a[16:19], v[40:43]
 ds_read_b64_tr_b16 v[252:253], v13 offset:8192
 v_mfma_f32_16x16x32_bf16 v[72:75], v[232:235], a[20:23], v[72:75]
 buffer_load_dwordx4 v17, s[12:15], s57 offen offset:2048 lds
 v_mfma_f32_16x16x32_bf16 v[104:107], v[232:235], a[24:27], v[104:107]
 ds_read_b64_tr_b16 v[254:255], v13 offset:9216
 v_mfma_f32_16x16x32_bf16 v[136:139], v[232:235], a[28:31], v[136:139]
 s_waitcnt lgkmcnt(5)
 v_mfma_f32_16x16x32_bf16 v[44:47], v[236:239], a[16:19], v[44:47]
 buffer_load_dwordx4 v18, s[12:15], s57 offen offset:3072 lds
 v_mfma_f32_16x16x32_bf16 v[76:79], v[236:239], a[20:23], v[76:79]
 buffer_store_dwordx4 v[160:163], v195, s[4:7], s58 offen sc1
 v_mfma_f32_16x16x32_bf16 v[108:111], v[236:239], a[24:27], v[108:111]
 s_add_u32 s59, s58, 8192
 v_mfma_f32_16x16x32_bf16 v[140:143], v[236:239], a[28:31], v[140:143]
 buffer_store_dwordx4 v[164:167], v195, s[4:7], s59 offen sc1
 v_mfma_f32_16x16x32_bf16 v[48:51], v[240:243], a[16:19], v[48:51]
 s_add_u32 s58, s58, 16384
 s_lshl_b32 s59, s2, 11
 v_mfma_f32_16x16x32_bf16 v[80:83], v[240:243], a[20:23], v[80:83]
 s_add_u32 s59, s59, 38797312
 v_mfma_f32_16x16x32_bf16 v[112:115], v[240:243], a[24:27], v[112:115]
 s_cmp_eq_u32 s3, 2
 s_cselect_b32 s58, s59, s58
 v_mfma_f32_16x16x32_bf16 v[144:147], v[240:243], a[28:31], v[144:147]
 s_waitcnt lgkmcnt(1)
 v_mfma_f32_16x16x32_bf16 v[52:55], v[244:247], a[16:19], v[52:55]
 s_waitcnt vmcnt(14)
 s_waitcnt lgkmcnt(0)
 s_barrier
 v_mfma_f32_16x16x32_bf16 v[84:87], v[244:247], a[20:23], v[84:87]
 ds_read_b64_tr_b16 v[224:225], v6 offset:16384
 ds_read_b64_tr_b16 v[226:227], v6 offset:17408
 v_mfma_f32_16x16x32_bf16 v[116:119], v[244:247], a[24:27], v[116:119]
 s_cmp_eq_u32 s3, 3
 s_cselect_b32 s58, 268435456, s58
 buffer_store_dwordx4 v[168:171], v195, s[4:7], s58 offen sc1
 v_mfma_f32_16x16x32_bf16 v[148:151], v[244:247], a[28:31], v[148:151]
 ds_read_b64_tr_b16 v[228:229], v7 offset:16384
 ds_read_b64_tr_b16 v[230:231], v7 offset:17408
 v_mfma_f32_16x16x32_bf16 v[56:59], v[248:251], a[16:19], v[56:59]
 ds_read_b64_tr_b16 v[232:233], v8 offset:16384
 ds_read_b64_tr_b16 v[234:235], v8 offset:17408
 v_mfma_f32_16x16x32_bf16 v[88:91], v[248:251], a[20:23], v[88:91]
 ds_read_b128 a[32:35], v19 offset:32768
 ds_read_b128 a[36:39], v19 offset:34816
 v_mfma_f32_16x16x32_bf16 v[120:123], v[248:251], a[24:27], v[120:123]
 s_add_u32 m0, s65, 0
 ds_read_b64_tr_b16 v[236:237], v9 offset:16384
 v_mfma_f32_16x16x32_bf16 v[152:155], v[248:251], a[28:31], v[152:155]
 ds_read_b128 a[40:43], v19 offset:36864
 ds_read_b64_tr_b16 v[238:239], v9 offset:17408
 v_mfma_f32_16x16x32_bf16 v[60:63], v[252:255], a[16:19], v[60:63]
 ds_read_b128 a[44:47], v19 offset:38912
 s_add_u32 s56, s68, 1572864
 v_mfma_f32_16x16x32_bf16 v[92:95], v[252:255], a[20:23], v[92:95]
 s_and_b32 s56, s56, 4194303
 ds_read_b64_tr_b16 v[240:241], v10 offset:16384
 v_mfma_f32_16x16x32_bf16 v[124:127], v[252:255], a[24:27], v[124:127]
 ds_read_b64_tr_b16 v[242:243], v10 offset:17408
 s_add_u32 s56, s56, s63
 v_mfma_f32_16x16x32_bf16 v[156:159], v[252:255], a[28:31], v[156:159]
 ds_read_b128 a[48:51], v20 offset:32768
 s_waitcnt lgkmcnt(8)
 v_mfma_f32_16x16x32_bf16 v[32:35], v[224:227], a[32:35], v[32:35]
 ds_read_b128 a[52:55], v20 offset:34816
 s_waitcnt lgkmcnt(8)
 v_mfma_f32_16x16x32_bf16 v[64:67], v[224:227], a[36:39], v[64:67]
 s_waitcnt lgkmcnt(6)
 v_mfma_f32_16x16x32_bf16 v[96:99], v[224:227], a[40:43], v[96:99]
 s_waitcnt lgkmcnt(4)
 v_mfma_f32_16x16x32_bf16 v[128:131], v[224:227], a[44:47], v[128:131]
 buffer_load_dwordx4 v2, s[16:19], s56 offen offset:0 lds
 v_mfma_f32_16x16x32_bf16 v[36:39], v[228:231], a[32:35], v[36:39]
 ds_read_b64_tr_b16 v[244:245], v11 offset:16384
 ds_read_b128 a[56:59], v20 offset:36864
 v_mfma_f32_16x16x32_bf16 v[68:71], v[228:231], a[36:39], v[68:71]
 ds_read_b64_tr_b16 v[246:247], v11 offset:17408
 ds_read_b128 a[60:63], v20 offset:38912
 v_mfma_f32_16x16x32_bf16 v[100:103], v[228:231], a[40:43], v[100:103]
 buffer_load_dwordx4 v3, s[16:19], s56 offen offset:1024 lds
 v_mfma_f32_16x16x32_bf16 v[132:135], v[228:231], a[44:47], v[132:135]
 buffer_load_dwordx4 v4, s[16:19], s56 offen offset:2048 lds
 v_mfma_f32_16x16x32_bf16 v[40:43], v[232:235], a[32:35], v[40:43]
 ds_read_b64_tr_b16 v[248:249], v12 offset:16384
 ds_read_b64_tr_b16 v[250:251], v12 offset:17408
 v_mfma_f32_16x16x32_bf16 v[72:75], v[232:235], a[36:39], v[72:75]
 buffer_load_dwordx4 v5, s[16:19], s56 offen offset:3072 lds
 v_mfma_f32_16x16x32_bf16 v[104:107], v[232:235], a[40:43], v[104:107]
 s_add_u32 m0, s64, 65536
 ds_read_b64_tr_b16 v[252:253], v13 offset:16384
 v_mfma_f32_16x16x32_bf16 v[136:139], v[232:235], a[44:47], v[136:139]
 ds_read_b64_tr_b16 v[254:255], v13 offset:17408
 s_add_u32 s57, s69, 384
 v_mfma_f32_16x16x32_bf16 v[44:47], v[236:239], a[32:35], v[44:47]
 s_and_b32 s57, s57, 1023
 ds_read_b64_tr_b16 v[224:225], v6 offset:24576
 v_mfma_f32_16x16x32_bf16 v[76:79], v[236:239], a[36:39], v[76:79]
 ds_read_b64_tr_b16 v[226:227], v6 offset:25600
 s_add_u32 s57, s57, s62
 v_mfma_f32_16x16x32_bf16 v[108:111], v[236:239], a[40:43], v[108:111]
 v_mfma_f32_16x16x32_bf16 v[140:143], v[236:239], a[44:47], v[140:143]
 s_waitcnt lgkmcnt(7)
 v_mfma_f32_16x16x32_bf16 v[48:51], v[240:243], a[32:35], v[48:51]
 buffer_load_dwordx4 v15, s[12:15], s57 offen offset:0 lds
 v_mfma_f32_16x16x32_bf16 v[80:83], v[240:243], a[36:39], v[80:83]
 ds_read_b64_tr_b16 v[228:229], v7 offset:24576
 ds_read_b64_tr_b16 v[230:231], v7 offset:25600
 v_mfma_f32_16x16x32_bf16 v[112:115], v[240:243], a[40:43], v[112:115]
 buffer_load_dwordx4 v16, s[12:15], s57 offen offset:1024 lds
 v_mfma_f32_16x16x32_bf16 v[144:147], v[240:243], a[44:47], v[144:147]
 buffer_load_dwordx4 v17, s[12:15], s57 offen offset:2048 lds
 v_mfma_f32_16x16x32_bf16 v[52:55], v[244:247], a[32:35], v[52:55]
 ds_read_b64_tr_b16 v[232:233], v8 offset:24576
 ds_read_b64_tr_b16 v[234:235], v8 offset:25600
 v_mfma_f32_16x16x32_bf16 v[84:87], v[244:247], a[36:39], v[84:87]
 buffer_load_dwordx4 v18, s[12:15], s57 offen offset:3072 lds
 v_mfma_f32_16x16x32_bf16 v[116:119], v[244:247], a[40:43], v[116:119]
 v_mfma_f32_16x16x32_bf16 v[148:151], v[244:247], a[44:47], v[148:151]
 s_add_u32 m0, s64, 69632
 s_waitcnt lgkmcnt(4)
 v_mfma_f32_16x16x32_bf16 v[56:59], v[248:251], a[32:35], v[56:59]
 ds_read_b64_tr_b16 v[236:237], v9 offset:24576
 ds_read_b64_tr_b16 v[238:239], v9 offset:25600
 v_mfma_f32_16x16x32_bf16 v[88:91], v[248:251], a[36:39], v[88:91]
 s_add_u32 s57, s57, 32768
 v_mfma_f32_16x16x32_bf16 v[120:123], v[248:251], a[40:43], v[120:123]
 v_mfma_f32_16x16x32_bf16 v[152:155], v[248:251], a[44:47], v[152:155]
 buffer_load_dwordx4 v15, s[12:15], s57 offen offset:0 lds
 v_mfma_f32_16x16x32_bf16 v[60:63], v[252:255], a[32:35], v[60:63]
 ds_read_b64_tr_b16 v[240:241], v10 offset:24576
 ds_read_b64_tr_b16 v[242:243], v10 offset:25600
 v_mfma_f32_16x16x32_bf16 v[92:95], v[252:255], a[36:39], v[92:95]
 buffer_load_dwordx4 v16, s[12:15], s57 offen offset:1024 lds
 v_mfma_f32_16x16x32_bf16 v[124:127], v[252:255], a[40:43], v[124:127]
 v_mfma_f32_16x16x32_bf16 v[156:159], v[252:255], a[44:47], v[156:159]
 buffer_load_dwordx4 v17, s[12:15], s57 offen offset:2048 lds
 v_mfma_f32_16x16x32_bf16 v[32:35], v[224:227], a[48:51], v[32:35]
 ds_read_b64_tr_b16 v[244:245], v11 offset:24576
 ds_read_b64_tr_b16 v[246:247], v11 offset:25600
 v_mfma_f32_16x16x32_bf16 v[64:67], v[224:227], a[52:55], v[64:67]
 buffer_load_dwordx4 v18, s[12:15], s57 offen offset:3072 lds
 v_mfma_f32_16x16x32_bf16 v[96:99], v[224:227], a[56:59], v[96:99]
 v_mfma_f32_16x16x32_bf16 v[128:131], v[224:227], a[60:63], v[128:131]
 s_waitcnt lgkmcnt(4)
 v_mfma_f32_16x16x32_bf16 v[36:39], v[228:231], a[48:51], v[36:39]
 ds_read_b64_tr_b16 v[248:249], v12 offset:24576
 ds_read_b64_tr_b16 v[250:251], v12 offset:25600
 v_mfma_f32_16x16x32_bf16 v[68:71], v[228:231], a[52:55], v[68:71]
 v_mfma_f32_16x16x32_bf16 v[100:103], v[228:231], a[56:59], v[100:103]
 v_mfma_f32_16x16x32_bf16 v[132:135], v[228:231], a[60:63], v[132:135]
 v_mfma_f32_16x16x32_bf16 v[40:43], v[232:235], a[48:51], v[40:43]
 ds_read_b64_tr_b16 v[252:253], v13 offset:24576
 ds_read_b64_tr_b16 v[254:255], v13 offset:25600
 v_mfma_f32_16x16x32_bf16 v[72:75], v[232:235], a[52:55], v[72:75]
 v_mfma_f32_16x16x32_bf16 v[104:107], v[232:235], a[56:59], v[104:107]
 v_mfma_f32_16x16x32_bf16 v[136:139], v[232:235], a[60:63], v[136:139]
 v_mfma_f32_16x16x32_bf16 v[44:47], v[236:239], a[48:51], v[44:47]
 v_mfma_f32_16x16x32_bf16 v[76:79], v[236:239], a[52:55], v[76:79]
 v_mfma_f32_16x16x32_bf16 v[108:111], v[236:239], a[56:59], v[108:111]
 v_mfma_f32_16x16x32_bf16 v[140:143], v[236:239], a[60:63], v[140:143]
 s_waitcnt lgkmcnt(2)
 v_mfma_f32_16x16x32_bf16 v[48:51], v[240:243], a[48:51], v[48:51]
 v_mfma_f32_16x16x32_bf16 v[80:83], v[240:243], a[52:55], v[80:83]
 v_mfma_f32_16x16x32_bf16 v[112:115], v[240:243], a[56:59], v[112:115]
 v_mfma_f32_16x16x32_bf16 v[144:147], v[240:243], a[60:63], v[144:147]
 v_mfma_f32_16x16x32_bf16 v[52:55], v[244:247], a[48:51], v[52:55]
 s_waitcnt vmcnt(15)
 s_waitcnt lgkmcnt(0)
 s_barrier
 v_mfma_f32_16x16x32_bf16 v[84:87], v[244:247], a[52:55], v[84:87]
 ds_read_b64_tr_b16 v[224:225], v6 offset:32768
 ds_read_b64_tr_b16 v[226:227], v6 offset:33792
 v_mfma_f32_16x16x32_bf16 v[116:119], v[244:247], a[56:59], v[116:119]
 ds_read_b64_tr_b16 v[228:229], v7 offset:32768
 ds_read_b64_tr_b16 v[230:231], v7 offset:33792
 v_mfma_f32_16x16x32_bf16 v[148:151], v[244:247], a[60:63], v[148:151]
 ds_read_b64_tr_b16 v[232:233], v8 offset:32768
 ds_read_b64_tr_b16 v[234:235], v8 offset:33792
 v_mfma_f32_16x16x32_bf16 v[56:59], v[248:251], a[48:51], v[56:59]
 ds_read_b128 a[64:67], v21 offset:0
 ds_read_b128 a[68:71], v21 offset:2048
 v_mfma_f32_16x16x32_bf16 v[88:91], v[248:251], a[52:55], v[88:91]
 s_add_u32 m0, s65, 16384
 ds_read_b64_tr_b16 v[236:237], v9 offset:32768
 v_mfma_f32_16x16x32_bf16 v[120:123], v[248:251], a[56:59], v[120:123]
 ds_read_b128 a[72:75], v21 offset:4096
 ds_read_b64_tr_b16 v[238:239], v9 offset:33792
 v_mfma_f32_16x16x32_bf16 v[152:155], v[248:251], a[60:63], v[152:155]
 ds_read_b128 a[76:79], v21 offset:6144
 s_add_u32 s56, s68, 2097152
 v_mfma_f32_16x16x32_bf16 v[60:63], v[252:255], a[48:51], v[60:63]
 s_and_b32 s56, s56, 4194303
 ds_read_b64_tr_b16 v[240:241], v10 offset:32768
 v_mfma_f32_16x16x32_bf16 v[92:95], v[252:255], a[52:55], v[92:95]
 ds_read_b64_tr_b16 v[242:243], v10 offset:33792
 s_add_u32 s56, s56, s63
 v_mfma_f32_16x16x32_bf16 v[124:127], v[252:255], a[56:59], v[124:127]
 ds_read_b128 a[80:83], v22 offset:0
 v_mfma_f32_16x16x32_bf16 v[156:159], v[252:255], a[60:63], v[156:159]
 ds_read_b128 a[84:87], v22 offset:2048
 s_waitcnt lgkmcnt(9)
 v_mfma_f32_16x16x32_bf16 v[32:35], v[224:227], a[64:67], v[32:35]
 s_waitcnt lgkmcnt(8)
 v_mfma_f32_16x16x32_bf16 v[64:67], v[224:227], a[68:71], v[64:67]
 s_waitcnt lgkmcnt(6)
 v_mfma_f32_16x16x32_bf16 v[96:99], v[224:227], a[72:75], v[96:99]
 s_waitcnt lgkmcnt(4)
 v_mfma_f32_16x16x32_bf16 v[128:131], v[224:227], a[76:79], v[128:131]
 buffer_load_dwordx4 v2, s[16:19], s56 offen offset:0 lds
 v_mfma_f32_16x16x32_bf16 v[36:39], v[228:231], a[64:67], v[36:39]
 ds_read_b64_tr_b16 v[244:245], v11 offset:32768
 ds_read_b128 a[88:91], v22 offset:4096
 v_mfma_f32_16x16x32_bf16 v[68:71], v[228:231], a[68:71], v[68:71]
 ds_read_b64_tr_b16 v[246:247], v11 offset:33792
 ds_read_b128 a[92:95], v22 offset:6144
 v_mfma_f32_16x16x32_bf16 v[100:103], v[228:231], a[72:75], v[100:103]
 buffer_load_dwordx4 v3, s[16:19], s56 offen offset:1024 lds
 v_mfma_f32_16x16x32_bf16 v[132:135], v[228:231], a[76:79], v[132:135]
 buffer_load_dwordx4 v4, s[16:19], s56 offen offset:2048 lds
 v_mfma_f32_16x16x32_bf16 v[40:43], v[232:235], a[64:67], v[40:43]
 ds_read_b64_tr_b16 v[248:249], v12 offset:32768
 ds_read_b64_tr_b16 v[250:251], v12 offset:33792
 v_mfma_f32_16x16x32_bf16 v[72:75], v[232:235], a[68:71], v[72:75]
 buffer_load_dwordx4 v5, s[16:19], s56 offen offset:3072 lds
 v_mfma_f32_16x16x32_bf16 v[104:107], v[232:235], a[72:75], v[104:107]
 s_add_u32 m0, s64, 98304
 ds_read_b64_tr_b16 v[252:253], v13 offset:32768
 v_mfma_f32_16x16x32_bf16 v[136:139], v[232:235], a[76:79], v[136:139]
 ds_read_b64_tr_b16 v[254:255], v13 offset:33792
 s_add_u32 s57, s69, 512
 v_mfma_f32_16x16x32_bf16 v[44:47], v[236:239], a[64:67], v[44:47]
 s_and_b32 s57, s57, 1023
 ds_read_b64_tr_b16 v[224:225], v6 offset:40960
 v_mfma_f32_16x16x32_bf16 v[76:79], v[236:239], a[68:71], v[76:79]
 ds_read_b64_tr_b16 v[226:227], v6 offset:41984
 s_add_u32 s57, s57, s62
 v_mfma_f32_16x16x32_bf16 v[108:111], v[236:239], a[72:75], v[108:111]
 v_mfma_f32_16x16x32_bf16 v[140:143], v[236:239], a[76:79], v[140:143]
 s_waitcnt lgkmcnt(7)
 v_mfma_f32_16x16x32_bf16 v[48:51], v[240:243], a[64:67], v[48:51]
 buffer_load_dwordx4 v15, s[12:15], s57 offen offset:0 lds
 v_mfma_f32_16x16x32_bf16 v[80:83], v[240:243], a[68:71], v[80:83]
 ds_read_b64_tr_b16 v[228:229], v7 offset:40960
 ds_read_b64_tr_b16 v[230:231], v7 offset:41984
 v_mfma_f32_16x16x32_bf16 v[112:115], v[240:243], a[72:75], v[112:115]
 buffer_load_dwordx4 v16, s[12:15], s57 offen offset:1024 lds
 v_mfma_f32_16x16x32_bf16 v[144:147], v[240:243], a[76:79], v[144:147]
 buffer_load_dwordx4 v17, s[12:15], s57 offen offset:2048 lds
 v_mfma_f32_16x16x32_bf16 v[52:55], v[244:247], a[64:67], v[52:55]
 ds_read_b64_tr_b16 v[232:233], v8 offset:40960
 ds_read_b64_tr_b16 v[234:235], v8 offset:41984
 v_mfma_f32_16x16x32_bf16 v[84:87], v[244:247], a[68:71], v[84:87]
 buffer_load_dwordx4 v18, s[12:15], s57 offen offset:3072 lds
 v_mfma_f32_16x16x32_bf16 v[116:119], v[244:247], a[72:75], v[116:119]
 v_mfma_f32_16x16x32_bf16 v[148:151], v[244:247], a[76:79], v[148:151]
 s_add_u32 m0, s64, 102400
 s_waitcnt lgkmcnt(4)
 v_mfma_f32_16x16x32_bf16 v[56:59], v[248:251], a[64:67], v[56:59]
 ds_read_b64_tr_b16 v[236:237], v9 offset:40960
 ds_read_b64_tr_b16 v[238:239], v9 offset:41984
 v_mfma_f32_16x16x32_bf16 v[88:91], v[248:251], a[68:71], v[88:91]
 s_add_u32 s57, s57, 32768
 v_mfma_f32_16x16x32_bf16 v[120:123], v[248:251], a[72:75], v[120:123]
 v_mfma_f32_16x16x32_bf16 v[152:155], v[248:251], a[76:79], v[152:155]
 buffer_load_dwordx4 v15, s[12:15], s57 offen offset:0 lds
 v_mfma_f32_16x16x32_bf16 v[60:63], v[252:255], a[64:67], v[60:63]
 ds_read_b64_tr_b16 v[240:241], v10 offset:40960
 ds_read_b64_tr_b16 v[242:243], v10 offset:41984
 v_mfma_f32_16x16x32_bf16 v[92:95], v[252:255], a[68:71], v[92:95]
 buffer_load_dwordx4 v16, s[12:15], s57 offen offset:1024 lds
 v_mfma_f32_16x16x32_bf16 v[124:127], v[252:255], a[72:75], v[124:127]
 v_mfma_f32_16x16x32_bf16 v[156:159], v[252:255], a[76:79], v[156:159]
 buffer_load_dwordx4 v17, s[12:15], s57 offen offset:2048 lds
 v_mfma_f32_16x16x32_bf16 v[32:35], v[224:227], a[80:83], v[32:35]
 ds_read_b64_tr_b16 v[244:245], v11 offset:40960
 ds_read_b64_tr_b16 v[246:247], v11 offset:41984
 v_mfma_f32_16x16x32_bf16 v[64:67], v[224:227], a[84:87], v[64:67]
 buffer_load_dwordx4 v18, s[12:15], s57 offen offset:3072 lds
 v_mfma_f32_16x16x32_bf16 v[96:99], v[224:227], a[88:91], v[96:99]
 v_mfma_f32_16x16x32_bf16 v[128:131], v[224:227], a[92:95], v[128:131]
 s_waitcnt lgkmcnt(4)
 v_mfma_f32_16x16x32_bf16 v[36:39], v[228:231], a[80:83], v[36:39]
 ds_read_b64_tr_b16 v[248:249], v12 offset:40960
 ds_read_b64_tr_b16 v[250:251], v12 offset:41984
 v_mfma_f32_16x16x32_bf16 v[68:71], v[228:231], a[84:87], v[68:71]
 v_mfma_f32_16x16x32_bf16 v[100:103], v[228:231], a[88:91], v[100:103]
 v_mfma_f32_16x16x32_bf16 v[132:135], v[228:231], a[92:95], v[132:135]
 v_mfma_f32_16x16x32_bf16 v[40:43], v[232:235], a[80:83], v[40:43]
 ds_read_b64_tr_b16 v[252:253], v13 offset:40960
 ds_read_b64_tr_b16 v[254:255], v13 offset:41984
 v_mfma_f32_16x16x32_bf16 v[72:75], v[232:235], a[84:87], v[72:75]
 v_mfma_f32_16x16x32_bf16 v[104:107], v[232:235], a[88:91], v[104:107]
 v_mfma_f32_16x16x32_bf16 v[136:139], v[232:235], a[92:95], v[136:139]
 v_mfma_f32_16x16x32_bf16 v[44:47], v[236:239], a[80:83], v[44:47]
 v_mfma_f32_16x16x32_bf16 v[76:79], v[236:239], a[84:87], v[76:79]
 v_mfma_f32_16x16x32_bf16 v[108:111], v[236:239], a[88:91], v[108:111]
 v_mfma_f32_16x16x32_bf16 v[140:143], v[236:239], a[92:95], v[140:143]
 s_waitcnt lgkmcnt(2)
 v_mfma_f32_16x16x32_bf16 v[48:51], v[240:243], a[80:83], v[48:51]
 v_mfma_f32_16x16x32_bf16 v[80:83], v[240:243], a[84:87], v[80:83]
 v_mfma_f32_16x16x32_bf16 v[112:115], v[240:243], a[88:91], v[112:115]
 v_mfma_f32_16x16x32_bf16 v[144:147], v[240:243], a[92:95], v[144:147]
 v_mfma_f32_16x16x32_bf16 v[52:55], v[244:247], a[80:83], v[52:55]
 s_waitcnt vmcnt(12)
 s_waitcnt lgkmcnt(0)
 s_barrier
 buffer_store_dword v27, v26, s[4:7], s71 offen sc1
 v_mfma_f32_16x16x32_bf16 v[84:87], v[244:247], a[84:87], v[84:87]
 ds_read_b64_tr_b16 v[224:225], v6 offset:0
 ds_read_b64_tr_b16 v[226:227], v6 offset:1024
 v_mfma_f32_16x16x32_bf16 v[116:119], v[244:247], a[88:91], v[116:119]
 ds_read_b64_tr_b16 v[228:229], v7 offset:0
 ds_read_b64_tr_b16 v[230:231], v7 offset:1024
 v_mfma_f32_16x16x32_bf16 v[148:151], v[244:247], a[92:95], v[148:151]
 ds_read_b64_tr_b16 v[232:233], v8 offset:0
 ds_read_b64_tr_b16 v[234:235], v8 offset:1024
 v_mfma_f32_16x16x32_bf16 v[56:59], v[248:251], a[80:83], v[56:59]
 ds_read_b128 a[96:99], v19 offset:0
 ds_read_b128 a[100:103], v19 offset:2048
 v_mfma_f32_16x16x32_bf16 v[88:91], v[248:251], a[84:87], v[88:91]
 s_add_u32 m0, s65, 32768
 ds_read_b64_tr_b16 v[236:237], v9 offset:0
 v_mfma_f32_16x16x32_bf16 v[120:123], v[248:251], a[88:91], v[120:123]
 ds_read_b128 a[104:107], v19 offset:4096
 ds_read_b64_tr_b16 v[238:239], v9 offset:1024
 v_mfma_f32_16x16x32_bf16 v[152:155], v[248:251], a[92:95], v[152:155]
 ds_read_b128 a[108:111], v19 offset:6144
 s_add_u32 s56, s68, 2621440
 v_mfma_f32_16x16x32_bf16 v[60:63], v[252:255], a[80:83], v[60:63]
 s_and_b32 s56, s56, 4194303
 ds_read_b64_tr_b16 v[240:241], v10 offset:0
 v_mfma_f32_16x16x32_bf16 v[92:95], v[252:255], a[84:87], v[92:95]
 ds_read_b64_tr_b16 v[242:243], v10 offset:1024
 s_add_u32 s56, s56, s63
 v_mfma_f32_16x16x32_bf16 v[124:127], v[252:255], a[88:91], v[124:127]
 ds_read_b128 a[112:115], v20 offset:0
 v_mfma_f32_16x16x32_bf16 v[156:159], v[252:255], a[92:95], v[156:159]
 ds_read_b128 a[116:119], v20 offset:2048
 s_waitcnt lgkmcnt(9)
 v_mfma_f32_16x16x32_bf16 v[32:35], v[224:227], a[96:99], v[32:35]
 s_waitcnt lgkmcnt(8)
 v_mfma_f32_16x16x32_bf16 v[64:67], v[224:227], a[100:103], v[64:67]
 s_waitcnt lgkmcnt(6)
 v_mfma_f32_16x16x32_bf16 v[96:99], v[224:227], a[104:107], v[96:99]
 s_waitcnt lgkmcnt(4)
 v_mfma_f32_16x16x32_bf16 v[128:131], v[224:227], a[108:111], v[128:131]
 buffer_load_dwordx4 v2, s[16:19], s56 offen offset:0 lds
 v_mfma_f32_16x16x32_bf16 v[36:39], v[228:231], a[96:99], v[36:39]
 ds_read_b64_tr_b16 v[244:245], v11 offset:0
 ds_read_b128 a[120:123], v20 offset:4096
 v_mfma_f32_16x16x32_bf16 v[68:71], v[228:231], a[100:103], v[68:71]
 ds_read_b64_tr_b16 v[246:247], v11 offset:1024
 ds_read_b128 a[124:127], v20 offset:6144
 v_mfma_f32_16x16x32_bf16 v[100:103], v[228:231], a[104:107], v[100:103]
 buffer_load_dwordx4 v3, s[16:19], s56 offen offset:1024 lds
 v_mfma_f32_16x16x32_bf16 v[132:135], v[228:231], a[108:111], v[132:135]
 buffer_load_dwordx4 v4, s[16:19], s56 offen offset:2048 lds
 v_mfma_f32_16x16x32_bf16 v[40:43], v[232:235], a[96:99], v[40:43]
 ds_read_b64_tr_b16 v[248:249], v12 offset:0
 ds_read_b64_tr_b16 v[250:251], v12 offset:1024
 v_mfma_f32_16x16x32_bf16 v[72:75], v[232:235], a[100:103], v[72:75]
 buffer_load_dwordx4 v5, s[16:19], s56 offen offset:3072 lds
 v_mfma_f32_16x16x32_bf16 v[104:107], v[232:235], a[104:107], v[104:107]
 s_add_u32 m0, s64, 131072
 ds_read_b64_tr_b16 v[252:253], v13 offset:0
 v_mfma_f32_16x16x32_bf16 v[136:139], v[232:235], a[108:111], v[136:139]
 ds_read_b64_tr_b16 v[254:255], v13 offset:1024
 s_add_u32 s57, s69, 640
 v_mfma_f32_16x16x32_bf16 v[44:47], v[236:239], a[96:99], v[44:47]
 s_and_b32 s57, s57, 1023
 ds_read_b64_tr_b16 v[224:225], v6 offset:8192
 v_mfma_f32_16x16x32_bf16 v[76:79], v[236:239], a[100:103], v[76:79]
 ds_read_b64_tr_b16 v[226:227], v6 offset:9216
 s_add_u32 s57, s57, s62
 v_mfma_f32_16x16x32_bf16 v[108:111], v[236:239], a[104:107], v[108:111]
 v_mfma_f32_16x16x32_bf16 v[140:143], v[236:239], a[108:111], v[140:143]
 s_waitcnt lgkmcnt(7)
 v_mfma_f32_16x16x32_bf16 v[48:51], v[240:243], a[96:99], v[48:51]
 buffer_load_dwordx4 v15, s[12:15], s57 offen offset:0 lds
 v_mfma_f32_16x16x32_bf16 v[80:83], v[240:243], a[100:103], v[80:83]
 ds_read_b64_tr_b16 v[228:229], v7 offset:8192
 ds_read_b64_tr_b16 v[230:231], v7 offset:9216
 v_mfma_f32_16x16x32_bf16 v[112:115], v[240:243], a[104:107], v[112:115]
 buffer_load_dwordx4 v16, s[12:15], s57 offen offset:1024 lds
 v_mfma_f32_16x16x32_bf16 v[144:147], v[240:243], a[108:111], v[144:147]
 buffer_load_dwordx4 v17, s[12:15], s57 offen offset:2048 lds
 v_mfma_f32_16x16x32_bf16 v[52:55], v[244:247], a[96:99], v[52:55]
 ds_read_b64_tr_b16 v[232:233], v8 offset:8192
 ds_read_b64_tr_b16 v[234:235], v8 offset:9216
 v_mfma_f32_16x16x32_bf16 v[84:87], v[244:247], a[100:103], v[84:87]
 buffer_load_dwordx4 v18, s[12:15], s57 offen offset:3072 lds
 v_mfma_f32_16x16x32_bf16 v[116:119], v[244:247], a[104:107], v[116:119]
 v_mfma_f32_16x16x32_bf16 v[148:151], v[244:247], a[108:111], v[148:151]
 s_add_u32 m0, s64, 135168
 s_waitcnt lgkmcnt(4)
 v_mfma_f32_16x16x32_bf16 v[56:59], v[248:251], a[96:99], v[56:59]
 ds_read_b64_tr_b16 v[236:237], v9 offset:8192
 ds_read_b64_tr_b16 v[238:239], v9 offset:9216
 v_mfma_f32_16x16x32_bf16 v[88:91], v[248:251], a[100:103], v[88:91]
 s_add_u32 s57, s57, 32768
 v_mfma_f32_16x16x32_bf16 v[120:123], v[248:251], a[104:107], v[120:123]
 v_mfma_f32_16x16x32_bf16 v[152:155], v[248:251], a[108:111], v[152:155]
 buffer_load_dwordx4 v15, s[12:15], s57 offen offset:0 lds
 v_mfma_f32_16x16x32_bf16 v[60:63], v[252:255], a[96:99], v[60:63]
 ds_read_b64_tr_b16 v[240:241], v10 offset:8192
 ds_read_b64_tr_b16 v[242:243], v10 offset:9216
 v_mfma_f32_16x16x32_bf16 v[92:95], v[252:255], a[100:103], v[92:95]
 buffer_load_dwordx4 v16, s[12:15], s57 offen offset:1024 lds
 v_mfma_f32_16x16x32_bf16 v[124:127], v[252:255], a[104:107], v[124:127]
 v_mfma_f32_16x16x32_bf16 v[156:159], v[252:255], a[108:111], v[156:159]
 buffer_load_dwordx4 v17, s[12:15], s57 offen offset:2048 lds
 v_mfma_f32_16x16x32_bf16 v[32:35], v[224:227], a[112:115], v[32:35]
 ds_read_b64_tr_b16 v[244:245], v11 offset:8192
 ds_read_b64_tr_b16 v[246:247], v11 offset:9216
 v_mfma_f32_16x16x32_bf16 v[64:67], v[224:227], a[116:119], v[64:67]
 buffer_load_dwordx4 v18, s[12:15], s57 offen offset:3072 lds
 v_mfma_f32_16x16x32_bf16 v[96:99], v[224:227], a[120:123], v[96:99]
 v_mfma_f32_16x16x32_bf16 v[128:131], v[224:227], a[124:127], v[128:131]
 s_waitcnt lgkmcnt(4)
 v_mfma_f32_16x16x32_bf16 v[36:39], v[228:231], a[112:115], v[36:39]
 ds_read_b64_tr_b16 v[248:249], v12 offset:8192
 ds_read_b64_tr_b16 v[250:251], v12 offset:9216
 v_mfma_f32_16x16x32_bf16 v[68:71], v[228:231], a[116:119], v[68:71]
 s_add_u32 m0, s65, 49152
 v_mfma_f32_16x16x32_bf16 v[100:103], v[228:231], a[120:123], v[100:103]
 s_add_u32 s56, s68, 0
 v_mfma_f32_16x16x32_bf16 v[132:135], v[228:231], a[124:127], v[132:135]
 v_mfma_f32_16x16x32_bf16 v[40:43], v[232:235], a[112:115], v[40:43]
 ds_read_b64_tr_b16 v[252:253], v13 offset:8192
 ds_read_b64_tr_b16 v[254:255], v13 offset:9216
 v_mfma_f32_16x16x32_bf16 v[72:75], v[232:235], a[116:119], v[72:75]
 s_and_b32 s56, s56, 4194303
 s_add_u32 s56, s56, s63
 v_mfma_f32_16x16x32_bf16 v[104:107], v[232:235], a[120:123], v[104:107]
 v_mfma_f32_16x16x32_bf16 v[136:139], v[232:235], a[124:127], v[136:139]
 buffer_load_dwordx4 v2, s[20:23], s56 offen offset:0 lds
 v_mfma_f32_16x16x32_bf16 v[44:47], v[236:239], a[112:115], v[44:47]
 v_mfma_f32_16x16x32_bf16 v[76:79], v[236:239], a[116:119], v[76:79]
 buffer_load_dwordx4 v3, s[20:23], s56 offen offset:1024 lds
 v_mfma_f32_16x16x32_bf16 v[108:111], v[236:239], a[120:123], v[108:111]
 buffer_load_dwordx4 v4, s[20:23], s56 offen offset:2048 lds
 v_mfma_f32_16x16x32_bf16 v[140:143], v[236:239], a[124:127], v[140:143]
 s_waitcnt lgkmcnt(2)
 v_mfma_f32_16x16x32_bf16 v[48:51], v[240:243], a[112:115], v[48:51]
 buffer_load_dwordx4 v5, s[20:23], s56 offen offset:3072 lds
 v_mfma_f32_16x16x32_bf16 v[80:83], v[240:243], a[116:119], v[80:83]
 v_mfma_f32_16x16x32_bf16 v[112:115], v[240:243], a[120:123], v[112:115]
 v_mfma_f32_16x16x32_bf16 v[144:147], v[240:243], a[124:127], v[144:147]
 v_mfma_f32_16x16x32_bf16 v[52:55], v[244:247], a[112:115], v[52:55]
 s_waitcnt vmcnt(17)
 s_waitcnt lgkmcnt(0)
 s_barrier
 v_mfma_f32_16x16x32_bf16 v[84:87], v[244:247], a[116:119], v[84:87]
 ds_read_b64_tr_b16 v[224:225], v6 offset:16384
 ds_read_b64_tr_b16 v[226:227], v6 offset:17408
 v_mfma_f32_16x16x32_bf16 v[116:119], v[244:247], a[120:123], v[116:119]
 ds_read_b64_tr_b16 v[228:229], v7 offset:16384
 ds_read_b64_tr_b16 v[230:231], v7 offset:17408
 v_mfma_f32_16x16x32_bf16 v[148:151], v[244:247], a[124:127], v[148:151]
 ds_read_b64_tr_b16 v[232:233], v8 offset:16384
 ds_read_b64_tr_b16 v[234:235], v8 offset:17408
 v_mfma_f32_16x16x32_bf16 v[56:59], v[248:251], a[112:115], v[56:59]
 ds_read_b128 a[128:131], v19 offset:32768
 ds_read_b128 a[132:135], v19 offset:34816
 v_mfma_f32_16x16x32_bf16 v[88:91], v[248:251], a[116:119], v[88:91]
 s_add_u32 m0, s65, 0
 ds_read_b64_tr_b16 v[236:237], v9 offset:16384
 v_mfma_f32_16x16x32_bf16 v[120:123], v[248:251], a[120:123], v[120:123]
 ds_read_b128 a[136:139], v19 offset:36864
 ds_read_b64_tr_b16 v[238:239], v9 offset:17408
 v_mfma_f32_16x16x32_bf16 v[152:155], v[248:251], a[124:127], v[152:155]
 ds_read_b128 a[140:143], v19 offset:38912
 s_add_u32 s56, s68, 3145728
 v_mfma_f32_16x16x32_bf16 v[60:63], v[252:255], a[112:115], v[60:63]
 s_and_b32 s56, s56, 4194303
 ds_read_b64_tr_b16 v[240:241], v10 offset:16384
 v_mfma_f32_16x16x32_bf16 v[92:95], v[252:255], a[116:119], v[92:95]
 ds_read_b64_tr_b16 v[242:243], v10 offset:17408
 s_add_u32 s56, s56, s63
 v_mfma_f32_16x16x32_bf16 v[124:127], v[252:255], a[120:123], v[124:127]
 ds_read_b128 a[144:147], v20 offset:32768
 v_mfma_f32_16x16x32_bf16 v[156:159], v[252:255], a[124:127], v[156:159]
 ds_read_b128 a[148:151], v20 offset:34816
 s_waitcnt lgkmcnt(9)
 v_mfma_f32_16x16x32_bf16 v[32:35], v[224:227], a[128:131], v[32:35]
 s_waitcnt lgkmcnt(8)
 v_mfma_f32_16x16x32_bf16 v[64:67], v[224:227], a[132:135], v[64:67]
 s_waitcnt lgkmcnt(6)
 v_mfma_f32_16x16x32_bf16 v[96:99], v[224:227], a[136:139], v[96:99]
 s_waitcnt lgkmcnt(4)
 v_mfma_f32_16x16x32_bf16 v[128:131], v[224:227], a[140:143], v[128:131]
 buffer_load_dwordx4 v2, s[16:19], s56 offen offset:0 lds
 v_mfma_f32_16x16x32_bf16 v[36:39], v[228:231], a[128:131], v[36:39]
 ds_read_b64_tr_b16 v[244:245], v11 offset:16384
 ds_read_b128 a[152:155], v20 offset:36864
 v_mfma_f32_16x16x32_bf16 v[68:71], v[228:231], a[132:135], v[68:71]
 ds_read_b64_tr_b16 v[246:247], v11 offset:17408
 ds_read_b128 a[156:159], v20 offset:38912
 v_mfma_f32_16x16x32_bf16 v[100:103], v[228:231], a[136:139], v[100:103]
 buffer_load_dwordx4 v3, s[16:19], s56 offen offset:1024 lds
 v_mfma_f32_16x16x32_bf16 v[132:135], v[228:231], a[140:143], v[132:135]
 buffer_load_dwordx4 v4, s[16:19], s56 offen offset:2048 lds
 v_mfma_f32_16x16x32_bf16 v[40:43], v[232:235], a[128:131], v[40:43]
 ds_read_b64_tr_b16 v[248:249], v12 offset:16384
 ds_read_b64_tr_b16 v[250:251], v12 offset:17408
 v_mfma_f32_16x16x32_bf16 v[72:75], v[232:235], a[132:135], v[72:75]
 buffer_load_dwordx4 v5, s[16:19], s56 offen offset:3072 lds
 v_mfma_f32_16x16x32_bf16 v[104:107], v[232:235], a[136:139], v[104:107]
 s_add_u32 m0, s64, 65536
 ds_read_b64_tr_b16 v[252:253], v13 offset:16384
 v_mfma_f32_16x16x32_bf16 v[136:139], v[232:235], a[140:143], v[136:139]
 ds_read_b64_tr_b16 v[254:255], v13 offset:17408
 s_add_u32 s57, s69, 768
 v_mfma_f32_16x16x32_bf16 v[44:47], v[236:239], a[128:131], v[44:47]
 s_and_b32 s57, s57, 1023
 ds_read_b64_tr_b16 v[224:225], v6 offset:24576
 v_mfma_f32_16x16x32_bf16 v[76:79], v[236:239], a[132:135], v[76:79]
 ds_read_b64_tr_b16 v[226:227], v6 offset:25600
 s_add_u32 s57, s57, s62
 v_mfma_f32_16x16x32_bf16 v[108:111], v[236:239], a[136:139], v[108:111]
 v_mfma_f32_16x16x32_bf16 v[140:143], v[236:239], a[140:143], v[140:143]
 s_waitcnt lgkmcnt(7)
 v_mfma_f32_16x16x32_bf16 v[48:51], v[240:243], a[128:131], v[48:51]
 buffer_load_dwordx4 v15, s[12:15], s57 offen offset:0 lds
 v_mfma_f32_16x16x32_bf16 v[80:83], v[240:243], a[132:135], v[80:83]
 ds_read_b64_tr_b16 v[228:229], v7 offset:24576
 ds_read_b64_tr_b16 v[230:231], v7 offset:25600
 v_mfma_f32_16x16x32_bf16 v[112:115], v[240:243], a[136:139], v[112:115]
 buffer_load_dwordx4 v16, s[12:15], s57 offen offset:1024 lds
 v_mfma_f32_16x16x32_bf16 v[144:147], v[240:243], a[140:143], v[144:147]
 buffer_load_dwordx4 v17, s[12:15], s57 offen offset:2048 lds
 v_mfma_f32_16x16x32_bf16 v[52:55], v[244:247], a[128:131], v[52:55]
 ds_read_b64_tr_b16 v[232:233], v8 offset:24576
 ds_read_b64_tr_b16 v[234:235], v8 offset:25600
 v_mfma_f32_16x16x32_bf16 v[84:87], v[244:247], a[132:135], v[84:87]
 buffer_load_dwordx4 v18, s[12:15], s57 offen offset:3072 lds
 v_mfma_f32_16x16x32_bf16 v[116:119], v[244:247], a[136:139], v[116:119]
 v_mfma_f32_16x16x32_bf16 v[148:151], v[244:247], a[140:143], v[148:151]
 s_add_u32 m0, s64, 69632
 s_waitcnt lgkmcnt(4)
 v_mfma_f32_16x16x32_bf16 v[56:59], v[248:251], a[128:131], v[56:59]
 ds_read_b64_tr_b16 v[236:237], v9 offset:24576
 ds_read_b64_tr_b16 v[238:239], v9 offset:25600
 v_mfma_f32_16x16x32_bf16 v[88:91], v[248:251], a[132:135], v[88:91]
 s_add_u32 s57, s57, 32768
 v_mfma_f32_16x16x32_bf16 v[120:123], v[248:251], a[136:139], v[120:123]
 v_mfma_f32_16x16x32_bf16 v[152:155], v[248:251], a[140:143], v[152:155]
 buffer_load_dwordx4 v15, s[12:15], s57 offen offset:0 lds
 v_mfma_f32_16x16x32_bf16 v[60:63], v[252:255], a[128:131], v[60:63]
 ds_read_b64_tr_b16 v[240:241], v10 offset:24576
 ds_read_b64_tr_b16 v[242:243], v10 offset:25600
 v_mfma_f32_16x16x32_bf16 v[92:95], v[252:255], a[132:135], v[92:95]
 buffer_load_dwordx4 v16, s[12:15], s57 offen offset:1024 lds
 v_mfma_f32_16x16x32_bf16 v[124:127], v[252:255], a[136:139], v[124:127]
 v_mfma_f32_16x16x32_bf16 v[156:159], v[252:255], a[140:143], v[156:159]
 buffer_load_dwordx4 v17, s[12:15], s57 offen offset:2048 lds
 v_mfma_f32_16x16x32_bf16 v[32:35], v[224:227], a[144:147], v[32:35]
 ds_read_b64_tr_b16 v[244:245], v11 offset:24576
 ds_read_b64_tr_b16 v[246:247], v11 offset:25600
 v_mfma_f32_16x16x32_bf16 v[64:67], v[224:227], a[148:151], v[64:67]
 buffer_load_dwordx4 v18, s[12:15], s57 offen offset:3072 lds
 v_mfma_f32_16x16x32_bf16 v[96:99], v[224:227], a[152:155], v[96:99]
 v_mfma_f32_16x16x32_bf16 v[128:131], v[224:227], a[156:159], v[128:131]
 s_waitcnt lgkmcnt(4)
 v_mfma_f32_16x16x32_bf16 v[36:39], v[228:231], a[144:147], v[36:39]
 ds_read_b64_tr_b16 v[248:249], v12 offset:24576
 ds_read_b64_tr_b16 v[250:251], v12 offset:25600
 v_mfma_f32_16x16x32_bf16 v[68:71], v[228:231], a[148:151], v[68:71]
 v_mfma_f32_16x16x32_bf16 v[100:103], v[228:231], a[152:155], v[100:103]
 v_mfma_f32_16x16x32_bf16 v[132:135], v[228:231], a[156:159], v[132:135]
 v_mfma_f32_16x16x32_bf16 v[40:43], v[232:235], a[144:147], v[40:43]
 ds_read_b64_tr_b16 v[252:253], v13 offset:24576
 ds_read_b64_tr_b16 v[254:255], v13 offset:25600
 v_mfma_f32_16x16x32_bf16 v[72:75], v[232:235], a[148:151], v[72:75]
 v_mfma_f32_16x16x32_bf16 v[104:107], v[232:235], a[152:155], v[104:107]
 v_mfma_f32_16x16x32_bf16 v[136:139], v[232:235], a[156:159], v[136:139]
 v_mfma_f32_16x16x32_bf16 v[44:47], v[236:239], a[144:147], v[44:47]
 v_mfma_f32_16x16x32_bf16 v[76:79], v[236:239], a[148:151], v[76:79]
 v_mfma_f32_16x16x32_bf16 v[108:111], v[236:239], a[152:155], v[108:111]
 v_mfma_f32_16x16x32_bf16 v[140:143], v[236:239], a[156:159], v[140:143]
 s_waitcnt lgkmcnt(2)
 v_mfma_f32_16x16x32_bf16 v[48:51], v[240:243], a[144:147], v[48:51]
 v_mfma_f32_16x16x32_bf16 v[80:83], v[240:243], a[148:151], v[80:83]
 v_mfma_f32_16x16x32_bf16 v[112:115], v[240:243], a[152:155], v[112:115]
 v_mfma_f32_16x16x32_bf16 v[144:147], v[240:243], a[156:159], v[144:147]
 v_mfma_f32_16x16x32_bf16 v[52:55], v[244:247], a[144:147], v[52:55]
 s_waitcnt vmcnt(16)
 s_waitcnt lgkmcnt(0)
 s_barrier
 v_mfma_f32_16x16x32_bf16 v[84:87], v[244:247], a[148:151], v[84:87]
 ds_read_b64_tr_b16 v[224:225], v6 offset:32768
 ds_read_b64_tr_b16 v[226:227], v6 offset:33792
 v_mfma_f32_16x16x32_bf16 v[116:119], v[244:247], a[152:155], v[116:119]
 ds_read_b64_tr_b16 v[228:229], v7 offset:32768
 ds_read_b64_tr_b16 v[230:231], v7 offset:33792
 v_mfma_f32_16x16x32_bf16 v[148:151], v[244:247], a[156:159], v[148:151]
 ds_read_b64_tr_b16 v[232:233], v8 offset:32768
 ds_read_b64_tr_b16 v[234:235], v8 offset:33792
 v_mfma_f32_16x16x32_bf16 v[56:59], v[248:251], a[144:147], v[56:59]
 ds_read_b128 a[160:163], v21 offset:0
 ds_read_b128 a[164:167], v21 offset:2048
 v_mfma_f32_16x16x32_bf16 v[88:91], v[248:251], a[148:151], v[88:91]
 s_add_u32 m0, s65, 16384
 ds_read_b64_tr_b16 v[236:237], v9 offset:32768
 v_mfma_f32_16x16x32_bf16 v[120:123], v[248:251], a[152:155], v[120:123]
 ds_read_b128 a[168:171], v21 offset:4096
 ds_read_b64_tr_b16 v[238:239], v9 offset:33792
 v_mfma_f32_16x16x32_bf16 v[152:155], v[248:251], a[156:159], v[152:155]
 ds_read_b128 a[172:175], v21 offset:6144
 s_add_u32 s56, s68, 3670016
 v_mfma_f32_16x16x32_bf16 v[60:63], v[252:255], a[144:147], v[60:63]
 s_and_b32 s56, s56, 4194303
 ds_read_b64_tr_b16 v[240:241], v10 offset:32768
 v_mfma_f32_16x16x32_bf16 v[92:95], v[252:255], a[148:151], v[92:95]
 ds_read_b64_tr_b16 v[242:243], v10 offset:33792
 s_add_u32 s56, s56, s63
 v_mfma_f32_16x16x32_bf16 v[124:127], v[252:255], a[152:155], v[124:127]
 ds_read_b128 a[176:179], v22 offset:0
 v_mfma_f32_16x16x32_bf16 v[156:159], v[252:255], a[156:159], v[156:159]
 ds_read_b128 a[180:183], v22 offset:2048
 s_waitcnt lgkmcnt(9)
 v_mfma_f32_16x16x32_bf16 v[32:35], v[224:227], a[160:163], v[32:35]
 s_waitcnt lgkmcnt(8)
 v_mfma_f32_16x16x32_bf16 v[64:67], v[224:227], a[164:167], v[64:67]
 s_waitcnt lgkmcnt(6)
 v_mfma_f32_16x16x32_bf16 v[96:99], v[224:227], a[168:171], v[96:99]
 s_waitcnt lgkmcnt(4)
 v_mfma_f32_16x16x32_bf16 v[128:131], v[224:227], a[172:175], v[128:131]
 buffer_load_dwordx4 v2, s[16:19], s56 offen offset:0 lds
 v_mfma_f32_16x16x32_bf16 v[36:39], v[228:231], a[160:163], v[36:39]
 ds_read_b64_tr_b16 v[244:245], v11 offset:32768
 ds_read_b128 a[184:187], v22 offset:4096
 v_mfma_f32_16x16x32_bf16 v[68:71], v[228:231], a[164:167], v[68:71]
 ds_read_b64_tr_b16 v[246:247], v11 offset:33792
 ds_read_b128 a[188:191], v22 offset:6144
 v_mfma_f32_16x16x32_bf16 v[100:103], v[228:231], a[168:171], v[100:103]
 buffer_load_dwordx4 v3, s[16:19], s56 offen offset:1024 lds
 v_mfma_f32_16x16x32_bf16 v[132:135], v[228:231], a[172:175], v[132:135]
 buffer_load_dwordx4 v4, s[16:19], s56 offen offset:2048 lds
 v_mfma_f32_16x16x32_bf16 v[40:43], v[232:235], a[160:163], v[40:43]
 ds_read_b64_tr_b16 v[248:249], v12 offset:32768
 ds_read_b64_tr_b16 v[250:251], v12 offset:33792
 v_mfma_f32_16x16x32_bf16 v[72:75], v[232:235], a[164:167], v[72:75]
 buffer_load_dwordx4 v5, s[16:19], s56 offen offset:3072 lds
 v_mfma_f32_16x16x32_bf16 v[104:107], v[232:235], a[168:171], v[104:107]
 s_add_u32 m0, s64, 98304
 ds_read_b64_tr_b16 v[252:253], v13 offset:32768
 v_mfma_f32_16x16x32_bf16 v[136:139], v[232:235], a[172:175], v[136:139]
 ds_read_b64_tr_b16 v[254:255], v13 offset:33792
 s_add_u32 s57, s69, 896
 v_mfma_f32_16x16x32_bf16 v[44:47], v[236:239], a[160:163], v[44:47]
 s_and_b32 s57, s57, 1023
 ds_read_b64_tr_b16 v[224:225], v6 offset:40960
 v_mfma_f32_16x16x32_bf16 v[76:79], v[236:239], a[164:167], v[76:79]
 ds_read_b64_tr_b16 v[226:227], v6 offset:41984
 s_add_u32 s57, s57, s62
 v_mfma_f32_16x16x32_bf16 v[108:111], v[236:239], a[168:171], v[108:111]
 v_mfma_f32_16x16x32_bf16 v[140:143], v[236:239], a[172:175], v[140:143]
 s_waitcnt lgkmcnt(7)
 v_mfma_f32_16x16x32_bf16 v[48:51], v[240:243], a[160:163], v[48:51]
 buffer_load_dwordx4 v15, s[12:15], s57 offen offset:0 lds
 v_mfma_f32_16x16x32_bf16 v[80:83], v[240:243], a[164:167], v[80:83]
 ds_read_b64_tr_b16 v[228:229], v7 offset:40960
 ds_read_b64_tr_b16 v[230:231], v7 offset:41984
 v_mfma_f32_16x16x32_bf16 v[112:115], v[240:243], a[168:171], v[112:115]
 buffer_load_dwordx4 v16, s[12:15], s57 offen offset:1024 lds
 v_mfma_f32_16x16x32_bf16 v[144:147], v[240:243], a[172:175], v[144:147]
 buffer_load_dwordx4 v17, s[12:15], s57 offen offset:2048 lds
 v_mfma_f32_16x16x32_bf16 v[52:55], v[244:247], a[160:163], v[52:55]
 ds_read_b64_tr_b16 v[232:233], v8 offset:40960
 ds_read_b64_tr_b16 v[234:235], v8 offset:41984
 v_mfma_f32_16x16x32_bf16 v[84:87], v[244:247], a[164:167], v[84:87]
 buffer_load_dwordx4 v18, s[12:15], s57 offen offset:3072 lds
 v_mfma_f32_16x16x32_bf16 v[116:119], v[244:247], a[168:171], v[116:119]
 v_mfma_f32_16x16x32_bf16 v[148:151], v[244:247], a[172:175], v[148:151]
 s_add_u32 m0, s64, 102400
 s_waitcnt lgkmcnt(4)
 v_mfma_f32_16x16x32_bf16 v[56:59], v[248:251], a[160:163], v[56:59]
 ds_read_b64_tr_b16 v[236:237], v9 offset:40960
 ds_read_b64_tr_b16 v[238:239], v9 offset:41984
 v_mfma_f32_16x16x32_bf16 v[88:91], v[248:251], a[164:167], v[88:91]
 s_add_u32 s57, s57, 32768
 v_mfma_f32_16x16x32_bf16 v[120:123], v[248:251], a[168:171], v[120:123]
 v_mfma_f32_16x16x32_bf16 v[152:155], v[248:251], a[172:175], v[152:155]
 buffer_load_dwordx4 v15, s[12:15], s57 offen offset:0 lds
 v_mfma_f32_16x16x32_bf16 v[60:63], v[252:255], a[160:163], v[60:63]
 ds_read_b64_tr_b16 v[240:241], v10 offset:40960
 ds_read_b64_tr_b16 v[242:243], v10 offset:41984
 v_mfma_f32_16x16x32_bf16 v[92:95], v[252:255], a[164:167], v[92:95]
 buffer_load_dwordx4 v16, s[12:15], s57 offen offset:1024 lds
 v_mfma_f32_16x16x32_bf16 v[124:127], v[252:255], a[168:171], v[124:127]
 v_mfma_f32_16x16x32_bf16 v[156:159], v[252:255], a[172:175], v[156:159]
 buffer_load_dwordx4 v17, s[12:15], s57 offen offset:2048 lds
 v_mfma_f32_16x16x32_bf16 v[32:35], v[224:227], a[176:179], v[32:35]
 ds_read_b64_tr_b16 v[244:245], v11 offset:40960
 ds_read_b64_tr_b16 v[246:247], v11 offset:41984
 v_mfma_f32_16x16x32_bf16 v[64:67], v[224:227], a[180:183], v[64:67]
 buffer_load_dwordx4 v18, s[12:15], s57 offen offset:3072 lds
 v_mfma_f32_16x16x32_bf16 v[96:99], v[224:227], a[184:187], v[96:99]
 v_mfma_f32_16x16x32_bf16 v[128:131], v[224:227], a[188:191], v[128:131]
 s_waitcnt lgkmcnt(4)
 v_mfma_f32_16x16x32_bf16 v[36:39], v[228:231], a[176:179], v[36:39]
 ds_read_b64_tr_b16 v[248:249], v12 offset:40960
 ds_read_b64_tr_b16 v[250:251], v12 offset:41984
 v_mfma_f32_16x16x32_bf16 v[68:71], v[228:231], a[180:183], v[68:71]
 v_mfma_f32_16x16x32_bf16 v[100:103], v[228:231], a[184:187], v[100:103]
 v_mfma_f32_16x16x32_bf16 v[132:135], v[228:231], a[188:191], v[132:135]
 v_mfma_f32_16x16x32_bf16 v[40:43], v[232:235], a[176:179], v[40:43]
 ds_read_b64_tr_b16 v[252:253], v13 offset:40960
 ds_read_b64_tr_b16 v[254:255], v13 offset:41984
 v_mfma_f32_16x16x32_bf16 v[72:75], v[232:235], a[180:183], v[72:75]
 v_mfma_f32_16x16x32_bf16 v[104:107], v[232:235], a[184:187], v[104:107]
 v_mfma_f32_16x16x32_bf16 v[136:139], v[232:235], a[188:191], v[136:139]
 v_mfma_f32_16x16x32_bf16 v[44:47], v[236:239], a[176:179], v[44:47]
 v_mfma_f32_16x16x32_bf16 v[76:79], v[236:239], a[180:183], v[76:79]
 v_mfma_f32_16x16x32_bf16 v[108:111], v[236:239], a[184:187], v[108:111]
 v_mfma_f32_16x16x32_bf16 v[140:143], v[236:239], a[188:191], v[140:143]
 s_waitcnt lgkmcnt(2)
 v_mfma_f32_16x16x32_bf16 v[48:51], v[240:243], a[176:179], v[48:51]
 v_mfma_f32_16x16x32_bf16 v[80:83], v[240:243], a[180:183], v[80:83]
 v_mfma_f32_16x16x32_bf16 v[112:115], v[240:243], a[184:187], v[112:115]
 v_mfma_f32_16x16x32_bf16 v[144:147], v[240:243], a[188:191], v[144:147]
 v_mfma_f32_16x16x32_bf16 v[52:55], v[244:247], a[176:179], v[52:55]
 s_waitcnt vmcnt(12)
 s_waitcnt lgkmcnt(0)
 s_barrier
 v_mfma_f32_16x16x32_bf16 v[84:87], v[244:247], a[180:183], v[84:87]
 ds_read_b64_tr_b16 v[224:225], v6 offset:0
 ds_read_b64_tr_b16 v[226:227], v6 offset:1024
 v_mfma_f32_16x16x32_bf16 v[116:119], v[244:247], a[184:187], v[116:119]
 ds_read_b64_tr_b16 v[228:229], v7 offset:0
 ds_read_b64_tr_b16 v[230:231], v7 offset:1024
 v_mfma_f32_16x16x32_bf16 v[148:151], v[244:247], a[188:191], v[148:151]
 ds_read_b64_tr_b16 v[232:233], v8 offset:0
 ds_read_b64_tr_b16 v[234:235], v8 offset:1024
 v_mfma_f32_16x16x32_bf16 v[56:59], v[248:251], a[176:179], v[56:59]
 ds_read_b128 a[192:195], v19 offset:0
 ds_read_b128 a[196:199], v19 offset:2048
 v_mfma_f32_16x16x32_bf16 v[88:91], v[248:251], a[180:183], v[88:91]
 s_add_u32 m0, s65, 32768
 ds_read_b64_tr_b16 v[236:237], v9 offset:0
 v_mfma_f32_16x16x32_bf16 v[120:123], v[248:251], a[184:187], v[120:123]
 ds_read_b128 a[200:203], v19 offset:4096
 ds_read_b64_tr_b16 v[238:239], v9 offset:1024
 v_mfma_f32_16x16x32_bf16 v[152:155], v[248:251], a[188:191], v[152:155]
 s_add_u32 s56, s68, 524288
 ds_read_b128 a[204:207], v19 offset:6144
 v_mfma_f32_16x16x32_bf16 v[60:63], v[252:255], a[176:179], v[60:63]
 s_and_b32 s56, s56, 4194303
 ds_read_b64_tr_b16 v[240:241], v10 offset:0
 v_mfma_f32_16x16x32_bf16 v[92:95], v[252:255], a[180:183], v[92:95]
 ds_read_b64_tr_b16 v[242:243], v10 offset:1024
 s_add_u32 s56, s56, s63
 v_mfma_f32_16x16x32_bf16 v[124:127], v[252:255], a[184:187], v[124:127]
 ds_read_b128 a[208:211], v20 offset:0
 v_mfma_f32_16x16x32_bf16 v[156:159], v[252:255], a[188:191], v[156:159]
 s_waitcnt lgkmcnt(8)
 v_mfma_f32_16x16x32_bf16 v[32:35], v[224:227], a[192:195], v[32:35]
 s_waitcnt lgkmcnt(7)
 v_mfma_f32_16x16x32_bf16 v[64:67], v[224:227], a[196:199], v[64:67]
 s_waitcnt lgkmcnt(5)
 v_mfma_f32_16x16x32_bf16 v[96:99], v[224:227], a[200:203], v[96:99]
 s_waitcnt lgkmcnt(3)
 v_mfma_f32_16x16x32_bf16 v[128:131], v[224:227], a[204:207], v[128:131]
 buffer_load_dwordx4 v2, s[20:23], s56 offen offset:0 lds
 v_mfma_f32_16x16x32_bf16 v[36:39], v[228:231], a[192:195], v[36:39]
 ds_read_b128 a[212:215], v20 offset:2048
 ds_read_b64_tr_b16 v[244:245], v11 offset:0
 v_mfma_f32_16x16x32_bf16 v[68:71], v[228:231], a[196:199], v[68:71]
 ds_read_b128 a[216:219], v20 offset:4096
 v_mfma_f32_16x16x32_bf16 v[100:103], v[228:231], a[200:203], v[100:103]
 buffer_load_dwordx4 v3, s[20:23], s56 offen offset:1024 lds
 v_mfma_f32_16x16x32_bf16 v[132:135], v[228:231], a[204:207], v[132:135]
 ds_read_b64_tr_b16 v[246:247], v11 offset:1024
 ds_read_b128 a[220:223], v20 offset:6144
 v_mfma_f32_16x16x32_bf16 v[40:43], v[232:235], a[192:195], v[40:43]
 buffer_load_dwordx4 v4, s[20:23], s56 offen offset:2048 lds
 v_mfma_f32_16x16x32_bf16 v[72:75], v[232:235], a[196:199], v[72:75]
 buffer_load_dwordx4 v5, s[20:23], s56 offen offset:3072 lds
 v_mfma_f32_16x16x32_bf16 v[104:107], v[232:235], a[200:203], v[104:107]
 ds_read_b64_tr_b16 v[248:249], v12 offset:0
 ds_read_b64_tr_b16 v[250:251], v12 offset:1024
 v_mfma_f32_16x16x32_bf16 v[136:139], v[232:235], a[204:207], v[136:139]
 s_add_u32 m0, s65, 131072
 s_add_u32 s56, s68, 1048576
 v_mfma_f32_16x16x32_bf16 v[44:47], v[236:239], a[192:195], v[44:47]
 ds_read_b64_tr_b16 v[252:253], v13 offset:0
 ds_read_b64_tr_b16 v[254:255], v13 offset:1024
 v_mfma_f32_16x16x32_bf16 v[76:79], v[236:239], a[196:199], v[76:79]
 s_and_b32 s56, s56, 4194303
 s_add_u32 s56, s56, s63
 v_mfma_f32_16x16x32_bf16 v[108:111], v[236:239], a[200:203], v[108:111]
 ds_read_b64_tr_b16 v[224:225], v6 offset:8192
 ds_read_b64_tr_b16 v[226:227], v6 offset:9216
 v_mfma_f32_16x16x32_bf16 v[140:143], v[236:239], a[204:207], v[140:143]
 s_waitcnt lgkmcnt(8)
 v_mfma_f32_16x16x32_bf16 v[48:51], v[240:243], a[192:195], v[48:51]
 buffer_load_dwordx4 v2, s[20:23], s56 offen offset:0 lds
 v_mfma_f32_16x16x32_bf16 v[80:83], v[240:243], a[196:199], v[80:83]
 buffer_load_dwordx4 v3, s[20:23], s56 offen offset:1024 lds
 v_mfma_f32_16x16x32_bf16 v[112:115], v[240:243], a[200:203], v[112:115]
 ds_read_b64_tr_b16 v[228:229], v7 offset:8192
 ds_read_b64_tr_b16 v[230:231], v7 offset:9216
 v_mfma_f32_16x16x32_bf16 v[144:147], v[240:243], a[204:207], v[144:147]
 s_and_b32 s58, s2, 7
 s_waitcnt lgkmcnt(8)
 v_mfma_f32_16x16x32_bf16 v[52:55], v[244:247], a[192:195], v[52:55]
 buffer_load_dwordx4 v4, s[20:23], s56 offen offset:2048 lds
 v_mfma_f32_16x16x32_bf16 v[84:87], v[244:247], a[196:199], v[84:87]
 buffer_load_dwordx4 v5, s[20:23], s56 offen offset:3072 lds
 v_mfma_f32_16x16x32_bf16 v[116:119], v[244:247], a[200:203], v[116:119]
 ds_read_b64_tr_b16 v[232:233], v8 offset:8192
 ds_read_b64_tr_b16 v[234:235], v8 offset:9216
 v_mfma_f32_16x16x32_bf16 v[148:151], v[244:247], a[204:207], v[148:151]
 s_add_u32 m0, s65, 147456
 s_waitcnt lgkmcnt(6)
 v_mfma_f32_16x16x32_bf16 v[56:59], v[248:251], a[192:195], v[56:59]
 s_add_u32 s56, s68, 1572864
 ds_read_b64_tr_b16 v[236:237], v9 offset:8192
 v_mfma_f32_16x16x32_bf16 v[88:91], v[248:251], a[196:199], v[88:91]
 s_and_b32 s56, s56, 4194303
 ds_read_b64_tr_b16 v[238:239], v9 offset:9216
 v_mfma_f32_16x16x32_bf16 v[120:123], v[248:251], a[200:203], v[120:123]
 s_add_u32 s56, s56, s63
 s_lshr_b32 s59, s2, 3
 v_mfma_f32_16x16x32_bf16 v[152:155], v[248:251], a[204:207], v[152:155]
 buffer_load_dwordx4 v2, s[20:23], s56 offen offset:0 lds
 v_mfma_f32_16x16x32_bf16 v[60:63], v[252:255], a[192:195], v[60:63]
 ds_read_b64_tr_b16 v[240:241], v10 offset:8192
 ds_read_b64_tr_b16 v[242:243], v10 offset:9216
 v_mfma_f32_16x16x32_bf16 v[92:95], v[252:255], a[196:199], v[92:95]
 buffer_load_dwordx4 v3, s[20:23], s56 offen offset:1024 lds
 v_mfma_f32_16x16x32_bf16 v[124:127], v[252:255], a[200:203], v[124:127]
 s_lshr_b32 s84, s59, 3
 s_lshl_b32 s58, s58, 2
 v_mfma_f32_16x16x32_bf16 v[156:159], v[252:255], a[204:207], v[156:159]
 s_add_u32 s84, s84, s58
 s_waitcnt lgkmcnt(6)
 v_mfma_f32_16x16x32_bf16 v[32:35], v[224:227], a[208:211], v[32:35]
 buffer_load_dwordx4 v4, s[20:23], s56 offen offset:2048 lds
 v_mfma_f32_16x16x32_bf16 v[64:67], v[224:227], a[212:215], v[64:67]
 ds_read_b64_tr_b16 v[244:245], v11 offset:8192
 ds_read_b64_tr_b16 v[246:247], v11 offset:9216
 v_mfma_f32_16x16x32_bf16 v[96:99], v[224:227], a[216:219], v[96:99]
 buffer_load_dwordx4 v5, s[20:23], s56 offen offset:3072 lds
 v_mfma_f32_16x16x32_bf16 v[128:131], v[224:227], a[220:223], v[128:131]
 s_and_b32 s85, s59, 7
 s_lshl_b32 s58, s85, 4
 v_mfma_f32_16x16x32_bf16 v[36:39], v[228:231], a[208:211], v[36:39]
 ds_read_b64_tr_b16 v[248:249], v12 offset:8192
 ds_read_b64_tr_b16 v[250:251], v12 offset:9216
 v_mfma_f32_16x16x32_bf16 v[68:71], v[228:231], a[212:215], v[68:71]
 v_bfe_u32 v30, v0, 4, 1
 v_mul_u32_u24 v30, 240, v30
 v_mfma_f32_16x16x32_bf16 v[100:103], v[228:231], a[216:219], v[100:103]
 v_xor_b32 v30, s58, v30
 v_mfma_f32_16x16x32_bf16 v[132:135], v[228:231], a[220:223], v[132:135]
 s_waitcnt lgkmcnt(4)
 v_mfma_f32_16x16x32_bf16 v[40:43], v[232:235], a[208:211], v[40:43]
 ds_read_b64_tr_b16 v[252:253], v13 offset:8192
 ds_read_b64_tr_b16 v[254:255], v13 offset:9216
 v_mfma_f32_16x16x32_bf16 v[72:75], v[232:235], a[212:215], v[72:75]
 v_and_b32 v31, 15, v0
 v_mfma_f32_16x16x32_bf16 v[104:107], v[232:235], a[216:219], v[104:107]
 v_add_lshl_u32 v30, v30, v31, 7
 v_mfma_f32_16x16x32_bf16 v[136:139], v[232:235], a[220:223], v[136:139]
 v_mfma_f32_16x16x32_bf16 v[44:47], v[236:239], a[208:211], v[44:47]
 v_mfma_f32_16x16x32_bf16 v[76:79], v[236:239], a[212:215], v[76:79]
 v_add_u32 v30, 39321600, v30
 v_mfma_f32_16x16x32_bf16 v[108:111], v[236:239], a[216:219], v[108:111]
 v_mfma_f32_16x16x32_bf16 v[140:143], v[236:239], a[220:223], v[140:143]
 buffer_load_dword v31, v30, s[4:7], 0 offen sc1
 v_mfma_f32_16x16x32_bf16 v[48:51], v[240:243], a[208:211], v[48:51]
 v_mfma_f32_16x16x32_bf16 v[80:83], v[240:243], a[212:215], v[80:83]
 v_mfma_f32_16x16x32_bf16 v[112:115], v[240:243], a[216:219], v[112:115]
 s_and_b32 s58, s85, 3
 v_mfma_f32_16x16x32_bf16 v[144:147], v[240:243], a[220:223], v[144:147]
 s_waitcnt lgkmcnt(0)
 v_mfma_f32_16x16x32_bf16 v[52:55], v[244:247], a[208:211], v[52:55]
 s_waitcnt vmcnt(13)
 s_waitcnt lgkmcnt(0)
 s_barrier
 v_mfma_f32_16x16x32_bf16 v[84:87], v[244:247], a[212:215], v[84:87]
 ds_read_b64_tr_b16 v[224:225], v6 offset:16384
 ds_read_b64_tr_b16 v[226:227], v6 offset:17408
 v_mfma_f32_16x16x32_bf16 v[116:119], v[244:247], a[216:219], v[116:119]
 ds_read_b64_tr_b16 v[228:229], v7 offset:16384
 ds_read_b64_tr_b16 v[230:231], v7 offset:17408
 v_mfma_f32_16x16x32_bf16 v[148:151], v[244:247], a[220:223], v[148:151]
 ds_read_b64_tr_b16 v[232:233], v8 offset:16384
 ds_read_b64_tr_b16 v[234:235], v8 offset:17408
 v_mfma_f32_16x16x32_bf16 v[56:59], v[248:251], a[208:211], v[56:59]
 ds_read_b128 a[224:227], v19 offset:32768
 ds_read_b128 a[228:231], v19 offset:34816
 v_mfma_f32_16x16x32_bf16 v[88:91], v[248:251], a[212:215], v[88:91]
 s_add_u32 m0, s65, 65536
 ds_read_b64_tr_b16 v[236:237], v9 offset:16384
 v_mfma_f32_16x16x32_bf16 v[120:123], v[248:251], a[216:219], v[120:123]
 ds_read_b128 a[232:235], v19 offset:36864
 ds_read_b64_tr_b16 v[238:239], v9 offset:17408
 v_mfma_f32_16x16x32_bf16 v[152:155], v[248:251], a[220:223], v[152:155]
 s_add_u32 s56, s68, 2097152
 ds_read_b128 a[236:239], v19 offset:38912
 v_mfma_f32_16x16x32_bf16 v[60:63], v[252:255], a[208:211], v[60:63]
 s_and_b32 s56, s56, 4194303
 ds_read_b64_tr_b16 v[240:241], v10 offset:16384
 v_mfma_f32_16x16x32_bf16 v[92:95], v[252:255], a[212:215], v[92:95]
 ds_read_b64_tr_b16 v[242:243], v10 offset:17408
 s_add_u32 s56, s56, s63
 v_mfma_f32_16x16x32_bf16 v[124:127], v[252:255], a[216:219], v[124:127]
 ds_read_b128 a[240:243], v20 offset:32768
 s_lshl_b32 s58, s58, 3
 v_mfma_f32_16x16x32_bf16 v[156:159], v[252:255], a[220:223], v[156:159]
 s_lshl_b32 s58, 64, s58
 s_waitcnt lgkmcnt(8)
 v_mfma_f32_16x16x32_bf16 v[32:35], v[224:227], a[224:227], v[32:35]
 s_or_b32 s58, s58, 2155905152
 s_waitcnt lgkmcnt(7)
 v_mfma_f32_16x16x32_bf16 v[64:67], v[224:227], a[228:231], v[64:67]
 s_bfm_b32 s59, s84, 0
 s_waitcnt lgkmcnt(5)
 v_mfma_f32_16x16x32_bf16 v[96:99], v[224:227], a[232:235], v[96:99]
 s_and_b32 s59, s59, s58
 s_waitcnt lgkmcnt(3)
 v_mfma_f32_16x16x32_bf16 v[128:131], v[224:227], a[236:239], v[128:131]
 buffer_load_dwordx4 v2, s[20:23], s56 offen offset:0 lds
 v_mfma_f32_16x16x32_bf16 v[36:39], v[228:231], a[224:227], v[36:39]
 ds_read_b128 a[244:247], v20 offset:34816
 ds_read_b64_tr_b16 v[244:245], v11 offset:16384
 v_mfma_f32_16x16x32_bf16 v[68:71], v[228:231], a[228:231], v[68:71]
 ds_read_b128 a[248:251], v20 offset:36864
 s_bcnt1_i32_b32 s59, s59
 v_mfma_f32_16x16x32_bf16 v[100:103], v[228:231], a[232:235], v[100:103]
 buffer_load_dwordx4 v3, s[20:23], s56 offen offset:1024 lds
 v_mfma_f32_16x16x32_bf16 v[132:135], v[228:231], a[236:239], v[132:135]
 ds_read_b64_tr_b16 v[246:247], v11 offset:17408
 ds_read_b128 a[252:255], v20 offset:38912
 v_mfma_f32_16x16x32_bf16 v[40:43], v[232:235], a[224:227], v[40:43]
 buffer_load_dwordx4 v4, s[20:23], s56 offen offset:2048 lds
 v_mfma_f32_16x16x32_bf16 v[72:75], v[232:235], a[228:231], v[72:75]
 buffer_load_dwordx4 v5, s[20:23], s56 offen offset:3072 lds
 v_mfma_f32_16x16x32_bf16 v[104:107], v[232:235], a[232:235], v[104:107]
 ds_read_b64_tr_b16 v[248:249], v12 offset:16384
 ds_read_b64_tr_b16 v[250:251], v12 offset:17408
 v_mfma_f32_16x16x32_bf16 v[136:139], v[232:235], a[236:239], v[136:139]
 s_add_u32 m0, s65, 81920
 s_add_u32 s56, s68, 2621440
 v_mfma_f32_16x16x32_bf16 v[44:47], v[236:239], a[224:227], v[44:47]
 ds_read_b64_tr_b16 v[252:253], v13 offset:16384
 ds_read_b64_tr_b16 v[254:255], v13 offset:17408
 v_mfma_f32_16x16x32_bf16 v[76:79], v[236:239], a[228:231], v[76:79]
 s_and_b32 s56, s56, 4194303
 s_add_u32 s56, s56, s63
 v_mfma_f32_16x16x32_bf16 v[108:111], v[236:239], a[232:235], v[108:111]
 ds_read_b64_tr_b16 v[224:225], v6 offset:24576
 ds_read_b64_tr_b16 v[226:227], v6 offset:25600
 v_mfma_f32_16x16x32_bf16 v[140:143], v[236:239], a[236:239], v[140:143]
 s_sub_u32 s86, s84, s59
 s_waitcnt lgkmcnt(8)
 v_mfma_f32_16x16x32_bf16 v[48:51], v[240:243], a[224:227], v[48:51]
 buffer_load_dwordx4 v2, s[20:23], s56 offen offset:0 lds
 v_mfma_f32_16x16x32_bf16 v[80:83], v[240:243], a[228:231], v[80:83]
 buffer_load_dwordx4 v3, s[20:23], s56 offen offset:1024 lds
 v_mfma_f32_16x16x32_bf16 v[112:115], v[240:243], a[232:235], v[112:115]
 ds_read_b64_tr_b16 v[228:229], v7 offset:24576
 ds_read_b64_tr_b16 v[230:231], v7 offset:25600
 v_mfma_f32_16x16x32_bf16 v[144:147], v[240:243], a[236:239], v[144:147]
 s_waitcnt lgkmcnt(8)
 v_mfma_f32_16x16x32_bf16 v[52:55], v[244:247], a[224:227], v[52:55]
 buffer_load_dwordx4 v4, s[20:23], s56 offen offset:2048 lds
 v_mfma_f32_16x16x32_bf16 v[84:87], v[244:247], a[228:231], v[84:87]
 buffer_load_dwordx4 v5, s[20:23], s56 offen offset:3072 lds
 v_mfma_f32_16x16x32_bf16 v[116:119], v[244:247], a[232:235], v[116:119]
 ds_read_b64_tr_b16 v[232:233], v8 offset:24576
 ds_read_b64_tr_b16 v[234:235], v8 offset:25600
 v_mfma_f32_16x16x32_bf16 v[148:151], v[244:247], a[236:239], v[148:151]
 s_add_u32 m0, s65, 0
 s_waitcnt lgkmcnt(6)
 v_mfma_f32_16x16x32_bf16 v[56:59], v[248:251], a[224:227], v[56:59]
 s_add_u32 s56, s68, 3145728
 ds_read_b64_tr_b16 v[236:237], v9 offset:24576
 v_mfma_f32_16x16x32_bf16 v[88:91], v[248:251], a[228:231], v[88:91]
 s_and_b32 s56, s56, 4194303
 ds_read_b64_tr_b16 v[238:239], v9 offset:25600
 v_mfma_f32_16x16x32_bf16 v[120:123], v[248:251], a[232:235], v[120:123]
 s_add_u32 s56, s56, s63
 v_mfma_f32_16x16x32_bf16 v[152:155], v[248:251], a[236:239], v[152:155]
 buffer_load_dwordx4 v2, s[20:23], s56 offen offset:0 lds
 v_mfma_f32_16x16x32_bf16 v[60:63], v[252:255], a[224:227], v[60:63]
 ds_read_b64_tr_b16 v[240:241], v10 offset:24576
 ds_read_b64_tr_b16 v[242:243], v10 offset:25600
 v_mfma_f32_16x16x32_bf16 v[92:95], v[252:255], a[228:231], v[92:95]
 buffer_load_dwordx4 v3, s[20:23], s56 offen offset:1024 lds
 v_mfma_f32_16x16x32_bf16 v[124:127], v[252:255], a[232:235], v[124:127]
 s_bitcmp1_b32 s58, s84
 s_cselect_b32 s86, 65536, s86
 v_mfma_f32_16x16x32_bf16 v[156:159], v[252:255], a[236:239], v[156:159]
 s_lshl_b32 s87, s3, 17
 s_waitcnt lgkmcnt(6)
 v_mfma_f32_16x16x32_bf16 v[32:35], v[224:227], a[240:243], v[32:35]
 buffer_load_dwordx4 v4, s[20:23], s56 offen offset:2048 lds
 v_mfma_f32_16x16x32_bf16 v[64:67], v[224:227], a[244:247], v[64:67]
 ds_read_b64_tr_b16 v[244:245], v11 offset:24576
 ds_read_b64_tr_b16 v[246:247], v11 offset:25600
 v_mfma_f32_16x16x32_bf16 v[96:99], v[224:227], a[248:251], v[96:99]
 buffer_load_dwordx4 v5, s[20:23], s56 offen offset:3072 lds
 v_mfma_f32_16x16x32_bf16 v[128:131], v[224:227], a[252:255], v[128:131]
 s_lshl_b32 s59, s84, 8
 s_add_u32 s87, s87, s59
 v_mfma_f32_16x16x32_bf16 v[36:39], v[228:231], a[240:243], v[36:39]
 ds_read_b64_tr_b16 v[248:249], v12 offset:24576
 ds_read_b64_tr_b16 v[250:251], v12 offset:25600
 v_mfma_f32_16x16x32_bf16 v[68:71], v[228:231], a[244:247], v[68:71]
 s_mul_i32 s88, s3, 55296
 s_lshl_b32 s59, s86, 7
 v_mfma_f32_16x16x32_bf16 v[100:103], v[228:231], a[248:251], v[100:103]
 s_add_u32 s88, s88, s59
 s_lshl_b32 s89, s3, 11
 v_mfma_f32_16x16x32_bf16 v[132:135], v[228:231], a[252:255], v[132:135]
 s_lshl_b32 s93, s85, 2
 s_waitcnt lgkmcnt(4)
 v_mfma_f32_16x16x32_bf16 v[40:43], v[232:235], a[240:243], v[40:43]
 ds_read_b64_tr_b16 v[252:253], v13 offset:24576
 ds_read_b64_tr_b16 v[254:255], v13 offset:25600
 v_mfma_f32_16x16x32_bf16 v[72:75], v[232:235], a[244:247], v[72:75]
 s_add_u32 s93, s93, s3
 s_sub_u32 s58, 15, s85
 v_mfma_f32_16x16x32_bf16 v[104:107], v[232:235], a[248:251], v[104:107]
 s_lshl_b32 s94, s58, 2
 s_add_u32 s94, s94, s3
 v_mfma_f32_16x16x32_bf16 v[136:139], v[232:235], a[252:255], v[136:139]
 s_lshl_b32 s95, s58, 1
 s_mul_i32 s90, s93, 40960
 v_mfma_f32_16x16x32_bf16 v[44:47], v[236:239], a[240:243], v[44:47]
 s_add_u32 s90, s90, 35651584
 s_mul_i32 s91, s94, 40960
 v_mfma_f32_16x16x32_bf16 v[76:79], v[236:239], a[244:247], v[76:79]
 v_mfma_f32_16x16x32_bf16 v[108:111], v[236:239], a[248:251], v[108:111]
 s_add_u32 s91, s91, 35651584
 v_mfma_f32_16x16x32_bf16 v[140:143], v[236:239], a[252:255], v[140:143]
 v_mfma_f32_16x16x32_bf16 v[48:51], v[240:243], a[240:243], v[48:51]
 v_mfma_f32_16x16x32_bf16 v[80:83], v[240:243], a[244:247], v[80:83]
 s_lshl_b32 s92, s84, 20
 v_mfma_f32_16x16x32_bf16 v[112:115], v[240:243], a[248:251], v[112:115]
 v_mfma_f32_16x16x32_bf16 v[144:147], v[240:243], a[252:255], v[144:147]
 s_add_u32 s92, s92, s65
 s_waitcnt lgkmcnt(0)
 v_mfma_f32_16x16x32_bf16 v[52:55], v[244:247], a[240:243], v[52:55]
 s_waitcnt vmcnt(13)
 s_waitcnt lgkmcnt(0)
 s_barrier
 v_mfma_f32_16x16x32_bf16 v[84:87], v[244:247], a[244:247], v[84:87]
 ds_read_b64_tr_b16 v[224:225], v6 offset:49152
 ds_read_b64_tr_b16 v[226:227], v6 offset:50176
 v_mfma_f32_16x16x32_bf16 v[116:119], v[244:247], a[248:251], v[116:119]
 ds_read_b64_tr_b16 v[228:229], v7 offset:49152
 ds_read_b64_tr_b16 v[230:231], v7 offset:50176
 v_mfma_f32_16x16x32_bf16 v[148:151], v[244:247], a[252:255], v[148:151]
 ds_read_b64_tr_b16 v[232:233], v8 offset:49152
 ds_read_b64_tr_b16 v[234:235], v8 offset:50176
 v_mfma_f32_16x16x32_bf16 v[56:59], v[248:251], a[240:243], v[56:59]
 s_add_u32 m0, s65, 16384
 s_add_u32 s56, s68, 3670016
 v_mfma_f32_16x16x32_bf16 v[88:91], v[248:251], a[244:247], v[88:91]
 ds_read_b64_tr_b16 v[236:237], v9 offset:49152
 ds_read_b64_tr_b16 v[238:239], v9 offset:50176
 v_mfma_f32_16x16x32_bf16 v[120:123], v[248:251], a[248:251], v[120:123]
 s_and_b32 s56, s56, 4194303
 v_mfma_f32_16x16x32_bf16 v[152:155], v[248:251], a[252:255], v[152:155]
 s_add_u32 s56, s56, s63
 v_mfma_f32_16x16x32_bf16 v[60:63], v[252:255], a[240:243], v[60:63]
 ds_read_b64_tr_b16 v[240:241], v6 offset:57344
 ds_read_b64_tr_b16 v[242:243], v6 offset:58368
 v_mfma_f32_16x16x32_bf16 v[92:95], v[252:255], a[244:247], v[92:95]
 buffer_load_dwordx4 v2, s[20:23], s56 offen offset:0 lds
 v_mfma_f32_16x16x32_bf16 v[124:127], v[252:255], a[248:251], v[124:127]
 buffer_load_dwordx4 v3, s[20:23], s56 offen offset:1024 lds
 v_mfma_f32_16x16x32_bf16 v[156:159], v[252:255], a[252:255], v[156:159]
 s_waitcnt lgkmcnt(8)
 v_mfma_f32_16x16x32_bf16 v[160:163], a[0:3], v[224:227], 0
 ds_read_b64_tr_b16 v[244:245], v7 offset:57344
 ds_read_b64_tr_b16 v[246:247], v7 offset:58368
 v_mfma_f32_16x16x32_bf16 v[164:167], a[4:7], v[224:227], 0
 buffer_load_dwordx4 v4, s[20:23], s56 offen offset:2048 lds
 v_mfma_f32_16x16x32_bf16 v[192:195], a[8:11], v[224:227], 0
 buffer_load_dwordx4 v5, s[20:23], s56 offen offset:3072 lds
 v_mfma_f32_16x16x32_bf16 v[196:199], a[12:15], v[224:227], 0
 s_waitcnt lgkmcnt(5)
 v_mfma_f32_16x16x32_bf16 v[168:171], a[0:3], v[228:231], 0
 ds_read_b64_tr_b16 v[248:249], v8 offset:57344
 ds_read_b64_tr_b16 v[250:251], v8 offset:58368
 v_mfma_f32_16x16x32_bf16 v[172:175], a[4:7], v[228:231], 0
 v_mfma_f32_16x16x32_bf16 v[200:203], a[8:11], v[228:231], 0
 v_mfma_f32_16x16x32_bf16 v[204:207], a[12:15], v[228:231], 0
 v_mfma_f32_16x16x32_bf16 v[176:179], a[0:3], v[232:235], 0
 ds_read_b64_tr_b16 v[252:253], v9 offset:57344
 ds_read_b64_tr_b16 v[254:255], v9 offset:58368
 v_mfma_f32_16x16x32_bf16 v[180:183], a[4:7], v[232:235], 0
 v_mul_f32 v32, s67, v32
 v_mul_f32 v33, s67, v33
 v_mfma_f32_16x16x32_bf16 v[208:211], a[8:11], v[232:235], 0
 v_mul_f32 v34, s67, v34
 v_mfma_f32_16x16x32_bf16 v[212:215], a[12:15], v[232:235], 0
 v_mul_f32 v35, s67, v35
 s_waitcnt lgkmcnt(4)
 v_mfma_f32_16x16x32_bf16 v[184:187], a[0:3], v[236:239], 0
 ds_read_b64_tr_b16 v[224:225], v6 offset:32768
 ds_read_b64_tr_b16 v[226:227], v6 offset:33792
 v_mfma_f32_16x16x32_bf16 v[188:191], a[4:7], v[236:239], 0
 v_mul_f32 v36, s67, v36
 v_mfma_f32_16x16x32_bf16 v[216:219], a[8:11], v[236:239], 0
 v_mul_f32 v37, s67, v37
 v_mfma_f32_16x16x32_bf16 v[220:223], a[12:15], v[236:239], 0
 v_mul_f32 v38, s67, v38
 v_mfma_f32_16x16x32_bf16 v[160:163], a[16:19], v[240:243], v[160:163]
 ds_read_b64_tr_b16 v[228:229], v7 offset:32768
 ds_read_b64_tr_b16 v[230:231], v7 offset:33792
 v_mfma_f32_16x16x32_bf16 v[164:167], a[20:23], v[240:243], v[164:167]
 v_mul_f32 v39, s67, v39
 v_mfma_f32_16x16x32_bf16 v[192:195], a[24:27], v[240:243], v[192:195]
 v_cvt_pk_bf16_f32 v32, v32, v33
 v_mfma_f32_16x16x32_bf16 v[196:199], a[28:31], v[240:243], v[196:199]
 v_cvt_pk_bf16_f32 v33, v34, v35
 v_mfma_f32_16x16x32_bf16 v[168:171], a[16:19], v[244:247], v[168:171]
 ds_read_b64_tr_b16 v[232:233], v8 offset:32768
 ds_read_b64_tr_b16 v[234:235], v8 offset:33792
 v_mfma_f32_16x16x32_bf16 v[172:175], a[20:23], v[244:247], v[172:175]
 v_cvt_pk_bf16_f32 v34, v36, v37
 v_mfma_f32_16x16x32_bf16 v[200:203], a[24:27], v[244:247], v[200:203]
 v_cvt_pk_bf16_f32 v35, v38, v39
 v_mfma_f32_16x16x32_bf16 v[204:207], a[28:31], v[244:247], v[204:207]
 s_add_u32 s57, s66, 0
 s_waitcnt lgkmcnt(4)
 v_mfma_f32_16x16x32_bf16 v[176:179], a[16:19], v[248:251], v[176:179]
 ds_read_b64_tr_b16 v[236:237], v9 offset:32768
 ds_read_b64_tr_b16 v[238:239], v9 offset:33792
 v_mfma_f32_16x16x32_bf16 v[180:183], a[20:23], v[248:251], v[180:183]
 buffer_store_dwordx4 v[32:35], v23, s[4:7], s57 offen offset:0 sc1
 v_mfma_f32_16x16x32_bf16 v[208:211], a[24:27], v[248:251], v[208:211]
 v_mul_f32 v40, s67, v40
 v_mfma_f32_16x16x32_bf16 v[212:215], a[28:31], v[248:251], v[212:215]
 v_mul_f32 v41, s67, v41
 v_mfma_f32_16x16x32_bf16 v[184:187], a[16:19], v[252:255], v[184:187]
 ds_read_b64_tr_b16 v[240:241], v6 offset:40960
 ds_read_b64_tr_b16 v[242:243], v6 offset:41984
 v_mfma_f32_16x16x32_bf16 v[188:191], a[20:23], v[252:255], v[188:191]
 v_mul_f32 v42, s67, v42
 v_mfma_f32_16x16x32_bf16 v[216:219], a[24:27], v[252:255], v[216:219]
 v_mul_f32 v43, s67, v43
 v_mfma_f32_16x16x32_bf16 v[220:223], a[28:31], v[252:255], v[220:223]
 v_mul_f32 v44, s67, v44
 v_mfma_f32_16x16x32_bf16 v[160:163], a[32:35], v[224:227], v[160:163]
 ds_read_b64_tr_b16 v[244:245], v7 offset:40960
 v_lshlrev_b32 v38, 7, v0
 v_mfma_f32_16x16x32_bf16 v[164:167], a[36:39], v[224:227], v[164:167]
 ds_read_b64_tr_b16 v[246:247], v7 offset:41984
 v_min_u32 v38, 4992, v38
 v_mfma_f32_16x16x32_bf16 v[192:195], a[40:43], v[224:227], v[192:195]
 s_mul_i32 s72, s70, 5120
 v_mul_f32 v45, s67, v45
 v_mfma_f32_16x16x32_bf16 v[196:199], a[44:47], v[224:227], v[196:199]
 v_mul_f32 v46, s67, v46
 s_waitcnt lgkmcnt(4)
 v_mfma_f32_16x16x32_bf16 v[168:171], a[32:35], v[228:231], v[168:171]
 ds_read_b64_tr_b16 v[248:249], v8 offset:40960
 v_min_u32 v39, 2048, v38
 v_mfma_f32_16x16x32_bf16 v[172:175], a[36:39], v[228:231], v[172:175]
 ds_read_b64_tr_b16 v[250:251], v8 offset:41984
 s_mul_i32 s73, s70, 2176
 v_mfma_f32_16x16x32_bf16 v[200:203], a[40:43], v[228:231], v[200:203]
 v_mul_f32 v47, s67, v47
 v_cvt_pk_bf16_f32 v40, v40, v41
 v_mfma_f32_16x16x32_bf16 v[204:207], a[44:47], v[228:231], v[204:207]
 v_cvt_pk_bf16_f32 v41, v42, v43
 v_cvt_pk_bf16_f32 v42, v44, v45
 v_mfma_f32_16x16x32_bf16 v[176:179], a[32:35], v[232:235], v[176:179]
 ds_read_b64_tr_b16 v[252:253], v9 offset:40960
 v_cvt_pk_bf16_f32 v43, v46, v47
 v_mfma_f32_16x16x32_bf16 v[180:183], a[36:39], v[232:235], v[180:183]
 buffer_load_dword v1, v38, s[28:31], s72 offen
 v_mfma_f32_16x16x32_bf16 v[208:211], a[40:43], v[232:235], v[208:211]
 ds_read_b64_tr_b16 v[254:255], v9 offset:41984
 s_add_u32 s57, s66, 0
 v_mfma_f32_16x16x32_bf16 v[212:215], a[44:47], v[232:235], v[212:215]
 v_add_u32 v6, 131072, v6
 v_add_u32 v7, 131072, v7
 v_mfma_f32_16x16x32_bf16 v[184:187], a[32:35], v[236:239], v[184:187]
 v_add_u32 v8, 131072, v8
 v_add_u32 v9, 131072, v9
 v_mfma_f32_16x16x32_bf16 v[188:191], a[36:39], v[236:239], v[188:191]
 v_add_u32 v10, 131072, v10
 v_add_u32 v11, 131072, v11
 v_mfma_f32_16x16x32_bf16 v[216:219], a[40:43], v[236:239], v[216:219]
 v_add_u32 v12, 131072, v12
 v_add_u32 v13, 131072, v13
 v_mfma_f32_16x16x32_bf16 v[220:223], a[44:47], v[236:239], v[220:223]
 ds_read_b64_tr_b16 v[224:225], v6 offset:0
 s_waitcnt lgkmcnt(3)
 v_mfma_f32_16x16x32_bf16 v[160:163], a[48:51], v[240:243], v[160:163]
 ds_read_b64_tr_b16 v[226:227], v6 offset:1024
 ds_read_b64_tr_b16 v[228:229], v7 offset:0
 v_mfma_f32_16x16x32_bf16 v[164:167], a[52:55], v[240:243], v[164:167]
 ds_read_b64_tr_b16 v[230:231], v7 offset:1024
 v_mfma_f32_16x16x32_bf16 v[192:195], a[56:59], v[240:243], v[192:195]
 buffer_store_dwordx4 v[40:43], v23, s[4:7], s57 offen offset:2048 sc1
 v_mfma_f32_16x16x32_bf16 v[196:199], a[60:63], v[240:243], v[196:199]
 v_mul_f32 v48, s67, v48
 v_mul_f32 v49, s67, v49
 v_mfma_f32_16x16x32_bf16 v[168:171], a[48:51], v[244:247], v[168:171]
 ds_read_b64_tr_b16 v[232:233], v8 offset:0
 ds_read_b64_tr_b16 v[234:235], v8 offset:1024
 v_mfma_f32_16x16x32_bf16 v[172:175], a[52:55], v[244:247], v[172:175]
 v_mul_f32 v50, s67, v50
 v_mul_f32 v51, s67, v51
 v_mfma_f32_16x16x32_bf16 v[200:203], a[56:59], v[244:247], v[200:203]
 v_mul_f32 v52, s67, v52
 v_mul_f32 v53, s67, v53
 v_mfma_f32_16x16x32_bf16 v[204:207], a[60:63], v[244:247], v[204:207]
 v_mul_f32 v54, s67, v54
 v_mul_f32 v55, s67, v55
 v_mfma_f32_16x16x32_bf16 v[176:179], a[48:51], v[248:251], v[176:179]
 ds_read_b64_tr_b16 v[236:237], v9 offset:0
 ds_read_b64_tr_b16 v[238:239], v9 offset:1024
 v_mfma_f32_16x16x32_bf16 v[180:183], a[52:55], v[248:251], v[180:183]
 v_cvt_pk_bf16_f32 v48, v48, v49
 v_cvt_pk_bf16_f32 v49, v50, v51
 v_mfma_f32_16x16x32_bf16 v[208:211], a[56:59], v[248:251], v[208:211]
 v_cvt_pk_bf16_f32 v50, v52, v53
 v_cvt_pk_bf16_f32 v51, v54, v55
 v_mfma_f32_16x16x32_bf16 v[212:215], a[60:63], v[248:251], v[212:215]
 s_add_u32 s57, s66, 4096
 s_waitcnt lgkmcnt(4)
 v_mfma_f32_16x16x32_bf16 v[184:187], a[48:51], v[252:255], v[184:187]
 ds_read_b64_tr_b16 v[240:241], v6 offset:8192
 ds_read_b64_tr_b16 v[242:243], v6 offset:9216
 v_mfma_f32_16x16x32_bf16 v[188:191], a[52:55], v[252:255], v[188:191]
 buffer_store_dwordx4 v[48:51], v23, s[4:7], s57 offen offset:0 sc1
 v_mfma_f32_16x16x32_bf16 v[216:219], a[56:59], v[252:255], v[216:219]
 v_mul_f32 v56, s67, v56
 v_mfma_f32_16x16x32_bf16 v[220:223], a[60:63], v[252:255], v[220:223]
 v_mul_f32 v57, s67, v57
 v_mfma_f32_16x16x32_bf16 v[160:163], a[64:67], v[224:227], v[160:163]
 ds_read_b64_tr_b16 v[244:245], v7 offset:8192
 ds_read_b64_tr_b16 v[246:247], v7 offset:9216
 v_mfma_f32_16x16x32_bf16 v[164:167], a[68:71], v[224:227], v[164:167]
 v_mul_f32 v58, s67, v58
 v_mfma_f32_16x16x32_bf16 v[192:195], a[72:75], v[224:227], v[192:195]
 v_mul_f32 v59, s67, v59
 v_mfma_f32_16x16x32_bf16 v[196:199], a[76:79], v[224:227], v[196:199]
 v_mul_f32 v60, s67, v60
 v_mfma_f32_16x16x32_bf16 v[168:171], a[64:67], v[228:231], v[168:171]
 ds_read_b64_tr_b16 v[248:249], v8 offset:8192
 ds_read_b64_tr_b16 v[250:251], v8 offset:9216
 v_mfma_f32_16x16x32_bf16 v[172:175], a[68:71], v[228:231], v[172:175]
 v_mul_f32 v61, s67, v61
 v_mfma_f32_16x16x32_bf16 v[200:203], a[72:75], v[228:231], v[200:203]
 v_mul_f32 v62, s67, v62
 v_mfma_f32_16x16x32_bf16 v[204:207], a[76:79], v[228:231], v[204:207]
 v_mul_f32 v63, s67, v63
 s_waitcnt lgkmcnt(4)
 v_mfma_f32_16x16x32_bf16 v[176:179], a[64:67], v[232:235], v[176:179]
 ds_read_b64_tr_b16 v[252:253], v9 offset:8192
 ds_read_b64_tr_b16 v[254:255], v9 offset:9216
 v_mfma_f32_16x16x32_bf16 v[180:183], a[68:71], v[232:235], v[180:183]
 v_cvt_pk_bf16_f32 v56, v56, v57
 v_mfma_f32_16x16x32_bf16 v[208:211], a[72:75], v[232:235], v[208:211]
 v_cvt_pk_bf16_f32 v57, v58, v59
 v_mfma_f32_16x16x32_bf16 v[212:215], a[76:79], v[232:235], v[212:215]
 v_cvt_pk_bf16_f32 v58, v60, v61
 v_mfma_f32_16x16x32_bf16 v[184:187], a[64:67], v[236:239], v[184:187]
 ds_read_b64_tr_b16 v[224:225], v6 offset:16384
 ds_read_b64_tr_b16 v[226:227], v6 offset:17408
 v_mfma_f32_16x16x32_bf16 v[188:191], a[68:71], v[236:239], v[188:191]
 v_cvt_pk_bf16_f32 v59, v62, v63
 s_add_u32 s57, s66, 4096
 v_mfma_f32_16x16x32_bf16 v[216:219], a[72:75], v[236:239], v[216:219]
 v_mfma_f32_16x16x32_bf16 v[220:223], a[76:79], v[236:239], v[220:223]
 buffer_store_dwordx4 v[56:59], v23, s[4:7], s57 offen offset:2048 sc1
 v_mfma_f32_16x16x32_bf16 v[160:163], a[80:83], v[240:243], v[160:163]
 ds_read_b64_tr_b16 v[228:229], v7 offset:16384
 ds_read_b64_tr_b16 v[230:231], v7 offset:17408
 v_mfma_f32_16x16x32_bf16 v[164:167], a[84:87], v[240:243], v[164:167]
 v_mul_f32 v64, s67, v64
 v_mul_f32 v65, s67, v65
 v_mfma_f32_16x16x32_bf16 v[192:195], a[88:91], v[240:243], v[192:195]
 v_mfma_f32_16x16x32_bf16 v[196:199], a[92:95], v[240:243], v[196:199]
 v_mul_f32 v66, s67, v66
 s_waitcnt lgkmcnt(4)
 v_mfma_f32_16x16x32_bf16 v[168:171], a[80:83], v[244:247], v[168:171]
 ds_read_b64_tr_b16 v[232:233], v8 offset:16384
 ds_read_b64_tr_b16 v[234:235], v8 offset:17408
 v_mfma_f32_16x16x32_bf16 v[172:175], a[84:87], v[244:247], v[172:175]
 v_mul_f32 v67, s67, v67
 v_mul_f32 v68, s67, v68
 v_mfma_f32_16x16x32_bf16 v[200:203], a[88:91], v[244:247], v[200:203]
 v_mul_f32 v69, s67, v69
 v_mfma_f32_16x16x32_bf16 v[204:207], a[92:95], v[244:247], v[204:207]
 v_mfma_f32_16x16x32_bf16 v[176:179], a[80:83], v[248:251], v[176:179]
 ds_read_b64_tr_b16 v[236:237], v9 offset:16384
 ds_read_b64_tr_b16 v[238:239], v9 offset:17408
 v_mfma_f32_16x16x32_bf16 v[180:183], a[84:87], v[248:251], v[180:183]
 v_mul_f32 v70, s67, v70
 v_mul_f32 v71, s67, v71
 v_mfma_f32_16x16x32_bf16 v[208:211], a[88:91], v[248:251], v[208:211]
 v_cvt_pk_bf16_f32 v64, v64, v65
 v_mfma_f32_16x16x32_bf16 v[212:215], a[92:95], v[248:251], v[212:215]
 v_mfma_f32_16x16x32_bf16 v[184:187], a[80:83], v[252:255], v[184:187]
 ds_read_b64_tr_b16 v[240:241], v6 offset:24576
 ds_read_b64_tr_b16 v[242:243], v6 offset:25600
 v_mfma_f32_16x16x32_bf16 v[188:191], a[84:87], v[252:255], v[188:191]
 v_cvt_pk_bf16_f32 v65, v66, v67
 v_cvt_pk_bf16_f32 v66, v68, v69
 v_mfma_f32_16x16x32_bf16 v[216:219], a[88:91], v[252:255], v[216:219]
 v_cvt_pk_bf16_f32 v67, v70, v71
 v_mfma_f32_16x16x32_bf16 v[220:223], a[92:95], v[252:255], v[220:223]
 s_waitcnt lgkmcnt(4)
 v_mfma_f32_16x16x32_bf16 v[160:163], a[96:99], v[224:227], v[160:163]
 ds_read_b64_tr_b16 v[244:245], v7 offset:24576
 ds_read_b64_tr_b16 v[246:247], v7 offset:25600
 v_mfma_f32_16x16x32_bf16 v[164:167], a[100:103], v[224:227], v[164:167]
 s_add_u32 s57, s66, 0
 v_mfma_f32_16x16x32_bf16 v[192:195], a[104:107], v[224:227], v[192:195]
 buffer_store_dwordx4 v[64:67], v23, s[4:7], s57 offen offset:128 sc1
 v_mfma_f32_16x16x32_bf16 v[196:199], a[108:111], v[224:227], v[196:199]
 v_mul_f32 v72, s67, v72
 v_mul_f32 v73, s67, v73
 v_mfma_f32_16x16x32_bf16 v[168:171], a[96:99], v[228:231], v[168:171]
 ds_read_b64_tr_b16 v[248:249], v8 offset:24576
 ds_read_b64_tr_b16 v[250:251], v8 offset:25600
 v_mfma_f32_16x16x32_bf16 v[172:175], a[100:103], v[228:231], v[172:175]
 v_mul_f32 v74, s67, v74
 v_mfma_f32_16x16x32_bf16 v[200:203], a[104:107], v[228:231], v[200:203]
 v_mul_f32 v75, s67, v75
 v_mfma_f32_16x16x32_bf16 v[204:207], a[108:111], v[228:231], v[204:207]
 v_mul_f32 v76, s67, v76
 v_mfma_f32_16x16x32_bf16 v[176:179], a[96:99], v[232:235], v[176:179]
 ds_read_b64_tr_b16 v[252:253], v9 offset:24576
 ds_read_b64_tr_b16 v[254:255], v9 offset:25600
 v_mfma_f32_16x16x32_bf16 v[180:183], a[100:103], v[232:235], v[180:183]
 v_mul_f32 v77, s67, v77
 v_mfma_f32_16x16x32_bf16 v[208:211], a[104:107], v[232:235], v[208:211]
 v_mul_f32 v78, s67, v78
 v_mfma_f32_16x16x32_bf16 v[212:215], a[108:111], v[232:235], v[212:215]
 v_mul_f32 v79, s67, v79
 s_waitcnt lgkmcnt(4)
 v_mfma_f32_16x16x32_bf16 v[184:187], a[96:99], v[236:239], v[184:187]
 v_cvt_pk_bf16_f32 v72, v72, v73
 v_mfma_f32_16x16x32_bf16 v[188:191], a[100:103], v[236:239], v[188:191]
 v_mfma_f32_16x16x32_bf16 v[216:219], a[104:107], v[236:239], v[216:219]
 v_cvt_pk_bf16_f32 v73, v74, v75
 v_mfma_f32_16x16x32_bf16 v[220:223], a[108:111], v[236:239], v[220:223]
 v_cvt_pk_bf16_f32 v74, v76, v77
 v_mfma_f32_16x16x32_bf16 v[160:163], a[112:115], v[240:243], v[160:163]
 v_cvt_pk_bf16_f32 v75, v78, v79
 v_mfma_f32_16x16x32_bf16 v[164:167], a[116:119], v[240:243], v[164:167]
 v_mfma_f32_16x16x32_bf16 v[192:195], a[120:123], v[240:243], v[192:195]
 s_add_u32 s57, s66, 0
 v_mfma_f32_16x16x32_bf16 v[196:199], a[124:127], v[240:243], v[196:199]
 buffer_store_dwordx4 v[72:75], v23, s[4:7], s57 offen offset:2176 sc1
 v_mfma_f32_16x16x32_bf16 v[168:171], a[112:115], v[244:247], v[168:171]
 s_waitcnt vmcnt(11)
 s_waitcnt vmcnt(7)
 s_waitcnt lgkmcnt(0)
 s_barrier
 v_mfma_f32_16x16x32_bf16 v[172:175], a[116:119], v[244:247], v[172:175]
 v_add_u32 v6, 4294901760, v6
 v_add_u32 v7, 4294901760, v7
 v_mfma_f32_16x16x32_bf16 v[200:203], a[120:123], v[244:247], v[200:203]
 v_add_u32 v8, 4294901760, v8
 v_add_u32 v9, 4294901760, v9
 v_mfma_f32_16x16x32_bf16 v[204:207], a[124:127], v[244:247], v[204:207]
 v_add_u32 v10, 4294901760, v10
 v_add_u32 v11, 4294901760, v11
 v_mfma_f32_16x16x32_bf16 v[176:179], a[112:115], v[248:251], v[176:179]
 v_add_u32 v12, 4294901760, v12
 v_add_u32 v13, 4294901760, v13
 ds_read_b64_tr_b16 v[224:225], v6 offset:0
 ds_read_b64_tr_b16 v[226:227], v6 offset:1024
 v_mfma_f32_16x16x32_bf16 v[180:183], a[116:119], v[248:251], v[180:183]
 ds_read_b64_tr_b16 v[228:229], v7 offset:0
 ds_read_b64_tr_b16 v[230:231], v7 offset:1024
 v_mfma_f32_16x16x32_bf16 v[208:211], a[120:123], v[248:251], v[208:211]
 ds_read_b64_tr_b16 v[232:233], v8 offset:0
 ds_read_b64_tr_b16 v[234:235], v8 offset:1024
 v_mfma_f32_16x16x32_bf16 v[212:215], a[124:127], v[248:251], v[212:215]
 ds_read_b64_tr_b16 v[236:237], v9 offset:0
 ds_read_b64_tr_b16 v[238:239], v9 offset:1024
 v_mfma_f32_16x16x32_bf16 v[184:187], a[112:115], v[252:255], v[184:187]
 ds_read_b64_tr_b16 v[240:241], v6 offset:8192
 ds_read_b64_tr_b16 v[242:243], v6 offset:9216
 v_mfma_f32_16x16x32_bf16 v[188:191], a[116:119], v[252:255], v[188:191]
 v_mul_f32 v80, s67, v80
 v_mul_f32 v81, s67, v81
 v_mfma_f32_16x16x32_bf16 v[216:219], a[120:123], v[252:255], v[216:219]
 v_mul_f32 v82, s67, v82
 v_mul_f32 v83, s67, v83
 v_mfma_f32_16x16x32_bf16 v[220:223], a[124:127], v[252:255], v[220:223]
 v_mul_f32 v84, s67, v84
 s_waitcnt lgkmcnt(8)
 v_mfma_f32_16x16x32_bf16 v[160:163], a[128:131], v[224:227], v[160:163]
 ds_read_b64_tr_b16 v[244:245], v7 offset:8192
 ds_read_b64_tr_b16 v[246:247], v7 offset:9216
 v_mfma_f32_16x16x32_bf16 v[164:167], a[132:135], v[224:227], v[164:167]
 v_mul_f32 v85, s67, v85
 v_mul_f32 v86, s67, v86
 v_mfma_f32_16x16x32_bf16 v[192:195], a[136:139], v[224:227], v[192:195]
 v_mul_f32 v87, s67, v87
 v_cvt_pk_bf16_f32 v80, v80, v81
 v_mfma_f32_16x16x32_bf16 v[196:199], a[140:143], v[224:227], v[196:199]
 v_cvt_pk_bf16_f32 v81, v82, v83
 s_waitcnt lgkmcnt(8)
 v_mfma_f32_16x16x32_bf16 v[168:171], a[128:131], v[228:231], v[168:171]
 ds_read_b64_tr_b16 v[248:249], v8 offset:8192
 ds_read_b64_tr_b16 v[250:251], v8 offset:9216
 v_mfma_f32_16x16x32_bf16 v[172:175], a[132:135], v[228:231], v[172:175]
 v_cvt_pk_bf16_f32 v82, v84, v85
 v_cvt_pk_bf16_f32 v83, v86, v87
 v_mfma_f32_16x16x32_bf16 v[200:203], a[136:139], v[228:231], v[200:203]
 s_add_u32 s57, s66, 4096
 v_mfma_f32_16x16x32_bf16 v[204:207], a[140:143], v[228:231], v[204:207]
 s_waitcnt lgkmcnt(4)
 v_mfma_f32_16x16x32_bf16 v[176:179], a[128:131], v[232:235], v[176:179]
 ds_read_b64_tr_b16 v[252:253], v9 offset:8192
 ds_read_b64_tr_b16 v[254:255], v9 offset:9216
 v_mfma_f32_16x16x32_bf16 v[180:183], a[132:135], v[232:235], v[180:183]
 buffer_store_dwordx4 v[80:83], v23, s[4:7], s57 offen offset:128 sc1
 v_mfma_f32_16x16x32_bf16 v[208:211], a[136:139], v[232:235], v[208:211]
 v_mul_f32 v88, s67, v88
 v_mul_f32 v89, s67, v89
 v_mfma_f32_16x16x32_bf16 v[212:215], a[140:143], v[232:235], v[212:215]
 v_mul_f32 v90, s67, v90
 v_mul_f32 v91, s67, v91
 v_mfma_f32_16x16x32_bf16 v[184:187], a[128:131], v[236:239], v[184:187]
 ds_read_b64_tr_b16 v[224:225], v6 offset:16384
 ds_read_b64_tr_b16 v[226:227], v6 offset:17408
 v_mfma_f32_16x16x32_bf16 v[188:191], a[132:135], v[236:239], v[188:191]
 v_mul_f32 v92, s67, v92
 v_mul_f32 v93, s67, v93
 v_mfma_f32_16x16x32_bf16 v[216:219], a[136:139], v[236:239], v[216:219]
 v_mul_f32 v94, s67, v94
 v_mfma_f32_16x16x32_bf16 v[220:223], a[140:143], v[236:239], v[220:223]
 v_mul_f32 v95, s67, v95
 v_mfma_f32_16x16x32_bf16 v[160:163], a[144:147], v[240:243], v[160:163]
 ds_read_b64_tr_b16 v[228:229], v7 offset:16384
 ds_read_b64_tr_b16 v[230:231], v7 offset:17408
 v_mfma_f32_16x16x32_bf16 v[164:167], a[148:151], v[240:243], v[164:167]
 v_cvt_pk_bf16_f32 v88, v88, v89
 v_mfma_f32_16x16x32_bf16 v[192:195], a[152:155], v[240:243], v[192:195]
 v_cvt_pk_bf16_f32 v89, v90, v91
 v_mfma_f32_16x16x32_bf16 v[196:199], a[156:159], v[240:243], v[196:199]
 v_cvt_pk_bf16_f32 v90, v92, v93
 s_waitcnt lgkmcnt(4)
 v_mfma_f32_16x16x32_bf16 v[168:171], a[144:147], v[244:247], v[168:171]
 ds_read_b64_tr_b16 v[232:233], v8 offset:16384
 ds_read_b64_tr_b16 v[234:235], v8 offset:17408
 v_mfma_f32_16x16x32_bf16 v[172:175], a[148:151], v[244:247], v[172:175]
 v_cvt_pk_bf16_f32 v91, v94, v95
 v_mfma_f32_16x16x32_bf16 v[200:203], a[152:155], v[244:247], v[200:203]
 s_add_u32 s57, s66, 4096
 v_mfma_f32_16x16x32_bf16 v[204:207], a[156:159], v[244:247], v[204:207]
 buffer_store_dwordx4 v[88:91], v23, s[4:7], s57 offen offset:2176 sc1
 v_mfma_f32_16x16x32_bf16 v[176:179], a[144:147], v[248:251], v[176:179]
 ds_read_b64_tr_b16 v[236:237], v9 offset:16384
 ds_read_b64_tr_b16 v[238:239], v9 offset:17408
 v_mfma_f32_16x16x32_bf16 v[180:183], a[148:151], v[248:251], v[180:183]
 v_mfma_f32_16x16x32_bf16 v[208:211], a[152:155], v[248:251], v[208:211]
 v_mul_f32 v96, s67, v96
 v_mfma_f32_16x16x32_bf16 v[212:215], a[156:159], v[248:251], v[212:215]
 v_mul_f32 v97, s67, v97
 v_mfma_f32_16x16x32_bf16 v[184:187], a[144:147], v[252:255], v[184:187]
 ds_read_b64_tr_b16 v[240:241], v6 offset:24576
 ds_read_b64_tr_b16 v[242:243], v6 offset:25600
 v_mfma_f32_16x16x32_bf16 v[188:191], a[148:151], v[252:255], v[188:191]
 v_mul_f32 v98, s67, v98
 v_mul_f32 v99, s67, v99
 v_mfma_f32_16x16x32_bf16 v[216:219], a[152:155], v[252:255], v[216:219]
 v_mul_f32 v100, s67, v100
 v_mfma_f32_16x16x32_bf16 v[220:223], a[156:159], v[252:255], v[220:223]
 s_waitcnt lgkmcnt(4)
 v_mfma_f32_16x16x32_bf16 v[160:163], a[160:163], v[224:227], v[160:163]
 ds_read_b64_tr_b16 v[244:245], v7 offset:24576
 v_mul_f32 v101, s67, v101
 v_mfma_f32_16x16x32_bf16 v[164:167], a[164:167], v[224:227], v[164:167]
 buffer_load_dword v1, v39, s[32:35], s73 offen
 v_mfma_f32_16x16x32_bf16 v[192:195], a[168:171], v[224:227], v[192:195]
 ds_read_b64_tr_b16 v[246:247], v7 offset:25600
 v_mul_f32 v102, s67, v102
 v_mfma_f32_16x16x32_bf16 v[196:199], a[172:175], v[224:227], v[196:199]
 v_mul_f32 v103, s67, v103
 v_cvt_pk_bf16_f32 v96, v96, v97
 v_mfma_f32_16x16x32_bf16 v[168:171], a[160:163], v[228:231], v[168:171]
 ds_read_b64_tr_b16 v[248:249], v8 offset:24576
 ds_read_b64_tr_b16 v[250:251], v8 offset:25600
 v_mfma_f32_16x16x32_bf16 v[172:175], a[164:167], v[228:231], v[172:175]
 v_cvt_pk_bf16_f32 v97, v98, v99
 v_mfma_f32_16x16x32_bf16 v[200:203], a[168:171], v[228:231], v[200:203]
 v_cvt_pk_bf16_f32 v98, v100, v101
 v_mfma_f32_16x16x32_bf16 v[204:207], a[172:175], v[228:231], v[204:207]
 v_cvt_pk_bf16_f32 v99, v102, v103
 v_mfma_f32_16x16x32_bf16 v[176:179], a[160:163], v[232:235], v[176:179]
 ds_read_b64_tr_b16 v[252:253], v9 offset:24576
 ds_read_b64_tr_b16 v[254:255], v9 offset:25600
 v_mfma_f32_16x16x32_bf16 v[180:183], a[164:167], v[232:235], v[180:183]
 s_add_u32 s57, s66, 8192
 v_mfma_f32_16x16x32_bf16 v[208:211], a[168:171], v[232:235], v[208:211]
 buffer_store_dwordx4 v[96:99], v23, s[4:7], s57 offen offset:0 sc1
 v_mfma_f32_16x16x32_bf16 v[212:215], a[172:175], v[232:235], v[212:215]
 v_add_u32 v6, 4294901760, v6
 s_waitcnt lgkmcnt(5)
 v_mfma_f32_16x16x32_bf16 v[184:187], a[160:163], v[236:239], v[184:187]
 v_add_u32 v7, 4294901760, v7
 v_add_u32 v8, 4294901760, v8
 v_mfma_f32_16x16x32_bf16 v[188:191], a[164:167], v[236:239], v[188:191]
 v_add_u32 v9, 4294901760, v9
 v_add_u32 v10, 4294901760, v10
 v_mfma_f32_16x16x32_bf16 v[216:219], a[168:171], v[236:239], v[216:219]
 v_add_u32 v11, 4294901760, v11
 v_add_u32 v12, 4294901760, v12
 v_mfma_f32_16x16x32_bf16 v[220:223], a[172:175], v[236:239], v[220:223]
 v_add_u32 v13, 4294901760, v13
 ds_read_b64_tr_b16 v[224:225], v6 offset:0
 v_mfma_f32_16x16x32_bf16 v[160:163], a[176:179], v[240:243], v[160:163]
 ds_read_b64_tr_b16 v[226:227], v6 offset:1024
 ds_read_b64_tr_b16 v[228:229], v7 offset:0
 v_mfma_f32_16x16x32_bf16 v[164:167], a[180:183], v[240:243], v[164:167]
 ds_read_b64_tr_b16 v[230:231], v7 offset:1024
 v_mul_f32 v104, s67, v104
 v_mfma_f32_16x16x32_bf16 v[192:195], a[184:187], v[240:243], v[192:195]
 v_mul_f32 v105, s67, v105
 v_mul_f32 v106, s67, v106
 v_mfma_f32_16x16x32_bf16 v[196:199], a[188:191], v[240:243], v[196:199]
 v_mul_f32 v107, s67, v107
 s_waitcnt lgkmcnt(4)
 v_mfma_f32_16x16x32_bf16 v[168:171], a[176:179], v[244:247], v[168:171]
 ds_read_b64_tr_b16 v[232:233], v8 offset:0
 ds_read_b64_tr_b16 v[234:235], v8 offset:1024
 v_mfma_f32_16x16x32_bf16 v[172:175], a[180:183], v[244:247], v[172:175]
 v_mul_f32 v108, s67, v108
 v_mul_f32 v109, s67, v109
 v_mfma_f32_16x16x32_bf16 v[200:203], a[184:187], v[244:247], v[200:203]
 v_mul_f32 v110, s67, v110
 v_mul_f32 v111, s67, v111
 v_mfma_f32_16x16x32_bf16 v[204:207], a[188:191], v[244:247], v[204:207]
 v_cvt_pk_bf16_f32 v104, v104, v105
 v_cvt_pk_bf16_f32 v105, v106, v107
 v_mfma_f32_16x16x32_bf16 v[176:179], a[176:179], v[248:251], v[176:179]
 ds_read_b64_tr_b16 v[236:237], v9 offset:0
 ds_read_b64_tr_b16 v[238:239], v9 offset:1024
 v_mfma_f32_16x16x32_bf16 v[180:183], a[180:183], v[248:251], v[180:183]
 v_cvt_pk_bf16_f32 v106, v108, v109
 v_cvt_pk_bf16_f32 v107, v110, v111
 v_mfma_f32_16x16x32_bf16 v[208:211], a[184:187], v[248:251], v[208:211]
 s_add_u32 s57, s66, 8192
 v_mfma_f32_16x16x32_bf16 v[212:215], a[188:191], v[248:251], v[212:215]
 buffer_store_dwordx4 v[104:107], v23, s[4:7], s57 offen offset:2048 sc1
 v_mfma_f32_16x16x32_bf16 v[184:187], a[176:179], v[252:255], v[184:187]
 ds_read_b64_tr_b16 v[240:241], v6 offset:8192
 ds_read_b64_tr_b16 v[242:243], v6 offset:9216
 v_mfma_f32_16x16x32_bf16 v[188:191], a[180:183], v[252:255], v[188:191]
 v_mul_f32 v112, s67, v112
 v_mul_f32 v113, s67, v113
 v_mfma_f32_16x16x32_bf16 v[216:219], a[184:187], v[252:255], v[216:219]
 v_mul_f32 v114, s67, v114
 v_mfma_f32_16x16x32_bf16 v[220:223], a[188:191], v[252:255], v[220:223]
 v_mul_f32 v115, s67, v115
 s_waitcnt lgkmcnt(4)
 v_mfma_f32_16x16x32_bf16 v[160:163], a[192:195], v[224:227], v[160:163]
 ds_read_b64_tr_b16 v[244:245], v7 offset:8192
 ds_read_b64_tr_b16 v[246:247], v7 offset:9216
 v_mfma_f32_16x16x32_bf16 v[164:167], a[196:199], v[224:227], v[164:167]
 v_mul_f32 v116, s67, v116
 v_mfma_f32_16x16x32_bf16 v[192:195], a[200:203], v[224:227], v[192:195]
 v_mul_f32 v117, s67, v117
 v_mfma_f32_16x16x32_bf16 v[196:199], a[204:207], v[224:227], v[196:199]
 v_mul_f32 v118, s67, v118
 v_mfma_f32_16x16x32_bf16 v[168:171], a[192:195], v[228:231], v[168:171]
 ds_read_b64_tr_b16 v[248:249], v8 offset:8192
 ds_read_b64_tr_b16 v[250:251], v8 offset:9216
 v_mfma_f32_16x16x32_bf16 v[172:175], a[196:199], v[228:231], v[172:175]
 v_mul_f32 v119, s67, v119
 v_cvt_pk_bf16_f32 v112, v112, v113
 v_mfma_f32_16x16x32_bf16 v[200:203], a[200:203], v[228:231], v[200:203]
 v_cvt_pk_bf16_f32 v113, v114, v115
 v_mfma_f32_16x16x32_bf16 v[204:207], a[204:207], v[228:231], v[204:207]
 v_mfma_f32_16x16x32_bf16 v[176:179], a[192:195], v[232:235], v[176:179]
 ds_read_b64_tr_b16 v[252:253], v9 offset:8192
 ds_read_b64_tr_b16 v[254:255], v9 offset:9216
 v_mfma_f32_16x16x32_bf16 v[180:183], a[196:199], v[232:235], v[180:183]
 v_cvt_pk_bf16_f32 v114, v116, v117
 v_cvt_pk_bf16_f32 v115, v118, v119
 v_mfma_f32_16x16x32_bf16 v[208:211], a[200:203], v[232:235], v[208:211]
 s_add_u32 s57, s66, 12288
 v_mfma_f32_16x16x32_bf16 v[212:215], a[204:207], v[232:235], v[212:215]
 s_waitcnt lgkmcnt(4)
 v_mfma_f32_16x16x32_bf16 v[184:187], a[192:195], v[236:239], v[184:187]
 ds_read_b64_tr_b16 v[224:225], v6 offset:16384
 ds_read_b64_tr_b16 v[226:227], v6 offset:17408
 v_mfma_f32_16x16x32_bf16 v[188:191], a[196:199], v[236:239], v[188:191]
 buffer_store_dwordx4 v[112:115], v23, s[4:7], s57 offen offset:0 sc1
 v_mfma_f32_16x16x32_bf16 v[216:219], a[200:203], v[236:239], v[216:219]
 v_mul_f32 v120, s67, v120
 v_mul_f32 v121, s67, v121
 v_mfma_f32_16x16x32_bf16 v[220:223], a[204:207], v[236:239], v[220:223]
 v_mul_f32 v122, s67, v122
 v_mfma_f32_16x16x32_bf16 v[160:163], a[208:211], v[240:243], v[160:163]
 ds_read_b64_tr_b16 v[228:229], v7 offset:16384
 ds_read_b64_tr_b16 v[230:231], v7 offset:17408
 v_mfma_f32_16x16x32_bf16 v[164:167], a[212:215], v[240:243], v[164:167]
 v_mul_f32 v123, s67, v123
 v_mul_f32 v124, s67, v124
 v_mfma_f32_16x16x32_bf16 v[192:195], a[216:219], v[240:243], v[192:195]
 v_mfma_f32_16x16x32_bf16 v[196:199], a[220:223], v[240:243], v[196:199]
 v_mul_f32 v125, s67, v125
 v_mfma_f32_16x16x32_bf16 v[168:171], a[208:211], v[244:247], v[168:171]
 ds_read_b64_tr_b16 v[232:233], v8 offset:16384
 ds_read_b64_tr_b16 v[234:235], v8 offset:17408
 v_mfma_f32_16x16x32_bf16 v[172:175], a[212:215], v[244:247], v[172:175]
 v_mul_f32 v126, s67, v126
 v_mul_f32 v127, s67, v127
 v_mfma_f32_16x16x32_bf16 v[200:203], a[216:219], v[244:247], v[200:203]
 v_cvt_pk_bf16_f32 v120, v120, v121
 v_mfma_f32_16x16x32_bf16 v[204:207], a[220:223], v[244:247], v[204:207]
 v_cvt_pk_bf16_f32 v121, v122, v123
 s_waitcnt lgkmcnt(4)
 v_mfma_f32_16x16x32_bf16 v[176:179], a[208:211], v[248:251], v[176:179]
 ds_read_b64_tr_b16 v[236:237], v9 offset:16384
 ds_read_b64_tr_b16 v[238:239], v9 offset:17408
 v_mfma_f32_16x16x32_bf16 v[180:183], a[212:215], v[248:251], v[180:183]
 v_cvt_pk_bf16_f32 v122, v124, v125
 v_mfma_f32_16x16x32_bf16 v[208:211], a[216:219], v[248:251], v[208:211]
 v_cvt_pk_bf16_f32 v123, v126, v127
 v_mfma_f32_16x16x32_bf16 v[212:215], a[220:223], v[248:251], v[212:215]
 s_add_u32 s57, s66, 12288
 v_mfma_f32_16x16x32_bf16 v[184:187], a[208:211], v[252:255], v[184:187]
 ds_read_b64_tr_b16 v[240:241], v6 offset:24576
 ds_read_b64_tr_b16 v[242:243], v6 offset:25600
 v_mfma_f32_16x16x32_bf16 v[188:191], a[212:215], v[252:255], v[188:191]
 buffer_store_dwordx4 v[120:123], v23, s[4:7], s57 offen offset:2048 sc1
 v_mfma_f32_16x16x32_bf16 v[216:219], a[216:219], v[252:255], v[216:219]
 v_mul_f32 v128, s67, v128
 v_mfma_f32_16x16x32_bf16 v[220:223], a[220:223], v[252:255], v[220:223]
 v_mul_f32 v129, s67, v129
 v_mfma_f32_16x16x32_bf16 v[160:163], a[224:227], v[224:227], v[160:163]
 ds_read_b64_tr_b16 v[244:245], v7 offset:24576
 ds_read_b64_tr_b16 v[246:247], v7 offset:25600
 v_mfma_f32_16x16x32_bf16 v[164:167], a[228:231], v[224:227], v[164:167]
 v_mul_f32 v130, s67, v130
 v_mul_f32 v131, s67, v131
 v_mfma_f32_16x16x32_bf16 v[192:195], a[232:235], v[224:227], v[192:195]
 v_mul_f32 v132, s67, v132
 v_mfma_f32_16x16x32_bf16 v[196:199], a[236:239], v[224:227], v[196:199]
 s_waitcnt lgkmcnt(4)
 v_mfma_f32_16x16x32_bf16 v[168:171], a[224:227], v[228:231], v[168:171]
 ds_read_b64_tr_b16 v[248:249], v8 offset:24576
 ds_read_b64_tr_b16 v[250:251], v8 offset:25600
 v_mfma_f32_16x16x32_bf16 v[172:175], a[228:231], v[228:231], v[172:175]
 v_mul_f32 v133, s67, v133
 v_mul_f32 v134, s67, v134
 v_mfma_f32_16x16x32_bf16 v[200:203], a[232:235], v[228:231], v[200:203]
 v_mul_f32 v135, s67, v135
 v_mfma_f32_16x16x32_bf16 v[204:207], a[236:239], v[228:231], v[204:207]
 v_cvt_pk_bf16_f32 v128, v128, v129
 v_mfma_f32_16x16x32_bf16 v[176:179], a[224:227], v[232:235], v[176:179]
 ds_read_b64_tr_b16 v[252:253], v9 offset:24576
 ds_read_b64_tr_b16 v[254:255], v9 offset:25600
 v_mfma_f32_16x16x32_bf16 v[180:183], a[228:231], v[232:235], v[180:183]
 v_cvt_pk_bf16_f32 v129, v130, v131
 v_mfma_f32_16x16x32_bf16 v[208:211], a[232:235], v[232:235], v[208:211]
 v_cvt_pk_bf16_f32 v130, v132, v133
 v_mfma_f32_16x16x32_bf16 v[212:215], a[236:239], v[232:235], v[212:215]
 v_cvt_pk_bf16_f32 v131, v134, v135
 v_mfma_f32_16x16x32_bf16 v[184:187], a[224:227], v[236:239], v[184:187]
 ds_read_b64_tr_b16 v[224:225], v10 offset:16384
 ds_read_b64_tr_b16 v[226:227], v10 offset:17408
 v_mfma_f32_16x16x32_bf16 v[188:191], a[228:231], v[236:239], v[188:191]
 s_add_u32 s57, s66, 8192
 v_mfma_f32_16x16x32_bf16 v[216:219], a[232:235], v[236:239], v[216:219]
 buffer_store_dwordx4 v[128:131], v23, s[4:7], s57 offen offset:128 sc1
 v_mfma_f32_16x16x32_bf16 v[220:223], a[236:239], v[236:239], v[220:223]
 v_mul_f32 v136, s67, v136
 s_waitcnt lgkmcnt(4)
 v_mfma_f32_16x16x32_bf16 v[160:163], a[240:243], v[240:243], v[160:163]
 ds_read_b64_tr_b16 v[228:229], v11 offset:16384
 ds_read_b64_tr_b16 v[230:231], v11 offset:17408
 v_mfma_f32_16x16x32_bf16 v[164:167], a[244:247], v[240:243], v[164:167]
 v_mul_f32 v137, s67, v137
 v_mul_f32 v138, s67, v138
 v_mfma_f32_16x16x32_bf16 v[192:195], a[248:251], v[240:243], v[192:195]
 v_mul_f32 v139, s67, v139
 v_mfma_f32_16x16x32_bf16 v[196:199], a[252:255], v[240:243], v[196:199]
 v_mul_f32 v140, s67, v140
 v_mfma_f32_16x16x32_bf16 v[168:171], a[240:243], v[244:247], v[168:171]
 ds_read_b64_tr_b16 v[232:233], v12 offset:16384
 ds_read_b64_tr_b16 v[234:235], v12 offset:17408
 v_mfma_f32_16x16x32_bf16 v[172:175], a[244:247], v[244:247], v[172:175]
 v_mul_f32 v141, s67, v141
 v_mfma_f32_16x16x32_bf16 v[200:203], a[248:251], v[244:247], v[200:203]
 v_mul_f32 v142, s67, v142
 v_mfma_f32_16x16x32_bf16 v[204:207], a[252:255], v[244:247], v[204:207]
 v_mul_f32 v143, s67, v143
 v_mfma_f32_16x16x32_bf16 v[176:179], a[240:243], v[248:251], v[176:179]
 ds_read_b64_tr_b16 v[236:237], v13 offset:16384
 ds_read_b64_tr_b16 v[238:239], v13 offset:17408
 v_mfma_f32_16x16x32_bf16 v[180:183], a[244:247], v[248:251], v[180:183]
 v_cvt_pk_bf16_f32 v136, v136, v137
 v_cvt_pk_bf16_f32 v137, v138, v139
 v_mfma_f32_16x16x32_bf16 v[208:211], a[248:251], v[248:251], v[208:211]
 v_mfma_f32_16x16x32_bf16 v[212:215], a[252:255], v[248:251], v[212:215]
 v_cvt_pk_bf16_f32 v138, v140, v141
 s_waitcnt lgkmcnt(4)
 v_mfma_f32_16x16x32_bf16 v[184:187], a[240:243], v[252:255], v[184:187]
 ds_read_b64_tr_b16 v[240:241], v10 offset:24576
 ds_read_b64_tr_b16 v[242:243], v10 offset:25600
 v_mfma_f32_16x16x32_bf16 v[188:191], a[244:247], v[252:255], v[188:191]
 v_cvt_pk_bf16_f32 v139, v142, v143
 s_add_u32 s57, s66, 8192
 v_mfma_f32_16x16x32_bf16 v[216:219], a[248:251], v[252:255], v[216:219]
 buffer_store_dwordx4 v[136:139], v23, s[4:7], s57 offen offset:2176 sc1
 v_mfma_f32_16x16x32_bf16 v[220:223], a[252:255], v[252:255], v[220:223]
 v_mfma_f32_16x16x32_bf16 v[32:35], a[224:227], v[224:227], 0
 ds_read_b64_tr_b16 v[244:245], v11 offset:24576
 ds_read_b64_tr_b16 v[246:247], v11 offset:25600
 v_mfma_f32_16x16x32_bf16 v[36:39], a[228:231], v[224:227], 0
 v_mul_f32 v144, s67, v144
 v_add_u32 v22, 20480, v14
 v_mfma_f32_16x16x32_bf16 v[64:67], a[232:235], v[224:227], 0
 v_mul_f32 v145, s67, v145
 v_bfe_u32 v29, v0, 1, 2
 v_mfma_f32_16x16x32_bf16 v[68:71], a[236:239], v[224:227], 0
 v_mul_f32 v146, s67, v146
 v_mul_f32 v147, s67, v147
 v_mfma_f32_16x16x32_bf16 v[40:43], a[224:227], v[228:231], 0
 ds_read_b64_tr_b16 v[248:249], v12 offset:24576
 ds_read_b64_tr_b16 v[250:251], v12 offset:25600
 v_mfma_f32_16x16x32_bf16 v[44:47], a[228:231], v[228:231], 0
 v_bfe_u32 v28, v0, 4, 1
 v_mul_f32 v148, s67, v148
 v_mfma_f32_16x16x32_bf16 v[72:75], a[232:235], v[228:231], 0
 v_xor_b32 v29, v29, v28
 v_mul_f32 v149, s67, v149
 v_mfma_f32_16x16x32_bf16 v[76:79], a[236:239], v[228:231], 0
 v_mul_f32 v150, s67, v150
 s_waitcnt lgkmcnt(4)
 v_mfma_f32_16x16x32_bf16 v[48:51], a[224:227], v[232:235], 0
 ds_read_b64_tr_b16 v[252:253], v13 offset:24576
 ds_read_b64_tr_b16 v[254:255], v13 offset:25600
 v_mfma_f32_16x16x32_bf16 v[52:55], a[228:231], v[232:235], 0
 v_lshlrev_b32 v29, 5, v29
 v_mul_f32 v151, s67, v151
 v_mfma_f32_16x16x32_bf16 v[80:83], a[232:235], v[232:235], 0
 v_and_b32 v28, 1, v0
 v_cvt_pk_bf16_f32 v144, v144, v145
 v_mfma_f32_16x16x32_bf16 v[84:87], a[236:239], v[232:235], 0
 v_cvt_pk_bf16_f32 v145, v146, v147
 v_lshl_add_u32 v29, v28, 4, v29
 v_mfma_f32_16x16x32_bf16 v[56:59], a[224:227], v[236:239], 0
 ds_read_b64_tr_b16 v[224:225], v10 offset:0
 ds_read_b64_tr_b16 v[226:227], v10 offset:1024
 v_mfma_f32_16x16x32_bf16 v[60:63], a[228:231], v[236:239], 0
 v_cvt_pk_bf16_f32 v146, v148, v149
 v_lshrrev_b32 v28, 3, v0
 v_mfma_f32_16x16x32_bf16 v[88:91], a[232:235], v[236:239], 0
 v_cvt_pk_bf16_f32 v147, v150, v151
 s_add_u32 s57, s66, 12288
 v_mfma_f32_16x16x32_bf16 v[92:95], a[236:239], v[236:239], 0
 v_mul_u32_u24 v28, 3456, v28
 v_mfma_f32_16x16x32_bf16 v[32:35], a[240:243], v[240:243], v[32:35]
 ds_read_b64_tr_b16 v[228:229], v11 offset:0
 ds_read_b64_tr_b16 v[230:231], v11 offset:1024
 v_mfma_f32_16x16x32_bf16 v[36:39], a[244:247], v[240:243], v[36:39]
 buffer_store_dwordx4 v[144:147], v23, s[4:7], s57 offen offset:128 sc1
 v_mfma_f32_16x16x32_bf16 v[64:67], a[248:251], v[240:243], v[64:67]
 v_mul_f32 v152, s67, v152
 v_add_u32 v19, v29, v28
 v_mfma_f32_16x16x32_bf16 v[68:71], a[252:255], v[240:243], v[68:71]
 v_mul_f32 v153, s67, v153
 s_waitcnt lgkmcnt(4)
 v_mfma_f32_16x16x32_bf16 v[40:43], a[240:243], v[244:247], v[40:43]
 ds_read_b64_tr_b16 v[232:233], v12 offset:0
 ds_read_b64_tr_b16 v[234:235], v12 offset:1024
 v_mfma_f32_16x16x32_bf16 v[44:47], a[244:247], v[244:247], v[44:47]
 v_xor_b32 v29, 64, v29
 v_mul_f32 v154, s67, v154
 v_mfma_f32_16x16x32_bf16 v[72:75], a[248:251], v[244:247], v[72:75]
 v_mul_f32 v155, s67, v155
 v_add_u32 v29, v29, v28
 v_mfma_f32_16x16x32_bf16 v[76:79], a[252:255], v[244:247], v[76:79]
 v_mul_f32 v156, s67, v156
 v_add_u32 v20, 26624, v29
 v_mfma_f32_16x16x32_bf16 v[48:51], a[240:243], v[248:251], v[48:51]
 ds_read_b64_tr_b16 v[236:237], v13 offset:0
 ds_read_b64_tr_b16 v[238:239], v13 offset:1024
 v_mfma_f32_16x16x32_bf16 v[52:55], a[244:247], v[248:251], v[52:55]
 v_mul_f32 v157, s67, v157
 v_mul_f32 v158, s67, v158
 v_mfma_f32_16x16x32_bf16 v[80:83], a[248:251], v[248:251], v[80:83]
 v_lshrrev_b32 v28, 4, v0
 v_mul_f32 v159, s67, v159
 v_mfma_f32_16x16x32_bf16 v[84:87], a[252:255], v[248:251], v[84:87]
 v_bfe_u32 v29, v0, 2, 2
 v_cvt_pk_bf16_f32 v152, v152, v153
 v_mfma_f32_16x16x32_bf16 v[56:59], a[240:243], v[252:255], v[56:59]
 ds_read_b64_tr_b16 v[240:241], v10 offset:8192
 ds_read_b64_tr_b16 v[242:243], v10 offset:9216
 v_mfma_f32_16x16x32_bf16 v[60:63], a[244:247], v[252:255], v[60:63]
 v_cvt_pk_bf16_f32 v153, v154, v155
 v_lshl_add_u32 v28, v28, 3, v29
 v_mfma_f32_16x16x32_bf16 v[88:91], a[248:251], v[252:255], v[88:91]
 v_cvt_pk_bf16_f32 v154, v156, v157
 v_and_b32 v29, 3, v0
 v_mfma_f32_16x16x32_bf16 v[92:95], a[252:255], v[252:255], v[92:95]
 v_cvt_pk_bf16_f32 v155, v158, v159
 s_waitcnt lgkmcnt(4)
 v_mfma_f32_16x16x32_bf16 v[32:35], a[192:195], v[224:227], v[32:35]
 ds_read_b64_tr_b16 v[244:245], v11 offset:8192
 ds_read_b64_tr_b16 v[246:247], v11 offset:9216
 v_mfma_f32_16x16x32_bf16 v[36:39], a[196:199], v[224:227], v[36:39]
 s_add_u32 s57, s66, 12288
 v_lshlrev_b32 v29, 3, v29
 v_mfma_f32_16x16x32_bf16 v[64:67], a[200:203], v[224:227], v[64:67]
 buffer_store_dwordx4 v[152:155], v23, s[4:7], s57 offen offset:2176 sc1
 v_mfma_f32_16x16x32_bf16 v[68:71], a[204:207], v[224:227], v[68:71]
 v_lshl_add_u32 v28, v28, 7, v29
 v_bfe_u32 v29, v0, 3, 2
 v_mfma_f32_16x16x32_bf16 v[40:43], a[192:195], v[228:231], v[40:43]
 ds_read_b64_tr_b16 v[248:249], v12 offset:8192
 ds_read_b64_tr_b16 v[250:251], v12 offset:9216
 v_mfma_f32_16x16x32_bf16 v[44:47], a[196:199], v[228:231], v[44:47]
 v_lshl_add_u32 v28, v29, 5, v28
 v_mfma_f32_16x16x32_bf16 v[72:75], a[200:203], v[228:231], v[72:75]
 v_mfma_f32_16x16x32_bf16 v[76:79], a[204:207], v[228:231], v[76:79]
 v_add_u32 v15, 98304, v28
 v_mfma_f32_16x16x32_bf16 v[48:51], a[192:195], v[232:235], v[48:51]
 ds_read_b64_tr_b16 v[252:253], v13 offset:8192
 ds_read_b64_tr_b16 v[254:255], v13 offset:9216
 v_mfma_f32_16x16x32_bf16 v[52:55], a[196:199], v[232:235], v[52:55]
 v_xor_b32 v16, 32, v15
 v_mfma_f32_16x16x32_bf16 v[80:83], a[200:203], v[232:235], v[80:83]
 v_xor_b32 v17, 64, v15
 v_mfma_f32_16x16x32_bf16 v[84:87], a[204:207], v[232:235], v[84:87]
 v_add_u32 v6, 65536, v6
 s_waitcnt lgkmcnt(4)
 v_mfma_f32_16x16x32_bf16 v[56:59], a[192:195], v[236:239], v[56:59]
 v_add_u32 v7, 65536, v7
 v_add_u32 v8, 65536, v8
 v_mfma_f32_16x16x32_bf16 v[60:63], a[196:199], v[236:239], v[60:63]
 v_add_u32 v9, 65536, v9
 v_add_u32 v10, 65536, v10
 v_mfma_f32_16x16x32_bf16 v[88:91], a[200:203], v[236:239], v[88:91]
 v_add_u32 v11, 65536, v11
 v_add_u32 v12, 65536, v12
 v_mfma_f32_16x16x32_bf16 v[92:95], a[204:207], v[236:239], v[92:95]
 v_add_u32 v13, 65536, v13
 ds_read_b64_tr_b16 v[224:225], v10 offset:16384
 v_mfma_f32_16x16x32_bf16 v[32:35], a[208:211], v[240:243], v[32:35]
 ds_read_b64_tr_b16 v[226:227], v10 offset:17408
 ds_read_b64_tr_b16 v[228:229], v11 offset:16384
 v_mfma_f32_16x16x32_bf16 v[36:39], a[212:215], v[240:243], v[36:39]
 ds_read_b64_tr_b16 v[230:231], v11 offset:17408
 v_xor_b32 v18, 96, v15
 v_mfma_f32_16x16x32_bf16 v[64:67], a[216:219], v[240:243], v[64:67]
 s_lshl_b32 s58, s3, 5
 v_xor_b32 v21, s58, v15
 v_mfma_f32_16x16x32_bf16 v[68:71], a[220:223], v[240:243], v[68:71]
 v_mfma_f32_16x16x32_bf16 v[40:43], a[208:211], v[244:247], v[40:43]
 ds_read_b64_tr_b16 v[232:233], v12 offset:16384
 ds_read_b64_tr_b16 v[234:235], v12 offset:17408
 v_mfma_f32_16x16x32_bf16 v[44:47], a[212:215], v[244:247], v[44:47]
 v_mfma_f32_16x16x32_bf16 v[72:75], a[216:219], v[244:247], v[72:75]
 v_mfma_f32_16x16x32_bf16 v[76:79], a[220:223], v[244:247], v[76:79]
 s_waitcnt lgkmcnt(6)
 v_mfma_f32_16x16x32_bf16 v[48:51], a[208:211], v[248:251], v[48:51]
 ds_read_b64_tr_b16 v[236:237], v13 offset:16384
 ds_read_b64_tr_b16 v[238:239], v13 offset:17408
 v_mfma_f32_16x16x32_bf16 v[52:55], a[212:215], v[248:251], v[52:55]
 v_mfma_f32_16x16x32_bf16 v[80:83], a[216:219], v[248:251], v[80:83]
 v_mfma_f32_16x16x32_bf16 v[84:87], a[220:223], v[248:251], v[84:87]
 v_mfma_f32_16x16x32_bf16 v[56:59], a[208:211], v[252:255], v[56:59]
 ds_read_b64_tr_b16 v[240:241], v10 offset:24576
 ds_read_b64_tr_b16 v[242:243], v10 offset:25600
 v_mfma_f32_16x16x32_bf16 v[60:63], a[212:215], v[252:255], v[60:63]
 v_mfma_f32_16x16x32_bf16 v[88:91], a[216:219], v[252:255], v[88:91]
 v_mfma_f32_16x16x32_bf16 v[92:95], a[220:223], v[252:255], v[92:95]
 s_waitcnt lgkmcnt(4)
 v_mfma_f32_16x16x32_bf16 v[32:35], a[160:163], v[224:227], v[32:35]
 ds_read_b64_tr_b16 v[244:245], v11 offset:24576
 ds_read_b64_tr_b16 v[246:247], v11 offset:25600
 v_mfma_f32_16x16x32_bf16 v[36:39], a[164:167], v[224:227], v[36:39]
 v_mfma_f32_16x16x32_bf16 v[64:67], a[168:171], v[224:227], v[64:67]
 v_mfma_f32_16x16x32_bf16 v[68:71], a[172:175], v[224:227], v[68:71]
 v_mfma_f32_16x16x32_bf16 v[40:43], a[160:163], v[228:231], v[40:43]
 ds_read_b64_tr_b16 v[248:249], v12 offset:24576
 s_waitcnt lgkmcnt(0)
 s_barrier
 v_mfma_f32_16x16x32_bf16 v[44:47], a[164:167], v[228:231], v[44:47]
 ds_read_b64_tr_b16 v[250:251], v12 offset:25600
 v_mfma_f32_16x16x32_bf16 v[72:75], a[168:171], v[228:231], v[72:75]
 s_add_u32 m0, s65, 0
 v_mfma_f32_16x16x32_bf16 v[76:79], a[172:175], v[228:231], v[76:79]
 v_mfma_f32_16x16x32_bf16 v[48:51], a[160:163], v[232:235], v[48:51]
 ds_read_b64_tr_b16 v[252:253], v13 offset:24576
 ds_read_b64_tr_b16 v[254:255], v13 offset:25600
 v_mfma_f32_16x16x32_bf16 v[52:55], a[164:167], v[232:235], v[52:55]
 s_add_u32 s56, s87, 0
 v_mfma_f32_16x16x32_bf16 v[80:83], a[168:171], v[232:235], v[80:83]
 v_mfma_f32_16x16x32_bf16 v[84:87], a[172:175], v[232:235], v[84:87]
 buffer_load_dwordx4 v2, s[28:31], s56 offen offset:0 lds
 v_mfma_f32_16x16x32_bf16 v[56:59], a[160:163], v[236:239], v[56:59]
 ds_read_b64_tr_b16 v[224:225], v10 offset:0
 ds_read_b64_tr_b16 v[226:227], v10 offset:1024
 v_mfma_f32_16x16x32_bf16 v[60:63], a[164:167], v[236:239], v[60:63]
 v_mfma_f32_16x16x32_bf16 v[88:91], a[168:171], v[236:239], v[88:91]
 buffer_load_dwordx4 v3, s[28:31], s56 offen offset:1024 lds
 v_mfma_f32_16x16x32_bf16 v[92:95], a[172:175], v[236:239], v[92:95]
 v_mfma_f32_16x16x32_bf16 v[32:35], a[176:179], v[240:243], v[32:35]
 ds_read_b64_tr_b16 v[228:229], v11 offset:0
 ds_read_b64_tr_b16 v[230:231], v11 offset:1024
 v_mfma_f32_16x16x32_bf16 v[36:39], a[180:183], v[240:243], v[36:39]
 buffer_load_dwordx4 v4, s[28:31], s56 offen offset:2048 lds
 v_mfma_f32_16x16x32_bf16 v[64:67], a[184:187], v[240:243], v[64:67]
 v_mfma_f32_16x16x32_bf16 v[68:71], a[188:191], v[240:243], v[68:71]
 buffer_load_dwordx4 v5, s[28:31], s56 offen offset:3072 lds
 v_mfma_f32_16x16x32_bf16 v[40:43], a[176:179], v[244:247], v[40:43]
 ds_read_b64_tr_b16 v[232:233], v12 offset:0
 ds_read_b64_tr_b16 v[234:235], v12 offset:1024
 v_mfma_f32_16x16x32_bf16 v[44:47], a[180:183], v[244:247], v[44:47]
 v_mfma_f32_16x16x32_bf16 v[72:75], a[184:187], v[244:247], v[72:75]
 s_add_u32 m0, s89, 98304
 v_mfma_f32_16x16x32_bf16 v[76:79], a[188:191], v[244:247], v[76:79]
 s_waitcnt lgkmcnt(4)
 v_mfma_f32_16x16x32_bf16 v[48:51], a[176:179], v[248:251], v[48:51]
 ds_read_b64_tr_b16 v[236:237], v13 offset:0
 ds_read_b64_tr_b16 v[238:239], v13 offset:1024
 v_mfma_f32_16x16x32_bf16 v[52:55], a[180:183], v[248:251], v[52:55]
 s_add_u32 s56, s88, 0
 v_mfma_f32_16x16x32_bf16 v[80:83], a[184:187], v[248:251], v[80:83]
 v_mfma_f32_16x16x32_bf16 v[84:87], a[188:191], v[248:251], v[84:87]
 v_mfma_f32_16x16x32_bf16 v[56:59], a[176:179], v[252:255], v[56:59]
 ds_read_b64_tr_b16 v[240:241], v10 offset:8192
 v_mfma_f32_16x16x32_bf16 v[60:63], a[180:183], v[252:255], v[60:63]
 buffer_load_dwordx4 v19, s[32:35], s56 offen offset:0 lds
 v_mfma_f32_16x16x32_bf16 v[88:91], a[184:187], v[252:255], v[88:91]
 ds_read_b64_tr_b16 v[242:243], v10 offset:9216
 v_mfma_f32_16x16x32_bf16 v[92:95], a[188:191], v[252:255], v[92:95]
 buffer_load_dwordx4 v20, s[32:35], s56 offen offset:1024 lds
 v_mfma_f32_16x16x32_bf16 v[32:35], a[128:131], v[224:227], v[32:35]
 ds_read_b64_tr_b16 v[244:245], v11 offset:8192
 ds_read_b64_tr_b16 v[246:247], v11 offset:9216
 v_mfma_f32_16x16x32_bf16 v[36:39], a[132:135], v[224:227], v[36:39]
 s_add_u32 m0, s65, 16384
 v_mfma_f32_16x16x32_bf16 v[64:67], a[136:139], v[224:227], v[64:67]
 v_mfma_f32_16x16x32_bf16 v[68:71], a[140:143], v[224:227], v[68:71]
 s_waitcnt lgkmcnt(4)
 v_mfma_f32_16x16x32_bf16 v[40:43], a[128:131], v[228:231], v[40:43]
 ds_read_b64_tr_b16 v[248:249], v12 offset:8192
 ds_read_b64_tr_b16 v[250:251], v12 offset:9216
 v_mfma_f32_16x16x32_bf16 v[44:47], a[132:135], v[228:231], v[44:47]
 s_add_u32 s56, s87, 524288
 v_mfma_f32_16x16x32_bf16 v[72:75], a[136:139], v[228:231], v[72:75]
 v_mfma_f32_16x16x32_bf16 v[76:79], a[140:143], v[228:231], v[76:79]
 buffer_load_dwordx4 v2, s[28:31], s56 offen offset:0 lds
 v_mfma_f32_16x16x32_bf16 v[48:51], a[128:131], v[232:235], v[48:51]
 ds_read_b64_tr_b16 v[252:253], v13 offset:8192
 ds_read_b64_tr_b16 v[254:255], v13 offset:9216
 v_mfma_f32_16x16x32_bf16 v[52:55], a[132:135], v[232:235], v[52:55]
 buffer_load_dwordx4 v3, s[28:31], s56 offen offset:1024 lds
 v_mfma_f32_16x16x32_bf16 v[80:83], a[136:139], v[232:235], v[80:83]
 v_mfma_f32_16x16x32_bf16 v[84:87], a[140:143], v[232:235], v[84:87]
 v_add_u32 v6, 65536, v6
 v_add_u32 v7, 65536, v7
 v_mfma_f32_16x16x32_bf16 v[56:59], a[128:131], v[236:239], v[56:59]
 v_add_u32 v8, 65536, v8
 v_add_u32 v9, 65536, v9
 v_mfma_f32_16x16x32_bf16 v[60:63], a[132:135], v[236:239], v[60:63]
 v_add_u32 v10, 65536, v10
 v_add_u32 v11, 65536, v11
 v_mfma_f32_16x16x32_bf16 v[88:91], a[136:139], v[236:239], v[88:91]
 v_add_u32 v12, 65536, v12
 v_add_u32 v13, 65536, v13
 v_mfma_f32_16x16x32_bf16 v[92:95], a[140:143], v[236:239], v[92:95]
 ds_read_b64_tr_b16 v[224:225], v10 offset:16384
 s_waitcnt lgkmcnt(3)
 v_mfma_f32_16x16x32_bf16 v[32:35], a[144:147], v[240:243], v[32:35]
 ds_read_b64_tr_b16 v[226:227], v10 offset:17408
 v_mfma_f32_16x16x32_bf16 v[36:39], a[148:151], v[240:243], v[36:39]
 buffer_load_dwordx4 v4, s[28:31], s56 offen offset:2048 lds
 v_mfma_f32_16x16x32_bf16 v[64:67], a[152:155], v[240:243], v[64:67]
 buffer_load_dwordx4 v5, s[28:31], s56 offen offset:3072 lds
 v_mfma_f32_16x16x32_bf16 v[68:71], a[156:159], v[240:243], v[68:71]
 ds_read_b64_tr_b16 v[228:229], v11 offset:16384
 ds_read_b64_tr_b16 v[230:231], v11 offset:17408
 v_mfma_f32_16x16x32_bf16 v[40:43], a[144:147], v[244:247], v[40:43]
 s_add_u32 m0, s89, 106496
 ds_read_b64_tr_b16 v[232:233], v12 offset:16384
 v_mfma_f32_16x16x32_bf16 v[44:47], a[148:151], v[244:247], v[44:47]
 ds_read_b64_tr_b16 v[234:235], v12 offset:17408
 s_add_u32 s56, s88, 221184
 v_mfma_f32_16x16x32_bf16 v[72:75], a[152:155], v[244:247], v[72:75]
 v_mfma_f32_16x16x32_bf16 v[76:79], a[156:159], v[244:247], v[76:79]
 buffer_load_dwordx4 v19, s[32:35], s56 offen offset:0 lds
 v_mfma_f32_16x16x32_bf16 v[48:51], a[144:147], v[248:251], v[48:51]
 ds_read_b64_tr_b16 v[236:237], v13 offset:16384
 ds_read_b64_tr_b16 v[238:239], v13 offset:17408
 v_mfma_f32_16x16x32_bf16 v[52:55], a[148:151], v[248:251], v[52:55]
 v_mfma_f32_16x16x32_bf16 v[80:83], a[152:155], v[248:251], v[80:83]
 buffer_load_dwordx4 v20, s[32:35], s56 offen offset:1024 lds
 v_mfma_f32_16x16x32_bf16 v[84:87], a[156:159], v[248:251], v[84:87]
 s_waitcnt lgkmcnt(6)
 v_mfma_f32_16x16x32_bf16 v[56:59], a[144:147], v[252:255], v[56:59]
 ds_read_b64_tr_b16 v[240:241], v10 offset:24576
 ds_read_b64_tr_b16 v[242:243], v10 offset:25600
 v_mfma_f32_16x16x32_bf16 v[60:63], a[148:151], v[252:255], v[60:63]
 v_mfma_f32_16x16x32_bf16 v[88:91], a[152:155], v[252:255], v[88:91]
 v_mfma_f32_16x16x32_bf16 v[92:95], a[156:159], v[252:255], v[92:95]
 v_mfma_f32_16x16x32_bf16 v[32:35], a[96:99], v[224:227], v[32:35]
 ds_read_b64_tr_b16 v[244:245], v11 offset:24576
 v_mfma_f32_16x16x32_bf16 v[36:39], a[100:103], v[224:227], v[36:39]
 v_cmp_ne_u32 vcc, s98, v31
 s_cbranch_vccnz P_parall_1
PB_parall_2:
 v_mfma_f32_16x16x32_bf16 v[64:67], a[104:107], v[224:227], v[64:67]
 ds_read_b64_tr_b16 v[246:247], v11 offset:25600
 s_add_u32 s59, s90, 0
 v_mfma_f32_16x16x32_bf16 v[68:71], a[108:111], v[224:227], v[68:71]
 s_waitcnt lgkmcnt(4)
 v_mfma_f32_16x16x32_bf16 v[40:43], a[96:99], v[228:231], v[40:43]
 ds_read_b64_tr_b16 v[248:249], v12 offset:24576
 ds_read_b64_tr_b16 v[250:251], v12 offset:25600
 v_mfma_f32_16x16x32_bf16 v[44:47], a[100:103], v[228:231], v[44:47]
 buffer_load_dwordx4 a[128:131], v14, s[4:7], s59 offen sc1
 v_mfma_f32_16x16x32_bf16 v[72:75], a[104:107], v[228:231], v[72:75]
 buffer_load_dwordx4 a[132:135], v22, s[4:7], s59 offen sc1
 v_mfma_f32_16x16x32_bf16 v[76:79], a[108:111], v[228:231], v[76:79]
 v_mfma_f32_16x16x32_bf16 v[48:51], a[96:99], v[232:235], v[48:51]
 ds_read_b64_tr_b16 v[252:253], v13 offset:24576
 ds_read_b64_tr_b16 v[254:255], v13 offset:25600
 v_mfma_f32_16x16x32_bf16 v[52:55], a[100:103], v[232:235], v[52:55]
 s_add_u32 s59, s91, 0
 v_mfma_f32_16x16x32_bf16 v[80:83], a[104:107], v[232:235], v[80:83]
 v_mfma_f32_16x16x32_bf16 v[84:87], a[108:111], v[232:235], v[84:87]
 buffer_load_dwordx4 a[136:139], v14, s[4:7], s59 offen sc1
 v_mfma_f32_16x16x32_bf16 v[56:59], a[96:99], v[236:239], v[56:59]
 ds_read_b64_tr_b16 v[224:225], v10 offset:0
 ds_read_b64_tr_b16 v[226:227], v10 offset:1024
 v_mfma_f32_16x16x32_bf16 v[60:63], a[100:103], v[236:239], v[60:63]
 v_mfma_f32_16x16x32_bf16 v[88:91], a[104:107], v[236:239], v[88:91]
 buffer_load_dwordx4 a[140:143], v22, s[4:7], s59 offen sc1
 v_mfma_f32_16x16x32_bf16 v[92:95], a[108:111], v[236:239], v[92:95]
 s_waitcnt lgkmcnt(4)
 v_mfma_f32_16x16x32_bf16 v[32:35], a[112:115], v[240:243], v[32:35]
 ds_read_b64_tr_b16 v[228:229], v11 offset:0
 ds_read_b64_tr_b16 v[230:231], v11 offset:1024
 v_mfma_f32_16x16x32_bf16 v[36:39], a[116:119], v[240:243], v[36:39]
 s_add_u32 s59, s90, 1024
 v_mfma_f32_16x16x32_bf16 v[64:67], a[120:123], v[240:243], v[64:67]
 buffer_load_dwordx4 a[144:147], v14, s[4:7], s59 offen sc1
 v_mfma_f32_16x16x32_bf16 v[68:71], a[124:127], v[240:243], v[68:71]
 v_mfma_f32_16x16x32_bf16 v[40:43], a[112:115], v[244:247], v[40:43]
 ds_read_b64_tr_b16 v[232:233], v12 offset:0
 ds_read_b64_tr_b16 v[234:235], v12 offset:1024
 v_mfma_f32_16x16x32_bf16 v[44:47], a[116:119], v[244:247], v[44:47]
 buffer_load_dwordx4 a[148:151], v22, s[4:7], s59 offen sc1
 v_mfma_f32_16x16x32_bf16 v[72:75], a[120:123], v[244:247], v[72:75]
 v_mfma_f32_16x16x32_bf16 v[76:79], a[124:127], v[244:247], v[76:79]
 s_add_u32 s59, s91, 1024
 v_mfma_f32_16x16x32_bf16 v[48:51], a[112:115], v[248:251], v[48:51]
 ds_read_b64_tr_b16 v[236:237], v13 offset:0
 ds_read_b64_tr_b16 v[238:239], v13 offset:1024
 v_mfma_f32_16x16x32_bf16 v[52:55], a[116:119], v[248:251], v[52:55]
 v_mfma_f32_16x16x32_bf16 v[80:83], a[120:123], v[248:251], v[80:83]
 buffer_load_dwordx4 a[152:155], v14, s[4:7], s59 offen sc1
 v_mfma_f32_16x16x32_bf16 v[84:87], a[124:127], v[248:251], v[84:87]
 s_waitcnt lgkmcnt(4)
 v_mfma_f32_16x16x32_bf16 v[56:59], a[112:115], v[252:255], v[56:59]
 ds_read_b64_tr_b16 v[240:241], v10 offset:8192
 ds_read_b64_tr_b16 v[242:243], v10 offset:9216
 v_mfma_f32_16x16x32_bf16 v[60:63], a[116:119], v[252:255], v[60:63]
 buffer_load_dwordx4 a[156:159], v22, s[4:7], s59 offen sc1
 v_mfma_f32_16x16x32_bf16 v[88:91], a[120:123], v[252:255], v[88:91]
 v_mfma_f32_16x16x32_bf16 v[92:95], a[124:127], v[252:255], v[92:95]
 s_add_u32 s59, s90, 2048
 v_mfma_f32_16x16x32_bf16 v[32:35], a[64:67], v[224:227], v[32:35]
 ds_read_b64_tr_b16 v[244:245], v11 offset:8192
 ds_read_b64_tr_b16 v[246:247], v11 offset:9216
 v_mfma_f32_16x16x32_bf16 v[36:39], a[68:71], v[224:227], v[36:39]
 buffer_load_dwordx4 a[160:163], v14, s[4:7], s59 offen sc1
 v_mfma_f32_16x16x32_bf16 v[64:67], a[72:75], v[224:227], v[64:67]
 v_mfma_f32_16x16x32_bf16 v[68:71], a[76:79], v[224:227], v[68:71]
 buffer_load_dwordx4 a[164:167], v22, s[4:7], s59 offen sc1
 v_mfma_f32_16x16x32_bf16 v[40:43], a[64:67], v[228:231], v[40:43]
 ds_read_b64_tr_b16 v[248:249], v12 offset:8192
 ds_read_b64_tr_b16 v[250:251], v12 offset:9216
 v_mfma_f32_16x16x32_bf16 v[44:47], a[68:71], v[228:231], v[44:47]
 v_mfma_f32_16x16x32_bf16 v[72:75], a[72:75], v[228:231], v[72:75]
 s_add_u32 s59, s91, 2048
 v_mfma_f32_16x16x32_bf16 v[76:79], a[76:79], v[228:231], v[76:79]
 s_waitcnt lgkmcnt(4)
 v_mfma_f32_16x16x32_bf16 v[48:51], a[64:67], v[232:235], v[48:51]
 ds_read_b64_tr_b16 v[252:253], v13 offset:8192
 ds_read_b64_tr_b16 v[254:255], v13 offset:9216
 v_mfma_f32_16x16x32_bf16 v[52:55], a[68:71], v[232:235], v[52:55]
 buffer_load_dwordx4 a[168:171], v14, s[4:7], s59 offen sc1
 v_mfma_f32_16x16x32_bf16 v[80:83], a[72:75], v[232:235], v[80:83]
 v_mfma_f32_16x16x32_bf16 v[84:87], a[76:79], v[232:235], v[84:87]
 buffer_load_dwordx4 a[172:175], v22, s[4:7], s59 offen sc1
 v_mfma_f32_16x16x32_bf16 v[56:59], a[64:67], v[236:239], v[56:59]
 v_add_u32 v6, 4294836224, v6
 v_add_u32 v7, 4294836224, v7
 v_mfma_f32_16x16x32_bf16 v[60:63], a[68:71], v[236:239], v[60:63]
 v_add_u32 v8, 4294836224, v8
 v_add_u32 v9, 4294836224, v9
 v_mfma_f32_16x16x32_bf16 v[88:91], a[72:75], v[236:239], v[88:91]
 v_add_u32 v10, 4294836224, v10
 v_add_u32 v11, 4294836224, v11
 v_mfma_f32_16x16x32_bf16 v[92:95], a[76:79], v[236:239], v[92:95]
 v_add_u32 v12, 4294836224, v12
 v_add_u32 v13, 4294836224, v13
 v_mfma_f32_16x16x32_bf16 v[32:35], a[80:83], v[240:243], v[32:35]
 ds_read_b64_tr_b16 v[224:225], v10 offset:32768
 ds_read_b64_tr_b16 v[226:227], v10 offset:33792
 v_mfma_f32_16x16x32_bf16 v[36:39], a[84:87], v[240:243], v[36:39]
 s_add_u32 s59, s90, 3072
 v_mfma_f32_16x16x32_bf16 v[64:67], a[88:91], v[240:243], v[64:67]
 buffer_load_dwordx4 a[176:179], v14, s[4:7], s59 offen sc1
 v_mfma_f32_16x16x32_bf16 v[68:71], a[92:95], v[240:243], v[68:71]
 ds_read_b64_tr_b16 v[228:229], v11 offset:32768
 s_waitcnt lgkmcnt(3)
 v_mfma_f32_16x16x32_bf16 v[40:43], a[80:83], v[244:247], v[40:43]
 ds_read_b64_tr_b16 v[230:231], v11 offset:33792
 v_mfma_f32_16x16x32_bf16 v[44:47], a[84:87], v[244:247], v[44:47]
 buffer_load_dwordx4 a[180:183], v22, s[4:7], s59 offen sc1
 v_mfma_f32_16x16x32_bf16 v[72:75], a[88:91], v[244:247], v[72:75]
 ds_read_b64_tr_b16 v[232:233], v12 offset:32768
 ds_read_b64_tr_b16 v[234:235], v12 offset:33792
 v_mfma_f32_16x16x32_bf16 v[76:79], a[92:95], v[244:247], v[76:79]
 s_add_u32 s59, s91, 3072
 v_mfma_f32_16x16x32_bf16 v[48:51], a[80:83], v[248:251], v[48:51]
 buffer_load_dwordx4 a[184:187], v14, s[4:7], s59 offen sc1
 v_mfma_f32_16x16x32_bf16 v[52:55], a[84:87], v[248:251], v[52:55]
 ds_read_b64_tr_b16 v[236:237], v13 offset:32768
 ds_read_b64_tr_b16 v[238:239], v13 offset:33792
 v_mfma_f32_16x16x32_bf16 v[80:83], a[88:91], v[248:251], v[80:83]
 buffer_load_dwordx4 a[188:191], v22, s[4:7], s59 offen sc1
 v_mfma_f32_16x16x32_bf16 v[84:87], a[92:95], v[248:251], v[84:87]
 v_mfma_f32_16x16x32_bf16 v[56:59], a[80:83], v[252:255], v[56:59]
 ds_read_b64_tr_b16 v[240:241], v10 offset:40960
 ds_read_b64_tr_b16 v[242:243], v10 offset:41984
 v_mfma_f32_16x16x32_bf16 v[60:63], a[84:87], v[252:255], v[60:63]
 v_mfma_f32_16x16x32_bf16 v[88:91], a[88:91], v[252:255], v[88:91]
 v_cvt_pk_bf16_f32 v160, v160, v161
 v_mfma_f32_16x16x32_bf16 v[92:95], a[92:95], v[252:255], v[92:95]
 v_cvt_pk_bf16_f32 v161, v162, v163
 s_waitcnt lgkmcnt(6)
 v_mfma_f32_16x16x32_bf16 v[32:35], a[32:35], v[224:227], v[32:35]
 ds_read_b64_tr_b16 v[244:245], v11 offset:40960
 ds_read_b64_tr_b16 v[246:247], v11 offset:41984
 v_mfma_f32_16x16x32_bf16 v[36:39], a[36:39], v[224:227], v[36:39]
 v_cvt_pk_bf16_f32 v162, v164, v165
 v_mfma_f32_16x16x32_bf16 v[64:67], a[40:43], v[224:227], v[64:67]
 v_cvt_pk_bf16_f32 v163, v166, v167
 v_mfma_f32_16x16x32_bf16 v[68:71], a[44:47], v[224:227], v[68:71]
 s_add_u32 s57, s66, 16384
 v_mfma_f32_16x16x32_bf16 v[40:43], a[32:35], v[228:231], v[40:43]
 ds_read_b64_tr_b16 v[248:249], v12 offset:40960
 ds_read_b64_tr_b16 v[250:251], v12 offset:41984
 v_mfma_f32_16x16x32_bf16 v[44:47], a[36:39], v[228:231], v[44:47]
 buffer_store_dwordx4 v[160:163], v24, s[4:7], s57 offen offset:0 sc1
 v_mfma_f32_16x16x32_bf16 v[72:75], a[40:43], v[228:231], v[72:75]
 v_cvt_pk_bf16_f32 v168, v168, v169
 v_mfma_f32_16x16x32_bf16 v[76:79], a[44:47], v[228:231], v[76:79]
 s_waitcnt lgkmcnt(4)
 v_mfma_f32_16x16x32_bf16 v[48:51], a[32:35], v[232:235], v[48:51]
 ds_read_b64_tr_b16 v[252:253], v13 offset:40960
 ds_read_b64_tr_b16 v[254:255], v13 offset:41984
 v_mfma_f32_16x16x32_bf16 v[52:55], a[36:39], v[232:235], v[52:55]
 v_cvt_pk_bf16_f32 v169, v170, v171
 v_cvt_pk_bf16_f32 v170, v172, v173
 v_mfma_f32_16x16x32_bf16 v[80:83], a[40:43], v[232:235], v[80:83]
 v_cvt_pk_bf16_f32 v171, v174, v175
 v_mfma_f32_16x16x32_bf16 v[84:87], a[44:47], v[232:235], v[84:87]
 v_mfma_f32_16x16x32_bf16 v[56:59], a[32:35], v[236:239], v[56:59]
 ds_read_b64_tr_b16 v[224:225], v10 offset:49152
 ds_read_b64_tr_b16 v[226:227], v10 offset:50176
 v_mfma_f32_16x16x32_bf16 v[60:63], a[36:39], v[236:239], v[60:63]
 buffer_store_dwordx4 v[168:171], v24, s[4:7], s57 offen offset:256 sc1
 v_mfma_f32_16x16x32_bf16 v[88:91], a[40:43], v[236:239], v[88:91]
 v_cvt_pk_bf16_f32 v176, v176, v177
 v_mfma_f32_16x16x32_bf16 v[92:95], a[44:47], v[236:239], v[92:95]
 v_cvt_pk_bf16_f32 v177, v178, v179
 v_mfma_f32_16x16x32_bf16 v[32:35], a[48:51], v[240:243], v[32:35]
 ds_read_b64_tr_b16 v[228:229], v11 offset:49152
 ds_read_b64_tr_b16 v[230:231], v11 offset:50176
 v_mfma_f32_16x16x32_bf16 v[36:39], a[52:55], v[240:243], v[36:39]
 v_cvt_pk_bf16_f32 v178, v180, v181
 v_mfma_f32_16x16x32_bf16 v[64:67], a[56:59], v[240:243], v[64:67]
 v_cvt_pk_bf16_f32 v179, v182, v183
 v_mfma_f32_16x16x32_bf16 v[68:71], a[60:63], v[240:243], v[68:71]
 s_waitcnt lgkmcnt(4)
 v_mfma_f32_16x16x32_bf16 v[40:43], a[48:51], v[244:247], v[40:43]
 ds_read_b64_tr_b16 v[232:233], v12 offset:49152
 ds_read_b64_tr_b16 v[234:235], v12 offset:50176
 v_mfma_f32_16x16x32_bf16 v[44:47], a[52:55], v[244:247], v[44:47]
 buffer_store_dwordx4 v[176:179], v24, s[4:7], s57 offen offset:1024 sc1
 v_mfma_f32_16x16x32_bf16 v[72:75], a[56:59], v[244:247], v[72:75]
 v_cvt_pk_bf16_f32 v184, v184, v185
 v_cvt_pk_bf16_f32 v185, v186, v187
 v_mfma_f32_16x16x32_bf16 v[76:79], a[60:63], v[244:247], v[76:79]
 v_cvt_pk_bf16_f32 v186, v188, v189
 v_mfma_f32_16x16x32_bf16 v[48:51], a[48:51], v[248:251], v[48:51]
 ds_read_b64_tr_b16 v[236:237], v13 offset:49152
 ds_read_b64_tr_b16 v[238:239], v13 offset:50176
 v_mfma_f32_16x16x32_bf16 v[52:55], a[52:55], v[248:251], v[52:55]
 v_cvt_pk_bf16_f32 v187, v190, v191
 v_mfma_f32_16x16x32_bf16 v[80:83], a[56:59], v[248:251], v[80:83]
 buffer_store_dwordx4 v[184:187], v24, s[4:7], s57 offen offset:1280 sc1
 v_mfma_f32_16x16x32_bf16 v[84:87], a[60:63], v[248:251], v[84:87]
 v_mfma_f32_16x16x32_bf16 v[56:59], a[48:51], v[252:255], v[56:59]
 ds_read_b64_tr_b16 v[240:241], v10 offset:57344
 ds_read_b64_tr_b16 v[242:243], v10 offset:58368
 v_mfma_f32_16x16x32_bf16 v[60:63], a[52:55], v[252:255], v[60:63]
 v_cvt_pk_bf16_f32 v192, v192, v193
 v_cvt_pk_bf16_f32 v193, v194, v195
 v_mfma_f32_16x16x32_bf16 v[88:91], a[56:59], v[252:255], v[88:91]
 v_cvt_pk_bf16_f32 v194, v196, v197
 v_mfma_f32_16x16x32_bf16 v[92:95], a[60:63], v[252:255], v[92:95]
 s_waitcnt lgkmcnt(4)
 v_mfma_f32_16x16x32_bf16 v[32:35], a[0:3], v[224:227], v[32:35]
 ds_read_b64_tr_b16 v[244:245], v11 offset:57344
 ds_read_b64_tr_b16 v[246:247], v11 offset:58368
 v_mfma_f32_16x16x32_bf16 v[36:39], a[4:7], v[224:227], v[36:39]
 v_cvt_pk_bf16_f32 v195, v198, v199
 s_add_u32 s57, s66, 24576
 v_mfma_f32_16x16x32_bf16 v[64:67], a[8:11], v[224:227], v[64:67]
 v_mfma_f32_16x16x32_bf16 v[68:71], a[12:15], v[224:227], v[68:71]
 buffer_store_dwordx4 v[192:195], v24, s[4:7], s57 offen offset:0 sc1
 v_mfma_f32_16x16x32_bf16 v[40:43], a[0:3], v[228:231], v[40:43]
 ds_read_b64_tr_b16 v[248:249], v12 offset:57344
 ds_read_b64_tr_b16 v[250:251], v12 offset:58368
 v_mfma_f32_16x16x32_bf16 v[44:47], a[4:7], v[228:231], v[44:47]
 v_cvt_pk_bf16_f32 v200, v200, v201
 v_mfma_f32_16x16x32_bf16 v[72:75], a[8:11], v[228:231], v[72:75]
 v_cvt_pk_bf16_f32 v201, v202, v203
 v_mfma_f32_16x16x32_bf16 v[76:79], a[12:15], v[228:231], v[76:79]
 v_cvt_pk_bf16_f32 v202, v204, v205
 v_mfma_f32_16x16x32_bf16 v[48:51], a[0:3], v[232:235], v[48:51]
 ds_read_b64_tr_b16 v[252:253], v13 offset:57344
 ds_read_b64_tr_b16 v[254:255], v13 offset:58368
 v_mfma_f32_16x16x32_bf16 v[52:55], a[4:7], v[232:235], v[52:55]
 v_cvt_pk_bf16_f32 v203, v206, v207
 v_mfma_f32_16x16x32_bf16 v[80:83], a[8:11], v[232:235], v[80:83]
 buffer_store_dwordx4 v[200:203], v24, s[4:7], s57 offen offset:256 sc1
 v_mfma_f32_16x16x32_bf16 v[84:87], a[12:15], v[232:235], v[84:87]
 v_cvt_pk_bf16_f32 v208, v208, v209
 s_waitcnt lgkmcnt(4)
 v_mfma_f32_16x16x32_bf16 v[56:59], a[0:3], v[236:239], v[56:59]
 v_mfma_f32_16x16x32_bf16 v[60:63], a[4:7], v[236:239], v[60:63]
 v_cvt_pk_bf16_f32 v209, v210, v211
 v_mfma_f32_16x16x32_bf16 v[88:91], a[8:11], v[236:239], v[88:91]
 v_cvt_pk_bf16_f32 v210, v212, v213
 v_mfma_f32_16x16x32_bf16 v[92:95], a[12:15], v[236:239], v[92:95]
 v_mfma_f32_16x16x32_bf16 v[32:35], a[16:19], v[240:243], v[32:35]
 v_cvt_pk_bf16_f32 v211, v214, v215
 v_mfma_f32_16x16x32_bf16 v[36:39], a[20:23], v[240:243], v[36:39]
 buffer_store_dwordx4 v[208:211], v24, s[4:7], s57 offen offset:1024 sc1
 v_mfma_f32_16x16x32_bf16 v[64:67], a[24:27], v[240:243], v[64:67]
 s_waitcnt vmcnt(29)
 s_waitcnt lgkmcnt(0)
 s_barrier
 v_mfma_f32_16x16x32_bf16 v[68:71], a[28:31], v[240:243], v[68:71]
 ds_read_b64_tr_b16 a[192:193], v6 offset:0
 ds_read_b64_tr_b16 a[194:195], v6 offset:1024
 v_mfma_f32_16x16x32_bf16 v[40:43], a[16:19], v[244:247], v[40:43]
 ds_read_b64_tr_b16 a[196:197], v7 offset:0
 ds_read_b64_tr_b16 a[198:199], v7 offset:1024
 v_mfma_f32_16x16x32_bf16 v[44:47], a[20:23], v[244:247], v[44:47]
 ds_read_b64_tr_b16 a[200:201], v8 offset:0
 ds_read_b64_tr_b16 a[202:203], v8 offset:1024
 v_mfma_f32_16x16x32_bf16 v[72:75], a[24:27], v[244:247], v[72:75]
 ds_read_b64_tr_b16 a[204:205], v9 offset:0
 ds_read_b64_tr_b16 a[206:207], v9 offset:1024
 v_mfma_f32_16x16x32_bf16 v[76:79], a[28:31], v[244:247], v[76:79]
 ds_read_b64_tr_b16 a[208:209], v10 offset:0
 ds_read_b64_tr_b16 a[210:211], v10 offset:1024
 v_mfma_f32_16x16x32_bf16 v[48:51], a[16:19], v[248:251], v[48:51]
 ds_read_b64_tr_b16 a[212:213], v11 offset:0
 s_add_u32 m0, s65, 32768
 v_mfma_f32_16x16x32_bf16 v[52:55], a[20:23], v[248:251], v[52:55]
 ds_read_b64_tr_b16 a[214:215], v11 offset:1024
 ds_read_b64_tr_b16 a[216:217], v12 offset:0
 v_mfma_f32_16x16x32_bf16 v[80:83], a[24:27], v[248:251], v[80:83]
 ds_read_b64_tr_b16 a[218:219], v12 offset:1024
 ds_read_b64_tr_b16 a[220:221], v13 offset:0
 v_mfma_f32_16x16x32_bf16 v[84:87], a[28:31], v[248:251], v[84:87]
 ds_read_b64_tr_b16 a[222:223], v13 offset:1024
 ds_read_b64_tr_b16 a[224:225], v15 offset:0
 v_mfma_f32_16x16x32_bf16 v[56:59], a[16:19], v[252:255], v[56:59]
 s_add_u32 s56, s87, 1048576
 ds_read_b64_tr_b16 a[226:227], v15 offset:512
 v_mfma_f32_16x16x32_bf16 v[60:63], a[20:23], v[252:255], v[60:63]
 buffer_load_dwordx4 v2, s[28:31], s56 offen offset:0 lds
 v_mfma_f32_16x16x32_bf16 v[88:91], a[24:27], v[252:255], v[88:91]
 ds_read_b64_tr_b16 a[228:229], v16 offset:0
 ds_read_b64_tr_b16 a[230:231], v16 offset:512
 v_mfma_f32_16x16x32_bf16 v[92:95], a[28:31], v[252:255], v[92:95]
 buffer_load_dwordx4 v3, s[28:31], s56 offen offset:1024 lds
L_B:
 s_waitcnt lgkmcnt(14) vmcnt(22)
 v_mfma_f32_16x16x32_bf16 v[96:99], a[192:195], a[136:139], 0
 ds_read_b64_tr_b16 a[232:233], v17 offset:0
 s_waitcnt vmcnt(21)
 v_mfma_f32_16x16x32_bf16 v[128:131], a[192:195], a[140:143], 0
 ds_read_b64_tr_b16 a[234:235], v17 offset:512
 v_cvt_pk_bf16_f32 v216, v216, v217
 v_mfma_f32_16x16x32_bf16 v[100:103], a[196:199], a[136:139], 0
 buffer_load_dwordx4 v4, s[28:31], s56 offen offset:2048 lds
 v_mfma_f32_16x16x32_bf16 v[132:135], a[196:199], a[140:143], 0
 ds_read_b64_tr_b16 v[224:225], v21 offset:0
 ds_read_b64_tr_b16 v[226:227], v21 offset:512
 v_mfma_f32_16x16x32_bf16 v[104:107], a[200:203], a[136:139], 0
 ds_read_b64_tr_b16 a[236:237], v18 offset:0
 v_cvt_pk_bf16_f32 v217, v218, v219
 v_mfma_f32_16x16x32_bf16 v[136:139], a[200:203], a[140:143], 0
 v_cvt_pk_bf16_f32 v218, v220, v221
 s_waitcnt lgkmcnt(8)
 v_mfma_f32_16x16x32_bf16 v[108:111], a[204:207], a[136:139], 0
 buffer_load_dwordx4 v5, s[28:31], s56 offen offset:3072 lds
 v_mfma_f32_16x16x32_bf16 v[140:143], a[204:207], a[140:143], 0
 ds_read_b64_tr_b16 a[238:239], v18 offset:512
 s_lshl_b32 s80, s60, 3
 v_mfma_f32_16x16x32_bf16 v[112:115], a[208:211], a[136:139], 0
 v_cvt_pk_bf16_f32 v219, v222, v223
 buffer_store_dwordx4 v[216:219], v24, s[4:7], s57 offen offset:1280 sc1
 s_add_u32 s57, s66, 16384
 s_add_u32 s58, s66, 24576
 v_mfma_f32_16x16x32_bf16 v[144:147], a[208:211], a[140:143], 0
 s_add_u32 s80, s80, s61
 s_lshl_b32 s80, s80, 7
 v_mfma_f32_16x16x32_bf16 v[116:119], a[212:215], a[136:139], 0
 s_add_u32 m0, s89, 114688
 s_add_u32 s80, s80, 39354368
 v_mfma_f32_16x16x32_bf16 v[148:151], a[212:215], a[140:143], 0
 s_add_u32 s56, s88, 442368
 v_cvt_pk_bf16_f32 v232, v32, v33
 v_mfma_f32_16x16x32_bf16 v[120:123], a[216:219], a[136:139], 0
 v_cvt_pk_bf16_f32 v233, v34, v35
 v_cvt_pk_bf16_f32 v234, v36, v37
 v_mfma_f32_16x16x32_bf16 v[152:155], a[216:219], a[140:143], 0
 buffer_load_dwordx4 v19, s[32:35], s56 offen offset:0 lds
 v_mfma_f32_16x16x32_bf16 v[124:127], a[220:223], a[136:139], 0
 v_cvt_pk_bf16_f32 v235, v38, v39
 v_cvt_pk_bf16_f32 v236, v64, v65
 v_mfma_f32_16x16x32_bf16 v[156:159], a[220:223], a[140:143], 0
 v_cvt_pk_bf16_f32 v237, v66, v67
 s_waitcnt lgkmcnt(1)
 v_mfma_f32_16x16x32_bf16 v[160:163], a[224:227], a[128:131], 0
 buffer_load_dwordx4 v20, s[32:35], s56 offen offset:1024 lds
 v_mfma_f32_16x16x32_bf16 v[176:179], a[224:227], a[132:135], 0
 v_cvt_pk_bf16_f32 v238, v68, v69
 v_cvt_pk_bf16_f32 v239, v70, v71
 v_mfma_f32_16x16x32_bf16 v[192:195], a[224:227], a[136:139], 0
 v_cvt_pk_bf16_f32 v240, v40, v41
 v_cvt_pk_bf16_f32 v241, v42, v43
 v_mfma_f32_16x16x32_bf16 v[208:211], a[224:227], a[140:143], 0
 v_cvt_pk_bf16_f32 v242, v44, v45
 v_cvt_pk_bf16_f32 v243, v46, v47
 v_mfma_f32_16x16x32_bf16 v[164:167], a[228:231], a[128:131], 0
 v_cvt_pk_bf16_f32 v244, v72, v73
 v_cvt_pk_bf16_f32 v245, v74, v75
 v_mfma_f32_16x16x32_bf16 v[180:183], a[228:231], a[132:135], 0
 v_cvt_pk_bf16_f32 v246, v76, v77
 v_cvt_pk_bf16_f32 v247, v78, v79
 v_mfma_f32_16x16x32_bf16 v[196:199], a[228:231], a[136:139], 0
 v_cvt_pk_bf16_f32 v248, v48, v49
 v_cvt_pk_bf16_f32 v249, v50, v51
 v_mfma_f32_16x16x32_bf16 v[212:215], a[228:231], a[140:143], 0
 v_cvt_pk_bf16_f32 v250, v52, v53
 v_cvt_pk_bf16_f32 v251, v54, v55
 v_mfma_f32_16x16x32_bf16 v[168:171], a[232:235], a[128:131], 0
 ds_read_b64_tr_b16 a[240:241], v6 offset:8192
 ds_read_b64_tr_b16 a[242:243], v6 offset:9216
 v_mfma_f32_16x16x32_bf16 v[184:187], a[232:235], a[132:135], 0
 v_cvt_pk_bf16_f32 v252, v80, v81
 v_cvt_pk_bf16_f32 v253, v82, v83
 v_mfma_f32_16x16x32_bf16 v[200:203], a[232:235], a[136:139], 0
 v_cvt_pk_bf16_f32 v254, v84, v85
 v_cvt_pk_bf16_f32 v255, v86, v87
 v_mfma_f32_16x16x32_bf16 v[216:219], a[232:235], a[140:143], 0
 v_cvt_pk_bf16_f32 v56, v56, v57
 s_waitcnt lgkmcnt(2)
 v_mfma_f32_16x16x32_bf16 v[172:175], a[236:239], a[128:131], 0
 ds_read_b64_tr_b16 a[244:245], v7 offset:8192
 ds_read_b64_tr_b16 a[246:247], v7 offset:9216
 v_mfma_f32_16x16x32_bf16 v[188:191], a[236:239], a[132:135], 0
 v_cvt_pk_bf16_f32 v57, v58, v59
 v_cvt_pk_bf16_f32 v58, v60, v61
 v_mfma_f32_16x16x32_bf16 v[204:207], a[236:239], a[136:139], 0
 v_cvt_pk_bf16_f32 v59, v62, v63
 v_mfma_f32_16x16x32_bf16 v[220:223], a[236:239], a[140:143], 0
 buffer_store_dwordx4 v[56:59], v24, s[4:7], s57 offen offset:3328 sc1
 v_mfma_f32_16x16x32_bf16 v[32:35], a[192:195], a[128:131], 0
 ds_read_b64_tr_b16 a[248:249], v8 offset:8192
 ds_read_b64_tr_b16 a[250:251], v8 offset:9216
 v_mfma_f32_16x16x32_bf16 v[64:67], a[192:195], a[132:135], 0
 v_cvt_pk_bf16_f32 v88, v88, v89
 v_cvt_pk_bf16_f32 v89, v90, v91
 v_mfma_f32_16x16x32_bf16 v[36:39], a[196:199], a[128:131], 0
 v_cvt_pk_bf16_f32 v90, v92, v93
 v_cvt_pk_bf16_f32 v91, v94, v95
 v_mfma_f32_16x16x32_bf16 v[68:71], a[196:199], a[132:135], 0
 buffer_store_dwordx4 v[88:91], v24, s[4:7], s58 offen offset:3328 sc1
 v_mfma_f32_16x16x32_bf16 v[40:43], a[200:203], a[128:131], 0
 ds_read_b64_tr_b16 a[252:253], v9 offset:8192
 ds_read_b64_tr_b16 a[254:255], v9 offset:9216
 v_mfma_f32_16x16x32_bf16 v[72:75], a[200:203], a[132:135], 0
 v_mov_b32 v25, 0
 v_mov_b32 v23, 0
 v_mfma_f32_16x16x32_bf16 v[44:47], a[204:207], a[128:131], 0
 v_lshlrev_b32 v28, 16, v224
 v_and_b32 v224, 0xffff0000, v224
 v_mfma_f32_16x16x32_bf16 v[76:79], a[204:207], a[132:135], 0
 v_add_f32 v25, v25, v28
 v_add_f32 v23, v23, v224
 v_mfma_f32_16x16x32_bf16 v[48:51], a[208:211], a[128:131], 0
 ds_read_b64_tr_b16 a[192:193], v10 offset:8192
 ds_read_b64_tr_b16 a[194:195], v10 offset:9216
 v_mfma_f32_16x16x32_bf16 v[80:83], a[208:211], a[132:135], 0
 v_lshlrev_b32 v28, 16, v225
 v_and_b32 v225, 0xffff0000, v225
 v_mfma_f32_16x16x32_bf16 v[52:55], a[212:215], a[128:131], 0
 v_add_f32 v25, v25, v28
 v_add_f32 v23, v23, v225
 v_mfma_f32_16x16x32_bf16 v[84:87], a[212:215], a[132:135], 0
 v_lshlrev_b32 v28, 16, v226
 v_and_b32 v226, 0xffff0000, v226
 v_mfma_f32_16x16x32_bf16 v[56:59], a[216:219], a[128:131], 0
 ds_read_b64_tr_b16 a[196:197], v11 offset:8192
 ds_read_b64_tr_b16 a[198:199], v11 offset:9216
 v_mfma_f32_16x16x32_bf16 v[88:91], a[216:219], a[132:135], 0
 v_add_f32 v25, v25, v28
 v_add_f32 v23, v23, v226
 v_mfma_f32_16x16x32_bf16 v[60:63], a[220:223], a[128:131], 0
 v_lshlrev_b32 v28, 16, v227
 v_and_b32 v227, 0xffff0000, v227
 v_mfma_f32_16x16x32_bf16 v[92:95], a[220:223], a[132:135], 0
 v_add_f32 v25, v25, v28
 s_waitcnt lgkmcnt(4) vmcnt(27)
 v_mfma_f32_16x16x32_bf16 v[32:35], a[240:243], a[144:147], v[32:35]
 ds_read_b64_tr_b16 a[200:201], v12 offset:8192
 s_waitcnt vmcnt(26)
 v_mfma_f32_16x16x32_bf16 v[64:67], a[240:243], a[148:151], v[64:67]
 s_add_u32 s59, s90, 4096
 s_waitcnt vmcnt(25)
 v_mfma_f32_16x16x32_bf16 v[96:99], a[240:243], a[152:155], v[96:99]
 ds_read_b64_tr_b16 a[202:203], v12 offset:9216
 s_waitcnt vmcnt(24)
 v_mfma_f32_16x16x32_bf16 v[128:131], a[240:243], a[156:159], v[128:131]
 ds_read_b64_tr_b16 v[228:229], v21 offset:4096
 ds_read_b64_tr_b16 v[230:231], v21 offset:4608
 v_mfma_f32_16x16x32_bf16 v[36:39], a[244:247], a[144:147], v[36:39]
 buffer_load_dwordx4 a[128:131], v14, s[4:7], s59 offen sc1
 v_mfma_f32_16x16x32_bf16 v[68:71], a[244:247], a[148:151], v[68:71]
 ds_read_b64_tr_b16 a[204:205], v13 offset:8192
 ds_read_b64_tr_b16 a[206:207], v13 offset:9216
 v_mfma_f32_16x16x32_bf16 v[100:103], a[244:247], a[152:155], v[100:103]
 buffer_load_dwordx4 a[132:135], v22, s[4:7], s59 offen sc1
 v_mfma_f32_16x16x32_bf16 v[132:135], a[244:247], a[156:159], v[132:135]
 v_add_f32 v23, v23, v227
 v_accvgpr_write_b32 a0, 0
 v_mfma_f32_16x16x32_bf16 v[40:43], a[248:251], a[144:147], v[40:43]
 ds_read_b64_tr_b16 a[208:209], v15 offset:4096
 ds_read_b64_tr_b16 a[210:211], v15 offset:4608
 v_mfma_f32_16x16x32_bf16 v[72:75], a[248:251], a[148:151], v[72:75]
 s_add_u32 s59, s91, 4096
 v_accvgpr_write_b32 a1, 0
 v_mfma_f32_16x16x32_bf16 v[104:107], a[248:251], a[152:155], v[104:107]
 v_mfma_f32_16x16x32_bf16 v[136:139], a[248:251], a[156:159], v[136:139]
 v_mfma_f32_16x16x32_bf16 v[44:47], a[252:255], a[144:147], v[44:47]
 ds_read_b64_tr_b16 a[212:213], v16 offset:4096
 v_mfma_f32_16x16x32_bf16 v[76:79], a[252:255], a[148:151], v[76:79]
 buffer_load_dwordx4 a[136:139], v14, s[4:7], s59 offen sc1
 v_mfma_f32_16x16x32_bf16 v[108:111], a[252:255], a[152:155], v[108:111]
 ds_read_b64_tr_b16 a[214:215], v16 offset:4608
 v_accvgpr_write_b32 a2, 0
 v_mfma_f32_16x16x32_bf16 v[140:143], a[252:255], a[156:159], v[140:143]
 s_waitcnt lgkmcnt(5)
 v_mfma_f32_16x16x32_bf16 v[48:51], a[192:195], a[144:147], v[48:51]
 buffer_load_dwordx4 a[140:143], v22, s[4:7], s59 offen sc1
 v_mfma_f32_16x16x32_bf16 v[80:83], a[192:195], a[148:151], v[80:83]
 ds_read_b64_tr_b16 a[216:217], v17 offset:4096
 ds_read_b64_tr_b16 a[218:219], v17 offset:4608
 v_mfma_f32_16x16x32_bf16 v[112:115], a[192:195], a[152:155], v[112:115]
 v_mfma_f32_16x16x32_bf16 v[144:147], a[192:195], a[156:159], v[144:147]
 v_accvgpr_write_b32 a3, 0
 v_mfma_f32_16x16x32_bf16 v[52:55], a[196:199], a[144:147], v[52:55]
 ds_read_b64_tr_b16 a[220:221], v18 offset:4096
 ds_read_b64_tr_b16 a[222:223], v18 offset:4608
 v_mfma_f32_16x16x32_bf16 v[84:87], a[196:199], a[148:151], v[84:87]
 v_mfma_f32_16x16x32_bf16 v[116:119], a[196:199], a[152:155], v[116:119]
 buffer_store_dwordx4 v[248:251], v24, s[4:7], s57 offen offset:3072 sc1
 v_mfma_f32_16x16x32_bf16 v[148:151], a[196:199], a[156:159], v[148:151]
 v_mfma_f32_16x16x32_bf16 v[56:59], a[200:203], a[144:147], v[56:59]
 v_lshlrev_b32 v28, 16, v228
 v_mfma_f32_16x16x32_bf16 v[88:91], a[200:203], a[148:151], v[88:91]
 v_and_b32 v228, 0xffff0000, v228
 v_accvgpr_write_b32 a4, 0
 v_mfma_f32_16x16x32_bf16 v[120:123], a[200:203], a[152:155], v[120:123]
 v_add_f32 v25, v25, v28
 v_mfma_f32_16x16x32_bf16 v[152:155], a[200:203], a[156:159], v[152:155]
 v_add_f32 v23, v23, v228
 s_waitcnt lgkmcnt(3)
 v_mfma_f32_16x16x32_bf16 v[60:63], a[204:207], a[144:147], v[60:63]
 v_lshlrev_b32 v28, 16, v229
 v_mfma_f32_16x16x32_bf16 v[92:95], a[204:207], a[148:151], v[92:95]
 v_and_b32 v229, 0xffff0000, v229
 v_mfma_f32_16x16x32_bf16 v[124:127], a[204:207], a[152:155], v[124:127]
 v_add_f32 v25, v25, v28
 v_mfma_f32_16x16x32_bf16 v[156:159], a[204:207], a[156:159], v[156:159]
 v_add_f32 v23, v23, v229
 v_accvgpr_write_b32 a5, 0
 v_mfma_f32_16x16x32_bf16 v[160:163], a[208:211], a[144:147], v[160:163]
 v_lshlrev_b32 v28, 16, v230
 v_mfma_f32_16x16x32_bf16 v[176:179], a[208:211], a[148:151], v[176:179]
 v_and_b32 v230, 0xffff0000, v230
 v_mfma_f32_16x16x32_bf16 v[192:195], a[208:211], a[152:155], v[192:195]
 s_waitcnt lgkmcnt(0)
 s_barrier
 v_mfma_f32_16x16x32_bf16 v[208:211], a[208:211], a[156:159], v[208:211]
 ds_read_b64_tr_b16 a[224:225], v6 offset:16384
 ds_read_b64_tr_b16 a[226:227], v6 offset:17408
 v_mfma_f32_16x16x32_bf16 v[164:167], a[212:215], a[144:147], v[164:167]
 ds_read_b64_tr_b16 a[228:229], v7 offset:16384
 ds_read_b64_tr_b16 a[230:231], v7 offset:17408
 v_mfma_f32_16x16x32_bf16 v[180:183], a[212:215], a[148:151], v[180:183]
 ds_read_b64_tr_b16 a[232:233], v8 offset:16384
 ds_read_b64_tr_b16 a[234:235], v8 offset:17408
 v_mfma_f32_16x16x32_bf16 v[196:199], a[212:215], a[152:155], v[196:199]
 ds_read_b64_tr_b16 a[236:237], v9 offset:16384
 ds_read_b64_tr_b16 a[238:239], v9 offset:17408
 v_mfma_f32_16x16x32_bf16 v[212:215], a[212:215], a[156:159], v[212:215]
 s_add_u32 m0, s65, 0
 v_add_f32 v25, v25, v28
 v_mfma_f32_16x16x32_bf16 v[168:171], a[216:219], a[144:147], v[168:171]
 ds_read_b64_tr_b16 a[240:241], v10 offset:16384
 s_add_u32 s56, s87, 1572864
 v_mfma_f32_16x16x32_bf16 v[184:187], a[216:219], a[148:151], v[184:187]
 ds_read_b64_tr_b16 a[242:243], v10 offset:17408
 v_add_f32 v23, v23, v230
 v_mfma_f32_16x16x32_bf16 v[200:203], a[216:219], a[152:155], v[200:203]
 v_lshlrev_b32 v28, 16, v231
 v_and_b32 v231, 0xffff0000, v231
 v_mfma_f32_16x16x32_bf16 v[216:219], a[216:219], a[156:159], v[216:219]
 buffer_load_dwordx4 v2, s[28:31], s56 offen offset:0 lds
 v_mfma_f32_16x16x32_bf16 v[172:175], a[220:223], a[144:147], v[172:175]
 ds_read_b64_tr_b16 a[244:245], v11 offset:16384
 ds_read_b64_tr_b16 a[246:247], v11 offset:17408
 v_mfma_f32_16x16x32_bf16 v[188:191], a[220:223], a[148:151], v[188:191]
 v_accvgpr_write_b32 a6, 0
 v_add_f32 v25, v25, v28
 v_mfma_f32_16x16x32_bf16 v[204:207], a[220:223], a[152:155], v[204:207]
 buffer_load_dwordx4 v3, s[28:31], s56 offen offset:1024 lds
 v_mfma_f32_16x16x32_bf16 v[220:223], a[220:223], a[156:159], v[220:223]
 v_add_f32 v23, v23, v231
 s_waitcnt lgkmcnt(7) vmcnt(30)
 v_mfma_f32_16x16x32_bf16 v[32:35], a[224:227], a[160:163], v[32:35]
 ds_read_b64_tr_b16 a[248:249], v12 offset:16384
 s_waitcnt vmcnt(29)
 v_mfma_f32_16x16x32_bf16 v[64:67], a[224:227], a[164:167], v[64:67]
 ds_read_b64_tr_b16 a[250:251], v12 offset:17408
 s_waitcnt vmcnt(28)
 v_mfma_f32_16x16x32_bf16 v[96:99], a[224:227], a[168:171], v[96:99]
 v_accvgpr_write_b32 a7, 0
 s_waitcnt vmcnt(27)
 v_mfma_f32_16x16x32_bf16 v[128:131], a[224:227], a[172:175], v[128:131]
 buffer_load_dwordx4 v4, s[28:31], s56 offen offset:2048 lds
 v_mfma_f32_16x16x32_bf16 v[36:39], a[228:231], a[160:163], v[36:39]
 ds_read_b64_tr_b16 v[224:225], v21 offset:8192
 ds_read_b64_tr_b16 v[226:227], v21 offset:8704
 v_mfma_f32_16x16x32_bf16 v[68:71], a[228:231], a[164:167], v[68:71]
 ds_read_b64_tr_b16 a[252:253], v13 offset:16384
 v_accvgpr_write_b32 a8, 0
 v_mfma_f32_16x16x32_bf16 v[100:103], a[228:231], a[168:171], v[100:103]
 buffer_load_dwordx4 v5, s[28:31], s56 offen offset:3072 lds
 v_mfma_f32_16x16x32_bf16 v[132:135], a[228:231], a[172:175], v[132:135]
 ds_read_b64_tr_b16 a[254:255], v13 offset:17408
 s_waitcnt lgkmcnt(6)
 v_mfma_f32_16x16x32_bf16 v[40:43], a[232:235], a[160:163], v[40:43]
 s_add_u32 m0, s89, 98304
 ds_read_b64_tr_b16 a[192:193], v15 offset:8192
 v_mfma_f32_16x16x32_bf16 v[72:75], a[232:235], a[164:167], v[72:75]
 ds_read_b64_tr_b16 a[194:195], v15 offset:8704
 v_accvgpr_write_b32 a9, 0
 v_mfma_f32_16x16x32_bf16 v[104:107], a[232:235], a[168:171], v[104:107]
 s_add_u32 s56, s88, 663552
 v_mfma_f32_16x16x32_bf16 v[136:139], a[232:235], a[172:175], v[136:139]
 v_mfma_f32_16x16x32_bf16 v[44:47], a[236:239], a[160:163], v[44:47]
 ds_read_b64_tr_b16 a[196:197], v16 offset:8192
 ds_read_b64_tr_b16 a[198:199], v16 offset:8704
 v_mfma_f32_16x16x32_bf16 v[76:79], a[236:239], a[164:167], v[76:79]
 buffer_load_dwordx4 v19, s[32:35], s56 offen offset:0 lds
 v_mfma_f32_16x16x32_bf16 v[108:111], a[236:239], a[168:171], v[108:111]
 v_accvgpr_write_b32 a10, 0
 v_mfma_f32_16x16x32_bf16 v[140:143], a[236:239], a[172:175], v[140:143]
 v_mfma_f32_16x16x32_bf16 v[48:51], a[240:243], a[160:163], v[48:51]
 ds_read_b64_tr_b16 a[200:201], v17 offset:8192
 v_mfma_f32_16x16x32_bf16 v[80:83], a[240:243], a[164:167], v[80:83]
 buffer_load_dwordx4 v20, s[32:35], s56 offen offset:1024 lds
 v_mfma_f32_16x16x32_bf16 v[112:115], a[240:243], a[168:171], v[112:115]
 ds_read_b64_tr_b16 a[202:203], v17 offset:8704
 s_add_u32 s59, s90, 5120
 v_mfma_f32_16x16x32_bf16 v[144:147], a[240:243], a[172:175], v[144:147]
 v_accvgpr_write_b32 a11, 0
 v_mfma_f32_16x16x32_bf16 v[52:55], a[244:247], a[160:163], v[52:55]
 ds_read_b64_tr_b16 a[204:205], v18 offset:8192
 ds_read_b64_tr_b16 a[206:207], v18 offset:8704
 v_mfma_f32_16x16x32_bf16 v[84:87], a[244:247], a[164:167], v[84:87]
 buffer_load_dwordx4 a[144:147], v14, s[4:7], s59 offen sc1
 v_mfma_f32_16x16x32_bf16 v[116:119], a[244:247], a[168:171], v[116:119]
 v_mfma_f32_16x16x32_bf16 v[148:151], a[244:247], a[172:175], v[148:151]
 s_waitcnt lgkmcnt(4)
 v_mfma_f32_16x16x32_bf16 v[56:59], a[248:251], a[160:163], v[56:59]
 ds_read_b64_tr_b16 a[208:209], v6 offset:24576
 v_lshlrev_b32 v28, 16, v224
 v_mfma_f32_16x16x32_bf16 v[88:91], a[248:251], a[164:167], v[88:91]
 buffer_load_dwordx4 a[148:151], v22, s[4:7], s59 offen sc1
 v_mfma_f32_16x16x32_bf16 v[120:123], a[248:251], a[168:171], v[120:123]
 ds_read_b64_tr_b16 a[210:211], v6 offset:25600
 v_accvgpr_write_b32 a12, 0
 v_mfma_f32_16x16x32_bf16 v[152:155], a[248:251], a[172:175], v[152:155]
 s_add_u32 s59, s91, 5120
 v_and_b32 v224, 0xffff0000, v224
 v_mfma_f32_16x16x32_bf16 v[60:63], a[252:255], a[160:163], v[60:63]
 ds_read_b64_tr_b16 a[212:213], v7 offset:24576
 ds_read_b64_tr_b16 a[214:215], v7 offset:25600
 v_mfma_f32_16x16x32_bf16 v[92:95], a[252:255], a[164:167], v[92:95]
 v_add_f32 v25, v25, v28
 v_add_f32 v23, v23, v224
 v_mfma_f32_16x16x32_bf16 v[124:127], a[252:255], a[168:171], v[124:127]
 buffer_load_dwordx4 a[152:155], v14, s[4:7], s59 offen sc1
 v_mfma_f32_16x16x32_bf16 v[156:159], a[252:255], a[172:175], v[156:159]
 v_lshlrev_b32 v28, 16, v225
 v_and_b32 v225, 0xffff0000, v225
 v_mfma_f32_16x16x32_bf16 v[160:163], a[192:195], a[160:163], v[160:163]
 ds_read_b64_tr_b16 a[216:217], v8 offset:24576
 ds_read_b64_tr_b16 a[218:219], v8 offset:25600
 v_mfma_f32_16x16x32_bf16 v[176:179], a[192:195], a[164:167], v[176:179]
 buffer_load_dwordx4 a[156:159], v22, s[4:7], s59 offen sc1
 v_mfma_f32_16x16x32_bf16 v[192:195], a[192:195], a[168:171], v[192:195]
 v_add_f32 v25, v25, v28
 v_accvgpr_write_b32 a13, 0
 v_mfma_f32_16x16x32_bf16 v[208:211], a[192:195], a[172:175], v[208:211]
 v_add_f32 v23, v23, v225
 v_lshlrev_b32 v28, 16, v226
 v_mfma_f32_16x16x32_bf16 v[164:167], a[196:199], a[160:163], v[164:167]
 ds_read_b64_tr_b16 a[220:221], v9 offset:24576
 ds_read_b64_tr_b16 a[222:223], v9 offset:25600
 v_mfma_f32_16x16x32_bf16 v[180:183], a[196:199], a[164:167], v[180:183]
 v_and_b32 v226, 0xffff0000, v226
 v_add_f32 v25, v25, v28
 v_mfma_f32_16x16x32_bf16 v[196:199], a[196:199], a[168:171], v[196:199]
 v_add_f32 v23, v23, v226
 v_lshlrev_b32 v28, 16, v227
 v_mfma_f32_16x16x32_bf16 v[212:215], a[196:199], a[172:175], v[212:215]
 v_accvgpr_write_b32 a14, 0
 s_waitcnt lgkmcnt(4)
 v_mfma_f32_16x16x32_bf16 v[168:171], a[200:203], a[160:163], v[168:171]
 ds_read_b64_tr_b16 a[224:225], v10 offset:24576
 ds_read_b64_tr_b16 a[226:227], v10 offset:25600
 v_mfma_f32_16x16x32_bf16 v[184:187], a[200:203], a[164:167], v[184:187]
 v_and_b32 v227, 0xffff0000, v227
 v_add_f32 v25, v25, v28
 v_mfma_f32_16x16x32_bf16 v[200:203], a[200:203], a[168:171], v[200:203]
 v_add_f32 v23, v23, v227
 v_mfma_f32_16x16x32_bf16 v[216:219], a[200:203], a[172:175], v[216:219]
 buffer_store_dwordx4 v[252:255], v24, s[4:7], s58 offen offset:3072 sc1
 v_mfma_f32_16x16x32_bf16 v[172:175], a[204:207], a[160:163], v[172:175]
 ds_read_b64_tr_b16 a[228:229], v11 offset:24576
 ds_read_b64_tr_b16 a[230:231], v11 offset:25600
 v_mfma_f32_16x16x32_bf16 v[188:191], a[204:207], a[164:167], v[188:191]
 v_accvgpr_write_b32 a15, 0
 v_mfma_f32_16x16x32_bf16 v[204:207], a[204:207], a[168:171], v[204:207]
 v_mfma_f32_16x16x32_bf16 v[220:223], a[204:207], a[172:175], v[220:223]
 v_accvgpr_write_b32 a16, 0
 s_waitcnt vmcnt(35)
 v_mfma_f32_16x16x32_bf16 v[32:35], a[208:211], a[176:179], v[32:35]
 ds_read_b64_tr_b16 a[232:233], v12 offset:24576
 s_waitcnt vmcnt(34)
 v_mfma_f32_16x16x32_bf16 v[64:67], a[208:211], a[180:183], v[64:67]
 s_add_u32 s59, s90, 6144
 s_waitcnt vmcnt(33)
 v_mfma_f32_16x16x32_bf16 v[96:99], a[208:211], a[184:187], v[96:99]
 ds_read_b64_tr_b16 a[234:235], v12 offset:25600
 s_waitcnt vmcnt(32)
 v_mfma_f32_16x16x32_bf16 v[128:131], a[208:211], a[188:191], v[128:131]
 ds_read_b64_tr_b16 v[228:229], v21 offset:12288
 ds_read_b64_tr_b16 v[230:231], v21 offset:12800
 v_mfma_f32_16x16x32_bf16 v[36:39], a[212:215], a[176:179], v[36:39]
 buffer_load_dwordx4 a[160:163], v14, s[4:7], s59 offen sc1
 v_mfma_f32_16x16x32_bf16 v[68:71], a[212:215], a[180:183], v[68:71]
 ds_read_b64_tr_b16 a[236:237], v13 offset:24576
 ds_read_b64_tr_b16 a[238:239], v13 offset:25600
 v_mfma_f32_16x16x32_bf16 v[100:103], a[212:215], a[184:187], v[100:103]
 buffer_load_dwordx4 a[164:167], v22, s[4:7], s59 offen sc1
 v_mfma_f32_16x16x32_bf16 v[132:135], a[212:215], a[188:191], v[132:135]
 v_accvgpr_write_b32 a17, 0
 s_waitcnt lgkmcnt(6)
 v_mfma_f32_16x16x32_bf16 v[40:43], a[216:219], a[176:179], v[40:43]
 ds_read_b64_tr_b16 a[240:241], v15 offset:12288
 ds_read_b64_tr_b16 a[242:243], v15 offset:12800
 v_mfma_f32_16x16x32_bf16 v[72:75], a[216:219], a[180:183], v[72:75]
 s_add_u32 s59, s91, 6144
 v_mfma_f32_16x16x32_bf16 v[104:107], a[216:219], a[184:187], v[104:107]
 v_mfma_f32_16x16x32_bf16 v[136:139], a[216:219], a[188:191], v[136:139]
 v_accvgpr_write_b32 a18, 0
 v_mfma_f32_16x16x32_bf16 v[44:47], a[220:223], a[176:179], v[44:47]
 ds_read_b64_tr_b16 a[244:245], v16 offset:12288
 v_mfma_f32_16x16x32_bf16 v[76:79], a[220:223], a[180:183], v[76:79]
 buffer_load_dwordx4 a[168:171], v14, s[4:7], s59 offen sc1
 v_mfma_f32_16x16x32_bf16 v[108:111], a[220:223], a[184:187], v[108:111]
 ds_read_b64_tr_b16 a[246:247], v16 offset:12800
 v_lshrrev_b32 v29, 3, v0
 v_mfma_f32_16x16x32_bf16 v[140:143], a[220:223], a[188:191], v[140:143]
 buffer_load_dwordx4 a[172:175], v22, s[4:7], s59 offen sc1
 v_mfma_f32_16x16x32_bf16 v[48:51], a[224:227], a[176:179], v[48:51]
 ds_read_b64_tr_b16 a[248:249], v17 offset:12288
 ds_read_b64_tr_b16 a[250:251], v17 offset:12800
 v_mfma_f32_16x16x32_bf16 v[80:83], a[224:227], a[180:183], v[80:83]
 v_accvgpr_write_b32 a19, 0
 v_mfma_f32_16x16x32_bf16 v[112:115], a[224:227], a[184:187], v[112:115]
 v_mfma_f32_16x16x32_bf16 v[144:147], a[224:227], a[188:191], v[144:147]
 v_mul_u32_u24 v248, 1280, v29
 v_mfma_f32_16x16x32_bf16 v[52:55], a[228:231], a[176:179], v[52:55]
 ds_read_b64_tr_b16 a[252:253], v18 offset:12288
 ds_read_b64_tr_b16 a[254:255], v18 offset:12800
 v_mfma_f32_16x16x32_bf16 v[84:87], a[228:231], a[180:183], v[84:87]
 v_mfma_f32_16x16x32_bf16 v[116:119], a[228:231], a[184:187], v[116:119]
 v_mfma_f32_16x16x32_bf16 v[148:151], a[228:231], a[188:191], v[148:151]
 v_accvgpr_write_b32 a20, 0
 s_waitcnt lgkmcnt(5)
 v_mfma_f32_16x16x32_bf16 v[56:59], a[232:235], a[176:179], v[56:59]
 v_lshlrev_b32 v28, 16, v228
 v_and_b32 v29, 7, v0
 v_mfma_f32_16x16x32_bf16 v[88:91], a[232:235], a[180:183], v[88:91]
 v_and_b32 v228, 0xffff0000, v228
 v_mfma_f32_16x16x32_bf16 v[120:123], a[232:235], a[184:187], v[120:123]
 v_add_f32 v25, v25, v28
 v_mfma_f32_16x16x32_bf16 v[152:155], a[232:235], a[188:191], v[152:155]
 v_add_f32 v23, v23, v228
 v_mfma_f32_16x16x32_bf16 v[60:63], a[236:239], a[176:179], v[60:63]
 v_lshlrev_b32 v28, 16, v229
 v_mfma_f32_16x16x32_bf16 v[92:95], a[236:239], a[180:183], v[92:95]
 v_and_b32 v229, 0xffff0000, v229
 v_accvgpr_write_b32 a21, 0
 v_mfma_f32_16x16x32_bf16 v[124:127], a[236:239], a[184:187], v[124:127]
 v_lshl_add_u32 v248, v29, 4, v248
 v_add_f32 v25, v25, v28
 v_mfma_f32_16x16x32_bf16 v[156:159], a[236:239], a[188:191], v[156:159]
 v_add_f32 v23, v23, v229
 v_mfma_f32_16x16x32_bf16 v[160:163], a[240:243], a[176:179], v[160:163]
 v_lshlrev_b32 v28, 16, v230
 v_mfma_f32_16x16x32_bf16 v[176:179], a[240:243], a[180:183], v[176:179]
 v_and_b32 v230, 0xffff0000, v230
 v_mfma_f32_16x16x32_bf16 v[192:195], a[240:243], a[184:187], v[192:195]
 s_waitcnt vmcnt(22)
 s_waitcnt lgkmcnt(0)
 s_barrier
 v_mfma_f32_16x16x32_bf16 v[208:211], a[240:243], a[188:191], v[208:211]
 ds_read_b64_tr_b16 a[192:193], v6 offset:32768
 ds_read_b64_tr_b16 a[194:195], v6 offset:33792
 v_mfma_f32_16x16x32_bf16 v[164:167], a[244:247], a[176:179], v[164:167]
 ds_read_b64_tr_b16 a[196:197], v7 offset:32768
 ds_read_b64_tr_b16 a[198:199], v7 offset:33792
 v_mfma_f32_16x16x32_bf16 v[180:183], a[244:247], a[180:183], v[180:183]
 ds_read_b64_tr_b16 a[200:201], v8 offset:32768
 ds_read_b64_tr_b16 a[202:203], v8 offset:33792
 v_mfma_f32_16x16x32_bf16 v[196:199], a[244:247], a[184:187], v[196:199]
 ds_read_b64_tr_b16 a[204:205], v9 offset:32768
 ds_read_b64_tr_b16 a[206:207], v9 offset:33792
 v_mfma_f32_16x16x32_bf16 v[212:215], a[244:247], a[188:191], v[212:215]
 s_add_u32 m0, s65, 16384
 v_add_f32 v25, v25, v28
 v_mfma_f32_16x16x32_bf16 v[168:171], a[248:251], a[176:179], v[168:171]
 ds_read_b64_tr_b16 a[208:209], v10 offset:32768
 s_add_u32 s56, s87, 2097152
 v_mfma_f32_16x16x32_bf16 v[184:187], a[248:251], a[180:183], v[184:187]
 ds_read_b64_tr_b16 a[210:211], v10 offset:33792
 s_mov_b32 s15, 0x00020000
 v_mfma_f32_16x16x32_bf16 v[200:203], a[248:251], a[184:187], v[200:203]
 v_accvgpr_write_b32 a22, 0
 v_add_f32 v23, v23, v230
 v_mfma_f32_16x16x32_bf16 v[216:219], a[248:251], a[188:191], v[216:219]
 buffer_load_dwordx4 v2, s[28:31], s56 offen offset:0 lds
 v_mfma_f32_16x16x32_bf16 v[172:175], a[252:255], a[176:179], v[172:175]
 ds_read_b64_tr_b16 a[212:213], v11 offset:32768
 ds_read_b64_tr_b16 a[214:215], v11 offset:33792
 v_mfma_f32_16x16x32_bf16 v[188:191], a[252:255], a[180:183], v[188:191]
 v_lshlrev_b32 v28, 16, v231
 v_and_b32 v231, 0xffff0000, v231
 v_mfma_f32_16x16x32_bf16 v[204:207], a[252:255], a[184:187], v[204:207]
 buffer_load_dwordx4 v3, s[28:31], s56 offen offset:1024 lds
 v_mfma_f32_16x16x32_bf16 v[220:223], a[252:255], a[188:191], v[220:223]
 v_add_f32 v25, v25, v28
 s_waitcnt lgkmcnt(7) vmcnt(21)
 v_mfma_f32_16x16x32_bf16 v[32:35], a[192:195], a[128:131], v[32:35]
 ds_read_b64_tr_b16 a[216:217], v12 offset:32768
 s_waitcnt vmcnt(20)
 v_mfma_f32_16x16x32_bf16 v[64:67], a[192:195], a[132:135], v[64:67]
 ds_read_b64_tr_b16 a[218:219], v12 offset:33792
 s_waitcnt vmcnt(19)
 v_mfma_f32_16x16x32_bf16 v[96:99], a[192:195], a[136:139], v[96:99]
 v_add_f32 v23, v23, v231
 s_waitcnt vmcnt(18)
 v_mfma_f32_16x16x32_bf16 v[128:131], a[192:195], a[140:143], v[128:131]
 buffer_load_dwordx4 v4, s[28:31], s56 offen offset:2048 lds
 v_mfma_f32_16x16x32_bf16 v[36:39], a[196:199], a[128:131], v[36:39]
 ds_read_b64_tr_b16 v[224:225], v21 offset:16384
 ds_read_b64_tr_b16 v[226:227], v21 offset:16896
 v_mfma_f32_16x16x32_bf16 v[68:71], a[196:199], a[132:135], v[68:71]
 ds_read_b64_tr_b16 a[220:221], v13 offset:32768
 s_mov_b32 s8, s70
 v_mfma_f32_16x16x32_bf16 v[100:103], a[196:199], a[136:139], v[100:103]
 buffer_load_dwordx4 v5, s[28:31], s56 offen offset:3072 lds
 v_mfma_f32_16x16x32_bf16 v[132:135], a[196:199], a[140:143], v[132:135]
 ds_read_b64_tr_b16 a[222:223], v13 offset:33792
 s_waitcnt lgkmcnt(6)
 v_mfma_f32_16x16x32_bf16 v[40:43], a[200:203], a[128:131], v[40:43]
 s_add_u32 m0, s89, 106496
 ds_read_b64_tr_b16 a[224:225], v15 offset:16384
 v_mfma_f32_16x16x32_bf16 v[72:75], a[200:203], a[132:135], v[72:75]
 ds_read_b64_tr_b16 a[226:227], v15 offset:16896
 v_accvgpr_write_b32 a23, 0
 v_mfma_f32_16x16x32_bf16 v[104:107], a[200:203], a[136:139], v[104:107]
 s_add_u32 s56, s88, 884736
 s_mul_hi_u32 s9, s8, 429496730
 v_mfma_f32_16x16x32_bf16 v[136:139], a[200:203], a[140:143], v[136:139]
 v_accvgpr_write_b32 a24, 0
 s_mul_i32 s82, s9, 10
 v_mfma_f32_16x16x32_bf16 v[44:47], a[204:207], a[128:131], v[44:47]
 ds_read_b64_tr_b16 a[228:229], v16 offset:16384
 ds_read_b64_tr_b16 a[230:231], v16 offset:16896
 v_mfma_f32_16x16x32_bf16 v[76:79], a[204:207], a[132:135], v[76:79]
 buffer_load_dwordx4 v19, s[32:35], s56 offen offset:0 lds
 v_mfma_f32_16x16x32_bf16 v[108:111], a[204:207], a[136:139], v[108:111]
 v_accvgpr_write_b32 a25, 0
 s_sub_u32 s10, s8, s82
 v_mfma_f32_16x16x32_bf16 v[140:143], a[204:207], a[140:143], v[140:143]
 buffer_store_dwordx4 v[232:235], v24, s[4:7], s57 offen offset:2048 sc1
 v_mfma_f32_16x16x32_bf16 v[48:51], a[208:211], a[128:131], v[48:51]
 ds_read_b64_tr_b16 a[232:233], v17 offset:16384
 v_accvgpr_write_b32 a26, 0
 v_mfma_f32_16x16x32_bf16 v[80:83], a[208:211], a[132:135], v[80:83]
 buffer_load_dwordx4 v20, s[32:35], s56 offen offset:1024 lds
 v_mfma_f32_16x16x32_bf16 v[112:115], a[208:211], a[136:139], v[112:115]
 ds_read_b64_tr_b16 a[234:235], v17 offset:16896
 s_add_u32 s59, s90, 7168
 v_mfma_f32_16x16x32_bf16 v[144:147], a[208:211], a[140:143], v[144:147]
 s_and_b32 s82, s9, 127
 v_accvgpr_write_b32 a27, 0
 v_mfma_f32_16x16x32_bf16 v[52:55], a[212:215], a[128:131], v[52:55]
 ds_read_b64_tr_b16 a[236:237], v18 offset:16384
 ds_read_b64_tr_b16 a[238:239], v18 offset:16896
 v_mfma_f32_16x16x32_bf16 v[84:87], a[212:215], a[132:135], v[84:87]
 buffer_load_dwordx4 a[176:179], v14, s[4:7], s59 offen sc1
 v_mfma_f32_16x16x32_bf16 v[116:119], a[212:215], a[136:139], v[116:119]
 s_mul_i32 s20, s82, 40960
 s_lshl_b32 s82, s10, 7
 v_mfma_f32_16x16x32_bf16 v[148:151], a[212:215], a[140:143], v[148:151]
 v_accvgpr_write_b32 a28, 0
 s_waitcnt lgkmcnt(4)
 v_mfma_f32_16x16x32_bf16 v[56:59], a[216:219], a[128:131], v[56:59]
 ds_read_b64_tr_b16 a[240:241], v6 offset:40960
 v_lshlrev_b32 v28, 16, v224
 v_mfma_f32_16x16x32_bf16 v[88:91], a[216:219], a[132:135], v[88:91]
 buffer_load_dwordx4 a[180:183], v22, s[4:7], s59 offen sc1
 v_mfma_f32_16x16x32_bf16 v[120:123], a[216:219], a[136:139], v[120:123]
 ds_read_b64_tr_b16 a[242:243], v6 offset:41984
 v_and_b32 v224, 0xffff0000, v224
 v_mfma_f32_16x16x32_bf16 v[152:155], a[216:219], a[140:143], v[152:155]
 s_add_u32 s59, s91, 7168
 v_add_f32 v25, v25, v28
 v_mfma_f32_16x16x32_bf16 v[60:63], a[220:223], a[128:131], v[60:63]
 ds_read_b64_tr_b16 a[244:245], v7 offset:40960
 ds_read_b64_tr_b16 a[246:247], v7 offset:41984
 v_mfma_f32_16x16x32_bf16 v[92:95], a[220:223], a[132:135], v[92:95]
 s_add_u32 s20, s20, s82
 v_add_f32 v23, v23, v224
 v_mfma_f32_16x16x32_bf16 v[124:127], a[220:223], a[136:139], v[124:127]
 buffer_load_dwordx4 a[184:187], v14, s[4:7], s59 offen sc1
 v_mfma_f32_16x16x32_bf16 v[156:159], a[220:223], a[140:143], v[156:159]
 v_accvgpr_write_b32 a29, 0
 v_lshlrev_b32 v28, 16, v225
 v_mfma_f32_16x16x32_bf16 v[160:163], a[224:227], a[128:131], v[160:163]
 ds_read_b64_tr_b16 a[248:249], v8 offset:40960
 ds_read_b64_tr_b16 a[250:251], v8 offset:41984
 v_mfma_f32_16x16x32_bf16 v[176:179], a[224:227], a[132:135], v[176:179]
 buffer_load_dwordx4 a[188:191], v22, s[4:7], s59 offen sc1
 v_mfma_f32_16x16x32_bf16 v[192:195], a[224:227], a[136:139], v[192:195]
 v_and_b32 v225, 0xffff0000, v225
 v_add_f32 v25, v25, v28
 v_mfma_f32_16x16x32_bf16 v[208:211], a[224:227], a[140:143], v[208:211]
 v_add_f32 v23, v23, v225
 s_lshl_b32 s10, s10, 1
 v_mfma_f32_16x16x32_bf16 v[164:167], a[228:231], a[128:131], v[164:167]
 ds_read_b64_tr_b16 a[252:253], v9 offset:40960
 ds_read_b64_tr_b16 a[254:255], v9 offset:41984
 v_mfma_f32_16x16x32_bf16 v[180:183], a[228:231], a[132:135], v[180:183]
 v_lshlrev_b32 v28, 16, v226
 v_and_b32 v226, 0xffff0000, v226
 v_mfma_f32_16x16x32_bf16 v[196:199], a[228:231], a[136:139], v[196:199]
 v_accvgpr_write_b32 a30, 0
 v_add_f32 v25, v25, v28
 v_mfma_f32_16x16x32_bf16 v[212:215], a[228:231], a[140:143], v[212:215]
 v_add_f32 v23, v23, v226
 s_waitcnt lgkmcnt(4)
 v_mfma_f32_16x16x32_bf16 v[168:171], a[232:235], a[128:131], v[168:171]
 ds_read_b64_tr_b16 a[192:193], v10 offset:40960
 ds_read_b64_tr_b16 a[194:195], v10 offset:41984
 v_mfma_f32_16x16x32_bf16 v[184:187], a[232:235], a[132:135], v[184:187]
 v_lshlrev_b32 v28, 16, v227
 s_mul_hi_u32 s82, s10, 858993460
 v_mfma_f32_16x16x32_bf16 v[200:203], a[232:235], a[136:139], v[200:203]
 v_and_b32 v227, 0xffff0000, v227
 v_add_f32 v25, v25, v28
 v_mfma_f32_16x16x32_bf16 v[216:219], a[232:235], a[140:143], v[216:219]
 v_add_f32 v23, v23, v227
 v_accvgpr_write_b32 a31, 0
 v_mfma_f32_16x16x32_bf16 v[172:175], a[236:239], a[128:131], v[172:175]
 ds_read_b64_tr_b16 a[196:197], v11 offset:40960
 ds_read_b64_tr_b16 a[198:199], v11 offset:41984
 v_mfma_f32_16x16x32_bf16 v[188:191], a[236:239], a[132:135], v[188:191]
 s_mul_i32 s16, s82, 1810
 v_accvgpr_write_b32 a32, 0
 v_mfma_f32_16x16x32_bf16 v[204:207], a[236:239], a[136:139], v[204:207]
 s_mul_i32 s82, s9, 10
 v_mfma_f32_16x16x32_bf16 v[220:223], a[236:239], a[140:143], v[220:223]
 s_waitcnt vmcnt(19)
 v_mfma_f32_16x16x32_bf16 v[32:35], a[240:243], a[144:147], v[32:35]
 ds_read_b64_tr_b16 a[200:201], v12 offset:40960
 s_waitcnt vmcnt(18)
 v_mfma_f32_16x16x32_bf16 v[64:67], a[240:243], a[148:151], v[64:67]
 s_add_u32 s59, s90, 8192
 s_waitcnt vmcnt(17)
 v_mfma_f32_16x16x32_bf16 v[96:99], a[240:243], a[152:155], v[96:99]
 ds_read_b64_tr_b16 a[202:203], v12 offset:41984
 s_waitcnt vmcnt(16)
 v_mfma_f32_16x16x32_bf16 v[128:131], a[240:243], a[156:159], v[128:131]
 ds_read_b64_tr_b16 v[228:229], v21 offset:20480
 ds_read_b64_tr_b16 v[230:231], v21 offset:20992
 v_mfma_f32_16x16x32_bf16 v[36:39], a[244:247], a[144:147], v[36:39]
 buffer_load_dwordx4 a[128:131], v14, s[4:7], s59 offen sc1
 v_mfma_f32_16x16x32_bf16 v[68:71], a[244:247], a[148:151], v[68:71]
 ds_read_b64_tr_b16 a[204:205], v13 offset:40960
 ds_read_b64_tr_b16 a[206:207], v13 offset:41984
 v_mfma_f32_16x16x32_bf16 v[100:103], a[244:247], a[152:155], v[100:103]
 buffer_load_dwordx4 a[132:135], v22, s[4:7], s59 offen sc1
 v_mfma_f32_16x16x32_bf16 v[132:135], a[244:247], a[156:159], v[132:135]
 v_accvgpr_write_b32 a33, 0
 s_waitcnt lgkmcnt(6)
 v_mfma_f32_16x16x32_bf16 v[40:43], a[248:251], a[144:147], v[40:43]
 ds_read_b64_tr_b16 a[208:209], v15 offset:20480
 ds_read_b64_tr_b16 a[210:211], v15 offset:20992
 v_mfma_f32_16x16x32_bf16 v[72:75], a[248:251], a[148:151], v[72:75]
 s_add_u32 s59, s91, 8192
 s_add_u32 s16, s16, s82
 v_mfma_f32_16x16x32_bf16 v[104:107], a[248:251], a[152:155], v[104:107]
 s_lshl_b32 s82, s10, 1
 v_accvgpr_write_b32 a34, 0
 v_mfma_f32_16x16x32_bf16 v[136:139], a[248:251], a[156:159], v[136:139]
 v_mfma_f32_16x16x32_bf16 v[44:47], a[252:255], a[144:147], v[44:47]
 ds_read_b64_tr_b16 a[212:213], v16 offset:20480
 v_mfma_f32_16x16x32_bf16 v[76:79], a[252:255], a[148:151], v[76:79]
 buffer_load_dwordx4 a[136:139], v14, s[4:7], s59 offen sc1
 v_mfma_f32_16x16x32_bf16 v[108:111], a[252:255], a[152:155], v[108:111]
 ds_read_b64_tr_b16 a[214:215], v16 offset:20992
 s_add_u32 s16, s16, s82
 v_mfma_f32_16x16x32_bf16 v[140:143], a[252:255], a[156:159], v[140:143]
 buffer_load_dwordx4 a[140:143], v22, s[4:7], s59 offen sc1
 v_mfma_f32_16x16x32_bf16 v[48:51], a[192:195], a[144:147], v[48:51]
 ds_read_b64_tr_b16 a[216:217], v17 offset:20480
 ds_read_b64_tr_b16 a[218:219], v17 offset:20992
 v_mfma_f32_16x16x32_bf16 v[80:83], a[192:195], a[148:151], v[80:83]
 v_accvgpr_write_b32 a35, 0
 v_mfma_f32_16x16x32_bf16 v[112:115], a[192:195], a[152:155], v[112:115]
 s_lshl_b32 s16, s16, 10
 v_mfma_f32_16x16x32_bf16 v[144:147], a[192:195], a[156:159], v[144:147]
 v_mfma_f32_16x16x32_bf16 v[52:55], a[196:199], a[144:147], v[52:55]
 ds_read_b64_tr_b16 a[220:221], v18 offset:20480
 ds_read_b64_tr_b16 a[222:223], v18 offset:20992
 v_mfma_f32_16x16x32_bf16 v[84:87], a[196:199], a[148:151], v[84:87]
 v_accvgpr_write_b32 a36, 0
 v_mfma_f32_16x16x32_bf16 v[116:119], a[196:199], a[152:155], v[116:119]
 v_mfma_f32_16x16x32_bf16 v[148:151], a[196:199], a[156:159], v[148:151]
 s_add_u32 s16, s16, 63963136
 s_waitcnt lgkmcnt(5)
 v_mfma_f32_16x16x32_bf16 v[56:59], a[200:203], a[144:147], v[56:59]
 v_lshlrev_b32 v28, 16, v228
 v_mfma_f32_16x16x32_bf16 v[88:91], a[200:203], a[148:151], v[88:91]
 v_and_b32 v228, 0xffff0000, v228
 v_mfma_f32_16x16x32_bf16 v[120:123], a[200:203], a[152:155], v[120:123]
 v_add_f32 v25, v25, v28
 v_accvgpr_write_b32 a37, 0
 v_mfma_f32_16x16x32_bf16 v[152:155], a[200:203], a[156:159], v[152:155]
 v_add_f32 v23, v23, v228
 v_mfma_f32_16x16x32_bf16 v[60:63], a[204:207], a[144:147], v[60:63]
 buffer_store_dwordx4 v[236:239], v24, s[4:7], s58 offen offset:2048 sc1
 v_mfma_f32_16x16x32_bf16 v[92:95], a[204:207], a[148:151], v[92:95]
 v_lshlrev_b32 v28, 16, v229
 s_add_u32 s10, s10, 1
 v_mfma_f32_16x16x32_bf16 v[124:127], a[204:207], a[152:155], v[124:127]
 v_and_b32 v229, 0xffff0000, v229
 v_add_f32 v25, v25, v28
 v_mfma_f32_16x16x32_bf16 v[156:159], a[204:207], a[156:159], v[156:159]
 v_add_f32 v23, v23, v229
 v_mfma_f32_16x16x32_bf16 v[160:163], a[208:211], a[144:147], v[160:163]
 v_lshlrev_b32 v28, 16, v230
 v_accvgpr_write_b32 a38, 0
 v_mfma_f32_16x16x32_bf16 v[176:179], a[208:211], a[148:151], v[176:179]
 v_and_b32 v230, 0xffff0000, v230
 s_mul_hi_u32 s82, s10, 858993460
 v_mfma_f32_16x16x32_bf16 v[192:195], a[208:211], a[152:155], v[192:195]
 s_waitcnt lgkmcnt(0)
 s_barrier
 v_mfma_f32_16x16x32_bf16 v[208:211], a[208:211], a[156:159], v[208:211]
 ds_read_b64_tr_b16 a[224:225], v6 offset:0
 ds_read_b64_tr_b16 a[226:227], v6 offset:1024
 v_mfma_f32_16x16x32_bf16 v[164:167], a[212:215], a[144:147], v[164:167]
 ds_read_b64_tr_b16 a[228:229], v7 offset:0
 ds_read_b64_tr_b16 a[230:231], v7 offset:1024
 v_mfma_f32_16x16x32_bf16 v[180:183], a[212:215], a[148:151], v[180:183]
 ds_read_b64_tr_b16 a[232:233], v8 offset:0
 ds_read_b64_tr_b16 a[234:235], v8 offset:1024
 v_mfma_f32_16x16x32_bf16 v[196:199], a[212:215], a[152:155], v[196:199]
 ds_read_b64_tr_b16 a[236:237], v9 offset:0
 ds_read_b64_tr_b16 a[238:239], v9 offset:1024
 v_mfma_f32_16x16x32_bf16 v[212:215], a[212:215], a[156:159], v[212:215]
 s_add_u32 m0, s65, 32768
 v_add_f32 v25, v25, v28
 v_mfma_f32_16x16x32_bf16 v[168:171], a[216:219], a[144:147], v[168:171]
 ds_read_b64_tr_b16 a[240:241], v10 offset:0
 s_add_u32 s56, s87, 2621440
 v_mfma_f32_16x16x32_bf16 v[184:187], a[216:219], a[148:151], v[184:187]
 ds_read_b64_tr_b16 a[242:243], v10 offset:1024
 v_add_f32 v23, v23, v230
 v_mfma_f32_16x16x32_bf16 v[200:203], a[216:219], a[152:155], v[200:203]
 v_lshlrev_b32 v28, 16, v231
 v_and_b32 v231, 0xffff0000, v231
 v_mfma_f32_16x16x32_bf16 v[216:219], a[216:219], a[156:159], v[216:219]
 buffer_load_dwordx4 v2, s[28:31], s56 offen offset:0 lds
 v_mfma_f32_16x16x32_bf16 v[172:175], a[220:223], a[144:147], v[172:175]
 ds_read_b64_tr_b16 a[244:245], v11 offset:0
 ds_read_b64_tr_b16 a[246:247], v11 offset:1024
 v_mfma_f32_16x16x32_bf16 v[188:191], a[220:223], a[148:151], v[188:191]
 v_add_f32 v25, v25, v28
 v_accvgpr_write_b32 a39, 0
 v_mfma_f32_16x16x32_bf16 v[204:207], a[220:223], a[152:155], v[204:207]
 buffer_load_dwordx4 v3, s[28:31], s56 offen offset:1024 lds
 v_mfma_f32_16x16x32_bf16 v[220:223], a[220:223], a[156:159], v[220:223]
 s_mul_i32 s17, s82, 1810
 s_waitcnt lgkmcnt(7) vmcnt(21)
 v_mfma_f32_16x16x32_bf16 v[32:35], a[224:227], a[160:163], v[32:35]
 ds_read_b64_tr_b16 a[248:249], v12 offset:0
 s_waitcnt vmcnt(20)
 v_mfma_f32_16x16x32_bf16 v[64:67], a[224:227], a[164:167], v[64:67]
 ds_read_b64_tr_b16 a[250:251], v12 offset:1024
 s_waitcnt vmcnt(19)
 v_mfma_f32_16x16x32_bf16 v[96:99], a[224:227], a[168:171], v[96:99]
 v_add_f32 v23, v23, v231
 s_waitcnt vmcnt(18)
 v_mfma_f32_16x16x32_bf16 v[128:131], a[224:227], a[172:175], v[128:131]
 buffer_load_dwordx4 v4, s[28:31], s56 offen offset:2048 lds
 v_mfma_f32_16x16x32_bf16 v[36:39], a[228:231], a[160:163], v[36:39]
 ds_read_b64_tr_b16 v[224:225], v21 offset:0
 ds_read_b64_tr_b16 v[226:227], v21 offset:512
 v_mfma_f32_16x16x32_bf16 v[68:71], a[228:231], a[164:167], v[68:71]
 ds_read_b64_tr_b16 a[252:253], v13 offset:0
 s_mul_i32 s82, s9, 10
 v_mfma_f32_16x16x32_bf16 v[100:103], a[228:231], a[168:171], v[100:103]
 buffer_load_dwordx4 v5, s[28:31], s56 offen offset:3072 lds
 v_mfma_f32_16x16x32_bf16 v[132:135], a[228:231], a[172:175], v[132:135]
 ds_read_b64_tr_b16 a[254:255], v13 offset:1024
 s_waitcnt lgkmcnt(6)
 v_mfma_f32_16x16x32_bf16 v[40:43], a[232:235], a[160:163], v[40:43]
 s_add_u32 m0, s89, 114688
 ds_read_b64_tr_b16 a[192:193], v15 offset:0
 v_mfma_f32_16x16x32_bf16 v[72:75], a[232:235], a[164:167], v[72:75]
 ds_read_b64_tr_b16 a[194:195], v15 offset:512
 v_accvgpr_write_b32 a40, 0
 v_mfma_f32_16x16x32_bf16 v[104:107], a[232:235], a[168:171], v[104:107]
 s_add_u32 s56, s88, 1105920
 s_add_u32 s17, s17, s82
 v_mfma_f32_16x16x32_bf16 v[136:139], a[232:235], a[172:175], v[136:139]
 v_accvgpr_write_b32 a41, 0
 s_lshl_b32 s82, s10, 1
 v_mfma_f32_16x16x32_bf16 v[44:47], a[236:239], a[160:163], v[44:47]
 ds_read_b64_tr_b16 a[196:197], v16 offset:0
 ds_read_b64_tr_b16 a[198:199], v16 offset:512
 v_mfma_f32_16x16x32_bf16 v[76:79], a[236:239], a[164:167], v[76:79]
 buffer_load_dwordx4 v19, s[32:35], s56 offen offset:0 lds
 v_mfma_f32_16x16x32_bf16 v[108:111], a[236:239], a[168:171], v[108:111]
 v_accvgpr_write_b32 a42, 0
 s_add_u32 s17, s17, s82
 v_mfma_f32_16x16x32_bf16 v[140:143], a[236:239], a[172:175], v[140:143]
 v_accvgpr_write_b32 a43, 0
 s_lshl_b32 s17, s17, 10
 v_mfma_f32_16x16x32_bf16 v[48:51], a[240:243], a[160:163], v[48:51]
 ds_read_b64_tr_b16 a[200:201], v17 offset:0
 v_mfma_f32_16x16x32_bf16 v[80:83], a[240:243], a[164:167], v[80:83]
 buffer_load_dwordx4 v20, s[32:35], s56 offen offset:1024 lds
 v_mfma_f32_16x16x32_bf16 v[112:115], a[240:243], a[168:171], v[112:115]
 ds_read_b64_tr_b16 a[202:203], v17 offset:512
 s_add_u32 s59, s90, 9216
 v_mfma_f32_16x16x32_bf16 v[144:147], a[240:243], a[172:175], v[144:147]
 v_accvgpr_write_b32 a44, 0
 v_mfma_f32_16x16x32_bf16 v[52:55], a[244:247], a[160:163], v[52:55]
 ds_read_b64_tr_b16 a[204:205], v18 offset:0
 ds_read_b64_tr_b16 a[206:207], v18 offset:512
 v_mfma_f32_16x16x32_bf16 v[84:87], a[244:247], a[164:167], v[84:87]
 buffer_load_dwordx4 a[144:147], v14, s[4:7], s59 offen sc1
 v_mfma_f32_16x16x32_bf16 v[116:119], a[244:247], a[168:171], v[116:119]
 s_add_u32 s17, s17, 63963136
 v_mfma_f32_16x16x32_bf16 v[148:151], a[244:247], a[172:175], v[148:151]
 s_waitcnt lgkmcnt(4)
 v_mfma_f32_16x16x32_bf16 v[56:59], a[248:251], a[160:163], v[56:59]
 ds_read_b64_tr_b16 a[208:209], v6 offset:8192
 v_lshlrev_b32 v28, 16, v224
 v_mfma_f32_16x16x32_bf16 v[88:91], a[248:251], a[164:167], v[88:91]
 buffer_load_dwordx4 a[148:151], v22, s[4:7], s59 offen sc1
 v_mfma_f32_16x16x32_bf16 v[120:123], a[248:251], a[168:171], v[120:123]
 ds_read_b64_tr_b16 a[210:211], v6 offset:9216
 v_and_b32 v224, 0xffff0000, v224
 v_mfma_f32_16x16x32_bf16 v[152:155], a[248:251], a[172:175], v[152:155]
 s_add_u32 s59, s91, 9216
 v_accvgpr_write_b32 a45, 0
 v_mfma_f32_16x16x32_bf16 v[60:63], a[252:255], a[160:163], v[60:63]
 ds_read_b64_tr_b16 a[212:213], v7 offset:8192
 ds_read_b64_tr_b16 a[214:215], v7 offset:9216
 v_mfma_f32_16x16x32_bf16 v[92:95], a[252:255], a[164:167], v[92:95]
 s_add_u32 s10, s10, 1
 v_add_f32 v25, v25, v28
 v_mfma_f32_16x16x32_bf16 v[124:127], a[252:255], a[168:171], v[124:127]
 buffer_load_dwordx4 a[152:155], v14, s[4:7], s59 offen sc1
 v_mfma_f32_16x16x32_bf16 v[156:159], a[252:255], a[172:175], v[156:159]
 v_add_f32 v23, v23, v224
 v_lshlrev_b32 v28, 16, v225
 v_mfma_f32_16x16x32_bf16 v[160:163], a[192:195], a[160:163], v[160:163]
 ds_read_b64_tr_b16 a[216:217], v8 offset:8192
 ds_read_b64_tr_b16 a[218:219], v8 offset:9216
 v_mfma_f32_16x16x32_bf16 v[176:179], a[192:195], a[164:167], v[176:179]
 buffer_load_dwordx4 a[156:159], v22, s[4:7], s59 offen sc1
 v_mfma_f32_16x16x32_bf16 v[192:195], a[192:195], a[168:171], v[192:195]
 v_and_b32 v225, 0xffff0000, v225
 v_add_f32 v25, v25, v28
 v_mfma_f32_16x16x32_bf16 v[208:211], a[192:195], a[172:175], v[208:211]
 s_add_u32 s8, s8, 1024
 v_add_f32 v23, v23, v225
 v_mfma_f32_16x16x32_bf16 v[164:167], a[196:199], a[160:163], v[164:167]
 ds_read_b64_tr_b16 a[220:221], v9 offset:8192
 ds_read_b64_tr_b16 a[222:223], v9 offset:9216
 v_mfma_f32_16x16x32_bf16 v[180:183], a[196:199], a[164:167], v[180:183]
 v_accvgpr_write_b32 a46, 0
 v_lshlrev_b32 v28, 16, v226
 v_mfma_f32_16x16x32_bf16 v[196:199], a[196:199], a[168:171], v[196:199]
 v_and_b32 v226, 0xffff0000, v226
 v_add_f32 v25, v25, v28
 v_mfma_f32_16x16x32_bf16 v[212:215], a[196:199], a[172:175], v[212:215]
 v_add_f32 v23, v23, v226
 s_waitcnt lgkmcnt(4)
 v_mfma_f32_16x16x32_bf16 v[168:171], a[200:203], a[160:163], v[168:171]
 ds_read_b64_tr_b16 a[224:225], v10 offset:8192
 ds_read_b64_tr_b16 a[226:227], v10 offset:9216
 v_mfma_f32_16x16x32_bf16 v[184:187], a[200:203], a[164:167], v[184:187]
 s_mul_hi_u32 s9, s8, 429496730
 v_lshlrev_b32 v28, 16, v227
 v_mfma_f32_16x16x32_bf16 v[200:203], a[200:203], a[168:171], v[200:203]
 v_and_b32 v227, 0xffff0000, v227
 v_accvgpr_write_b32 a47, 0
 v_mfma_f32_16x16x32_bf16 v[216:219], a[200:203], a[172:175], v[216:219]
 v_add_f32 v25, v25, v28
 v_add_f32 v23, v23, v227
 v_mfma_f32_16x16x32_bf16 v[172:175], a[204:207], a[160:163], v[172:175]
 ds_read_b64_tr_b16 a[228:229], v11 offset:8192
 ds_read_b64_tr_b16 a[230:231], v11 offset:9216
 v_mfma_f32_16x16x32_bf16 v[188:191], a[204:207], a[164:167], v[188:191]
 s_mul_i32 s82, s9, 10
 v_accvgpr_write_b32 a48, 0
 v_mfma_f32_16x16x32_bf16 v[204:207], a[204:207], a[168:171], v[204:207]
 s_sub_u32 s10, s8, s82
 v_mfma_f32_16x16x32_bf16 v[220:223], a[204:207], a[172:175], v[220:223]
 s_waitcnt vmcnt(18)
 v_mfma_f32_16x16x32_bf16 v[32:35], a[208:211], a[176:179], v[32:35]
 ds_read_b64_tr_b16 a[232:233], v12 offset:8192
 s_waitcnt vmcnt(17)
 v_mfma_f32_16x16x32_bf16 v[64:67], a[208:211], a[180:183], v[64:67]
 s_add_u32 s59, s90, 10240
 s_waitcnt vmcnt(16)
 v_mfma_f32_16x16x32_bf16 v[96:99], a[208:211], a[184:187], v[96:99]
 ds_read_b64_tr_b16 a[234:235], v12 offset:9216
 s_waitcnt vmcnt(15)
 v_mfma_f32_16x16x32_bf16 v[128:131], a[208:211], a[188:191], v[128:131]
 ds_read_b64_tr_b16 v[228:229], v21 offset:4096
 ds_read_b64_tr_b16 v[230:231], v21 offset:4608
 v_mfma_f32_16x16x32_bf16 v[36:39], a[212:215], a[176:179], v[36:39]
 buffer_load_dwordx4 a[160:163], v14, s[4:7], s59 offen sc1
 v_mfma_f32_16x16x32_bf16 v[68:71], a[212:215], a[180:183], v[68:71]
 ds_read_b64_tr_b16 a[236:237], v13 offset:8192
 ds_read_b64_tr_b16 a[238:239], v13 offset:9216
 v_mfma_f32_16x16x32_bf16 v[100:103], a[212:215], a[184:187], v[100:103]
 buffer_load_dwordx4 a[164:167], v22, s[4:7], s59 offen sc1
 v_mfma_f32_16x16x32_bf16 v[132:135], a[212:215], a[188:191], v[132:135]
 s_waitcnt lgkmcnt(6)
 v_mfma_f32_16x16x32_bf16 v[40:43], a[216:219], a[176:179], v[40:43]
 ds_read_b64_tr_b16 a[240:241], v15 offset:4096
 ds_read_b64_tr_b16 a[242:243], v15 offset:4608
 v_mfma_f32_16x16x32_bf16 v[72:75], a[216:219], a[180:183], v[72:75]
 s_add_u32 s59, s91, 10240
 v_mfma_f32_16x16x32_bf16 v[104:107], a[216:219], a[184:187], v[104:107]
 buffer_store_dwordx4 v[240:243], v24, s[4:7], s57 offen offset:2304 sc1
 v_mfma_f32_16x16x32_bf16 v[136:139], a[216:219], a[188:191], v[136:139]
 v_accvgpr_write_b32 a49, 0
 v_mfma_f32_16x16x32_bf16 v[44:47], a[220:223], a[176:179], v[44:47]
 ds_read_b64_tr_b16 a[244:245], v16 offset:4096
 v_mfma_f32_16x16x32_bf16 v[76:79], a[220:223], a[180:183], v[76:79]
 buffer_load_dwordx4 a[168:171], v14, s[4:7], s59 offen sc1
 v_mfma_f32_16x16x32_bf16 v[108:111], a[220:223], a[184:187], v[108:111]
 ds_read_b64_tr_b16 a[246:247], v16 offset:4608
 v_mfma_f32_16x16x32_bf16 v[140:143], a[220:223], a[188:191], v[140:143]
 buffer_load_dwordx4 a[172:175], v22, s[4:7], s59 offen sc1
 v_mfma_f32_16x16x32_bf16 v[48:51], a[224:227], a[176:179], v[48:51]
 ds_read_b64_tr_b16 a[248:249], v17 offset:4096
 ds_read_b64_tr_b16 a[250:251], v17 offset:4608
 v_mfma_f32_16x16x32_bf16 v[80:83], a[224:227], a[180:183], v[80:83]
 s_cmp_lt_u32 s9, 128
 s_cselect_b64 s[12:13], s[40:41], s[44:45]
 v_mfma_f32_16x16x32_bf16 v[112:115], a[224:227], a[184:187], v[112:115]
 v_accvgpr_write_b32 a50, 0
 v_mfma_f32_16x16x32_bf16 v[144:147], a[224:227], a[188:191], v[144:147]
 s_cmp_lt_u32 s9, 128
 s_cselect_b32 s14, s42, s46
 v_mfma_f32_16x16x32_bf16 v[52:55], a[228:231], a[176:179], v[52:55]
 ds_read_b64_tr_b16 a[252:253], v18 offset:4096
 ds_read_b64_tr_b16 a[254:255], v18 offset:4608
 v_mfma_f32_16x16x32_bf16 v[84:87], a[228:231], a[180:183], v[84:87]
 v_accvgpr_write_b32 a51, 0
 v_mfma_f32_16x16x32_bf16 v[116:119], a[228:231], a[184:187], v[116:119]
 s_cmp_lt_u32 s9, 128
 s_cselect_b32 s11, 1, 2
 v_mfma_f32_16x16x32_bf16 v[148:151], a[228:231], a[188:191], v[148:151]
 s_and_b32 s82, s9, 127
 s_waitcnt lgkmcnt(5)
 v_mfma_f32_16x16x32_bf16 v[56:59], a[232:235], a[176:179], v[56:59]
 v_accvgpr_write_b32 a52, 0
 s_mul_i32 s21, s82, 40960
 v_mfma_f32_16x16x32_bf16 v[88:91], a[232:235], a[180:183], v[88:91]
 v_lshlrev_b32 v28, 16, v228
 v_accvgpr_write_b32 a53, 0
 v_mfma_f32_16x16x32_bf16 v[120:123], a[232:235], a[184:187], v[120:123]
 v_and_b32 v228, 0xffff0000, v228
 v_add_f32 v25, v25, v28
 v_mfma_f32_16x16x32_bf16 v[152:155], a[232:235], a[188:191], v[152:155]
 v_add_f32 v23, v23, v228
 v_mfma_f32_16x16x32_bf16 v[60:63], a[236:239], a[176:179], v[60:63]
 v_lshlrev_b32 v28, 16, v229
 s_lshl_b32 s82, s10, 7
 v_mfma_f32_16x16x32_bf16 v[92:95], a[236:239], a[180:183], v[92:95]
 v_and_b32 v229, 0xffff0000, v229
 v_mfma_f32_16x16x32_bf16 v[124:127], a[236:239], a[184:187], v[124:127]
 v_add_f32 v25, v25, v28
 v_accvgpr_write_b32 a54, 0
 v_mfma_f32_16x16x32_bf16 v[156:159], a[236:239], a[188:191], v[156:159]
 v_add_f32 v23, v23, v229
 v_mfma_f32_16x16x32_bf16 v[160:163], a[240:243], a[176:179], v[160:163]
 v_lshlrev_b32 v28, 16, v230
 v_mfma_f32_16x16x32_bf16 v[176:179], a[240:243], a[180:183], v[176:179]
 v_and_b32 v230, 0xffff0000, v230
 s_add_u32 s21, s21, s82
 v_mfma_f32_16x16x32_bf16 v[192:195], a[240:243], a[184:187], v[192:195]
 s_waitcnt lgkmcnt(0)
 s_barrier
 v_mfma_f32_16x16x32_bf16 v[208:211], a[240:243], a[188:191], v[208:211]
 ds_read_b64_tr_b16 a[192:193], v6 offset:16384
 ds_read_b64_tr_b16 a[194:195], v6 offset:17408
 v_mfma_f32_16x16x32_bf16 v[164:167], a[244:247], a[176:179], v[164:167]
 ds_read_b64_tr_b16 a[196:197], v7 offset:16384
 ds_read_b64_tr_b16 a[198:199], v7 offset:17408
 v_mfma_f32_16x16x32_bf16 v[180:183], a[244:247], a[180:183], v[180:183]
 ds_read_b64_tr_b16 a[200:201], v8 offset:16384
 ds_read_b64_tr_b16 a[202:203], v8 offset:17408
 v_mfma_f32_16x16x32_bf16 v[196:199], a[244:247], a[184:187], v[196:199]
 ds_read_b64_tr_b16 a[204:205], v9 offset:16384
 ds_read_b64_tr_b16 a[206:207], v9 offset:17408
 v_mfma_f32_16x16x32_bf16 v[212:215], a[244:247], a[188:191], v[212:215]
 s_add_u32 m0, s65, 0
 v_add_f32 v25, v25, v28
 v_mfma_f32_16x16x32_bf16 v[168:171], a[248:251], a[176:179], v[168:171]
 ds_read_b64_tr_b16 a[208:209], v10 offset:16384
 s_add_u32 s56, s87, 3145728
 v_mfma_f32_16x16x32_bf16 v[184:187], a[248:251], a[180:183], v[184:187]
 ds_read_b64_tr_b16 a[210:211], v10 offset:17408
 v_add_f32 v23, v23, v230
 v_mfma_f32_16x16x32_bf16 v[200:203], a[248:251], a[184:187], v[200:203]
 v_lshlrev_b32 v28, 16, v231
 v_accvgpr_write_b32 a55, 0
 v_mfma_f32_16x16x32_bf16 v[216:219], a[248:251], a[188:191], v[216:219]
 buffer_load_dwordx4 v2, s[28:31], s56 offen offset:0 lds
 v_mfma_f32_16x16x32_bf16 v[172:175], a[252:255], a[176:179], v[172:175]
 ds_read_b64_tr_b16 a[212:213], v11 offset:16384
 ds_read_b64_tr_b16 a[214:215], v11 offset:17408
 v_mfma_f32_16x16x32_bf16 v[188:191], a[252:255], a[180:183], v[188:191]
 v_and_b32 v231, 0xffff0000, v231
 v_add_f32 v25, v25, v28
 v_mfma_f32_16x16x32_bf16 v[204:207], a[252:255], a[184:187], v[204:207]
 buffer_load_dwordx4 v3, s[28:31], s56 offen offset:1024 lds
 v_mfma_f32_16x16x32_bf16 v[220:223], a[252:255], a[188:191], v[220:223]
 s_lshl_b32 s10, s10, 1
 s_waitcnt lgkmcnt(7) vmcnt(21)
 v_mfma_f32_16x16x32_bf16 v[32:35], a[192:195], a[128:131], v[32:35]
 ds_read_b64_tr_b16 a[216:217], v12 offset:16384
 s_waitcnt vmcnt(20)
 v_mfma_f32_16x16x32_bf16 v[64:67], a[192:195], a[132:135], v[64:67]
 ds_read_b64_tr_b16 a[218:219], v12 offset:17408
 s_waitcnt vmcnt(19)
 v_mfma_f32_16x16x32_bf16 v[96:99], a[192:195], a[136:139], v[96:99]
 v_add_f32 v23, v23, v231
 s_waitcnt vmcnt(18)
 v_mfma_f32_16x16x32_bf16 v[128:131], a[192:195], a[140:143], v[128:131]
 buffer_load_dwordx4 v4, s[28:31], s56 offen offset:2048 lds
 v_mfma_f32_16x16x32_bf16 v[36:39], a[196:199], a[128:131], v[36:39]
 ds_read_b64_tr_b16 v[224:225], v21 offset:8192
 ds_read_b64_tr_b16 v[226:227], v21 offset:8704
 v_mfma_f32_16x16x32_bf16 v[68:71], a[196:199], a[132:135], v[68:71]
 ds_read_b64_tr_b16 a[220:221], v13 offset:16384
 v_accvgpr_write_b32 a56, 0
 v_mfma_f32_16x16x32_bf16 v[100:103], a[196:199], a[136:139], v[100:103]
 buffer_load_dwordx4 v5, s[28:31], s56 offen offset:3072 lds
 v_mfma_f32_16x16x32_bf16 v[132:135], a[196:199], a[140:143], v[132:135]
 ds_read_b64_tr_b16 a[222:223], v13 offset:17408
 s_waitcnt lgkmcnt(6)
 v_mfma_f32_16x16x32_bf16 v[40:43], a[200:203], a[128:131], v[40:43]
 s_add_u32 m0, s89, 98304
 ds_read_b64_tr_b16 a[224:225], v15 offset:8192
 v_mfma_f32_16x16x32_bf16 v[72:75], a[200:203], a[132:135], v[72:75]
 ds_read_b64_tr_b16 a[226:227], v15 offset:8704
 s_mul_hi_u32 s82, s10, 858993460
 v_mfma_f32_16x16x32_bf16 v[104:107], a[200:203], a[136:139], v[104:107]
 s_add_u32 s56, s88, 1327104
 v_accvgpr_write_b32 a57, 0
 v_mfma_f32_16x16x32_bf16 v[136:139], a[200:203], a[140:143], v[136:139]
 s_mul_i32 s18, s82, 1810
 s_mul_i32 s82, s9, 10
 v_mfma_f32_16x16x32_bf16 v[44:47], a[204:207], a[128:131], v[44:47]
 ds_read_b64_tr_b16 a[228:229], v16 offset:8192
 ds_read_b64_tr_b16 a[230:231], v16 offset:8704
 v_mfma_f32_16x16x32_bf16 v[76:79], a[204:207], a[132:135], v[76:79]
 buffer_load_dwordx4 v19, s[32:35], s56 offen offset:0 lds
 v_mfma_f32_16x16x32_bf16 v[108:111], a[204:207], a[136:139], v[108:111]
 v_accvgpr_write_b32 a58, 0
 s_add_u32 s18, s18, s82
 v_mfma_f32_16x16x32_bf16 v[140:143], a[204:207], a[140:143], v[140:143]
 v_accvgpr_write_b32 a59, 0
 s_lshl_b32 s82, s10, 1
 v_mfma_f32_16x16x32_bf16 v[48:51], a[208:211], a[128:131], v[48:51]
 ds_read_b64_tr_b16 a[232:233], v17 offset:8192
 v_mfma_f32_16x16x32_bf16 v[80:83], a[208:211], a[132:135], v[80:83]
 buffer_load_dwordx4 v20, s[32:35], s56 offen offset:1024 lds
 v_mfma_f32_16x16x32_bf16 v[112:115], a[208:211], a[136:139], v[112:115]
 ds_read_b64_tr_b16 a[234:235], v17 offset:8704
 s_add_u32 s59, s90, 11264
 v_mfma_f32_16x16x32_bf16 v[144:147], a[208:211], a[140:143], v[144:147]
 buffer_store_dwordx4 v[244:247], v24, s[4:7], s58 offen offset:2304 sc1
 v_mfma_f32_16x16x32_bf16 v[52:55], a[212:215], a[128:131], v[52:55]
 ds_read_b64_tr_b16 a[236:237], v18 offset:8192
 ds_read_b64_tr_b16 a[238:239], v18 offset:8704
 v_mfma_f32_16x16x32_bf16 v[84:87], a[212:215], a[132:135], v[84:87]
 buffer_load_dwordx4 a[176:179], v14, s[4:7], s59 offen sc1
 v_mfma_f32_16x16x32_bf16 v[116:119], a[212:215], a[136:139], v[116:119]
 v_accvgpr_write_b32 a60, 0
 s_add_u32 s18, s18, s82
 v_mfma_f32_16x16x32_bf16 v[148:151], a[212:215], a[140:143], v[148:151]
 v_accvgpr_write_b32 a61, 0
 s_waitcnt lgkmcnt(4)
 v_mfma_f32_16x16x32_bf16 v[56:59], a[216:219], a[128:131], v[56:59]
 ds_read_b64_tr_b16 a[240:241], v6 offset:24576
 v_lshlrev_b32 v28, 16, v224
 v_mfma_f32_16x16x32_bf16 v[88:91], a[216:219], a[132:135], v[88:91]
 buffer_load_dwordx4 a[180:183], v22, s[4:7], s59 offen sc1
 v_mfma_f32_16x16x32_bf16 v[120:123], a[216:219], a[136:139], v[120:123]
 ds_read_b64_tr_b16 a[242:243], v6 offset:25600
 v_and_b32 v224, 0xffff0000, v224
 v_mfma_f32_16x16x32_bf16 v[152:155], a[216:219], a[140:143], v[152:155]
 s_add_u32 s59, s91, 11264
 s_lshl_b32 s18, s18, 10
 v_mfma_f32_16x16x32_bf16 v[60:63], a[220:223], a[128:131], v[60:63]
 ds_read_b64_tr_b16 a[244:245], v7 offset:24576
 ds_read_b64_tr_b16 a[246:247], v7 offset:25600
 v_mfma_f32_16x16x32_bf16 v[92:95], a[220:223], a[132:135], v[92:95]
 v_add_f32 v25, v25, v28
 v_add_f32 v23, v23, v224
 v_mfma_f32_16x16x32_bf16 v[124:127], a[220:223], a[136:139], v[124:127]
 buffer_load_dwordx4 a[184:187], v14, s[4:7], s59 offen sc1
 v_mfma_f32_16x16x32_bf16 v[156:159], a[220:223], a[140:143], v[156:159]
 v_lshlrev_b32 v28, 16, v225
 v_and_b32 v225, 0xffff0000, v225
 v_mfma_f32_16x16x32_bf16 v[160:163], a[224:227], a[128:131], v[160:163]
 ds_read_b64_tr_b16 a[248:249], v8 offset:24576
 ds_read_b64_tr_b16 a[250:251], v8 offset:25600
 v_mfma_f32_16x16x32_bf16 v[176:179], a[224:227], a[132:135], v[176:179]
 buffer_load_dwordx4 a[188:191], v22, s[4:7], s59 offen sc1
 v_mfma_f32_16x16x32_bf16 v[192:195], a[224:227], a[136:139], v[192:195]
 v_accvgpr_write_b32 a62, 0
 v_add_f32 v25, v25, v28
 v_mfma_f32_16x16x32_bf16 v[208:211], a[224:227], a[140:143], v[208:211]
 s_add_u32 s18, s18, 63963136
 v_add_f32 v23, v23, v225
 v_mfma_f32_16x16x32_bf16 v[164:167], a[228:231], a[128:131], v[164:167]
 ds_read_b64_tr_b16 a[252:253], v9 offset:24576
 ds_read_b64_tr_b16 a[254:255], v9 offset:25600
 v_mfma_f32_16x16x32_bf16 v[180:183], a[228:231], a[132:135], v[180:183]
 v_lshlrev_b32 v28, 16, v226
 v_and_b32 v226, 0xffff0000, v226
 v_mfma_f32_16x16x32_bf16 v[196:199], a[228:231], a[136:139], v[196:199]
 v_add_f32 v25, v25, v28
 v_add_f32 v23, v23, v226
 v_mfma_f32_16x16x32_bf16 v[212:215], a[228:231], a[140:143], v[212:215]
 v_accvgpr_write_b32 a63, 0
 s_waitcnt lgkmcnt(4)
 v_mfma_f32_16x16x32_bf16 v[168:171], a[232:235], a[128:131], v[168:171]
 ds_read_b64_tr_b16 a[192:193], v10 offset:24576
 ds_read_b64_tr_b16 a[194:195], v10 offset:25600
 v_mfma_f32_16x16x32_bf16 v[184:187], a[232:235], a[132:135], v[184:187]
 s_add_u32 s10, s10, 1
 v_lshlrev_b32 v28, 16, v227
 v_mfma_f32_16x16x32_bf16 v[200:203], a[232:235], a[136:139], v[200:203]
 v_and_b32 v227, 0xffff0000, v227
 v_add_f32 v25, v25, v28
 v_mfma_f32_16x16x32_bf16 v[216:219], a[232:235], a[140:143], v[216:219]
 v_add_f32 v23, v23, v227
 v_mfma_f32_16x16x32_bf16 v[172:175], a[236:239], a[128:131], v[172:175]
 ds_read_b64_tr_b16 a[196:197], v11 offset:24576
 ds_read_b64_tr_b16 a[198:199], v11 offset:25600
 v_mfma_f32_16x16x32_bf16 v[188:191], a[236:239], a[132:135], v[188:191]
 s_cmp_lt_u32 s8, 1820
 s_cselect_b32 s18, s18, 268435456
 v_mfma_f32_16x16x32_bf16 v[204:207], a[236:239], a[136:139], v[204:207]
 v_accvgpr_write_b32 a64, 0
 s_mul_hi_u32 s82, s10, 858993460
 v_mfma_f32_16x16x32_bf16 v[220:223], a[236:239], a[140:143], v[220:223]
 v_accvgpr_write_b32 a65, 0
 s_waitcnt vmcnt(19)
 v_mfma_f32_16x16x32_bf16 v[32:35], a[240:243], a[144:147], v[32:35]
 ds_read_b64_tr_b16 a[200:201], v12 offset:24576
 s_waitcnt vmcnt(18)
 v_mfma_f32_16x16x32_bf16 v[64:67], a[240:243], a[148:151], v[64:67]
 s_add_u32 s59, s90, 12288
 s_waitcnt vmcnt(17)
 v_mfma_f32_16x16x32_bf16 v[96:99], a[240:243], a[152:155], v[96:99]
 ds_read_b64_tr_b16 a[202:203], v12 offset:25600
 s_waitcnt vmcnt(16)
 v_mfma_f32_16x16x32_bf16 v[128:131], a[240:243], a[156:159], v[128:131]
 ds_read_b64_tr_b16 v[228:229], v21 offset:12288
 ds_read_b64_tr_b16 v[230:231], v21 offset:12800
 v_mfma_f32_16x16x32_bf16 v[36:39], a[244:247], a[144:147], v[36:39]
 buffer_load_dwordx4 a[128:131], v14, s[4:7], s59 offen sc1
 v_mfma_f32_16x16x32_bf16 v[68:71], a[244:247], a[148:151], v[68:71]
 ds_read_b64_tr_b16 a[204:205], v13 offset:24576
 ds_read_b64_tr_b16 a[206:207], v13 offset:25600
 v_mfma_f32_16x16x32_bf16 v[100:103], a[244:247], a[152:155], v[100:103]
 buffer_load_dwordx4 a[132:135], v22, s[4:7], s59 offen sc1
 v_mfma_f32_16x16x32_bf16 v[132:135], a[244:247], a[156:159], v[132:135]
 s_mul_i32 s19, s82, 1810
 s_waitcnt lgkmcnt(6)
 v_mfma_f32_16x16x32_bf16 v[40:43], a[248:251], a[144:147], v[40:43]
 ds_read_b64_tr_b16 a[208:209], v15 offset:12288
 ds_read_b64_tr_b16 a[210:211], v15 offset:12800
 v_mfma_f32_16x16x32_bf16 v[72:75], a[248:251], a[148:151], v[72:75]
 s_add_u32 s59, s91, 12288
 v_accvgpr_write_b32 a66, 0
 v_mfma_f32_16x16x32_bf16 v[104:107], a[248:251], a[152:155], v[104:107]
 s_mul_i32 s82, s9, 10
 v_accvgpr_write_b32 a67, 0
 v_mfma_f32_16x16x32_bf16 v[136:139], a[248:251], a[156:159], v[136:139]
 v_mfma_f32_16x16x32_bf16 v[44:47], a[252:255], a[144:147], v[44:47]
 ds_read_b64_tr_b16 a[212:213], v16 offset:12288
 s_add_u32 s19, s19, s82
 v_mfma_f32_16x16x32_bf16 v[76:79], a[252:255], a[148:151], v[76:79]
 buffer_load_dwordx4 a[136:139], v14, s[4:7], s59 offen sc1
 v_mfma_f32_16x16x32_bf16 v[108:111], a[252:255], a[152:155], v[108:111]
 ds_read_b64_tr_b16 a[214:215], v16 offset:12800
 v_mfma_f32_16x16x32_bf16 v[140:143], a[252:255], a[156:159], v[140:143]
 buffer_load_dwordx4 a[140:143], v22, s[4:7], s59 offen sc1
 v_mfma_f32_16x16x32_bf16 v[48:51], a[192:195], a[144:147], v[48:51]
 ds_read_b64_tr_b16 a[216:217], v17 offset:12288
 ds_read_b64_tr_b16 a[218:219], v17 offset:12800
 v_mfma_f32_16x16x32_bf16 v[80:83], a[192:195], a[148:151], v[80:83]
 v_accvgpr_write_b32 a68, 0
 s_lshl_b32 s82, s10, 1
 v_mfma_f32_16x16x32_bf16 v[112:115], a[192:195], a[152:155], v[112:115]
 v_mfma_f32_16x16x32_bf16 v[144:147], a[192:195], a[156:159], v[144:147]
 v_mfma_f32_16x16x32_bf16 v[52:55], a[196:199], a[144:147], v[52:55]
 ds_read_b64_tr_b16 a[220:221], v18 offset:12288
 ds_read_b64_tr_b16 a[222:223], v18 offset:12800
 v_mfma_f32_16x16x32_bf16 v[84:87], a[196:199], a[148:151], v[84:87]
 v_mfma_f32_16x16x32_bf16 v[116:119], a[196:199], a[152:155], v[116:119]
 v_accvgpr_write_b32 a69, 0
 s_add_u32 s19, s19, s82
 v_mfma_f32_16x16x32_bf16 v[148:151], a[196:199], a[156:159], v[148:151]
 s_waitcnt lgkmcnt(5)
 v_mfma_f32_16x16x32_bf16 v[56:59], a[200:203], a[144:147], v[56:59]
 v_lshlrev_b32 v28, 16, v228
 v_mfma_f32_16x16x32_bf16 v[88:91], a[200:203], a[148:151], v[88:91]
 v_and_b32 v228, 0xffff0000, v228
 v_mfma_f32_16x16x32_bf16 v[120:123], a[200:203], a[152:155], v[120:123]
 v_add_f32 v25, v25, v28
 v_mfma_f32_16x16x32_bf16 v[152:155], a[200:203], a[156:159], v[152:155]
 v_add_f32 v23, v23, v228
 s_lshl_b32 s19, s19, 10
 v_mfma_f32_16x16x32_bf16 v[60:63], a[204:207], a[144:147], v[60:63]
 v_lshlrev_b32 v28, 16, v229
 v_accvgpr_write_b32 a70, 0
 v_mfma_f32_16x16x32_bf16 v[92:95], a[204:207], a[148:151], v[92:95]
 v_and_b32 v229, 0xffff0000, v229
 v_mfma_f32_16x16x32_bf16 v[124:127], a[204:207], a[152:155], v[124:127]
 v_add_f32 v25, v25, v28
 v_mfma_f32_16x16x32_bf16 v[156:159], a[204:207], a[156:159], v[156:159]
 v_add_f32 v23, v23, v229
 v_mfma_f32_16x16x32_bf16 v[160:163], a[208:211], a[144:147], v[160:163]
 v_lshlrev_b32 v28, 16, v230
 s_add_u32 s19, s19, 63963136
 v_mfma_f32_16x16x32_bf16 v[176:179], a[208:211], a[148:151], v[176:179]
 v_and_b32 v230, 0xffff0000, v230
 v_mfma_f32_16x16x32_bf16 v[192:195], a[208:211], a[152:155], v[192:195]
 s_waitcnt lgkmcnt(0)
 s_barrier
 v_mfma_f32_16x16x32_bf16 v[208:211], a[208:211], a[156:159], v[208:211]
 ds_read_b64_tr_b16 a[224:225], v6 offset:32768
 ds_read_b64_tr_b16 a[226:227], v6 offset:33792
 v_mfma_f32_16x16x32_bf16 v[164:167], a[212:215], a[144:147], v[164:167]
 ds_read_b64_tr_b16 a[228:229], v7 offset:32768
 ds_read_b64_tr_b16 a[230:231], v7 offset:33792
 v_mfma_f32_16x16x32_bf16 v[180:183], a[212:215], a[148:151], v[180:183]
 ds_read_b64_tr_b16 a[232:233], v8 offset:32768
 ds_read_b64_tr_b16 a[234:235], v8 offset:33792
 v_mfma_f32_16x16x32_bf16 v[196:199], a[212:215], a[152:155], v[196:199]
 ds_read_b64_tr_b16 a[236:237], v9 offset:32768
 ds_read_b64_tr_b16 a[238:239], v9 offset:33792
 v_mfma_f32_16x16x32_bf16 v[212:215], a[212:215], a[156:159], v[212:215]
 s_add_u32 m0, s65, 16384
 v_add_f32 v25, v25, v28
 v_mfma_f32_16x16x32_bf16 v[168:171], a[216:219], a[144:147], v[168:171]
 ds_read_b64_tr_b16 a[240:241], v10 offset:32768
 s_add_u32 s56, s87, 3670016
 v_mfma_f32_16x16x32_bf16 v[184:187], a[216:219], a[148:151], v[184:187]
 ds_read_b64_tr_b16 a[242:243], v10 offset:33792
 v_accvgpr_write_b32 a71, 0
 v_mfma_f32_16x16x32_bf16 v[200:203], a[216:219], a[152:155], v[200:203]
 v_add_f32 v23, v23, v230
 v_lshlrev_b32 v28, 16, v231
 v_mfma_f32_16x16x32_bf16 v[216:219], a[216:219], a[156:159], v[216:219]
 buffer_load_dwordx4 v2, s[28:31], s56 offen offset:0 lds
 v_mfma_f32_16x16x32_bf16 v[172:175], a[220:223], a[144:147], v[172:175]
 ds_read_b64_tr_b16 a[244:245], v11 offset:32768
 ds_read_b64_tr_b16 a[246:247], v11 offset:33792
 v_mfma_f32_16x16x32_bf16 v[188:191], a[220:223], a[148:151], v[188:191]
 v_and_b32 v231, 0xffff0000, v231
 s_add_u32 s10, s10, 1
 v_mfma_f32_16x16x32_bf16 v[204:207], a[220:223], a[152:155], v[204:207]
 buffer_load_dwordx4 v3, s[28:31], s56 offen offset:1024 lds
 v_mfma_f32_16x16x32_bf16 v[220:223], a[220:223], a[156:159], v[220:223]
 v_add_f32 v25, v25, v28
 s_waitcnt lgkmcnt(7) vmcnt(21)
 v_mfma_f32_16x16x32_bf16 v[32:35], a[224:227], a[160:163], v[32:35]
 ds_read_b64_tr_b16 a[248:249], v12 offset:32768
 s_waitcnt vmcnt(20)
 v_mfma_f32_16x16x32_bf16 v[64:67], a[224:227], a[164:167], v[64:67]
 ds_read_b64_tr_b16 a[250:251], v12 offset:33792
 s_waitcnt vmcnt(18)
 v_mfma_f32_16x16x32_bf16 v[96:99], a[224:227], a[168:171], v[96:99]
 v_add_f32 v23, v23, v231
 s_waitcnt vmcnt(17)
 v_mfma_f32_16x16x32_bf16 v[128:131], a[224:227], a[172:175], v[128:131]
 buffer_load_dwordx4 v4, s[28:31], s56 offen offset:2048 lds
 v_mfma_f32_16x16x32_bf16 v[36:39], a[228:231], a[160:163], v[36:39]
 ds_read_b64_tr_b16 v[224:225], v21 offset:16384
 ds_read_b64_tr_b16 v[226:227], v21 offset:16896
 v_mfma_f32_16x16x32_bf16 v[68:71], a[228:231], a[164:167], v[68:71]
 ds_read_b64_tr_b16 a[252:253], v13 offset:32768
 v_accvgpr_write_b32 a72, 0
 v_mfma_f32_16x16x32_bf16 v[100:103], a[228:231], a[168:171], v[100:103]
 buffer_load_dwordx4 v5, s[28:31], s56 offen offset:3072 lds
 v_mfma_f32_16x16x32_bf16 v[132:135], a[228:231], a[172:175], v[132:135]
 ds_read_b64_tr_b16 a[254:255], v13 offset:33792
 s_waitcnt lgkmcnt(6)
 v_mfma_f32_16x16x32_bf16 v[40:43], a[232:235], a[160:163], v[40:43]
 s_add_u32 m0, s89, 106496
 ds_read_b64_tr_b16 a[192:193], v15 offset:16384
 v_mfma_f32_16x16x32_bf16 v[72:75], a[232:235], a[164:167], v[72:75]
 ds_read_b64_tr_b16 a[194:195], v15 offset:16896
 v_mfma_f32_16x16x32_bf16 v[104:107], a[232:235], a[168:171], v[104:107]
 s_add_u32 s56, s88, 1548288
 v_mfma_f32_16x16x32_bf16 v[136:139], a[232:235], a[172:175], v[136:139]
 s_cmp_lt_u32 s8, 1820
 s_cselect_b32 s19, s19, 268435456
 v_mfma_f32_16x16x32_bf16 v[44:47], a[236:239], a[160:163], v[44:47]
 ds_read_b64_tr_b16 a[196:197], v16 offset:16384
 ds_read_b64_tr_b16 a[198:199], v16 offset:16896
 v_mfma_f32_16x16x32_bf16 v[76:79], a[236:239], a[164:167], v[76:79]
 buffer_load_dwordx4 v19, s[32:35], s56 offen offset:0 lds
 v_mfma_f32_16x16x32_bf16 v[108:111], a[236:239], a[168:171], v[108:111]
 v_accvgpr_write_b32 a73, 0
 v_bfe_u32 v250, v0, 2, 4
 v_mfma_f32_16x16x32_bf16 v[140:143], a[236:239], a[172:175], v[140:143]
 v_accvgpr_write_b32 a74, 0
 v_and_b32 v29, 3, v0
 v_mfma_f32_16x16x32_bf16 v[48:51], a[240:243], a[160:163], v[48:51]
 ds_read_b64_tr_b16 a[200:201], v17 offset:16384
 v_accvgpr_write_b32 a75, 0
 v_mfma_f32_16x16x32_bf16 v[80:83], a[240:243], a[164:167], v[80:83]
 buffer_load_dwordx4 v20, s[32:35], s56 offen offset:1024 lds
 v_mfma_f32_16x16x32_bf16 v[112:115], a[240:243], a[168:171], v[112:115]
 ds_read_b64_tr_b16 a[202:203], v17 offset:16896
 s_add_u32 s59, s90, 13312
 v_mfma_f32_16x16x32_bf16 v[144:147], a[240:243], a[172:175], v[144:147]
 v_lshlrev_b32 v29, 3, v29
 v_lshl_add_u32 v250, v250, 7, v29
 v_mfma_f32_16x16x32_bf16 v[52:55], a[244:247], a[160:163], v[52:55]
 ds_read_b64_tr_b16 a[204:205], v18 offset:16384
 ds_read_b64_tr_b16 a[206:207], v18 offset:16896
 v_mfma_f32_16x16x32_bf16 v[84:87], a[244:247], a[164:167], v[84:87]
 buffer_load_dwordx4 a[144:147], v14, s[4:7], s59 offen sc1
 v_mfma_f32_16x16x32_bf16 v[116:119], a[244:247], a[168:171], v[116:119]
 v_accvgpr_write_b32 a76, 0
 s_add_u32 s82, s64, 131072
 v_mfma_f32_16x16x32_bf16 v[148:151], a[244:247], a[172:175], v[148:151]
 v_accvgpr_write_b32 a77, 0
 s_waitcnt lgkmcnt(4)
 v_mfma_f32_16x16x32_bf16 v[56:59], a[248:251], a[160:163], v[56:59]
 ds_read_b64_tr_b16 a[208:209], v6 offset:40960
 v_lshlrev_b32 v28, 16, v224
 v_mfma_f32_16x16x32_bf16 v[88:91], a[248:251], a[164:167], v[88:91]
 buffer_load_dwordx4 a[148:151], v22, s[4:7], s59 offen sc1
 v_mfma_f32_16x16x32_bf16 v[120:123], a[248:251], a[168:171], v[120:123]
 ds_read_b64_tr_b16 a[210:211], v6 offset:41984
 v_add_u32 v250, s82, v250
 v_mfma_f32_16x16x32_bf16 v[152:155], a[248:251], a[172:175], v[152:155]
 s_add_u32 s59, s91, 13312
 v_and_b32 v224, 0xffff0000, v224
 v_mfma_f32_16x16x32_bf16 v[60:63], a[252:255], a[160:163], v[60:63]
 ds_read_b64_tr_b16 a[212:213], v7 offset:40960
 ds_read_b64_tr_b16 a[214:215], v7 offset:41984
 v_mfma_f32_16x16x32_bf16 v[92:95], a[252:255], a[164:167], v[92:95]
 v_add_f32 v25, v25, v28
 v_add_f32 v23, v23, v224
 v_mfma_f32_16x16x32_bf16 v[124:127], a[252:255], a[168:171], v[124:127]
 buffer_load_dwordx4 a[152:155], v14, s[4:7], s59 offen sc1
 v_mfma_f32_16x16x32_bf16 v[156:159], a[252:255], a[172:175], v[156:159]
 v_accvgpr_write_b32 a78, 0
 v_lshlrev_b32 v28, 16, v225
 v_mfma_f32_16x16x32_bf16 v[160:163], a[192:195], a[160:163], v[160:163]
 ds_read_b64_tr_b16 a[216:217], v8 offset:40960
 ds_read_b64_tr_b16 a[218:219], v8 offset:41984
 v_mfma_f32_16x16x32_bf16 v[176:179], a[192:195], a[164:167], v[176:179]
 buffer_load_dwordx4 a[156:159], v22, s[4:7], s59 offen sc1
 v_mfma_f32_16x16x32_bf16 v[192:195], a[192:195], a[168:171], v[192:195]
 v_and_b32 v225, 0xffff0000, v225
 v_lshrrev_b32 v29, 5, v0
 v_mfma_f32_16x16x32_bf16 v[208:211], a[192:195], a[172:175], v[208:211]
 v_add_f32 v25, v25, v28
 v_add_f32 v23, v23, v225
 v_mfma_f32_16x16x32_bf16 v[164:167], a[196:199], a[160:163], v[164:167]
 ds_read_b64_tr_b16 a[220:221], v9 offset:40960
 ds_read_b64_tr_b16 a[222:223], v9 offset:41984
 v_mfma_f32_16x16x32_bf16 v[180:183], a[196:199], a[164:167], v[180:183]
 v_lshlrev_b32 v28, 16, v226
 v_accvgpr_write_b32 a79, 0
 v_mfma_f32_16x16x32_bf16 v[196:199], a[196:199], a[168:171], v[196:199]
 v_and_b32 v226, 0xffff0000, v226
 v_add_f32 v25, v25, v28
 v_mfma_f32_16x16x32_bf16 v[212:215], a[196:199], a[172:175], v[212:215]
 v_lshl_add_u32 v249, v29, 10, v250
 s_waitcnt lgkmcnt(4)
 v_mfma_f32_16x16x32_bf16 v[168:171], a[200:203], a[160:163], v[168:171]
 ds_read_b64_tr_b16 a[224:225], v10 offset:40960
 ds_read_b64_tr_b16 a[226:227], v10 offset:41984
 v_mfma_f32_16x16x32_bf16 v[184:187], a[200:203], a[164:167], v[184:187]
 v_add_f32 v23, v23, v226
 v_lshlrev_b32 v28, 16, v227
 v_mfma_f32_16x16x32_bf16 v[200:203], a[200:203], a[168:171], v[200:203]
 v_and_b32 v227, 0xffff0000, v227
 v_add_f32 v25, v25, v28
 v_mfma_f32_16x16x32_bf16 v[216:219], a[200:203], a[172:175], v[216:219]
 v_accvgpr_write_b32 a80, 0
 v_add_f32 v23, v23, v227
 v_mfma_f32_16x16x32_bf16 v[172:175], a[204:207], a[160:163], v[172:175]
 ds_read_b64_tr_b16 a[228:229], v11 offset:40960
 ds_read_b64_tr_b16 a[230:231], v11 offset:41984
 v_mfma_f32_16x16x32_bf16 v[188:191], a[204:207], a[164:167], v[188:191]
 v_accvgpr_write_b32 a81, 0
 v_mfma_f32_16x16x32_bf16 v[204:207], a[204:207], a[168:171], v[204:207]
 v_mfma_f32_16x16x32_bf16 v[220:223], a[204:207], a[172:175], v[220:223]
 s_waitcnt vmcnt(17)
 v_mfma_f32_16x16x32_bf16 v[32:35], a[208:211], a[176:179], v[32:35]
 ds_read_b64_tr_b16 a[232:233], v12 offset:40960
 s_waitcnt vmcnt(16)
 v_mfma_f32_16x16x32_bf16 v[64:67], a[208:211], a[180:183], v[64:67]
 s_add_u32 s59, s90, 14336
 s_waitcnt vmcnt(15)
 v_mfma_f32_16x16x32_bf16 v[96:99], a[208:211], a[184:187], v[96:99]
 ds_read_b64_tr_b16 a[234:235], v12 offset:41984
 s_waitcnt vmcnt(14)
 v_mfma_f32_16x16x32_bf16 v[128:131], a[208:211], a[188:191], v[128:131]
 ds_read_b64_tr_b16 v[228:229], v21 offset:20480
 ds_read_b64_tr_b16 v[230:231], v21 offset:20992
 v_mfma_f32_16x16x32_bf16 v[36:39], a[212:215], a[176:179], v[36:39]
 buffer_load_dwordx4 a[160:163], v14, s[4:7], s59 offen sc1
 v_mfma_f32_16x16x32_bf16 v[68:71], a[212:215], a[180:183], v[68:71]
 ds_read_b64_tr_b16 a[236:237], v13 offset:40960
 ds_read_b64_tr_b16 a[238:239], v13 offset:41984
 v_mfma_f32_16x16x32_bf16 v[100:103], a[212:215], a[184:187], v[100:103]
 buffer_load_dwordx4 a[164:167], v22, s[4:7], s59 offen sc1
 v_mfma_f32_16x16x32_bf16 v[132:135], a[212:215], a[188:191], v[132:135]
 v_accvgpr_write_b32 a82, 0
 s_waitcnt lgkmcnt(6)
 v_mfma_f32_16x16x32_bf16 v[40:43], a[216:219], a[176:179], v[40:43]
 ds_read_b64_tr_b16 a[240:241], v15 offset:20480
 ds_read_b64_tr_b16 a[242:243], v15 offset:20992
 v_mfma_f32_16x16x32_bf16 v[72:75], a[216:219], a[180:183], v[72:75]
 s_add_u32 s59, s91, 14336
 v_accvgpr_write_b32 a83, 0
 v_mfma_f32_16x16x32_bf16 v[104:107], a[216:219], a[184:187], v[104:107]
 v_mfma_f32_16x16x32_bf16 v[136:139], a[216:219], a[188:191], v[136:139]
 v_mfma_f32_16x16x32_bf16 v[44:47], a[220:223], a[176:179], v[44:47]
 ds_read_b64_tr_b16 a[244:245], v16 offset:20480
 v_mfma_f32_16x16x32_bf16 v[76:79], a[220:223], a[180:183], v[76:79]
 buffer_load_dwordx4 a[168:171], v14, s[4:7], s59 offen sc1
 v_mfma_f32_16x16x32_bf16 v[108:111], a[220:223], a[184:187], v[108:111]
 ds_read_b64_tr_b16 a[246:247], v16 offset:20992
 v_accvgpr_write_b32 a84, 0
 v_mfma_f32_16x16x32_bf16 v[140:143], a[220:223], a[188:191], v[140:143]
 buffer_load_dwordx4 a[172:175], v22, s[4:7], s59 offen sc1
 v_mfma_f32_16x16x32_bf16 v[48:51], a[224:227], a[176:179], v[48:51]
 ds_read_b64_tr_b16 a[248:249], v17 offset:20480
 ds_read_b64_tr_b16 a[250:251], v17 offset:20992
 v_mfma_f32_16x16x32_bf16 v[80:83], a[224:227], a[180:183], v[80:83]
 v_mfma_f32_16x16x32_bf16 v[112:115], a[224:227], a[184:187], v[112:115]
 v_mfma_f32_16x16x32_bf16 v[144:147], a[224:227], a[188:191], v[144:147]
 s_add_u32 m0, s64, 131072
 v_mfma_f32_16x16x32_bf16 v[52:55], a[228:231], a[176:179], v[52:55]
 ds_read_b64_tr_b16 a[252:253], v18 offset:20480
 ds_read_b64_tr_b16 a[254:255], v18 offset:20992
 v_mfma_f32_16x16x32_bf16 v[84:87], a[228:231], a[180:183], v[84:87]
 s_add_u32 s56, s20, 0
 v_accvgpr_write_b32 a85, 0
 v_mfma_f32_16x16x32_bf16 v[116:119], a[228:231], a[184:187], v[116:119]
 buffer_load_dwordx4 v248, s[40:43], s56 offen offset:0 lds
 v_mfma_f32_16x16x32_bf16 v[148:151], a[228:231], a[188:191], v[148:151]
 s_add_u32 s56, s20, 9216
 s_waitcnt lgkmcnt(5)
 v_mfma_f32_16x16x32_bf16 v[56:59], a[232:235], a[176:179], v[56:59]
 v_lshlrev_b32 v28, 16, v228
 v_mfma_f32_16x16x32_bf16 v[88:91], a[232:235], a[180:183], v[88:91]
 buffer_load_dwordx4 v248, s[40:43], s56 offen offset:1024 lds
 v_mfma_f32_16x16x32_bf16 v[120:123], a[232:235], a[184:187], v[120:123]
 s_add_u32 s56, s20, 18432
 v_and_b32 v228, 0xffff0000, v228
 v_mfma_f32_16x16x32_bf16 v[152:155], a[232:235], a[188:191], v[152:155]
 v_accvgpr_write_b32 a86, 0
 v_add_f32 v25, v25, v28
 v_mfma_f32_16x16x32_bf16 v[60:63], a[236:239], a[176:179], v[60:63]
 buffer_load_dwordx4 v248, s[40:43], s56 offen offset:2048 lds
 v_mfma_f32_16x16x32_bf16 v[92:95], a[236:239], a[180:183], v[92:95]
 s_add_u32 s56, s20, 27648
 v_add_f32 v23, v23, v228
 v_mfma_f32_16x16x32_bf16 v[124:127], a[236:239], a[184:187], v[124:127]
 v_lshlrev_b32 v28, 16, v229
 v_and_b32 v229, 0xffff0000, v229
 v_mfma_f32_16x16x32_bf16 v[156:159], a[236:239], a[188:191], v[156:159]
 buffer_load_dwordx4 v248, s[40:43], s56 offen offset:3072 lds
 v_mfma_f32_16x16x32_bf16 v[160:163], a[240:243], a[176:179], v[160:163]
 v_add_f32 v25, v25, v28
 v_add_f32 v23, v23, v229
 v_mfma_f32_16x16x32_bf16 v[176:179], a[240:243], a[180:183], v[176:179]
 v_accvgpr_write_b32 a87, 0
 v_lshlrev_b32 v28, 16, v230
 v_mfma_f32_16x16x32_bf16 v[192:195], a[240:243], a[184:187], v[192:195]
 s_waitcnt lgkmcnt(0)
 s_barrier
 buffer_store_dword v27, v26, s[4:7], s80 offen sc1
 v_mfma_f32_16x16x32_bf16 v[208:211], a[240:243], a[188:191], v[208:211]
 ds_read_b64_tr_b16 a[192:193], v6 offset:0
 ds_read_b64_tr_b16 a[194:195], v6 offset:1024
 v_mfma_f32_16x16x32_bf16 v[164:167], a[244:247], a[176:179], v[164:167]
 ds_read_b64_tr_b16 a[196:197], v7 offset:0
 ds_read_b64_tr_b16 a[198:199], v7 offset:1024
 v_mfma_f32_16x16x32_bf16 v[180:183], a[244:247], a[180:183], v[180:183]
 ds_read_b64_tr_b16 a[200:201], v8 offset:0
 ds_read_b64_tr_b16 a[202:203], v8 offset:1024
 v_mfma_f32_16x16x32_bf16 v[196:199], a[244:247], a[184:187], v[196:199]
 ds_read_b64_tr_b16 a[204:205], v9 offset:0
 ds_read_b64_tr_b16 a[206:207], v9 offset:1024
 v_mfma_f32_16x16x32_bf16 v[212:215], a[244:247], a[188:191], v[212:215]
 s_add_u32 m0, s65, 32768
 v_and_b32 v230, 0xffff0000, v230
 v_mfma_f32_16x16x32_bf16 v[168:171], a[248:251], a[176:179], v[168:171]
 ds_read_b64_tr_b16 a[208:209], v10 offset:0
 s_add_u32 s56, s87, 4194304
 v_mfma_f32_16x16x32_bf16 v[184:187], a[248:251], a[180:183], v[184:187]
 ds_read_b64_tr_b16 a[210:211], v10 offset:1024
 v_add_f32 v25, v25, v28
 v_mfma_f32_16x16x32_bf16 v[200:203], a[248:251], a[184:187], v[200:203]
 v_add_f32 v23, v23, v230
 v_lshlrev_b32 v28, 16, v231
 v_mfma_f32_16x16x32_bf16 v[216:219], a[248:251], a[188:191], v[216:219]
 buffer_load_dwordx4 v2, s[28:31], s56 offen offset:0 lds
 v_mfma_f32_16x16x32_bf16 v[172:175], a[252:255], a[176:179], v[172:175]
 ds_read_b64_tr_b16 a[212:213], v11 offset:0
 ds_read_b64_tr_b16 a[214:215], v11 offset:1024
 v_mfma_f32_16x16x32_bf16 v[188:191], a[252:255], a[180:183], v[188:191]
 v_and_b32 v231, 0xffff0000, v231
 v_accvgpr_write_b32 a88, 0
 v_mfma_f32_16x16x32_bf16 v[204:207], a[252:255], a[184:187], v[204:207]
 buffer_load_dwordx4 v3, s[28:31], s56 offen offset:1024 lds
 v_mfma_f32_16x16x32_bf16 v[220:223], a[252:255], a[188:191], v[220:223]
 v_add_f32 v25, v25, v28
 s_waitcnt lgkmcnt(7) vmcnt(24)
 v_mfma_f32_16x16x32_bf16 v[32:35], a[192:195], a[128:131], v[32:35]
 ds_read_b64_tr_b16 a[216:217], v12 offset:0
 s_waitcnt vmcnt(23)
 v_mfma_f32_16x16x32_bf16 v[64:67], a[192:195], a[132:135], v[64:67]
 ds_read_b64_tr_b16 a[218:219], v12 offset:1024
 s_waitcnt vmcnt(22)
 v_mfma_f32_16x16x32_bf16 v[96:99], a[192:195], a[136:139], v[96:99]
 v_add_f32 v23, v23, v231
 s_waitcnt vmcnt(21)
 v_mfma_f32_16x16x32_bf16 v[128:131], a[192:195], a[140:143], v[128:131]
 buffer_load_dwordx4 v4, s[28:31], s56 offen offset:2048 lds
 v_mfma_f32_16x16x32_bf16 v[36:39], a[196:199], a[128:131], v[36:39]
 ds_read_b64_tr_b16 v[224:225], v21 offset:0
 ds_read_b64_tr_b16 v[226:227], v21 offset:512
 v_mfma_f32_16x16x32_bf16 v[68:71], a[196:199], a[132:135], v[68:71]
 ds_read_b64_tr_b16 a[220:221], v13 offset:0
 v_accvgpr_write_b32 a89, 0
 v_mfma_f32_16x16x32_bf16 v[100:103], a[196:199], a[136:139], v[100:103]
 buffer_load_dwordx4 v5, s[28:31], s56 offen offset:3072 lds
 v_mfma_f32_16x16x32_bf16 v[132:135], a[196:199], a[140:143], v[132:135]
 ds_read_b64_tr_b16 a[222:223], v13 offset:1024
 s_waitcnt lgkmcnt(6)
 v_mfma_f32_16x16x32_bf16 v[40:43], a[200:203], a[128:131], v[40:43]
 s_add_u32 m0, s89, 114688
 ds_read_b64_tr_b16 a[224:225], v15 offset:0
 v_mfma_f32_16x16x32_bf16 v[72:75], a[200:203], a[132:135], v[72:75]
 ds_read_b64_tr_b16 a[226:227], v15 offset:512
 v_accvgpr_write_b32 a90, 0
 v_mfma_f32_16x16x32_bf16 v[104:107], a[200:203], a[136:139], v[104:107]
 s_add_u32 s56, s88, 1769472
 v_accvgpr_write_b32 a91, 0
 v_mfma_f32_16x16x32_bf16 v[136:139], a[200:203], a[140:143], v[136:139]
 v_mfma_f32_16x16x32_bf16 v[44:47], a[204:207], a[128:131], v[44:47]
 ds_read_b64_tr_b16 a[228:229], v16 offset:0
 ds_read_b64_tr_b16 a[230:231], v16 offset:512
 v_mfma_f32_16x16x32_bf16 v[76:79], a[204:207], a[132:135], v[76:79]
 buffer_load_dwordx4 v19, s[32:35], s56 offen offset:0 lds
 v_mfma_f32_16x16x32_bf16 v[108:111], a[204:207], a[136:139], v[108:111]
 v_accvgpr_write_b32 a92, 0
 v_mfma_f32_16x16x32_bf16 v[140:143], a[204:207], a[140:143], v[140:143]
 v_mfma_f32_16x16x32_bf16 v[48:51], a[208:211], a[128:131], v[48:51]
 ds_read_b64_tr_b16 a[232:233], v17 offset:0
 v_mfma_f32_16x16x32_bf16 v[80:83], a[208:211], a[132:135], v[80:83]
 buffer_load_dwordx4 v20, s[32:35], s56 offen offset:1024 lds
 v_mfma_f32_16x16x32_bf16 v[112:115], a[208:211], a[136:139], v[112:115]
 ds_read_b64_tr_b16 a[234:235], v17 offset:512
 s_add_u32 s59, s90, 15360
 v_mfma_f32_16x16x32_bf16 v[144:147], a[208:211], a[140:143], v[144:147]
 v_accvgpr_write_b32 a93, 0
 v_mfma_f32_16x16x32_bf16 v[52:55], a[212:215], a[128:131], v[52:55]
 ds_read_b64_tr_b16 a[236:237], v18 offset:0
 ds_read_b64_tr_b16 a[238:239], v18 offset:512
 v_mfma_f32_16x16x32_bf16 v[84:87], a[212:215], a[132:135], v[84:87]
 buffer_load_dwordx4 a[176:179], v14, s[4:7], s59 offen sc1
 v_mfma_f32_16x16x32_bf16 v[116:119], a[212:215], a[136:139], v[116:119]
 v_mfma_f32_16x16x32_bf16 v[148:151], a[212:215], a[140:143], v[148:151]
 s_waitcnt lgkmcnt(4)
 v_mfma_f32_16x16x32_bf16 v[56:59], a[216:219], a[128:131], v[56:59]
 ds_read_b64_tr_b16 a[240:241], v6 offset:8192
 v_lshlrev_b32 v28, 16, v224
 v_mfma_f32_16x16x32_bf16 v[88:91], a[216:219], a[132:135], v[88:91]
 buffer_load_dwordx4 a[180:183], v22, s[4:7], s59 offen sc1
 v_mfma_f32_16x16x32_bf16 v[120:123], a[216:219], a[136:139], v[120:123]
 ds_read_b64_tr_b16 a[242:243], v6 offset:9216
 v_accvgpr_write_b32 a94, 0
 v_mfma_f32_16x16x32_bf16 v[152:155], a[216:219], a[140:143], v[152:155]
 s_add_u32 s59, s91, 15360
 v_and_b32 v224, 0xffff0000, v224
 v_mfma_f32_16x16x32_bf16 v[60:63], a[220:223], a[128:131], v[60:63]
 ds_read_b64_tr_b16 a[244:245], v7 offset:8192
 ds_read_b64_tr_b16 a[246:247], v7 offset:9216
 v_mfma_f32_16x16x32_bf16 v[92:95], a[220:223], a[132:135], v[92:95]
 v_add_f32 v25, v25, v28
 v_add_f32 v23, v23, v224
 v_mfma_f32_16x16x32_bf16 v[124:127], a[220:223], a[136:139], v[124:127]
 buffer_load_dwordx4 a[184:187], v14, s[4:7], s59 offen sc1
 v_mfma_f32_16x16x32_bf16 v[156:159], a[220:223], a[140:143], v[156:159]
 v_lshlrev_b32 v28, 16, v225
 v_and_b32 v225, 0xffff0000, v225
 v_mfma_f32_16x16x32_bf16 v[160:163], a[224:227], a[128:131], v[160:163]
 ds_read_b64_tr_b16 a[248:249], v8 offset:8192
 ds_read_b64_tr_b16 a[250:251], v8 offset:9216
 v_mfma_f32_16x16x32_bf16 v[176:179], a[224:227], a[132:135], v[176:179]
 buffer_load_dwordx4 a[188:191], v22, s[4:7], s59 offen sc1
 v_mfma_f32_16x16x32_bf16 v[192:195], a[224:227], a[136:139], v[192:195]
 v_add_f32 v25, v25, v28
 v_accvgpr_write_b32 a95, 0
 v_mfma_f32_16x16x32_bf16 v[208:211], a[224:227], a[140:143], v[208:211]
 v_add_f32 v23, v23, v225
 v_lshlrev_b32 v28, 16, v226
 v_mfma_f32_16x16x32_bf16 v[164:167], a[228:231], a[128:131], v[164:167]
 ds_read_b64_tr_b16 a[252:253], v9 offset:8192
 ds_read_b64_tr_b16 a[254:255], v9 offset:9216
 v_mfma_f32_16x16x32_bf16 v[180:183], a[228:231], a[132:135], v[180:183]
 v_and_b32 v226, 0xffff0000, v226
 v_add_f32 v25, v25, v28
 v_mfma_f32_16x16x32_bf16 v[196:199], a[228:231], a[136:139], v[196:199]
 v_add_f32 v23, v23, v226
 v_lshlrev_b32 v28, 16, v227
 v_mfma_f32_16x16x32_bf16 v[212:215], a[228:231], a[140:143], v[212:215]
 v_accvgpr_write_b32 a96, 0
 s_waitcnt lgkmcnt(4)
 v_mfma_f32_16x16x32_bf16 v[168:171], a[232:235], a[128:131], v[168:171]
 ds_read_b64_tr_b16 a[192:193], v10 offset:8192
 ds_read_b64_tr_b16 a[194:195], v10 offset:9216
 v_mfma_f32_16x16x32_bf16 v[184:187], a[232:235], a[132:135], v[184:187]
 v_and_b32 v227, 0xffff0000, v227
 v_add_f32 v25, v25, v28
 v_mfma_f32_16x16x32_bf16 v[200:203], a[232:235], a[136:139], v[200:203]
 v_add_f32 v23, v23, v227
 v_accvgpr_write_b32 a97, 0
 v_mfma_f32_16x16x32_bf16 v[216:219], a[232:235], a[140:143], v[216:219]
 v_mfma_f32_16x16x32_bf16 v[172:175], a[236:239], a[128:131], v[172:175]
 ds_read_b64_tr_b16 a[196:197], v11 offset:8192
 ds_read_b64_tr_b16 a[198:199], v11 offset:9216
 v_mfma_f32_16x16x32_bf16 v[188:191], a[236:239], a[132:135], v[188:191]
 v_mfma_f32_16x16x32_bf16 v[204:207], a[236:239], a[136:139], v[204:207]
 v_mfma_f32_16x16x32_bf16 v[220:223], a[236:239], a[140:143], v[220:223]
 s_waitcnt vmcnt(22)
 v_mfma_f32_16x16x32_bf16 v[32:35], a[240:243], a[144:147], v[32:35]
 ds_read_b64_tr_b16 a[200:201], v12 offset:8192
 s_waitcnt vmcnt(21)
 v_mfma_f32_16x16x32_bf16 v[64:67], a[240:243], a[148:151], v[64:67]
 s_add_u32 s59, s90, 16384
 s_waitcnt vmcnt(20)
 v_mfma_f32_16x16x32_bf16 v[96:99], a[240:243], a[152:155], v[96:99]
 ds_read_b64_tr_b16 a[202:203], v12 offset:9216
 s_waitcnt vmcnt(19)
 v_mfma_f32_16x16x32_bf16 v[128:131], a[240:243], a[156:159], v[128:131]
 ds_read_b64_tr_b16 v[228:229], v21 offset:4096
 ds_read_b64_tr_b16 v[230:231], v21 offset:4608
 v_mfma_f32_16x16x32_bf16 v[36:39], a[244:247], a[144:147], v[36:39]
 buffer_load_dwordx4 a[128:131], v14, s[4:7], s59 offen sc1
 v_mfma_f32_16x16x32_bf16 v[68:71], a[244:247], a[148:151], v[68:71]
 ds_read_b64_tr_b16 a[204:205], v13 offset:8192
 ds_read_b64_tr_b16 a[206:207], v13 offset:9216
 v_mfma_f32_16x16x32_bf16 v[100:103], a[244:247], a[152:155], v[100:103]
 buffer_load_dwordx4 a[132:135], v22, s[4:7], s59 offen sc1
 v_mfma_f32_16x16x32_bf16 v[132:135], a[244:247], a[156:159], v[132:135]
 v_accvgpr_write_b32 a98, 0
 s_waitcnt lgkmcnt(6)
 v_mfma_f32_16x16x32_bf16 v[40:43], a[248:251], a[144:147], v[40:43]
 ds_read_b64_tr_b16 a[208:209], v15 offset:4096
 ds_read_b64_tr_b16 a[210:211], v15 offset:4608
 v_mfma_f32_16x16x32_bf16 v[72:75], a[248:251], a[148:151], v[72:75]
 s_add_u32 s59, s91, 16384
 v_accvgpr_write_b32 a99, 0
 v_mfma_f32_16x16x32_bf16 v[104:107], a[248:251], a[152:155], v[104:107]
 v_mfma_f32_16x16x32_bf16 v[136:139], a[248:251], a[156:159], v[136:139]
 v_accvgpr_write_b32 a100, 0
 v_mfma_f32_16x16x32_bf16 v[44:47], a[252:255], a[144:147], v[44:47]
 ds_read_b64_tr_b16 a[212:213], v16 offset:4096
 v_mfma_f32_16x16x32_bf16 v[76:79], a[252:255], a[148:151], v[76:79]
 buffer_load_dwordx4 a[136:139], v14, s[4:7], s59 offen sc1
 v_mfma_f32_16x16x32_bf16 v[108:111], a[252:255], a[152:155], v[108:111]
 ds_read_b64_tr_b16 a[214:215], v16 offset:4608
 v_mfma_f32_16x16x32_bf16 v[140:143], a[252:255], a[156:159], v[140:143]
 buffer_load_dwordx4 a[140:143], v22, s[4:7], s59 offen sc1
 v_mfma_f32_16x16x32_bf16 v[48:51], a[192:195], a[144:147], v[48:51]
 ds_read_b64_tr_b16 a[216:217], v17 offset:4096
 ds_read_b64_tr_b16 a[218:219], v17 offset:4608
 v_mfma_f32_16x16x32_bf16 v[80:83], a[192:195], a[148:151], v[80:83]
 v_accvgpr_write_b32 a101, 0
 v_mfma_f32_16x16x32_bf16 v[112:115], a[192:195], a[152:155], v[112:115]
 v_mfma_f32_16x16x32_bf16 v[144:147], a[192:195], a[156:159], v[144:147]
 s_add_u32 m0, s64, 135168
 v_mfma_f32_16x16x32_bf16 v[52:55], a[196:199], a[144:147], v[52:55]
 ds_read_b64_tr_b16 a[220:221], v18 offset:4096
 ds_read_b64_tr_b16 a[222:223], v18 offset:4608
 v_mfma_f32_16x16x32_bf16 v[84:87], a[196:199], a[148:151], v[84:87]
 s_add_u32 s56, s21, 0
 v_mfma_f32_16x16x32_bf16 v[116:119], a[196:199], a[152:155], v[116:119]
 buffer_load_dwordx4 v248, s[12:15], s56 offen offset:0 lds
 v_mfma_f32_16x16x32_bf16 v[148:151], a[196:199], a[156:159], v[148:151]
 s_add_u32 s56, s21, 9216
 s_waitcnt lgkmcnt(5)
 v_mfma_f32_16x16x32_bf16 v[56:59], a[200:203], a[144:147], v[56:59]
 v_accvgpr_write_b32 a102, 0
 v_lshlrev_b32 v28, 16, v228
 v_mfma_f32_16x16x32_bf16 v[88:91], a[200:203], a[148:151], v[88:91]
 buffer_load_dwordx4 v248, s[12:15], s56 offen offset:1024 lds
 v_mfma_f32_16x16x32_bf16 v[120:123], a[200:203], a[152:155], v[120:123]
 s_add_u32 s56, s21, 18432
 v_and_b32 v228, 0xffff0000, v228
 v_mfma_f32_16x16x32_bf16 v[152:155], a[200:203], a[156:159], v[152:155]
 v_add_f32 v25, v25, v28
 v_add_f32 v23, v23, v228
 v_mfma_f32_16x16x32_bf16 v[60:63], a[204:207], a[144:147], v[60:63]
 buffer_load_dwordx4 v248, s[12:15], s56 offen offset:2048 lds
 v_mfma_f32_16x16x32_bf16 v[92:95], a[204:207], a[148:151], v[92:95]
 s_add_u32 s56, s21, 27648
 v_lshlrev_b32 v28, 16, v229
 v_mfma_f32_16x16x32_bf16 v[124:127], a[204:207], a[152:155], v[124:127]
 v_and_b32 v229, 0xffff0000, v229
 v_accvgpr_write_b32 a103, 0
 v_mfma_f32_16x16x32_bf16 v[156:159], a[204:207], a[156:159], v[156:159]
 buffer_load_dwordx4 v248, s[12:15], s56 offen offset:3072 lds
 v_mfma_f32_16x16x32_bf16 v[160:163], a[208:211], a[144:147], v[160:163]
 v_add_f32 v25, v25, v28
 v_add_f32 v23, v23, v229
 v_mfma_f32_16x16x32_bf16 v[176:179], a[208:211], a[148:151], v[176:179]
 v_lshlrev_b32 v28, 16, v230
 v_and_b32 v230, 0xffff0000, v230
 v_mfma_f32_16x16x32_bf16 v[192:195], a[208:211], a[152:155], v[192:195]
 s_waitcnt lgkmcnt(0)
 s_barrier
 v_mfma_f32_16x16x32_bf16 v[208:211], a[208:211], a[156:159], v[208:211]
 ds_read_b64_tr_b16 a[224:225], v6 offset:16384
 ds_read_b64_tr_b16 a[226:227], v6 offset:17408
 v_mfma_f32_16x16x32_bf16 v[164:167], a[212:215], a[144:147], v[164:167]
 ds_read_b64_tr_b16 a[228:229], v7 offset:16384
 ds_read_b64_tr_b16 a[230:231], v7 offset:17408
 v_mfma_f32_16x16x32_bf16 v[180:183], a[212:215], a[148:151], v[180:183]
 ds_read_b64_tr_b16 a[232:233], v8 offset:16384
 ds_read_b64_tr_b16 a[234:235], v8 offset:17408
 v_mfma_f32_16x16x32_bf16 v[196:199], a[212:215], a[152:155], v[196:199]
 ds_read_b64_tr_b16 a[236:237], v9 offset:16384
 ds_read_b64_tr_b16 a[238:239], v9 offset:17408
 v_mfma_f32_16x16x32_bf16 v[212:215], a[212:215], a[156:159], v[212:215]
 s_add_u32 m0, s65, 0
 v_add_f32 v25, v25, v28
 v_mfma_f32_16x16x32_bf16 v[168:171], a[216:219], a[144:147], v[168:171]
 ds_read_b64_tr_b16 a[240:241], v10 offset:16384
 s_add_u32 s56, s87, 4718592
 v_mfma_f32_16x16x32_bf16 v[184:187], a[216:219], a[148:151], v[184:187]
 ds_read_b64_tr_b16 a[242:243], v10 offset:17408
 v_add_f32 v23, v23, v230
 v_mfma_f32_16x16x32_bf16 v[200:203], a[216:219], a[152:155], v[200:203]
 v_accvgpr_write_b32 a104, 0
 v_lshlrev_b32 v28, 16, v231
 v_mfma_f32_16x16x32_bf16 v[216:219], a[216:219], a[156:159], v[216:219]
 buffer_load_dwordx4 v2, s[28:31], s56 offen offset:0 lds
 v_mfma_f32_16x16x32_bf16 v[172:175], a[220:223], a[144:147], v[172:175]
 ds_read_b64_tr_b16 a[244:245], v11 offset:16384
 ds_read_b64_tr_b16 a[246:247], v11 offset:17408
 v_mfma_f32_16x16x32_bf16 v[188:191], a[220:223], a[148:151], v[188:191]
 v_and_b32 v231, 0xffff0000, v231
 v_add_f32 v25, v25, v28
 v_mfma_f32_16x16x32_bf16 v[204:207], a[220:223], a[152:155], v[204:207]
 buffer_load_dwordx4 v3, s[28:31], s56 offen offset:1024 lds
 v_mfma_f32_16x16x32_bf16 v[220:223], a[220:223], a[156:159], v[220:223]
 v_add_f32 v23, v23, v231
 s_waitcnt lgkmcnt(7) vmcnt(28)
 v_mfma_f32_16x16x32_bf16 v[32:35], a[224:227], a[160:163], v[32:35]
 ds_read_b64_tr_b16 a[248:249], v12 offset:16384
 s_waitcnt vmcnt(27)
 v_mfma_f32_16x16x32_bf16 v[64:67], a[224:227], a[164:167], v[64:67]
 ds_read_b64_tr_b16 a[250:251], v12 offset:17408
 s_waitcnt vmcnt(26)
 v_mfma_f32_16x16x32_bf16 v[96:99], a[224:227], a[168:171], v[96:99]
 v_accvgpr_write_b32 a105, 0
 s_waitcnt vmcnt(25)
 v_mfma_f32_16x16x32_bf16 v[128:131], a[224:227], a[172:175], v[128:131]
 buffer_load_dwordx4 v4, s[28:31], s56 offen offset:2048 lds
 v_mfma_f32_16x16x32_bf16 v[36:39], a[228:231], a[160:163], v[36:39]
 ds_read_b64_tr_b16 v[224:225], v21 offset:8192
 ds_read_b64_tr_b16 v[226:227], v21 offset:8704
 v_mfma_f32_16x16x32_bf16 v[68:71], a[228:231], a[164:167], v[68:71]
 ds_read_b64_tr_b16 a[252:253], v13 offset:16384
 v_accvgpr_write_b32 a106, 0
 v_mfma_f32_16x16x32_bf16 v[100:103], a[228:231], a[168:171], v[100:103]
 buffer_load_dwordx4 v5, s[28:31], s56 offen offset:3072 lds
 v_mfma_f32_16x16x32_bf16 v[132:135], a[228:231], a[172:175], v[132:135]
 ds_read_b64_tr_b16 a[254:255], v13 offset:17408
 s_waitcnt lgkmcnt(6)
 v_mfma_f32_16x16x32_bf16 v[40:43], a[232:235], a[160:163], v[40:43]
 s_add_u32 m0, s89, 98304
 ds_read_b64_tr_b16 a[192:193], v15 offset:8192
 v_mfma_f32_16x16x32_bf16 v[72:75], a[232:235], a[164:167], v[72:75]
 ds_read_b64_tr_b16 a[194:195], v15 offset:8704
 v_mfma_f32_16x16x32_bf16 v[104:107], a[232:235], a[168:171], v[104:107]
 s_add_u32 s56, s88, 1990656
 v_mfma_f32_16x16x32_bf16 v[136:139], a[232:235], a[172:175], v[136:139]
 s_cmp_eq_u32 s11, 1
 s_cselect_b64 vcc, -1, 0
 v_mfma_f32_16x16x32_bf16 v[44:47], a[236:239], a[160:163], v[44:47]
 ds_read_b64_tr_b16 a[196:197], v16 offset:8192
 ds_read_b64_tr_b16 a[198:199], v16 offset:8704
 v_mfma_f32_16x16x32_bf16 v[76:79], a[236:239], a[164:167], v[76:79]
 buffer_load_dwordx4 v19, s[32:35], s56 offen offset:0 lds
 v_mfma_f32_16x16x32_bf16 v[108:111], a[236:239], a[168:171], v[108:111]
 v_accvgpr_write_b32 a107, 0
 v_cndmask_b32 v251, v250, v249, vcc
 v_mfma_f32_16x16x32_bf16 v[140:143], a[236:239], a[172:175], v[140:143]
 v_accvgpr_write_b32 a108, 0
 s_lshl_b32 s82, s11, 10
 v_mfma_f32_16x16x32_bf16 v[48:51], a[240:243], a[160:163], v[48:51]
 ds_read_b64_tr_b16 a[200:201], v17 offset:8192
 v_accvgpr_write_b32 a109, 0
 v_mfma_f32_16x16x32_bf16 v[80:83], a[240:243], a[164:167], v[80:83]
 buffer_load_dwordx4 v20, s[32:35], s56 offen offset:1024 lds
 v_mfma_f32_16x16x32_bf16 v[112:115], a[240:243], a[168:171], v[112:115]
 ds_read_b64_tr_b16 a[202:203], v17 offset:8704
 s_add_u32 s59, s90, 17408
 v_mfma_f32_16x16x32_bf16 v[144:147], a[240:243], a[172:175], v[144:147]
 v_mfma_f32_16x16x32_bf16 v[52:55], a[244:247], a[160:163], v[52:55]
 ds_read_b64_tr_b16 a[204:205], v18 offset:8192
 ds_read_b64_tr_b16 a[206:207], v18 offset:8704
 v_mfma_f32_16x16x32_bf16 v[84:87], a[244:247], a[164:167], v[84:87]
 buffer_load_dwordx4 a[144:147], v14, s[4:7], s59 offen sc1
 v_mfma_f32_16x16x32_bf16 v[116:119], a[244:247], a[168:171], v[116:119]
 v_add_u32 v248, s82, v251
 v_accvgpr_write_b32 a110, 0
 v_mfma_f32_16x16x32_bf16 v[148:151], a[244:247], a[172:175], v[148:151]
 s_waitcnt lgkmcnt(4)
 v_mfma_f32_16x16x32_bf16 v[56:59], a[248:251], a[160:163], v[56:59]
 ds_read_b64_tr_b16 a[208:209], v6 offset:24576
 v_lshlrev_b32 v28, 16, v224
 v_mfma_f32_16x16x32_bf16 v[88:91], a[248:251], a[164:167], v[88:91]
 buffer_load_dwordx4 a[148:151], v22, s[4:7], s59 offen sc1
 v_mfma_f32_16x16x32_bf16 v[120:123], a[248:251], a[168:171], v[120:123]
 ds_read_b64_tr_b16 a[210:211], v6 offset:25600
 v_and_b32 v224, 0xffff0000, v224
 v_mfma_f32_16x16x32_bf16 v[152:155], a[248:251], a[172:175], v[152:155]
 s_add_u32 s59, s91, 17408
 v_add_f32 v25, v25, v28
 v_mfma_f32_16x16x32_bf16 v[60:63], a[252:255], a[160:163], v[60:63]
 ds_read_b64_tr_b16 a[212:213], v7 offset:24576
 ds_read_b64_tr_b16 a[214:215], v7 offset:25600
 v_mfma_f32_16x16x32_bf16 v[92:95], a[252:255], a[164:167], v[92:95]
 v_add_f32 v23, v23, v224
 v_lshlrev_b32 v28, 16, v225
 v_mfma_f32_16x16x32_bf16 v[124:127], a[252:255], a[168:171], v[124:127]
 buffer_load_dwordx4 a[152:155], v14, s[4:7], s59 offen sc1
 v_mfma_f32_16x16x32_bf16 v[156:159], a[252:255], a[172:175], v[156:159]
 v_accvgpr_write_b32 a111, 0
 v_and_b32 v225, 0xffff0000, v225
 v_mfma_f32_16x16x32_bf16 v[160:163], a[192:195], a[160:163], v[160:163]
 ds_read_b64_tr_b16 a[216:217], v8 offset:24576
 ds_read_b64_tr_b16 a[218:219], v8 offset:25600
 v_mfma_f32_16x16x32_bf16 v[176:179], a[192:195], a[164:167], v[176:179]
 buffer_load_dwordx4 a[156:159], v22, s[4:7], s59 offen sc1
 v_mfma_f32_16x16x32_bf16 v[192:195], a[192:195], a[168:171], v[192:195]
 v_add_f32 v25, v25, v28
 v_add_f32 v23, v23, v225
 v_mfma_f32_16x16x32_bf16 v[208:211], a[192:195], a[172:175], v[208:211]
 v_lshlrev_b32 v28, 16, v226
 v_and_b32 v226, 0xffff0000, v226
 v_mfma_f32_16x16x32_bf16 v[164:167], a[196:199], a[160:163], v[164:167]
 ds_read_b64_tr_b16 a[220:221], v9 offset:24576
 ds_read_b64_tr_b16 a[222:223], v9 offset:25600
 v_mfma_f32_16x16x32_bf16 v[180:183], a[196:199], a[164:167], v[180:183]
 v_add_f32 v25, v25, v28
 v_accvgpr_write_b32 a112, 0
 v_mfma_f32_16x16x32_bf16 v[196:199], a[196:199], a[168:171], v[196:199]
 v_add_f32 v23, v23, v226
 v_lshlrev_b32 v28, 16, v227
 v_mfma_f32_16x16x32_bf16 v[212:215], a[196:199], a[172:175], v[212:215]
 v_and_b32 v227, 0xffff0000, v227
 s_waitcnt lgkmcnt(4)
 v_mfma_f32_16x16x32_bf16 v[168:171], a[200:203], a[160:163], v[168:171]
 ds_read_b64_tr_b16 a[224:225], v10 offset:24576
 s_lshl_b32 s81, s84, 10
 v_mfma_f32_16x16x32_bf16 v[184:187], a[200:203], a[164:167], v[184:187]
 ds_read_b64_tr_b16 a[226:227], v10 offset:25600
 s_add_u32 s81, s81, 39354368
 v_mfma_f32_16x16x32_bf16 v[200:203], a[200:203], a[168:171], v[200:203]
 v_and_b32 v30, 7, v0
 v_lshlrev_b32 v30, 7, v30
 v_mfma_f32_16x16x32_bf16 v[216:219], a[200:203], a[172:175], v[216:219]
 buffer_load_dword v31, v30, s[4:7], s81 offen sc1
 v_mfma_f32_16x16x32_bf16 v[172:175], a[204:207], a[160:163], v[172:175]
 ds_read_b64_tr_b16 a[228:229], v11 offset:24576
 ds_read_b64_tr_b16 a[230:231], v11 offset:25600
 v_mfma_f32_16x16x32_bf16 v[188:191], a[204:207], a[164:167], v[188:191]
 v_add_f32 v25, v25, v28
 v_add_f32 v23, v23, v227
 v_mfma_f32_16x16x32_bf16 v[204:207], a[204:207], a[168:171], v[204:207]
 v_accvgpr_write_b32 a113, 0
 v_accvgpr_write_b32 a114, 0
 v_mfma_f32_16x16x32_bf16 v[220:223], a[204:207], a[172:175], v[220:223]
 s_waitcnt vmcnt(22)
 v_mfma_f32_16x16x32_bf16 v[32:35], a[208:211], a[176:179], v[32:35]
 ds_read_b64_tr_b16 a[232:233], v12 offset:24576
 s_waitcnt vmcnt(21)
 v_mfma_f32_16x16x32_bf16 v[64:67], a[208:211], a[180:183], v[64:67]
 s_add_u32 s59, s90, 18432
 s_waitcnt vmcnt(20)
 v_mfma_f32_16x16x32_bf16 v[96:99], a[208:211], a[184:187], v[96:99]
 ds_read_b64_tr_b16 a[234:235], v12 offset:25600
 s_waitcnt vmcnt(19)
 v_mfma_f32_16x16x32_bf16 v[128:131], a[208:211], a[188:191], v[128:131]
 ds_read_b64_tr_b16 v[228:229], v21 offset:12288
 ds_read_b64_tr_b16 v[230:231], v21 offset:12800
 v_mfma_f32_16x16x32_bf16 v[36:39], a[212:215], a[176:179], v[36:39]
 buffer_load_dwordx4 a[160:163], v14, s[4:7], s59 offen sc1
 v_mfma_f32_16x16x32_bf16 v[68:71], a[212:215], a[180:183], v[68:71]
 ds_read_b64_tr_b16 a[236:237], v13 offset:24576
 ds_read_b64_tr_b16 a[238:239], v13 offset:25600
 v_mfma_f32_16x16x32_bf16 v[100:103], a[212:215], a[184:187], v[100:103]
 buffer_load_dwordx4 a[164:167], v22, s[4:7], s59 offen sc1
 v_mfma_f32_16x16x32_bf16 v[132:135], a[212:215], a[188:191], v[132:135]
 v_accvgpr_write_b32 a115, 0
 s_waitcnt lgkmcnt(6)
 v_mfma_f32_16x16x32_bf16 v[40:43], a[216:219], a[176:179], v[40:43]
 ds_read_b64_tr_b16 a[240:241], v15 offset:12288
 ds_read_b64_tr_b16 a[242:243], v15 offset:12800
 v_mfma_f32_16x16x32_bf16 v[72:75], a[216:219], a[180:183], v[72:75]
 s_add_u32 s59, s91, 18432
 v_accvgpr_write_b32 a116, 0
 v_mfma_f32_16x16x32_bf16 v[104:107], a[216:219], a[184:187], v[104:107]
 v_mfma_f32_16x16x32_bf16 v[136:139], a[216:219], a[188:191], v[136:139]
 v_mfma_f32_16x16x32_bf16 v[44:47], a[220:223], a[176:179], v[44:47]
 ds_read_b64_tr_b16 a[244:245], v16 offset:12288
 v_mfma_f32_16x16x32_bf16 v[76:79], a[220:223], a[180:183], v[76:79]
 buffer_load_dwordx4 a[168:171], v14, s[4:7], s59 offen sc1
 v_mfma_f32_16x16x32_bf16 v[108:111], a[220:223], a[184:187], v[108:111]
 ds_read_b64_tr_b16 a[246:247], v16 offset:12800
 v_mfma_f32_16x16x32_bf16 v[140:143], a[220:223], a[188:191], v[140:143]
 buffer_load_dwordx4 a[172:175], v22, s[4:7], s59 offen sc1
 v_mfma_f32_16x16x32_bf16 v[48:51], a[224:227], a[176:179], v[48:51]
 ds_read_b64_tr_b16 a[248:249], v17 offset:12288
 ds_read_b64_tr_b16 a[250:251], v17 offset:12800
 v_mfma_f32_16x16x32_bf16 v[80:83], a[224:227], a[180:183], v[80:83]
 v_accvgpr_write_b32 a117, 0
 v_mfma_f32_16x16x32_bf16 v[112:115], a[224:227], a[184:187], v[112:115]
 v_mfma_f32_16x16x32_bf16 v[144:147], a[224:227], a[188:191], v[144:147]
 v_mfma_f32_16x16x32_bf16 v[52:55], a[228:231], a[176:179], v[52:55]
 ds_read_b64_tr_b16 a[252:253], v18 offset:12288
 ds_read_b64_tr_b16 a[254:255], v18 offset:12800
 v_mfma_f32_16x16x32_bf16 v[84:87], a[228:231], a[180:183], v[84:87]
 v_accvgpr_write_b32 a118, 0
 v_mfma_f32_16x16x32_bf16 v[116:119], a[228:231], a[184:187], v[116:119]
 v_mfma_f32_16x16x32_bf16 v[148:151], a[228:231], a[188:191], v[148:151]
 s_waitcnt lgkmcnt(5)
 v_mfma_f32_16x16x32_bf16 v[56:59], a[232:235], a[176:179], v[56:59]
 v_lshlrev_b32 v28, 16, v228
 v_mfma_f32_16x16x32_bf16 v[88:91], a[232:235], a[180:183], v[88:91]
 v_and_b32 v228, 0xffff0000, v228
 v_mfma_f32_16x16x32_bf16 v[120:123], a[232:235], a[184:187], v[120:123]
 v_add_f32 v25, v25, v28
 v_mfma_f32_16x16x32_bf16 v[152:155], a[232:235], a[188:191], v[152:155]
 v_add_f32 v23, v23, v228
 v_accvgpr_write_b32 a119, 0
 v_mfma_f32_16x16x32_bf16 v[60:63], a[236:239], a[176:179], v[60:63]
 v_lshlrev_b32 v28, 16, v229
 v_mfma_f32_16x16x32_bf16 v[92:95], a[236:239], a[180:183], v[92:95]
 v_and_b32 v229, 0xffff0000, v229
 v_mfma_f32_16x16x32_bf16 v[124:127], a[236:239], a[184:187], v[124:127]
 v_add_f32 v25, v25, v28
 v_mfma_f32_16x16x32_bf16 v[156:159], a[236:239], a[188:191], v[156:159]
 v_add_f32 v23, v23, v229
 v_mfma_f32_16x16x32_bf16 v[160:163], a[240:243], a[176:179], v[160:163]
 v_lshlrev_b32 v28, 16, v230
 v_mfma_f32_16x16x32_bf16 v[176:179], a[240:243], a[180:183], v[176:179]
 v_and_b32 v230, 0xffff0000, v230
 v_accvgpr_write_b32 a120, 0
 v_mfma_f32_16x16x32_bf16 v[192:195], a[240:243], a[184:187], v[192:195]
 s_waitcnt lgkmcnt(0)
 s_barrier
 v_mfma_f32_16x16x32_bf16 v[208:211], a[240:243], a[188:191], v[208:211]
 ds_read_b64_tr_b16 a[192:193], v6 offset:32768
 ds_read_b64_tr_b16 a[194:195], v6 offset:33792
 v_mfma_f32_16x16x32_bf16 v[164:167], a[244:247], a[176:179], v[164:167]
 ds_read_b64_tr_b16 a[196:197], v7 offset:32768
 ds_read_b64_tr_b16 a[198:199], v7 offset:33792
 v_mfma_f32_16x16x32_bf16 v[180:183], a[244:247], a[180:183], v[180:183]
 ds_read_b64_tr_b16 a[200:201], v8 offset:32768
 ds_read_b64_tr_b16 a[202:203], v8 offset:33792
 v_mfma_f32_16x16x32_bf16 v[196:199], a[244:247], a[184:187], v[196:199]
 ds_read_b64_tr_b16 a[204:205], v9 offset:32768
 ds_read_b64_tr_b16 a[206:207], v9 offset:33792
 v_mfma_f32_16x16x32_bf16 v[212:215], a[244:247], a[188:191], v[212:215]
 v_add_f32 v25, v25, v28
 v_add_f32 v23, v23, v230
 v_mfma_f32_16x16x32_bf16 v[168:171], a[248:251], a[176:179], v[168:171]
 ds_read_b64_tr_b16 a[208:209], v10 offset:32768
 ds_read_b64_tr_b16 a[210:211], v10 offset:33792
 v_mfma_f32_16x16x32_bf16 v[184:187], a[248:251], a[180:183], v[184:187]
 v_lshlrev_b32 v28, 16, v231
 v_and_b32 v231, 0xffff0000, v231
 v_mfma_f32_16x16x32_bf16 v[200:203], a[248:251], a[184:187], v[200:203]
 v_add_f32 v25, v25, v28
 v_accvgpr_write_b32 a121, 0
 v_mfma_f32_16x16x32_bf16 v[216:219], a[248:251], a[188:191], v[216:219]
 v_add_f32 v23, v23, v231
 v_mfma_f32_16x16x32_bf16 v[172:175], a[252:255], a[176:179], v[172:175]
 ds_read_b64_tr_b16 a[212:213], v11 offset:32768
 ds_read_b64_tr_b16 a[214:215], v11 offset:33792
 v_mfma_f32_16x16x32_bf16 v[188:191], a[252:255], a[180:183], v[188:191]
 v_accvgpr_write_b32 a122, 0
 v_mfma_f32_16x16x32_bf16 v[204:207], a[252:255], a[184:187], v[204:207]
 v_mfma_f32_16x16x32_bf16 v[220:223], a[252:255], a[188:191], v[220:223]
 s_waitcnt lgkmcnt(7) vmcnt(22)
 v_mfma_f32_16x16x32_bf16 v[32:35], a[192:195], a[128:131], v[32:35]
 ds_read_b64_tr_b16 a[216:217], v12 offset:32768
 s_waitcnt vmcnt(21)
 v_mfma_f32_16x16x32_bf16 v[64:67], a[192:195], a[132:135], v[64:67]
 ds_read_b64_tr_b16 a[218:219], v12 offset:33792
 s_waitcnt vmcnt(20)
 v_mfma_f32_16x16x32_bf16 v[96:99], a[192:195], a[136:139], v[96:99]
 ds_read_b64_tr_b16 v[224:225], v21 offset:16384
 s_waitcnt vmcnt(19)
 v_mfma_f32_16x16x32_bf16 v[128:131], a[192:195], a[140:143], v[128:131]
 ds_read_b64_tr_b16 v[226:227], v21 offset:16896
 v_accvgpr_write_b32 a123, 0
 v_mfma_f32_16x16x32_bf16 v[36:39], a[196:199], a[128:131], v[36:39]
 ds_read_b64_tr_b16 a[220:221], v13 offset:32768
 ds_read_b64_tr_b16 a[222:223], v13 offset:33792
 v_mfma_f32_16x16x32_bf16 v[68:71], a[196:199], a[132:135], v[68:71]
 v_mfma_f32_16x16x32_bf16 v[100:103], a[196:199], a[136:139], v[100:103]
 v_mfma_f32_16x16x32_bf16 v[132:135], a[196:199], a[140:143], v[132:135]
 s_waitcnt lgkmcnt(6)
 v_mfma_f32_16x16x32_bf16 v[40:43], a[200:203], a[128:131], v[40:43]
 ds_read_b64_tr_b16 a[224:225], v6 offset:40960
 ds_read_b64_tr_b16 a[226:227], v6 offset:41984
 v_mfma_f32_16x16x32_bf16 v[72:75], a[200:203], a[132:135], v[72:75]
 v_accvgpr_write_b32 a124, 0
 v_mfma_f32_16x16x32_bf16 v[104:107], a[200:203], a[136:139], v[104:107]
 v_mfma_f32_16x16x32_bf16 v[136:139], a[200:203], a[140:143], v[136:139]
 v_mfma_f32_16x16x32_bf16 v[44:47], a[204:207], a[128:131], v[44:47]
 ds_read_b64_tr_b16 a[228:229], v7 offset:40960
 ds_read_b64_tr_b16 a[230:231], v7 offset:41984
 v_mfma_f32_16x16x32_bf16 v[76:79], a[204:207], a[132:135], v[76:79]
 v_mfma_f32_16x16x32_bf16 v[108:111], a[204:207], a[136:139], v[108:111]
 v_accvgpr_write_b32 a125, 0
 v_mfma_f32_16x16x32_bf16 v[140:143], a[204:207], a[140:143], v[140:143]
 v_mfma_f32_16x16x32_bf16 v[48:51], a[208:211], a[128:131], v[48:51]
 ds_read_b64_tr_b16 a[232:233], v8 offset:40960
 ds_read_b64_tr_b16 a[234:235], v8 offset:41984
 v_mfma_f32_16x16x32_bf16 v[80:83], a[208:211], a[132:135], v[80:83]
 v_mfma_f32_16x16x32_bf16 v[112:115], a[208:211], a[136:139], v[112:115]
 s_add_u32 s59, s90, 19456
 v_mfma_f32_16x16x32_bf16 v[144:147], a[208:211], a[140:143], v[144:147]
 v_mfma_f32_16x16x32_bf16 v[52:55], a[212:215], a[128:131], v[52:55]
 ds_read_b64_tr_b16 a[236:237], v9 offset:40960
 ds_read_b64_tr_b16 a[238:239], v9 offset:41984
 v_mfma_f32_16x16x32_bf16 v[84:87], a[212:215], a[132:135], v[84:87]
 buffer_load_dwordx4 a[176:179], v14, s[4:7], s59 offen sc1
 v_mfma_f32_16x16x32_bf16 v[116:119], a[212:215], a[136:139], v[116:119]
 v_accvgpr_write_b32 a126, 0
 v_mfma_f32_16x16x32_bf16 v[148:151], a[212:215], a[140:143], v[148:151]
 s_waitcnt lgkmcnt(4)
 v_mfma_f32_16x16x32_bf16 v[56:59], a[216:219], a[128:131], v[56:59]
 ds_read_b64_tr_b16 a[240:241], v10 offset:40960
 v_lshlrev_b32 v28, 16, v224
 v_mfma_f32_16x16x32_bf16 v[88:91], a[216:219], a[132:135], v[88:91]
 buffer_load_dwordx4 a[180:183], v22, s[4:7], s59 offen sc1
 v_mfma_f32_16x16x32_bf16 v[120:123], a[216:219], a[136:139], v[120:123]
 ds_read_b64_tr_b16 a[242:243], v10 offset:41984
 v_and_b32 v224, 0xffff0000, v224
 v_mfma_f32_16x16x32_bf16 v[152:155], a[216:219], a[140:143], v[152:155]
 s_add_u32 s59, s91, 19456
 v_add_f32 v25, v25, v28
 v_mfma_f32_16x16x32_bf16 v[60:63], a[220:223], a[128:131], v[60:63]
 ds_read_b64_tr_b16 a[244:245], v11 offset:40960
 ds_read_b64_tr_b16 a[246:247], v11 offset:41984
 v_mfma_f32_16x16x32_bf16 v[92:95], a[220:223], a[132:135], v[92:95]
 v_lshlrev_b32 v28, 16, v225
 v_accvgpr_write_b32 a127, 0
 v_mfma_f32_16x16x32_bf16 v[124:127], a[220:223], a[136:139], v[124:127]
 buffer_load_dwordx4 a[184:187], v14, s[4:7], s59 offen sc1
 v_mfma_f32_16x16x32_bf16 v[156:159], a[220:223], a[140:143], v[156:159]
 v_add_f32 v23, v23, v224
 s_waitcnt vmcnt(11)
 v_mfma_f32_16x16x32_bf16 v[32:35], a[224:227], a[144:147], v[32:35]
 ds_read_b64_tr_b16 a[248:249], v12 offset:40960
 s_waitcnt vmcnt(10)
 v_mfma_f32_16x16x32_bf16 v[64:67], a[224:227], a[148:151], v[64:67]
 ds_read_b64_tr_b16 a[250:251], v12 offset:41984
 s_waitcnt vmcnt(9)
 v_mfma_f32_16x16x32_bf16 v[96:99], a[224:227], a[152:155], v[96:99]
 v_and_b32 v225, 0xffff0000, v225
 s_waitcnt vmcnt(8)
 v_mfma_f32_16x16x32_bf16 v[128:131], a[224:227], a[156:159], v[128:131]
 buffer_load_dwordx4 a[188:191], v22, s[4:7], s59 offen sc1
 v_mfma_f32_16x16x32_bf16 v[36:39], a[228:231], a[144:147], v[36:39]
 ds_read_b64_tr_b16 v[228:229], v21 offset:20480
 ds_read_b64_tr_b16 v[230:231], v21 offset:20992
 v_mfma_f32_16x16x32_bf16 v[68:71], a[228:231], a[148:151], v[68:71]
 ds_read_b64_tr_b16 a[252:253], v13 offset:40960
 ds_read_b64_tr_b16 a[254:255], v13 offset:41984
 v_mfma_f32_16x16x32_bf16 v[100:103], a[228:231], a[152:155], v[100:103]
 s_waitcnt vmcnt(8)
 v_cmp_ne_u32 vcc, s98, v31
 s_cbranch_vccnz P_parall_4
PB_parall_5:
 v_mfma_f32_16x16x32_bf16 v[132:135], a[228:231], a[156:159], v[132:135]
 v_add_f32 v25, v25, v28
 s_waitcnt lgkmcnt(6)
 v_mfma_f32_16x16x32_bf16 v[40:43], a[232:235], a[144:147], v[40:43]
 s_add_u32 m0, s65, 65536
 v_add_f32 v23, v23, v225
 v_mfma_f32_16x16x32_bf16 v[72:75], a[232:235], a[148:151], v[72:75]
 v_lshlrev_b32 v28, 16, v226
 v_and_b32 v226, 0xffff0000, v226
 v_mfma_f32_16x16x32_bf16 v[104:107], a[232:235], a[152:155], v[104:107]
 v_add_f32 v25, v25, v28
 v_add_f32 v23, v23, v226
 v_mfma_f32_16x16x32_bf16 v[136:139], a[232:235], a[156:159], v[136:139]
 v_lshlrev_b32 v28, 16, v227
 v_and_b32 v227, 0xffff0000, v227
 v_mfma_f32_16x16x32_bf16 v[44:47], a[236:239], a[144:147], v[44:47]
 s_add_u32 s56, s92, 0
 v_add_f32 v25, v25, v28
 v_mfma_f32_16x16x32_bf16 v[76:79], a[236:239], a[148:151], v[76:79]
 v_add_f32 v23, v23, v227
 v_and_b32 v29, 7, v0
 v_mfma_f32_16x16x32_bf16 v[108:111], a[236:239], a[152:155], v[108:111]
 v_lshlrev_b32 v29, 3, v29
 v_mfma_f32_16x16x32_bf16 v[140:143], a[236:239], a[156:159], v[140:143]
 v_bfe_u32 v30, v0, 3, 1
 v_mfma_f32_16x16x32_bf16 v[48:51], a[240:243], a[144:147], v[48:51]
 buffer_load_dwordx4 v14, s[4:7], s56 offen offset:0 sc1 lds
 v_mfma_f32_16x16x32_bf16 v[80:83], a[240:243], a[148:151], v[80:83]
 v_mfma_f32_16x16x32_bf16 v[112:115], a[240:243], a[152:155], v[112:115]
 s_waitcnt lgkmcnt(0)
 s_barrier
 v_mfma_f32_16x16x32_bf16 v[144:147], a[240:243], a[156:159], v[144:147]
 ds_read_b64_tr_b16 a[192:193], v6 offset:0
 ds_read_b64_tr_b16 a[194:195], v6 offset:1024
 v_mfma_f32_16x16x32_bf16 v[52:55], a[244:247], a[144:147], v[52:55]
 ds_read_b64_tr_b16 a[196:197], v7 offset:0
 ds_read_b64_tr_b16 a[198:199], v7 offset:1024
 v_mfma_f32_16x16x32_bf16 v[84:87], a[244:247], a[148:151], v[84:87]
 ds_read_b64_tr_b16 a[200:201], v8 offset:0
 ds_read_b64_tr_b16 a[202:203], v8 offset:1024
 v_mfma_f32_16x16x32_bf16 v[116:119], a[244:247], a[152:155], v[116:119]
 ds_read_b64_tr_b16 a[204:205], v9 offset:0
 ds_read_b64_tr_b16 a[206:207], v9 offset:1024
 v_mfma_f32_16x16x32_bf16 v[148:151], a[244:247], a[156:159], v[148:151]
 buffer_load_dwordx4 v14, s[4:7], s56 offen offset:1024 sc1 lds
 v_mfma_f32_16x16x32_bf16 v[56:59], a[248:251], a[144:147], v[56:59]
 ds_read_b64_tr_b16 a[208:209], v10 offset:0
 ds_read_b64_tr_b16 a[210:211], v10 offset:1024
 v_mfma_f32_16x16x32_bf16 v[88:91], a[248:251], a[148:151], v[88:91]
 buffer_load_dwordx4 v14, s[4:7], s56 offen offset:2048 sc1 lds
 v_mfma_f32_16x16x32_bf16 v[120:123], a[248:251], a[152:155], v[120:123]
 v_lshl_add_u32 v29, v30, 11, v29
 v_lshrrev_b32 v30, 4, v0
 v_mfma_f32_16x16x32_bf16 v[152:155], a[248:251], a[156:159], v[152:155]
 v_lshlrev_b32 v30, 3, v30
 v_lshlrev_b32 v28, 16, v228
 v_mfma_f32_16x16x32_bf16 v[60:63], a[252:255], a[144:147], v[60:63]
 ds_read_b64_tr_b16 a[212:213], v11 offset:0
 ds_read_b64_tr_b16 a[214:215], v11 offset:1024
 v_mfma_f32_16x16x32_bf16 v[92:95], a[252:255], a[148:151], v[92:95]
 buffer_load_dwordx4 v14, s[4:7], s56 offen offset:3072 sc1 lds
 v_mfma_f32_16x16x32_bf16 v[124:127], a[252:255], a[152:155], v[124:127]
 v_and_b32 v228, 0xffff0000, v228
 v_add_f32 v25, v25, v28
 v_mfma_f32_16x16x32_bf16 v[156:159], a[252:255], a[156:159], v[156:159]
 v_lshlrev_b32 v28, 16, v229
 s_waitcnt lgkmcnt(7) vmcnt(11)
 v_mfma_f32_16x16x32_bf16 v[32:35], a[192:195], a[160:163], v[32:35]
 ds_read_b64_tr_b16 a[216:217], v12 offset:0
 s_waitcnt vmcnt(10)
 v_mfma_f32_16x16x32_bf16 v[64:67], a[192:195], a[164:167], v[64:67]
 ds_read_b64_tr_b16 a[218:219], v12 offset:1024
 s_waitcnt vmcnt(9)
 v_mfma_f32_16x16x32_bf16 v[96:99], a[192:195], a[168:171], v[96:99]
 s_add_u32 m0, s65, 81920
 s_waitcnt vmcnt(8)
 v_mfma_f32_16x16x32_bf16 v[128:131], a[192:195], a[172:175], v[128:131]
 ds_read_b64_tr_b16 v[224:225], v21 offset:0
 ds_read_b64_tr_b16 v[226:227], v21 offset:512
 v_mfma_f32_16x16x32_bf16 v[36:39], a[196:199], a[160:163], v[36:39]
 ds_read_b64_tr_b16 a[220:221], v13 offset:0
 ds_read_b64_tr_b16 a[222:223], v13 offset:1024
 v_mfma_f32_16x16x32_bf16 v[68:71], a[196:199], a[164:167], v[68:71]
 s_add_u32 s56, s92, 32768
 s_lshl_b32 s58, s93, 13
 v_mfma_f32_16x16x32_bf16 v[100:103], a[196:199], a[168:171], v[100:103]
 v_add_f32 v23, v23, v228
 v_and_b32 v229, 0xffff0000, v229
 v_mfma_f32_16x16x32_bf16 v[132:135], a[196:199], a[172:175], v[132:135]
 v_add_f32 v25, v25, v28
 s_waitcnt lgkmcnt(6)
 v_mfma_f32_16x16x32_bf16 v[40:43], a[200:203], a[160:163], v[40:43]
 ds_read_b64_tr_b16 a[224:225], v6 offset:8192
 ds_read_b64_tr_b16 a[226:227], v6 offset:9216
 v_mfma_f32_16x16x32_bf16 v[72:75], a[200:203], a[164:167], v[72:75]
 buffer_load_dwordx4 v14, s[4:7], s56 offen offset:0 sc1 lds
 v_mfma_f32_16x16x32_bf16 v[104:107], a[200:203], a[168:171], v[104:107]
 v_add_f32 v23, v23, v229
 v_lshlrev_b32 v28, 16, v230
 v_mfma_f32_16x16x32_bf16 v[136:139], a[200:203], a[172:175], v[136:139]
 s_add_u32 s58, s58, 38797312
 v_and_b32 v230, 0xffff0000, v230
 v_mfma_f32_16x16x32_bf16 v[44:47], a[204:207], a[160:163], v[44:47]
 ds_read_b64_tr_b16 a[228:229], v7 offset:8192
 ds_read_b64_tr_b16 a[230:231], v7 offset:9216
 v_mfma_f32_16x16x32_bf16 v[76:79], a[204:207], a[164:167], v[76:79]
 v_add_f32 v25, v25, v28
 v_add_f32 v23, v23, v230
 v_mfma_f32_16x16x32_bf16 v[108:111], a[204:207], a[168:171], v[108:111]
 buffer_load_dwordx4 v14, s[4:7], s56 offen offset:1024 sc1 lds
 v_mfma_f32_16x16x32_bf16 v[140:143], a[204:207], a[172:175], v[140:143]
 v_lshlrev_b32 v28, 16, v231
 v_mfma_f32_16x16x32_bf16 v[48:51], a[208:211], a[160:163], v[48:51]
 ds_read_b64_tr_b16 a[232:233], v8 offset:8192
 ds_read_b64_tr_b16 a[234:235], v8 offset:9216
 v_mfma_f32_16x16x32_bf16 v[80:83], a[208:211], a[164:167], v[80:83]
 buffer_load_dwordx2 v[232:233], v29, s[4:7], s58 offen sc1
 v_mfma_f32_16x16x32_bf16 v[112:115], a[208:211], a[168:171], v[112:115]
 buffer_load_dwordx4 v14, s[4:7], s56 offen offset:2048 sc1 lds
 v_mfma_f32_16x16x32_bf16 v[144:147], a[208:211], a[172:175], v[144:147]
 v_and_b32 v231, 0xffff0000, v231
 v_add_f32 v25, v25, v28
 v_mfma_f32_16x16x32_bf16 v[52:55], a[212:215], a[160:163], v[52:55]
 ds_read_b64_tr_b16 a[236:237], v9 offset:8192
 ds_read_b64_tr_b16 a[238:239], v9 offset:9216
 v_mfma_f32_16x16x32_bf16 v[84:87], a[212:215], a[164:167], v[84:87]
 v_add_f32 v23, v23, v231
 s_lshl_b32 s58, s93, 13
 v_mfma_f32_16x16x32_bf16 v[116:119], a[212:215], a[168:171], v[116:119]
 buffer_load_dwordx4 v14, s[4:7], s56 offen offset:3072 sc1 lds
 v_mfma_f32_16x16x32_bf16 v[148:151], a[212:215], a[172:175], v[148:151]
 s_add_u32 s58, s58, 38801408
 s_waitcnt lgkmcnt(4)
 v_mfma_f32_16x16x32_bf16 v[56:59], a[216:219], a[160:163], v[56:59]
 ds_read_b64_tr_b16 a[240:241], v10 offset:8192
 ds_read_b64_tr_b16 a[242:243], v10 offset:9216
 v_mfma_f32_16x16x32_bf16 v[88:91], a[216:219], a[164:167], v[88:91]
 buffer_load_dwordx2 v[234:235], v29, s[4:7], s58 offen sc1
 v_mfma_f32_16x16x32_bf16 v[120:123], a[216:219], a[168:171], v[120:123]
 s_add_u32 m0, s65, 49152
 s_lshl_b32 s58, s94, 13
 v_mfma_f32_16x16x32_bf16 v[152:155], a[216:219], a[172:175], v[152:155]
 s_add_u32 s58, s58, 38797312
 v_mfma_f32_16x16x32_bf16 v[60:63], a[220:223], a[160:163], v[60:63]
 ds_read_b64_tr_b16 a[244:245], v11 offset:8192
 ds_read_b64_tr_b16 a[246:247], v11 offset:9216
 v_mfma_f32_16x16x32_bf16 v[92:95], a[220:223], a[164:167], v[92:95]
 buffer_load_dwordx2 v[236:237], v29, s[4:7], s58 offen sc1
 v_mfma_f32_16x16x32_bf16 v[124:127], a[220:223], a[168:171], v[124:127]
 s_add_u32 s56, s92, 16384
 s_lshl_b32 s58, s94, 13
 v_mfma_f32_16x16x32_bf16 v[156:159], a[220:223], a[172:175], v[156:159]
 s_add_u32 s58, s58, 38801408
 s_waitcnt vmcnt(14)
 v_mfma_f32_16x16x32_bf16 v[32:35], a[224:227], a[176:179], v[32:35]
 ds_read_b64_tr_b16 a[248:249], v12 offset:8192
 s_waitcnt vmcnt(13)
 v_mfma_f32_16x16x32_bf16 v[64:67], a[224:227], a[180:183], v[64:67]
 ds_read_b64_tr_b16 a[250:251], v12 offset:9216
 s_waitcnt vmcnt(12)
 v_mfma_f32_16x16x32_bf16 v[96:99], a[224:227], a[184:187], v[96:99]
 ds_read_b64_tr_b16 v[228:229], v21 offset:4096
 s_waitcnt vmcnt(11)
 v_mfma_f32_16x16x32_bf16 v[128:131], a[224:227], a[188:191], v[128:131]
 ds_read_b64_tr_b16 v[230:231], v21 offset:4608
 v_lshlrev_b32 v28, 16, v224
 v_mfma_f32_16x16x32_bf16 v[36:39], a[228:231], a[176:179], v[36:39]
 buffer_load_dwordx4 v14, s[4:7], s56 offen offset:0 sc1 lds
 v_mfma_f32_16x16x32_bf16 v[68:71], a[228:231], a[180:183], v[68:71]
 ds_read_b64_tr_b16 a[252:253], v13 offset:8192
 ds_read_b64_tr_b16 a[254:255], v13 offset:9216
 v_mfma_f32_16x16x32_bf16 v[100:103], a[228:231], a[184:187], v[100:103]
 v_and_b32 v224, 0xffff0000, v224
 v_mfma_f32_16x16x32_bf16 v[132:135], a[228:231], a[188:191], v[132:135]
 s_waitcnt lgkmcnt(6)
 v_mfma_f32_16x16x32_bf16 v[40:43], a[232:235], a[176:179], v[40:43]
 buffer_load_dwordx4 v14, s[4:7], s56 offen offset:1024 sc1 lds
 v_mfma_f32_16x16x32_bf16 v[72:75], a[232:235], a[180:183], v[72:75]
 ds_read_b64_tr_b16 a[192:193], v15 offset:16384
 ds_read_b64_tr_b16 a[194:195], v15 offset:16896
 v_mfma_f32_16x16x32_bf16 v[104:107], a[232:235], a[184:187], v[104:107]
 buffer_load_dwordx2 v[238:239], v29, s[4:7], s58 offen sc1
 v_mfma_f32_16x16x32_bf16 v[136:139], a[232:235], a[188:191], v[136:139]
 buffer_load_dwordx4 v14, s[4:7], s56 offen offset:2048 sc1 lds
 v_mfma_f32_16x16x32_bf16 v[44:47], a[236:239], a[176:179], v[44:47]
 ds_read_b64_tr_b16 a[196:197], v16 offset:16384
 ds_read_b64_tr_b16 a[198:199], v16 offset:16896
 v_mfma_f32_16x16x32_bf16 v[76:79], a[236:239], a[180:183], v[76:79]
 v_add_f32 v25, v25, v28
 v_lshlrev_b32 v28, 16, v225
 v_mfma_f32_16x16x32_bf16 v[108:111], a[236:239], a[184:187], v[108:111]
 v_add_f32 v23, v23, v224
 v_and_b32 v225, 0xffff0000, v225
 v_mfma_f32_16x16x32_bf16 v[140:143], a[236:239], a[188:191], v[140:143]
 buffer_load_dwordx4 v14, s[4:7], s56 offen offset:3072 sc1 lds
 v_mfma_f32_16x16x32_bf16 v[48:51], a[240:243], a[176:179], v[48:51]
 ds_read_b64_tr_b16 a[200:201], v17 offset:16384
 ds_read_b64_tr_b16 a[202:203], v17 offset:16896
 v_mfma_f32_16x16x32_bf16 v[80:83], a[240:243], a[180:183], v[80:83]
 v_add_f32 v25, v25, v28
 s_lshl_b32 s58, s86, 7
 v_mfma_f32_16x16x32_bf16 v[112:115], a[240:243], a[184:187], v[112:115]
 v_add_f32 v23, v23, v225
 v_lshlrev_b32 v28, 16, v226
 v_mfma_f32_16x16x32_bf16 v[144:147], a[240:243], a[188:191], v[144:147]
 v_and_b32 v226, 0xffff0000, v226
 v_mfma_f32_16x16x32_bf16 v[52:55], a[244:247], a[176:179], v[52:55]
 ds_read_b64_tr_b16 a[204:205], v18 offset:16384
 ds_read_b64_tr_b16 a[206:207], v18 offset:16896
 v_mfma_f32_16x16x32_bf16 v[84:87], a[244:247], a[180:183], v[84:87]
 buffer_load_dwordx2 v[240:241], v30, s[36:39], s58 offen offset:0
 v_mfma_f32_16x16x32_bf16 v[116:119], a[244:247], a[184:187], v[116:119]
 v_add_f32 v25, v25, v28
 v_add_f32 v23, v23, v226
 v_lshlrev_b32 v28, 16, v227
 v_and_b32 v227, 0xffff0000, v227
 buffer_load_dwordx2 v[242:243], v30, s[36:39], s58 offen offset:32
 v_add_f32 v25, v25, v28
 v_add_f32 v23, v23, v227
 buffer_load_dwordx2 v[244:245], v30, s[36:39], s58 offen offset:64
 buffer_load_dwordx2 v[246:247], v30, s[36:39], s58 offen offset:96
 v_mfma_f32_16x16x32_bf16 v[148:151], a[244:247], a[188:191], v[148:151]
 s_waitcnt lgkmcnt(4)
 v_mfma_f32_16x16x32_bf16 v[56:59], a[248:251], a[176:179], v[56:59]
 ds_read_b64_tr_b16 a[208:209], v15 offset:20480
 ds_read_b64_tr_b16 a[210:211], v15 offset:20992
 v_mfma_f32_16x16x32_bf16 v[88:91], a[248:251], a[180:183], v[88:91]
 v_lshlrev_b32 v28, 16, v228
 v_and_b32 v228, 0xffff0000, v228
 v_mfma_f32_16x16x32_bf16 v[120:123], a[248:251], a[184:187], v[120:123]
 v_add_f32 v25, v25, v28
 v_lshlrev_b32 v28, 16, v229
 v_mfma_f32_16x16x32_bf16 v[152:155], a[248:251], a[188:191], v[152:155]
 v_add_f32 v23, v23, v228
 v_and_b32 v229, 0xffff0000, v229
 v_mfma_f32_16x16x32_bf16 v[60:63], a[252:255], a[176:179], v[60:63]
 ds_read_b64_tr_b16 a[212:213], v16 offset:20480
 ds_read_b64_tr_b16 a[214:215], v16 offset:20992
 v_mfma_f32_16x16x32_bf16 v[92:95], a[252:255], a[180:183], v[92:95]
 v_add_f32 v25, v25, v28
 v_add_f32 v23, v23, v229
 v_mfma_f32_16x16x32_bf16 v[124:127], a[252:255], a[184:187], v[124:127]
 v_lshlrev_b32 v28, 16, v230
 v_and_b32 v230, 0xffff0000, v230
 v_mfma_f32_16x16x32_bf16 v[156:159], a[252:255], a[188:191], v[156:159]
 v_add_f32 v25, v25, v28
 v_mfma_f32_16x16x32_bf16 v[160:163], a[192:195], a[128:131], v[160:163]
 ds_read_b64_tr_b16 a[216:217], v17 offset:20480
 ds_read_b64_tr_b16 a[218:219], v17 offset:20992
 v_mfma_f32_16x16x32_bf16 v[176:179], a[192:195], a[132:135], v[176:179]
 v_add_f32 v23, v23, v230
 v_lshlrev_b32 v28, 16, v231
 v_mfma_f32_16x16x32_bf16 v[192:195], a[192:195], a[136:139], v[192:195]
 v_and_b32 v231, 0xffff0000, v231
 v_add_f32 v25, v25, v28
 v_mfma_f32_16x16x32_bf16 v[208:211], a[192:195], a[140:143], v[208:211]
 v_add_f32 v23, v23, v231
 v_mfma_f32_16x16x32_bf16 v[164:167], a[196:199], a[128:131], v[164:167]
 ds_read_b64_tr_b16 a[220:221], v18 offset:20480
 ds_read_b64_tr_b16 a[222:223], v18 offset:20992
 v_mfma_f32_16x16x32_bf16 v[180:183], a[196:199], a[132:135], v[180:183]
 v_mfma_f32_16x16x32_bf16 v[196:199], a[196:199], a[136:139], v[196:199]
 v_cvt_pk_bf16_f32 v32, v32, v33
 v_cvt_pk_bf16_f32 v33, v34, v35
 v_mfma_f32_16x16x32_bf16 v[212:215], a[196:199], a[140:143], v[212:215]
 v_cvt_pk_bf16_f32 v34, v36, v37
 s_waitcnt lgkmcnt(4)
 v_mfma_f32_16x16x32_bf16 v[168:171], a[200:203], a[128:131], v[168:171]
 ds_read_b64_tr_b16 a[224:225], v15 offset:0
 ds_read_b64_tr_b16 a[226:227], v15 offset:512
 v_mfma_f32_16x16x32_bf16 v[184:187], a[200:203], a[132:135], v[184:187]
 v_cvt_pk_bf16_f32 v35, v38, v39
 v_cvt_pk_bf16_f32 v36, v40, v41
 v_mfma_f32_16x16x32_bf16 v[200:203], a[200:203], a[136:139], v[200:203]
 v_cvt_pk_bf16_f32 v37, v42, v43
 v_cvt_pk_bf16_f32 v38, v44, v45
 v_mfma_f32_16x16x32_bf16 v[216:219], a[200:203], a[140:143], v[216:219]
 v_cvt_pk_bf16_f32 v39, v46, v47
 v_cvt_pk_bf16_f32 v40, v48, v49
 v_mfma_f32_16x16x32_bf16 v[172:175], a[204:207], a[128:131], v[172:175]
 ds_read_b64_tr_b16 a[228:229], v16 offset:0
 ds_read_b64_tr_b16 a[230:231], v16 offset:512
 v_mfma_f32_16x16x32_bf16 v[188:191], a[204:207], a[132:135], v[188:191]
 v_cvt_pk_bf16_f32 v41, v50, v51
 v_cvt_pk_bf16_f32 v42, v52, v53
 v_mfma_f32_16x16x32_bf16 v[204:207], a[204:207], a[136:139], v[204:207]
 v_cvt_pk_bf16_f32 v43, v54, v55
 v_cvt_pk_bf16_f32 v44, v56, v57
 v_mfma_f32_16x16x32_bf16 v[220:223], a[204:207], a[140:143], v[220:223]
 v_cvt_pk_bf16_f32 v45, v58, v59
 v_cvt_pk_bf16_f32 v46, v60, v61
 v_mfma_f32_16x16x32_bf16 v[160:163], a[208:211], a[144:147], v[160:163]
 ds_read_b64_tr_b16 a[232:233], v17 offset:0
 ds_read_b64_tr_b16 a[234:235], v17 offset:512
 v_mfma_f32_16x16x32_bf16 v[176:179], a[208:211], a[148:151], v[176:179]
 v_cvt_pk_bf16_f32 v47, v62, v63
 v_cvt_pk_bf16_f32 v48, v64, v65
 v_mfma_f32_16x16x32_bf16 v[192:195], a[208:211], a[152:155], v[192:195]
 v_cvt_pk_bf16_f32 v49, v66, v67
 v_cvt_pk_bf16_f32 v50, v68, v69
 v_mfma_f32_16x16x32_bf16 v[208:211], a[208:211], a[156:159], v[208:211]
 v_cvt_pk_bf16_f32 v51, v70, v71
 v_cvt_pk_bf16_f32 v52, v72, v73
 v_mfma_f32_16x16x32_bf16 v[164:167], a[212:215], a[144:147], v[164:167]
 ds_read_b64_tr_b16 a[236:237], v18 offset:0
 ds_read_b64_tr_b16 a[238:239], v18 offset:512
 v_mfma_f32_16x16x32_bf16 v[180:183], a[212:215], a[148:151], v[180:183]
 v_cvt_pk_bf16_f32 v53, v74, v75
 v_cvt_pk_bf16_f32 v54, v76, v77
 v_mfma_f32_16x16x32_bf16 v[196:199], a[212:215], a[152:155], v[196:199]
 v_cvt_pk_bf16_f32 v55, v78, v79
 v_cvt_pk_bf16_f32 v56, v80, v81
 v_mfma_f32_16x16x32_bf16 v[212:215], a[212:215], a[156:159], v[212:215]
 v_cvt_pk_bf16_f32 v57, v82, v83
 s_waitcnt lgkmcnt(4)
 v_mfma_f32_16x16x32_bf16 v[168:171], a[216:219], a[144:147], v[168:171]
 ds_read_b64_tr_b16 a[240:241], v15 offset:4096
 ds_read_b64_tr_b16 a[242:243], v15 offset:4608
 v_mfma_f32_16x16x32_bf16 v[184:187], a[216:219], a[148:151], v[184:187]
 v_cvt_pk_bf16_f32 v58, v84, v85
 v_cvt_pk_bf16_f32 v59, v86, v87
 v_mfma_f32_16x16x32_bf16 v[200:203], a[216:219], a[152:155], v[200:203]
 v_cvt_pk_bf16_f32 v60, v88, v89
 v_cvt_pk_bf16_f32 v61, v90, v91
 v_mfma_f32_16x16x32_bf16 v[216:219], a[216:219], a[156:159], v[216:219]
 v_cvt_pk_bf16_f32 v62, v92, v93
 v_cvt_pk_bf16_f32 v63, v94, v95
 v_mfma_f32_16x16x32_bf16 v[172:175], a[220:223], a[144:147], v[172:175]
 ds_read_b64_tr_b16 a[244:245], v16 offset:4096
 ds_read_b64_tr_b16 a[246:247], v16 offset:4608
 v_mfma_f32_16x16x32_bf16 v[188:191], a[220:223], a[148:151], v[188:191]
 v_cvt_pk_bf16_f32 v64, v96, v97
 v_cvt_pk_bf16_f32 v65, v98, v99
 v_mfma_f32_16x16x32_bf16 v[204:207], a[220:223], a[152:155], v[204:207]
 v_cvt_pk_bf16_f32 v66, v100, v101
 v_cvt_pk_bf16_f32 v67, v102, v103
 v_mfma_f32_16x16x32_bf16 v[220:223], a[220:223], a[156:159], v[220:223]
 v_cvt_pk_bf16_f32 v68, v104, v105
 v_cvt_pk_bf16_f32 v69, v106, v107
 v_mfma_f32_16x16x32_bf16 v[160:163], a[224:227], a[160:163], v[160:163]
 ds_read_b64_tr_b16 a[248:249], v17 offset:4096
 ds_read_b64_tr_b16 a[250:251], v17 offset:4608
 v_mfma_f32_16x16x32_bf16 v[176:179], a[224:227], a[164:167], v[176:179]
 v_cvt_pk_bf16_f32 v70, v108, v109
 v_cvt_pk_bf16_f32 v71, v110, v111
 v_mfma_f32_16x16x32_bf16 v[192:195], a[224:227], a[168:171], v[192:195]
 v_cvt_pk_bf16_f32 v72, v112, v113
 v_cvt_pk_bf16_f32 v73, v114, v115
 v_mfma_f32_16x16x32_bf16 v[208:211], a[224:227], a[172:175], v[208:211]
 v_cvt_pk_bf16_f32 v74, v116, v117
 v_cvt_pk_bf16_f32 v75, v118, v119
 v_mfma_f32_16x16x32_bf16 v[164:167], a[228:231], a[160:163], v[164:167]
 ds_read_b64_tr_b16 a[252:253], v18 offset:4096
 ds_read_b64_tr_b16 a[254:255], v18 offset:4608
 v_mfma_f32_16x16x32_bf16 v[180:183], a[228:231], a[164:167], v[180:183]
 v_cvt_pk_bf16_f32 v76, v120, v121
 v_cvt_pk_bf16_f32 v77, v122, v123
 v_mfma_f32_16x16x32_bf16 v[196:199], a[228:231], a[168:171], v[196:199]
 v_cvt_pk_bf16_f32 v78, v124, v125
 v_cvt_pk_bf16_f32 v79, v126, v127
 v_mfma_f32_16x16x32_bf16 v[212:215], a[228:231], a[172:175], v[212:215]
 v_cvt_pk_bf16_f32 v80, v128, v129
 s_waitcnt lgkmcnt(4)
 v_mfma_f32_16x16x32_bf16 v[168:171], a[232:235], a[160:163], v[168:171]
 v_cvt_pk_bf16_f32 v81, v130, v131
 v_cvt_pk_bf16_f32 v82, v132, v133
 v_mfma_f32_16x16x32_bf16 v[184:187], a[232:235], a[164:167], v[184:187]
 v_cvt_pk_bf16_f32 v83, v134, v135
 v_cvt_pk_bf16_f32 v84, v136, v137
 v_mfma_f32_16x16x32_bf16 v[200:203], a[232:235], a[168:171], v[200:203]
 v_cvt_pk_bf16_f32 v85, v138, v139
 v_cvt_pk_bf16_f32 v86, v140, v141
 v_mfma_f32_16x16x32_bf16 v[216:219], a[232:235], a[172:175], v[216:219]
 v_cvt_pk_bf16_f32 v87, v142, v143
 v_cvt_pk_bf16_f32 v88, v144, v145
 v_mfma_f32_16x16x32_bf16 v[172:175], a[236:239], a[160:163], v[172:175]
 v_cvt_pk_bf16_f32 v89, v146, v147
 v_cvt_pk_bf16_f32 v90, v148, v149
 v_mfma_f32_16x16x32_bf16 v[188:191], a[236:239], a[164:167], v[188:191]
 v_cvt_pk_bf16_f32 v91, v150, v151
 v_cvt_pk_bf16_f32 v92, v152, v153
 v_mfma_f32_16x16x32_bf16 v[204:207], a[236:239], a[168:171], v[204:207]
 v_cvt_pk_bf16_f32 v93, v154, v155
 v_cvt_pk_bf16_f32 v94, v156, v157
 v_mfma_f32_16x16x32_bf16 v[220:223], a[236:239], a[172:175], v[220:223]
 v_cvt_pk_bf16_f32 v95, v158, v159
 v_permlane16_swap_b32 v32, v48
 v_mfma_f32_16x16x32_bf16 v[160:163], a[240:243], a[176:179], v[160:163]
 v_permlane16_swap_b32 v33, v49
 v_permlane16_swap_b32 v34, v50
 v_mfma_f32_16x16x32_bf16 v[176:179], a[240:243], a[180:183], v[176:179]
 v_permlane16_swap_b32 v35, v51
 v_permlane16_swap_b32 v36, v52
 v_mfma_f32_16x16x32_bf16 v[192:195], a[240:243], a[184:187], v[192:195]
 v_permlane16_swap_b32 v37, v53
 v_permlane16_swap_b32 v38, v54
 v_mfma_f32_16x16x32_bf16 v[208:211], a[240:243], a[188:191], v[208:211]
 v_permlane16_swap_b32 v39, v55
 v_permlane16_swap_b32 v40, v56
 v_mfma_f32_16x16x32_bf16 v[164:167], a[244:247], a[176:179], v[164:167]
 v_permlane16_swap_b32 v41, v57
 v_permlane16_swap_b32 v42, v58
 v_mfma_f32_16x16x32_bf16 v[180:183], a[244:247], a[180:183], v[180:183]
 v_permlane16_swap_b32 v43, v59
 v_permlane16_swap_b32 v44, v60
 v_mfma_f32_16x16x32_bf16 v[196:199], a[244:247], a[184:187], v[196:199]
 v_permlane16_swap_b32 v45, v61
 v_permlane16_swap_b32 v46, v62
 v_mfma_f32_16x16x32_bf16 v[212:215], a[244:247], a[188:191], v[212:215]
 v_permlane16_swap_b32 v47, v63
 s_waitcnt lgkmcnt(0)
 v_mfma_f32_16x16x32_bf16 v[168:171], a[248:251], a[176:179], v[168:171]
 v_permlane16_swap_b32 v64, v80
 v_permlane16_swap_b32 v65, v81
 v_mfma_f32_16x16x32_bf16 v[184:187], a[248:251], a[180:183], v[184:187]
 v_permlane16_swap_b32 v66, v82
 v_permlane16_swap_b32 v67, v83
 v_mfma_f32_16x16x32_bf16 v[200:203], a[248:251], a[184:187], v[200:203]
 v_permlane16_swap_b32 v68, v84
 v_permlane16_swap_b32 v69, v85
 v_mfma_f32_16x16x32_bf16 v[216:219], a[248:251], a[188:191], v[216:219]
 v_permlane16_swap_b32 v70, v86
 v_permlane16_swap_b32 v71, v87
 v_mfma_f32_16x16x32_bf16 v[172:175], a[252:255], a[176:179], v[172:175]
 v_permlane16_swap_b32 v72, v88
 v_permlane16_swap_b32 v73, v89
 v_mfma_f32_16x16x32_bf16 v[188:191], a[252:255], a[180:183], v[188:191]
 v_permlane16_swap_b32 v74, v90
 v_permlane16_swap_b32 v75, v91
 v_mfma_f32_16x16x32_bf16 v[204:207], a[252:255], a[184:187], v[204:207]
 v_permlane16_swap_b32 v76, v92
 v_permlane16_swap_b32 v77, v93
 v_mfma_f32_16x16x32_bf16 v[220:223], a[252:255], a[188:191], v[220:223]
 v_permlane16_swap_b32 v78, v94
 v_permlane16_swap_b32 v79, v95
 ds_read_b64_tr_b16 a[192:193], v249 offset:0
 ds_read_b64_tr_b16 a[194:195], v249 offset:1024
 ds_read_b64_tr_b16 a[196:197], v249 offset:32
 ds_read_b64_tr_b16 a[198:199], v249 offset:1056
 ds_read_b64_tr_b16 a[200:201], v249 offset:64
 ds_read_b64_tr_b16 a[202:203], v249 offset:1088
 ds_read_b64_tr_b16 a[204:205], v249 offset:96
 ds_read_b64_tr_b16 a[206:207], v249 offset:1120
 ds_read_b64_tr_b16 a[208:209], v251 offset:4096
 ds_read_b64_tr_b16 a[210:211], v248 offset:4096
 ds_read_b64_tr_b16 a[212:213], v251 offset:4128
 ds_read_b64_tr_b16 a[214:215], v248 offset:4128
 ds_read_b64_tr_b16 a[216:217], v251 offset:4160
 ds_read_b64_tr_b16 a[218:219], v248 offset:4160
 ds_read_b64_tr_b16 a[220:221], v251 offset:4192
 ds_read_b64_tr_b16 a[222:223], v248 offset:4192
 v_add_f32 v25, v25, v23
 v_mov_b32 v31, v25
 s_nop 1
 v_permlane16_swap_b32 v25, v31
 v_add_f32 v25, v25, v31
 v_mov_b32 v31, v25
 s_nop 1
 v_permlane32_swap_b32 v25, v31
 v_add_f32 v25, v25, v31
 v_and_b32 v29, 15, v0
 v_lshlrev_b32 v29, 2, v29
 s_lshl_b32 s57, s3, 6
 s_add_u32 s57, s57, 122880
 v_add_u32 v29, s57, v29
 ds_write_b32 v29, v25
 s_waitcnt vmcnt(0) lgkmcnt(0)
 s_barrier
 s_cmp_gt_u32 s86, 26
 s_cbranch_scc1 L_parall_7
 v_lshrrev_b32 v29, 4, v0
 v_lshlrev_b32 v29, 4, v29
 v_add_u32 v29, 122880, v29
 ds_read_b128 v[96:99], v29 offset:0
 ds_read_b128 v[100:103], v29 offset:64
 ds_read_b128 v[104:107], v29 offset:128
 ds_read_b128 v[108:111], v29 offset:192
 v_lshlrev_b32 v112, 16, v240
 v_and_b32 v113, 0xffff0000, v240
 v_lshlrev_b32 v114, 16, v241
 v_and_b32 v115, 0xffff0000, v241
 v_lshlrev_b32 v116, 16, v242
 v_and_b32 v117, 0xffff0000, v242
 v_lshlrev_b32 v118, 16, v243
 v_and_b32 v119, 0xffff0000, v243
 v_lshlrev_b32 v120, 16, v244
 v_and_b32 v121, 0xffff0000, v244
 v_lshlrev_b32 v122, 16, v245
 v_and_b32 v123, 0xffff0000, v245
 v_lshlrev_b32 v124, 16, v246
 v_and_b32 v125, 0xffff0000, v246
 v_lshlrev_b32 v126, 16, v247
 v_and_b32 v127, 0xffff0000, v247
 v_mul_f32 v233, -v232, v233
 v_mul_f32 v235, -v234, v235
 v_mul_f32 v237, -v236, v237
 v_mul_f32 v239, -v238, v239
 s_mov_b32 s12, 0xbdd2d3e8
 s_mov_b32 s13, 0xbdd2d3e8
 v_mov_b32 v144, 0xc0135761
 v_mov_b32 v145, 0xc0135761
 s_waitcnt lgkmcnt(3)
 v_pk_fma_f32 v[128:129], v[96:97], v[232:233], v[112:113] op_sel:[0,1,0] op_sel_hi:[1,1,1]
 v_pk_fma_f32 v[130:131], v[98:99], v[232:233], v[114:115] op_sel:[0,1,0] op_sel_hi:[1,1,1]
 s_waitcnt lgkmcnt(2)
 v_pk_fma_f32 v[132:133], v[100:101], v[232:233], v[116:117] op_sel:[0,1,0] op_sel_hi:[1,1,1]
 v_pk_fma_f32 v[134:135], v[102:103], v[232:233], v[118:119] op_sel:[0,1,0] op_sel_hi:[1,1,1]
 v_pk_fma_f32 v[160:161], v[160:161], v[232:233], v[128:129] op_sel:[0,0,0] op_sel_hi:[1,0,1]
 v_pk_fma_f32 v[162:163], v[162:163], v[232:233], v[130:131] op_sel:[0,0,0] op_sel_hi:[1,0,1]
 v_pk_fma_f32 v[164:165], v[164:165], v[232:233], v[132:133] op_sel:[0,0,0] op_sel_hi:[1,0,1]
 v_pk_fma_f32 v[166:167], v[166:167], v[232:233], v[134:135] op_sel:[0,0,0] op_sel_hi:[1,0,1]
 v_pk_mul_f32 v[128:129], v[160:161], v[160:161]
 v_pk_mul_f32 v[130:131], v[162:163], v[162:163]
 v_pk_mul_f32 v[132:133], v[164:165], v[164:165]
 v_pk_mul_f32 v[134:135], v[166:167], v[166:167]
 v_pk_fma_f32 v[128:129], v[128:129], s[12:13], v[144:145]
 v_pk_fma_f32 v[130:131], v[130:131], s[12:13], v[144:145]
 v_pk_fma_f32 v[132:133], v[132:133], s[12:13], v[144:145]
 v_pk_fma_f32 v[134:135], v[134:135], s[12:13], v[144:145]
 v_pk_mul_f32 v[128:129], v[128:129], v[160:161]
 v_pk_mul_f32 v[130:131], v[130:131], v[162:163]
 v_pk_mul_f32 v[132:133], v[132:133], v[164:165]
 v_pk_mul_f32 v[134:135], v[134:135], v[166:167]
 buffer_store_dwordx4 a[192:195], v14, s[4:7], s16 offen offset:0 sc1
 v_exp_f32 v128, v128
 v_exp_f32 v129, v129
 v_exp_f32 v130, v130
 v_exp_f32 v131, v131
 v_exp_f32 v132, v132
 v_exp_f32 v133, v133
 v_exp_f32 v134, v134
 v_exp_f32 v135, v135
 v_pk_add_f32 v[128:129], v[128:129], 1.0 op_sel_hi:[1,0]
 v_pk_add_f32 v[130:131], v[130:131], 1.0 op_sel_hi:[1,0]
 v_pk_add_f32 v[132:133], v[132:133], 1.0 op_sel_hi:[1,0]
 v_pk_add_f32 v[134:135], v[134:135], 1.0 op_sel_hi:[1,0]
 v_rcp_f32 v128, v128
 v_rcp_f32 v129, v129
 v_rcp_f32 v130, v130
 v_rcp_f32 v131, v131
 v_rcp_f32 v132, v132
 v_rcp_f32 v133, v133
 v_rcp_f32 v134, v134
 v_rcp_f32 v135, v135
 v_pk_mul_f32 v[160:161], v[160:161], v[128:129]
 v_pk_mul_f32 v[162:163], v[162:163], v[130:131]
 v_pk_mul_f32 v[164:165], v[164:165], v[132:133]
 v_pk_mul_f32 v[166:167], v[166:167], v[134:135]
 v_cvt_pk_bf16_f32 v160, v160, v161
 v_cvt_pk_bf16_f32 v161, v162, v163
 v_cvt_pk_bf16_f32 v162, v164, v165
 v_cvt_pk_bf16_f32 v163, v166, v167
 s_lshl_b32 s57, s93, 1
 s_add_u32 s57, s57, 0
 s_mul_i32 s57, s57, 186368
 s_lshl_b32 s58, s86, 11
 s_add_u32 s57, s57, s58
 s_add_u32 s57, s57, 39976960
 buffer_store_dwordx4 v[160:163], v14, s[4:7], s57 offen offset:0 sc1
 s_waitcnt lgkmcnt(0)
 v_pk_fma_f32 v[128:129], v[104:105], v[232:233], v[120:121] op_sel:[0,1,0] op_sel_hi:[1,1,1]
 v_pk_fma_f32 v[130:131], v[106:107], v[232:233], v[122:123] op_sel:[0,1,0] op_sel_hi:[1,1,1]
 v_pk_fma_f32 v[132:133], v[108:109], v[232:233], v[124:125] op_sel:[0,1,0] op_sel_hi:[1,1,1]
 v_pk_fma_f32 v[134:135], v[110:111], v[232:233], v[126:127] op_sel:[0,1,0] op_sel_hi:[1,1,1]
 v_pk_fma_f32 v[168:169], v[168:169], v[232:233], v[128:129] op_sel:[0,0,0] op_sel_hi:[1,0,1]
 v_pk_fma_f32 v[170:171], v[170:171], v[232:233], v[130:131] op_sel:[0,0,0] op_sel_hi:[1,0,1]
 v_pk_fma_f32 v[172:173], v[172:173], v[232:233], v[132:133] op_sel:[0,0,0] op_sel_hi:[1,0,1]
 v_pk_fma_f32 v[174:175], v[174:175], v[232:233], v[134:135] op_sel:[0,0,0] op_sel_hi:[1,0,1]
 v_pk_mul_f32 v[128:129], v[168:169], v[168:169]
 v_pk_mul_f32 v[130:131], v[170:171], v[170:171]
 v_pk_mul_f32 v[132:133], v[172:173], v[172:173]
 v_pk_mul_f32 v[134:135], v[174:175], v[174:175]
 v_pk_fma_f32 v[128:129], v[128:129], s[12:13], v[144:145]
 v_pk_fma_f32 v[130:131], v[130:131], s[12:13], v[144:145]
 v_pk_fma_f32 v[132:133], v[132:133], s[12:13], v[144:145]
 v_pk_fma_f32 v[134:135], v[134:135], s[12:13], v[144:145]
 v_pk_mul_f32 v[128:129], v[128:129], v[168:169]
 v_pk_mul_f32 v[130:131], v[130:131], v[170:171]
 v_pk_mul_f32 v[132:133], v[132:133], v[172:173]
 v_pk_mul_f32 v[134:135], v[134:135], v[174:175]
 buffer_store_dwordx4 a[196:199], v14, s[4:7], s16 offen offset:1024 sc1
 v_exp_f32 v128, v128
 v_exp_f32 v129, v129
 v_exp_f32 v130, v130
 v_exp_f32 v131, v131
 v_exp_f32 v132, v132
 v_exp_f32 v133, v133
 v_exp_f32 v134, v134
 v_exp_f32 v135, v135
 v_pk_add_f32 v[128:129], v[128:129], 1.0 op_sel_hi:[1,0]
 v_pk_add_f32 v[130:131], v[130:131], 1.0 op_sel_hi:[1,0]
 v_pk_add_f32 v[132:133], v[132:133], 1.0 op_sel_hi:[1,0]
 v_pk_add_f32 v[134:135], v[134:135], 1.0 op_sel_hi:[1,0]
 v_rcp_f32 v128, v128
 v_rcp_f32 v129, v129
 v_rcp_f32 v130, v130
 v_rcp_f32 v131, v131
 v_rcp_f32 v132, v132
 v_rcp_f32 v133, v133
 v_rcp_f32 v134, v134
 v_rcp_f32 v135, v135
 v_pk_mul_f32 v[168:169], v[168:169], v[128:129]
 v_pk_mul_f32 v[170:171], v[170:171], v[130:131]
 v_pk_mul_f32 v[172:173], v[172:173], v[132:133]
 v_pk_mul_f32 v[174:175], v[174:175], v[134:135]
 v_cvt_pk_bf16_f32 v168, v168, v169
 v_cvt_pk_bf16_f32 v169, v170, v171
 v_cvt_pk_bf16_f32 v170, v172, v173
 v_cvt_pk_bf16_f32 v171, v174, v175
 buffer_store_dwordx4 v[168:171], v14, s[4:7], s57 offen offset:1024 sc1
 v_pk_fma_f32 v[128:129], v[96:97], v[234:235], v[112:113] op_sel:[0,1,0] op_sel_hi:[1,1,1]
 v_pk_fma_f32 v[130:131], v[98:99], v[234:235], v[114:115] op_sel:[0,1,0] op_sel_hi:[1,1,1]
 v_pk_fma_f32 v[132:133], v[100:101], v[234:235], v[116:117] op_sel:[0,1,0] op_sel_hi:[1,1,1]
 v_pk_fma_f32 v[134:135], v[102:103], v[234:235], v[118:119] op_sel:[0,1,0] op_sel_hi:[1,1,1]
 v_pk_fma_f32 v[176:177], v[176:177], v[234:235], v[128:129] op_sel:[0,0,0] op_sel_hi:[1,0,1]
 v_pk_fma_f32 v[178:179], v[178:179], v[234:235], v[130:131] op_sel:[0,0,0] op_sel_hi:[1,0,1]
 v_pk_fma_f32 v[180:181], v[180:181], v[234:235], v[132:133] op_sel:[0,0,0] op_sel_hi:[1,0,1]
 v_pk_fma_f32 v[182:183], v[182:183], v[234:235], v[134:135] op_sel:[0,0,0] op_sel_hi:[1,0,1]
 v_pk_mul_f32 v[128:129], v[176:177], v[176:177]
 v_pk_mul_f32 v[130:131], v[178:179], v[178:179]
 v_pk_mul_f32 v[132:133], v[180:181], v[180:181]
 v_pk_mul_f32 v[134:135], v[182:183], v[182:183]
 v_pk_fma_f32 v[128:129], v[128:129], s[12:13], v[144:145]
 v_pk_fma_f32 v[130:131], v[130:131], s[12:13], v[144:145]
 v_pk_fma_f32 v[132:133], v[132:133], s[12:13], v[144:145]
 v_pk_fma_f32 v[134:135], v[134:135], s[12:13], v[144:145]
 v_pk_mul_f32 v[128:129], v[128:129], v[176:177]
 v_pk_mul_f32 v[130:131], v[130:131], v[178:179]
 v_pk_mul_f32 v[132:133], v[132:133], v[180:181]
 v_pk_mul_f32 v[134:135], v[134:135], v[182:183]
 buffer_store_dwordx4 a[200:203], v14, s[4:7], s17 offen offset:0 sc1
 v_exp_f32 v128, v128
 v_exp_f32 v129, v129
 v_exp_f32 v130, v130
 v_exp_f32 v131, v131
 v_exp_f32 v132, v132
 v_exp_f32 v133, v133
 v_exp_f32 v134, v134
 v_exp_f32 v135, v135
 v_pk_add_f32 v[128:129], v[128:129], 1.0 op_sel_hi:[1,0]
 v_pk_add_f32 v[130:131], v[130:131], 1.0 op_sel_hi:[1,0]
 v_pk_add_f32 v[132:133], v[132:133], 1.0 op_sel_hi:[1,0]
 v_pk_add_f32 v[134:135], v[134:135], 1.0 op_sel_hi:[1,0]
 v_rcp_f32 v128, v128
 v_rcp_f32 v129, v129
 v_rcp_f32 v130, v130
 v_rcp_f32 v131, v131
 v_rcp_f32 v132, v132
 v_rcp_f32 v133, v133
 v_rcp_f32 v134, v134
 v_rcp_f32 v135, v135
 v_pk_mul_f32 v[176:177], v[176:177], v[128:129]
 v_pk_mul_f32 v[178:179], v[178:179], v[130:131]
 v_pk_mul_f32 v[180:181], v[180:181], v[132:133]
 v_pk_mul_f32 v[182:183], v[182:183], v[134:135]
 v_cvt_pk_bf16_f32 v176, v176, v177
 v_cvt_pk_bf16_f32 v177, v178, v179
 v_cvt_pk_bf16_f32 v178, v180, v181
 v_cvt_pk_bf16_f32 v179, v182, v183
 s_lshl_b32 s57, s93, 1
 s_add_u32 s57, s57, 1
 s_mul_i32 s57, s57, 186368
 s_lshl_b32 s58, s86, 11
 s_add_u32 s57, s57, s58
 s_add_u32 s57, s57, 39976960
 buffer_store_dwordx4 v[176:179], v14, s[4:7], s57 offen offset:0 sc1
 v_pk_fma_f32 v[128:129], v[104:105], v[234:235], v[120:121] op_sel:[0,1,0] op_sel_hi:[1,1,1]
 v_pk_fma_f32 v[130:131], v[106:107], v[234:235], v[122:123] op_sel:[0,1,0] op_sel_hi:[1,1,1]
 v_pk_fma_f32 v[132:133], v[108:109], v[234:235], v[124:125] op_sel:[0,1,0] op_sel_hi:[1,1,1]
 v_pk_fma_f32 v[134:135], v[110:111], v[234:235], v[126:127] op_sel:[0,1,0] op_sel_hi:[1,1,1]
 v_pk_fma_f32 v[184:185], v[184:185], v[234:235], v[128:129] op_sel:[0,0,0] op_sel_hi:[1,0,1]
 v_pk_fma_f32 v[186:187], v[186:187], v[234:235], v[130:131] op_sel:[0,0,0] op_sel_hi:[1,0,1]
 v_pk_fma_f32 v[188:189], v[188:189], v[234:235], v[132:133] op_sel:[0,0,0] op_sel_hi:[1,0,1]
 v_pk_fma_f32 v[190:191], v[190:191], v[234:235], v[134:135] op_sel:[0,0,0] op_sel_hi:[1,0,1]
 v_pk_mul_f32 v[128:129], v[184:185], v[184:185]
 v_pk_mul_f32 v[130:131], v[186:187], v[186:187]
 v_pk_mul_f32 v[132:133], v[188:189], v[188:189]
 v_pk_mul_f32 v[134:135], v[190:191], v[190:191]
 v_pk_fma_f32 v[128:129], v[128:129], s[12:13], v[144:145]
 v_pk_fma_f32 v[130:131], v[130:131], s[12:13], v[144:145]
 v_pk_fma_f32 v[132:133], v[132:133], s[12:13], v[144:145]
 v_pk_fma_f32 v[134:135], v[134:135], s[12:13], v[144:145]
 v_pk_mul_f32 v[128:129], v[128:129], v[184:185]
 v_pk_mul_f32 v[130:131], v[130:131], v[186:187]
 v_pk_mul_f32 v[132:133], v[132:133], v[188:189]
 v_pk_mul_f32 v[134:135], v[134:135], v[190:191]
 buffer_store_dwordx4 a[204:207], v14, s[4:7], s17 offen offset:1024 sc1
 v_exp_f32 v128, v128
 v_exp_f32 v129, v129
 v_exp_f32 v130, v130
 v_exp_f32 v131, v131
 v_exp_f32 v132, v132
 v_exp_f32 v133, v133
 v_exp_f32 v134, v134
 v_exp_f32 v135, v135
 v_pk_add_f32 v[128:129], v[128:129], 1.0 op_sel_hi:[1,0]
 v_pk_add_f32 v[130:131], v[130:131], 1.0 op_sel_hi:[1,0]
 v_pk_add_f32 v[132:133], v[132:133], 1.0 op_sel_hi:[1,0]
 v_pk_add_f32 v[134:135], v[134:135], 1.0 op_sel_hi:[1,0]
 v_rcp_f32 v128, v128
 v_rcp_f32 v129, v129
 v_rcp_f32 v130, v130
 v_rcp_f32 v131, v131
 v_rcp_f32 v132, v132
 v_rcp_f32 v133, v133
 v_rcp_f32 v134, v134
 v_rcp_f32 v135, v135
 v_pk_mul_f32 v[184:185], v[184:185], v[128:129]
 v_pk_mul_f32 v[186:187], v[186:187], v[130:131]
 v_pk_mul_f32 v[188:189], v[188:189], v[132:133]
 v_pk_mul_f32 v[190:191], v[190:191], v[134:135]
 v_cvt_pk_bf16_f32 v184, v184, v185
 v_cvt_pk_bf16_f32 v185, v186, v187
 v_cvt_pk_bf16_f32 v186, v188, v189
 v_cvt_pk_bf16_f32 v187, v190, v191
 buffer_store_dwordx4 v[184:187], v14, s[4:7], s57 offen offset:1024 sc1
 v_pk_fma_f32 v[128:129], v[96:97], v[236:237], v[112:113] op_sel:[0,1,0] op_sel_hi:[1,1,1]
 v_pk_fma_f32 v[130:131], v[98:99], v[236:237], v[114:115] op_sel:[0,1,0] op_sel_hi:[1,1,1]
 v_pk_fma_f32 v[132:133], v[100:101], v[236:237], v[116:117] op_sel:[0,1,0] op_sel_hi:[1,1,1]
 v_pk_fma_f32 v[134:135], v[102:103], v[236:237], v[118:119] op_sel:[0,1,0] op_sel_hi:[1,1,1]
 v_pk_fma_f32 v[192:193], v[192:193], v[236:237], v[128:129] op_sel:[0,0,0] op_sel_hi:[1,0,1]
 v_pk_fma_f32 v[194:195], v[194:195], v[236:237], v[130:131] op_sel:[0,0,0] op_sel_hi:[1,0,1]
 v_pk_fma_f32 v[196:197], v[196:197], v[236:237], v[132:133] op_sel:[0,0,0] op_sel_hi:[1,0,1]
 v_pk_fma_f32 v[198:199], v[198:199], v[236:237], v[134:135] op_sel:[0,0,0] op_sel_hi:[1,0,1]
 v_pk_mul_f32 v[128:129], v[192:193], v[192:193]
 v_pk_mul_f32 v[130:131], v[194:195], v[194:195]
 v_pk_mul_f32 v[132:133], v[196:197], v[196:197]
 v_pk_mul_f32 v[134:135], v[198:199], v[198:199]
 v_pk_fma_f32 v[128:129], v[128:129], s[12:13], v[144:145]
 v_pk_fma_f32 v[130:131], v[130:131], s[12:13], v[144:145]
 v_pk_fma_f32 v[132:133], v[132:133], s[12:13], v[144:145]
 v_pk_fma_f32 v[134:135], v[134:135], s[12:13], v[144:145]
 v_pk_mul_f32 v[128:129], v[128:129], v[192:193]
 v_pk_mul_f32 v[130:131], v[130:131], v[194:195]
 v_pk_mul_f32 v[132:133], v[132:133], v[196:197]
 v_pk_mul_f32 v[134:135], v[134:135], v[198:199]
 buffer_store_dwordx4 a[208:211], v14, s[4:7], s18 offen offset:0 sc1
 v_exp_f32 v128, v128
 v_exp_f32 v129, v129
 v_exp_f32 v130, v130
 v_exp_f32 v131, v131
 v_exp_f32 v132, v132
 v_exp_f32 v133, v133
 v_exp_f32 v134, v134
 v_exp_f32 v135, v135
 v_pk_add_f32 v[128:129], v[128:129], 1.0 op_sel_hi:[1,0]
 v_pk_add_f32 v[130:131], v[130:131], 1.0 op_sel_hi:[1,0]
 v_pk_add_f32 v[132:133], v[132:133], 1.0 op_sel_hi:[1,0]
 v_pk_add_f32 v[134:135], v[134:135], 1.0 op_sel_hi:[1,0]
 v_rcp_f32 v128, v128
 v_rcp_f32 v129, v129
 v_rcp_f32 v130, v130
 v_rcp_f32 v131, v131
 v_rcp_f32 v132, v132
 v_rcp_f32 v133, v133
 v_rcp_f32 v134, v134
 v_rcp_f32 v135, v135
 v_pk_mul_f32 v[192:193], v[192:193], v[128:129]
 v_pk_mul_f32 v[194:195], v[194:195], v[130:131]
 v_pk_mul_f32 v[196:197], v[196:197], v[132:133]
 v_pk_mul_f32 v[198:199], v[198:199], v[134:135]
 v_cvt_pk_bf16_f32 v192, v192, v193
 v_cvt_pk_bf16_f32 v193, v194, v195
 v_cvt_pk_bf16_f32 v194, v196, v197
 v_cvt_pk_bf16_f32 v195, v198, v199
 s_lshl_b32 s57, s94, 1
 s_add_u32 s57, s57, 0
 s_mul_i32 s57, s57, 186368
 s_lshl_b32 s58, s86, 11
 s_add_u32 s57, s57, s58
 s_add_u32 s57, s57, 39976960
 buffer_store_dwordx4 v[192:195], v14, s[4:7], s57 offen offset:0 sc1
 v_pk_fma_f32 v[128:129], v[104:105], v[236:237], v[120:121] op_sel:[0,1,0] op_sel_hi:[1,1,1]
 v_pk_fma_f32 v[130:131], v[106:107], v[236:237], v[122:123] op_sel:[0,1,0] op_sel_hi:[1,1,1]
 v_pk_fma_f32 v[132:133], v[108:109], v[236:237], v[124:125] op_sel:[0,1,0] op_sel_hi:[1,1,1]
 v_pk_fma_f32 v[134:135], v[110:111], v[236:237], v[126:127] op_sel:[0,1,0] op_sel_hi:[1,1,1]
 v_pk_fma_f32 v[200:201], v[200:201], v[236:237], v[128:129] op_sel:[0,0,0] op_sel_hi:[1,0,1]
 v_pk_fma_f32 v[202:203], v[202:203], v[236:237], v[130:131] op_sel:[0,0,0] op_sel_hi:[1,0,1]
 v_pk_fma_f32 v[204:205], v[204:205], v[236:237], v[132:133] op_sel:[0,0,0] op_sel_hi:[1,0,1]
 v_pk_fma_f32 v[206:207], v[206:207], v[236:237], v[134:135] op_sel:[0,0,0] op_sel_hi:[1,0,1]
 v_pk_mul_f32 v[128:129], v[200:201], v[200:201]
 v_pk_mul_f32 v[130:131], v[202:203], v[202:203]
 v_pk_mul_f32 v[132:133], v[204:205], v[204:205]
 v_pk_mul_f32 v[134:135], v[206:207], v[206:207]
 v_pk_fma_f32 v[128:129], v[128:129], s[12:13], v[144:145]
 v_pk_fma_f32 v[130:131], v[130:131], s[12:13], v[144:145]
 v_pk_fma_f32 v[132:133], v[132:133], s[12:13], v[144:145]
 v_pk_fma_f32 v[134:135], v[134:135], s[12:13], v[144:145]
 v_pk_mul_f32 v[128:129], v[128:129], v[200:201]
 v_pk_mul_f32 v[130:131], v[130:131], v[202:203]
 v_pk_mul_f32 v[132:133], v[132:133], v[204:205]
 v_pk_mul_f32 v[134:135], v[134:135], v[206:207]
 buffer_store_dwordx4 a[212:215], v14, s[4:7], s18 offen offset:1024 sc1
 v_exp_f32 v128, v128
 v_exp_f32 v129, v129
 v_exp_f32 v130, v130
 v_exp_f32 v131, v131
 v_exp_f32 v132, v132
 v_exp_f32 v133, v133
 v_exp_f32 v134, v134
 v_exp_f32 v135, v135
 v_pk_add_f32 v[128:129], v[128:129], 1.0 op_sel_hi:[1,0]
 v_pk_add_f32 v[130:131], v[130:131], 1.0 op_sel_hi:[1,0]
 v_pk_add_f32 v[132:133], v[132:133], 1.0 op_sel_hi:[1,0]
 v_pk_add_f32 v[134:135], v[134:135], 1.0 op_sel_hi:[1,0]
 v_rcp_f32 v128, v128
 v_rcp_f32 v129, v129
 v_rcp_f32 v130, v130
 v_rcp_f32 v131, v131
 v_rcp_f32 v132, v132
 v_rcp_f32 v133, v133
 v_rcp_f32 v134, v134
 v_rcp_f32 v135, v135
 v_pk_mul_f32 v[200:201], v[200:201], v[128:129]
 v_pk_mul_f32 v[202:203], v[202:203], v[130:131]
 v_pk_mul_f32 v[204:205], v[204:205], v[132:133]
 v_pk_mul_f32 v[206:207], v[206:207], v[134:135]
 v_cvt_pk_bf16_f32 v200, v200, v201
 v_cvt_pk_bf16_f32 v201, v202, v203
 v_cvt_pk_bf16_f32 v202, v204, v205
 v_cvt_pk_bf16_f32 v203, v206, v207
 buffer_store_dwordx4 v[200:203], v14, s[4:7], s57 offen offset:1024 sc1
 v_pk_fma_f32 v[128:129], v[96:97], v[238:239], v[112:113] op_sel:[0,1,0] op_sel_hi:[1,1,1]
 v_pk_fma_f32 v[130:131], v[98:99], v[238:239], v[114:115] op_sel:[0,1,0] op_sel_hi:[1,1,1]
 v_pk_fma_f32 v[132:133], v[100:101], v[238:239], v[116:117] op_sel:[0,1,0] op_sel_hi:[1,1,1]
 v_pk_fma_f32 v[134:135], v[102:103], v[238:239], v[118:119] op_sel:[0,1,0] op_sel_hi:[1,1,1]
 v_pk_fma_f32 v[208:209], v[208:209], v[238:239], v[128:129] op_sel:[0,0,0] op_sel_hi:[1,0,1]
 v_pk_fma_f32 v[210:211], v[210:211], v[238:239], v[130:131] op_sel:[0,0,0] op_sel_hi:[1,0,1]
 v_pk_fma_f32 v[212:213], v[212:213], v[238:239], v[132:133] op_sel:[0,0,0] op_sel_hi:[1,0,1]
 v_pk_fma_f32 v[214:215], v[214:215], v[238:239], v[134:135] op_sel:[0,0,0] op_sel_hi:[1,0,1]
 v_pk_mul_f32 v[128:129], v[208:209], v[208:209]
 v_pk_mul_f32 v[130:131], v[210:211], v[210:211]
 v_pk_mul_f32 v[132:133], v[212:213], v[212:213]
 v_pk_mul_f32 v[134:135], v[214:215], v[214:215]
 v_pk_fma_f32 v[128:129], v[128:129], s[12:13], v[144:145]
 v_pk_fma_f32 v[130:131], v[130:131], s[12:13], v[144:145]
 v_pk_fma_f32 v[132:133], v[132:133], s[12:13], v[144:145]
 v_pk_fma_f32 v[134:135], v[134:135], s[12:13], v[144:145]
 v_pk_mul_f32 v[128:129], v[128:129], v[208:209]
 v_pk_mul_f32 v[130:131], v[130:131], v[210:211]
 v_pk_mul_f32 v[132:133], v[132:133], v[212:213]
 v_pk_mul_f32 v[134:135], v[134:135], v[214:215]
 buffer_store_dwordx4 a[216:219], v14, s[4:7], s19 offen offset:0 sc1
 v_exp_f32 v128, v128
 v_exp_f32 v129, v129
 v_exp_f32 v130, v130
 v_exp_f32 v131, v131
 v_exp_f32 v132, v132
 v_exp_f32 v133, v133
 v_exp_f32 v134, v134
 v_exp_f32 v135, v135
 v_pk_add_f32 v[128:129], v[128:129], 1.0 op_sel_hi:[1,0]
 v_pk_add_f32 v[130:131], v[130:131], 1.0 op_sel_hi:[1,0]
 v_pk_add_f32 v[132:133], v[132:133], 1.0 op_sel_hi:[1,0]
 v_pk_add_f32 v[134:135], v[134:135], 1.0 op_sel_hi:[1,0]
 v_rcp_f32 v128, v128
 v_rcp_f32 v129, v129
 v_rcp_f32 v130, v130
 v_rcp_f32 v131, v131
 v_rcp_f32 v132, v132
 v_rcp_f32 v133, v133
 v_rcp_f32 v134, v134
 v_rcp_f32 v135, v135
 v_pk_mul_f32 v[208:209], v[208:209], v[128:129]
 v_pk_mul_f32 v[210:211], v[210:211], v[130:131]
 v_pk_mul_f32 v[212:213], v[212:213], v[132:133]
 v_pk_mul_f32 v[214:215], v[214:215], v[134:135]
 v_cvt_pk_bf16_f32 v208, v208, v209
 v_cvt_pk_bf16_f32 v209, v210, v211
 v_cvt_pk_bf16_f32 v210, v212, v213
 v_cvt_pk_bf16_f32 v211, v214, v215
 s_lshl_b32 s57, s94, 1
 s_add_u32 s57, s57, 1
 s_mul_i32 s57, s57, 186368
 s_lshl_b32 s58, s86, 11
 s_add_u32 s57, s57, s58
 s_add_u32 s57, s57, 39976960
 buffer_store_dwordx4 v[208:211], v14, s[4:7], s57 offen offset:0 sc1
 v_pk_fma_f32 v[128:129], v[104:105], v[238:239], v[120:121] op_sel:[0,1,0] op_sel_hi:[1,1,1]
 v_pk_fma_f32 v[130:131], v[106:107], v[238:239], v[122:123] op_sel:[0,1,0] op_sel_hi:[1,1,1]
 v_pk_fma_f32 v[132:133], v[108:109], v[238:239], v[124:125] op_sel:[0,1,0] op_sel_hi:[1,1,1]
 v_pk_fma_f32 v[134:135], v[110:111], v[238:239], v[126:127] op_sel:[0,1,0] op_sel_hi:[1,1,1]
 v_pk_fma_f32 v[216:217], v[216:217], v[238:239], v[128:129] op_sel:[0,0,0] op_sel_hi:[1,0,1]
 v_pk_fma_f32 v[218:219], v[218:219], v[238:239], v[130:131] op_sel:[0,0,0] op_sel_hi:[1,0,1]
 v_pk_fma_f32 v[220:221], v[220:221], v[238:239], v[132:133] op_sel:[0,0,0] op_sel_hi:[1,0,1]
 v_pk_fma_f32 v[222:223], v[222:223], v[238:239], v[134:135] op_sel:[0,0,0] op_sel_hi:[1,0,1]
 v_pk_mul_f32 v[128:129], v[216:217], v[216:217]
 v_pk_mul_f32 v[130:131], v[218:219], v[218:219]
 v_pk_mul_f32 v[132:133], v[220:221], v[220:221]
 v_pk_mul_f32 v[134:135], v[222:223], v[222:223]
 v_pk_fma_f32 v[128:129], v[128:129], s[12:13], v[144:145]
 v_pk_fma_f32 v[130:131], v[130:131], s[12:13], v[144:145]
 v_pk_fma_f32 v[132:133], v[132:133], s[12:13], v[144:145]
 v_pk_fma_f32 v[134:135], v[134:135], s[12:13], v[144:145]
 v_pk_mul_f32 v[128:129], v[128:129], v[216:217]
 v_pk_mul_f32 v[130:131], v[130:131], v[218:219]
 v_pk_mul_f32 v[132:133], v[132:133], v[220:221]
 v_pk_mul_f32 v[134:135], v[134:135], v[222:223]
 buffer_store_dwordx4 a[220:223], v14, s[4:7], s19 offen offset:1024 sc1
 v_exp_f32 v128, v128
 v_exp_f32 v129, v129
 v_exp_f32 v130, v130
 v_exp_f32 v131, v131
 v_exp_f32 v132, v132
 v_exp_f32 v133, v133
 v_exp_f32 v134, v134
 v_exp_f32 v135, v135
 v_pk_add_f32 v[128:129], v[128:129], 1.0 op_sel_hi:[1,0]
 v_pk_add_f32 v[130:131], v[130:131], 1.0 op_sel_hi:[1,0]
 v_pk_add_f32 v[132:133], v[132:133], 1.0 op_sel_hi:[1,0]
 v_pk_add_f32 v[134:135], v[134:135], 1.0 op_sel_hi:[1,0]
 v_rcp_f32 v128, v128
 v_rcp_f32 v129, v129
 v_rcp_f32 v130, v130
 v_rcp_f32 v131, v131
 v_rcp_f32 v132, v132
 v_rcp_f32 v133, v133
 v_rcp_f32 v134, v134
 v_rcp_f32 v135, v135
 v_pk_mul_f32 v[216:217], v[216:217], v[128:129]
 v_pk_mul_f32 v[218:219], v[218:219], v[130:131]
 v_pk_mul_f32 v[220:221], v[220:221], v[132:133]
 v_pk_mul_f32 v[222:223], v[222:223], v[134:135]
 v_cvt_pk_bf16_f32 v216, v216, v217
 v_cvt_pk_bf16_f32 v217, v218, v219
 v_cvt_pk_bf16_f32 v218, v220, v221
 v_cvt_pk_bf16_f32 v219, v222, v223
 buffer_store_dwordx4 v[216:219], v14, s[4:7], s57 offen offset:1024 sc1
 s_nop 1
 s_branch L_parall_8
L_parall_7:
L_C:
 buffer_store_dwordx4 a[192:195], v14, s[4:7], s16 offen offset:0 sc1
 buffer_store_dwordx4 a[196:199], v14, s[4:7], s16 offen offset:1024 sc1
 buffer_store_dwordx4 a[200:203], v14, s[4:7], s17 offen offset:0 sc1
 buffer_store_dwordx4 a[204:207], v14, s[4:7], s17 offen offset:1024 sc1
 buffer_store_dwordx4 a[208:211], v14, s[4:7], s18 offen offset:0 sc1
 buffer_store_dwordx4 a[212:215], v14, s[4:7], s18 offen offset:1024 sc1
 buffer_store_dwordx4 a[216:219], v14, s[4:7], s19 offen offset:0 sc1
 buffer_store_dwordx4 a[220:223], v14, s[4:7], s19 offen offset:1024 sc1
L_parall_8:
 s_mov_b64 s[32:33], s[4:5]
 s_mov_b32 s35, 0x00020000
 s_add_u32 s34, s95, 2
 s_lshl_b32 s34, s34, 15
 s_lshl_b32 s57, s84, 20
 s_add_u32 s34, s34, s57
 s_mov_b32 s18, 0
 v_add_u32 v23, 65536, v14
 s_add_u32 s90, s92, 65536
 s_add_u32 s91, s65, 32768
 s_add_u32 s87, s65, 16384
 s_mov_b32 s14, 0x5f800000
 s_mov_b32 s15, 0xf149f2ca
 v_and_b32 v29, 31, v0
 v_lshrrev_b32 v30, 5, v0
 v_lshlrev_b32 v30, 2, v30
 v_sub_u32 v29, v29, v30
 v_cmp_gt_i32 s[8:9], 0, v29
 v_cmp_gt_i32 s[10:11], 1, v29
 v_cmp_gt_i32 s[36:37], 2, v29
 v_cmp_gt_i32 s[38:39], 3, v29
 v_cndmask_b32 v240, 0, 1.0, s[8:9]
 v_cndmask_b32 v241, 0, 1.0, s[10:11]
 ds_read_b128 a[128:131], v23 offset:0
 ds_read_b128 a[132:135], v23 offset:1024
 ds_read_b128 a[136:139], v23 offset:2048
 ds_read_b128 a[140:143], v23 offset:3072
 ds_read_b128 a[144:147], v23 offset:4096
 s_waitcnt lgkmcnt(4)
 v_mfma_f32_32x32x16_bf16 v[96:111], a[128:131], v[32:35], 0
 ds_read_b128 a[148:151], v23 offset:5120
 v_cndmask_b32 v242, 0, 1.0, s[36:37]
 v_cndmask_b32 v243, 0, 1.0, s[38:39]
 v_cmp_gt_i32 s[8:9], 8, v29
 v_cmp_gt_i32 s[10:11], 9, v29
 v_cmp_gt_i32 s[36:37], 10, v29
 v_mfma_f32_32x32x16_bf16 v[112:127], a[128:131], v[64:67], 0
 s_or_b32 m0, s91, 0x10000
 v_cmp_gt_i32 s[38:39], 11, v29
 v_cndmask_b32 v244, 0, 1.0, s[8:9]
 v_cndmask_b32 v245, 0, 1.0, s[10:11]
 v_cndmask_b32 v246, 0, 1.0, s[36:37]
 s_waitcnt lgkmcnt(4)
 v_mfma_f32_32x32x16_bf16 v[96:111], a[132:135], v[48:51], v[96:111]
 ds_read_b128 a[152:155], v23 offset:6144
 buffer_load_dwordx4 v14, s[32:35], s90 offen offset:0 sc1 lds
 v_cndmask_b32 v247, 0, 1.0, s[38:39]
 v_cmp_gt_i32 s[8:9], 16, v29
 v_cmp_gt_i32 s[10:11], 17, v29
 v_mfma_f32_32x32x16_bf16 v[112:127], a[132:135], v[80:83], v[112:127]
 buffer_load_dwordx4 v14, s[32:35], s90 offen offset:1024 sc1 lds
 v_cmp_gt_i32 s[36:37], 18, v29
 v_cmp_gt_i32 s[38:39], 19, v29
 v_cndmask_b32 v248, 0, 1.0, s[8:9]
 s_waitcnt lgkmcnt(4)
 v_mfma_f32_32x32x16_bf16 v[96:111], a[136:139], v[36:39], v[96:111]
 ds_read_b128 a[156:159], v23 offset:7168
 buffer_load_dwordx4 v14, s[32:35], s90 offen offset:2048 sc1 lds
 v_cndmask_b32 v249, 0, 1.0, s[10:11]
 v_cndmask_b32 v250, 0, 1.0, s[36:37]
 v_cndmask_b32 v251, 0, 1.0, s[38:39]
 v_mfma_f32_32x32x16_bf16 v[112:127], a[136:139], v[68:71], v[112:127]
 v_cmp_gt_i32 s[8:9], 24, v29
 v_cmp_gt_i32 s[10:11], 25, v29
 v_cmp_gt_i32 s[36:37], 26, v29
 v_cmp_gt_i32 s[38:39], 27, v29
 v_cndmask_b32 v252, 0, 1.0, s[8:9]
 s_waitcnt lgkmcnt(2)
 v_mfma_f32_32x32x16_bf16 v[96:111], a[140:143], v[52:55], v[96:111]
 ds_read_b128 a[160:163], v23 offset:8192
 buffer_load_dwordx4 v14, s[32:35], s90 offen offset:3072 sc1 lds
 v_cndmask_b32 v253, 0, 1.0, s[10:11]
 v_cndmask_b32 v254, 0, 1.0, s[36:37]
 v_cndmask_b32 v255, 0, 1.0, s[38:39]
 v_mfma_f32_32x32x16_bf16 v[112:127], a[140:143], v[84:87], v[112:127]
 s_xor_b32 m0, s87, 0xc000
 s_sub_u32 s57, 65536, s65
 v_add_u32 v236, s57, v14
 s_lshl_b32 s17, s85, 1
 s_add_u32 s16, s17, 2
 v_bfe_u32 v29, v0, 4, 1
 v_mfma_f32_32x32x16_bf16 v[96:111], a[144:147], v[40:43], v[96:111]
 ds_read_b128 a[164:167], v23 offset:9216
 s_add_u32 s56, s90, 4294950912
 v_mul_u32_u24 v29, 186368, v29
 v_and_b32 v30, 15, v0
 v_lshl_add_u32 v29, v30, 4, v29
 v_lshrrev_b32 v30, 5, v0
 v_mfma_f32_32x32x16_bf16 v[112:127], a[144:147], v[72:75], v[112:127]
 buffer_load_dwordx4 v14, s[32:35], s56 offen offset:0 sc1 lds
 v_lshl_add_u32 v25, v30, 8, v29
 s_bfe_u32 s66, s2, 0x20001
 s_xor_b32 s28, s2, s66
 s_and_b32 s28, s28, 1
 v_mfma_f32_32x32x16_bf16 v[96:111], a[148:151], v[56:59], v[96:111]
 ds_read_b128 a[168:171], v23 offset:10240
 s_lshl_b32 s28, s28, 3
 s_lshr_b32 s67, s2, 5
 s_add_u32 s67, s67, s28
 s_bfe_u32 s68, s2, 0x20003
 s_lshl_b32 s75, s67, 2
 v_mfma_f32_32x32x16_bf16 v[112:127], a[148:151], v[88:91], v[112:127]
 buffer_load_dwordx4 v14, s[32:35], s56 offen offset:1024 sc1 lds
 s_add_u32 s75, s75, s68
 s_and_b32 s28, s2, 1
 s_mul_i32 s28, s28, 4
 s_waitcnt lgkmcnt(2)
 v_mfma_f32_32x32x16_bf16 v[96:111], a[152:155], v[44:47], v[96:111]
 ds_read_b128 a[172:175], v23 offset:11264
 buffer_load_dwordx4 v14, s[32:35], s56 offen offset:2048 sc1 lds
 s_add_u32 s28, s28, 12
 s_lshr_b32 s29, s66, 1
 s_sub_u32 s28, s28, s29
 v_mfma_f32_32x32x16_bf16 v[112:127], a[152:155], v[76:79], v[112:127]
 buffer_load_dwordx4 v14, s[32:35], s56 offen offset:3072 sc1 lds
 s_and_b32 s30, s66, 1
 s_mul_i32 s28, s28, s30
 s_mul_i32 s29, s29, 27
 s_add_u32 s28, s28, s29
 v_mfma_f32_32x32x16_bf16 v[96:111], a[156:159], v[60:63], v[96:111]
 ds_read_b128 a[176:179], v23 offset:12288
 s_add_u32 s28, s28, 128
 s_lshl_b32 s29, s66, 5
 s_mul_i32 s30, s68, 182
 s_mul_i32 s74, s3, 5120
 s_add_u32 s69, s30, s28
 v_mfma_f32_32x32x16_bf16 v[112:127], a[156:159], v[92:95], v[112:127]
 s_mul_i32 s69, s69, 10240
 s_add_u32 s69, s69, s74
 s_add_u32 s69, s69, 63963136
 s_add_u32 s70, s30, s29
 s_mul_i32 s70, s70, 10240
 s_add_u32 s70, s70, s74
 v_mfma_f32_32x32x16_bf16 v[128:143], a[160:163], v[32:35], 0
 ds_read_b128 a[180:183], v23 offset:13312
 s_add_u32 s70, s70, 63963136
 s_lshl_b32 s30, s67, 3
 s_lshl_b32 s73, s3, 1
 s_add_u32 s30, s30, s73
 s_mul_i32 s30, s30, 182
 v_mfma_f32_32x32x16_bf16 v[144:159], a[160:163], v[64:67], 0
 s_add_u32 s71, s30, s28
 s_lshl_b32 s71, s71, 10
 s_add_u32 s71, s71, 39845888
 s_add_u32 s72, s30, s29
 s_lshl_b32 s72, s72, 10
 s_waitcnt lgkmcnt(2)
 v_mfma_f32_32x32x16_bf16 v[128:143], a[164:167], v[48:51], v[128:143]
 s_add_u32 s72, s72, 39845888
 s_cmp_lt_u32 s66, 2
 s_cselect_b32 s73, s71, 268435456
 s_lshr_b32 s28, s66, 1
 s_mul_i32 s28, s28, 186368
 s_sub_u32 s29, 186368, s28
 v_add_u32 v2, s28, v14
 v_add_u32 v3, s29, v14
 s_and_b32 s28, s66, 1
 s_mul_i32 s28, s28, 5120
 v_add_u32 v4, s28, v14
 v_subrev_u32 v7, s28, v14
 v_add_u32 v7, 5120, v7
 v_add_u32 v5, 61440, v4
 v_add_u32 v6, 122880, v4
 v_add_u32 v8, 61440, v7
 v_add_u32 v9, 122880, v7
 s_sub_u32 s28, 15, s67
 s_min_u32 s28, s28, s67
 s_lshl_b32 s78, s28, 12
 s_add_u32 s78, s78, 39387136
 s_lshl_b32 s77, s66, 10
 s_add_u32 s77, s77, s78
 s_add_u32 s77, s77, 32768
 s_lshl_b32 s79, s85, 5
 s_add_u32 s79, s79, s84
 s_lshl_b32 s79, s79, 7
 s_add_u32 s79, s79, 39387136
 s_lshl_b32 s28, s3, 13
 s_add_u32 s28, s28, 39387136
 v_lshl_add_u32 v12, v0, 7, s28
 v_and_b32 v13, 3, v0
 v_lshlrev_b32 v13, 7, v13
 v_mfma_f32_32x32x16_bf16 v[144:159], a[164:167], v[80:83], v[144:159]
 ds_read_b128 a[184:187], v23 offset:14336
 s_lshl_b32 s19, s18, 1
 s_add_u32 s19, s19, 0
 s_cmp_ge_u32 s19, s93
 s_cbranch_scc1 M_parall_9
MB_parall_10:
 v_mfma_f32_32x32x16_bf16 v[128:143], a[168:171], v[36:39], v[128:143]
 v_max3_f32 v232, v96, v97, v98
 v_max3_f32 v232, v232, v99, v100
 v_max3_f32 v232, v232, v101, v102
 v_max3_f32 v232, v232, v103, v104
 v_max3_f32 v232, v232, v105, v106
 ds_read_b128 a[188:191], v23 offset:15360
 v_mfma_f32_32x32x16_bf16 v[144:159], a[168:171], v[68:71], v[144:159]
 v_max3_f32 v232, v232, v107, v108
 v_max3_f32 v232, v232, v109, v110
 v_max_f32 v232, v232, v111
 v_mov_b32 v235, v232
 s_nop 1
 v_permlane32_swap_b32 v232, v235
 v_mfma_f32_32x32x16_bf16 v[128:143], a[172:175], v[52:55], v[128:143]
 v_max_f32 v232, v232, v235
 v_max3_f32 v233, v112, v113, v114
 v_max3_f32 v233, v233, v115, v116
 v_max3_f32 v233, v233, v117, v118
 v_max3_f32 v233, v233, v119, v120
 v_max3_f32 v233, v233, v121, v122
 v_mfma_f32_32x32x16_bf16 v[144:159], a[172:175], v[84:87], v[144:159]
 v_max3_f32 v233, v233, v123, v124
 v_max3_f32 v233, v233, v125, v126
 v_max_f32 v233, v233, v127
 v_mov_b32 v235, v233
 s_nop 1
 v_permlane32_swap_b32 v233, v235
 s_waitcnt lgkmcnt(1)
 v_mfma_f32_32x32x16_bf16 v[128:143], a[176:179], v[40:43], v[128:143]
 v_max_f32 v233, v233, v235
 v_sub_f32 v96, v96, v232
 v_sub_f32 v97, v97, v232
 v_sub_f32 v98, v98, v232
 v_sub_f32 v99, v99, v232
 v_sub_f32 v100, v100, v232
 v_mfma_f32_32x32x16_bf16 v[144:159], a[176:179], v[72:75], v[144:159]
 v_sub_f32 v101, v101, v232
 v_sub_f32 v102, v102, v232
 v_sub_f32 v103, v103, v232
 v_sub_f32 v104, v104, v232
 v_sub_f32 v105, v105, v232
 v_sub_f32 v106, v106, v232
 v_mfma_f32_32x32x16_bf16 v[128:143], a[180:183], v[56:59], v[128:143]
 v_sub_f32 v107, v107, v232
 v_sub_f32 v108, v108, v232
 v_sub_f32 v109, v109, v232
 v_sub_f32 v110, v110, v232
 v_sub_f32 v111, v111, v232
 v_sub_f32 v112, v112, v233
 v_mfma_f32_32x32x16_bf16 v[144:159], a[180:183], v[88:91], v[144:159]
 v_sub_f32 v113, v113, v233
 v_sub_f32 v114, v114, v233
 v_sub_f32 v115, v115, v233
 v_sub_f32 v116, v116, v233
 v_sub_f32 v117, v117, v233
 v_sub_f32 v118, v118, v233
 v_mfma_f32_32x32x16_bf16 v[128:143], a[184:187], v[44:47], v[128:143]
 v_sub_f32 v119, v119, v233
 v_sub_f32 v120, v120, v233
 v_sub_f32 v121, v121, v233
 v_sub_f32 v122, v122, v233
 v_sub_f32 v123, v123, v233
 v_sub_f32 v124, v124, v233
 v_mfma_f32_32x32x16_bf16 v[144:159], a[184:187], v[76:79], v[144:159]
 v_sub_f32 v125, v125, v233
 v_sub_f32 v126, v126, v233
 v_sub_f32 v127, v127, v233
 v_sub_f32 v192, 0, v232
 v_sub_f32 v193, 0, v232
 s_waitcnt lgkmcnt(0)
 v_mfma_f32_32x32x16_bf16 v[128:143], a[188:191], v[60:63], v[128:143]
 v_sub_f32 v194, 0, v232
 v_sub_f32 v195, 0, v232
 v_sub_f32 v196, 0, v232
 v_sub_f32 v197, 0, v232
 v_sub_f32 v198, 0, v232
 v_sub_f32 v199, 0, v232
 v_mfma_f32_32x32x16_bf16 v[144:159], a[188:191], v[92:95], v[144:159]
 v_sub_f32 v200, 0, v232
 v_sub_f32 v201, 0, v232
 v_sub_f32 v202, 0, v232
 v_sub_f32 v203, 0, v232
 v_sub_f32 v204, 0, v232
 v_sub_f32 v205, 0, v232
 v_sub_f32 v206, 0, v232
 v_sub_f32 v207, 0, v232
 v_sub_f32 v208, 0, v233
 v_sub_f32 v209, 0, v233
 v_sub_f32 v210, 0, v233
 v_sub_f32 v211, 0, v233
 v_sub_f32 v212, 0, v233
 v_sub_f32 v213, 0, v233
 v_sub_f32 v214, 0, v233
 v_sub_f32 v215, 0, v233
 v_sub_f32 v216, 0, v233
 v_sub_f32 v217, 0, v233
 v_sub_f32 v218, 0, v233
 v_sub_f32 v219, 0, v233
 v_sub_f32 v220, 0, v233
 v_sub_f32 v221, 0, v233
 v_sub_f32 v222, 0, v233
 v_sub_f32 v223, 0, v233
 s_lshl_b32 s19, s18, 1
 s_add_u32 s19, s19, 1
 s_cmp_ge_u32 s19, s93
 s_cbranch_scc1 M_parall_11
MB_parall_12:
 v_xor_b32 v24, 0x1c000, v23
 v_add_u32 v23, s87, v236
 s_mov_b32 s87, s91
 s_add_u32 s91, s91, 16384
 s_and_b32 s91, s91, 0xffff
 s_add_u32 s90, s90, 32768
 s_add_u32 s18, s18, 1
 v_exp_f32 v224, v96
 v_exp_f32 v225, v97
 v_exp_f32 v226, v98
 v_exp_f32 v227, v99
 v_add_f32 v228, v224, v225
 v_cvt_pk_bf16_f32 v160, v224, v225
 v_exp_f32 v224, v100
 v_exp_f32 v225, v101
 v_add_f32 v228, v228, v226
 v_cvt_pk_bf16_f32 v161, v226, v227
 v_add_f32 v228, v228, v227
 v_exp_f32 v226, v102
 v_exp_f32 v227, v103
 v_add_f32 v228, v228, v224
 v_cvt_pk_bf16_f32 v162, v224, v225
 v_add_f32 v228, v228, v225
 v_exp_f32 v224, v104
 v_exp_f32 v225, v105
 v_add_f32 v228, v228, v226
 v_cvt_pk_bf16_f32 v163, v226, v227
 v_add_f32 v228, v228, v227
 v_exp_f32 v226, v106
 v_exp_f32 v227, v107
 v_add_f32 v228, v228, v224
 v_cvt_pk_bf16_f32 v164, v224, v225
 v_add_f32 v228, v228, v225
 v_exp_f32 v224, v108
 v_exp_f32 v225, v109
 v_add_f32 v228, v228, v226
 v_cvt_pk_bf16_f32 v165, v226, v227
 v_add_f32 v228, v228, v227
 v_exp_f32 v226, v110
 v_exp_f32 v227, v111
 v_add_f32 v228, v228, v224
 v_cvt_pk_bf16_f32 v166, v224, v225
 v_add_f32 v228, v228, v225
 v_exp_f32 v224, v112
 v_exp_f32 v225, v113
 v_add_f32 v228, v228, v226
 v_cvt_pk_bf16_f32 v167, v226, v227
 v_sub_f32 v128, v128, v232
 v_sub_f32 v129, v129, v232
 v_sub_f32 v130, v130, v232
 v_sub_f32 v131, v131, v232
 v_sub_f32 v132, v132, v232
 v_sub_f32 v133, v133, v232
 v_sub_f32 v134, v134, v232
 v_sub_f32 v135, v135, v232
 v_sub_f32 v136, v136, v232
 v_sub_f32 v137, v137, v232
 v_sub_f32 v138, v138, v232
 v_sub_f32 v139, v139, v232
 v_sub_f32 v140, v140, v232
 v_sub_f32 v141, v141, v232
 v_sub_f32 v142, v142, v232
 v_sub_f32 v143, v143, v232
 v_sub_f32 v144, v144, v233
 v_sub_f32 v145, v145, v233
 v_sub_f32 v146, v146, v233
 v_sub_f32 v147, v147, v233
 v_sub_f32 v148, v148, v233
 v_sub_f32 v149, v149, v233
 v_sub_f32 v150, v150, v233
 v_sub_f32 v151, v151, v233
 v_sub_f32 v152, v152, v233
 v_sub_f32 v153, v153, v233
 v_sub_f32 v154, v154, v233
 v_sub_f32 v155, v155, v233
 v_sub_f32 v156, v156, v233
 v_sub_f32 v157, v157, v233
 v_sub_f32 v158, v158, v233
 v_sub_f32 v159, v159, v233
 s_waitcnt vmcnt(8)
 s_barrier
 buffer_store_dword v27, v26, s[4:7], s79 offen sc1
 s_or_b32 m0, s91, 0x10000
 s_nop 0
 buffer_load_dwordx4 v14, s[32:35], s90 offen offset:0 sc1 lds
 buffer_load_dwordx4 v14, s[32:35], s90 offen offset:1024 sc1 lds
 buffer_load_dwordx4 v14, s[32:35], s90 offen offset:2048 sc1 lds
 buffer_load_dwordx4 v14, s[32:35], s90 offen offset:3072 sc1 lds
 ds_read_b128 a[128:131], v23 offset:0
 ds_read_b128 a[132:135], v23 offset:1024
 ds_read_b128 a[136:139], v23 offset:2048
 ds_read_b128 a[140:143], v23 offset:3072
 ds_read_b128 a[144:147], v23 offset:4096
 ds_read_b128 a[148:151], v23 offset:5120
 v_add_f32 v228, v228, v227
 v_exp_f32 v226, v114
 v_exp_f32 v227, v115
 v_add_f32 v229, v224, v225
 v_cvt_pk_bf16_f32 v168, v224, v225
 v_exp_f32 v224, v116
 v_exp_f32 v225, v117
 v_add_f32 v229, v229, v226
 v_cvt_pk_bf16_f32 v169, v226, v227
 v_add_f32 v229, v229, v227
 v_exp_f32 v226, v118
 v_exp_f32 v227, v119
 v_add_f32 v229, v229, v224
 v_cvt_pk_bf16_f32 v170, v224, v225
 v_add_f32 v229, v229, v225
 v_exp_f32 v224, v120
 v_exp_f32 v225, v121
 v_add_f32 v229, v229, v226
 v_cvt_pk_bf16_f32 v171, v226, v227
 v_add_f32 v229, v229, v227
 v_exp_f32 v226, v122
 v_exp_f32 v227, v123
 v_add_f32 v229, v229, v224
 v_cvt_pk_bf16_f32 v172, v224, v225
 v_add_f32 v229, v229, v225
 v_exp_f32 v224, v124
 v_exp_f32 v225, v125
 v_add_f32 v229, v229, v226
 v_cvt_pk_bf16_f32 v173, v226, v227
 v_add_f32 v229, v229, v227
 v_exp_f32 v226, v126
 v_exp_f32 v227, v127
 v_add_f32 v229, v229, v224
 v_cvt_pk_bf16_f32 v174, v224, v225
 v_add_f32 v229, v229, v225
 v_add_f32 v229, v229, v226
 v_cvt_pk_bf16_f32 v175, v226, v227
 v_add_f32 v229, v229, v227
 s_cmp_ge_u32 s18, s17
 s_cbranch_scc1 L_dualm0
L_dual:
 s_waitcnt lgkmcnt(5)
 v_mfma_f32_32x32x16_bf16 v[96:111], a[128:131], v[32:35], v[192:207]
 v_exp_f32 v224, v128
 v_exp_f32 v225, v129
 v_exp_f32 v226, v130
 v_mfma_f32_32x32x16_bf16 v[112:127], a[128:131], v[64:67], v[208:223]
 ds_read_b128 a[152:155], v23 offset:6144
 v_exp_f32 v227, v131
 v_add_f32 v230, v228, v224
 v_cvt_pk_bf16_f32 v176, v224, v225
 s_waitcnt lgkmcnt(5)
 v_mfma_f32_32x32x16_bf16 v[96:111], a[132:135], v[48:51], v[96:111]
 v_add_f32 v230, v230, v225
 v_exp_f32 v224, v132
 v_exp_f32 v225, v133
 v_mfma_f32_32x32x16_bf16 v[112:127], a[132:135], v[80:83], v[112:127]
 ds_read_b128 a[156:159], v23 offset:7168
 v_add_f32 v230, v230, v226
 v_cvt_pk_bf16_f32 v177, v226, v227
 v_add_f32 v230, v230, v227
 s_waitcnt lgkmcnt(5)
 v_mfma_f32_32x32x16_bf16 v[96:111], a[136:139], v[36:39], v[96:111]
 v_exp_f32 v226, v134
 v_exp_f32 v227, v135
 v_add_f32 v230, v230, v224
 v_cvt_pk_bf16_f32 v178, v224, v225
 v_mfma_f32_32x32x16_bf16 v[112:127], a[136:139], v[68:71], v[112:127]
 ds_read_b128 a[160:163], v24 offset:0
 v_add_f32 v230, v230, v225
 v_exp_f32 v224, v136
 s_waitcnt lgkmcnt(3)
 v_mfma_f32_32x32x16_bf16 v[96:111], a[140:143], v[52:55], v[96:111]
 v_exp_f32 v225, v137
 v_add_f32 v230, v230, v226
 v_cvt_pk_bf16_f32 v179, v226, v227
 v_add_f32 v230, v230, v227
 v_mfma_f32_32x32x16_bf16 v[112:127], a[140:143], v[84:87], v[112:127]
 ds_read_b128 a[164:167], v24 offset:1024
 v_exp_f32 v226, v138
 v_exp_f32 v227, v139
 v_add_f32 v230, v230, v224
 v_mfma_f32_32x32x16_bf16 v[96:111], a[144:147], v[40:43], v[96:111]
 s_xor_b32 m0, s87, 0xc000
 v_cvt_pk_bf16_f32 v180, v224, v225
 v_add_f32 v230, v230, v225
 v_exp_f32 v224, v140
 v_mfma_f32_32x32x16_bf16 v[112:127], a[144:147], v[72:75], v[112:127]
 ds_read_b128 a[168:171], v24 offset:2048
 v_exp_f32 v225, v141
 v_add_f32 v230, v230, v226
 v_cvt_pk_bf16_f32 v181, v226, v227
 v_add_f32 v230, v230, v227
 v_mfma_f32_32x32x16_bf16 v[96:111], a[148:151], v[56:59], v[96:111]
 v_exp_f32 v226, v142
 v_exp_f32 v227, v143
 v_add_f32 v230, v230, v224
 v_cvt_pk_bf16_f32 v182, v224, v225
 v_mfma_f32_32x32x16_bf16 v[112:127], a[148:151], v[88:91], v[112:127]
 ds_read_b128 a[172:175], v24 offset:3072
 v_add_f32 v230, v230, v225
 v_exp_f32 v224, v144
 s_waitcnt lgkmcnt(3)
 v_mfma_f32_32x32x16_bf16 v[96:111], a[152:155], v[44:47], v[96:111]
 v_exp_f32 v225, v145
 v_add_f32 v230, v230, v226
 v_cvt_pk_bf16_f32 v183, v226, v227
 v_add_f32 v230, v230, v227
 v_mfma_f32_32x32x16_bf16 v[112:127], a[152:155], v[76:79], v[112:127]
 ds_read_b128 a[176:179], v24 offset:4096
 s_add_u32 s56, s90, 4294950912
 v_exp_f32 v226, v146
 v_exp_f32 v227, v147
 v_mfma_f32_32x32x16_bf16 v[96:111], a[156:159], v[60:63], v[96:111]
 v_add_f32 v231, v229, v224
 v_cvt_pk_bf16_f32 v184, v224, v225
 v_add_f32 v231, v231, v225
 v_exp_f32 v224, v148
 v_mfma_f32_32x32x16_bf16 v[112:127], a[156:159], v[92:95], v[112:127]
 ds_read_b128 a[180:183], v24 offset:5120
 v_exp_f32 v225, v149
 v_add_f32 v231, v231, v226
 v_cvt_pk_bf16_f32 v185, v226, v227
 v_add_f32 v231, v231, v227
 v_mfma_f32_32x32x16_bf16 a[0:15], a[160:163], v[160:163], a[0:15]
 v_exp_f32 v226, v150
 v_exp_f32 v227, v151
 v_add_f32 v231, v231, v224
 v_cvt_pk_bf16_f32 v186, v224, v225
 v_mfma_f32_32x32x16_bf16 a[64:79], a[160:163], v[168:171], a[64:79]
 ds_read_b128 a[184:187], v24 offset:6144
 v_add_f32 v231, v231, v225
 v_exp_f32 v224, v152
 s_waitcnt lgkmcnt(3)
 v_mfma_f32_32x32x16_bf16 a[16:31], a[164:167], v[160:163], a[16:31]
 buffer_load_dwordx4 v14, s[32:35], s56 offen offset:0 sc1 lds
 v_exp_f32 v225, v153
 v_add_f32 v231, v231, v226
 v_cvt_pk_bf16_f32 v187, v226, v227
 v_mfma_f32_32x32x16_bf16 a[80:95], a[164:167], v[168:171], a[80:95]
 ds_read_b128 a[188:191], v24 offset:7168
 v_add_f32 v231, v231, v227
 v_exp_f32 v226, v154
 v_exp_f32 v227, v155
 v_mfma_f32_32x32x16_bf16 a[32:47], a[168:171], v[160:163], a[32:47]
 v_add_f32 v231, v231, v224
 v_cvt_pk_bf16_f32 v188, v224, v225
 v_add_f32 v231, v231, v225
 v_exp_f32 v224, v156
 v_mfma_f32_32x32x16_bf16 a[96:111], a[168:171], v[168:171], a[96:111]
 ds_read_b128 a[128:131], v23 offset:8192
 v_exp_f32 v225, v157
 v_add_f32 v231, v231, v226
 v_cvt_pk_bf16_f32 v189, v226, v227
 v_add_f32 v231, v231, v227
 v_mfma_f32_32x32x16_bf16 a[48:63], a[172:175], v[160:163], a[48:63]
 v_exp_f32 v226, v158
 v_exp_f32 v227, v159
 v_add_f32 v231, v231, v224
 v_cvt_pk_bf16_f32 v190, v224, v225
 v_mfma_f32_32x32x16_bf16 a[112:127], a[172:175], v[168:171], a[112:127]
 ds_read_b128 a[132:135], v23 offset:9216
 v_add_f32 v231, v231, v225
 v_add_f32 v231, v231, v226
 v_cvt_pk_bf16_f32 v191, v226, v227
 v_add_f32 v231, v231, v227
 s_waitcnt lgkmcnt(3)
 v_mfma_f32_32x32x16_bf16 a[0:15], a[176:179], v[164:167], a[0:15]
 buffer_load_dwordx4 v14, s[32:35], s56 offen offset:1024 sc1 lds
 v_mfma_f32_32x32x16_bf16 a[64:79], a[176:179], v[172:175], a[64:79]
 ds_read_b128 a[136:139], v23 offset:10240
 v_mfma_f32_32x32x16_bf16 a[16:31], a[180:183], v[164:167], a[16:31]
 v_mfma_f32_32x32x16_bf16 a[80:95], a[180:183], v[172:175], a[80:95]
 ds_read_b128 a[140:143], v23 offset:11264
 v_mfma_f32_32x32x16_bf16 a[32:47], a[184:187], v[164:167], a[32:47]
 v_mfma_f32_32x32x16_bf16 a[96:111], a[184:187], v[172:175], a[96:111]
 ds_read_b128 a[144:147], v23 offset:12288
 buffer_load_dwordx4 v14, s[32:35], s56 offen offset:2048 sc1 lds
 s_waitcnt lgkmcnt(3)
 v_mfma_f32_32x32x16_bf16 a[48:63], a[188:191], v[164:167], a[48:63]
 v_mfma_f32_32x32x16_bf16 a[112:127], a[188:191], v[172:175], a[112:127]
 ds_read_b128 a[148:151], v23 offset:13312
 v_mfma_f32_32x32x16_bf16 v[128:143], a[128:131], v[32:35], v[192:207]
 v_exp_f32 v224, v96
 v_exp_f32 v225, v97
 v_exp_f32 v226, v98
 v_mfma_f32_32x32x16_bf16 v[144:159], a[128:131], v[64:67], v[208:223]
 ds_read_b128 a[152:155], v23 offset:14336
 v_exp_f32 v227, v99
 v_add_f32 v228, v230, v224
 v_cvt_pk_bf16_f32 v160, v224, v225
 v_mfma_f32_32x32x16_bf16 v[128:143], a[132:135], v[48:51], v[128:143]
 buffer_load_dwordx4 v14, s[32:35], s56 offen offset:3072 sc1 lds
 v_add_f32 v228, v228, v225
 v_exp_f32 v224, v100
 v_mfma_f32_32x32x16_bf16 v[144:159], a[132:135], v[80:83], v[144:159]
 ds_read_b128 a[156:159], v23 offset:15360
 v_exp_f32 v225, v101
 v_add_f32 v228, v228, v226
 v_cvt_pk_bf16_f32 v161, v226, v227
 s_waitcnt lgkmcnt(3)
 v_mfma_f32_32x32x16_bf16 v[128:143], a[136:139], v[36:39], v[128:143]
 v_add_f32 v228, v228, v227
 v_exp_f32 v226, v102
 v_exp_f32 v227, v103
 v_add_f32 v228, v228, v224
 v_mfma_f32_32x32x16_bf16 v[144:159], a[136:139], v[68:71], v[144:159]
 ds_read_b128 a[160:163], v24 offset:8192
 v_cvt_pk_bf16_f32 v162, v224, v225
 v_add_f32 v228, v228, v225
 v_exp_f32 v224, v104
 v_mfma_f32_32x32x16_bf16 v[128:143], a[140:143], v[52:55], v[128:143]
 v_exp_f32 v225, v105
 v_add_f32 v228, v228, v226
 v_cvt_pk_bf16_f32 v163, v226, v227
 v_add_f32 v228, v228, v227
 v_mfma_f32_32x32x16_bf16 v[144:159], a[140:143], v[84:87], v[144:159]
 ds_read_b128 a[164:167], v24 offset:9216
 v_exp_f32 v226, v106
 v_exp_f32 v227, v107
 v_add_f32 v228, v228, v224
 v_mfma_f32_32x32x16_bf16 v[128:143], a[144:147], v[40:43], v[128:143]
 v_cvt_pk_bf16_f32 v164, v224, v225
 v_add_f32 v228, v228, v225
 v_exp_f32 v224, v108
 v_exp_f32 v225, v109
 v_mfma_f32_32x32x16_bf16 v[144:159], a[144:147], v[72:75], v[144:159]
 ds_read_b128 a[168:171], v24 offset:10240
 v_add_f32 v228, v228, v226
 v_cvt_pk_bf16_f32 v165, v226, v227
 v_add_f32 v228, v228, v227
 s_waitcnt lgkmcnt(3)
 v_mfma_f32_32x32x16_bf16 v[128:143], a[148:151], v[56:59], v[128:143]
 v_exp_f32 v226, v110
 v_exp_f32 v227, v111
 v_add_f32 v228, v228, v224
 v_cvt_pk_bf16_f32 v166, v224, v225
 v_mfma_f32_32x32x16_bf16 v[144:159], a[148:151], v[88:91], v[144:159]
 ds_read_b128 a[172:175], v24 offset:11264
 v_add_f32 v228, v228, v225
 v_exp_f32 v224, v112
 v_exp_f32 v225, v113
 v_mfma_f32_32x32x16_bf16 v[128:143], a[152:155], v[44:47], v[128:143]
 v_add_f32 v228, v228, v226
 v_cvt_pk_bf16_f32 v167, v226, v227
 v_add_f32 v228, v228, v227
 v_exp_f32 v226, v114
 v_mfma_f32_32x32x16_bf16 v[144:159], a[152:155], v[76:79], v[144:159]
 ds_read_b128 a[176:179], v24 offset:12288
 v_exp_f32 v227, v115
 v_add_f32 v229, v231, v224
 v_cvt_pk_bf16_f32 v168, v224, v225
 v_mfma_f32_32x32x16_bf16 v[128:143], a[156:159], v[60:63], v[128:143]
 v_add_f32 v229, v229, v225
 v_exp_f32 v224, v116
 v_exp_f32 v225, v117
 v_mfma_f32_32x32x16_bf16 v[144:159], a[156:159], v[92:95], v[144:159]
 ds_read_b128 a[180:183], v24 offset:13312
 v_add_f32 v229, v229, v226
 v_cvt_pk_bf16_f32 v169, v226, v227
 v_add_f32 v229, v229, v227
 s_waitcnt lgkmcnt(3)
 v_mfma_f32_32x32x16_bf16 a[0:15], a[160:163], v[176:179], a[0:15]
 v_exp_f32 v226, v118
 v_exp_f32 v227, v119
 v_add_f32 v229, v229, v224
 v_cvt_pk_bf16_f32 v170, v224, v225
 v_mfma_f32_32x32x16_bf16 a[64:79], a[160:163], v[184:187], a[64:79]
 ds_read_b128 a[184:187], v24 offset:14336
 v_add_f32 v229, v229, v225
 v_exp_f32 v224, v120
 v_exp_f32 v225, v121
 v_mfma_f32_32x32x16_bf16 a[16:31], a[164:167], v[176:179], a[16:31]
 ds_read_b128 a[188:191], v24 offset:15360
 v_add_f32 v229, v229, v226
 v_cvt_pk_bf16_f32 v171, v226, v227
 v_add_f32 v229, v229, v227
 v_exp_f32 v226, v122
 v_mfma_f32_32x32x16_bf16 a[80:95], a[164:167], v[184:187], a[80:95]
 v_exp_f32 v227, v123
 v_add_f32 v229, v229, v224
 v_cvt_pk_bf16_f32 v172, v224, v225
 v_mfma_f32_32x32x16_bf16 a[32:47], a[168:171], v[176:179], a[32:47]
 v_xor_b32 v24, 0x1c000, v23
 v_add_u32 v23, s87, v236
 v_add_f32 v229, v229, v225
 v_exp_f32 v224, v124
 v_mfma_f32_32x32x16_bf16 a[96:111], a[168:171], v[184:187], a[96:111]
 v_exp_f32 v225, v125
 v_add_f32 v229, v229, v226
 v_cvt_pk_bf16_f32 v173, v226, v227
 v_add_f32 v229, v229, v227
 s_waitcnt lgkmcnt(2)
 v_mfma_f32_32x32x16_bf16 a[48:63], a[172:175], v[176:179], a[48:63]
 s_waitcnt vmcnt(8) lgkmcnt(0)
 s_barrier
 ds_read_b128 a[128:131], v23 offset:0
 s_mov_b32 s87, s91
 ds_read_b128 a[132:135], v23 offset:1024
 v_mfma_f32_32x32x16_bf16 a[112:127], a[172:175], v[184:187], a[112:127]
 ds_read_b128 a[136:139], v23 offset:2048
 s_add_u32 s91, s91, 16384
 v_exp_f32 v226, v126
 v_exp_f32 v227, v127
 v_mfma_f32_32x32x16_bf16 a[0:15], a[176:179], v[180:183], a[0:15]
 ds_read_b128 a[140:143], v23 offset:3072
 s_and_b32 s91, s91, 0xffff
 v_add_f32 v229, v229, v224
 v_cvt_pk_bf16_f32 v174, v224, v225
 v_add_f32 v229, v229, v225
 v_add_f32 v229, v229, v226
 v_mfma_f32_32x32x16_bf16 a[64:79], a[176:179], v[188:191], a[64:79]
 ds_read_b128 a[144:147], v23 offset:4096
 s_add_u32 s90, s90, 32768
 v_cvt_pk_bf16_f32 v175, v226, v227
 v_add_f32 v229, v229, v227
 v_mfma_f32_32x32x16_bf16 a[16:31], a[180:183], v[180:183], a[16:31]
 ds_read_b128 a[148:151], v23 offset:5120
 s_add_u32 s18, s18, 1
 v_mfma_f32_32x32x16_bf16 a[80:95], a[180:183], v[188:191], a[80:95]
 s_or_b32 m0, s91, 0x10000
 s_nop 0
 buffer_load_dwordx4 v14, s[32:35], s90 offen offset:0 sc1 lds
 v_mfma_f32_32x32x16_bf16 a[32:47], a[184:187], v[180:183], a[32:47]
 buffer_load_dwordx4 v14, s[32:35], s90 offen offset:1024 sc1 lds
 v_mfma_f32_32x32x16_bf16 a[96:111], a[184:187], v[188:191], a[96:111]
 buffer_load_dwordx4 v14, s[32:35], s90 offen offset:2048 sc1 lds
 v_mfma_f32_32x32x16_bf16 a[48:63], a[188:191], v[180:183], a[48:63]
 buffer_load_dwordx4 v14, s[32:35], s90 offen offset:3072 sc1 lds
 v_mfma_f32_32x32x16_bf16 a[112:127], a[188:191], v[188:191], a[112:127]
 s_cmp_lt_u32 s18, s17
 s_cbranch_scc1 L_dual
L_dualm0:
L_dualm:
 s_waitcnt lgkmcnt(5)
 v_mfma_f32_32x32x16_bf16 v[96:111], a[128:131], v[32:35], v[192:207]
 v_exp_f32 v224, v128
 v_exp_f32 v225, v129
 v_exp_f32 v226, v130
 v_mfma_f32_32x32x16_bf16 v[112:127], a[128:131], v[64:67], v[208:223]
 ds_read_b128 a[152:155], v23 offset:6144
 v_exp_f32 v227, v131
 v_add_f32 v230, v228, v224
 v_cvt_pk_bf16_f32 v176, v224, v225
 s_waitcnt lgkmcnt(5)
 v_mfma_f32_32x32x16_bf16 v[96:111], a[132:135], v[48:51], v[96:111]
 v_add_f32 v230, v230, v225
 v_exp_f32 v224, v132
 v_exp_f32 v225, v133
 v_mfma_f32_32x32x16_bf16 v[112:127], a[132:135], v[80:83], v[112:127]
 ds_read_b128 a[156:159], v23 offset:7168
 v_add_f32 v230, v230, v226
 v_cvt_pk_bf16_f32 v177, v226, v227
 v_add_f32 v230, v230, v227
 s_waitcnt lgkmcnt(5)
 v_mfma_f32_32x32x16_bf16 v[96:111], a[136:139], v[36:39], v[96:111]
 v_exp_f32 v226, v134
 v_exp_f32 v227, v135
 v_add_f32 v230, v230, v224
 v_cvt_pk_bf16_f32 v178, v224, v225
 v_mfma_f32_32x32x16_bf16 v[112:127], a[136:139], v[68:71], v[112:127]
 ds_read_b128 a[160:163], v24 offset:0
 v_add_f32 v230, v230, v225
 v_exp_f32 v224, v136
 s_waitcnt lgkmcnt(3)
 v_mfma_f32_32x32x16_bf16 v[96:111], a[140:143], v[52:55], v[96:111]
 v_exp_f32 v225, v137
 v_add_f32 v230, v230, v226
 v_cvt_pk_bf16_f32 v179, v226, v227
 v_add_f32 v230, v230, v227
 v_mfma_f32_32x32x16_bf16 v[112:127], a[140:143], v[84:87], v[112:127]
 ds_read_b128 a[164:167], v24 offset:1024
 v_exp_f32 v226, v138
 v_exp_f32 v227, v139
 v_add_f32 v230, v230, v224
 v_mfma_f32_32x32x16_bf16 v[96:111], a[144:147], v[40:43], v[96:111]
 s_xor_b32 m0, s87, 0xc000
 v_cvt_pk_bf16_f32 v180, v224, v225
 v_add_f32 v230, v230, v225
 v_exp_f32 v224, v140
 v_mfma_f32_32x32x16_bf16 v[112:127], a[144:147], v[72:75], v[112:127]
 ds_read_b128 a[168:171], v24 offset:2048
 v_exp_f32 v225, v141
 v_add_f32 v230, v230, v226
 v_cvt_pk_bf16_f32 v181, v226, v227
 v_add_f32 v230, v230, v227
 v_mfma_f32_32x32x16_bf16 v[96:111], a[148:151], v[56:59], v[96:111]
 v_exp_f32 v226, v142
 v_exp_f32 v227, v143
 v_add_f32 v230, v230, v224
 v_cvt_pk_bf16_f32 v182, v224, v225
 v_mfma_f32_32x32x16_bf16 v[112:127], a[148:151], v[88:91], v[112:127]
 ds_read_b128 a[172:175], v24 offset:3072
 v_add_f32 v230, v230, v225
 v_exp_f32 v224, v144
 s_waitcnt lgkmcnt(3)
 v_mfma_f32_32x32x16_bf16 v[96:111], a[152:155], v[44:47], v[96:111]
 v_exp_f32 v225, v145
 v_add_f32 v230, v230, v226
 v_cvt_pk_bf16_f32 v183, v226, v227
 v_add_f32 v230, v230, v227
 v_mfma_f32_32x32x16_bf16 v[112:127], a[152:155], v[76:79], v[112:127]
 ds_read_b128 a[176:179], v24 offset:4096
 s_add_u32 s56, s90, 4294950912
 v_exp_f32 v226, v146
 v_exp_f32 v227, v147
 v_mfma_f32_32x32x16_bf16 v[96:111], a[156:159], v[60:63], v[96:111]
 v_add_f32 v231, v229, v224
 v_cvt_pk_bf16_f32 v184, v224, v225
 v_add_f32 v231, v231, v225
 v_exp_f32 v224, v148
 v_mfma_f32_32x32x16_bf16 v[112:127], a[156:159], v[92:95], v[112:127]
 ds_read_b128 a[180:183], v24 offset:5120
 v_exp_f32 v225, v149
 v_add_f32 v231, v231, v226
 v_cvt_pk_bf16_f32 v185, v226, v227
 v_add_f32 v231, v231, v227
 v_mfma_f32_32x32x16_bf16 a[0:15], a[160:163], v[160:163], a[0:15]
 v_exp_f32 v226, v150
 v_exp_f32 v227, v151
 v_add_f32 v231, v231, v224
 v_cvt_pk_bf16_f32 v186, v224, v225
 v_mfma_f32_32x32x16_bf16 a[64:79], a[160:163], v[168:171], a[64:79]
 ds_read_b128 a[184:187], v24 offset:6144
 v_add_f32 v231, v231, v225
 v_exp_f32 v224, v152
 s_waitcnt lgkmcnt(3)
 v_mfma_f32_32x32x16_bf16 a[16:31], a[164:167], v[160:163], a[16:31]
 buffer_load_dwordx4 v14, s[32:35], s56 offen offset:0 sc1 lds
 v_exp_f32 v225, v153
 s_lshl_b32 s19, s18, 1
 v_add_f32 v231, v231, v226
 v_mfma_f32_32x32x16_bf16 a[80:95], a[164:167], v[168:171], a[80:95]
 ds_read_b128 a[188:191], v24 offset:7168
 s_add_u32 s19, s19, 0
 v_cvt_pk_bf16_f32 v187, v226, v227
 v_add_f32 v231, v231, v227
 s_cmp_eq_u32 s19, s93
 s_cselect_b32 s12, s15, 0
 v_mfma_f32_32x32x16_bf16 a[32:47], a[168:171], v[160:163], a[32:47]
 v_exp_f32 v226, v154
 v_exp_f32 v227, v155
 s_cmp_gt_u32 s19, s93
 s_cselect_b32 s13, s15, 0
 v_mfma_f32_32x32x16_bf16 a[96:111], a[168:171], v[168:171], a[96:111]
 ds_read_b128 a[128:131], v23 offset:8192
 v_add_f32 v231, v231, v224
 v_cvt_pk_bf16_f32 v188, v224, v225
 v_fma_f32 v96, v240, s12, v96
 v_add_f32 v231, v231, v225
 v_mfma_f32_32x32x16_bf16 a[48:63], a[172:175], v[160:163], a[48:63]
 v_exp_f32 v224, v156
 v_fma_f32 v97, v241, s12, v97
 v_fma_f32 v98, v242, s12, v98
 v_exp_f32 v225, v157
 v_mfma_f32_32x32x16_bf16 a[112:127], a[172:175], v[168:171], a[112:127]
 ds_read_b128 a[132:135], v23 offset:9216
 v_fma_f32 v99, v243, s12, v99
 v_add_f32 v231, v231, v226
 v_fma_f32 v100, v244, s12, v100
 v_cvt_pk_bf16_f32 v189, v226, v227
 s_waitcnt lgkmcnt(3)
 v_mfma_f32_32x32x16_bf16 a[0:15], a[176:179], v[164:167], a[0:15]
 buffer_load_dwordx4 v14, s[32:35], s56 offen offset:1024 sc1 lds
 v_add_f32 v231, v231, v227
 v_fma_f32 v101, v245, s12, v101
 v_exp_f32 v226, v158
 v_mfma_f32_32x32x16_bf16 a[64:79], a[176:179], v[172:175], a[64:79]
 ds_read_b128 a[136:139], v23 offset:10240
 v_fma_f32 v102, v246, s12, v102
 v_exp_f32 v227, v159
 v_fma_f32 v103, v247, s12, v103
 v_add_f32 v231, v231, v224
 v_mfma_f32_32x32x16_bf16 a[16:31], a[180:183], v[164:167], a[16:31]
 v_fma_f32 v104, v248, s12, v104
 v_cvt_pk_bf16_f32 v190, v224, v225
 v_fma_f32 v105, v249, s12, v105
 v_add_f32 v231, v231, v225
 v_add_f32 v231, v231, v226
 v_fma_f32 v106, v250, s12, v106
 v_mfma_f32_32x32x16_bf16 a[80:95], a[180:183], v[172:175], a[80:95]
 ds_read_b128 a[140:143], v23 offset:11264
 v_cvt_pk_bf16_f32 v191, v226, v227
 v_add_f32 v231, v231, v227
 v_fma_f32 v107, v251, s12, v107
 v_fma_f32 v108, v252, s12, v108
 v_fma_f32 v109, v253, s12, v109
 v_mfma_f32_32x32x16_bf16 a[32:47], a[184:187], v[164:167], a[32:47]
 v_fma_f32 v110, v254, s12, v110
 v_fma_f32 v111, v255, s12, v111
 v_add_f32 v96, s13, v96
 v_add_f32 v97, s13, v97
 v_add_f32 v98, s13, v98
 v_add_f32 v99, s13, v99
 v_mfma_f32_32x32x16_bf16 a[96:111], a[184:187], v[172:175], a[96:111]
 ds_read_b128 a[144:147], v23 offset:12288
 buffer_load_dwordx4 v14, s[32:35], s56 offen offset:2048 sc1 lds
 v_add_f32 v100, s13, v100
 v_add_f32 v101, s13, v101
 s_waitcnt lgkmcnt(3)
 v_mfma_f32_32x32x16_bf16 a[48:63], a[188:191], v[164:167], a[48:63]
 v_add_f32 v102, s13, v102
 v_add_f32 v103, s13, v103
 v_add_f32 v104, s13, v104
 v_add_f32 v105, s13, v105
 v_add_f32 v106, s13, v106
 v_add_f32 v107, s13, v107
 v_mfma_f32_32x32x16_bf16 a[112:127], a[188:191], v[172:175], a[112:127]
 v_add_f32 v108, s13, v108
 v_add_f32 v109, s13, v109
 v_add_f32 v110, s13, v110
 v_add_f32 v111, s13, v111
 ds_read_b128 a[148:151], v23 offset:13312
 v_mfma_f32_32x32x16_bf16 v[128:143], a[128:131], v[32:35], v[192:207]
 v_exp_f32 v224, v96
 v_exp_f32 v225, v97
 v_exp_f32 v226, v98
 v_mfma_f32_32x32x16_bf16 v[144:159], a[128:131], v[64:67], v[208:223]
 ds_read_b128 a[152:155], v23 offset:14336
 v_exp_f32 v227, v99
 v_add_f32 v228, v230, v224
 v_cvt_pk_bf16_f32 v160, v224, v225
 v_mfma_f32_32x32x16_bf16 v[128:143], a[132:135], v[48:51], v[128:143]
 buffer_load_dwordx4 v14, s[32:35], s56 offen offset:3072 sc1 lds
 v_add_f32 v228, v228, v225
 v_exp_f32 v224, v100
 v_mfma_f32_32x32x16_bf16 v[144:159], a[132:135], v[80:83], v[144:159]
 ds_read_b128 a[156:159], v23 offset:15360
 v_exp_f32 v225, v101
 v_add_f32 v228, v228, v226
 v_cvt_pk_bf16_f32 v161, v226, v227
 s_waitcnt lgkmcnt(3)
 v_mfma_f32_32x32x16_bf16 v[128:143], a[136:139], v[36:39], v[128:143]
 v_add_f32 v228, v228, v227
 v_exp_f32 v226, v102
 v_exp_f32 v227, v103
 v_add_f32 v228, v228, v224
 v_mfma_f32_32x32x16_bf16 v[144:159], a[136:139], v[68:71], v[144:159]
 ds_read_b128 a[160:163], v24 offset:8192
 v_cvt_pk_bf16_f32 v162, v224, v225
 v_add_f32 v228, v228, v225
 v_exp_f32 v224, v104
 v_mfma_f32_32x32x16_bf16 v[128:143], a[140:143], v[52:55], v[128:143]
 v_exp_f32 v225, v105
 v_add_f32 v228, v228, v226
 v_cvt_pk_bf16_f32 v163, v226, v227
 v_add_f32 v228, v228, v227
 v_mfma_f32_32x32x16_bf16 v[144:159], a[140:143], v[84:87], v[144:159]
 ds_read_b128 a[164:167], v24 offset:9216
 v_exp_f32 v226, v106
 v_exp_f32 v227, v107
 v_add_f32 v228, v228, v224
 v_mfma_f32_32x32x16_bf16 v[128:143], a[144:147], v[40:43], v[128:143]
 v_cvt_pk_bf16_f32 v164, v224, v225
 v_add_f32 v228, v228, v225
 v_exp_f32 v224, v108
 v_exp_f32 v225, v109
 v_mfma_f32_32x32x16_bf16 v[144:159], a[144:147], v[72:75], v[144:159]
 ds_read_b128 a[168:171], v24 offset:10240
 v_add_f32 v228, v228, v226
 v_cvt_pk_bf16_f32 v165, v226, v227
 v_add_f32 v228, v228, v227
 s_waitcnt lgkmcnt(3)
 v_mfma_f32_32x32x16_bf16 v[128:143], a[148:151], v[56:59], v[128:143]
 v_exp_f32 v226, v110
 v_exp_f32 v227, v111
 v_add_f32 v228, v228, v224
 v_cvt_pk_bf16_f32 v166, v224, v225
 v_mfma_f32_32x32x16_bf16 v[144:159], a[148:151], v[88:91], v[144:159]
 ds_read_b128 a[172:175], v24 offset:11264
 v_add_f32 v228, v228, v225
 v_exp_f32 v224, v112
 v_exp_f32 v225, v113
 v_mfma_f32_32x32x16_bf16 v[128:143], a[152:155], v[44:47], v[128:143]
 v_add_f32 v228, v228, v226
 v_cvt_pk_bf16_f32 v167, v226, v227
 v_add_f32 v228, v228, v227
 v_exp_f32 v226, v114
 v_mfma_f32_32x32x16_bf16 v[144:159], a[152:155], v[76:79], v[144:159]
 ds_read_b128 a[176:179], v24 offset:12288
 v_exp_f32 v227, v115
 v_add_f32 v229, v231, v224
 v_cvt_pk_bf16_f32 v168, v224, v225
 v_mfma_f32_32x32x16_bf16 v[128:143], a[156:159], v[60:63], v[128:143]
 v_add_f32 v229, v229, v225
 v_exp_f32 v224, v116
 v_exp_f32 v225, v117
 v_mfma_f32_32x32x16_bf16 v[144:159], a[156:159], v[92:95], v[144:159]
 ds_read_b128 a[180:183], v24 offset:13312
 v_add_f32 v229, v229, v226
 v_cvt_pk_bf16_f32 v169, v226, v227
 v_add_f32 v229, v229, v227
 s_waitcnt lgkmcnt(3)
 v_mfma_f32_32x32x16_bf16 a[0:15], a[160:163], v[176:179], a[0:15]
 v_exp_f32 v226, v118
 v_exp_f32 v227, v119
 v_add_f32 v229, v229, v224
 v_cvt_pk_bf16_f32 v170, v224, v225
 v_mfma_f32_32x32x16_bf16 a[64:79], a[160:163], v[184:187], a[64:79]
 ds_read_b128 a[184:187], v24 offset:14336
 v_add_f32 v229, v229, v225
 v_exp_f32 v224, v120
 v_exp_f32 v225, v121
 v_mfma_f32_32x32x16_bf16 a[16:31], a[164:167], v[176:179], a[16:31]
 ds_read_b128 a[188:191], v24 offset:15360
 s_lshl_b32 s19, s18, 1
 v_add_f32 v229, v229, v226
 s_add_u32 s19, s19, 1
 v_cvt_pk_bf16_f32 v171, v226, v227
 v_add_f32 v229, v229, v227
 v_mfma_f32_32x32x16_bf16 a[80:95], a[164:167], v[184:187], a[80:95]
 s_cmp_eq_u32 s19, s93
 s_cselect_b32 s12, s15, 0
 v_exp_f32 v226, v122
 v_exp_f32 v227, v123
 v_mfma_f32_32x32x16_bf16 a[32:47], a[168:171], v[176:179], a[32:47]
 v_xor_b32 v24, 0x1c000, v23
 v_add_u32 v23, s87, v236
 s_cmp_gt_u32 s19, s93
 s_cselect_b32 s13, s15, 0
 v_add_f32 v229, v229, v224
 v_cvt_pk_bf16_f32 v172, v224, v225
 v_mfma_f32_32x32x16_bf16 a[96:111], a[168:171], v[184:187], a[96:111]
 v_fma_f32 v128, v240, s12, v128
 v_add_f32 v229, v229, v225
 v_exp_f32 v224, v124
 v_fma_f32 v129, v241, s12, v129
 s_waitcnt lgkmcnt(2)
 v_mfma_f32_32x32x16_bf16 a[48:63], a[172:175], v[176:179], a[48:63]
 s_waitcnt vmcnt(8) lgkmcnt(0)
 s_barrier
 ds_read_b128 a[128:131], v23 offset:0
 s_mov_b32 s87, s91
 ds_read_b128 a[132:135], v23 offset:1024
 v_fma_f32 v130, v242, s12, v130
 v_mfma_f32_32x32x16_bf16 a[112:127], a[172:175], v[184:187], a[112:127]
 ds_read_b128 a[136:139], v23 offset:2048
 s_add_u32 s91, s91, 16384
 v_exp_f32 v225, v125
 v_fma_f32 v131, v243, s12, v131
 v_add_f32 v229, v229, v226
 v_mfma_f32_32x32x16_bf16 a[0:15], a[176:179], v[180:183], a[0:15]
 ds_read_b128 a[140:143], v23 offset:3072
 s_and_b32 s91, s91, 0xffff
 v_fma_f32 v132, v244, s12, v132
 v_cvt_pk_bf16_f32 v173, v226, v227
 v_add_f32 v229, v229, v227
 v_fma_f32 v133, v245, s12, v133
 v_mfma_f32_32x32x16_bf16 a[64:79], a[176:179], v[188:191], a[64:79]
 ds_read_b128 a[144:147], v23 offset:4096
 s_add_u32 s90, s90, 32768
 v_exp_f32 v226, v126
 v_fma_f32 v134, v246, s12, v134
 v_mfma_f32_32x32x16_bf16 a[16:31], a[180:183], v[180:183], a[16:31]
 ds_read_b128 a[148:151], v23 offset:5120
 s_or_b32 m0, s91, 0x10000
 v_exp_f32 v227, v127
 v_fma_f32 v135, v247, s12, v135
 v_add_f32 v229, v229, v224
 v_mfma_f32_32x32x16_bf16 a[80:95], a[180:183], v[188:191], a[80:95]
 buffer_load_dwordx4 v14, s[32:35], s90 offen offset:0 sc1 lds
 v_fma_f32 v136, v248, s12, v136
 v_cvt_pk_bf16_f32 v174, v224, v225
 v_fma_f32 v137, v249, s12, v137
 v_add_f32 v229, v229, v225
 v_mfma_f32_32x32x16_bf16 a[32:47], a[184:187], v[180:183], a[32:47]
 buffer_load_dwordx4 v14, s[32:35], s90 offen offset:1024 sc1 lds
 v_add_f32 v229, v229, v226
 v_fma_f32 v138, v250, s12, v138
 v_cvt_pk_bf16_f32 v175, v226, v227
 v_add_f32 v229, v229, v227
 v_mfma_f32_32x32x16_bf16 a[96:111], a[184:187], v[188:191], a[96:111]
 buffer_load_dwordx4 v14, s[32:35], s90 offen offset:2048 sc1 lds
 v_fma_f32 v139, v251, s12, v139
 v_fma_f32 v140, v252, s12, v140
 v_fma_f32 v141, v253, s12, v141
 v_fma_f32 v142, v254, s12, v142
 v_mfma_f32_32x32x16_bf16 a[48:63], a[188:191], v[180:183], a[48:63]
 buffer_load_dwordx4 v14, s[32:35], s90 offen offset:3072 sc1 lds
 v_fma_f32 v143, v255, s12, v143
 v_add_f32 v128, s13, v128
 v_add_f32 v129, s13, v129
 v_add_f32 v130, s13, v130
 v_mfma_f32_32x32x16_bf16 a[112:127], a[188:191], v[188:191], a[112:127]
 v_add_f32 v131, s13, v131
 v_add_f32 v132, s13, v132
 v_add_f32 v133, s13, v133
 v_add_f32 v134, s13, v134
 v_add_f32 v135, s13, v135
 v_add_f32 v136, s13, v136
 v_add_f32 v137, s13, v137
 v_add_f32 v138, s13, v138
 v_add_f32 v139, s13, v139
 v_add_f32 v140, s13, v140
 v_add_f32 v141, s13, v141
 v_add_f32 v142, s13, v142
 v_add_f32 v143, s13, v143
 s_add_u32 s18, s18, 1
 s_cmp_lt_u32 s18, s16
 s_cbranch_scc1 L_dualm
 s_cmp_lt_u32 s18, s95
 s_cbranch_scc1 L_X
 s_waitcnt lgkmcnt(5)
 v_mfma_f32_32x32x16_bf16 v[96:111], a[128:131], v[64:67], v[208:223]
 buffer_load_dword v15, v12, s[4:7], 0 offen sc1
 ds_read_b128 a[152:155], v23 offset:6144
 ds_read_b128 a[156:159], v23 offset:7168
 ds_read_b128 a[160:163], v23 offset:8192
 s_waitcnt lgkmcnt(7)
 v_mfma_f32_32x32x16_bf16 v[96:111], a[132:135], v[80:83], v[96:111]
 s_mov_b32 m0, s91
 ds_read_b128 a[164:167], v23 offset:9216
 ds_read_b128 a[168:171], v23 offset:10240
 ds_read_b128 a[172:175], v23 offset:11264
 s_waitcnt lgkmcnt(9)
 v_mfma_f32_32x32x16_bf16 v[96:111], a[136:139], v[68:71], v[96:111]
 ds_read_b128 a[176:179], v23 offset:12288
 ds_read_b128 a[180:183], v23 offset:13312
 v_exp_f32 v224, v128
 s_waitcnt lgkmcnt(10)
 v_mfma_f32_32x32x16_bf16 v[96:111], a[140:143], v[84:87], v[96:111]
 ds_read_b128 a[184:187], v23 offset:14336
 s_add_u32 s56, s90, 4294950912
 v_exp_f32 v225, v129
 s_waitcnt lgkmcnt(10)
 v_mfma_f32_32x32x16_bf16 v[96:111], a[144:147], v[72:75], v[96:111]
 ds_read_b128 a[188:191], v23 offset:15360
 v_exp_f32 v226, v130
 v_exp_f32 v227, v131
 s_waitcnt lgkmcnt(10)
 v_mfma_f32_32x32x16_bf16 v[96:111], a[148:151], v[88:91], v[96:111]
 ds_read_b128 a[128:131], v24 offset:0
 v_add_f32 v230, v228, v224
 v_cvt_pk_bf16_f32 v176, v224, v225
 v_add_f32 v230, v230, v225
 s_waitcnt lgkmcnt(8)
 v_mfma_f32_32x32x16_bf16 v[96:111], a[152:155], v[76:79], v[96:111]
 buffer_load_dwordx4 v14, s[32:35], s56 offen offset:0 sc1 lds
 v_exp_f32 v224, v132
 v_exp_f32 v225, v133
 v_mfma_f32_32x32x16_bf16 v[96:111], a[156:159], v[92:95], v[96:111]
 ds_read_b128 a[132:135], v24 offset:1024
 v_add_f32 v230, v230, v226
 v_cvt_pk_bf16_f32 v177, v226, v227
 v_add_f32 v230, v230, v227
 v_exp_f32 v226, v134
 v_mfma_f32_32x32x16_bf16 v[112:127], a[160:163], v[64:67], v[208:223]
 v_exp_f32 v227, v135
 v_add_f32 v230, v230, v224
 v_cvt_pk_bf16_f32 v178, v224, v225
 v_add_f32 v230, v230, v225
 s_waitcnt lgkmcnt(3)
 v_mfma_f32_32x32x16_bf16 v[112:127], a[164:167], v[80:83], v[112:127]
 ds_read_b128 a[136:139], v24 offset:2048
 buffer_load_dwordx4 v14, s[32:35], s56 offen offset:1024 sc1 lds
 v_exp_f32 v224, v136
 v_mfma_f32_32x32x16_bf16 v[112:127], a[168:171], v[68:71], v[112:127]
 v_exp_f32 v225, v137
 v_add_f32 v230, v230, v226
 v_cvt_pk_bf16_f32 v179, v226, v227
 v_add_f32 v230, v230, v227
 v_mfma_f32_32x32x16_bf16 v[112:127], a[172:175], v[84:87], v[112:127]
 ds_read_b128 a[140:143], v24 offset:3072
 v_exp_f32 v226, v138
 v_exp_f32 v227, v139
 v_add_f32 v230, v230, v224
 v_mfma_f32_32x32x16_bf16 v[112:127], a[176:179], v[72:75], v[112:127]
 buffer_load_dwordx4 v14, s[32:35], s56 offen offset:2048 sc1 lds
 v_cvt_pk_bf16_f32 v180, v224, v225
 v_add_f32 v230, v230, v225
 v_exp_f32 v224, v140
 v_mfma_f32_32x32x16_bf16 v[112:127], a[180:183], v[88:91], v[112:127]
 ds_read_b128 a[144:147], v24 offset:4096
 v_exp_f32 v225, v141
 v_add_f32 v230, v230, v226
 v_cvt_pk_bf16_f32 v181, v226, v227
 v_add_f32 v230, v230, v227
 v_mfma_f32_32x32x16_bf16 v[112:127], a[184:187], v[76:79], v[112:127]
 v_exp_f32 v226, v142
 v_exp_f32 v227, v143
 v_add_f32 v230, v230, v224
 s_waitcnt lgkmcnt(2)
 v_mfma_f32_32x32x16_bf16 v[112:127], a[188:191], v[92:95], v[112:127]
 ds_read_b128 a[148:151], v24 offset:5120
 buffer_load_dwordx4 v14, s[32:35], s56 offen offset:3072 sc1 lds
 v_cvt_pk_bf16_f32 v182, v224, v225
 v_add_f32 v230, v230, v225
 v_mfma_f32_32x32x16_bf16 a[0:15], a[128:131], v[160:163], a[0:15]
 v_exp_f32 v224, v144
 v_exp_f32 v225, v145
 v_add_f32 v230, v230, v226
 v_cvt_pk_bf16_f32 v183, v226, v227
 v_mfma_f32_32x32x16_bf16 a[64:79], a[128:131], v[168:171], a[64:79]
 ds_read_b128 a[152:155], v24 offset:6144
 v_add_f32 v230, v230, v227
 v_exp_f32 v226, v146
 v_exp_f32 v227, v147
 v_mfma_f32_32x32x16_bf16 a[16:31], a[132:135], v[160:163], a[16:31]
 v_add_f32 v231, v229, v224
 v_cvt_pk_bf16_f32 v184, v224, v225
 v_add_f32 v231, v231, v225
 v_exp_f32 v224, v148
 v_mfma_f32_32x32x16_bf16 a[80:95], a[132:135], v[168:171], a[80:95]
 ds_read_b128 a[156:159], v24 offset:7168
 v_exp_f32 v225, v149
 v_add_f32 v231, v231, v226
 v_cvt_pk_bf16_f32 v185, v226, v227
 v_add_f32 v231, v231, v227
 v_mfma_f32_32x32x16_bf16 a[32:47], a[136:139], v[160:163], a[32:47]
 s_waitcnt vmcnt(13)
 s_barrier
 v_exp_f32 v226, v150
 v_exp_f32 v227, v151
 v_mfma_f32_32x32x16_bf16 a[96:111], a[136:139], v[168:171], a[96:111]
 ds_read_b128 a[160:163], v23 offset:16384
 v_add_f32 v231, v231, v224
 v_cvt_pk_bf16_f32 v186, v224, v225
 v_add_f32 v231, v231, v225
 s_waitcnt lgkmcnt(3)
 v_mfma_f32_32x32x16_bf16 a[48:63], a[140:143], v[160:163], a[48:63]
 ds_read_b128 a[164:167], v23 offset:17408
 v_exp_f32 v224, v152
 v_exp_f32 v225, v153
 s_lshl_b32 s19, s18, 1
 v_mfma_f32_32x32x16_bf16 a[112:127], a[140:143], v[168:171], a[112:127]
 ds_read_b128 a[168:171], v23 offset:18432
 s_add_u32 s19, s19, 0
 v_add_f32 v231, v231, v226
 s_cmp_eq_u32 s19, s94
 s_cselect_b32 s12, s15, 0
 v_cvt_pk_bf16_f32 v187, v226, v227
 v_mfma_f32_32x32x16_bf16 a[0:15], a[144:147], v[164:167], a[0:15]
 ds_read_b128 a[172:175], v23 offset:19456
 s_waitcnt vmcnt(4)
 v_cmp_ne_u32 vcc, s98, v15
 s_cbranch_vccnz P_parall_13
PB_parall_14:
 s_barrier
 v_mfma_f32_32x32x16_bf16 a[64:79], a[144:147], v[172:175], a[64:79]
 ds_read_b128 a[176:179], v23 offset:20480
 s_add_u32 m0, s74, 143360
 s_add_u32 s56, s69, 0
 v_add_f32 v231, v231, v227
 s_cmp_gt_u32 s19, s94
 s_cselect_b32 s13, s15, 0
 v_mfma_f32_32x32x16_bf16 a[16:31], a[148:151], v[164:167], a[16:31]
 ds_read_b128 a[180:183], v23 offset:21504
 buffer_load_dwordx4 v14, s[4:7], s56 offen offset:0 sc1 lds
 v_exp_f32 v226, v154
 v_fma_f32 v96, v240, s12, v96
 v_mfma_f32_32x32x16_bf16 a[80:95], a[148:151], v[172:175], a[80:95]
 ds_read_b128 a[184:187], v23 offset:22528
 buffer_load_dwordx4 v14, s[4:7], s56 offen offset:1024 sc1 lds
 v_fma_f32 v97, v241, s12, v97
 s_waitcnt lgkmcnt(4)
 v_mfma_f32_32x32x16_bf16 a[32:47], a[152:155], v[164:167], a[32:47]
 ds_read_b128 a[188:191], v23 offset:23552
 buffer_load_dwordx4 v14, s[4:7], s56 offen offset:2048 sc1 lds
 v_exp_f32 v227, v155
 v_fma_f32 v98, v242, s12, v98
 v_mfma_f32_32x32x16_bf16 a[96:111], a[152:155], v[172:175], a[96:111]
 ds_read_b128 a[128:131], v23 offset:24576
 buffer_load_dwordx4 v14, s[4:7], s56 offen offset:3072 sc1 lds
 v_fma_f32 v99, v243, s12, v99
 v_fma_f32 v100, v244, s12, v100
 v_add_f32 v231, v231, v224
 v_mfma_f32_32x32x16_bf16 a[48:63], a[156:159], v[164:167], a[48:63]
 ds_read_b128 a[132:135], v23 offset:25600
 s_add_u32 m0, s74, 147456
 v_fma_f32 v101, v245, s12, v101
 v_cvt_pk_bf16_f32 v188, v224, v225
 v_fma_f32 v102, v246, s12, v102
 v_add_f32 v231, v231, v225
 v_mfma_f32_32x32x16_bf16 a[112:127], a[156:159], v[172:175], a[112:127]
 v_fma_f32 v103, v247, s12, v103
 v_exp_f32 v224, v156
 v_fma_f32 v104, v248, s12, v104
 v_fma_f32 v105, v249, s12, v105
 v_fma_f32 v106, v250, s12, v106
 v_exp_f32 v225, v157
 v_fma_f32 v107, v251, s12, v107
 v_fma_f32 v108, v252, s12, v108
 v_add_f32 v231, v231, v226
 v_fma_f32 v109, v253, s12, v109
 v_fma_f32 v110, v254, s12, v110
 v_cvt_pk_bf16_f32 v189, v226, v227
 v_fma_f32 v111, v255, s12, v111
 v_add_f32 v231, v231, v227
 v_add_f32 v96, s13, v96
 v_exp_f32 v226, v158
 v_add_f32 v97, s13, v97
 v_add_f32 v98, s13, v98
 v_add_f32 v99, s13, v99
 v_exp_f32 v227, v159
 v_add_f32 v100, s13, v100
 v_add_f32 v101, s13, v101
 v_add_f32 v231, v231, v224
 v_add_f32 v102, s13, v102
 v_cvt_pk_bf16_f32 v190, v224, v225
 v_add_f32 v103, s13, v103
 v_add_f32 v104, s13, v104
 v_add_f32 v231, v231, v225
 v_add_f32 v105, s13, v105
 v_add_f32 v231, v231, v226
 v_add_f32 v106, s13, v106
 v_cvt_pk_bf16_f32 v191, v226, v227
 v_add_f32 v107, s13, v107
 v_add_f32 v231, v231, v227
 v_add_f32 v108, s13, v108
 v_add_f32 v109, s13, v109
 v_add_f32 v110, s13, v110
 v_add_f32 v111, s13, v111
 s_lshl_b32 s19, s18, 1
 s_add_u32 s19, s19, 1
 s_cmp_eq_u32 s19, s94
 s_cselect_b32 s12, s15, 0
 s_cmp_gt_u32 s19, s94
 s_cselect_b32 s13, s15, 0
 v_fma_f32 v112, v240, s12, v112
 v_fma_f32 v113, v241, s12, v113
 v_fma_f32 v114, v242, s12, v114
 v_fma_f32 v115, v243, s12, v115
 v_fma_f32 v116, v244, s12, v116
 v_fma_f32 v117, v245, s12, v117
 v_fma_f32 v118, v246, s12, v118
 v_fma_f32 v119, v247, s12, v119
 v_fma_f32 v120, v248, s12, v120
 v_fma_f32 v121, v249, s12, v121
 v_fma_f32 v122, v250, s12, v122
 v_fma_f32 v123, v251, s12, v123
 v_fma_f32 v124, v252, s12, v124
 v_fma_f32 v125, v253, s12, v125
 v_fma_f32 v126, v254, s12, v126
 v_fma_f32 v127, v255, s12, v127
 v_add_f32 v112, s13, v112
 v_add_f32 v113, s13, v113
 v_add_f32 v114, s13, v114
 v_add_f32 v115, s13, v115
 v_add_f32 v116, s13, v116
 v_add_f32 v117, s13, v117
 v_add_f32 v118, s13, v118
 v_add_f32 v119, s13, v119
 v_add_f32 v120, s13, v120
 v_add_f32 v121, s13, v121
 v_add_f32 v122, s13, v122
 v_add_f32 v123, s13, v123
 v_add_f32 v124, s13, v124
 v_add_f32 v125, s13, v125
 v_add_f32 v126, s13, v126
 v_add_f32 v127, s13, v127
 v_mfma_f32_32x32x16_bf16 v[128:143], a[160:163], v[64:67], v[208:223]
 ds_read_b128 a[136:139], v23 offset:26624
 s_add_u32 s56, s56, 4096
 ds_read_b128 a[140:143], v23 offset:27648
 buffer_load_dwordx4 v14, s[4:7], s56 offen sc1 lds
 v_mfma_f32_32x32x16_bf16 v[128:143], a[164:167], v[80:83], v[128:143]
 ds_read_b128 a[144:147], v23 offset:28672
 s_add_u32 s59, s71, 0
 buffer_load_dwordx4 a[192:195], v2, s[4:7], s73 offen offset:0 sc1
 v_exp_f32 v224, v96
 v_mfma_f32_32x32x16_bf16 v[128:143], a[168:171], v[68:71], v[128:143]
 ds_read_b128 a[148:151], v23 offset:29696
 buffer_load_dwordx4 a[196:199], v3, s[4:7], s73 offen offset:0 sc1
 v_exp_f32 v225, v97
 s_waitcnt lgkmcnt(4)
 v_mfma_f32_32x32x16_bf16 v[128:143], a[172:175], v[84:87], v[128:143]
 ds_read_b128 a[152:155], v23 offset:30720
 buffer_load_dwordx4 a[200:203], v2, s[4:7], s59 offen offset:1024 sc1
 v_exp_f32 v226, v98
 v_mfma_f32_32x32x16_bf16 v[128:143], a[176:179], v[72:75], v[128:143]
 ds_read_b128 a[156:159], v23 offset:31744
 buffer_load_dwordx4 a[204:207], v3, s[4:7], s59 offen offset:1024 sc1
 v_exp_f32 v227, v99
 v_add_f32 v229, v231, v224
 v_mfma_f32_32x32x16_bf16 v[128:143], a[180:183], v[88:91], v[128:143]
 ds_read_b128 a[160:163], v24 offset:8192
 s_add_u32 s59, s71, 2048
 v_cvt_pk_bf16_f32 v160, v224, v225
 v_add_f32 v229, v229, v225
 v_exp_f32 v224, v100
 v_mfma_f32_32x32x16_bf16 v[128:143], a[184:187], v[76:79], v[128:143]
 buffer_load_dwordx4 a[208:211], v2, s[4:7], s59 offen offset:0 sc1
 v_exp_f32 v225, v101
 v_add_f32 v229, v229, v226
 v_cvt_pk_bf16_f32 v161, v226, v227
 v_mfma_f32_32x32x16_bf16 v[128:143], a[188:191], v[92:95], v[128:143]
 ds_read_b128 a[164:167], v24 offset:9216
 buffer_load_dwordx4 a[212:215], v3, s[4:7], s59 offen offset:0 sc1
 v_add_f32 v229, v229, v227
 v_exp_f32 v226, v102
 v_mfma_f32_32x32x16_bf16 v[144:159], a[128:131], v[64:67], v[208:223]
 buffer_load_dwordx4 a[216:219], v2, s[4:7], s59 offen offset:1024 sc1
 v_exp_f32 v227, v103
 v_add_f32 v229, v229, v224
 v_cvt_pk_bf16_f32 v162, v224, v225
 v_mfma_f32_32x32x16_bf16 v[144:159], a[132:135], v[80:83], v[144:159]
 ds_read_b128 a[168:171], v24 offset:10240
 buffer_load_dwordx4 a[220:223], v3, s[4:7], s59 offen offset:1024 sc1
 v_add_f32 v229, v229, v225
 s_waitcnt lgkmcnt(3)
 v_mfma_f32_32x32x16_bf16 v[144:159], a[136:139], v[68:71], v[144:159]
 s_add_u32 s59, s71, 4096
 buffer_load_dwordx4 a[224:227], v2, s[4:7], s59 offen offset:0 sc1
 v_exp_f32 v224, v104
 v_mfma_f32_32x32x16_bf16 v[144:159], a[140:143], v[84:87], v[144:159]
 ds_read_b128 a[172:175], v24 offset:11264
 buffer_load_dwordx4 a[228:231], v3, s[4:7], s59 offen offset:0 sc1
 v_exp_f32 v225, v105
 v_add_f32 v229, v229, v226
 v_mfma_f32_32x32x16_bf16 v[144:159], a[144:147], v[72:75], v[144:159]
 buffer_load_dwordx4 a[232:235], v2, s[4:7], s59 offen offset:1024 sc1
 v_cvt_pk_bf16_f32 v163, v226, v227
 v_add_f32 v229, v229, v227
 v_exp_f32 v226, v106
 v_mfma_f32_32x32x16_bf16 v[144:159], a[148:151], v[88:91], v[144:159]
 ds_read_b128 a[176:179], v24 offset:12288
 buffer_load_dwordx4 a[236:239], v3, s[4:7], s59 offen offset:1024 sc1
 v_exp_f32 v227, v107
 v_add_f32 v229, v229, v224
 v_mfma_f32_32x32x16_bf16 v[144:159], a[152:155], v[76:79], v[144:159]
 s_add_u32 s59, s71, 6144
 v_cvt_pk_bf16_f32 v164, v224, v225
 v_add_f32 v229, v229, v225
 v_exp_f32 v224, v108
 v_mfma_f32_32x32x16_bf16 v[144:159], a[156:159], v[92:95], v[144:159]
 ds_read_b128 a[180:183], v24 offset:13312
 buffer_load_dwordx4 a[240:243], v2, s[4:7], s59 offen offset:0 sc1
 v_exp_f32 v225, v109
 s_waitcnt lgkmcnt(3)
 v_mfma_f32_32x32x16_bf16 a[0:15], a[160:163], v[176:179], a[0:15]
 buffer_load_dwordx4 a[244:247], v3, s[4:7], s59 offen offset:0 sc1
 v_add_f32 v229, v229, v226
 v_cvt_pk_bf16_f32 v165, v226, v227
 v_add_f32 v229, v229, v227
 v_mfma_f32_32x32x16_bf16 a[64:79], a[160:163], v[184:187], a[64:79]
 ds_read_b128 a[184:187], v24 offset:14336
 buffer_load_dwordx4 a[248:251], v2, s[4:7], s59 offen offset:1024 sc1
 v_exp_f32 v226, v110
 v_mfma_f32_32x32x16_bf16 a[16:31], a[164:167], v[176:179], a[16:31]
 ds_read_b128 a[188:191], v24 offset:15360
 buffer_load_dwordx4 a[252:255], v3, s[4:7], s59 offen offset:1024 sc1
 v_exp_f32 v227, v111
 v_add_f32 v229, v229, v224
 v_mfma_f32_32x32x16_bf16 a[80:95], a[164:167], v[184:187], a[80:95]
 v_cvt_pk_bf16_f32 v166, v224, v225
 v_add_f32 v229, v229, v225
 v_exp_f32 v224, v112
 v_exp_f32 v225, v113
 v_mfma_f32_32x32x16_bf16 a[32:47], a[168:171], v[176:179], a[32:47]
 v_xor_b32 v24, 0x18000, v23
 v_xor_b32 v23, 0x8000, v23
 v_add_f32 v229, v229, v226
 v_cvt_pk_bf16_f32 v167, v226, v227
 v_add_f32 v229, v229, v227
 v_mfma_f32_32x32x16_bf16 a[96:111], a[168:171], v[184:187], a[96:111]
 v_exp_f32 v226, v114
 v_exp_f32 v227, v115
 v_add_f32 v229, v229, v224
 s_waitcnt lgkmcnt(2)
 v_mfma_f32_32x32x16_bf16 a[48:63], a[172:175], v[176:179], a[48:63]
 s_waitcnt vmcnt(21) lgkmcnt(0)
 s_barrier
 ds_read_b128 a[128:131], v23 offset:0
 s_xor_b32 s91, s91, 0x8000
 ds_read_b128 a[132:135], v23 offset:1024
 v_cvt_pk_bf16_f32 v168, v224, v225
 v_mfma_f32_32x32x16_bf16 a[112:127], a[172:175], v[184:187], a[112:127]
 ds_read_b128 a[136:139], v23 offset:2048
 s_add_u32 s90, s90, 65536
 v_add_f32 v229, v229, v225
 v_exp_f32 v224, v116
 v_mfma_f32_32x32x16_bf16 a[0:15], a[176:179], v[180:183], a[0:15]
 ds_read_b128 a[140:143], v23 offset:3072
 s_add_u32 m0, s74, 81920
 s_add_u32 s56, s69, 20480
 v_exp_f32 v225, v117
 v_add_f32 v229, v229, v226
 v_mfma_f32_32x32x16_bf16 a[64:79], a[176:179], v[188:191], a[64:79]
 ds_read_b128 a[144:147], v23 offset:4096
 buffer_load_dwordx4 v14, s[4:7], s56 offen offset:0 sc1 lds
 v_cvt_pk_bf16_f32 v169, v226, v227
 v_add_f32 v229, v229, v227
 v_mfma_f32_32x32x16_bf16 a[16:31], a[180:183], v[180:183], a[16:31]
 ds_read_b128 a[148:151], v23 offset:5120
 buffer_load_dwordx4 v14, s[4:7], s56 offen offset:1024 sc1 lds
 v_exp_f32 v226, v118
 v_mfma_f32_32x32x16_bf16 a[80:95], a[180:183], v[188:191], a[80:95]
 buffer_load_dwordx4 v14, s[4:7], s56 offen offset:2048 sc1 lds
 v_exp_f32 v227, v119
 v_add_f32 v229, v229, v224
 v_cvt_pk_bf16_f32 v170, v224, v225
 v_mfma_f32_32x32x16_bf16 a[32:47], a[184:187], v[180:183], a[32:47]
 buffer_load_dwordx4 v14, s[4:7], s56 offen offset:3072 sc1 lds
 v_add_f32 v229, v229, v225
 v_exp_f32 v224, v120
 v_mfma_f32_32x32x16_bf16 a[96:111], a[184:187], v[188:191], a[96:111]
 s_add_u32 m0, s74, 86016
 s_add_u32 s56, s56, 4096
 v_exp_f32 v225, v121
 s_lshl_b32 s19, s18, 1
 s_add_u32 s19, s19, 2
 v_mfma_f32_32x32x16_bf16 a[48:63], a[188:191], v[180:183], a[48:63]
 buffer_load_dwordx4 v14, s[4:7], s56 offen sc1 lds
 v_add_f32 v229, v229, v226
 s_cmp_eq_u32 s19, s94
 s_cselect_b32 s12, s15, 0
 v_cvt_pk_bf16_f32 v171, v226, v227
 v_mfma_f32_32x32x16_bf16 a[112:127], a[188:191], v[188:191], a[112:127]
 v_add_f32 v229, v229, v227
 s_cmp_gt_u32 s19, s94
 s_cselect_b32 s13, s15, 0
 v_exp_f32 v226, v122
 v_fma_f32 v128, v240, s12, v128
 v_fma_f32 v129, v241, s12, v129
 v_exp_f32 v227, v123
 v_fma_f32 v130, v242, s12, v130
 v_fma_f32 v131, v243, s12, v131
 v_fma_f32 v132, v244, s12, v132
 v_add_f32 v229, v229, v224
 v_fma_f32 v133, v245, s12, v133
 v_cvt_pk_bf16_f32 v172, v224, v225
 v_fma_f32 v134, v246, s12, v134
 v_add_f32 v229, v229, v225
 v_fma_f32 v135, v247, s12, v135
 v_exp_f32 v224, v124
 v_fma_f32 v136, v248, s12, v136
 v_fma_f32 v137, v249, s12, v137
 v_fma_f32 v138, v250, s12, v138
 v_exp_f32 v225, v125
 v_fma_f32 v139, v251, s12, v139
 v_fma_f32 v140, v252, s12, v140
 v_add_f32 v229, v229, v226
 v_fma_f32 v141, v253, s12, v141
 v_fma_f32 v142, v254, s12, v142
 v_cvt_pk_bf16_f32 v173, v226, v227
 v_fma_f32 v143, v255, s12, v143
 v_add_f32 v229, v229, v227
 v_add_f32 v128, s13, v128
 v_exp_f32 v226, v126
 v_add_f32 v129, s13, v129
 v_add_f32 v130, s13, v130
 v_add_f32 v131, s13, v131
 v_exp_f32 v227, v127
 v_add_f32 v132, s13, v132
 v_add_f32 v133, s13, v133
 v_add_f32 v229, v229, v224
 v_add_f32 v134, s13, v134
 v_cvt_pk_bf16_f32 v174, v224, v225
 v_add_f32 v135, s13, v135
 v_add_f32 v136, s13, v136
 v_add_f32 v229, v229, v225
 v_add_f32 v137, s13, v137
 v_add_f32 v229, v229, v226
 v_add_f32 v138, s13, v138
 v_cvt_pk_bf16_f32 v175, v226, v227
 v_add_f32 v139, s13, v139
 v_add_f32 v229, v229, v227
 v_add_f32 v140, s13, v140
 v_add_f32 v141, s13, v141
 v_add_f32 v142, s13, v142
 v_add_f32 v143, s13, v143
 s_lshl_b32 s19, s18, 1
 s_add_u32 s19, s19, 3
 s_cmp_eq_u32 s19, s94
 s_cselect_b32 s12, s15, 0
 s_cmp_gt_u32 s19, s94
 s_cselect_b32 s13, s15, 0
 v_fma_f32 v144, v240, s12, v144
 v_fma_f32 v145, v241, s12, v145
 v_fma_f32 v146, v242, s12, v146
 v_fma_f32 v147, v243, s12, v147
 v_fma_f32 v148, v244, s12, v148
 v_fma_f32 v149, v245, s12, v149
 v_fma_f32 v150, v246, s12, v150
 v_fma_f32 v151, v247, s12, v151
 v_fma_f32 v152, v248, s12, v152
 v_fma_f32 v153, v249, s12, v153
 v_fma_f32 v154, v250, s12, v154
 v_fma_f32 v155, v251, s12, v155
 v_fma_f32 v156, v252, s12, v156
 v_fma_f32 v157, v253, s12, v157
 v_fma_f32 v158, v254, s12, v158
 v_fma_f32 v159, v255, s12, v159
 v_add_f32 v144, s13, v144
 v_add_f32 v145, s13, v145
 v_add_f32 v146, s13, v146
 v_add_f32 v147, s13, v147
 v_add_f32 v148, s13, v148
 v_add_f32 v149, s13, v149
 v_add_f32 v150, s13, v150
 v_add_f32 v151, s13, v151
 v_add_f32 v152, s13, v152
 v_add_f32 v153, s13, v153
 v_add_f32 v154, s13, v154
 v_add_f32 v155, s13, v155
 v_add_f32 v156, s13, v156
 v_add_f32 v157, s13, v157
 v_add_f32 v158, s13, v158
 v_add_f32 v159, s13, v159
 s_add_u32 s18, s18, 2
 v_mov_b32 v235, v230
 s_nop 1
 v_permlane32_swap_b32 v230, v235
 v_add_f32 v230, v230, v235
 v_rcp_f32 v232, v230
 s_mul_i32 s57, s93, 372736
 s_lshl_b32 s58, s84, 12
 s_add_u32 s57, s57, s58
 s_add_u32 s57, s57, 39845888
 v_accvgpr_read_b32 v96, a0
 v_accvgpr_read_b32 v97, a1
 v_accvgpr_read_b32 v98, a2
 v_accvgpr_read_b32 v99, a3
 v_accvgpr_read_b32 v100, a4
 v_accvgpr_read_b32 v101, a5
 v_accvgpr_read_b32 v102, a6
 v_accvgpr_read_b32 v103, a7
 v_accvgpr_read_b32 v104, a8
 v_accvgpr_read_b32 v105, a9
 v_accvgpr_read_b32 v106, a10
 v_accvgpr_read_b32 v107, a11
 v_accvgpr_read_b32 v108, a12
 v_accvgpr_read_b32 v109, a13
 v_accvgpr_read_b32 v110, a14
 v_accvgpr_read_b32 v111, a15
 v_pk_mul_f32 v[96:97], v[96:97], v[232:233] op_sel_hi:[1,0]
 v_pk_mul_f32 v[98:99], v[98:99], v[232:233] op_sel_hi:[1,0]
 v_pk_mul_f32 v[100:101], v[100:101], v[232:233] op_sel_hi:[1,0]
 v_pk_mul_f32 v[102:103], v[102:103], v[232:233] op_sel_hi:[1,0]
 v_pk_mul_f32 v[104:105], v[104:105], v[232:233] op_sel_hi:[1,0]
 v_pk_mul_f32 v[106:107], v[106:107], v[232:233] op_sel_hi:[1,0]
 v_pk_mul_f32 v[108:109], v[108:109], v[232:233] op_sel_hi:[1,0]
 v_pk_mul_f32 v[110:111], v[110:111], v[232:233] op_sel_hi:[1,0]
 v_cvt_pk_bf16_f32 v96, v96, v97
 v_cvt_pk_bf16_f32 v97, v98, v99
 v_cvt_pk_bf16_f32 v98, v100, v101
 v_cvt_pk_bf16_f32 v99, v102, v103
 buffer_store_dwordx4 v[96:99], v25, s[4:7], s57 offen offset:0 sc1
 v_cvt_pk_bf16_f32 v104, v104, v105
 v_cvt_pk_bf16_f32 v105, v106, v107
 v_cvt_pk_bf16_f32 v106, v108, v109
 v_cvt_pk_bf16_f32 v107, v110, v111
 buffer_store_dwordx4 v[104:107], v25, s[4:7], s57 offen offset:512 sc1
 v_accvgpr_read_b32 v112, a16
 v_accvgpr_read_b32 v113, a17
 v_accvgpr_read_b32 v114, a18
 v_accvgpr_read_b32 v115, a19
 v_accvgpr_read_b32 v116, a20
 v_accvgpr_read_b32 v117, a21
 v_accvgpr_read_b32 v118, a22
 v_accvgpr_read_b32 v119, a23
 v_accvgpr_read_b32 v120, a24
 v_accvgpr_read_b32 v121, a25
 v_accvgpr_read_b32 v122, a26
 v_accvgpr_read_b32 v123, a27
 v_accvgpr_read_b32 v124, a28
 v_accvgpr_read_b32 v125, a29
 v_accvgpr_read_b32 v126, a30
 v_accvgpr_read_b32 v127, a31
 v_pk_mul_f32 v[112:113], v[112:113], v[232:233] op_sel_hi:[1,0]
 v_pk_mul_f32 v[114:115], v[114:115], v[232:233] op_sel_hi:[1,0]
 v_pk_mul_f32 v[116:117], v[116:117], v[232:233] op_sel_hi:[1,0]
 v_pk_mul_f32 v[118:119], v[118:119], v[232:233] op_sel_hi:[1,0]
 v_pk_mul_f32 v[120:121], v[120:121], v[232:233] op_sel_hi:[1,0]
 v_pk_mul_f32 v[122:123], v[122:123], v[232:233] op_sel_hi:[1,0]
 v_pk_mul_f32 v[124:125], v[124:125], v[232:233] op_sel_hi:[1,0]
 v_pk_mul_f32 v[126:127], v[126:127], v[232:233] op_sel_hi:[1,0]
 v_cvt_pk_bf16_f32 v112, v112, v113
 v_cvt_pk_bf16_f32 v113, v114, v115
 v_cvt_pk_bf16_f32 v114, v116, v117
 v_cvt_pk_bf16_f32 v115, v118, v119
 buffer_store_dwordx4 v[112:115], v25, s[4:7], s57 offen offset:1024 sc1
 v_cvt_pk_bf16_f32 v120, v120, v121
 v_cvt_pk_bf16_f32 v121, v122, v123
 v_cvt_pk_bf16_f32 v122, v124, v125
 v_cvt_pk_bf16_f32 v123, v126, v127
 buffer_store_dwordx4 v[120:123], v25, s[4:7], s57 offen offset:1536 sc1
 v_accvgpr_read_b32 v96, a32
 v_accvgpr_read_b32 v97, a33
 v_accvgpr_read_b32 v98, a34
 v_accvgpr_read_b32 v99, a35
 v_accvgpr_read_b32 v100, a36
 v_accvgpr_read_b32 v101, a37
 v_accvgpr_read_b32 v102, a38
 v_accvgpr_read_b32 v103, a39
 v_accvgpr_read_b32 v104, a40
 v_accvgpr_read_b32 v105, a41
 v_accvgpr_read_b32 v106, a42
 v_accvgpr_read_b32 v107, a43
 v_accvgpr_read_b32 v108, a44
 v_accvgpr_read_b32 v109, a45
 v_accvgpr_read_b32 v110, a46
 v_accvgpr_read_b32 v111, a47
 v_pk_mul_f32 v[96:97], v[96:97], v[232:233] op_sel_hi:[1,0]
 v_pk_mul_f32 v[98:99], v[98:99], v[232:233] op_sel_hi:[1,0]
 v_pk_mul_f32 v[100:101], v[100:101], v[232:233] op_sel_hi:[1,0]
 v_pk_mul_f32 v[102:103], v[102:103], v[232:233] op_sel_hi:[1,0]
 v_pk_mul_f32 v[104:105], v[104:105], v[232:233] op_sel_hi:[1,0]
 v_pk_mul_f32 v[106:107], v[106:107], v[232:233] op_sel_hi:[1,0]
 v_pk_mul_f32 v[108:109], v[108:109], v[232:233] op_sel_hi:[1,0]
 v_pk_mul_f32 v[110:111], v[110:111], v[232:233] op_sel_hi:[1,0]
 v_cvt_pk_bf16_f32 v96, v96, v97
 v_cvt_pk_bf16_f32 v97, v98, v99
 v_cvt_pk_bf16_f32 v98, v100, v101
 v_cvt_pk_bf16_f32 v99, v102, v103
 buffer_store_dwordx4 v[96:99], v25, s[4:7], s57 offen offset:2048 sc1
 v_cvt_pk_bf16_f32 v104, v104, v105
 v_cvt_pk_bf16_f32 v105, v106, v107
 v_cvt_pk_bf16_f32 v106, v108, v109
 v_cvt_pk_bf16_f32 v107, v110, v111
 buffer_store_dwordx4 v[104:107], v25, s[4:7], s57 offen offset:2560 sc1
 v_accvgpr_read_b32 v112, a48
 v_accvgpr_read_b32 v113, a49
 v_accvgpr_read_b32 v114, a50
 v_accvgpr_read_b32 v115, a51
 v_accvgpr_read_b32 v116, a52
 v_accvgpr_read_b32 v117, a53
 v_accvgpr_read_b32 v118, a54
 v_accvgpr_read_b32 v119, a55
 v_accvgpr_read_b32 v120, a56
 v_accvgpr_read_b32 v121, a57
 v_accvgpr_read_b32 v122, a58
 v_accvgpr_read_b32 v123, a59
 v_accvgpr_read_b32 v124, a60
 v_accvgpr_read_b32 v125, a61
 v_accvgpr_read_b32 v126, a62
 v_accvgpr_read_b32 v127, a63
 v_pk_mul_f32 v[112:113], v[112:113], v[232:233] op_sel_hi:[1,0]
 v_pk_mul_f32 v[114:115], v[114:115], v[232:233] op_sel_hi:[1,0]
 v_pk_mul_f32 v[116:117], v[116:117], v[232:233] op_sel_hi:[1,0]
 v_pk_mul_f32 v[118:119], v[118:119], v[232:233] op_sel_hi:[1,0]
 v_pk_mul_f32 v[120:121], v[120:121], v[232:233] op_sel_hi:[1,0]
 v_pk_mul_f32 v[122:123], v[122:123], v[232:233] op_sel_hi:[1,0]
 v_pk_mul_f32 v[124:125], v[124:125], v[232:233] op_sel_hi:[1,0]
 v_pk_mul_f32 v[126:127], v[126:127], v[232:233] op_sel_hi:[1,0]
 v_cvt_pk_bf16_f32 v112, v112, v113
 v_cvt_pk_bf16_f32 v113, v114, v115
 v_cvt_pk_bf16_f32 v114, v116, v117
 v_cvt_pk_bf16_f32 v115, v118, v119
 buffer_store_dwordx4 v[112:115], v25, s[4:7], s57 offen offset:3072 sc1
 v_cvt_pk_bf16_f32 v120, v120, v121
 v_cvt_pk_bf16_f32 v121, v122, v123
 v_cvt_pk_bf16_f32 v122, v124, v125
 v_cvt_pk_bf16_f32 v123, v126, v127
 buffer_store_dwordx4 v[120:123], v25, s[4:7], s57 offen offset:3584 sc1
 s_branch L_drain_f
L_X:
 s_waitcnt lgkmcnt(5)
 v_mfma_f32_32x32x16_bf16 v[96:111], a[128:131], v[64:67], v[208:223]
 ds_read_b128 a[152:155], v23 offset:6144
 ds_read_b128 a[156:159], v23 offset:7168
 ds_read_b128 a[160:163], v23 offset:8192
 v_exp_f32 v224, v128
 s_waitcnt lgkmcnt(7)
 v_mfma_f32_32x32x16_bf16 v[96:111], a[132:135], v[80:83], v[96:111]
 s_add_u32 m0, s91, 0x14000
 ds_read_b128 a[164:167], v23 offset:9216
 ds_read_b128 a[168:171], v23 offset:10240
 ds_read_b128 a[172:175], v23 offset:11264
 s_waitcnt lgkmcnt(9)
 v_mfma_f32_32x32x16_bf16 v[96:111], a[136:139], v[68:71], v[96:111]
 ds_read_b128 a[176:179], v23 offset:12288
 ds_read_b128 a[180:183], v23 offset:13312
 v_exp_f32 v225, v129
 s_waitcnt lgkmcnt(10)
 v_mfma_f32_32x32x16_bf16 v[96:111], a[140:143], v[84:87], v[96:111]
 ds_read_b128 a[184:187], v23 offset:14336
 s_add_u32 s56, s90, 32768
 v_exp_f32 v226, v130
 s_waitcnt lgkmcnt(10)
 v_mfma_f32_32x32x16_bf16 v[96:111], a[144:147], v[72:75], v[96:111]
 ds_read_b128 a[188:191], v23 offset:15360
 v_exp_f32 v227, v131
 v_add_f32 v230, v228, v224
 v_cvt_pk_bf16_f32 v176, v224, v225
 s_waitcnt lgkmcnt(10)
 v_mfma_f32_32x32x16_bf16 v[96:111], a[148:151], v[88:91], v[96:111]
 ds_read_b128 a[128:131], v24 offset:0
 v_add_f32 v230, v230, v225
 v_exp_f32 v224, v132
 s_waitcnt lgkmcnt(8)
 v_mfma_f32_32x32x16_bf16 v[96:111], a[152:155], v[76:79], v[96:111]
 buffer_load_dwordx4 v14, s[32:35], s56 offen offset:0 sc1 lds
 v_exp_f32 v225, v133
 v_add_f32 v230, v230, v226
 v_cvt_pk_bf16_f32 v177, v226, v227
 v_mfma_f32_32x32x16_bf16 v[96:111], a[156:159], v[92:95], v[96:111]
 ds_read_b128 a[132:135], v24 offset:1024
 v_add_f32 v230, v230, v227
 v_exp_f32 v226, v134
 v_exp_f32 v227, v135
 v_mfma_f32_32x32x16_bf16 v[112:127], a[160:163], v[64:67], v[208:223]
 v_add_f32 v230, v230, v224
 v_cvt_pk_bf16_f32 v178, v224, v225
 v_add_f32 v230, v230, v225
 v_exp_f32 v224, v136
 s_waitcnt lgkmcnt(3)
 v_mfma_f32_32x32x16_bf16 v[112:127], a[164:167], v[80:83], v[112:127]
 ds_read_b128 a[136:139], v24 offset:2048
 buffer_load_dwordx4 v14, s[32:35], s56 offen offset:1024 sc1 lds
 v_exp_f32 v225, v137
 v_add_f32 v230, v230, v226
 v_mfma_f32_32x32x16_bf16 v[112:127], a[168:171], v[68:71], v[112:127]
 v_cvt_pk_bf16_f32 v179, v226, v227
 v_add_f32 v230, v230, v227
 v_exp_f32 v226, v138
 v_exp_f32 v227, v139
 v_mfma_f32_32x32x16_bf16 v[112:127], a[172:175], v[84:87], v[112:127]
 ds_read_b128 a[140:143], v24 offset:3072
 v_add_f32 v230, v230, v224
 v_cvt_pk_bf16_f32 v180, v224, v225
 v_add_f32 v230, v230, v225
 v_exp_f32 v224, v140
 v_mfma_f32_32x32x16_bf16 v[112:127], a[176:179], v[72:75], v[112:127]
 buffer_load_dwordx4 v14, s[32:35], s56 offen offset:2048 sc1 lds
 v_exp_f32 v225, v141
 v_add_f32 v230, v230, v226
 v_cvt_pk_bf16_f32 v181, v226, v227
 v_mfma_f32_32x32x16_bf16 v[112:127], a[180:183], v[88:91], v[112:127]
 ds_read_b128 a[144:147], v24 offset:4096
 v_add_f32 v230, v230, v227
 v_exp_f32 v226, v142
 v_exp_f32 v227, v143
 v_mfma_f32_32x32x16_bf16 v[112:127], a[184:187], v[76:79], v[112:127]
 v_add_f32 v230, v230, v224
 v_cvt_pk_bf16_f32 v182, v224, v225
 v_add_f32 v230, v230, v225
 v_exp_f32 v224, v144
 s_waitcnt lgkmcnt(2)
 v_mfma_f32_32x32x16_bf16 v[112:127], a[188:191], v[92:95], v[112:127]
 ds_read_b128 a[148:151], v24 offset:5120
 buffer_load_dwordx4 v14, s[32:35], s56 offen offset:3072 sc1 lds
 v_exp_f32 v225, v145
 v_add_f32 v230, v230, v226
 v_mfma_f32_32x32x16_bf16 a[0:15], a[128:131], v[160:163], a[0:15]
 v_cvt_pk_bf16_f32 v183, v226, v227
 v_add_f32 v230, v230, v227
 v_exp_f32 v226, v146
 v_exp_f32 v227, v147
 v_mfma_f32_32x32x16_bf16 a[64:79], a[128:131], v[168:171], a[64:79]
 ds_read_b128 a[152:155], v24 offset:6144
 v_add_f32 v231, v229, v224
 v_cvt_pk_bf16_f32 v184, v224, v225
 v_add_f32 v231, v231, v225
 v_exp_f32 v224, v148
 v_mfma_f32_32x32x16_bf16 a[16:31], a[132:135], v[160:163], a[16:31]
 s_mov_b32 m0, s91
 v_exp_f32 v225, v149
 v_add_f32 v231, v231, v226
 v_cvt_pk_bf16_f32 v185, v226, v227
 v_add_f32 v231, v231, v227
 v_mfma_f32_32x32x16_bf16 a[80:95], a[132:135], v[168:171], a[80:95]
 ds_read_b128 a[156:159], v24 offset:7168
 v_exp_f32 v226, v150
 v_exp_f32 v227, v151
 v_add_f32 v231, v231, v224
 v_mfma_f32_32x32x16_bf16 a[32:47], a[136:139], v[160:163], a[32:47]
 s_waitcnt vmcnt(12)
 s_barrier
 v_cvt_pk_bf16_f32 v186, v224, v225
 v_add_f32 v231, v231, v225
 v_exp_f32 v224, v152
 v_mfma_f32_32x32x16_bf16 a[96:111], a[136:139], v[168:171], a[96:111]
 ds_read_b128 a[160:163], v23 offset:16384
 s_add_u32 s56, s90, 4294950912
 v_exp_f32 v225, v153
 v_add_f32 v231, v231, v226
 s_waitcnt lgkmcnt(3)
 v_mfma_f32_32x32x16_bf16 a[48:63], a[140:143], v[160:163], a[48:63]
 ds_read_b128 a[164:167], v23 offset:17408
 v_cvt_pk_bf16_f32 v187, v226, v227
 v_add_f32 v231, v231, v227
 v_exp_f32 v226, v154
 v_mfma_f32_32x32x16_bf16 a[112:127], a[140:143], v[168:171], a[112:127]
 ds_read_b128 a[168:171], v23 offset:18432
 v_exp_f32 v227, v155
 v_add_f32 v231, v231, v224
 v_cvt_pk_bf16_f32 v188, v224, v225
 v_add_f32 v231, v231, v225
 v_mfma_f32_32x32x16_bf16 a[0:15], a[144:147], v[164:167], a[0:15]
 ds_read_b128 a[172:175], v23 offset:19456
 buffer_load_dwordx4 v14, s[32:35], s56 offen offset:0 sc1 lds
 v_exp_f32 v224, v156
 v_mfma_f32_32x32x16_bf16 a[64:79], a[144:147], v[172:175], a[64:79]
 ds_read_b128 a[176:179], v23 offset:20480
 v_exp_f32 v225, v157
 v_add_f32 v231, v231, v226
 v_cvt_pk_bf16_f32 v189, v226, v227
 v_add_f32 v231, v231, v227
 v_mfma_f32_32x32x16_bf16 a[16:31], a[148:151], v[164:167], a[16:31]
 ds_read_b128 a[180:183], v23 offset:21504
 v_exp_f32 v226, v158
 v_exp_f32 v227, v159
 v_add_f32 v231, v231, v224
 v_mfma_f32_32x32x16_bf16 a[80:95], a[148:151], v[172:175], a[80:95]
 ds_read_b128 a[184:187], v23 offset:22528
 buffer_load_dwordx4 v14, s[32:35], s56 offen offset:1024 sc1 lds
 v_cvt_pk_bf16_f32 v190, v224, v225
 v_add_f32 v231, v231, v225
 s_waitcnt lgkmcnt(5)
 v_mfma_f32_32x32x16_bf16 a[32:47], a[152:155], v[164:167], a[32:47]
 ds_read_b128 a[188:191], v23 offset:23552
 v_add_f32 v231, v231, v226
 v_cvt_pk_bf16_f32 v191, v226, v227
 v_add_f32 v231, v231, v227
 v_mfma_f32_32x32x16_bf16 a[96:111], a[152:155], v[172:175], a[96:111]
 ds_read_b128 a[128:131], v23 offset:24576
 v_mfma_f32_32x32x16_bf16 a[48:63], a[156:159], v[164:167], a[48:63]
 ds_read_b128 a[132:135], v23 offset:25600
 buffer_load_dwordx4 v14, s[32:35], s56 offen offset:2048 sc1 lds
 v_mfma_f32_32x32x16_bf16 a[112:127], a[156:159], v[172:175], a[112:127]
 ds_read_b128 a[136:139], v23 offset:26624
 v_mfma_f32_32x32x16_bf16 v[128:143], a[160:163], v[64:67], v[208:223]
 ds_read_b128 a[140:143], v23 offset:27648
 v_exp_f32 v224, v96
 v_exp_f32 v225, v97
 v_mfma_f32_32x32x16_bf16 v[128:143], a[164:167], v[80:83], v[128:143]
 ds_read_b128 a[144:147], v23 offset:28672
 buffer_load_dwordx4 v14, s[32:35], s56 offen offset:3072 sc1 lds
 v_exp_f32 v226, v98
 s_waitcnt lgkmcnt(5)
 v_mfma_f32_32x32x16_bf16 v[128:143], a[168:171], v[68:71], v[128:143]
 ds_read_b128 a[148:151], v23 offset:29696
 v_exp_f32 v227, v99
 v_add_f32 v229, v231, v224
 v_cvt_pk_bf16_f32 v160, v224, v225
 v_add_f32 v229, v229, v225
 v_mfma_f32_32x32x16_bf16 v[128:143], a[172:175], v[84:87], v[128:143]
 ds_read_b128 a[152:155], v23 offset:30720
 v_exp_f32 v224, v100
 v_exp_f32 v225, v101
 v_add_f32 v229, v229, v226
 v_mfma_f32_32x32x16_bf16 v[128:143], a[176:179], v[72:75], v[128:143]
 ds_read_b128 a[156:159], v23 offset:31744
 v_cvt_pk_bf16_f32 v161, v226, v227
 v_add_f32 v229, v229, v227
 v_exp_f32 v226, v102
 v_mfma_f32_32x32x16_bf16 v[128:143], a[180:183], v[88:91], v[128:143]
 ds_read_b128 a[160:163], v24 offset:8192
 v_exp_f32 v227, v103
 v_add_f32 v229, v229, v224
 v_cvt_pk_bf16_f32 v162, v224, v225
 v_add_f32 v229, v229, v225
 v_mfma_f32_32x32x16_bf16 v[128:143], a[184:187], v[76:79], v[128:143]
 v_exp_f32 v224, v104
 v_exp_f32 v225, v105
 v_add_f32 v229, v229, v226
 v_cvt_pk_bf16_f32 v163, v226, v227
 v_mfma_f32_32x32x16_bf16 v[128:143], a[188:191], v[92:95], v[128:143]
 ds_read_b128 a[164:167], v24 offset:9216
 v_add_f32 v229, v229, v227
 v_exp_f32 v226, v106
 s_waitcnt lgkmcnt(4)
 v_mfma_f32_32x32x16_bf16 v[144:159], a[128:131], v[64:67], v[208:223]
 v_exp_f32 v227, v107
 v_add_f32 v229, v229, v224
 v_cvt_pk_bf16_f32 v164, v224, v225
 v_add_f32 v229, v229, v225
 v_mfma_f32_32x32x16_bf16 v[144:159], a[132:135], v[80:83], v[144:159]
 ds_read_b128 a[168:171], v24 offset:10240
 v_exp_f32 v224, v108
 v_exp_f32 v225, v109
 v_add_f32 v229, v229, v226
 v_mfma_f32_32x32x16_bf16 v[144:159], a[136:139], v[68:71], v[144:159]
 v_cvt_pk_bf16_f32 v165, v226, v227
 v_add_f32 v229, v229, v227
 v_exp_f32 v226, v110
 v_exp_f32 v227, v111
 v_mfma_f32_32x32x16_bf16 v[144:159], a[140:143], v[84:87], v[144:159]
 ds_read_b128 a[172:175], v24 offset:11264
 v_add_f32 v229, v229, v224
 v_cvt_pk_bf16_f32 v166, v224, v225
 v_add_f32 v229, v229, v225
 v_exp_f32 v224, v112
 v_mfma_f32_32x32x16_bf16 v[144:159], a[144:147], v[72:75], v[144:159]
 v_exp_f32 v225, v113
 v_add_f32 v229, v229, v226
 v_cvt_pk_bf16_f32 v167, v226, v227
 v_add_f32 v229, v229, v227
 v_mfma_f32_32x32x16_bf16 v[144:159], a[148:151], v[88:91], v[144:159]
 ds_read_b128 a[176:179], v24 offset:12288
 v_exp_f32 v226, v114
 v_exp_f32 v227, v115
 s_waitcnt lgkmcnt(3)
 v_mfma_f32_32x32x16_bf16 v[144:159], a[152:155], v[76:79], v[144:159]
 v_add_f32 v229, v229, v224
 v_cvt_pk_bf16_f32 v168, v224, v225
 v_add_f32 v229, v229, v225
 v_exp_f32 v224, v116
 v_mfma_f32_32x32x16_bf16 v[144:159], a[156:159], v[92:95], v[144:159]
 ds_read_b128 a[180:183], v24 offset:13312
 v_exp_f32 v225, v117
 v_add_f32 v229, v229, v226
 v_cvt_pk_bf16_f32 v169, v226, v227
 v_add_f32 v229, v229, v227
 v_mfma_f32_32x32x16_bf16 a[0:15], a[160:163], v[176:179], a[0:15]
 v_exp_f32 v226, v118
 v_exp_f32 v227, v119
 v_add_f32 v229, v229, v224
 v_cvt_pk_bf16_f32 v170, v224, v225
 v_mfma_f32_32x32x16_bf16 a[64:79], a[160:163], v[184:187], a[64:79]
 ds_read_b128 a[184:187], v24 offset:14336
 v_add_f32 v229, v229, v225
 v_exp_f32 v224, v120
 v_exp_f32 v225, v121
 v_mfma_f32_32x32x16_bf16 a[16:31], a[164:167], v[176:179], a[16:31]
 ds_read_b128 a[188:191], v24 offset:15360
 v_add_f32 v229, v229, v226
 v_cvt_pk_bf16_f32 v171, v226, v227
 v_add_f32 v229, v229, v227
 v_exp_f32 v226, v122
 v_mfma_f32_32x32x16_bf16 a[80:95], a[164:167], v[184:187], a[80:95]
 v_exp_f32 v227, v123
 v_add_f32 v229, v229, v224
 v_cvt_pk_bf16_f32 v172, v224, v225
 s_waitcnt lgkmcnt(3)
 v_mfma_f32_32x32x16_bf16 a[32:47], a[168:171], v[176:179], a[32:47]
 v_xor_b32 v24, 0x18000, v23
 v_xor_b32 v23, 0x8000, v23
 v_add_f32 v229, v229, v225
 v_exp_f32 v224, v124
 v_mfma_f32_32x32x16_bf16 a[96:111], a[168:171], v[184:187], a[96:111]
 v_exp_f32 v225, v125
 v_add_f32 v229, v229, v226
 v_cvt_pk_bf16_f32 v173, v226, v227
 v_add_f32 v229, v229, v227
 v_mfma_f32_32x32x16_bf16 a[48:63], a[172:175], v[176:179], a[48:63]
 s_waitcnt vmcnt(0) lgkmcnt(0)
 s_barrier
 ds_read_b128 a[128:131], v23 offset:0
 s_xor_b32 s91, s91, 0x8000
 ds_read_b128 a[132:135], v23 offset:1024
 v_mfma_f32_32x32x16_bf16 a[112:127], a[172:175], v[184:187], a[112:127]
 ds_read_b128 a[136:139], v23 offset:2048
 s_add_u32 s90, s90, 65536
 v_exp_f32 v226, v126
 v_exp_f32 v227, v127
 v_mfma_f32_32x32x16_bf16 a[0:15], a[176:179], v[180:183], a[0:15]
 ds_read_b128 a[140:143], v23 offset:3072
 s_add_u32 s18, s18, 2
 v_add_f32 v229, v229, v224
 v_cvt_pk_bf16_f32 v174, v224, v225
 v_add_f32 v229, v229, v225
 v_add_f32 v229, v229, v226
 v_mfma_f32_32x32x16_bf16 a[64:79], a[176:179], v[188:191], a[64:79]
 ds_read_b128 a[144:147], v23 offset:4096
 s_or_b32 m0, s91, 0x10000
 v_cvt_pk_bf16_f32 v175, v226, v227
 v_add_f32 v229, v229, v227
 v_mfma_f32_32x32x16_bf16 a[16:31], a[180:183], v[180:183], a[16:31]
 ds_read_b128 a[148:151], v23 offset:5120
 v_mfma_f32_32x32x16_bf16 a[80:95], a[180:183], v[188:191], a[80:95]
 buffer_load_dwordx4 v14, s[32:35], s90 offen offset:0 sc1 lds
 v_mfma_f32_32x32x16_bf16 a[32:47], a[184:187], v[180:183], a[32:47]
 buffer_load_dwordx4 v14, s[32:35], s90 offen offset:1024 sc1 lds
 v_mfma_f32_32x32x16_bf16 a[96:111], a[184:187], v[188:191], a[96:111]
 buffer_load_dwordx4 v14, s[32:35], s90 offen offset:2048 sc1 lds
 v_mfma_f32_32x32x16_bf16 a[48:63], a[188:191], v[180:183], a[48:63]
 buffer_load_dwordx4 v14, s[32:35], s90 offen offset:3072 sc1 lds
 v_mfma_f32_32x32x16_bf16 a[112:127], a[188:191], v[188:191], a[112:127]
 v_mov_b32 v235, v230
 s_nop 1
 v_permlane32_swap_b32 v230, v235
 v_add_f32 v230, v230, v235
 v_rcp_f32 v232, v230
 s_mul_i32 s57, s93, 372736
 s_lshl_b32 s58, s84, 12
 s_add_u32 s57, s57, s58
 s_add_u32 s57, s57, 39845888
 v_accvgpr_read_b32 v96, a0
 v_accvgpr_read_b32 v97, a1
 v_accvgpr_read_b32 v98, a2
 v_accvgpr_read_b32 v99, a3
 v_accvgpr_read_b32 v100, a4
 v_accvgpr_read_b32 v101, a5
 v_accvgpr_read_b32 v102, a6
 v_accvgpr_read_b32 v103, a7
 v_accvgpr_read_b32 v104, a8
 v_accvgpr_read_b32 v105, a9
 v_accvgpr_read_b32 v106, a10
 v_accvgpr_read_b32 v107, a11
 v_accvgpr_read_b32 v108, a12
 v_accvgpr_read_b32 v109, a13
 v_accvgpr_read_b32 v110, a14
 v_accvgpr_read_b32 v111, a15
 v_pk_mul_f32 v[96:97], v[96:97], v[232:233] op_sel_hi:[1,0]
 v_pk_mul_f32 v[98:99], v[98:99], v[232:233] op_sel_hi:[1,0]
 v_pk_mul_f32 v[100:101], v[100:101], v[232:233] op_sel_hi:[1,0]
 v_pk_mul_f32 v[102:103], v[102:103], v[232:233] op_sel_hi:[1,0]
 v_pk_mul_f32 v[104:105], v[104:105], v[232:233] op_sel_hi:[1,0]
 v_pk_mul_f32 v[106:107], v[106:107], v[232:233] op_sel_hi:[1,0]
 v_pk_mul_f32 v[108:109], v[108:109], v[232:233] op_sel_hi:[1,0]
 v_pk_mul_f32 v[110:111], v[110:111], v[232:233] op_sel_hi:[1,0]
 v_cvt_pk_bf16_f32 v96, v96, v97
 v_cvt_pk_bf16_f32 v97, v98, v99
 v_cvt_pk_bf16_f32 v98, v100, v101
 v_cvt_pk_bf16_f32 v99, v102, v103
 buffer_store_dwordx4 v[96:99], v25, s[4:7], s57 offen offset:0 sc1
 v_cvt_pk_bf16_f32 v104, v104, v105
 v_cvt_pk_bf16_f32 v105, v106, v107
 v_cvt_pk_bf16_f32 v106, v108, v109
 v_cvt_pk_bf16_f32 v107, v110, v111
 buffer_store_dwordx4 v[104:107], v25, s[4:7], s57 offen offset:512 sc1
 v_accvgpr_read_b32 v112, a16
 v_accvgpr_read_b32 v113, a17
 v_accvgpr_read_b32 v114, a18
 v_accvgpr_read_b32 v115, a19
 v_accvgpr_read_b32 v116, a20
 v_accvgpr_read_b32 v117, a21
 v_accvgpr_read_b32 v118, a22
 v_accvgpr_read_b32 v119, a23
 v_accvgpr_read_b32 v120, a24
 v_accvgpr_read_b32 v121, a25
 v_accvgpr_read_b32 v122, a26
 v_accvgpr_read_b32 v123, a27
 v_accvgpr_read_b32 v124, a28
 v_accvgpr_read_b32 v125, a29
 v_accvgpr_read_b32 v126, a30
 v_accvgpr_read_b32 v127, a31
 v_pk_mul_f32 v[112:113], v[112:113], v[232:233] op_sel_hi:[1,0]
 v_pk_mul_f32 v[114:115], v[114:115], v[232:233] op_sel_hi:[1,0]
 v_pk_mul_f32 v[116:117], v[116:117], v[232:233] op_sel_hi:[1,0]
 v_pk_mul_f32 v[118:119], v[118:119], v[232:233] op_sel_hi:[1,0]
 v_pk_mul_f32 v[120:121], v[120:121], v[232:233] op_sel_hi:[1,0]
 v_pk_mul_f32 v[122:123], v[122:123], v[232:233] op_sel_hi:[1,0]
 v_pk_mul_f32 v[124:125], v[124:125], v[232:233] op_sel_hi:[1,0]
 v_pk_mul_f32 v[126:127], v[126:127], v[232:233] op_sel_hi:[1,0]
 v_cvt_pk_bf16_f32 v112, v112, v113
 v_cvt_pk_bf16_f32 v113, v114, v115
 v_cvt_pk_bf16_f32 v114, v116, v117
 v_cvt_pk_bf16_f32 v115, v118, v119
 buffer_store_dwordx4 v[112:115], v25, s[4:7], s57 offen offset:1024 sc1
 v_cvt_pk_bf16_f32 v120, v120, v121
 v_cvt_pk_bf16_f32 v121, v122, v123
 v_cvt_pk_bf16_f32 v122, v124, v125
 v_cvt_pk_bf16_f32 v123, v126, v127
 buffer_store_dwordx4 v[120:123], v25, s[4:7], s57 offen offset:1536 sc1
 v_accvgpr_read_b32 v96, a32
 v_accvgpr_read_b32 v97, a33
 v_accvgpr_read_b32 v98, a34
 v_accvgpr_read_b32 v99, a35
 v_accvgpr_read_b32 v100, a36
 v_accvgpr_read_b32 v101, a37
 v_accvgpr_read_b32 v102, a38
 v_accvgpr_read_b32 v103, a39
 v_accvgpr_read_b32 v104, a40
 v_accvgpr_read_b32 v105, a41
 v_accvgpr_read_b32 v106, a42
 v_accvgpr_read_b32 v107, a43
 v_accvgpr_read_b32 v108, a44
 v_accvgpr_read_b32 v109, a45
 v_accvgpr_read_b32 v110, a46
 v_accvgpr_read_b32 v111, a47
 v_pk_mul_f32 v[96:97], v[96:97], v[232:233] op_sel_hi:[1,0]
 v_pk_mul_f32 v[98:99], v[98:99], v[232:233] op_sel_hi:[1,0]
 v_pk_mul_f32 v[100:101], v[100:101], v[232:233] op_sel_hi:[1,0]
 v_pk_mul_f32 v[102:103], v[102:103], v[232:233] op_sel_hi:[1,0]
 v_pk_mul_f32 v[104:105], v[104:105], v[232:233] op_sel_hi:[1,0]
 v_pk_mul_f32 v[106:107], v[106:107], v[232:233] op_sel_hi:[1,0]
 v_pk_mul_f32 v[108:109], v[108:109], v[232:233] op_sel_hi:[1,0]
 v_pk_mul_f32 v[110:111], v[110:111], v[232:233] op_sel_hi:[1,0]
 v_cvt_pk_bf16_f32 v96, v96, v97
 v_cvt_pk_bf16_f32 v97, v98, v99
 v_cvt_pk_bf16_f32 v98, v100, v101
 v_cvt_pk_bf16_f32 v99, v102, v103
 buffer_store_dwordx4 v[96:99], v25, s[4:7], s57 offen offset:2048 sc1
 v_cvt_pk_bf16_f32 v104, v104, v105
 v_cvt_pk_bf16_f32 v105, v106, v107
 v_cvt_pk_bf16_f32 v106, v108, v109
 v_cvt_pk_bf16_f32 v107, v110, v111
 buffer_store_dwordx4 v[104:107], v25, s[4:7], s57 offen offset:2560 sc1
 v_accvgpr_read_b32 v112, a48
 v_accvgpr_read_b32 v113, a49
 v_accvgpr_read_b32 v114, a50
 v_accvgpr_read_b32 v115, a51
 v_accvgpr_read_b32 v116, a52
 v_accvgpr_read_b32 v117, a53
 v_accvgpr_read_b32 v118, a54
 v_accvgpr_read_b32 v119, a55
 v_accvgpr_read_b32 v120, a56
 v_accvgpr_read_b32 v121, a57
 v_accvgpr_read_b32 v122, a58
 v_accvgpr_read_b32 v123, a59
 v_accvgpr_read_b32 v124, a60
 v_accvgpr_read_b32 v125, a61
 v_accvgpr_read_b32 v126, a62
 v_accvgpr_read_b32 v127, a63
 v_pk_mul_f32 v[112:113], v[112:113], v[232:233] op_sel_hi:[1,0]
 v_pk_mul_f32 v[114:115], v[114:115], v[232:233] op_sel_hi:[1,0]
 v_pk_mul_f32 v[116:117], v[116:117], v[232:233] op_sel_hi:[1,0]
 v_pk_mul_f32 v[118:119], v[118:119], v[232:233] op_sel_hi:[1,0]
 v_pk_mul_f32 v[120:121], v[120:121], v[232:233] op_sel_hi:[1,0]
 v_pk_mul_f32 v[122:123], v[122:123], v[232:233] op_sel_hi:[1,0]
 v_pk_mul_f32 v[124:125], v[124:125], v[232:233] op_sel_hi:[1,0]
 v_pk_mul_f32 v[126:127], v[126:127], v[232:233] op_sel_hi:[1,0]
 v_cvt_pk_bf16_f32 v112, v112, v113
 v_cvt_pk_bf16_f32 v113, v114, v115
 v_cvt_pk_bf16_f32 v114, v116, v117
 v_cvt_pk_bf16_f32 v115, v118, v119
 buffer_store_dwordx4 v[112:115], v25, s[4:7], s57 offen offset:3072 sc1
 v_cvt_pk_bf16_f32 v120, v120, v121
 v_cvt_pk_bf16_f32 v121, v122, v123
 v_cvt_pk_bf16_f32 v122, v124, v125
 v_cvt_pk_bf16_f32 v123, v126, v127
 buffer_store_dwordx4 v[120:123], v25, s[4:7], s57 offen offset:3584 sc1
L_single:
 s_waitcnt lgkmcnt(5)
 v_mfma_f32_32x32x16_bf16 v[96:111], a[128:131], v[64:67], v[208:223]
 ds_read_b128 a[152:155], v23 offset:6144
 ds_read_b128 a[156:159], v23 offset:7168
 ds_read_b128 a[160:163], v23 offset:8192
 v_exp_f32 v224, v128
 s_waitcnt lgkmcnt(7)
 v_mfma_f32_32x32x16_bf16 v[96:111], a[132:135], v[80:83], v[96:111]
 s_add_u32 m0, s91, 0x14000
 ds_read_b128 a[164:167], v23 offset:9216
 ds_read_b128 a[168:171], v23 offset:10240
 ds_read_b128 a[172:175], v23 offset:11264
 s_waitcnt lgkmcnt(9)
 v_mfma_f32_32x32x16_bf16 v[96:111], a[136:139], v[68:71], v[96:111]
 ds_read_b128 a[176:179], v23 offset:12288
 ds_read_b128 a[180:183], v23 offset:13312
 s_add_u32 s56, s90, 32768
 v_exp_f32 v225, v129
 s_waitcnt lgkmcnt(10)
 v_mfma_f32_32x32x16_bf16 v[96:111], a[140:143], v[84:87], v[96:111]
 ds_read_b128 a[184:187], v23 offset:14336
 v_exp_f32 v226, v130
 v_exp_f32 v227, v131
 s_waitcnt lgkmcnt(10)
 v_mfma_f32_32x32x16_bf16 v[96:111], a[144:147], v[72:75], v[96:111]
 ds_read_b128 a[188:191], v23 offset:15360
 buffer_load_dwordx4 v14, s[32:35], s56 offen offset:0 sc1 lds
 v_add_f32 v231, v229, v224
 v_cvt_pk_bf16_f32 v176, v224, v225
 s_waitcnt lgkmcnt(10)
 v_mfma_f32_32x32x16_bf16 v[96:111], a[148:151], v[88:91], v[96:111]
 ds_read_b128 a[128:131], v24 offset:16384
 v_add_f32 v231, v231, v225
 v_exp_f32 v224, v132
 s_waitcnt lgkmcnt(8)
 v_mfma_f32_32x32x16_bf16 v[96:111], a[152:155], v[76:79], v[96:111]
 ds_read_b128 a[132:135], v24 offset:17408
 buffer_load_dwordx4 v14, s[32:35], s56 offen offset:1024 sc1 lds
 v_exp_f32 v225, v133
 v_add_f32 v231, v231, v226
 v_mfma_f32_32x32x16_bf16 v[96:111], a[156:159], v[92:95], v[96:111]
 ds_read_b128 a[136:139], v24 offset:18432
 v_cvt_pk_bf16_f32 v177, v226, v227
 v_add_f32 v231, v231, v227
 v_exp_f32 v226, v134
 v_mfma_f32_32x32x16_bf16 v[112:127], a[160:163], v[64:67], v[208:223]
 ds_read_b128 a[140:143], v24 offset:19456
 buffer_load_dwordx4 v14, s[32:35], s56 offen offset:2048 sc1 lds
 v_exp_f32 v227, v135
 s_waitcnt lgkmcnt(5)
 v_mfma_f32_32x32x16_bf16 v[112:127], a[164:167], v[80:83], v[112:127]
 ds_read_b128 a[144:147], v24 offset:20480
 v_add_f32 v231, v231, v224
 v_cvt_pk_bf16_f32 v178, v224, v225
 v_add_f32 v231, v231, v225
 v_exp_f32 v224, v136
 v_mfma_f32_32x32x16_bf16 v[112:127], a[168:171], v[68:71], v[112:127]
 ds_read_b128 a[148:151], v24 offset:21504
 buffer_load_dwordx4 v14, s[32:35], s56 offen offset:3072 sc1 lds
 v_exp_f32 v225, v137
 v_add_f32 v231, v231, v226
 v_mfma_f32_32x32x16_bf16 v[112:127], a[172:175], v[84:87], v[112:127]
 ds_read_b128 a[152:155], v24 offset:22528
 v_cvt_pk_bf16_f32 v179, v226, v227
 v_add_f32 v231, v231, v227
 v_exp_f32 v226, v138
 v_mfma_f32_32x32x16_bf16 v[112:127], a[176:179], v[72:75], v[112:127]
 ds_read_b128 a[156:159], v24 offset:23552
 s_xor_b32 m0, s91, 0x4000
 v_exp_f32 v227, v139
 v_add_f32 v231, v231, v224
 v_cvt_pk_bf16_f32 v180, v224, v225
 v_mfma_f32_32x32x16_bf16 v[112:127], a[180:183], v[88:91], v[112:127]
 ds_read_b128 a[160:163], v24 offset:24576
 v_add_f32 v231, v231, v225
 v_exp_f32 v224, v140
 v_exp_f32 v225, v141
 v_mfma_f32_32x32x16_bf16 v[112:127], a[184:187], v[76:79], v[112:127]
 ds_read_b128 a[164:167], v24 offset:25600
 s_add_u32 s56, s90, 4294918144
 v_add_f32 v231, v231, v226
 v_cvt_pk_bf16_f32 v181, v226, v227
 v_add_f32 v231, v231, v227
 s_waitcnt lgkmcnt(5)
 v_mfma_f32_32x32x16_bf16 v[112:127], a[188:191], v[92:95], v[112:127]
 ds_read_b128 a[168:171], v24 offset:26624
 v_exp_f32 v226, v142
 v_exp_f32 v227, v143
 v_add_f32 v231, v231, v224
 v_mfma_f32_32x32x16_bf16 a[64:79], a[128:131], v[160:163], a[64:79]
 ds_read_b128 a[172:175], v24 offset:27648
 buffer_load_dwordx4 v14, s[32:35], s56 offen offset:0 sc1 lds
 v_cvt_pk_bf16_f32 v182, v224, v225
 v_add_f32 v231, v231, v225
 v_mfma_f32_32x32x16_bf16 a[80:95], a[132:135], v[160:163], a[80:95]
 ds_read_b128 a[176:179], v24 offset:28672
 v_exp_f32 v224, v144
 v_exp_f32 v225, v145
 v_add_f32 v231, v231, v226
 v_mfma_f32_32x32x16_bf16 a[96:111], a[136:139], v[160:163], a[96:111]
 ds_read_b128 a[180:183], v24 offset:29696
 buffer_load_dwordx4 v14, s[32:35], s56 offen offset:1024 sc1 lds
 v_cvt_pk_bf16_f32 v183, v226, v227
 v_add_f32 v231, v231, v227
 v_mfma_f32_32x32x16_bf16 a[112:127], a[140:143], v[160:163], a[112:127]
 ds_read_b128 a[184:187], v24 offset:30720
 v_exp_f32 v226, v146
 v_exp_f32 v227, v147
 v_add_f32 v231, v231, v224
 v_mfma_f32_32x32x16_bf16 a[64:79], a[144:147], v[164:167], a[64:79]
 ds_read_b128 a[188:191], v24 offset:31744
 buffer_load_dwordx4 v14, s[32:35], s56 offen offset:2048 sc1 lds
 v_cvt_pk_bf16_f32 v184, v224, v225
 v_add_f32 v231, v231, v225
 s_waitcnt lgkmcnt(5)
 v_mfma_f32_32x32x16_bf16 a[80:95], a[148:151], v[164:167], a[80:95]
 ds_read_b128 a[128:131], v23 offset:16384
 v_exp_f32 v224, v148
 v_exp_f32 v225, v149
 v_add_f32 v231, v231, v226
 v_mfma_f32_32x32x16_bf16 a[96:111], a[152:155], v[164:167], a[96:111]
 ds_read_b128 a[132:135], v23 offset:17408
 buffer_load_dwordx4 v14, s[32:35], s56 offen offset:3072 sc1 lds
 v_cvt_pk_bf16_f32 v185, v226, v227
 v_add_f32 v231, v231, v227
 v_mfma_f32_32x32x16_bf16 a[112:127], a[156:159], v[164:167], a[112:127]
 ds_read_b128 a[136:139], v23 offset:18432
 v_exp_f32 v226, v150
 v_exp_f32 v227, v151
 v_add_f32 v231, v231, v224
 v_mfma_f32_32x32x16_bf16 a[64:79], a[160:163], v[168:171], a[64:79]
 ds_read_b128 a[140:143], v23 offset:19456
 s_mov_b32 m0, s91
 v_cvt_pk_bf16_f32 v186, v224, v225
 v_add_f32 v231, v231, v225
 v_exp_f32 v224, v152
 v_mfma_f32_32x32x16_bf16 a[80:95], a[164:167], v[168:171], a[80:95]
 ds_read_b128 a[144:147], v23 offset:20480
 v_exp_f32 v225, v153
 v_add_f32 v231, v231, v226
 v_cvt_pk_bf16_f32 v187, v226, v227
 v_add_f32 v231, v231, v227
 v_mfma_f32_32x32x16_bf16 a[96:111], a[168:171], v[168:171], a[96:111]
 ds_read_b128 a[148:151], v23 offset:21504
 s_add_u32 s56, s90, 4294950912
 v_exp_f32 v226, v154
 s_waitcnt lgkmcnt(5)
 v_mfma_f32_32x32x16_bf16 a[112:127], a[172:175], v[168:171], a[112:127]
 ds_read_b128 a[152:155], v23 offset:22528
 v_exp_f32 v227, v155
 v_add_f32 v231, v231, v224
 v_cvt_pk_bf16_f32 v188, v224, v225
 v_add_f32 v231, v231, v225
 v_mfma_f32_32x32x16_bf16 a[64:79], a[176:179], v[172:175], a[64:79]
 ds_read_b128 a[156:159], v23 offset:23552
 buffer_load_dwordx4 v14, s[32:35], s56 offen offset:0 sc1 lds
 v_exp_f32 v224, v156
 v_mfma_f32_32x32x16_bf16 a[80:95], a[180:183], v[172:175], a[80:95]
 ds_read_b128 a[160:163], v23 offset:24576
 v_exp_f32 v225, v157
 v_add_f32 v231, v231, v226
 v_cvt_pk_bf16_f32 v189, v226, v227
 v_add_f32 v231, v231, v227
 v_mfma_f32_32x32x16_bf16 a[96:111], a[184:187], v[172:175], a[96:111]
 ds_read_b128 a[164:167], v23 offset:25600
 buffer_load_dwordx4 v14, s[32:35], s56 offen offset:1024 sc1 lds
 v_exp_f32 v226, v158
 v_mfma_f32_32x32x16_bf16 a[112:127], a[188:191], v[172:175], a[112:127]
 v_exp_f32 v227, v159
 v_add_f32 v231, v231, v224
 v_cvt_pk_bf16_f32 v190, v224, v225
 v_add_f32 v231, v231, v225
 v_add_f32 v231, v231, v226
 v_cvt_pk_bf16_f32 v191, v226, v227
 v_add_f32 v231, v231, v227
 v_mfma_f32_32x32x16_bf16 v[128:143], a[128:131], v[64:67], v[208:223]
 ds_read_b128 a[168:171], v23 offset:26624
 ds_read_b128 a[172:175], v23 offset:27648
 buffer_load_dwordx4 v14, s[32:35], s56 offen offset:2048 sc1 lds
 s_waitcnt lgkmcnt(5)
 v_mfma_f32_32x32x16_bf16 v[128:143], a[132:135], v[80:83], v[128:143]
 ds_read_b128 a[176:179], v23 offset:28672
 v_exp_f32 v224, v96
 v_exp_f32 v225, v97
 v_mfma_f32_32x32x16_bf16 v[128:143], a[136:139], v[68:71], v[128:143]
 ds_read_b128 a[180:183], v23 offset:29696
 buffer_load_dwordx4 v14, s[32:35], s56 offen offset:3072 sc1 lds
 v_exp_f32 v226, v98
 v_mfma_f32_32x32x16_bf16 v[128:143], a[140:143], v[84:87], v[128:143]
 ds_read_b128 a[184:187], v23 offset:30720
 v_exp_f32 v227, v99
 v_add_f32 v229, v231, v224
 v_cvt_pk_bf16_f32 v160, v224, v225
 v_add_f32 v229, v229, v225
 v_mfma_f32_32x32x16_bf16 v[128:143], a[144:147], v[72:75], v[128:143]
 ds_read_b128 a[188:191], v23 offset:31744
 v_exp_f32 v224, v100
 v_exp_f32 v225, v101
 v_add_f32 v229, v229, v226
 v_mfma_f32_32x32x16_bf16 v[128:143], a[148:151], v[88:91], v[128:143]
 ds_read_b128 a[128:131], v24 offset:0
 v_cvt_pk_bf16_f32 v161, v226, v227
 v_add_f32 v229, v229, v227
 v_exp_f32 v226, v102
 v_mfma_f32_32x32x16_bf16 v[128:143], a[152:155], v[76:79], v[128:143]
 ds_read_b128 a[132:135], v24 offset:1024
 v_exp_f32 v227, v103
 v_add_f32 v229, v229, v224
 v_cvt_pk_bf16_f32 v162, v224, v225
 s_waitcnt lgkmcnt(5)
 v_mfma_f32_32x32x16_bf16 v[128:143], a[156:159], v[92:95], v[128:143]
 ds_read_b128 a[136:139], v24 offset:2048
 v_add_f32 v229, v229, v225
 v_exp_f32 v224, v104
 v_exp_f32 v225, v105
 v_mfma_f32_32x32x16_bf16 v[144:159], a[160:163], v[64:67], v[208:223]
 ds_read_b128 a[140:143], v24 offset:3072
 v_add_f32 v229, v229, v226
 v_cvt_pk_bf16_f32 v163, v226, v227
 v_add_f32 v229, v229, v227
 v_exp_f32 v226, v106
 v_mfma_f32_32x32x16_bf16 v[144:159], a[164:167], v[80:83], v[144:159]
 ds_read_b128 a[144:147], v24 offset:4096
 v_exp_f32 v227, v107
 v_add_f32 v229, v229, v224
 v_cvt_pk_bf16_f32 v164, v224, v225
 v_add_f32 v229, v229, v225
 v_mfma_f32_32x32x16_bf16 v[144:159], a[168:171], v[68:71], v[144:159]
 ds_read_b128 a[148:151], v24 offset:5120
 v_exp_f32 v224, v108
 v_exp_f32 v225, v109
 v_add_f32 v229, v229, v226
 v_mfma_f32_32x32x16_bf16 v[144:159], a[172:175], v[84:87], v[144:159]
 ds_read_b128 a[152:155], v24 offset:6144
 v_cvt_pk_bf16_f32 v165, v226, v227
 v_add_f32 v229, v229, v227
 v_exp_f32 v226, v110
 v_mfma_f32_32x32x16_bf16 v[144:159], a[176:179], v[72:75], v[144:159]
 ds_read_b128 a[156:159], v24 offset:7168
 v_exp_f32 v227, v111
 v_add_f32 v229, v229, v224
 v_cvt_pk_bf16_f32 v166, v224, v225
 s_waitcnt lgkmcnt(5)
 v_mfma_f32_32x32x16_bf16 v[144:159], a[180:183], v[88:91], v[144:159]
 ds_read_b128 a[160:163], v24 offset:8192
 v_add_f32 v229, v229, v225
 v_exp_f32 v224, v112
 v_exp_f32 v225, v113
 v_mfma_f32_32x32x16_bf16 v[144:159], a[184:187], v[76:79], v[144:159]
 ds_read_b128 a[164:167], v24 offset:9216
 v_add_f32 v229, v229, v226
 v_cvt_pk_bf16_f32 v167, v226, v227
 v_add_f32 v229, v229, v227
 v_exp_f32 v226, v114
 v_mfma_f32_32x32x16_bf16 v[144:159], a[188:191], v[92:95], v[144:159]
 ds_read_b128 a[168:171], v24 offset:10240
 v_exp_f32 v227, v115
 v_add_f32 v229, v229, v224
 v_cvt_pk_bf16_f32 v168, v224, v225
 v_add_f32 v229, v229, v225
 v_mfma_f32_32x32x16_bf16 a[64:79], a[128:131], v[176:179], a[64:79]
 ds_read_b128 a[172:175], v24 offset:11264
 v_exp_f32 v224, v116
 v_exp_f32 v225, v117
 v_add_f32 v229, v229, v226
 v_mfma_f32_32x32x16_bf16 a[80:95], a[132:135], v[176:179], a[80:95]
 ds_read_b128 a[176:179], v24 offset:12288
 v_cvt_pk_bf16_f32 v169, v226, v227
 v_add_f32 v229, v229, v227
 v_exp_f32 v226, v118
 v_mfma_f32_32x32x16_bf16 a[96:111], a[136:139], v[176:179], a[96:111]
 ds_read_b128 a[180:183], v24 offset:13312
 ds_read_b128 a[184:187], v24 offset:14336
 ds_read_b128 a[188:191], v24 offset:15360
 v_exp_f32 v227, v119
 s_waitcnt lgkmcnt(7)
 v_mfma_f32_32x32x16_bf16 a[112:127], a[140:143], v[176:179], a[112:127]
 v_add_f32 v229, v229, v224
 v_cvt_pk_bf16_f32 v170, v224, v225
 v_add_f32 v229, v229, v225
 v_exp_f32 v224, v120
 v_mfma_f32_32x32x16_bf16 a[64:79], a[144:147], v[180:183], a[64:79]
 v_xor_b32 v24, 0x18000, v23
 v_xor_b32 v23, 0x8000, v23
 v_exp_f32 v225, v121
 v_add_f32 v229, v229, v226
 v_cvt_pk_bf16_f32 v171, v226, v227
 v_mfma_f32_32x32x16_bf16 a[80:95], a[148:151], v[180:183], a[80:95]
 v_add_f32 v229, v229, v227
 v_exp_f32 v226, v122
 v_exp_f32 v227, v123
 v_add_f32 v229, v229, v224
 v_mfma_f32_32x32x16_bf16 a[96:111], a[152:155], v[180:183], a[96:111]
 s_waitcnt vmcnt(0) lgkmcnt(0)
 s_barrier
 ds_read_b128 a[128:131], v23 offset:0
 s_xor_b32 s91, s91, 0x8000
 ds_read_b128 a[132:135], v23 offset:1024
 v_cvt_pk_bf16_f32 v172, v224, v225
 v_mfma_f32_32x32x16_bf16 a[112:127], a[156:159], v[180:183], a[112:127]
 ds_read_b128 a[136:139], v23 offset:2048
 s_add_u32 s90, s90, 65536
 v_add_f32 v229, v229, v225
 v_exp_f32 v224, v124
 v_mfma_f32_32x32x16_bf16 a[64:79], a[160:163], v[184:187], a[64:79]
 ds_read_b128 a[140:143], v23 offset:3072
 s_add_u32 s18, s18, 2
 v_exp_f32 v225, v125
 v_add_f32 v229, v229, v226
 v_cvt_pk_bf16_f32 v173, v226, v227
 v_mfma_f32_32x32x16_bf16 a[80:95], a[164:167], v[184:187], a[80:95]
 ds_read_b128 a[144:147], v23 offset:4096
 s_or_b32 m0, s91, 0x10000
 v_add_f32 v229, v229, v227
 v_exp_f32 v226, v126
 v_mfma_f32_32x32x16_bf16 a[96:111], a[168:171], v[184:187], a[96:111]
 ds_read_b128 a[148:151], v23 offset:5120
 v_exp_f32 v227, v127
 v_add_f32 v229, v229, v224
 v_cvt_pk_bf16_f32 v174, v224, v225
 v_add_f32 v229, v229, v225
 v_mfma_f32_32x32x16_bf16 a[112:127], a[172:175], v[184:187], a[112:127]
 buffer_load_dwordx4 v14, s[32:35], s90 offen offset:0 sc1 lds
 v_add_f32 v229, v229, v226
 v_cvt_pk_bf16_f32 v175, v226, v227
 v_add_f32 v229, v229, v227
 v_mfma_f32_32x32x16_bf16 a[64:79], a[176:179], v[188:191], a[64:79]
 buffer_load_dwordx4 v14, s[32:35], s90 offen offset:1024 sc1 lds
 v_mfma_f32_32x32x16_bf16 a[80:95], a[180:183], v[188:191], a[80:95]
 buffer_load_dwordx4 v14, s[32:35], s90 offen offset:2048 sc1 lds
 v_mfma_f32_32x32x16_bf16 a[96:111], a[184:187], v[188:191], a[96:111]
 buffer_load_dwordx4 v14, s[32:35], s90 offen offset:3072 sc1 lds
 v_mfma_f32_32x32x16_bf16 a[112:127], a[188:191], v[188:191], a[112:127]
 s_cmp_lt_u32 s18, s95
 s_cbranch_scc1 L_single
 s_waitcnt lgkmcnt(5)
 v_mfma_f32_32x32x16_bf16 v[96:111], a[128:131], v[64:67], v[208:223]
 buffer_load_dword v15, v12, s[4:7], 0 offen sc1
 ds_read_b128 a[152:155], v23 offset:6144
 ds_read_b128 a[156:159], v23 offset:7168
 ds_read_b128 a[160:163], v23 offset:8192
 s_waitcnt lgkmcnt(7)
 v_mfma_f32_32x32x16_bf16 v[96:111], a[132:135], v[80:83], v[96:111]
 s_xor_b32 m0, s91, 0x4000
 ds_read_b128 a[164:167], v23 offset:9216
 ds_read_b128 a[168:171], v23 offset:10240
 ds_read_b128 a[172:175], v23 offset:11264
 s_waitcnt lgkmcnt(9)
 v_mfma_f32_32x32x16_bf16 v[96:111], a[136:139], v[68:71], v[96:111]
 ds_read_b128 a[176:179], v23 offset:12288
 s_add_u32 s56, s90, 4294918144
 ds_read_b128 a[180:183], v23 offset:13312
 v_exp_f32 v224, v128
 s_waitcnt lgkmcnt(10)
 v_mfma_f32_32x32x16_bf16 v[96:111], a[140:143], v[84:87], v[96:111]
 ds_read_b128 a[184:187], v23 offset:14336
 buffer_load_dwordx4 v14, s[32:35], s56 offen offset:0 sc1 lds
 v_exp_f32 v225, v129
 s_waitcnt lgkmcnt(10)
 v_mfma_f32_32x32x16_bf16 v[96:111], a[144:147], v[72:75], v[96:111]
 ds_read_b128 a[188:191], v23 offset:15360
 v_exp_f32 v226, v130
 v_exp_f32 v227, v131
 s_waitcnt lgkmcnt(10)
 v_mfma_f32_32x32x16_bf16 v[96:111], a[148:151], v[88:91], v[96:111]
 ds_read_b128 a[128:131], v24 offset:16384
 buffer_load_dwordx4 v14, s[32:35], s56 offen offset:1024 sc1 lds
 v_add_f32 v231, v229, v224
 v_cvt_pk_bf16_f32 v176, v224, v225
 s_waitcnt lgkmcnt(8)
 v_mfma_f32_32x32x16_bf16 v[96:111], a[152:155], v[76:79], v[96:111]
 ds_read_b128 a[132:135], v24 offset:17408
 buffer_load_dwordx4 v14, s[32:35], s56 offen offset:2048 sc1 lds
 v_add_f32 v231, v231, v225
 v_exp_f32 v224, v132
 v_mfma_f32_32x32x16_bf16 v[96:111], a[156:159], v[92:95], v[96:111]
 ds_read_b128 a[136:139], v24 offset:18432
 v_exp_f32 v225, v133
 v_add_f32 v231, v231, v226
 v_cvt_pk_bf16_f32 v177, v226, v227
 v_add_f32 v231, v231, v227
 v_mfma_f32_32x32x16_bf16 v[112:127], a[160:163], v[64:67], v[208:223]
 ds_read_b128 a[140:143], v24 offset:19456
 buffer_load_dwordx4 v14, s[32:35], s56 offen offset:3072 sc1 lds
 v_exp_f32 v226, v134
 s_waitcnt lgkmcnt(5)
 v_mfma_f32_32x32x16_bf16 v[112:127], a[164:167], v[80:83], v[112:127]
 ds_read_b128 a[144:147], v24 offset:20480
 s_mov_b32 m0, s91
 v_exp_f32 v227, v135
 v_add_f32 v231, v231, v224
 v_cvt_pk_bf16_f32 v178, v224, v225
 v_mfma_f32_32x32x16_bf16 v[112:127], a[168:171], v[68:71], v[112:127]
 ds_read_b128 a[148:151], v24 offset:21504
 s_add_u32 s56, s90, 4294950912
 v_add_f32 v231, v231, v225
 v_exp_f32 v224, v136
 v_mfma_f32_32x32x16_bf16 v[112:127], a[172:175], v[84:87], v[112:127]
 ds_read_b128 a[152:155], v24 offset:22528
 v_exp_f32 v225, v137
 v_add_f32 v231, v231, v226
 v_cvt_pk_bf16_f32 v179, v226, v227
 v_add_f32 v231, v231, v227
 v_mfma_f32_32x32x16_bf16 v[112:127], a[176:179], v[72:75], v[112:127]
 ds_read_b128 a[156:159], v24 offset:23552
 buffer_load_dwordx4 v14, s[32:35], s56 offen offset:0 sc1 lds
 v_exp_f32 v226, v138
 v_mfma_f32_32x32x16_bf16 v[112:127], a[180:183], v[88:91], v[112:127]
 ds_read_b128 a[160:163], v24 offset:24576
 buffer_load_dwordx4 v14, s[32:35], s56 offen offset:1024 sc1 lds
 v_exp_f32 v227, v139
 v_add_f32 v231, v231, v224
 v_mfma_f32_32x32x16_bf16 v[112:127], a[184:187], v[76:79], v[112:127]
 ds_read_b128 a[164:167], v24 offset:25600
 v_cvt_pk_bf16_f32 v180, v224, v225
 v_add_f32 v231, v231, v225
 v_exp_f32 v224, v140
 s_waitcnt lgkmcnt(5)
 v_mfma_f32_32x32x16_bf16 v[112:127], a[188:191], v[92:95], v[112:127]
 ds_read_b128 a[168:171], v24 offset:26624
 buffer_load_dwordx4 v14, s[32:35], s56 offen offset:2048 sc1 lds
 v_exp_f32 v225, v141
 v_add_f32 v231, v231, v226
 v_mfma_f32_32x32x16_bf16 a[64:79], a[128:131], v[160:163], a[64:79]
 ds_read_b128 a[172:175], v24 offset:27648
 buffer_load_dwordx4 v14, s[32:35], s56 offen offset:3072 sc1 lds
 v_cvt_pk_bf16_f32 v181, v226, v227
 v_add_f32 v231, v231, v227
 v_mfma_f32_32x32x16_bf16 a[80:95], a[132:135], v[160:163], a[80:95]
 ds_read_b128 a[176:179], v24 offset:28672
 v_exp_f32 v226, v142
 v_exp_f32 v227, v143
 v_add_f32 v231, v231, v224
 v_mfma_f32_32x32x16_bf16 a[96:111], a[136:139], v[160:163], a[96:111]
 ds_read_b128 a[180:183], v24 offset:29696
 v_cvt_pk_bf16_f32 v182, v224, v225
 v_add_f32 v231, v231, v225
 v_exp_f32 v224, v144
 v_mfma_f32_32x32x16_bf16 a[112:127], a[140:143], v[160:163], a[112:127]
 ds_read_b128 a[184:187], v24 offset:30720
 v_exp_f32 v225, v145
 v_add_f32 v231, v231, v226
 v_cvt_pk_bf16_f32 v183, v226, v227
 v_add_f32 v231, v231, v227
 v_mfma_f32_32x32x16_bf16 a[64:79], a[144:147], v[164:167], a[64:79]
 ds_read_b128 a[188:191], v24 offset:31744
 v_exp_f32 v226, v146
 v_exp_f32 v227, v147
 s_waitcnt lgkmcnt(5)
 v_mfma_f32_32x32x16_bf16 a[80:95], a[148:151], v[164:167], a[80:95]
 ds_read_b128 a[128:131], v23 offset:16384
 v_add_f32 v231, v231, v224
 v_cvt_pk_bf16_f32 v184, v224, v225
 v_add_f32 v231, v231, v225
 v_exp_f32 v224, v148
 v_mfma_f32_32x32x16_bf16 a[96:111], a[152:155], v[164:167], a[96:111]
 ds_read_b128 a[132:135], v23 offset:17408
 v_exp_f32 v225, v149
 v_add_f32 v231, v231, v226
 v_cvt_pk_bf16_f32 v185, v226, v227
 v_add_f32 v231, v231, v227
 v_mfma_f32_32x32x16_bf16 a[112:127], a[156:159], v[164:167], a[112:127]
 ds_read_b128 a[136:139], v23 offset:18432
 v_exp_f32 v226, v150
 v_exp_f32 v227, v151
 v_add_f32 v231, v231, v224
 v_mfma_f32_32x32x16_bf16 a[64:79], a[160:163], v[168:171], a[64:79]
 ds_read_b128 a[140:143], v23 offset:19456
 s_waitcnt vmcnt(8)
 v_cmp_ne_u32 vcc, s98, v15
 s_cbranch_vccnz P_parall_16
PB_parall_17:
 s_barrier
 v_mfma_f32_32x32x16_bf16 a[80:95], a[164:167], v[168:171], a[80:95]
 ds_read_b128 a[144:147], v23 offset:20480
 s_add_u32 m0, s74, 143360
 s_add_u32 s56, s69, 0
 v_cvt_pk_bf16_f32 v186, v224, v225
 v_add_f32 v231, v231, v225
 v_mfma_f32_32x32x16_bf16 a[96:111], a[168:171], v[168:171], a[96:111]
 ds_read_b128 a[148:151], v23 offset:21504
 buffer_load_dwordx4 v14, s[4:7], s56 offen offset:0 sc1 lds
 v_exp_f32 v224, v152
 s_waitcnt lgkmcnt(4)
 v_mfma_f32_32x32x16_bf16 a[112:127], a[172:175], v[168:171], a[112:127]
 ds_read_b128 a[152:155], v23 offset:22528
 buffer_load_dwordx4 v14, s[4:7], s56 offen offset:1024 sc1 lds
 v_exp_f32 v225, v153
 s_lshl_b32 s19, s18, 1
 v_mfma_f32_32x32x16_bf16 a[64:79], a[176:179], v[172:175], a[64:79]
 ds_read_b128 a[156:159], v23 offset:23552
 buffer_load_dwordx4 v14, s[4:7], s56 offen offset:2048 sc1 lds
 s_add_u32 s19, s19, 0
 v_add_f32 v231, v231, v226
 v_mfma_f32_32x32x16_bf16 a[80:95], a[180:183], v[172:175], a[80:95]
 ds_read_b128 a[160:163], v23 offset:24576
 buffer_load_dwordx4 v14, s[4:7], s56 offen offset:3072 sc1 lds
 s_cmp_eq_u32 s19, s94
 s_cselect_b32 s12, s15, 0
 v_cvt_pk_bf16_f32 v187, v226, v227
 v_mfma_f32_32x32x16_bf16 a[96:111], a[184:187], v[172:175], a[96:111]
 ds_read_b128 a[164:167], v23 offset:25600
 s_add_u32 m0, s74, 147456
 v_add_f32 v231, v231, v227
 s_cmp_gt_u32 s19, s94
 s_cselect_b32 s13, s15, 0
 v_mfma_f32_32x32x16_bf16 a[112:127], a[188:191], v[172:175], a[112:127]
 v_exp_f32 v226, v154
 v_fma_f32 v96, v240, s12, v96
 v_fma_f32 v97, v241, s12, v97
 v_exp_f32 v227, v155
 v_fma_f32 v98, v242, s12, v98
 v_fma_f32 v99, v243, s12, v99
 v_fma_f32 v100, v244, s12, v100
 v_add_f32 v231, v231, v224
 v_fma_f32 v101, v245, s12, v101
 v_cvt_pk_bf16_f32 v188, v224, v225
 v_fma_f32 v102, v246, s12, v102
 v_add_f32 v231, v231, v225
 v_fma_f32 v103, v247, s12, v103
 v_exp_f32 v224, v156
 v_fma_f32 v104, v248, s12, v104
 v_fma_f32 v105, v249, s12, v105
 v_fma_f32 v106, v250, s12, v106
 v_exp_f32 v225, v157
 v_fma_f32 v107, v251, s12, v107
 v_fma_f32 v108, v252, s12, v108
 v_add_f32 v231, v231, v226
 v_fma_f32 v109, v253, s12, v109
 v_fma_f32 v110, v254, s12, v110
 v_cvt_pk_bf16_f32 v189, v226, v227
 v_fma_f32 v111, v255, s12, v111
 v_add_f32 v231, v231, v227
 v_add_f32 v96, s13, v96
 v_exp_f32 v226, v158
 v_add_f32 v97, s13, v97
 v_add_f32 v98, s13, v98
 v_add_f32 v99, s13, v99
 v_exp_f32 v227, v159
 v_add_f32 v100, s13, v100
 v_add_f32 v101, s13, v101
 v_add_f32 v231, v231, v224
 v_add_f32 v102, s13, v102
 v_cvt_pk_bf16_f32 v190, v224, v225
 v_add_f32 v103, s13, v103
 v_add_f32 v104, s13, v104
 v_add_f32 v231, v231, v225
 v_add_f32 v105, s13, v105
 v_add_f32 v231, v231, v226
 v_add_f32 v106, s13, v106
 v_cvt_pk_bf16_f32 v191, v226, v227
 v_add_f32 v107, s13, v107
 v_add_f32 v231, v231, v227
 v_add_f32 v108, s13, v108
 v_add_f32 v109, s13, v109
 v_add_f32 v110, s13, v110
 v_add_f32 v111, s13, v111
 s_lshl_b32 s19, s18, 1
 s_add_u32 s19, s19, 1
 s_cmp_eq_u32 s19, s94
 s_cselect_b32 s12, s15, 0
 s_cmp_gt_u32 s19, s94
 s_cselect_b32 s13, s15, 0
 v_fma_f32 v112, v240, s12, v112
 v_fma_f32 v113, v241, s12, v113
 v_fma_f32 v114, v242, s12, v114
 v_fma_f32 v115, v243, s12, v115
 v_fma_f32 v116, v244, s12, v116
 v_fma_f32 v117, v245, s12, v117
 v_fma_f32 v118, v246, s12, v118
 v_fma_f32 v119, v247, s12, v119
 v_fma_f32 v120, v248, s12, v120
 v_fma_f32 v121, v249, s12, v121
 v_fma_f32 v122, v250, s12, v122
 v_fma_f32 v123, v251, s12, v123
 v_fma_f32 v124, v252, s12, v124
 v_fma_f32 v125, v253, s12, v125
 v_fma_f32 v126, v254, s12, v126
 v_fma_f32 v127, v255, s12, v127
 v_add_f32 v112, s13, v112
 v_add_f32 v113, s13, v113
 v_add_f32 v114, s13, v114
 v_add_f32 v115, s13, v115
 v_add_f32 v116, s13, v116
 v_add_f32 v117, s13, v117
 v_add_f32 v118, s13, v118
 v_add_f32 v119, s13, v119
 v_add_f32 v120, s13, v120
 v_add_f32 v121, s13, v121
 v_add_f32 v122, s13, v122
 v_add_f32 v123, s13, v123
 v_add_f32 v124, s13, v124
 v_add_f32 v125, s13, v125
 v_add_f32 v126, s13, v126
 v_add_f32 v127, s13, v127
 v_mfma_f32_32x32x16_bf16 v[128:143], a[128:131], v[64:67], v[208:223]
 ds_read_b128 a[168:171], v23 offset:26624
 s_add_u32 s56, s56, 4096
 ds_read_b128 a[172:175], v23 offset:27648
 buffer_load_dwordx4 v14, s[4:7], s56 offen sc1 lds
 v_mfma_f32_32x32x16_bf16 v[128:143], a[132:135], v[80:83], v[128:143]
 ds_read_b128 a[176:179], v23 offset:28672
 s_add_u32 s59, s71, 0
 buffer_load_dwordx4 a[192:195], v2, s[4:7], s73 offen offset:0 sc1
 s_waitcnt lgkmcnt(3)
 v_mfma_f32_32x32x16_bf16 v[128:143], a[136:139], v[68:71], v[128:143]
 ds_read_b128 a[180:183], v23 offset:29696
 buffer_load_dwordx4 a[196:199], v3, s[4:7], s73 offen offset:0 sc1
 v_exp_f32 v224, v96
 v_mfma_f32_32x32x16_bf16 v[128:143], a[140:143], v[84:87], v[128:143]
 ds_read_b128 a[184:187], v23 offset:30720
 buffer_load_dwordx4 a[200:203], v2, s[4:7], s59 offen offset:1024 sc1
 v_exp_f32 v225, v97
 v_mfma_f32_32x32x16_bf16 v[128:143], a[144:147], v[72:75], v[128:143]
 ds_read_b128 a[188:191], v23 offset:31744
 buffer_load_dwordx4 a[204:207], v3, s[4:7], s59 offen offset:1024 sc1
 v_exp_f32 v226, v98
 v_mfma_f32_32x32x16_bf16 v[128:143], a[148:151], v[88:91], v[128:143]
 ds_read_b128 a[128:131], v24 offset:0
 s_add_u32 s59, s71, 2048
 v_exp_f32 v227, v99
 v_add_f32 v229, v231, v224
 v_cvt_pk_bf16_f32 v160, v224, v225
 v_mfma_f32_32x32x16_bf16 v[128:143], a[152:155], v[76:79], v[128:143]
 ds_read_b128 a[132:135], v24 offset:1024
 buffer_load_dwordx4 a[208:211], v2, s[4:7], s59 offen offset:0 sc1
 v_add_f32 v229, v229, v225
 v_exp_f32 v224, v100
 v_mfma_f32_32x32x16_bf16 v[128:143], a[156:159], v[92:95], v[128:143]
 ds_read_b128 a[136:139], v24 offset:2048
 buffer_load_dwordx4 a[212:215], v3, s[4:7], s59 offen offset:0 sc1
 v_exp_f32 v225, v101
 v_add_f32 v229, v229, v226
 v_mfma_f32_32x32x16_bf16 v[144:159], a[160:163], v[64:67], v[208:223]
 ds_read_b128 a[140:143], v24 offset:3072
 buffer_load_dwordx4 a[216:219], v2, s[4:7], s59 offen offset:1024 sc1
 v_cvt_pk_bf16_f32 v161, v226, v227
 v_add_f32 v229, v229, v227
 v_mfma_f32_32x32x16_bf16 v[144:159], a[164:167], v[80:83], v[144:159]
 ds_read_b128 a[144:147], v24 offset:4096
 buffer_load_dwordx4 a[220:223], v3, s[4:7], s59 offen offset:1024 sc1
 v_exp_f32 v226, v102
 s_waitcnt lgkmcnt(5)
 v_mfma_f32_32x32x16_bf16 v[144:159], a[168:171], v[68:71], v[144:159]
 ds_read_b128 a[148:151], v24 offset:5120
 s_add_u32 s59, s71, 4096
 buffer_load_dwordx4 a[224:227], v2, s[4:7], s59 offen offset:0 sc1
 v_exp_f32 v227, v103
 v_mfma_f32_32x32x16_bf16 v[144:159], a[172:175], v[84:87], v[144:159]
 ds_read_b128 a[152:155], v24 offset:6144
 buffer_load_dwordx4 a[228:231], v3, s[4:7], s59 offen offset:0 sc1
 v_add_f32 v229, v229, v224
 v_cvt_pk_bf16_f32 v162, v224, v225
 v_add_f32 v229, v229, v225
 v_mfma_f32_32x32x16_bf16 v[144:159], a[176:179], v[72:75], v[144:159]
 ds_read_b128 a[156:159], v24 offset:7168
 buffer_load_dwordx4 a[232:235], v2, s[4:7], s59 offen offset:1024 sc1
 v_exp_f32 v224, v104
 v_mfma_f32_32x32x16_bf16 v[144:159], a[180:183], v[88:91], v[144:159]
 ds_read_b128 a[160:163], v24 offset:8192
 buffer_load_dwordx4 a[236:239], v3, s[4:7], s59 offen offset:1024 sc1
 v_exp_f32 v225, v105
 v_add_f32 v229, v229, v226
 v_mfma_f32_32x32x16_bf16 v[144:159], a[184:187], v[76:79], v[144:159]
 ds_read_b128 a[164:167], v24 offset:9216
 s_add_u32 s59, s71, 6144
 v_cvt_pk_bf16_f32 v163, v226, v227
 v_add_f32 v229, v229, v227
 v_exp_f32 v226, v106
 v_mfma_f32_32x32x16_bf16 v[144:159], a[188:191], v[92:95], v[144:159]
 ds_read_b128 a[168:171], v24 offset:10240
 buffer_load_dwordx4 a[240:243], v2, s[4:7], s59 offen offset:0 sc1
 v_exp_f32 v227, v107
 s_waitcnt lgkmcnt(5)
 v_mfma_f32_32x32x16_bf16 a[64:79], a[128:131], v[176:179], a[64:79]
 ds_read_b128 a[172:175], v24 offset:11264
 buffer_load_dwordx4 a[244:247], v3, s[4:7], s59 offen offset:0 sc1
 v_add_f32 v229, v229, v224
 v_cvt_pk_bf16_f32 v164, v224, v225
 v_add_f32 v229, v229, v225
 v_mfma_f32_32x32x16_bf16 a[80:95], a[132:135], v[176:179], a[80:95]
 ds_read_b128 a[176:179], v24 offset:12288
 buffer_load_dwordx4 a[248:251], v2, s[4:7], s59 offen offset:1024 sc1
 v_exp_f32 v224, v108
 v_mfma_f32_32x32x16_bf16 a[96:111], a[136:139], v[176:179], a[96:111]
 ds_read_b128 a[180:183], v24 offset:13312
 buffer_load_dwordx4 a[252:255], v3, s[4:7], s59 offen offset:1024 sc1
 ds_read_b128 a[184:187], v24 offset:14336
 ds_read_b128 a[188:191], v24 offset:15360
 v_mfma_f32_32x32x16_bf16 a[112:127], a[140:143], v[176:179], a[112:127]
 v_exp_f32 v225, v109
 v_add_f32 v229, v229, v226
 v_cvt_pk_bf16_f32 v165, v226, v227
 v_add_f32 v229, v229, v227
 v_mfma_f32_32x32x16_bf16 a[64:79], a[144:147], v[180:183], a[64:79]
 v_xor_b32 v24, 0x18000, v23
 v_xor_b32 v23, 0x8000, v23
 v_exp_f32 v226, v110
 v_exp_f32 v227, v111
 v_mfma_f32_32x32x16_bf16 a[80:95], a[148:151], v[180:183], a[80:95]
 v_add_f32 v229, v229, v224
 v_cvt_pk_bf16_f32 v166, v224, v225
 v_add_f32 v229, v229, v225
 v_exp_f32 v224, v112
 s_waitcnt lgkmcnt(4)
 v_mfma_f32_32x32x16_bf16 a[96:111], a[152:155], v[180:183], a[96:111]
 s_waitcnt vmcnt(21) lgkmcnt(0)
 s_barrier
 ds_read_b128 a[128:131], v23 offset:0
 s_xor_b32 s91, s91, 0x8000
 ds_read_b128 a[132:135], v23 offset:1024
 v_mfma_f32_32x32x16_bf16 a[112:127], a[156:159], v[180:183], a[112:127]
 ds_read_b128 a[136:139], v23 offset:2048
 s_add_u32 s90, s90, 65536
 v_exp_f32 v225, v113
 v_add_f32 v229, v229, v226
 v_cvt_pk_bf16_f32 v167, v226, v227
 v_mfma_f32_32x32x16_bf16 a[64:79], a[160:163], v[184:187], a[64:79]
 ds_read_b128 a[140:143], v23 offset:3072
 s_add_u32 m0, s74, 81920
 s_add_u32 s56, s69, 20480
 v_add_f32 v229, v229, v227
 v_exp_f32 v226, v114
 v_mfma_f32_32x32x16_bf16 a[80:95], a[164:167], v[184:187], a[80:95]
 ds_read_b128 a[144:147], v23 offset:4096
 buffer_load_dwordx4 v14, s[4:7], s56 offen offset:0 sc1 lds
 v_exp_f32 v227, v115
 v_add_f32 v229, v229, v224
 v_mfma_f32_32x32x16_bf16 a[96:111], a[168:171], v[184:187], a[96:111]
 ds_read_b128 a[148:151], v23 offset:5120
 buffer_load_dwordx4 v14, s[4:7], s56 offen offset:1024 sc1 lds
 v_cvt_pk_bf16_f32 v168, v224, v225
 v_add_f32 v229, v229, v225
 v_mfma_f32_32x32x16_bf16 a[112:127], a[172:175], v[184:187], a[112:127]
 buffer_load_dwordx4 v14, s[4:7], s56 offen offset:2048 sc1 lds
 v_exp_f32 v224, v116
 v_exp_f32 v225, v117
 v_mfma_f32_32x32x16_bf16 a[64:79], a[176:179], v[188:191], a[64:79]
 buffer_load_dwordx4 v14, s[4:7], s56 offen offset:3072 sc1 lds
 v_add_f32 v229, v229, v226
 v_cvt_pk_bf16_f32 v169, v226, v227
 v_add_f32 v229, v229, v227
 v_mfma_f32_32x32x16_bf16 a[80:95], a[180:183], v[188:191], a[80:95]
 s_add_u32 m0, s74, 86016
 s_add_u32 s56, s56, 4096
 v_exp_f32 v226, v118
 v_exp_f32 v227, v119
 v_mfma_f32_32x32x16_bf16 a[96:111], a[184:187], v[188:191], a[96:111]
 buffer_load_dwordx4 v14, s[4:7], s56 offen sc1 lds
 v_add_f32 v229, v229, v224
 v_cvt_pk_bf16_f32 v170, v224, v225
 v_add_f32 v229, v229, v225
 v_mfma_f32_32x32x16_bf16 a[112:127], a[188:191], v[188:191], a[112:127]
 v_exp_f32 v224, v120
 v_exp_f32 v225, v121
 s_lshl_b32 s19, s18, 1
 s_add_u32 s19, s19, 2
 v_add_f32 v229, v229, v226
 s_cmp_eq_u32 s19, s94
 s_cselect_b32 s12, s15, 0
 v_cvt_pk_bf16_f32 v171, v226, v227
 v_add_f32 v229, v229, v227
 s_cmp_gt_u32 s19, s94
 s_cselect_b32 s13, s15, 0
 v_exp_f32 v226, v122
 v_fma_f32 v128, v240, s12, v128
 v_fma_f32 v129, v241, s12, v129
 v_exp_f32 v227, v123
 v_fma_f32 v130, v242, s12, v130
 v_fma_f32 v131, v243, s12, v131
 v_fma_f32 v132, v244, s12, v132
 v_add_f32 v229, v229, v224
 v_fma_f32 v133, v245, s12, v133
 v_cvt_pk_bf16_f32 v172, v224, v225
 v_fma_f32 v134, v246, s12, v134
 v_add_f32 v229, v229, v225
 v_fma_f32 v135, v247, s12, v135
 v_exp_f32 v224, v124
 v_fma_f32 v136, v248, s12, v136
 v_fma_f32 v137, v249, s12, v137
 v_fma_f32 v138, v250, s12, v138
 v_exp_f32 v225, v125
 v_fma_f32 v139, v251, s12, v139
 v_fma_f32 v140, v252, s12, v140
 v_add_f32 v229, v229, v226
 v_fma_f32 v141, v253, s12, v141
 v_fma_f32 v142, v254, s12, v142
 v_cvt_pk_bf16_f32 v173, v226, v227
 v_fma_f32 v143, v255, s12, v143
 v_add_f32 v229, v229, v227
 v_add_f32 v128, s13, v128
 v_exp_f32 v226, v126
 v_add_f32 v129, s13, v129
 v_add_f32 v130, s13, v130
 v_add_f32 v131, s13, v131
 v_exp_f32 v227, v127
 v_add_f32 v132, s13, v132
 v_add_f32 v133, s13, v133
 v_add_f32 v229, v229, v224
 v_add_f32 v134, s13, v134
 v_cvt_pk_bf16_f32 v174, v224, v225
 v_add_f32 v135, s13, v135
 v_add_f32 v136, s13, v136
 v_add_f32 v229, v229, v225
 v_add_f32 v137, s13, v137
 v_add_f32 v229, v229, v226
 v_add_f32 v138, s13, v138
 v_cvt_pk_bf16_f32 v175, v226, v227
 v_add_f32 v139, s13, v139
 v_add_f32 v229, v229, v227
 v_add_f32 v140, s13, v140
 v_add_f32 v141, s13, v141
 v_add_f32 v142, s13, v142
 v_add_f32 v143, s13, v143
 s_lshl_b32 s19, s18, 1
 s_add_u32 s19, s19, 3
 s_cmp_eq_u32 s19, s94
 s_cselect_b32 s12, s15, 0
 s_cmp_gt_u32 s19, s94
 s_cselect_b32 s13, s15, 0
 v_fma_f32 v144, v240, s12, v144
 v_fma_f32 v145, v241, s12, v145
 v_fma_f32 v146, v242, s12, v146
 v_fma_f32 v147, v243, s12, v147
 v_fma_f32 v148, v244, s12, v148
 v_fma_f32 v149, v245, s12, v149
 v_fma_f32 v150, v246, s12, v150
 v_fma_f32 v151, v247, s12, v151
 v_fma_f32 v152, v248, s12, v152
 v_fma_f32 v153, v249, s12, v153
 v_fma_f32 v154, v250, s12, v154
 v_fma_f32 v155, v251, s12, v155
 v_fma_f32 v156, v252, s12, v156
 v_fma_f32 v157, v253, s12, v157
 v_fma_f32 v158, v254, s12, v158
 v_fma_f32 v159, v255, s12, v159
 v_add_f32 v144, s13, v144
 v_add_f32 v145, s13, v145
 v_add_f32 v146, s13, v146
 v_add_f32 v147, s13, v147
 v_add_f32 v148, s13, v148
 v_add_f32 v149, s13, v149
 v_add_f32 v150, s13, v150
 v_add_f32 v151, s13, v151
 v_add_f32 v152, s13, v152
 v_add_f32 v153, s13, v153
 v_add_f32 v154, s13, v154
 v_add_f32 v155, s13, v155
 v_add_f32 v156, s13, v156
 v_add_f32 v157, s13, v157
 v_add_f32 v158, s13, v158
 v_add_f32 v159, s13, v159
 s_add_u32 s18, s18, 2
L_drain_f:
 ds_read_b128 a[160:163], v24 offset:16384
 ds_read_b128 a[164:167], v24 offset:17408
 ds_read_b128 a[168:171], v24 offset:18432
 ds_read_b128 a[172:175], v24 offset:19456
 ds_read_b128 a[176:179], v24 offset:20480
 ds_read_b128 a[180:183], v24 offset:21504
 ds_read_b128 a[184:187], v24 offset:22528
 ds_read_b128 a[188:191], v24 offset:23552
 v_exp_f32 v224, v128
 v_exp_f32 v225, v129
 v_exp_f32 v226, v130
 v_exp_f32 v227, v131
 v_add_f32 v231, v229, v224
 v_cvt_pk_bf16_f32 v176, v224, v225
 v_add_f32 v231, v231, v225
 v_exp_f32 v224, v132
 v_exp_f32 v225, v133
 v_add_f32 v231, v231, v226
 v_cvt_pk_bf16_f32 v177, v226, v227
 v_add_f32 v231, v231, v227
 s_waitcnt lgkmcnt(7)
 v_mfma_f32_32x32x16_bf16 a[64:79], a[160:163], v[160:163], a[64:79]
 ds_read_b128 a[128:131], v24 offset:24576
 v_exp_f32 v226, v134
 v_exp_f32 v227, v135
 s_waitcnt lgkmcnt(7)
 v_mfma_f32_32x32x16_bf16 a[80:95], a[164:167], v[160:163], a[80:95]
 ds_read_b128 a[132:135], v24 offset:25600
 v_add_f32 v231, v231, v224
 v_cvt_pk_bf16_f32 v178, v224, v225
 v_add_f32 v231, v231, v225
 s_waitcnt lgkmcnt(7)
 v_mfma_f32_32x32x16_bf16 a[96:111], a[168:171], v[160:163], a[96:111]
 ds_read_b128 a[136:139], v24 offset:26624
 v_exp_f32 v224, v136
 v_exp_f32 v225, v137
 s_waitcnt lgkmcnt(3)
 v_mfma_f32_32x32x16_bf16 a[112:127], a[172:175], v[160:163], a[112:127]
 ds_read_b128 a[140:143], v24 offset:27648
 v_add_f32 v231, v231, v226
 v_cvt_pk_bf16_f32 v179, v226, v227
 v_add_f32 v231, v231, v227
 v_exp_f32 v226, v138
 v_mfma_f32_32x32x16_bf16 a[64:79], a[176:179], v[164:167], a[64:79]
 ds_read_b128 a[144:147], v24 offset:28672
 v_exp_f32 v227, v139
 v_add_f32 v231, v231, v224
 v_cvt_pk_bf16_f32 v180, v224, v225
 v_add_f32 v231, v231, v225
 v_mfma_f32_32x32x16_bf16 a[80:95], a[180:183], v[164:167], a[80:95]
 ds_read_b128 a[148:151], v24 offset:29696
 v_exp_f32 v224, v140
 v_exp_f32 v225, v141
 v_add_f32 v231, v231, v226
 v_mfma_f32_32x32x16_bf16 a[96:111], a[184:187], v[164:167], a[96:111]
 ds_read_b128 a[152:155], v24 offset:30720
 v_cvt_pk_bf16_f32 v181, v226, v227
 v_add_f32 v231, v231, v227
 v_exp_f32 v226, v142
 v_mfma_f32_32x32x16_bf16 a[112:127], a[188:191], v[164:167], a[112:127]
 ds_read_b128 a[156:159], v24 offset:31744
 v_exp_f32 v227, v143
 v_add_f32 v231, v231, v224
 v_cvt_pk_bf16_f32 v182, v224, v225
 s_waitcnt lgkmcnt(5)
 v_mfma_f32_32x32x16_bf16 a[64:79], a[128:131], v[168:171], a[64:79]
 ds_read_b128 a[160:163], v24 offset:0
 v_add_f32 v231, v231, v225
 v_exp_f32 v224, v144
 v_exp_f32 v225, v145
 v_mfma_f32_32x32x16_bf16 a[80:95], a[132:135], v[168:171], a[80:95]
 ds_read_b128 a[164:167], v24 offset:4096
 v_add_f32 v231, v231, v226
 v_cvt_pk_bf16_f32 v183, v226, v227
 v_add_f32 v231, v231, v227
 v_exp_f32 v226, v146
 v_mfma_f32_32x32x16_bf16 a[96:111], a[136:139], v[168:171], a[96:111]
 ds_read_b128 a[168:171], v24 offset:8192
 v_exp_f32 v227, v147
 v_add_f32 v231, v231, v224
 v_cvt_pk_bf16_f32 v184, v224, v225
 s_waitcnt lgkmcnt(5)
 v_mfma_f32_32x32x16_bf16 a[112:127], a[140:143], v[168:171], a[112:127]
 ds_read_b128 a[172:175], v24 offset:12288
 v_add_f32 v231, v231, v225
 v_exp_f32 v224, v148
 v_exp_f32 v225, v149
 v_mfma_f32_32x32x16_bf16 a[64:79], a[144:147], v[172:175], a[64:79]
 ds_read_b128 a[176:179], v24 offset:1024
 v_add_f32 v231, v231, v226
 v_cvt_pk_bf16_f32 v185, v226, v227
 v_add_f32 v231, v231, v227
 v_exp_f32 v226, v150
 v_mfma_f32_32x32x16_bf16 a[80:95], a[148:151], v[172:175], a[80:95]
 ds_read_b128 a[180:183], v24 offset:5120
 v_exp_f32 v227, v151
 v_add_f32 v231, v231, v224
 v_cvt_pk_bf16_f32 v186, v224, v225
 s_waitcnt lgkmcnt(5)
 v_mfma_f32_32x32x16_bf16 a[96:111], a[152:155], v[172:175], a[96:111]
 ds_read_b128 a[184:187], v24 offset:9216
 v_add_f32 v231, v231, v225
 v_exp_f32 v224, v152
 v_exp_f32 v225, v153
 v_mfma_f32_32x32x16_bf16 a[112:127], a[156:159], v[172:175], a[112:127]
 v_add_f32 v231, v231, v226
 v_cvt_pk_bf16_f32 v187, v226, v227
 v_add_f32 v231, v231, v227
 v_exp_f32 v226, v154
 v_exp_f32 v227, v155
 v_add_f32 v231, v231, v224
 v_cvt_pk_bf16_f32 v188, v224, v225
 v_add_f32 v231, v231, v225
 v_exp_f32 v224, v156
 v_exp_f32 v225, v157
 v_add_f32 v231, v231, v226
 v_cvt_pk_bf16_f32 v189, v226, v227
 v_add_f32 v231, v231, v227
 v_exp_f32 v226, v158
 v_exp_f32 v227, v159
 v_add_f32 v231, v231, v224
 v_cvt_pk_bf16_f32 v190, v224, v225
 v_add_f32 v231, v231, v225
 v_add_f32 v231, v231, v226
 v_cvt_pk_bf16_f32 v191, v226, v227
 v_add_f32 v231, v231, v227
 v_mfma_f32_32x32x16_bf16 a[64:79], a[160:163], v[176:179], a[64:79]
 ds_read_b128 a[188:191], v24 offset:13312
 ds_read_b128 a[128:131], v24 offset:2048
 s_add_u32 m0, s74, 102400
 s_add_u32 s56, s69, 40960
 s_waitcnt lgkmcnt(2)
 v_mfma_f32_32x32x16_bf16 a[64:79], a[164:167], v[180:183], a[64:79]
 ds_read_b128 a[132:135], v24 offset:6144
 buffer_load_dwordx4 v14, s[4:7], s56 offen offset:0 sc1 lds
 buffer_load_dwordx4 v14, s[4:7], s56 offen offset:1024 sc1 lds
 v_mfma_f32_32x32x16_bf16 a[64:79], a[168:171], v[184:187], a[64:79]
 ds_read_b128 a[136:139], v24 offset:10240
 buffer_load_dwordx4 v14, s[4:7], s56 offen offset:2048 sc1 lds
 buffer_load_dwordx4 v14, s[4:7], s56 offen offset:3072 sc1 lds
 s_add_u32 m0, s74, 106496
 v_mfma_f32_32x32x16_bf16 a[64:79], a[172:175], v[188:191], a[64:79]
 ds_read_b128 a[140:143], v24 offset:14336
 s_add_u32 s56, s56, 4096
 buffer_load_dwordx4 v14, s[4:7], s56 offen sc1 lds
 s_add_u32 m0, s74, 122880
 s_add_u32 s56, s69, 61440
 v_mfma_f32_32x32x16_bf16 a[80:95], a[176:179], v[176:179], a[80:95]
 ds_read_b128 a[144:147], v24 offset:3072
 buffer_load_dwordx4 v14, s[4:7], s56 offen offset:0 sc1 lds
 buffer_load_dwordx4 v14, s[4:7], s56 offen offset:1024 sc1 lds
 v_mfma_f32_32x32x16_bf16 a[80:95], a[180:183], v[180:183], a[80:95]
 ds_read_b128 a[148:151], v24 offset:7168
 buffer_load_dwordx4 v14, s[4:7], s56 offen offset:2048 sc1 lds
 buffer_load_dwordx4 v14, s[4:7], s56 offen offset:3072 sc1 lds
 s_add_u32 m0, s74, 126976
 v_mfma_f32_32x32x16_bf16 a[80:95], a[184:187], v[184:187], a[80:95]
 ds_read_b128 a[152:155], v24 offset:11264
 s_add_u32 s56, s56, 4096
 buffer_load_dwordx4 v14, s[4:7], s56 offen sc1 lds
 v_add_f32 v234, v230, v231
 s_waitcnt lgkmcnt(5)
 v_mfma_f32_32x32x16_bf16 a[80:95], a[188:191], v[188:191], a[80:95]
 ds_read_b128 a[156:159], v24 offset:15360
 v_cmp_nge_f32 vcc, s14, v234
 s_nop 1
 v_cndmask_b32 v233, 0, 1, vcc
 v_xor_b32 v234, 0x8000, v24
 v_mfma_f32_32x32x16_bf16 a[96:111], a[128:131], v[176:179], a[96:111]
 v_and_b32 v234, 0x8000, v234
 s_lshl_b32 s57, s3, 8
 v_lshl_add_u32 v234, v0, 2, v234
 v_add_u32 v234, s57, v234
 ds_write_b32 v234, v233
 v_mov_b32 v235, v231
 v_mfma_f32_32x32x16_bf16 a[96:111], a[132:135], v[180:183], a[96:111]
 s_nop 0
 v_permlane32_swap_b32 v231, v235
 v_add_f32 v231, v231, v235
 v_rcp_f32 v232, v231
 s_waitcnt lgkmcnt(4)
 v_mfma_f32_32x32x16_bf16 a[96:111], a[136:139], v[184:187], a[96:111]
 s_mul_i32 s57, s94, 372736
 s_lshl_b32 s58, s84, 12
 s_add_u32 s57, s57, s58
 s_add_u32 s57, s57, 39845888
 v_accvgpr_read_b32 v128, a64
 v_accvgpr_read_b32 v129, a65
 v_mfma_f32_32x32x16_bf16 a[96:111], a[140:143], v[188:191], a[96:111]
 v_accvgpr_read_b32 v130, a66
 v_accvgpr_read_b32 v131, a67
 v_accvgpr_read_b32 v132, a68
 v_accvgpr_read_b32 v133, a69
 v_accvgpr_read_b32 v134, a70
 v_accvgpr_read_b32 v135, a71
 v_mfma_f32_32x32x16_bf16 a[112:127], a[144:147], v[176:179], a[112:127]
 v_accvgpr_read_b32 v136, a72
 v_accvgpr_read_b32 v137, a73
 v_accvgpr_read_b32 v138, a74
 v_accvgpr_read_b32 v139, a75
 v_accvgpr_read_b32 v140, a76
 s_waitcnt lgkmcnt(1)
 v_mfma_f32_32x32x16_bf16 a[112:127], a[148:151], v[180:183], a[112:127]
 v_accvgpr_read_b32 v141, a77
 v_accvgpr_read_b32 v142, a78
 v_accvgpr_read_b32 v143, a79
 v_mul_f32 v128, v128, v232
 v_mul_f32 v129, v129, v232
 v_mul_f32 v130, v130, v232
 v_mfma_f32_32x32x16_bf16 a[112:127], a[152:155], v[184:187], a[112:127]
 v_mul_f32 v131, v131, v232
 v_mul_f32 v132, v132, v232
 v_mul_f32 v133, v133, v232
 v_mul_f32 v134, v134, v232
 v_mul_f32 v135, v135, v232
 v_mul_f32 v136, v136, v232
 v_mfma_f32_32x32x16_bf16 a[112:127], a[156:159], v[188:191], a[112:127]
 v_mul_f32 v137, v137, v232
 v_mul_f32 v138, v138, v232
 v_mul_f32 v139, v139, v232
 v_mul_f32 v140, v140, v232
 v_mul_f32 v141, v141, v232
 v_mul_f32 v142, v142, v232
 v_mul_f32 v143, v143, v232
 v_cvt_pk_bf16_f32 v128, v128, v129
 v_cvt_pk_bf16_f32 v129, v130, v131
 v_cvt_pk_bf16_f32 v130, v132, v133
 v_cvt_pk_bf16_f32 v131, v134, v135
 buffer_store_dwordx4 v[128:131], v25, s[4:7], s57 offen offset:0 sc1
 v_cvt_pk_bf16_f32 v136, v136, v137
 v_cvt_pk_bf16_f32 v137, v138, v139
 v_cvt_pk_bf16_f32 v138, v140, v141
 v_cvt_pk_bf16_f32 v139, v142, v143
 buffer_store_dwordx4 v[136:139], v25, s[4:7], s57 offen offset:512 sc1
 s_waitcnt lgkmcnt(0)
 s_barrier
 v_xor_b32 v234, 0x8000, v24
 ds_read_b128 v[224:227], v234
 v_accvgpr_read_b32 v144, a80
 v_accvgpr_read_b32 v145, a81
 v_accvgpr_read_b32 v146, a82
 v_accvgpr_read_b32 v147, a83
 v_accvgpr_read_b32 v148, a84
 v_accvgpr_read_b32 v149, a85
 v_accvgpr_read_b32 v150, a86
 v_accvgpr_read_b32 v151, a87
 v_accvgpr_read_b32 v152, a88
 v_accvgpr_read_b32 v153, a89
 v_accvgpr_read_b32 v154, a90
 v_accvgpr_read_b32 v155, a91
 v_accvgpr_read_b32 v156, a92
 v_accvgpr_read_b32 v157, a93
 v_accvgpr_read_b32 v158, a94
 v_accvgpr_read_b32 v159, a95
 v_pk_mul_f32 v[144:145], v[144:145], v[232:233] op_sel_hi:[1,0]
 v_pk_mul_f32 v[146:147], v[146:147], v[232:233] op_sel_hi:[1,0]
 v_pk_mul_f32 v[148:149], v[148:149], v[232:233] op_sel_hi:[1,0]
 v_pk_mul_f32 v[150:151], v[150:151], v[232:233] op_sel_hi:[1,0]
 v_pk_mul_f32 v[152:153], v[152:153], v[232:233] op_sel_hi:[1,0]
 v_pk_mul_f32 v[154:155], v[154:155], v[232:233] op_sel_hi:[1,0]
 v_pk_mul_f32 v[156:157], v[156:157], v[232:233] op_sel_hi:[1,0]
 v_pk_mul_f32 v[158:159], v[158:159], v[232:233] op_sel_hi:[1,0]
 v_cvt_pk_bf16_f32 v144, v144, v145
 v_cvt_pk_bf16_f32 v145, v146, v147
 v_cvt_pk_bf16_f32 v146, v148, v149
 v_cvt_pk_bf16_f32 v147, v150, v151
 buffer_store_dwordx4 v[144:147], v25, s[4:7], s57 offen offset:1024 sc1
 v_cvt_pk_bf16_f32 v152, v152, v153
 v_cvt_pk_bf16_f32 v153, v154, v155
 v_cvt_pk_bf16_f32 v154, v156, v157
 v_cvt_pk_bf16_f32 v155, v158, v159
 buffer_store_dwordx4 v[152:155], v25, s[4:7], s57 offen offset:1536 sc1
 v_accvgpr_read_b32 v128, a96
 v_accvgpr_read_b32 v129, a97
 v_accvgpr_read_b32 v130, a98
 v_accvgpr_read_b32 v131, a99
 v_accvgpr_read_b32 v132, a100
 v_accvgpr_read_b32 v133, a101
 v_accvgpr_read_b32 v134, a102
 v_accvgpr_read_b32 v135, a103
 v_accvgpr_read_b32 v136, a104
 v_accvgpr_read_b32 v137, a105
 v_accvgpr_read_b32 v138, a106
 v_accvgpr_read_b32 v139, a107
 v_accvgpr_read_b32 v140, a108
 v_accvgpr_read_b32 v141, a109
 v_accvgpr_read_b32 v142, a110
 v_accvgpr_read_b32 v143, a111
 v_pk_mul_f32 v[128:129], v[128:129], v[232:233] op_sel_hi:[1,0]
 v_pk_mul_f32 v[130:131], v[130:131], v[232:233] op_sel_hi:[1,0]
 v_pk_mul_f32 v[132:133], v[132:133], v[232:233] op_sel_hi:[1,0]
 v_pk_mul_f32 v[134:135], v[134:135], v[232:233] op_sel_hi:[1,0]
 v_pk_mul_f32 v[136:137], v[136:137], v[232:233] op_sel_hi:[1,0]
 v_pk_mul_f32 v[138:139], v[138:139], v[232:233] op_sel_hi:[1,0]
 v_pk_mul_f32 v[140:141], v[140:141], v[232:233] op_sel_hi:[1,0]
 v_pk_mul_f32 v[142:143], v[142:143], v[232:233] op_sel_hi:[1,0]
 v_cvt_pk_bf16_f32 v128, v128, v129
 v_cvt_pk_bf16_f32 v129, v130, v131
 v_cvt_pk_bf16_f32 v130, v132, v133
 v_cvt_pk_bf16_f32 v131, v134, v135
 buffer_store_dwordx4 v[128:131], v25, s[4:7], s57 offen offset:2048 sc1
 v_cvt_pk_bf16_f32 v136, v136, v137
 v_cvt_pk_bf16_f32 v137, v138, v139
 v_cvt_pk_bf16_f32 v138, v140, v141
 v_cvt_pk_bf16_f32 v139, v142, v143
 buffer_store_dwordx4 v[136:139], v25, s[4:7], s57 offen offset:2560 sc1
 v_accvgpr_read_b32 v144, a112
 v_accvgpr_read_b32 v145, a113
 v_accvgpr_read_b32 v146, a114
 v_accvgpr_read_b32 v147, a115
 v_accvgpr_read_b32 v148, a116
 v_accvgpr_read_b32 v149, a117
 v_accvgpr_read_b32 v150, a118
 v_accvgpr_read_b32 v151, a119
 v_accvgpr_read_b32 v152, a120
 v_accvgpr_read_b32 v153, a121
 v_accvgpr_read_b32 v154, a122
 v_accvgpr_read_b32 v155, a123
 v_accvgpr_read_b32 v156, a124
 v_accvgpr_read_b32 v157, a125
 v_accvgpr_read_b32 v158, a126
 v_accvgpr_read_b32 v159, a127
 v_pk_mul_f32 v[144:145], v[144:145], v[232:233] op_sel_hi:[1,0]
 v_pk_mul_f32 v[146:147], v[146:147], v[232:233] op_sel_hi:[1,0]
 v_pk_mul_f32 v[148:149], v[148:149], v[232:233] op_sel_hi:[1,0]
 v_pk_mul_f32 v[150:151], v[150:151], v[232:233] op_sel_hi:[1,0]
 v_pk_mul_f32 v[152:153], v[152:153], v[232:233] op_sel_hi:[1,0]
 v_pk_mul_f32 v[154:155], v[154:155], v[232:233] op_sel_hi:[1,0]
 v_pk_mul_f32 v[156:157], v[156:157], v[232:233] op_sel_hi:[1,0]
 v_pk_mul_f32 v[158:159], v[158:159], v[232:233] op_sel_hi:[1,0]
 v_cvt_pk_bf16_f32 v144, v144, v145
 v_cvt_pk_bf16_f32 v145, v146, v147
 v_cvt_pk_bf16_f32 v146, v148, v149
 v_cvt_pk_bf16_f32 v147, v150, v151
 buffer_store_dwordx4 v[144:147], v25, s[4:7], s57 offen offset:3072 sc1
 v_cvt_pk_bf16_f32 v152, v152, v153
 v_cvt_pk_bf16_f32 v153, v154, v155
 v_cvt_pk_bf16_f32 v154, v156, v157
 v_cvt_pk_bf16_f32 v155, v158, v159
 buffer_store_dwordx4 v[152:155], v25, s[4:7], s57 offen offset:3584 sc1
 s_waitcnt vmcnt(18)
 s_waitcnt lgkmcnt(0)
 s_barrier
 v_or_b32 v224, v224, v225
 v_or3_b32 v224, v224, v226, v227
 v_cmp_ne_u32 vcc, 0, v224
 s_cbranch_vccnz L_safe
L_D:
 s_bitcmp1_b32 s2, 0
 s_cbranch_scc1 L_Dodd
 ds_read_b128 a[0:3], v6 offset:20480
 ds_read_b128 a[4:7], v6 offset:21504
 ds_read_b128 a[8:11], v6 offset:22528
 ds_read_b128 a[12:15], v6 offset:23552
 ds_read_b128 a[16:19], v6 offset:24576
 ds_read_b128 a[20:23], v9 offset:20480
 ds_read_b128 a[24:27], v9 offset:21504
 ds_read_b128 a[28:31], v9 offset:22528
 ds_read_b128 a[32:35], v9 offset:23552
 ds_read_b128 a[36:39], v9 offset:24576
 ds_read_b128 a[40:43], v6 offset:30720
 s_waitcnt lgkmcnt(10)
 v_mfma_f32_16x16x32_bf16 v[32:35], a[0:3], a[192:195], 0
 ds_read_b128 a[44:47], v6 offset:31744
 v_mfma_f32_16x16x32_bf16 v[72:75], a[0:3], a[196:199], 0
 s_waitcnt lgkmcnt(10)
 v_mfma_f32_16x16x32_bf16 v[36:39], a[4:7], a[192:195], 0
 ds_read_b128 a[48:51], v6 offset:32768
 s_add_u32 s79, s79, 32768
 v_mfma_f32_16x16x32_bf16 v[76:79], a[4:7], a[196:199], 0
 s_waitcnt lgkmcnt(10)
 v_mfma_f32_16x16x32_bf16 v[40:43], a[8:11], a[192:195], 0
 ds_read_b128 a[52:55], v6 offset:33792
 v_mfma_f32_16x16x32_bf16 v[80:83], a[8:11], a[196:199], 0
 s_waitcnt lgkmcnt(10)
 v_mfma_f32_16x16x32_bf16 v[44:47], a[12:15], a[192:195], 0
 ds_read_b128 a[56:59], v6 offset:34816
 v_mfma_f32_16x16x32_bf16 v[84:87], a[12:15], a[196:199], 0
 s_waitcnt lgkmcnt(10)
 v_mfma_f32_16x16x32_bf16 v[48:51], a[16:19], a[192:195], 0
 ds_read_b128 a[60:63], v9 offset:30720
 v_mfma_f32_16x16x32_bf16 v[88:91], a[16:19], a[196:199], 0
 s_waitcnt lgkmcnt(5)
 v_mfma_f32_16x16x32_bf16 v[52:55], a[20:23], a[192:195], 0
 ds_read_b128 a[0:3], v9 offset:31744
 v_mfma_f32_16x16x32_bf16 v[92:95], a[20:23], a[196:199], 0
 v_mfma_f32_16x16x32_bf16 v[56:59], a[24:27], a[192:195], 0
 ds_read_b128 a[4:7], v9 offset:32768
 v_mfma_f32_16x16x32_bf16 v[96:99], a[24:27], a[196:199], 0
 v_mfma_f32_16x16x32_bf16 v[60:63], a[28:31], a[192:195], 0
 ds_read_b128 a[8:11], v9 offset:33792
 v_mfma_f32_16x16x32_bf16 v[100:103], a[28:31], a[196:199], 0
 v_mfma_f32_16x16x32_bf16 v[64:67], a[32:35], a[192:195], 0
 ds_read_b128 a[12:15], v9 offset:34816
 s_add_u32 s78, s77, 512
 v_mfma_f32_16x16x32_bf16 v[104:107], a[32:35], a[196:199], 0
 v_mfma_f32_16x16x32_bf16 v[68:71], a[36:39], a[192:195], 0
 ds_read_b128 a[16:19], v5 offset:20480
 v_mfma_f32_16x16x32_bf16 v[108:111], a[36:39], a[196:199], 0
 v_mfma_f32_16x16x32_bf16 v[32:35], a[40:43], a[200:203], v[32:35]
 ds_read_b128 a[20:23], v5 offset:21504
 s_add_u32 s59, s71, 8192
 v_mfma_f32_16x16x32_bf16 v[72:75], a[40:43], a[204:207], v[72:75]
 s_add_u32 m0, s74, 0
 s_waitcnt lgkmcnt(5)
 v_mfma_f32_16x16x32_bf16 v[36:39], a[44:47], a[200:203], v[36:39]
 ds_read_b128 a[24:27], v5 offset:22528
 s_add_u32 s56, s69, 81920
 v_mfma_f32_16x16x32_bf16 v[76:79], a[44:47], a[204:207], v[76:79]
 v_mfma_f32_16x16x32_bf16 v[40:43], a[48:51], a[200:203], v[40:43]
 ds_read_b128 a[28:31], v5 offset:23552
 v_mfma_f32_16x16x32_bf16 v[80:83], a[48:51], a[204:207], v[80:83]
 buffer_load_dwordx4 a[176:179], v2, s[4:7], s59 offen offset:0 sc1
 v_mfma_f32_16x16x32_bf16 v[44:47], a[52:55], a[200:203], v[44:47]
 buffer_load_dwordx4 v14, s[4:7], s56 offen offset:0 sc1 lds
 v_mfma_f32_16x16x32_bf16 v[84:87], a[52:55], a[204:207], v[84:87]
 ds_read_b128 a[32:35], v5 offset:24576
 v_mfma_f32_16x16x32_bf16 v[48:51], a[56:59], a[200:203], v[48:51]
 buffer_load_dwordx4 v14, s[4:7], s56 offen offset:1024 sc1 lds
 v_mfma_f32_16x16x32_bf16 v[88:91], a[56:59], a[204:207], v[88:91]
 ds_read_b128 a[36:39], v8 offset:20480
 v_mfma_f32_16x16x32_bf16 v[52:55], a[60:63], a[200:203], v[52:55]
 buffer_load_dwordx4 a[180:183], v3, s[4:7], s59 offen offset:0 sc1
 v_mfma_f32_16x16x32_bf16 v[92:95], a[60:63], a[204:207], v[92:95]
 ds_read_b128 a[40:43], v8 offset:21504
 v_mfma_f32_16x16x32_bf16 v[56:59], a[0:3], a[200:203], v[56:59]
 buffer_load_dwordx4 v14, s[4:7], s56 offen offset:2048 sc1 lds
 v_mfma_f32_16x16x32_bf16 v[96:99], a[0:3], a[204:207], v[96:99]
 ds_read_b128 a[44:47], v8 offset:22528
 s_waitcnt lgkmcnt(5)
 v_mfma_f32_16x16x32_bf16 v[60:63], a[4:7], a[200:203], v[60:63]
 buffer_load_dwordx4 a[184:187], v2, s[4:7], s59 offen offset:1024 sc1
 v_mfma_f32_16x16x32_bf16 v[100:103], a[4:7], a[204:207], v[100:103]
 buffer_load_dwordx4 v14, s[4:7], s56 offen offset:3072 sc1 lds
 v_mfma_f32_16x16x32_bf16 v[64:67], a[8:11], a[200:203], v[64:67]
 ds_read_b128 a[48:51], v8 offset:23552
 s_add_u32 m0, s74, 4096
 v_mfma_f32_16x16x32_bf16 v[104:107], a[8:11], a[204:207], v[104:107]
 ds_read_b128 a[52:55], v8 offset:24576
 v_mfma_f32_16x16x32_bf16 v[68:71], a[12:15], a[200:203], v[68:71]
 buffer_load_dwordx4 a[188:191], v3, s[4:7], s59 offen offset:1024 sc1
 v_mfma_f32_16x16x32_bf16 v[108:111], a[12:15], a[204:207], v[108:111]
 s_add_u32 s56, s56, 4096
 ds_read_b128 a[56:59], v5 offset:30720
 v_mfma_f32_16x16x32_bf16 v[32:35], a[16:19], a[208:211], v[32:35]
 ds_read_b128 a[60:63], v5 offset:31744
 v_mfma_f32_16x16x32_bf16 v[72:75], a[16:19], a[212:215], v[72:75]
 buffer_load_dwordx4 v14, s[4:7], s56 offen sc1 lds
 v_mfma_f32_16x16x32_bf16 v[36:39], a[20:23], a[208:211], v[36:39]
 s_add_u32 s59, s71, 10240
 ds_read_b128 a[0:3], v5 offset:32768
 v_mfma_f32_16x16x32_bf16 v[76:79], a[20:23], a[212:215], v[76:79]
 s_add_u32 m0, s74, 20480
 v_mfma_f32_16x16x32_bf16 v[40:43], a[24:27], a[208:211], v[40:43]
 ds_read_b128 a[4:7], v5 offset:33792
 v_mfma_f32_16x16x32_bf16 v[80:83], a[24:27], a[212:215], v[80:83]
 s_add_u32 s56, s69, 102400
 s_waitcnt lgkmcnt(6)
 v_mfma_f32_16x16x32_bf16 v[44:47], a[28:31], a[208:211], v[44:47]
 ds_read_b128 a[8:11], v5 offset:34816
 v_mfma_f32_16x16x32_bf16 v[84:87], a[28:31], a[212:215], v[84:87]
 buffer_load_dwordx4 a[192:195], v2, s[4:7], s59 offen offset:0 sc1
 v_mfma_f32_16x16x32_bf16 v[48:51], a[32:35], a[208:211], v[48:51]
 ds_read_b128 a[12:15], v8 offset:30720
 v_mfma_f32_16x16x32_bf16 v[88:91], a[32:35], a[212:215], v[88:91]
 buffer_load_dwordx4 v14, s[4:7], s56 offen offset:0 sc1 lds
 v_mfma_f32_16x16x32_bf16 v[52:55], a[36:39], a[208:211], v[52:55]
 ds_read_b128 a[16:19], v8 offset:31744
 v_mfma_f32_16x16x32_bf16 v[92:95], a[36:39], a[212:215], v[92:95]
 buffer_load_dwordx4 v14, s[4:7], s56 offen offset:1024 sc1 lds
 v_mfma_f32_16x16x32_bf16 v[56:59], a[40:43], a[208:211], v[56:59]
 buffer_load_dwordx4 a[196:199], v3, s[4:7], s59 offen offset:0 sc1
 v_mfma_f32_16x16x32_bf16 v[96:99], a[40:43], a[212:215], v[96:99]
 ds_read_b128 a[20:23], v8 offset:32768
 v_mfma_f32_16x16x32_bf16 v[60:63], a[44:47], a[208:211], v[60:63]
 buffer_load_dwordx4 v14, s[4:7], s56 offen offset:2048 sc1 lds
 v_mfma_f32_16x16x32_bf16 v[100:103], a[44:47], a[212:215], v[100:103]
 ds_read_b128 a[24:27], v8 offset:33792
 s_waitcnt lgkmcnt(5)
 v_mfma_f32_16x16x32_bf16 v[64:67], a[48:51], a[208:211], v[64:67]
 buffer_load_dwordx4 v14, s[4:7], s56 offen offset:3072 sc1 lds
 v_mfma_f32_16x16x32_bf16 v[104:107], a[48:51], a[212:215], v[104:107]
 ds_read_b128 a[28:31], v8 offset:34816
 v_mfma_f32_16x16x32_bf16 v[68:71], a[52:55], a[208:211], v[68:71]
 buffer_load_dwordx4 a[200:203], v2, s[4:7], s59 offen offset:1024 sc1
 v_mfma_f32_16x16x32_bf16 v[108:111], a[52:55], a[212:215], v[108:111]
 s_add_u32 m0, s74, 24576
 v_mfma_f32_16x16x32_bf16 v[32:35], a[56:59], a[216:219], v[32:35]
 s_add_u32 s56, s56, 4096
 v_mfma_f32_16x16x32_bf16 v[72:75], a[56:59], a[220:223], v[72:75]
 v_mfma_f32_16x16x32_bf16 v[36:39], a[60:63], a[216:219], v[36:39]
 buffer_load_dwordx4 a[204:207], v3, s[4:7], s59 offen offset:1024 sc1
 v_mfma_f32_16x16x32_bf16 v[76:79], a[60:63], a[220:223], v[76:79]
 buffer_load_dwordx4 v14, s[4:7], s56 offen sc1 lds
 v_mfma_f32_16x16x32_bf16 v[40:43], a[0:3], a[216:219], v[40:43]
 v_mfma_f32_16x16x32_bf16 v[80:83], a[0:3], a[220:223], v[80:83]
 v_mfma_f32_16x16x32_bf16 v[44:47], a[4:7], a[216:219], v[44:47]
 v_mfma_f32_16x16x32_bf16 v[84:87], a[4:7], a[220:223], v[84:87]
 s_waitcnt lgkmcnt(0)
 v_mfma_f32_16x16x32_bf16 v[48:51], a[8:11], a[216:219], v[48:51]
 s_waitcnt vmcnt(31)
 s_waitcnt vmcnt(26)
 s_waitcnt lgkmcnt(0)
 s_barrier
 v_mfma_f32_16x16x32_bf16 v[88:91], a[8:11], a[220:223], v[88:91]
 ds_read_b128 a[32:35], v5 offset:40960
 ds_read_b128 a[36:39], v5 offset:41984
 v_mfma_f32_16x16x32_bf16 v[52:55], a[12:15], a[216:219], v[52:55]
 ds_read_b128 a[40:43], v5 offset:43008
 ds_read_b128 a[44:47], v5 offset:44032
 v_mfma_f32_16x16x32_bf16 v[92:95], a[12:15], a[220:223], v[92:95]
 s_add_u32 m0, s74, 40960
 ds_read_b128 a[48:51], v5 offset:45056
 v_mfma_f32_16x16x32_bf16 v[56:59], a[16:19], a[216:219], v[56:59]
 ds_read_b128 a[52:55], v8 offset:40960
 ds_read_b128 a[56:59], v8 offset:41984
 v_mfma_f32_16x16x32_bf16 v[96:99], a[16:19], a[220:223], v[96:99]
 ds_read_b128 a[60:63], v8 offset:43008
 s_add_u32 s56, s69, 122880
 v_mfma_f32_16x16x32_bf16 v[60:63], a[20:23], a[216:219], v[60:63]
 ds_read_b128 a[0:3], v8 offset:44032
 v_mfma_f32_16x16x32_bf16 v[100:103], a[20:23], a[220:223], v[100:103]
 buffer_load_dwordx4 v14, s[4:7], s56 offen offset:0 sc1 lds
 v_mfma_f32_16x16x32_bf16 v[64:67], a[24:27], a[216:219], v[64:67]
 ds_read_b128 a[4:7], v8 offset:45056
 v_mfma_f32_16x16x32_bf16 v[104:107], a[24:27], a[220:223], v[104:107]
 v_mfma_f32_16x16x32_bf16 v[68:71], a[28:31], a[216:219], v[68:71]
 ds_read_b128 a[8:11], v5 offset:51200
 v_mfma_f32_16x16x32_bf16 v[108:111], a[28:31], a[220:223], v[108:111]
 s_waitcnt lgkmcnt(10)
 v_mfma_f32_16x16x32_bf16 v[32:35], a[32:35], a[224:227], v[32:35]
 buffer_load_dwordx4 v14, s[4:7], s56 offen offset:1024 sc1 lds
 v_mfma_f32_16x16x32_bf16 v[72:75], a[32:35], a[228:231], v[72:75]
 ds_read_b128 a[12:15], v5 offset:52224
 s_waitcnt lgkmcnt(8)
 v_mfma_f32_16x16x32_bf16 v[36:39], a[36:39], a[224:227], v[36:39]
 buffer_load_dwordx4 v14, s[4:7], s56 offen offset:2048 sc1 lds
 v_mfma_f32_16x16x32_bf16 v[76:79], a[36:39], a[228:231], v[76:79]
 s_add_u32 s59, s71, 12288
 ds_read_b128 a[16:19], v5 offset:53248
 v_mfma_f32_16x16x32_bf16 v[40:43], a[40:43], a[224:227], v[40:43]
 ds_read_b128 a[20:23], v5 offset:54272
 v_mfma_f32_16x16x32_bf16 v[80:83], a[40:43], a[228:231], v[80:83]
 buffer_load_dwordx4 v14, s[4:7], s56 offen offset:3072 sc1 lds
 v_mfma_f32_16x16x32_bf16 v[44:47], a[44:47], a[224:227], v[44:47]
 ds_read_b128 a[24:27], v5 offset:55296
 v_mfma_f32_16x16x32_bf16 v[84:87], a[44:47], a[228:231], v[84:87]
 s_waitcnt lgkmcnt(5)
 v_mfma_f32_16x16x32_bf16 v[48:51], a[48:51], a[224:227], v[48:51]
 buffer_load_dwordx4 a[208:211], v2, s[4:7], s59 offen offset:0 sc1
 v_mfma_f32_16x16x32_bf16 v[88:91], a[48:51], a[228:231], v[88:91]
 s_add_u32 m0, s74, 45056
 ds_read_b128 a[28:31], v8 offset:51200
 v_mfma_f32_16x16x32_bf16 v[52:55], a[52:55], a[224:227], v[52:55]
 s_add_u32 s56, s56, 4096
 ds_read_b128 a[32:35], v8 offset:52224
 v_mfma_f32_16x16x32_bf16 v[92:95], a[52:55], a[228:231], v[92:95]
 buffer_load_dwordx4 a[212:215], v3, s[4:7], s59 offen offset:0 sc1
 v_mfma_f32_16x16x32_bf16 v[56:59], a[56:59], a[224:227], v[56:59]
 ds_read_b128 a[36:39], v8 offset:53248
 v_mfma_f32_16x16x32_bf16 v[96:99], a[56:59], a[228:231], v[96:99]
 buffer_load_dwordx4 v14, s[4:7], s56 offen sc1 lds
 v_mfma_f32_16x16x32_bf16 v[60:63], a[60:63], a[224:227], v[60:63]
 ds_read_b128 a[40:43], v8 offset:54272
 v_mfma_f32_16x16x32_bf16 v[100:103], a[60:63], a[228:231], v[100:103]
 s_add_u32 m0, s74, 61440
 v_mfma_f32_16x16x32_bf16 v[64:67], a[0:3], a[224:227], v[64:67]
 ds_read_b128 a[44:47], v8 offset:55296
 v_mfma_f32_16x16x32_bf16 v[104:107], a[0:3], a[228:231], v[104:107]
 buffer_load_dwordx4 a[216:219], v2, s[4:7], s59 offen offset:1024 sc1
 v_mfma_f32_16x16x32_bf16 v[68:71], a[4:7], a[224:227], v[68:71]
 ds_read_b128 a[48:51], v6 offset:0
 s_add_u32 s56, s69, 143360
 v_mfma_f32_16x16x32_bf16 v[108:111], a[4:7], a[228:231], v[108:111]
 s_waitcnt lgkmcnt(6)
 v_mfma_f32_16x16x32_bf16 v[32:35], a[8:11], a[232:235], v[32:35]
 ds_read_b128 a[52:55], v6 offset:1024
 s_waitcnt vmcnt(26)
 s_waitcnt lgkmcnt(0)
 s_barrier
 buffer_store_dword v27, v26, s[4:7], s79 offen sc1
 v_mfma_f32_16x16x32_bf16 v[72:75], a[8:11], a[236:239], v[72:75]
 buffer_load_dwordx4 v14, s[4:7], s56 offen offset:0 sc1 lds
 v_mfma_f32_16x16x32_bf16 v[36:39], a[12:15], a[232:235], v[36:39]
 ds_read_b128 a[56:59], v6 offset:2048
 v_mfma_f32_16x16x32_bf16 v[76:79], a[12:15], a[236:239], v[76:79]
 buffer_load_dwordx4 a[220:223], v3, s[4:7], s59 offen offset:1024 sc1
 v_mfma_f32_16x16x32_bf16 v[40:43], a[16:19], a[232:235], v[40:43]
 buffer_load_dwordx4 v14, s[4:7], s56 offen offset:1024 sc1 lds
 v_mfma_f32_16x16x32_bf16 v[80:83], a[16:19], a[236:239], v[80:83]
 ds_read_b128 a[60:63], v6 offset:3072
 v_lshrrev_b32 v28, 2, v0
 v_mfma_f32_16x16x32_bf16 v[44:47], a[20:23], a[232:235], v[44:47]
 ds_read_b128 a[0:3], v6 offset:4096
 v_and_b32 v29, 3, v0
 v_mfma_f32_16x16x32_bf16 v[84:87], a[20:23], a[236:239], v[84:87]
 buffer_load_dwordx4 v14, s[4:7], s56 offen offset:2048 sc1 lds
 v_mfma_f32_16x16x32_bf16 v[48:51], a[24:27], a[232:235], v[48:51]
 ds_read_b128 a[4:7], v9 offset:0
 v_lshl_add_u32 v19, v29, 4, v28
 v_mfma_f32_16x16x32_bf16 v[88:91], a[24:27], a[236:239], v[88:91]
 buffer_load_dwordx4 v14, s[4:7], s56 offen offset:3072 sc1 lds
 v_mfma_f32_16x16x32_bf16 v[52:55], a[28:31], a[232:235], v[52:55]
 ds_read_b128 a[8:11], v9 offset:1024
 v_lshlrev_b32 v19, 2, v19
 v_mfma_f32_16x16x32_bf16 v[92:95], a[28:31], a[236:239], v[92:95]
 v_mul_u32_u24 v28, 1280, v28
 v_mfma_f32_16x16x32_bf16 v[56:59], a[32:35], a[232:235], v[56:59]
 ds_read_b128 a[12:15], v9 offset:2048
 s_add_u32 m0, s74, 65536
 v_mfma_f32_16x16x32_bf16 v[96:99], a[32:35], a[236:239], v[96:99]
 v_lshl_add_u32 v10, v29, 3, v28
 v_mfma_f32_16x16x32_bf16 v[60:63], a[36:39], a[232:235], v[60:63]
 ds_read_b128 a[16:19], v9 offset:3072
 v_lshrrev_b32 v29, 4, v0
 v_mfma_f32_16x16x32_bf16 v[100:103], a[36:39], a[236:239], v[100:103]
 s_add_u32 s56, s56, 4096
 v_lshlrev_b32 v11, 3, v29
 v_mfma_f32_16x16x32_bf16 v[64:67], a[40:43], a[232:235], v[64:67]
 ds_read_b128 a[20:23], v9 offset:4096
 v_mfma_f32_16x16x32_bf16 v[104:107], a[40:43], a[236:239], v[104:107]
 buffer_load_dwordx4 v14, s[4:7], s56 offen sc1 lds
 v_mfma_f32_16x16x32_bf16 v[68:71], a[44:47], a[232:235], v[68:71]
 ds_read_b128 a[24:27], v6 offset:10240
 v_and_b32 v28, 15, v0
 v_mfma_f32_16x16x32_bf16 v[108:111], a[44:47], a[236:239], v[108:111]
 v_lshl_add_u32 v18, v28, 2, v29
 v_mfma_f32_16x16x32_bf16 v[32:35], a[48:51], a[240:243], v[32:35]
 ds_read_b128 a[28:31], v6 offset:11264
 s_add_u32 m0, s74, 143360
 v_mfma_f32_16x16x32_bf16 v[72:75], a[48:51], a[244:247], v[72:75]
 s_add_u32 s59, s71, 14336
 v_lshlrev_b32 v18, 2, v18
 v_mfma_f32_16x16x32_bf16 v[36:39], a[52:55], a[240:243], v[36:39]
 ds_read_b128 a[32:35], v6 offset:12288
 s_lshl_b32 s58, s67, 3
 v_mfma_f32_16x16x32_bf16 v[76:79], a[52:55], a[244:247], v[76:79]
 s_add_u32 s56, s70, 0
 s_waitcnt lgkmcnt(5)
 v_mfma_f32_16x16x32_bf16 v[40:43], a[56:59], a[240:243], v[40:43]
 ds_read_b128 a[36:39], v6 offset:13312
 s_lshl_b32 s76, s3, 1
 v_mfma_f32_16x16x32_bf16 v[80:83], a[56:59], a[244:247], v[80:83]
 v_mfma_f32_16x16x32_bf16 v[44:47], a[60:63], a[240:243], v[44:47]
 ds_read_b128 a[40:43], v6 offset:14336
 s_add_u32 s58, s58, s76
 v_mfma_f32_16x16x32_bf16 v[84:87], a[60:63], a[244:247], v[84:87]
 buffer_load_dwordx4 v14, s[4:7], s56 offen offset:0 sc1 lds
 v_mfma_f32_16x16x32_bf16 v[48:51], a[0:3], a[240:243], v[48:51]
 buffer_load_dwordx4 a[224:227], v2, s[4:7], s59 offen offset:0 sc1
 v_mfma_f32_16x16x32_bf16 v[88:91], a[0:3], a[244:247], v[88:91]
 ds_read_b128 a[44:47], v9 offset:10240
 s_lshr_b32 s76, s66, 1
 v_mfma_f32_16x16x32_bf16 v[52:55], a[4:7], a[240:243], v[52:55]
 buffer_load_dwordx4 v14, s[4:7], s56 offen offset:1024 sc1 lds
 v_mfma_f32_16x16x32_bf16 v[92:95], a[4:7], a[244:247], v[92:95]
 ds_read_b128 a[48:51], v9 offset:11264
 s_add_u32 s58, s58, s76
 v_mfma_f32_16x16x32_bf16 v[56:59], a[8:11], a[240:243], v[56:59]
 buffer_load_dwordx4 a[228:231], v3, s[4:7], s59 offen offset:0 sc1
 v_mfma_f32_16x16x32_bf16 v[96:99], a[8:11], a[244:247], v[96:99]
 buffer_load_dwordx4 v14, s[4:7], s56 offen offset:2048 sc1 lds
 v_mfma_f32_16x16x32_bf16 v[60:63], a[12:15], a[240:243], v[60:63]
 ds_read_b128 a[52:55], v9 offset:12288
 ds_read_b128 a[56:59], v9 offset:13312
 v_mfma_f32_16x16x32_bf16 v[100:103], a[12:15], a[244:247], v[100:103]
 s_mul_i32 s73, s58, 20480
 s_waitcnt lgkmcnt(5)
 v_mfma_f32_16x16x32_bf16 v[64:67], a[16:19], a[240:243], v[64:67]
 buffer_load_dwordx4 v14, s[4:7], s56 offen offset:3072 sc1 lds
 v_mfma_f32_16x16x32_bf16 v[104:107], a[16:19], a[244:247], v[104:107]
 ds_read_b128 a[60:63], v9 offset:14336
 s_lshl_b32 s58, s68, 1
 v_mfma_f32_16x16x32_bf16 v[68:71], a[20:23], a[240:243], v[68:71]
 buffer_load_dwordx4 a[232:235], v2, s[4:7], s59 offen offset:1024 sc1
 v_mfma_f32_16x16x32_bf16 v[108:111], a[20:23], a[244:247], v[108:111]
 s_add_u32 m0, s74, 147456
 s_and_b32 s76, s66, 1
 v_mfma_f32_16x16x32_bf16 v[32:35], a[24:27], a[248:251], v[32:35]
 s_add_u32 s56, s56, 4096
 s_add_u32 s58, s58, s76
 v_mfma_f32_16x16x32_bf16 v[72:75], a[24:27], a[252:255], v[72:75]
 s_mul_i32 s58, s58, 160
 s_add_u32 s73, s73, s58
 v_mfma_f32_16x16x32_bf16 v[36:39], a[28:31], a[248:251], v[36:39]
 buffer_load_dwordx4 a[236:239], v3, s[4:7], s59 offen offset:1024 sc1
 v_mfma_f32_16x16x32_bf16 v[76:79], a[28:31], a[252:255], v[76:79]
 buffer_load_dwordx4 v14, s[4:7], s56 offen sc1 lds
 v_mfma_f32_16x16x32_bf16 v[40:43], a[32:35], a[248:251], v[40:43]
 buffer_load_dwordx2 v[122:123], v11, s[48:51], s58 offen offset:0
 v_mfma_f32_16x16x32_bf16 v[80:83], a[32:35], a[252:255], v[80:83]
 buffer_load_dwordx2 v[124:125], v11, s[48:51], s58 offen offset:32
 v_mfma_f32_16x16x32_bf16 v[44:47], a[36:39], a[248:251], v[44:47]
 buffer_load_dwordx2 v[126:127], v11, s[48:51], s58 offen offset:64
 v_mfma_f32_16x16x32_bf16 v[84:87], a[36:39], a[252:255], v[84:87]
 s_waitcnt lgkmcnt(0)
 v_mfma_f32_16x16x32_bf16 v[48:51], a[40:43], a[248:251], v[48:51]
 s_waitcnt vmcnt(36)
 s_waitcnt vmcnt(27)
 s_waitcnt lgkmcnt(0)
 s_barrier
 v_mfma_f32_16x16x32_bf16 v[88:91], a[40:43], a[252:255], v[88:91]
 ds_read_b128 a[0:3], v4 offset:0
 ds_read_b128 a[4:7], v4 offset:1024
 v_mfma_f32_16x16x32_bf16 v[52:55], a[44:47], a[248:251], v[52:55]
 ds_read_b128 a[8:11], v4 offset:2048
 ds_read_b128 a[12:15], v4 offset:3072
 v_mfma_f32_16x16x32_bf16 v[92:95], a[44:47], a[252:255], v[92:95]
 s_add_u32 m0, s74, 81920
 ds_read_b128 a[16:19], v4 offset:4096
 v_mfma_f32_16x16x32_bf16 v[56:59], a[48:51], a[248:251], v[56:59]
 ds_read_b128 a[20:23], v7 offset:0
 ds_read_b128 a[24:27], v7 offset:1024
 v_mfma_f32_16x16x32_bf16 v[96:99], a[48:51], a[252:255], v[96:99]
 ds_read_b128 a[28:31], v7 offset:2048
 s_add_u32 s56, s70, 20480
 v_mfma_f32_16x16x32_bf16 v[60:63], a[52:55], a[248:251], v[60:63]
 ds_read_b128 a[32:35], v7 offset:3072
 v_mfma_f32_16x16x32_bf16 v[100:103], a[52:55], a[252:255], v[100:103]
 buffer_load_dword v15, v13, s[4:7], s77 offen sc1
 v_mfma_f32_16x16x32_bf16 v[64:67], a[56:59], a[248:251], v[64:67]
 buffer_load_dwordx4 v14, s[4:7], s56 offen offset:0 sc1 lds
 v_mfma_f32_16x16x32_bf16 v[104:107], a[56:59], a[252:255], v[104:107]
 ds_read_b128 a[36:39], v7 offset:4096
 v_mfma_f32_16x16x32_bf16 v[68:71], a[60:63], a[248:251], v[68:71]
 ds_read_b128 a[40:43], v4 offset:10240
 v_mfma_f32_16x16x32_bf16 v[108:111], a[60:63], a[252:255], v[108:111]
 s_waitcnt lgkmcnt(10)
 v_mfma_f32_16x16x32_bf16 v[32:35], a[0:3], a[176:179], v[32:35]
 buffer_load_dwordx4 v14, s[4:7], s56 offen offset:1024 sc1 lds
 v_mfma_f32_16x16x32_bf16 v[72:75], a[0:3], a[180:183], v[72:75]
 ds_read_b128 a[44:47], v4 offset:11264
 s_waitcnt lgkmcnt(8)
 v_mfma_f32_16x16x32_bf16 v[36:39], a[4:7], a[176:179], v[36:39]
 buffer_load_dwordx4 v14, s[4:7], s56 offen offset:2048 sc1 lds
 v_mfma_f32_16x16x32_bf16 v[76:79], a[4:7], a[180:183], v[76:79]
 ds_read_b128 a[48:51], v4 offset:12288
 v_mfma_f32_16x16x32_bf16 v[40:43], a[8:11], a[176:179], v[40:43]
 ds_read_b128 a[52:55], v4 offset:13312
 v_mfma_f32_16x16x32_bf16 v[80:83], a[8:11], a[180:183], v[80:83]
 buffer_load_dwordx4 v14, s[4:7], s56 offen offset:3072 sc1 lds
 v_mfma_f32_16x16x32_bf16 v[44:47], a[12:15], a[176:179], v[44:47]
 ds_read_b128 a[56:59], v4 offset:14336
 s_add_u32 m0, s74, 86016
 v_mfma_f32_16x16x32_bf16 v[84:87], a[12:15], a[180:183], v[84:87]
 s_waitcnt lgkmcnt(5)
 v_mfma_f32_16x16x32_bf16 v[48:51], a[16:19], a[176:179], v[48:51]
 ds_read_b128 a[60:63], v7 offset:10240
 v_mfma_f32_16x16x32_bf16 v[88:91], a[16:19], a[180:183], v[88:91]
 s_add_u32 s56, s56, 4096
 v_mfma_f32_16x16x32_bf16 v[52:55], a[20:23], a[176:179], v[52:55]
 ds_read_b128 a[0:3], v7 offset:11264
 v_mfma_f32_16x16x32_bf16 v[92:95], a[20:23], a[180:183], v[92:95]
 buffer_load_dwordx2 v[128:129], v11, s[48:51], s58 offen offset:96
 v_mfma_f32_16x16x32_bf16 v[56:59], a[24:27], a[176:179], v[56:59]
 ds_read_b128 a[4:7], v7 offset:12288
 v_mfma_f32_16x16x32_bf16 v[96:99], a[24:27], a[180:183], v[96:99]
 buffer_load_dwordx4 v14, s[4:7], s56 offen sc1 lds
 v_mfma_f32_16x16x32_bf16 v[60:63], a[28:31], a[176:179], v[60:63]
 ds_read_b128 a[8:11], v7 offset:13312
 v_mfma_f32_16x16x32_bf16 v[100:103], a[28:31], a[180:183], v[100:103]
 s_add_u32 m0, s74, 102400
 v_mfma_f32_16x16x32_bf16 v[64:67], a[32:35], a[176:179], v[64:67]
 ds_read_b128 a[12:15], v7 offset:14336
 v_mfma_f32_16x16x32_bf16 v[104:107], a[32:35], a[180:183], v[104:107]
 buffer_load_dwordx2 v[130:131], v11, s[48:51], s58 offen offset:128
 v_mfma_f32_16x16x32_bf16 v[68:71], a[36:39], a[176:179], v[68:71]
 ds_read_b128 a[16:19], v4 offset:20480
 s_add_u32 s56, s70, 40960
 v_mfma_f32_16x16x32_bf16 v[108:111], a[36:39], a[180:183], v[108:111]
 s_waitcnt lgkmcnt(5)
 v_mfma_f32_16x16x32_bf16 v[32:35], a[40:43], a[184:187], v[32:35]
 ds_read_b128 a[20:23], v4 offset:21504
 v_mfma_f32_16x16x32_bf16 v[72:75], a[40:43], a[188:191], v[72:75]
 buffer_load_dwordx4 v14, s[4:7], s56 offen offset:0 sc1 lds
 v_mfma_f32_16x16x32_bf16 v[36:39], a[44:47], a[184:187], v[36:39]
 ds_read_b128 a[24:27], v4 offset:22528
 v_mfma_f32_16x16x32_bf16 v[76:79], a[44:47], a[188:191], v[76:79]
 buffer_load_dwordx4 v14, s[4:7], s56 offen offset:1024 sc1 lds
 v_mfma_f32_16x16x32_bf16 v[40:43], a[48:51], a[184:187], v[40:43]
 ds_read_b128 a[28:31], v4 offset:23552
 v_mfma_f32_16x16x32_bf16 v[80:83], a[48:51], a[188:191], v[80:83]
 v_mfma_f32_16x16x32_bf16 v[44:47], a[52:55], a[184:187], v[44:47]
 ds_read_b128 a[32:35], v4 offset:24576
 v_mfma_f32_16x16x32_bf16 v[84:87], a[52:55], a[188:191], v[84:87]
 buffer_load_dwordx4 v14, s[4:7], s56 offen offset:2048 sc1 lds
 v_mfma_f32_16x16x32_bf16 v[48:51], a[56:59], a[184:187], v[48:51]
 ds_read_b128 a[36:39], v7 offset:20480
 v_mfma_f32_16x16x32_bf16 v[88:91], a[56:59], a[188:191], v[88:91]
 buffer_load_dwordx4 v14, s[4:7], s56 offen offset:3072 sc1 lds
 v_mfma_f32_16x16x32_bf16 v[52:55], a[60:63], a[184:187], v[52:55]
 ds_read_b128 a[40:43], v7 offset:21504
 v_mfma_f32_16x16x32_bf16 v[92:95], a[60:63], a[188:191], v[92:95]
 s_waitcnt lgkmcnt(5)
 v_mfma_f32_16x16x32_bf16 v[56:59], a[0:3], a[184:187], v[56:59]
 ds_read_b128 a[44:47], v7 offset:22528
 s_add_u32 m0, s74, 106496
 v_mfma_f32_16x16x32_bf16 v[96:99], a[0:3], a[188:191], v[96:99]
 v_mfma_f32_16x16x32_bf16 v[60:63], a[4:7], a[184:187], v[60:63]
 ds_read_b128 a[48:51], v7 offset:23552
 v_mfma_f32_16x16x32_bf16 v[100:103], a[4:7], a[188:191], v[100:103]
 s_add_u32 s56, s56, 4096
 v_mfma_f32_16x16x32_bf16 v[64:67], a[8:11], a[184:187], v[64:67]
 ds_read_b128 a[52:55], v7 offset:24576
 v_mfma_f32_16x16x32_bf16 v[104:107], a[8:11], a[188:191], v[104:107]
 buffer_load_dwordx4 v14, s[4:7], s56 offen sc1 lds
 v_mfma_f32_16x16x32_bf16 v[68:71], a[12:15], a[184:187], v[68:71]
 ds_read_b128 a[56:59], v4 offset:30720
 v_mfma_f32_16x16x32_bf16 v[108:111], a[12:15], a[188:191], v[108:111]
 v_mfma_f32_16x16x32_bf16 v[32:35], a[16:19], a[192:195], v[32:35]
 ds_read_b128 a[60:63], v4 offset:31744
 v_mfma_f32_16x16x32_bf16 v[72:75], a[16:19], a[196:199], v[72:75]
 s_waitcnt vmcnt(12)
 v_cmp_ne_u32 vcc, s98, v15
 s_cbranch_vccnz P_parall_19
PB_parall_20:
 v_mfma_f32_16x16x32_bf16 v[36:39], a[20:23], a[192:195], v[36:39]
 s_add_u32 m0, s74, 122880
 s_add_u32 s59, s72, 0
 v_mfma_f32_16x16x32_bf16 v[76:79], a[20:23], a[196:199], v[76:79]
 ds_read_b128 a[0:3], v4 offset:32768
 s_waitcnt lgkmcnt(4)
 v_mfma_f32_16x16x32_bf16 v[40:43], a[24:27], a[192:195], v[40:43]
 buffer_load_dwordx4 a[240:243], v2, s[4:7], s59 offen offset:0 sc1
 v_mfma_f32_16x16x32_bf16 v[80:83], a[24:27], a[196:199], v[80:83]
 s_add_u32 s56, s70, 61440
 ds_read_b128 a[4:7], v4 offset:33792
 v_mfma_f32_16x16x32_bf16 v[44:47], a[28:31], a[192:195], v[44:47]
 buffer_load_dwordx4 a[244:247], v3, s[4:7], s59 offen offset:0 sc1
 v_mfma_f32_16x16x32_bf16 v[84:87], a[28:31], a[196:199], v[84:87]
 ds_read_b128 a[8:11], v4 offset:34816
 v_mfma_f32_16x16x32_bf16 v[48:51], a[32:35], a[192:195], v[48:51]
 buffer_load_dwordx4 v14, s[4:7], s56 offen offset:0 sc1 lds
 v_mfma_f32_16x16x32_bf16 v[88:91], a[32:35], a[196:199], v[88:91]
 buffer_load_dwordx4 a[248:251], v2, s[4:7], s59 offen offset:1024 sc1
 v_mfma_f32_16x16x32_bf16 v[52:55], a[36:39], a[192:195], v[52:55]
 ds_read_b128 a[12:15], v7 offset:30720
 v_mfma_f32_16x16x32_bf16 v[92:95], a[36:39], a[196:199], v[92:95]
 buffer_load_dwordx4 v14, s[4:7], s56 offen offset:1024 sc1 lds
 v_mfma_f32_16x16x32_bf16 v[56:59], a[40:43], a[192:195], v[56:59]
 buffer_load_dwordx4 a[252:255], v3, s[4:7], s59 offen offset:1024 sc1
 v_mfma_f32_16x16x32_bf16 v[96:99], a[40:43], a[196:199], v[96:99]
 ds_read_b128 a[16:19], v7 offset:31744
 v_mfma_f32_16x16x32_bf16 v[60:63], a[44:47], a[192:195], v[60:63]
 buffer_load_dwordx4 v14, s[4:7], s56 offen offset:2048 sc1 lds
 v_mfma_f32_16x16x32_bf16 v[100:103], a[44:47], a[196:199], v[100:103]
 ds_read_b128 a[20:23], v7 offset:32768
 s_add_u32 s59, s72, 2048
 v_mfma_f32_16x16x32_bf16 v[64:67], a[48:51], a[192:195], v[64:67]
 ds_read_b128 a[24:27], v7 offset:33792
 v_mfma_f32_16x16x32_bf16 v[104:107], a[48:51], a[196:199], v[104:107]
 s_waitcnt lgkmcnt(4)
 v_mfma_f32_16x16x32_bf16 v[68:71], a[52:55], a[192:195], v[68:71]
 buffer_load_dwordx4 v14, s[4:7], s56 offen offset:3072 sc1 lds
 v_mfma_f32_16x16x32_bf16 v[108:111], a[52:55], a[196:199], v[108:111]
 buffer_load_dwordx4 a[176:179], v2, s[4:7], s59 offen offset:0 sc1
 v_mfma_f32_16x16x32_bf16 v[32:35], a[56:59], a[200:203], v[32:35]
 ds_read_b128 a[28:31], v7 offset:34816
 v_mfma_f32_16x16x32_bf16 v[72:75], a[56:59], a[204:207], v[72:75]
 buffer_load_dwordx4 a[180:183], v3, s[4:7], s59 offen offset:0 sc1
 v_mfma_f32_16x16x32_bf16 v[36:39], a[60:63], a[200:203], v[36:39]
 s_add_u32 m0, s74, 126976
 v_mfma_f32_16x16x32_bf16 v[76:79], a[60:63], a[204:207], v[76:79]
 buffer_load_dwordx4 a[184:187], v2, s[4:7], s59 offen offset:1024 sc1
 v_mfma_f32_16x16x32_bf16 v[40:43], a[0:3], a[200:203], v[40:43]
 s_add_u32 s56, s56, 4096
 v_mfma_f32_16x16x32_bf16 v[80:83], a[0:3], a[204:207], v[80:83]
 buffer_load_dwordx4 a[188:191], v3, s[4:7], s59 offen offset:1024 sc1
 v_mfma_f32_16x16x32_bf16 v[44:47], a[4:7], a[200:203], v[44:47]
 buffer_load_dwordx4 v14, s[4:7], s56 offen sc1 lds
 v_mfma_f32_16x16x32_bf16 v[84:87], a[4:7], a[204:207], v[84:87]
 v_mfma_f32_16x16x32_bf16 v[48:51], a[8:11], a[200:203], v[48:51]
 s_waitcnt lgkmcnt(0)
 s_barrier
 v_mfma_f32_16x16x32_bf16 v[88:91], a[8:11], a[204:207], v[88:91]
 ds_read_b128 a[32:35], v4 offset:40960
 ds_read_b128 a[36:39], v4 offset:41984
 v_mfma_f32_16x16x32_bf16 v[52:55], a[12:15], a[200:203], v[52:55]
 ds_read_b128 a[40:43], v4 offset:43008
 ds_read_b128 a[44:47], v4 offset:44032
 v_mfma_f32_16x16x32_bf16 v[92:95], a[12:15], a[204:207], v[92:95]
 s_add_u32 m0, s74, 0
 ds_read_b128 a[48:51], v4 offset:45056
 v_mfma_f32_16x16x32_bf16 v[56:59], a[16:19], a[200:203], v[56:59]
 ds_read_b128 a[52:55], v7 offset:40960
 ds_read_b128 a[56:59], v7 offset:41984
 v_mfma_f32_16x16x32_bf16 v[96:99], a[16:19], a[204:207], v[96:99]
 ds_read_b128 a[60:63], v7 offset:43008
 s_add_u32 s56, s70, 81920
 v_mfma_f32_16x16x32_bf16 v[60:63], a[20:23], a[200:203], v[60:63]
 ds_read_b128 a[0:3], v7 offset:44032
 v_mfma_f32_16x16x32_bf16 v[100:103], a[20:23], a[204:207], v[100:103]
 v_mfma_f32_16x16x32_bf16 v[64:67], a[24:27], a[200:203], v[64:67]
 ds_read_b128 a[4:7], v7 offset:45056
 v_mfma_f32_16x16x32_bf16 v[104:107], a[24:27], a[204:207], v[104:107]
 buffer_load_dwordx4 v14, s[4:7], s56 offen offset:0 sc1 lds
 v_mfma_f32_16x16x32_bf16 v[68:71], a[28:31], a[200:203], v[68:71]
 ds_read_b128 a[8:11], v4 offset:51200
 v_mfma_f32_16x16x32_bf16 v[108:111], a[28:31], a[204:207], v[108:111]
 s_waitcnt lgkmcnt(10)
 v_mfma_f32_16x16x32_bf16 v[32:35], a[32:35], a[208:211], v[32:35]
 ds_read_b128 a[12:15], v4 offset:52224
 v_mfma_f32_16x16x32_bf16 v[72:75], a[32:35], a[212:215], v[72:75]
 s_add_u32 s59, s72, 4096
 s_waitcnt lgkmcnt(8)
 v_mfma_f32_16x16x32_bf16 v[36:39], a[36:39], a[208:211], v[36:39]
 buffer_load_dwordx4 v14, s[4:7], s56 offen offset:1024 sc1 lds
 v_mfma_f32_16x16x32_bf16 v[76:79], a[36:39], a[212:215], v[76:79]
 ds_read_b128 a[16:19], v4 offset:53248
 v_mfma_f32_16x16x32_bf16 v[40:43], a[40:43], a[208:211], v[40:43]
 ds_read_b128 a[20:23], v4 offset:54272
 v_mfma_f32_16x16x32_bf16 v[80:83], a[40:43], a[212:215], v[80:83]
 buffer_load_dwordx4 v14, s[4:7], s56 offen offset:2048 sc1 lds
 v_mfma_f32_16x16x32_bf16 v[44:47], a[44:47], a[208:211], v[44:47]
 ds_read_b128 a[24:27], v4 offset:55296
 v_mfma_f32_16x16x32_bf16 v[84:87], a[44:47], a[212:215], v[84:87]
 s_waitcnt lgkmcnt(5)
 v_mfma_f32_16x16x32_bf16 v[48:51], a[48:51], a[208:211], v[48:51]
 buffer_load_dwordx4 a[192:195], v2, s[4:7], s59 offen offset:0 sc1
 v_mfma_f32_16x16x32_bf16 v[88:91], a[48:51], a[212:215], v[88:91]
 ds_read_b128 a[28:31], v7 offset:51200
 v_mfma_f32_16x16x32_bf16 v[52:55], a[52:55], a[208:211], v[52:55]
 buffer_load_dwordx4 v14, s[4:7], s56 offen offset:3072 sc1 lds
 v_mfma_f32_16x16x32_bf16 v[92:95], a[52:55], a[212:215], v[92:95]
 ds_read_b128 a[32:35], v7 offset:52224
 v_mfma_f32_16x16x32_bf16 v[56:59], a[56:59], a[208:211], v[56:59]
 buffer_load_dwordx4 a[196:199], v3, s[4:7], s59 offen offset:0 sc1
 v_mfma_f32_16x16x32_bf16 v[96:99], a[56:59], a[212:215], v[96:99]
 ds_read_b128 a[36:39], v7 offset:53248
 s_add_u32 m0, s74, 4096
 v_mfma_f32_16x16x32_bf16 v[60:63], a[60:63], a[208:211], v[60:63]
 ds_read_b128 a[40:43], v7 offset:54272
 v_mfma_f32_16x16x32_bf16 v[100:103], a[60:63], a[212:215], v[100:103]
 v_mfma_f32_16x16x32_bf16 v[64:67], a[0:3], a[208:211], v[64:67]
 ds_read_b128 a[44:47], v7 offset:55296
 v_mfma_f32_16x16x32_bf16 v[104:107], a[0:3], a[212:215], v[104:107]
 buffer_load_dwordx4 a[200:203], v2, s[4:7], s59 offen offset:1024 sc1
 v_mfma_f32_16x16x32_bf16 v[68:71], a[4:7], a[208:211], v[68:71]
 s_add_u32 s56, s56, 4096
 ds_read_b128 a[48:51], v5 offset:0
 v_mfma_f32_16x16x32_bf16 v[108:111], a[4:7], a[212:215], v[108:111]
 s_waitcnt lgkmcnt(5)
 v_mfma_f32_16x16x32_bf16 v[32:35], a[8:11], a[216:219], v[32:35]
 ds_read_b128 a[52:55], v5 offset:1024
 v_mfma_f32_16x16x32_bf16 v[72:75], a[8:11], a[220:223], v[72:75]
 buffer_load_dwordx4 v14, s[4:7], s56 offen sc1 lds
 v_mfma_f32_16x16x32_bf16 v[36:39], a[12:15], a[216:219], v[36:39]
 ds_read_b128 a[56:59], v5 offset:2048
 v_mfma_f32_16x16x32_bf16 v[76:79], a[12:15], a[220:223], v[76:79]
 buffer_load_dwordx4 a[204:207], v3, s[4:7], s59 offen offset:1024 sc1
 v_mfma_f32_16x16x32_bf16 v[40:43], a[16:19], a[216:219], v[40:43]
 ds_read_b128 a[60:63], v5 offset:3072
 v_mfma_f32_16x16x32_bf16 v[80:83], a[16:19], a[220:223], v[80:83]
 s_add_u32 m0, s74, 20480
 v_mfma_f32_16x16x32_bf16 v[44:47], a[20:23], a[216:219], v[44:47]
 ds_read_b128 a[0:3], v5 offset:4096
 v_mfma_f32_16x16x32_bf16 v[84:87], a[20:23], a[220:223], v[84:87]
 v_mfma_f32_16x16x32_bf16 v[48:51], a[24:27], a[216:219], v[48:51]
 ds_read_b128 a[4:7], v8 offset:0
 s_add_u32 s56, s70, 102400
 v_mfma_f32_16x16x32_bf16 v[88:91], a[24:27], a[220:223], v[88:91]
 v_mfma_f32_16x16x32_bf16 v[52:55], a[28:31], a[216:219], v[52:55]
 ds_read_b128 a[8:11], v8 offset:1024
 v_mfma_f32_16x16x32_bf16 v[92:95], a[28:31], a[220:223], v[92:95]
 s_waitcnt lgkmcnt(5)
 v_mfma_f32_16x16x32_bf16 v[56:59], a[32:35], a[216:219], v[56:59]
 ds_read_b128 a[12:15], v8 offset:2048
 v_mfma_f32_16x16x32_bf16 v[96:99], a[32:35], a[220:223], v[96:99]
 buffer_load_dwordx4 v14, s[4:7], s56 offen offset:0 sc1 lds
 v_mfma_f32_16x16x32_bf16 v[60:63], a[36:39], a[216:219], v[60:63]
 ds_read_b128 a[16:19], v8 offset:3072
 v_mfma_f32_16x16x32_bf16 v[100:103], a[36:39], a[220:223], v[100:103]
 v_mfma_f32_16x16x32_bf16 v[64:67], a[40:43], a[216:219], v[64:67]
 ds_read_b128 a[20:23], v8 offset:4096
 v_mfma_f32_16x16x32_bf16 v[104:107], a[40:43], a[220:223], v[104:107]
 buffer_load_dwordx4 v14, s[4:7], s56 offen offset:1024 sc1 lds
 v_mfma_f32_16x16x32_bf16 v[68:71], a[44:47], a[216:219], v[68:71]
 ds_read_b128 a[24:27], v5 offset:10240
 v_mfma_f32_16x16x32_bf16 v[108:111], a[44:47], a[220:223], v[108:111]
 v_mfma_f32_16x16x32_bf16 v[32:35], a[48:51], a[224:227], v[32:35]
 ds_read_b128 a[28:31], v5 offset:11264
 v_mfma_f32_16x16x32_bf16 v[72:75], a[48:51], a[228:231], v[72:75]
 buffer_load_dwordx4 v14, s[4:7], s56 offen offset:2048 sc1 lds
 v_mfma_f32_16x16x32_bf16 v[36:39], a[52:55], a[224:227], v[36:39]
 s_add_u32 s59, s72, 6144
 ds_read_b128 a[32:35], v5 offset:12288
 v_mfma_f32_16x16x32_bf16 v[76:79], a[52:55], a[228:231], v[76:79]
 s_waitcnt lgkmcnt(5)
 v_mfma_f32_16x16x32_bf16 v[40:43], a[56:59], a[224:227], v[40:43]
 ds_read_b128 a[36:39], v5 offset:13312
 v_mfma_f32_16x16x32_bf16 v[80:83], a[56:59], a[228:231], v[80:83]
 buffer_load_dwordx4 v14, s[4:7], s56 offen offset:3072 sc1 lds
 v_mfma_f32_16x16x32_bf16 v[44:47], a[60:63], a[224:227], v[44:47]
 ds_read_b128 a[40:43], v5 offset:14336
 v_mfma_f32_16x16x32_bf16 v[84:87], a[60:63], a[228:231], v[84:87]
 buffer_load_dwordx4 a[208:211], v2, s[4:7], s59 offen offset:0 sc1
 v_mfma_f32_16x16x32_bf16 v[48:51], a[0:3], a[224:227], v[48:51]
 ds_read_b128 a[44:47], v8 offset:10240
 s_add_u32 m0, s74, 24576
 v_mfma_f32_16x16x32_bf16 v[88:91], a[0:3], a[228:231], v[88:91]
 v_mfma_f32_16x16x32_bf16 v[52:55], a[4:7], a[224:227], v[52:55]
 ds_read_b128 a[48:51], v8 offset:11264
 v_mfma_f32_16x16x32_bf16 v[92:95], a[4:7], a[228:231], v[92:95]
 buffer_load_dwordx4 a[212:215], v3, s[4:7], s59 offen offset:0 sc1
 v_mfma_f32_16x16x32_bf16 v[56:59], a[8:11], a[224:227], v[56:59]
 ds_read_b128 a[52:55], v8 offset:12288
 s_add_u32 s56, s56, 4096
 v_mfma_f32_16x16x32_bf16 v[96:99], a[8:11], a[228:231], v[96:99]
 v_mfma_f32_16x16x32_bf16 v[60:63], a[12:15], a[224:227], v[60:63]
 ds_read_b128 a[56:59], v8 offset:13312
 v_mfma_f32_16x16x32_bf16 v[100:103], a[12:15], a[228:231], v[100:103]
 s_waitcnt lgkmcnt(5)
 v_mfma_f32_16x16x32_bf16 v[64:67], a[16:19], a[224:227], v[64:67]
 ds_read_b128 a[60:63], v8 offset:14336
 v_mfma_f32_16x16x32_bf16 v[104:107], a[16:19], a[228:231], v[104:107]
 buffer_load_dwordx4 v14, s[4:7], s56 offen sc1 lds
 v_mfma_f32_16x16x32_bf16 v[68:71], a[20:23], a[224:227], v[68:71]
 buffer_load_dwordx4 a[216:219], v2, s[4:7], s59 offen offset:1024 sc1
 v_mfma_f32_16x16x32_bf16 v[108:111], a[20:23], a[228:231], v[108:111]
 v_mfma_f32_16x16x32_bf16 v[32:35], a[24:27], a[232:235], v[32:35]
 v_mfma_f32_16x16x32_bf16 v[72:75], a[24:27], a[236:239], v[72:75]
 v_mfma_f32_16x16x32_bf16 v[36:39], a[28:31], a[232:235], v[36:39]
 buffer_load_dwordx4 a[220:223], v3, s[4:7], s59 offen offset:1024 sc1
 v_mfma_f32_16x16x32_bf16 v[76:79], a[28:31], a[236:239], v[76:79]
 v_mfma_f32_16x16x32_bf16 v[40:43], a[32:35], a[232:235], v[40:43]
 v_mfma_f32_16x16x32_bf16 v[80:83], a[32:35], a[236:239], v[80:83]
 v_mfma_f32_16x16x32_bf16 v[44:47], a[36:39], a[232:235], v[44:47]
 v_mfma_f32_16x16x32_bf16 v[84:87], a[36:39], a[236:239], v[84:87]
 s_waitcnt lgkmcnt(0)
 v_mfma_f32_16x16x32_bf16 v[48:51], a[40:43], a[232:235], v[48:51]
 s_waitcnt vmcnt(37)
 s_waitcnt lgkmcnt(0)
 s_barrier
 v_mfma_f32_16x16x32_bf16 v[88:91], a[40:43], a[236:239], v[88:91]
 ds_read_b128 a[0:3], v6 offset:20480
 ds_read_b128 a[4:7], v6 offset:21504
 v_mfma_f32_16x16x32_bf16 v[52:55], a[44:47], a[232:235], v[52:55]
 ds_read_b128 a[8:11], v6 offset:22528
 ds_read_b128 a[12:15], v6 offset:23552
 v_mfma_f32_16x16x32_bf16 v[92:95], a[44:47], a[236:239], v[92:95]
 s_add_u32 m0, s74, 40960
 ds_read_b128 a[16:19], v6 offset:24576
 v_mfma_f32_16x16x32_bf16 v[56:59], a[48:51], a[232:235], v[56:59]
 ds_read_b128 a[20:23], v9 offset:20480
 ds_read_b128 a[24:27], v9 offset:21504
 v_mfma_f32_16x16x32_bf16 v[96:99], a[48:51], a[236:239], v[96:99]
 ds_read_b128 a[28:31], v9 offset:22528
 s_add_u32 s56, s70, 122880
 v_mfma_f32_16x16x32_bf16 v[60:63], a[52:55], a[232:235], v[60:63]
 ds_read_b128 a[32:35], v9 offset:23552
 v_mfma_f32_16x16x32_bf16 v[100:103], a[52:55], a[236:239], v[100:103]
 v_mfma_f32_16x16x32_bf16 v[64:67], a[56:59], a[232:235], v[64:67]
 ds_read_b128 a[36:39], v9 offset:24576
 v_mfma_f32_16x16x32_bf16 v[104:107], a[56:59], a[236:239], v[104:107]
 buffer_load_dwordx4 v14, s[4:7], s56 offen offset:0 sc1 lds
 v_mfma_f32_16x16x32_bf16 v[68:71], a[60:63], a[232:235], v[68:71]
 ds_read_b128 a[40:43], v6 offset:30720
 v_mfma_f32_16x16x32_bf16 v[108:111], a[60:63], a[236:239], v[108:111]
 s_waitcnt lgkmcnt(10) vmcnt(31)
 v_mfma_f32_16x16x32_bf16 v[32:35], a[0:3], a[240:243], v[32:35]
 ds_read_b128 a[44:47], v6 offset:31744
 s_waitcnt vmcnt(30)
 v_mfma_f32_16x16x32_bf16 v[72:75], a[0:3], a[244:247], v[72:75]
 s_add_u32 s59, s72, 8192
 s_waitcnt lgkmcnt(8)
 v_mfma_f32_16x16x32_bf16 v[36:39], a[4:7], a[240:243], v[36:39]
 buffer_load_dwordx4 v14, s[4:7], s56 offen offset:1024 sc1 lds
 v_mfma_f32_16x16x32_bf16 v[76:79], a[4:7], a[244:247], v[76:79]
 ds_read_b128 a[48:51], v6 offset:32768
 v_mfma_f32_16x16x32_bf16 v[40:43], a[8:11], a[240:243], v[40:43]
 ds_read_b128 a[52:55], v6 offset:33792
 v_mfma_f32_16x16x32_bf16 v[80:83], a[8:11], a[244:247], v[80:83]
 buffer_load_dwordx4 v14, s[4:7], s56 offen offset:2048 sc1 lds
 v_mfma_f32_16x16x32_bf16 v[44:47], a[12:15], a[240:243], v[44:47]
 ds_read_b128 a[56:59], v6 offset:34816
 v_mfma_f32_16x16x32_bf16 v[84:87], a[12:15], a[244:247], v[84:87]
 s_waitcnt lgkmcnt(5)
 v_mfma_f32_16x16x32_bf16 v[48:51], a[16:19], a[240:243], v[48:51]
 buffer_load_dwordx4 a[224:227], v2, s[4:7], s59 offen offset:0 sc1
 v_mfma_f32_16x16x32_bf16 v[88:91], a[16:19], a[244:247], v[88:91]
 ds_read_b128 a[60:63], v9 offset:30720
 v_mfma_f32_16x16x32_bf16 v[52:55], a[20:23], a[240:243], v[52:55]
 buffer_load_dwordx4 v14, s[4:7], s56 offen offset:3072 sc1 lds
 v_mfma_f32_16x16x32_bf16 v[92:95], a[20:23], a[244:247], v[92:95]
 ds_read_b128 a[0:3], v9 offset:31744
 v_mfma_f32_16x16x32_bf16 v[56:59], a[24:27], a[240:243], v[56:59]
 buffer_load_dwordx4 a[228:231], v3, s[4:7], s59 offen offset:0 sc1
 v_mfma_f32_16x16x32_bf16 v[96:99], a[24:27], a[244:247], v[96:99]
 ds_read_b128 a[4:7], v9 offset:32768
 s_add_u32 m0, s74, 45056
 v_mfma_f32_16x16x32_bf16 v[60:63], a[28:31], a[240:243], v[60:63]
 ds_read_b128 a[8:11], v9 offset:33792
 v_mfma_f32_16x16x32_bf16 v[100:103], a[28:31], a[244:247], v[100:103]
 v_mfma_f32_16x16x32_bf16 v[64:67], a[32:35], a[240:243], v[64:67]
 ds_read_b128 a[12:15], v9 offset:34816
 v_mfma_f32_16x16x32_bf16 v[104:107], a[32:35], a[244:247], v[104:107]
 buffer_load_dwordx4 a[232:235], v2, s[4:7], s59 offen offset:1024 sc1
 v_mfma_f32_16x16x32_bf16 v[68:71], a[36:39], a[240:243], v[68:71]
 s_add_u32 s56, s56, 4096
 ds_read_b128 a[16:19], v5 offset:20480
 v_mfma_f32_16x16x32_bf16 v[108:111], a[36:39], a[244:247], v[108:111]
 s_waitcnt lgkmcnt(5) vmcnt(34)
 v_mfma_f32_16x16x32_bf16 v[32:35], a[40:43], a[248:251], v[32:35]
 ds_read_b128 a[20:23], v5 offset:21504
 s_waitcnt vmcnt(32)
 v_mfma_f32_16x16x32_bf16 v[72:75], a[40:43], a[252:255], v[72:75]
 buffer_load_dwordx4 v14, s[4:7], s56 offen sc1 lds
 v_mfma_f32_16x16x32_bf16 v[36:39], a[44:47], a[248:251], v[36:39]
 ds_read_b128 a[24:27], v5 offset:22528
 v_mfma_f32_16x16x32_bf16 v[76:79], a[44:47], a[252:255], v[76:79]
 buffer_load_dwordx4 a[236:239], v3, s[4:7], s59 offen offset:1024 sc1
 v_mfma_f32_16x16x32_bf16 v[40:43], a[48:51], a[248:251], v[40:43]
 ds_read_b128 a[28:31], v5 offset:23552
 v_mfma_f32_16x16x32_bf16 v[80:83], a[48:51], a[252:255], v[80:83]
 s_add_u32 m0, s74, 61440
 v_mfma_f32_16x16x32_bf16 v[44:47], a[52:55], a[248:251], v[44:47]
 ds_read_b128 a[32:35], v5 offset:24576
 v_mfma_f32_16x16x32_bf16 v[84:87], a[52:55], a[252:255], v[84:87]
 v_mfma_f32_16x16x32_bf16 v[48:51], a[56:59], a[248:251], v[48:51]
 ds_read_b128 a[36:39], v8 offset:20480
 s_add_u32 s56, s70, 143360
 v_mfma_f32_16x16x32_bf16 v[88:91], a[56:59], a[252:255], v[88:91]
 v_mfma_f32_16x16x32_bf16 v[52:55], a[60:63], a[248:251], v[52:55]
 ds_read_b128 a[40:43], v8 offset:21504
 v_mfma_f32_16x16x32_bf16 v[92:95], a[60:63], a[252:255], v[92:95]
 s_waitcnt lgkmcnt(5)
 v_mfma_f32_16x16x32_bf16 v[56:59], a[0:3], a[248:251], v[56:59]
 ds_read_b128 a[44:47], v8 offset:22528
 v_mfma_f32_16x16x32_bf16 v[96:99], a[0:3], a[252:255], v[96:99]
 buffer_load_dwordx4 v14, s[4:7], s56 offen offset:0 sc1 lds
 v_mfma_f32_16x16x32_bf16 v[60:63], a[4:7], a[248:251], v[60:63]
 ds_read_b128 a[48:51], v8 offset:23552
 v_mfma_f32_16x16x32_bf16 v[100:103], a[4:7], a[252:255], v[100:103]
 v_mfma_f32_16x16x32_bf16 v[64:67], a[8:11], a[248:251], v[64:67]
 ds_read_b128 a[52:55], v8 offset:24576
 v_mfma_f32_16x16x32_bf16 v[104:107], a[8:11], a[252:255], v[104:107]
 buffer_load_dwordx4 v14, s[4:7], s56 offen offset:1024 sc1 lds
 v_mfma_f32_16x16x32_bf16 v[68:71], a[12:15], a[248:251], v[68:71]
 ds_read_b128 a[56:59], v5 offset:30720
 v_mfma_f32_16x16x32_bf16 v[108:111], a[12:15], a[252:255], v[108:111]
 s_waitcnt vmcnt(33)
 v_mfma_f32_16x16x32_bf16 v[32:35], a[16:19], a[176:179], v[32:35]
 ds_read_b128 a[60:63], v5 offset:31744
 s_waitcnt vmcnt(32)
 v_mfma_f32_16x16x32_bf16 v[72:75], a[16:19], a[180:183], v[72:75]
 buffer_load_dwordx4 v14, s[4:7], s56 offen offset:2048 sc1 lds
 v_mfma_f32_16x16x32_bf16 v[36:39], a[20:23], a[176:179], v[36:39]
 s_add_u32 s59, s72, 10240
 ds_read_b128 a[0:3], v5 offset:32768
 v_mfma_f32_16x16x32_bf16 v[76:79], a[20:23], a[180:183], v[76:79]
 s_waitcnt lgkmcnt(5)
 v_mfma_f32_16x16x32_bf16 v[40:43], a[24:27], a[176:179], v[40:43]
 ds_read_b128 a[4:7], v5 offset:33792
 v_mfma_f32_16x16x32_bf16 v[80:83], a[24:27], a[180:183], v[80:83]
 buffer_load_dwordx4 v14, s[4:7], s56 offen offset:3072 sc1 lds
 v_mfma_f32_16x16x32_bf16 v[44:47], a[28:31], a[176:179], v[44:47]
 ds_read_b128 a[8:11], v5 offset:34816
 v_mfma_f32_16x16x32_bf16 v[84:87], a[28:31], a[180:183], v[84:87]
 buffer_load_dwordx4 a[240:243], v2, s[4:7], s59 offen offset:0 sc1
 v_mfma_f32_16x16x32_bf16 v[48:51], a[32:35], a[176:179], v[48:51]
 ds_read_b128 a[12:15], v8 offset:30720
 s_add_u32 m0, s74, 65536
 v_mfma_f32_16x16x32_bf16 v[88:91], a[32:35], a[180:183], v[88:91]
 v_mfma_f32_16x16x32_bf16 v[52:55], a[36:39], a[176:179], v[52:55]
 ds_read_b128 a[16:19], v8 offset:31744
 v_mfma_f32_16x16x32_bf16 v[92:95], a[36:39], a[180:183], v[92:95]
 buffer_load_dwordx4 a[244:247], v3, s[4:7], s59 offen offset:0 sc1
 v_mfma_f32_16x16x32_bf16 v[56:59], a[40:43], a[176:179], v[56:59]
 ds_read_b128 a[20:23], v8 offset:32768
 s_add_u32 s56, s56, 4096
 v_mfma_f32_16x16x32_bf16 v[96:99], a[40:43], a[180:183], v[96:99]
 v_mfma_f32_16x16x32_bf16 v[60:63], a[44:47], a[176:179], v[60:63]
 ds_read_b128 a[24:27], v8 offset:33792
 v_mfma_f32_16x16x32_bf16 v[100:103], a[44:47], a[180:183], v[100:103]
 s_waitcnt lgkmcnt(5)
 v_mfma_f32_16x16x32_bf16 v[64:67], a[48:51], a[176:179], v[64:67]
 ds_read_b128 a[28:31], v8 offset:34816
 v_mfma_f32_16x16x32_bf16 v[104:107], a[48:51], a[180:183], v[104:107]
 buffer_load_dwordx4 v14, s[4:7], s56 offen sc1 lds
 v_mfma_f32_16x16x32_bf16 v[68:71], a[52:55], a[176:179], v[68:71]
 buffer_load_dwordx4 a[248:251], v2, s[4:7], s59 offen offset:1024 sc1
 v_mfma_f32_16x16x32_bf16 v[108:111], a[52:55], a[180:183], v[108:111]
 s_waitcnt vmcnt(37)
 v_mfma_f32_16x16x32_bf16 v[32:35], a[56:59], a[184:187], v[32:35]
 s_waitcnt vmcnt(36)
 v_mfma_f32_16x16x32_bf16 v[72:75], a[56:59], a[188:191], v[72:75]
 v_mfma_f32_16x16x32_bf16 v[36:39], a[60:63], a[184:187], v[36:39]
 buffer_load_dwordx4 a[252:255], v3, s[4:7], s59 offen offset:1024 sc1
 v_mfma_f32_16x16x32_bf16 v[76:79], a[60:63], a[188:191], v[76:79]
 v_mfma_f32_16x16x32_bf16 v[40:43], a[0:3], a[184:187], v[40:43]
 v_mfma_f32_16x16x32_bf16 v[80:83], a[0:3], a[188:191], v[80:83]
 v_mfma_f32_16x16x32_bf16 v[44:47], a[4:7], a[184:187], v[44:47]
 v_mfma_f32_16x16x32_bf16 v[84:87], a[4:7], a[188:191], v[84:87]
 s_waitcnt lgkmcnt(0)
 v_mfma_f32_16x16x32_bf16 v[48:51], a[8:11], a[184:187], v[48:51]
 s_waitcnt vmcnt(36)
 s_waitcnt lgkmcnt(0)
 s_barrier
 v_mfma_f32_16x16x32_bf16 v[88:91], a[8:11], a[188:191], v[88:91]
 ds_read_b128 a[32:35], v5 offset:40960
 ds_read_b128 a[36:39], v5 offset:41984
 v_mfma_f32_16x16x32_bf16 v[52:55], a[12:15], a[184:187], v[52:55]
 ds_read_b128 a[40:43], v5 offset:43008
 ds_read_b128 a[44:47], v5 offset:44032
 v_mfma_f32_16x16x32_bf16 v[92:95], a[12:15], a[188:191], v[92:95]
 s_add_u32 m0, s74, 143360
 ds_read_b128 a[48:51], v5 offset:45056
 v_mfma_f32_16x16x32_bf16 v[56:59], a[16:19], a[184:187], v[56:59]
 ds_read_b128 a[52:55], v8 offset:40960
 ds_read_b128 a[56:59], v8 offset:41984
 v_mfma_f32_16x16x32_bf16 v[96:99], a[16:19], a[188:191], v[96:99]
 ds_read_b128 a[60:63], v8 offset:43008
 s_add_u32 s56, s70, 163840
 v_mfma_f32_16x16x32_bf16 v[60:63], a[20:23], a[184:187], v[60:63]
 ds_read_b128 a[0:3], v8 offset:44032
 v_mfma_f32_16x16x32_bf16 v[100:103], a[20:23], a[188:191], v[100:103]
 v_mfma_f32_16x16x32_bf16 v[64:67], a[24:27], a[184:187], v[64:67]
 ds_read_b128 a[4:7], v8 offset:45056
 v_mfma_f32_16x16x32_bf16 v[104:107], a[24:27], a[188:191], v[104:107]
 buffer_load_dwordx4 v14, s[4:7], s56 offen offset:0 sc1 lds
 v_mfma_f32_16x16x32_bf16 v[68:71], a[28:31], a[184:187], v[68:71]
 ds_read_b128 a[8:11], v5 offset:51200
 v_mfma_f32_16x16x32_bf16 v[108:111], a[28:31], a[188:191], v[108:111]
 s_waitcnt lgkmcnt(10) vmcnt(33)
 v_mfma_f32_16x16x32_bf16 v[32:35], a[32:35], a[192:195], v[32:35]
 ds_read_b128 a[12:15], v5 offset:52224
 s_waitcnt vmcnt(31)
 v_mfma_f32_16x16x32_bf16 v[72:75], a[32:35], a[196:199], v[72:75]
 s_add_u32 s59, s72, 12288
 s_waitcnt lgkmcnt(8)
 v_mfma_f32_16x16x32_bf16 v[36:39], a[36:39], a[192:195], v[36:39]
 buffer_load_dwordx4 v14, s[4:7], s56 offen offset:1024 sc1 lds
 v_mfma_f32_16x16x32_bf16 v[76:79], a[36:39], a[196:199], v[76:79]
 ds_read_b128 a[16:19], v5 offset:53248
 v_mfma_f32_16x16x32_bf16 v[40:43], a[40:43], a[192:195], v[40:43]
 ds_read_b128 a[20:23], v5 offset:54272
 v_mfma_f32_16x16x32_bf16 v[80:83], a[40:43], a[196:199], v[80:83]
 buffer_load_dwordx4 v14, s[4:7], s56 offen offset:2048 sc1 lds
 v_mfma_f32_16x16x32_bf16 v[44:47], a[44:47], a[192:195], v[44:47]
 ds_read_b128 a[24:27], v5 offset:55296
 v_mfma_f32_16x16x32_bf16 v[84:87], a[44:47], a[196:199], v[84:87]
 s_waitcnt lgkmcnt(5)
 v_mfma_f32_16x16x32_bf16 v[48:51], a[48:51], a[192:195], v[48:51]
 buffer_load_dwordx4 a[176:179], v2, s[4:7], s59 offen offset:0 sc1
 v_mfma_f32_16x16x32_bf16 v[88:91], a[48:51], a[196:199], v[88:91]
 ds_read_b128 a[28:31], v8 offset:51200
 v_mfma_f32_16x16x32_bf16 v[52:55], a[52:55], a[192:195], v[52:55]
 buffer_load_dwordx4 v14, s[4:7], s56 offen offset:3072 sc1 lds
 v_mfma_f32_16x16x32_bf16 v[92:95], a[52:55], a[196:199], v[92:95]
 ds_read_b128 a[32:35], v8 offset:52224
 v_mfma_f32_16x16x32_bf16 v[56:59], a[56:59], a[192:195], v[56:59]
 buffer_load_dwordx4 a[180:183], v3, s[4:7], s59 offen offset:0 sc1
 v_mfma_f32_16x16x32_bf16 v[96:99], a[56:59], a[196:199], v[96:99]
 ds_read_b128 a[36:39], v8 offset:53248
 s_add_u32 m0, s74, 147456
 v_mfma_f32_16x16x32_bf16 v[60:63], a[60:63], a[192:195], v[60:63]
 ds_read_b128 a[40:43], v8 offset:54272
 v_mfma_f32_16x16x32_bf16 v[100:103], a[60:63], a[196:199], v[100:103]
 v_mfma_f32_16x16x32_bf16 v[64:67], a[0:3], a[192:195], v[64:67]
 ds_read_b128 a[44:47], v8 offset:55296
 v_mfma_f32_16x16x32_bf16 v[104:107], a[0:3], a[196:199], v[104:107]
 buffer_load_dwordx4 a[184:187], v2, s[4:7], s59 offen offset:1024 sc1
 v_mfma_f32_16x16x32_bf16 v[68:71], a[4:7], a[192:195], v[68:71]
 s_add_u32 s56, s56, 4096
 ds_read_b128 a[48:51], v6 offset:0
 v_mfma_f32_16x16x32_bf16 v[108:111], a[4:7], a[196:199], v[108:111]
 s_waitcnt lgkmcnt(5) vmcnt(36)
 v_mfma_f32_16x16x32_bf16 v[32:35], a[8:11], a[200:203], v[32:35]
 ds_read_b128 a[52:55], v6 offset:1024
 s_waitcnt vmcnt(34)
 v_mfma_f32_16x16x32_bf16 v[72:75], a[8:11], a[204:207], v[72:75]
 buffer_load_dwordx4 v14, s[4:7], s56 offen sc1 lds
 v_mfma_f32_16x16x32_bf16 v[36:39], a[12:15], a[200:203], v[36:39]
 ds_read_b128 a[56:59], v6 offset:2048
 v_mfma_f32_16x16x32_bf16 v[76:79], a[12:15], a[204:207], v[76:79]
 buffer_load_dwordx4 a[188:191], v3, s[4:7], s59 offen offset:1024 sc1
 v_mfma_f32_16x16x32_bf16 v[40:43], a[16:19], a[200:203], v[40:43]
 ds_read_b128 a[60:63], v6 offset:3072
 v_mfma_f32_16x16x32_bf16 v[80:83], a[16:19], a[204:207], v[80:83]
 s_add_u32 m0, s74, 81920
 v_mfma_f32_16x16x32_bf16 v[44:47], a[20:23], a[200:203], v[44:47]
 ds_read_b128 a[0:3], v6 offset:4096
 v_mfma_f32_16x16x32_bf16 v[84:87], a[20:23], a[204:207], v[84:87]
 v_mfma_f32_16x16x32_bf16 v[48:51], a[24:27], a[200:203], v[48:51]
 ds_read_b128 a[4:7], v9 offset:0
 s_add_u32 s56, s70, 184320
 v_mfma_f32_16x16x32_bf16 v[88:91], a[24:27], a[204:207], v[88:91]
 v_mfma_f32_16x16x32_bf16 v[52:55], a[28:31], a[200:203], v[52:55]
 ds_read_b128 a[8:11], v9 offset:1024
 v_mfma_f32_16x16x32_bf16 v[92:95], a[28:31], a[204:207], v[92:95]
 s_waitcnt lgkmcnt(5)
 v_mfma_f32_16x16x32_bf16 v[56:59], a[32:35], a[200:203], v[56:59]
 ds_read_b128 a[12:15], v9 offset:2048
 v_mfma_f32_16x16x32_bf16 v[96:99], a[32:35], a[204:207], v[96:99]
 buffer_load_dwordx4 v14, s[4:7], s56 offen offset:0 sc1 lds
 v_mfma_f32_16x16x32_bf16 v[60:63], a[36:39], a[200:203], v[60:63]
 ds_read_b128 a[16:19], v9 offset:3072
 v_mfma_f32_16x16x32_bf16 v[100:103], a[36:39], a[204:207], v[100:103]
 v_mfma_f32_16x16x32_bf16 v[64:67], a[40:43], a[200:203], v[64:67]
 ds_read_b128 a[20:23], v9 offset:4096
 v_mfma_f32_16x16x32_bf16 v[104:107], a[40:43], a[204:207], v[104:107]
 buffer_load_dwordx4 v14, s[4:7], s56 offen offset:1024 sc1 lds
 v_mfma_f32_16x16x32_bf16 v[68:71], a[44:47], a[200:203], v[68:71]
 ds_read_b128 a[24:27], v6 offset:10240
 v_mfma_f32_16x16x32_bf16 v[108:111], a[44:47], a[204:207], v[108:111]
 s_waitcnt vmcnt(33)
 v_mfma_f32_16x16x32_bf16 v[32:35], a[48:51], a[208:211], v[32:35]
 ds_read_b128 a[28:31], v6 offset:11264
 s_waitcnt vmcnt(32)
 v_mfma_f32_16x16x32_bf16 v[72:75], a[48:51], a[212:215], v[72:75]
 buffer_load_dwordx4 v14, s[4:7], s56 offen offset:2048 sc1 lds
 v_mfma_f32_16x16x32_bf16 v[36:39], a[52:55], a[208:211], v[36:39]
 s_add_u32 s59, s72, 14336
 ds_read_b128 a[32:35], v6 offset:12288
 v_mfma_f32_16x16x32_bf16 v[76:79], a[52:55], a[212:215], v[76:79]
 v_lshlrev_b32 v172, 16, v122
 s_waitcnt lgkmcnt(5)
 v_mfma_f32_16x16x32_bf16 v[40:43], a[56:59], a[208:211], v[40:43]
 ds_read_b128 a[36:39], v6 offset:13312
 v_and_b32 v173, 0xffff0000, v122
 v_mfma_f32_16x16x32_bf16 v[80:83], a[56:59], a[212:215], v[80:83]
 buffer_load_dwordx4 v14, s[4:7], s56 offen offset:3072 sc1 lds
 v_mfma_f32_16x16x32_bf16 v[44:47], a[60:63], a[208:211], v[44:47]
 ds_read_b128 a[40:43], v6 offset:14336
 v_mfma_f32_16x16x32_bf16 v[84:87], a[60:63], a[212:215], v[84:87]
 buffer_load_dwordx4 a[192:195], v2, s[4:7], s59 offen offset:0 sc1
 v_mfma_f32_16x16x32_bf16 v[48:51], a[0:3], a[208:211], v[48:51]
 ds_read_b128 a[44:47], v9 offset:10240
 s_add_u32 m0, s74, 86016
 v_mfma_f32_16x16x32_bf16 v[88:91], a[0:3], a[212:215], v[88:91]
 v_lshlrev_b32 v174, 16, v123
 v_mfma_f32_16x16x32_bf16 v[52:55], a[4:7], a[208:211], v[52:55]
 ds_read_b128 a[48:51], v9 offset:11264
 v_mfma_f32_16x16x32_bf16 v[92:95], a[4:7], a[212:215], v[92:95]
 buffer_load_dwordx4 a[196:199], v3, s[4:7], s59 offen offset:0 sc1
 v_mfma_f32_16x16x32_bf16 v[56:59], a[8:11], a[208:211], v[56:59]
 ds_read_b128 a[52:55], v9 offset:12288
 s_add_u32 s56, s56, 4096
 v_mfma_f32_16x16x32_bf16 v[96:99], a[8:11], a[212:215], v[96:99]
 v_and_b32 v175, 0xffff0000, v123
 v_mfma_f32_16x16x32_bf16 v[60:63], a[12:15], a[208:211], v[60:63]
 ds_read_b128 a[56:59], v9 offset:13312
 v_lshlrev_b32 v176, 16, v124
 v_mfma_f32_16x16x32_bf16 v[100:103], a[12:15], a[212:215], v[100:103]
 s_waitcnt lgkmcnt(5)
 v_mfma_f32_16x16x32_bf16 v[64:67], a[16:19], a[208:211], v[64:67]
 ds_read_b128 a[60:63], v9 offset:14336
 v_mfma_f32_16x16x32_bf16 v[104:107], a[16:19], a[212:215], v[104:107]
 buffer_load_dwordx4 v14, s[4:7], s56 offen sc1 lds
 v_mfma_f32_16x16x32_bf16 v[68:71], a[20:23], a[208:211], v[68:71]
 buffer_load_dwordx4 a[200:203], v2, s[4:7], s59 offen offset:1024 sc1
 v_mfma_f32_16x16x32_bf16 v[108:111], a[20:23], a[212:215], v[108:111]
 v_and_b32 v177, 0xffff0000, v124
 s_waitcnt vmcnt(36)
 v_mfma_f32_16x16x32_bf16 v[32:35], a[24:27], a[216:219], v[32:35]
 s_waitcnt vmcnt(35)
 v_mfma_f32_16x16x32_bf16 v[72:75], a[24:27], a[220:223], v[72:75]
 v_mfma_f32_16x16x32_bf16 v[36:39], a[28:31], a[216:219], v[36:39]
 buffer_load_dwordx4 a[204:207], v3, s[4:7], s59 offen offset:1024 sc1
 v_mfma_f32_16x16x32_bf16 v[76:79], a[28:31], a[220:223], v[76:79]
 v_lshlrev_b32 v178, 16, v125
 v_mfma_f32_16x16x32_bf16 v[40:43], a[32:35], a[216:219], v[40:43]
 v_mfma_f32_16x16x32_bf16 v[80:83], a[32:35], a[220:223], v[80:83]
 v_mfma_f32_16x16x32_bf16 v[44:47], a[36:39], a[216:219], v[44:47]
 v_and_b32 v179, 0xffff0000, v125
 v_mfma_f32_16x16x32_bf16 v[84:87], a[36:39], a[220:223], v[84:87]
 s_waitcnt lgkmcnt(0)
 v_mfma_f32_16x16x32_bf16 v[48:51], a[40:43], a[216:219], v[48:51]
 s_waitcnt lgkmcnt(0)
 s_barrier
 v_mfma_f32_16x16x32_bf16 v[88:91], a[40:43], a[220:223], v[88:91]
 ds_read_b128 a[0:3], v4 offset:0
 ds_read_b128 a[4:7], v4 offset:1024
 v_mfma_f32_16x16x32_bf16 v[52:55], a[44:47], a[216:219], v[52:55]
 ds_read_b128 a[8:11], v4 offset:2048
 ds_read_b128 a[12:15], v4 offset:3072
 v_mfma_f32_16x16x32_bf16 v[92:95], a[44:47], a[220:223], v[92:95]
 s_add_u32 m0, s74, 102400
 ds_read_b128 a[16:19], v4 offset:4096
 v_mfma_f32_16x16x32_bf16 v[56:59], a[48:51], a[216:219], v[56:59]
 ds_read_b128 a[20:23], v7 offset:0
 ds_read_b128 a[24:27], v7 offset:1024
 v_mfma_f32_16x16x32_bf16 v[96:99], a[48:51], a[220:223], v[96:99]
 ds_read_b128 a[28:31], v7 offset:2048
 s_add_u32 s56, s70, 204800
 v_mfma_f32_16x16x32_bf16 v[60:63], a[52:55], a[216:219], v[60:63]
 ds_read_b128 a[32:35], v7 offset:3072
 v_lshlrev_b32 v180, 16, v126
 v_mfma_f32_16x16x32_bf16 v[100:103], a[52:55], a[220:223], v[100:103]
 v_and_b32 v181, 0xffff0000, v126
 v_mfma_f32_16x16x32_bf16 v[64:67], a[56:59], a[216:219], v[64:67]
 ds_read_b128 a[36:39], v7 offset:4096
 v_mfma_f32_16x16x32_bf16 v[104:107], a[56:59], a[220:223], v[104:107]
 buffer_load_dwordx4 v14, s[4:7], s56 offen offset:0 sc1 lds
 v_mfma_f32_16x16x32_bf16 v[68:71], a[60:63], a[216:219], v[68:71]
 ds_read_b128 a[40:43], v4 offset:10240
 v_lshlrev_b32 v182, 16, v127
 v_mfma_f32_16x16x32_bf16 v[108:111], a[60:63], a[220:223], v[108:111]
 s_waitcnt lgkmcnt(10) vmcnt(33)
 v_mfma_f32_16x16x32_bf16 v[32:35], a[0:3], a[224:227], v[32:35]
 ds_read_b128 a[44:47], v4 offset:11264
 s_waitcnt vmcnt(31)
 v_mfma_f32_16x16x32_bf16 v[72:75], a[0:3], a[228:231], v[72:75]
 v_and_b32 v183, 0xffff0000, v127
 s_waitcnt lgkmcnt(8)
 v_mfma_f32_16x16x32_bf16 v[36:39], a[4:7], a[224:227], v[36:39]
 buffer_load_dwordx4 v14, s[4:7], s56 offen offset:1024 sc1 lds
 v_mfma_f32_16x16x32_bf16 v[76:79], a[4:7], a[228:231], v[76:79]
 ds_read_b128 a[48:51], v4 offset:12288
 v_mfma_f32_16x16x32_bf16 v[40:43], a[8:11], a[224:227], v[40:43]
 ds_read_b128 a[52:55], v4 offset:13312
 v_lshlrev_b32 v184, 16, v128
 v_mfma_f32_16x16x32_bf16 v[80:83], a[8:11], a[228:231], v[80:83]
 buffer_load_dwordx4 v14, s[4:7], s56 offen offset:2048 sc1 lds
 v_mfma_f32_16x16x32_bf16 v[44:47], a[12:15], a[224:227], v[44:47]
 ds_read_b128 a[56:59], v4 offset:14336
 v_mfma_f32_16x16x32_bf16 v[84:87], a[12:15], a[228:231], v[84:87]
 s_waitcnt lgkmcnt(5)
 v_mfma_f32_16x16x32_bf16 v[48:51], a[16:19], a[224:227], v[48:51]
 ds_read_b128 a[60:63], v7 offset:10240
 v_and_b32 v185, 0xffff0000, v128
 v_mfma_f32_16x16x32_bf16 v[88:91], a[16:19], a[228:231], v[88:91]
 buffer_load_dwordx4 v14, s[4:7], s56 offen offset:3072 sc1 lds
 v_mfma_f32_16x16x32_bf16 v[52:55], a[20:23], a[224:227], v[52:55]
 ds_read_b128 a[0:3], v7 offset:11264
 v_mfma_f32_16x16x32_bf16 v[92:95], a[20:23], a[228:231], v[92:95]
 v_mfma_f32_16x16x32_bf16 v[56:59], a[24:27], a[224:227], v[56:59]
 ds_read_b128 a[4:7], v7 offset:12288
 v_lshlrev_b32 v186, 16, v129
 v_mfma_f32_16x16x32_bf16 v[96:99], a[24:27], a[228:231], v[96:99]
 s_add_u32 m0, s74, 106496
 v_mfma_f32_16x16x32_bf16 v[60:63], a[28:31], a[224:227], v[60:63]
 ds_read_b128 a[8:11], v7 offset:13312
 v_mfma_f32_16x16x32_bf16 v[100:103], a[28:31], a[228:231], v[100:103]
 v_and_b32 v187, 0xffff0000, v129
 v_mfma_f32_16x16x32_bf16 v[64:67], a[32:35], a[224:227], v[64:67]
 ds_read_b128 a[12:15], v7 offset:14336
 v_mfma_f32_16x16x32_bf16 v[104:107], a[32:35], a[228:231], v[104:107]
 s_add_u32 s56, s56, 4096
 v_mfma_f32_16x16x32_bf16 v[68:71], a[36:39], a[224:227], v[68:71]
 ds_read_b128 a[16:19], v4 offset:20480
 v_mfma_f32_16x16x32_bf16 v[108:111], a[36:39], a[228:231], v[108:111]
 v_lshlrev_b32 v188, 16, v130
 s_waitcnt lgkmcnt(5) vmcnt(33)
 v_mfma_f32_16x16x32_bf16 v[32:35], a[40:43], a[232:235], v[32:35]
 ds_read_b128 a[20:23], v4 offset:21504
 s_waitcnt vmcnt(31)
 v_mfma_f32_16x16x32_bf16 v[72:75], a[40:43], a[236:239], v[72:75]
 buffer_load_dwordx4 v14, s[4:7], s56 offen sc1 lds
 v_mfma_f32_16x16x32_bf16 v[36:39], a[44:47], a[232:235], v[36:39]
 ds_read_b128 a[24:27], v4 offset:22528
 v_mfma_f32_16x16x32_bf16 v[76:79], a[44:47], a[236:239], v[76:79]
 v_and_b32 v189, 0xffff0000, v130
 v_mfma_f32_16x16x32_bf16 v[40:43], a[48:51], a[232:235], v[40:43]
 ds_read_b128 a[28:31], v4 offset:23552
 v_mfma_f32_16x16x32_bf16 v[80:83], a[48:51], a[236:239], v[80:83]
 s_add_u32 m0, s74, 122880
 v_mfma_f32_16x16x32_bf16 v[44:47], a[52:55], a[232:235], v[44:47]
 ds_read_b128 a[32:35], v4 offset:24576
 v_lshlrev_b32 v190, 16, v131
 v_mfma_f32_16x16x32_bf16 v[84:87], a[52:55], a[236:239], v[84:87]
 v_mfma_f32_16x16x32_bf16 v[48:51], a[56:59], a[232:235], v[48:51]
 ds_read_b128 a[36:39], v7 offset:20480
 s_add_u32 s56, s70, 225280
 v_mfma_f32_16x16x32_bf16 v[88:91], a[56:59], a[236:239], v[88:91]
 v_mfma_f32_16x16x32_bf16 v[52:55], a[60:63], a[232:235], v[52:55]
 ds_read_b128 a[40:43], v7 offset:21504
 v_and_b32 v191, 0xffff0000, v131
 v_mfma_f32_16x16x32_bf16 v[92:95], a[60:63], a[236:239], v[92:95]
 s_waitcnt lgkmcnt(5)
 v_mfma_f32_16x16x32_bf16 v[56:59], a[0:3], a[232:235], v[56:59]
 buffer_load_dword v15, v13, s[4:7], s78 offen sc1
 v_mfma_f32_16x16x32_bf16 v[96:99], a[0:3], a[236:239], v[96:99]
 ds_read_b128 a[44:47], v7 offset:22528
 v_mfma_f32_16x16x32_bf16 v[60:63], a[4:7], a[232:235], v[60:63]
 buffer_load_dwordx4 v14, s[4:7], s56 offen offset:0 sc1 lds
 v_mfma_f32_16x16x32_bf16 v[100:103], a[4:7], a[236:239], v[100:103]
 ds_read_b128 a[48:51], v7 offset:23552
 s_mul_i32 s58, s3, 3072
 v_mfma_f32_16x16x32_bf16 v[64:67], a[8:11], a[232:235], v[64:67]
 ds_read_b128 a[52:55], v7 offset:24576
 v_mfma_f32_16x16x32_bf16 v[104:107], a[8:11], a[236:239], v[104:107]
 buffer_load_dwordx4 v14, s[4:7], s56 offen offset:1024 sc1 lds
 v_mfma_f32_16x16x32_bf16 v[68:71], a[12:15], a[232:235], v[68:71]
 ds_read_b128 a[56:59], v4 offset:30720
 s_lshl_b32 s57, s75, 2
 v_mfma_f32_16x16x32_bf16 v[108:111], a[12:15], a[236:239], v[108:111]
 s_waitcnt vmcnt(30)
 v_mfma_f32_16x16x32_bf16 v[32:35], a[16:19], a[240:243], v[32:35]
 ds_read_b128 a[60:63], v4 offset:31744
 s_waitcnt vmcnt(29)
 v_mfma_f32_16x16x32_bf16 v[72:75], a[16:19], a[244:247], v[72:75]
 buffer_load_dwordx4 v14, s[4:7], s56 offen offset:2048 sc1 lds
 v_mfma_f32_16x16x32_bf16 v[36:39], a[20:23], a[240:243], v[36:39]
 ds_read_b128 a[0:3], v4 offset:32768
 s_xor_b32 s31, s66, 0
 v_mfma_f32_16x16x32_bf16 v[76:79], a[20:23], a[244:247], v[76:79]
 s_waitcnt lgkmcnt(5)
 v_mfma_f32_16x16x32_bf16 v[40:43], a[24:27], a[240:243], v[40:43]
 ds_read_b128 a[4:7], v4 offset:33792
 v_mfma_f32_16x16x32_bf16 v[80:83], a[24:27], a[244:247], v[80:83]
 buffer_load_dwordx4 v14, s[4:7], s56 offen offset:3072 sc1 lds
 v_mfma_f32_16x16x32_bf16 v[44:47], a[28:31], a[240:243], v[44:47]
 ds_read_b128 a[8:11], v4 offset:34816
 s_add_u32 s31, s31, s57
 v_mfma_f32_16x16x32_bf16 v[84:87], a[28:31], a[244:247], v[84:87]
 v_mfma_f32_16x16x32_bf16 v[48:51], a[32:35], a[240:243], v[48:51]
 ds_read_b128 a[12:15], v7 offset:30720
 s_add_u32 m0, s74, 126976
 v_mfma_f32_16x16x32_bf16 v[88:91], a[32:35], a[244:247], v[88:91]
 s_mul_i32 s31, s31, 36864
 v_mfma_f32_16x16x32_bf16 v[52:55], a[36:39], a[240:243], v[52:55]
 ds_read_b128 a[16:19], v7 offset:31744
 v_mfma_f32_16x16x32_bf16 v[92:95], a[36:39], a[244:247], v[92:95]
 v_mfma_f32_16x16x32_bf16 v[56:59], a[40:43], a[240:243], v[56:59]
 ds_read_b128 a[20:23], v7 offset:32768
 s_add_u32 s56, s56, 4096
 v_mfma_f32_16x16x32_bf16 v[96:99], a[40:43], a[244:247], v[96:99]
 s_add_u32 s31, s31, s58
 v_mfma_f32_16x16x32_bf16 v[60:63], a[44:47], a[240:243], v[60:63]
 ds_read_b128 a[24:27], v7 offset:33792
 v_mfma_f32_16x16x32_bf16 v[100:103], a[44:47], a[244:247], v[100:103]
 s_waitcnt lgkmcnt(5)
 v_mfma_f32_16x16x32_bf16 v[64:67], a[48:51], a[240:243], v[64:67]
 ds_read_b128 a[28:31], v7 offset:34816
 s_add_u32 s31, s31, 72351744
 v_mfma_f32_16x16x32_bf16 v[104:107], a[48:51], a[244:247], v[104:107]
 buffer_load_dwordx4 v14, s[4:7], s56 offen sc1 lds
 v_mfma_f32_16x16x32_bf16 v[68:71], a[52:55], a[240:243], v[68:71]
 v_mfma_f32_16x16x32_bf16 v[108:111], a[52:55], a[244:247], v[108:111]
 s_waitcnt vmcnt(30)
 v_mfma_f32_16x16x32_bf16 v[32:35], a[56:59], a[248:251], v[32:35]
 s_xor_b32 s28, s66, 1
 s_waitcnt vmcnt(29)
 v_mfma_f32_16x16x32_bf16 v[72:75], a[56:59], a[252:255], v[72:75]
 v_mfma_f32_16x16x32_bf16 v[36:39], a[60:63], a[248:251], v[36:39]
 v_mfma_f32_16x16x32_bf16 v[76:79], a[60:63], a[252:255], v[76:79]
 v_mfma_f32_16x16x32_bf16 v[40:43], a[0:3], a[248:251], v[40:43]
 s_add_u32 s28, s28, s57
 v_mfma_f32_16x16x32_bf16 v[80:83], a[0:3], a[252:255], v[80:83]
 v_mfma_f32_16x16x32_bf16 v[44:47], a[4:7], a[248:251], v[44:47]
 v_mfma_f32_16x16x32_bf16 v[84:87], a[4:7], a[252:255], v[84:87]
 s_mul_i32 s28, s28, 36864
 s_waitcnt lgkmcnt(0)
 v_mfma_f32_16x16x32_bf16 v[48:51], a[8:11], a[248:251], v[48:51]
 s_waitcnt lgkmcnt(0)
 s_barrier
 v_mfma_f32_16x16x32_bf16 v[88:91], a[8:11], a[252:255], v[88:91]
 ds_read_b128 a[32:35], v4 offset:40960
 ds_read_b128 a[36:39], v4 offset:41984
 v_mfma_f32_16x16x32_bf16 v[52:55], a[12:15], a[248:251], v[52:55]
 ds_read_b128 a[40:43], v4 offset:43008
 ds_read_b128 a[44:47], v4 offset:44032
 v_mfma_f32_16x16x32_bf16 v[92:95], a[12:15], a[252:255], v[92:95]
 s_add_u32 m0, s74, 0
 ds_read_b128 a[48:51], v4 offset:45056
 v_mfma_f32_16x16x32_bf16 v[56:59], a[16:19], a[248:251], v[56:59]
 ds_read_b128 a[52:55], v7 offset:40960
 ds_read_b128 a[56:59], v7 offset:41984
 v_mfma_f32_16x16x32_bf16 v[96:99], a[16:19], a[252:255], v[96:99]
 ds_read_b128 a[60:63], v7 offset:43008
 s_add_u32 s56, s70, 245760
 v_mfma_f32_16x16x32_bf16 v[60:63], a[20:23], a[248:251], v[60:63]
 ds_read_b128 a[0:3], v7 offset:44032
 s_add_u32 s28, s28, s58
 v_mfma_f32_16x16x32_bf16 v[100:103], a[20:23], a[252:255], v[100:103]
 s_add_u32 s28, s28, 72351744
 v_mfma_f32_16x16x32_bf16 v[64:67], a[24:27], a[248:251], v[64:67]
 ds_read_b128 a[4:7], v7 offset:45056
 v_mfma_f32_16x16x32_bf16 v[104:107], a[24:27], a[252:255], v[104:107]
 buffer_load_dwordx4 v14, s[4:7], s56 offen offset:0 sc1 lds
 v_mfma_f32_16x16x32_bf16 v[68:71], a[28:31], a[248:251], v[68:71]
 ds_read_b128 a[8:11], v4 offset:51200
 v_mfma_f32_16x16x32_bf16 v[108:111], a[28:31], a[252:255], v[108:111]
 s_xor_b32 s29, s66, 2
 s_waitcnt lgkmcnt(10) vmcnt(26)
 v_mfma_f32_16x16x32_bf16 v[32:35], a[32:35], a[176:179], v[32:35]
 ds_read_b128 a[12:15], v4 offset:52224
 s_waitcnt vmcnt(24)
 v_mfma_f32_16x16x32_bf16 v[72:75], a[32:35], a[180:183], v[72:75]
 s_waitcnt vmcnt(6)
 v_cmp_ne_u32 vcc, s98, v15
 s_cbranch_vccnz P_parall_22
PB_parall_23:
 s_waitcnt lgkmcnt(4)
 v_mfma_f32_16x16x32_bf16 v[36:39], a[36:39], a[176:179], v[36:39]
 s_add_u32 s59, s72, 16384
 s_add_u32 s29, s29, s57
 v_mfma_f32_16x16x32_bf16 v[76:79], a[36:39], a[180:183], v[76:79]
 buffer_load_dwordx4 v14, s[4:7], s56 offen offset:1024 sc1 lds
 v_mfma_f32_16x16x32_bf16 v[40:43], a[40:43], a[176:179], v[40:43]
 ds_read_b128 a[16:19], v4 offset:53248
 v_mfma_f32_16x16x32_bf16 v[80:83], a[40:43], a[180:183], v[80:83]
 buffer_load_dwordx4 a[64:67], v2, s[4:7], s59 offen offset:0 sc1
 v_mfma_f32_16x16x32_bf16 v[44:47], a[44:47], a[176:179], v[44:47]
 ds_read_b128 a[20:23], v4 offset:54272
 s_mul_i32 s29, s29, 36864
 v_mfma_f32_16x16x32_bf16 v[84:87], a[44:47], a[180:183], v[84:87]
 buffer_load_dwordx4 a[212:215], v3, s[4:7], s59 offen offset:0 sc1
 v_mfma_f32_16x16x32_bf16 v[48:51], a[48:51], a[176:179], v[48:51]
 buffer_load_dwordx4 v14, s[4:7], s56 offen offset:2048 sc1 lds
 v_mfma_f32_16x16x32_bf16 v[88:91], a[48:51], a[180:183], v[88:91]
 ds_read_b128 a[24:27], v4 offset:55296
 v_mfma_f32_16x16x32_bf16 v[52:55], a[52:55], a[176:179], v[52:55]
 buffer_load_dwordx4 a[68:71], v2, s[4:7], s59 offen offset:1024 sc1
 v_mfma_f32_16x16x32_bf16 v[92:95], a[52:55], a[180:183], v[92:95]
 ds_read_b128 a[28:31], v7 offset:51200
 s_add_u32 s29, s29, s58
 v_mfma_f32_16x16x32_bf16 v[56:59], a[56:59], a[176:179], v[56:59]
 buffer_load_dwordx4 v14, s[4:7], s56 offen offset:3072 sc1 lds
 v_mfma_f32_16x16x32_bf16 v[96:99], a[56:59], a[180:183], v[96:99]
 buffer_load_dwordx4 a[220:223], v3, s[4:7], s59 offen offset:1024 sc1
 v_mfma_f32_16x16x32_bf16 v[60:63], a[60:63], a[176:179], v[60:63]
 ds_read_b128 a[32:35], v7 offset:52224
 ds_read_b128 a[36:39], v7 offset:53248
 v_mfma_f32_16x16x32_bf16 v[100:103], a[60:63], a[180:183], v[100:103]
 s_add_u32 s59, s72, 18432
 s_waitcnt lgkmcnt(5)
 v_mfma_f32_16x16x32_bf16 v[64:67], a[0:3], a[176:179], v[64:67]
 s_add_u32 m0, s74, 4096
 ds_read_b128 a[40:43], v7 offset:54272
 v_mfma_f32_16x16x32_bf16 v[104:107], a[0:3], a[180:183], v[104:107]
 buffer_load_dwordx4 a[72:75], v2, s[4:7], s59 offen offset:0 sc1
 v_mfma_f32_16x16x32_bf16 v[68:71], a[4:7], a[176:179], v[68:71]
 ds_read_b128 a[44:47], v7 offset:55296
 s_add_u32 s56, s56, 4096
 v_mfma_f32_16x16x32_bf16 v[108:111], a[4:7], a[180:183], v[108:111]
 buffer_load_dwordx4 a[228:231], v3, s[4:7], s59 offen offset:0 sc1
 v_mfma_f32_16x16x32_bf16 v[32:35], a[8:11], a[184:187], v[32:35]
 ds_read_b128 a[48:51], v5 offset:0
 s_add_u32 s29, s29, 72364032
 v_mfma_f32_16x16x32_bf16 v[72:75], a[8:11], a[188:191], v[72:75]
 buffer_load_dwordx4 a[76:79], v2, s[4:7], s59 offen offset:1024 sc1
 v_mfma_f32_16x16x32_bf16 v[36:39], a[12:15], a[184:187], v[36:39]
 ds_read_b128 a[52:55], v5 offset:1024
 s_xor_b32 s30, s66, 3
 v_mfma_f32_16x16x32_bf16 v[76:79], a[12:15], a[188:191], v[76:79]
 buffer_load_dwordx4 v14, s[4:7], s56 offen sc1 lds
 v_mfma_f32_16x16x32_bf16 v[40:43], a[16:19], a[184:187], v[40:43]
 buffer_load_dwordx4 a[236:239], v3, s[4:7], s59 offen offset:1024 sc1
 v_mfma_f32_16x16x32_bf16 v[80:83], a[16:19], a[188:191], v[80:83]
 ds_read_b128 a[56:59], v5 offset:2048
 s_waitcnt lgkmcnt(5)
 v_mfma_f32_16x16x32_bf16 v[44:47], a[20:23], a[184:187], v[44:47]
 ds_read_b128 a[60:63], v5 offset:3072
 s_add_u32 m0, s74, 20480
 v_mfma_f32_16x16x32_bf16 v[84:87], a[20:23], a[188:191], v[84:87]
 s_add_u32 s59, s72, 20480
 ds_read_b128 a[0:3], v5 offset:4096
 v_mfma_f32_16x16x32_bf16 v[48:51], a[24:27], a[184:187], v[48:51]
 buffer_load_dwordx4 a[80:83], v2, s[4:7], s59 offen offset:0 sc1
 v_mfma_f32_16x16x32_bf16 v[88:91], a[24:27], a[188:191], v[88:91]
 ds_read_b128 a[4:7], v8 offset:0
 s_add_u32 s56, s70, 266240
 v_mfma_f32_16x16x32_bf16 v[52:55], a[28:31], a[184:187], v[52:55]
 buffer_load_dwordx4 a[244:247], v3, s[4:7], s59 offen offset:0 sc1
 v_mfma_f32_16x16x32_bf16 v[92:95], a[28:31], a[188:191], v[92:95]
 ds_read_b128 a[8:11], v8 offset:1024
 s_add_u32 s30, s30, s57
 v_mfma_f32_16x16x32_bf16 v[56:59], a[32:35], a[184:187], v[56:59]
 buffer_load_dwordx4 a[84:87], v2, s[4:7], s59 offen offset:1024 sc1
 v_mfma_f32_16x16x32_bf16 v[96:99], a[32:35], a[188:191], v[96:99]
 ds_read_b128 a[12:15], v8 offset:2048
 s_mul_i32 s30, s30, 36864
 v_mfma_f32_16x16x32_bf16 v[60:63], a[36:39], a[184:187], v[60:63]
 buffer_load_dwordx4 v14, s[4:7], s56 offen offset:0 sc1 lds
 v_mfma_f32_16x16x32_bf16 v[100:103], a[36:39], a[188:191], v[100:103]
 s_add_u32 s30, s30, s58
 s_waitcnt lgkmcnt(5)
 v_mfma_f32_16x16x32_bf16 v[64:67], a[40:43], a[184:187], v[64:67]
 buffer_load_dwordx4 a[252:255], v3, s[4:7], s59 offen offset:1024 sc1
 v_mfma_f32_16x16x32_bf16 v[104:107], a[40:43], a[188:191], v[104:107]
 ds_read_b128 a[16:19], v8 offset:3072
 ds_read_b128 a[20:23], v8 offset:4096
 v_mfma_f32_16x16x32_bf16 v[68:71], a[44:47], a[184:187], v[68:71]
 buffer_load_dwordx4 v14, s[4:7], s56 offen offset:1024 sc1 lds
 v_mfma_f32_16x16x32_bf16 v[108:111], a[44:47], a[188:191], v[108:111]
 ds_read_b128 a[24:27], v5 offset:10240
 s_add_u32 s30, s30, 72376320
 v_mfma_f32_16x16x32_bf16 v[32:35], a[48:51], a[192:195], v[32:35]
 ds_read_b128 a[28:31], v5 offset:11264
 s_mov_b32 s76, 0
 v_mfma_f32_16x16x32_bf16 v[72:75], a[48:51], a[196:199], v[72:75]
 buffer_load_dwordx4 v14, s[4:7], s56 offen offset:2048 sc1 lds
 v_mfma_f32_16x16x32_bf16 v[36:39], a[52:55], a[192:195], v[36:39]
 s_add_u32 s59, s72, 22528
 ds_read_b128 a[32:35], v5 offset:12288
 v_mfma_f32_16x16x32_bf16 v[76:79], a[52:55], a[196:199], v[76:79]
 v_mfma_f32_16x16x32_bf16 v[40:43], a[56:59], a[192:195], v[40:43]
 ds_read_b128 a[36:39], v5 offset:13312
 v_mfma_f32_16x16x32_bf16 v[80:83], a[56:59], a[196:199], v[80:83]
 s_waitcnt lgkmcnt(6)
 v_mfma_f32_16x16x32_bf16 v[44:47], a[60:63], a[192:195], v[44:47]
 buffer_load_dwordx4 v14, s[4:7], s56 offen offset:3072 sc1 lds
 v_mfma_f32_16x16x32_bf16 v[84:87], a[60:63], a[196:199], v[84:87]
 ds_read_b128 a[40:43], v5 offset:14336
 v_mfma_f32_16x16x32_bf16 v[48:51], a[0:3], a[192:195], v[48:51]
 buffer_load_dwordx4 a[176:179], v2, s[4:7], s59 offen offset:0 sc1
 v_mfma_f32_16x16x32_bf16 v[88:91], a[0:3], a[196:199], v[88:91]
 ds_read_b128 a[44:47], v8 offset:10240
 s_add_u32 m0, s74, 24576
 v_mfma_f32_16x16x32_bf16 v[52:55], a[4:7], a[192:195], v[52:55]
 ds_read_b128 a[48:51], v8 offset:11264
 v_mfma_f32_16x16x32_bf16 v[92:95], a[4:7], a[196:199], v[92:95]
 buffer_load_dwordx4 a[180:183], v3, s[4:7], s59 offen offset:0 sc1
 v_mfma_f32_16x16x32_bf16 v[56:59], a[8:11], a[192:195], v[56:59]
 ds_read_b128 a[52:55], v8 offset:12288
 s_add_u32 s56, s56, 4096
 v_mfma_f32_16x16x32_bf16 v[96:99], a[8:11], a[196:199], v[96:99]
 v_mfma_f32_16x16x32_bf16 v[60:63], a[12:15], a[192:195], v[60:63]
 ds_read_b128 a[56:59], v8 offset:13312
 v_mfma_f32_16x16x32_bf16 v[100:103], a[12:15], a[196:199], v[100:103]
 s_waitcnt lgkmcnt(5)
 v_mfma_f32_16x16x32_bf16 v[64:67], a[16:19], a[192:195], v[64:67]
 ds_read_b128 a[60:63], v8 offset:14336
 v_mfma_f32_16x16x32_bf16 v[104:107], a[16:19], a[196:199], v[104:107]
 buffer_load_dwordx4 v14, s[4:7], s56 offen sc1 lds
 v_mfma_f32_16x16x32_bf16 v[68:71], a[20:23], a[192:195], v[68:71]
 buffer_load_dwordx4 a[184:187], v2, s[4:7], s59 offen offset:1024 sc1
 v_mfma_f32_16x16x32_bf16 v[108:111], a[20:23], a[196:199], v[108:111]
 v_mfma_f32_16x16x32_bf16 v[32:35], a[24:27], a[200:203], v[32:35]
 v_mfma_f32_16x16x32_bf16 v[72:75], a[24:27], a[204:207], v[72:75]
 v_mfma_f32_16x16x32_bf16 v[36:39], a[28:31], a[200:203], v[36:39]
 buffer_load_dwordx4 a[188:191], v3, s[4:7], s59 offen offset:1024 sc1
 v_mfma_f32_16x16x32_bf16 v[76:79], a[28:31], a[204:207], v[76:79]
 v_mfma_f32_16x16x32_bf16 v[40:43], a[32:35], a[200:203], v[40:43]
 v_mfma_f32_16x16x32_bf16 v[80:83], a[32:35], a[204:207], v[80:83]
 v_mfma_f32_16x16x32_bf16 v[44:47], a[36:39], a[200:203], v[44:47]
 v_mfma_f32_16x16x32_bf16 v[84:87], a[36:39], a[204:207], v[84:87]
 s_waitcnt lgkmcnt(0)
 v_mfma_f32_16x16x32_bf16 v[48:51], a[40:43], a[200:203], v[48:51]
 s_waitcnt lgkmcnt(0)
 s_barrier
 v_mfma_f32_16x16x32_bf16 v[88:91], a[40:43], a[204:207], v[88:91]
 ds_read_b128 a[0:3], v6 offset:20480
 ds_read_b128 a[4:7], v6 offset:21504
 v_mfma_f32_16x16x32_bf16 v[52:55], a[44:47], a[200:203], v[52:55]
 ds_read_b128 a[8:11], v6 offset:22528
 ds_read_b128 a[12:15], v6 offset:23552
 v_mfma_f32_16x16x32_bf16 v[92:95], a[44:47], a[204:207], v[92:95]
 s_add_u32 m0, s74, 40960
 ds_read_b128 a[16:19], v6 offset:24576
 v_mfma_f32_16x16x32_bf16 v[56:59], a[48:51], a[200:203], v[56:59]
 ds_read_b128 a[20:23], v9 offset:20480
 ds_read_b128 a[24:27], v9 offset:21504
 v_mfma_f32_16x16x32_bf16 v[96:99], a[48:51], a[204:207], v[96:99]
 ds_read_b128 a[28:31], v9 offset:22528
 ds_read_b128 a[32:35], v9 offset:23552
 v_mfma_f32_16x16x32_bf16 v[60:63], a[52:55], a[200:203], v[60:63]
 ds_read_b128 a[36:39], v9 offset:24576
 s_add_u32 s56, s70, 286720
 v_mfma_f32_16x16x32_bf16 v[100:103], a[52:55], a[204:207], v[100:103]
 ds_read_b128 a[40:43], v6 offset:30720
 ds_read_b128 a[44:47], v6 offset:31744
 v_mfma_f32_16x16x32_bf16 v[64:67], a[56:59], a[200:203], v[64:67]
 ds_read_b128 a[48:51], v6 offset:32768
 ds_read_b128 a[52:55], v6 offset:33792
 v_mfma_f32_16x16x32_bf16 v[104:107], a[56:59], a[204:207], v[104:107]
 buffer_load_dwordx4 v14, s[4:7], s56 offen offset:0 sc1 lds
 v_mfma_f32_16x16x32_bf16 v[68:71], a[60:63], a[200:203], v[68:71]
 ds_read_b128 a[56:59], v6 offset:34816
 v_mfma_f32_16x16x32_bf16 v[108:111], a[60:63], a[204:207], v[108:111]
 ds_read_b128 a[60:63], v9 offset:30720
 s_waitcnt lgkmcnt(15) vmcnt(23)
 v_mfma_f32_16x16x32_bf16 v[72:75], a[0:3], a[212:215], v[72:75]
 s_waitcnt lgkmcnt(13)
 v_mfma_f32_16x16x32_bf16 v[76:79], a[4:7], a[212:215], v[76:79]
 buffer_load_dwordx4 v14, s[4:7], s56 offen offset:1024 sc1 lds
 v_mfma_f32_16x16x32_bf16 v[80:83], a[8:11], a[212:215], v[80:83]
 ds_read_b128 a[0:3], v9 offset:31744
 s_waitcnt lgkmcnt(11)
 v_mfma_f32_16x16x32_bf16 v[84:87], a[12:15], a[212:215], v[84:87]
 s_add_u32 s59, s72, 24576
 ds_read_b128 a[4:7], v9 offset:32768
 v_mfma_f32_16x16x32_bf16 v[88:91], a[16:19], a[212:215], v[88:91]
 buffer_load_dwordx4 v14, s[4:7], s56 offen offset:2048 sc1 lds
 v_mfma_f32_16x16x32_bf16 v[52:55], a[20:23], a[64:67], v[52:55]
 ds_read_b128 a[8:11], v9 offset:33792
 v_mfma_f32_16x16x32_bf16 v[92:95], a[20:23], a[212:215], v[92:95]
 s_waitcnt lgkmcnt(6)
 v_mfma_f32_16x16x32_bf16 v[56:59], a[24:27], a[64:67], v[56:59]
 buffer_load_dwordx4 v14, s[4:7], s56 offen offset:3072 sc1 lds
 v_mfma_f32_16x16x32_bf16 v[96:99], a[24:27], a[212:215], v[96:99]
 ds_read_b128 a[12:15], v9 offset:34816
 v_mfma_f32_16x16x32_bf16 v[60:63], a[28:31], a[64:67], v[60:63]
 buffer_load_dwordx4 a[192:195], v2, s[4:7], s59 offen offset:0 sc1
 v_mfma_f32_16x16x32_bf16 v[100:103], a[28:31], a[212:215], v[100:103]
 ds_read_b128 a[16:19], v5 offset:20480
 s_add_u32 m0, s74, 45056
 v_mfma_f32_16x16x32_bf16 v[64:67], a[32:35], a[64:67], v[64:67]
 ds_read_b128 a[20:23], v5 offset:21504
 ds_read_b128 a[24:27], v5 offset:22528
 v_mfma_f32_16x16x32_bf16 v[104:107], a[32:35], a[212:215], v[104:107]
 ds_read_b128 a[28:31], v5 offset:23552
 s_add_u32 s56, s56, 4096
 v_mfma_f32_16x16x32_bf16 v[68:71], a[36:39], a[64:67], v[68:71]
 buffer_load_dwordx4 a[196:199], v3, s[4:7], s59 offen offset:0 sc1
 v_mfma_f32_16x16x32_bf16 v[108:111], a[36:39], a[212:215], v[108:111]
 ds_read_b128 a[32:35], v5 offset:24576
 s_waitcnt vmcnt(24)
 v_mfma_f32_16x16x32_bf16 v[72:75], a[40:43], a[220:223], v[72:75]
 ds_read_b128 a[36:39], v8 offset:20480
 v_mfma_f32_16x16x32_bf16 v[76:79], a[44:47], a[220:223], v[76:79]
 buffer_load_dwordx4 v14, s[4:7], s56 offen sc1 lds
 v_mfma_f32_16x16x32_bf16 v[80:83], a[48:51], a[220:223], v[80:83]
 ds_read_b128 a[40:43], v8 offset:21504
 s_waitcnt lgkmcnt(8)
 v_mfma_f32_16x16x32_bf16 v[84:87], a[52:55], a[220:223], v[84:87]
 ds_read_b128 a[44:47], v8 offset:22528
 v_mfma_f32_16x16x32_bf16 v[88:91], a[56:59], a[220:223], v[88:91]
 buffer_load_dwordx4 a[200:203], v2, s[4:7], s59 offen offset:1024 sc1
 v_mfma_f32_16x16x32_bf16 v[52:55], a[60:63], a[68:71], v[52:55]
 s_add_u32 m0, s74, 61440
 ds_read_b128 a[48:51], v8 offset:23552
 v_mfma_f32_16x16x32_bf16 v[92:95], a[60:63], a[220:223], v[92:95]
 ds_read_b128 a[52:55], v8 offset:24576
 s_add_u32 s56, s70, 307200
 v_mfma_f32_16x16x32_bf16 v[56:59], a[0:3], a[68:71], v[56:59]
 buffer_load_dwordx4 a[204:207], v3, s[4:7], s59 offen offset:1024 sc1
 v_mfma_f32_16x16x32_bf16 v[96:99], a[0:3], a[220:223], v[96:99]
 ds_read_b128 a[56:59], v5 offset:30720
 v_mfma_f32_16x16x32_bf16 v[60:63], a[4:7], a[68:71], v[60:63]
 ds_read_b128 a[60:63], v5 offset:31744
 v_mfma_f32_16x16x32_bf16 v[100:103], a[4:7], a[220:223], v[100:103]
 buffer_load_dwordx4 v14, s[4:7], s56 offen offset:0 sc1 lds
 v_mfma_f32_16x16x32_bf16 v[64:67], a[8:11], a[68:71], v[64:67]
 ds_read_b128 a[0:3], v5 offset:32768
 ds_read_b128 a[4:7], v5 offset:33792
 v_mfma_f32_16x16x32_bf16 v[104:107], a[8:11], a[220:223], v[104:107]
 ds_read_b128 a[8:11], v5 offset:34816
 s_waitcnt lgkmcnt(8)
 v_mfma_f32_16x16x32_bf16 v[68:71], a[12:15], a[68:71], v[68:71]
 buffer_load_dwordx4 v14, s[4:7], s56 offen offset:1024 sc1 lds
 v_mfma_f32_16x16x32_bf16 v[108:111], a[12:15], a[220:223], v[108:111]
 ds_read_b128 a[12:15], v8 offset:30720
 s_waitcnt vmcnt(27)
 v_mfma_f32_16x16x32_bf16 v[72:75], a[16:19], a[228:231], v[72:75]
 ds_read_b128 a[16:19], v8 offset:31744
 v_mfma_f32_16x16x32_bf16 v[76:79], a[20:23], a[228:231], v[76:79]
 buffer_load_dwordx4 v14, s[4:7], s56 offen offset:2048 sc1 lds
 v_mfma_f32_16x16x32_bf16 v[80:83], a[24:27], a[228:231], v[80:83]
 s_add_u32 s59, s72, 26624
 ds_read_b128 a[20:23], v8 offset:32768
 v_mfma_f32_16x16x32_bf16 v[84:87], a[28:31], a[228:231], v[84:87]
 buffer_load_dwordx4 v14, s[4:7], s56 offen offset:3072 sc1 lds
 v_mfma_f32_16x16x32_bf16 v[88:91], a[32:35], a[228:231], v[88:91]
 ds_read_b128 a[24:27], v8 offset:33792
 v_mfma_f32_16x16x32_bf16 v[52:55], a[36:39], a[72:75], v[52:55]
 v_mfma_f32_16x16x32_bf16 v[92:95], a[36:39], a[228:231], v[92:95]
 ds_read_b128 a[28:31], v8 offset:34816
 s_add_u32 m0, s74, 65536
 v_mfma_f32_16x16x32_bf16 v[56:59], a[40:43], a[72:75], v[56:59]
 buffer_load_dwordx4 a[208:211], v2, s[4:7], s59 offen offset:0 sc1
 v_mfma_f32_16x16x32_bf16 v[96:99], a[40:43], a[228:231], v[96:99]
 s_waitcnt lgkmcnt(5)
 v_mfma_f32_16x16x32_bf16 v[60:63], a[44:47], a[72:75], v[60:63]
 s_add_u32 s56, s56, 4096
 v_mfma_f32_16x16x32_bf16 v[100:103], a[44:47], a[228:231], v[100:103]
 buffer_load_dwordx2 v[112:113], v10, s[24:27], s73 offen offset:0
 v_mfma_f32_16x16x32_bf16 v[64:67], a[48:51], a[72:75], v[64:67]
 buffer_load_dwordx4 a[212:215], v3, s[4:7], s59 offen offset:0 sc1
 v_mfma_f32_16x16x32_bf16 v[104:107], a[48:51], a[228:231], v[104:107]
 buffer_load_dwordx4 v14, s[4:7], s56 offen sc1 lds
 v_mfma_f32_16x16x32_bf16 v[68:71], a[52:55], a[72:75], v[68:71]
 v_mfma_f32_16x16x32_bf16 v[108:111], a[52:55], a[228:231], v[108:111]
 s_waitcnt vmcnt(30)
 v_mfma_f32_16x16x32_bf16 v[72:75], a[56:59], a[236:239], v[72:75]
 buffer_load_dwordx2 v[114:115], v10, s[24:27], s73 offen offset:32
 v_mfma_f32_16x16x32_bf16 v[76:79], a[60:63], a[236:239], v[76:79]
 v_mfma_f32_16x16x32_bf16 v[80:83], a[0:3], a[236:239], v[80:83]
 buffer_load_dwordx4 a[216:219], v2, s[4:7], s59 offen offset:1024 sc1
 v_mfma_f32_16x16x32_bf16 v[84:87], a[4:7], a[236:239], v[84:87]
 s_waitcnt lgkmcnt(0)
 s_barrier
 v_mfma_f32_16x16x32_bf16 v[88:91], a[8:11], a[236:239], v[88:91]
 ds_read_b128 a[32:35], v5 offset:40960
 ds_read_b128 a[36:39], v5 offset:41984
 v_mfma_f32_16x16x32_bf16 v[52:55], a[12:15], a[76:79], v[52:55]
 ds_read_b128 a[40:43], v5 offset:43008
 ds_read_b128 a[44:47], v5 offset:44032
 v_mfma_f32_16x16x32_bf16 v[92:95], a[12:15], a[236:239], v[92:95]
 ds_read_b128 a[48:51], v5 offset:45056
 ds_read_b128 a[52:55], v8 offset:40960
 v_mfma_f32_16x16x32_bf16 v[56:59], a[16:19], a[76:79], v[56:59]
 ds_read_b128 a[56:59], v8 offset:41984
 ds_read_b128 a[60:63], v8 offset:43008
 v_mfma_f32_16x16x32_bf16 v[96:99], a[16:19], a[236:239], v[96:99]
 buffer_load_dwordx4 a[220:223], v3, s[4:7], s59 offen offset:1024 sc1
 v_mfma_f32_16x16x32_bf16 v[60:63], a[20:23], a[76:79], v[60:63]
 ds_read_b128 a[0:3], v8 offset:44032
 ds_read_b128 a[4:7], v8 offset:45056
 v_mfma_f32_16x16x32_bf16 v[100:103], a[20:23], a[236:239], v[100:103]
 ds_read_b128 a[8:11], v5 offset:51200
 ds_read_b128 a[12:15], v5 offset:52224
 v_mfma_f32_16x16x32_bf16 v[64:67], a[24:27], a[76:79], v[64:67]
 ds_read_b128 a[16:19], v5 offset:53248
 ds_read_b128 a[20:23], v5 offset:54272
 v_mfma_f32_16x16x32_bf16 v[104:107], a[24:27], a[236:239], v[104:107]
 ds_read_b128 a[24:27], v5 offset:55296
 v_mfma_f32_16x16x32_bf16 v[68:71], a[28:31], a[76:79], v[68:71]
 buffer_load_dwordx2 v[116:117], v10, s[24:27], s73 offen offset:64
 v_mfma_f32_16x16x32_bf16 v[108:111], a[28:31], a[236:239], v[108:111]
 ds_read_b128 a[28:31], v8 offset:51200
 s_waitcnt lgkmcnt(15) vmcnt(32)
 v_mfma_f32_16x16x32_bf16 v[72:75], a[32:35], a[244:247], v[72:75]
 ds_read_b128 a[32:35], v8 offset:52224
 s_waitcnt lgkmcnt(14)
 v_mfma_f32_16x16x32_bf16 v[76:79], a[36:39], a[244:247], v[76:79]
 s_add_u32 s59, s72, 28672
 v_mfma_f32_16x16x32_bf16 v[80:83], a[40:43], a[244:247], v[80:83]
 ds_read_b128 a[36:39], v8 offset:53248
 s_waitcnt lgkmcnt(11)
 v_mfma_f32_16x16x32_bf16 v[84:87], a[44:47], a[244:247], v[84:87]
 buffer_load_dwordx2 v[118:119], v10, s[24:27], s73 offen offset:96
 v_mfma_f32_16x16x32_bf16 v[88:91], a[48:51], a[244:247], v[88:91]
 ds_read_b128 a[40:43], v8 offset:54272
 v_mfma_f32_16x16x32_bf16 v[52:55], a[52:55], a[80:83], v[52:55]
 buffer_load_dwordx2 v[120:121], v10, s[24:27], s73 offen offset:128
 v_mfma_f32_16x16x32_bf16 v[92:95], a[52:55], a[244:247], v[92:95]
 ds_read_b128 a[44:47], v8 offset:55296
 v_mfma_f32_16x16x32_bf16 v[56:59], a[56:59], a[80:83], v[56:59]
 buffer_load_dwordx4 a[224:227], v2, s[4:7], s59 offen offset:0 sc1
 v_mfma_f32_16x16x32_bf16 v[96:99], a[56:59], a[244:247], v[96:99]
 ds_read_b128 a[48:51], v6 offset:0
 s_waitcnt lgkmcnt(6)
 v_mfma_f32_16x16x32_bf16 v[60:63], a[60:63], a[80:83], v[60:63]
 ds_read_b128 a[52:55], v6 offset:1024
 v_mfma_f32_16x16x32_bf16 v[100:103], a[60:63], a[244:247], v[100:103]
 ds_read_b128 a[56:59], v6 offset:2048
 v_mfma_f32_16x16x32_bf16 v[64:67], a[0:3], a[80:83], v[64:67]
 ds_read_b128 a[60:63], v6 offset:3072
 v_mfma_f32_16x16x32_bf16 v[104:107], a[0:3], a[244:247], v[104:107]
 buffer_load_dwordx4 a[228:231], v3, s[4:7], s59 offen offset:0 sc1
 v_mfma_f32_16x16x32_bf16 v[68:71], a[4:7], a[80:83], v[68:71]
 ds_read_b128 a[0:3], v6 offset:4096
 v_mfma_f32_16x16x32_bf16 v[108:111], a[4:7], a[244:247], v[108:111]
 ds_read_b128 a[4:7], v9 offset:0
 s_waitcnt vmcnt(33)
 v_mfma_f32_16x16x32_bf16 v[72:75], a[8:11], a[252:255], v[72:75]
 ds_read_b128 a[8:11], v9 offset:1024
 v_mfma_f32_16x16x32_bf16 v[76:79], a[12:15], a[252:255], v[76:79]
 v_mfma_f32_16x16x32_bf16 v[80:83], a[16:19], a[252:255], v[80:83]
 ds_read_b128 a[12:15], v9 offset:2048
 v_mfma_f32_16x16x32_bf16 v[84:87], a[20:23], a[252:255], v[84:87]
 buffer_load_dwordx4 a[232:235], v2, s[4:7], s59 offen offset:1024 sc1
 v_mfma_f32_16x16x32_bf16 v[88:91], a[24:27], a[252:255], v[88:91]
 ds_read_b128 a[16:19], v9 offset:3072
 s_waitcnt lgkmcnt(7)
 v_mfma_f32_16x16x32_bf16 v[52:55], a[28:31], a[84:87], v[52:55]
 v_mfma_f32_16x16x32_bf16 v[92:95], a[28:31], a[252:255], v[92:95]
 ds_read_b128 a[20:23], v9 offset:4096
 v_mfma_f32_16x16x32_bf16 v[56:59], a[32:35], a[84:87], v[56:59]
 buffer_load_dwordx4 a[236:239], v3, s[4:7], s59 offen offset:1024 sc1
 v_mfma_f32_16x16x32_bf16 v[96:99], a[32:35], a[252:255], v[96:99]
 ds_read_b128 a[24:27], v6 offset:10240
 v_mfma_f32_16x16x32_bf16 v[60:63], a[36:39], a[84:87], v[60:63]
 ds_read_b128 a[28:31], v6 offset:11264
 v_mfma_f32_16x16x32_bf16 v[100:103], a[36:39], a[252:255], v[100:103]
 ds_read_b128 a[32:35], v6 offset:12288
 v_mfma_f32_16x16x32_bf16 v[64:67], a[40:43], a[84:87], v[64:67]
 ds_read_b128 a[36:39], v6 offset:13312
 v_mfma_f32_16x16x32_bf16 v[104:107], a[40:43], a[252:255], v[104:107]
 ds_read_b128 a[40:43], v6 offset:14336
 v_mfma_f32_16x16x32_bf16 v[68:71], a[44:47], a[84:87], v[68:71]
 v_mfma_f32_16x16x32_bf16 v[108:111], a[44:47], a[252:255], v[108:111]
 ds_read_b128 a[44:47], v9 offset:10240
 s_waitcnt vmcnt(30)
 v_mfma_f32_16x16x32_bf16 v[72:75], a[48:51], a[180:183], v[72:75]
 ds_read_b128 a[48:51], v9 offset:11264
 v_mfma_f32_16x16x32_bf16 v[76:79], a[52:55], a[180:183], v[76:79]
 s_add_u32 s59, s72, 30720
 s_waitcnt lgkmcnt(7)
 v_mfma_f32_16x16x32_bf16 v[80:83], a[56:59], a[180:183], v[80:83]
 ds_read_b128 a[52:55], v9 offset:12288
 v_mfma_f32_16x16x32_bf16 v[84:87], a[60:63], a[180:183], v[84:87]
 v_mfma_f32_16x16x32_bf16 v[88:91], a[0:3], a[180:183], v[88:91]
 ds_read_b128 a[56:59], v9 offset:13312
 v_mfma_f32_16x16x32_bf16 v[52:55], a[4:7], a[176:179], v[52:55]
 v_mfma_f32_16x16x32_bf16 v[92:95], a[4:7], a[180:183], v[92:95]
 ds_read_b128 a[60:63], v9 offset:14336
 v_mfma_f32_16x16x32_bf16 v[56:59], a[8:11], a[176:179], v[56:59]
 buffer_load_dwordx4 a[240:243], v2, s[4:7], s59 offen offset:0 sc1
 v_mfma_f32_16x16x32_bf16 v[96:99], a[8:11], a[180:183], v[96:99]
 v_mfma_f32_16x16x32_bf16 v[60:63], a[12:15], a[176:179], v[60:63]
 v_mfma_f32_16x16x32_bf16 v[100:103], a[12:15], a[180:183], v[100:103]
 v_mfma_f32_16x16x32_bf16 v[64:67], a[16:19], a[176:179], v[64:67]
 buffer_load_dwordx4 a[244:247], v3, s[4:7], s59 offen offset:0 sc1
 v_mfma_f32_16x16x32_bf16 v[104:107], a[16:19], a[180:183], v[104:107]
 v_mfma_f32_16x16x32_bf16 v[68:71], a[20:23], a[176:179], v[68:71]
 v_mfma_f32_16x16x32_bf16 v[108:111], a[20:23], a[180:183], v[108:111]
 s_waitcnt lgkmcnt(1) vmcnt(29)
 v_mfma_f32_16x16x32_bf16 v[72:75], a[24:27], a[188:191], v[72:75]
 v_mfma_f32_16x16x32_bf16 v[76:79], a[28:31], a[188:191], v[76:79]
 v_mfma_f32_16x16x32_bf16 v[80:83], a[32:35], a[188:191], v[80:83]
 buffer_load_dwordx4 a[248:251], v2, s[4:7], s59 offen offset:1024 sc1
 v_mfma_f32_16x16x32_bf16 v[84:87], a[36:39], a[188:191], v[84:87]
 s_waitcnt lgkmcnt(0)
 s_barrier
 v_mfma_f32_16x16x32_bf16 v[88:91], a[40:43], a[188:191], v[88:91]
 ds_read_b128 a[0:3], v4 offset:0
 ds_read_b128 a[4:7], v4 offset:1024
 v_mfma_f32_16x16x32_bf16 v[52:55], a[44:47], a[184:187], v[52:55]
 ds_read_b128 a[8:11], v4 offset:2048
 ds_read_b128 a[12:15], v4 offset:3072
 v_mfma_f32_16x16x32_bf16 v[92:95], a[44:47], a[188:191], v[92:95]
 ds_read_b128 a[16:19], v4 offset:4096
 ds_read_b128 a[20:23], v7 offset:0
 v_mfma_f32_16x16x32_bf16 v[56:59], a[48:51], a[184:187], v[56:59]
 ds_read_b128 a[24:27], v7 offset:1024
 ds_read_b128 a[28:31], v7 offset:2048
 v_mfma_f32_16x16x32_bf16 v[96:99], a[48:51], a[188:191], v[96:99]
 buffer_load_dwordx4 a[252:255], v3, s[4:7], s59 offen offset:1024 sc1
 v_mfma_f32_16x16x32_bf16 v[60:63], a[52:55], a[184:187], v[60:63]
 ds_read_b128 a[32:35], v7 offset:3072
 ds_read_b128 a[36:39], v7 offset:4096
 v_mfma_f32_16x16x32_bf16 v[100:103], a[52:55], a[188:191], v[100:103]
 ds_read_b128 a[40:43], v4 offset:10240
 ds_read_b128 a[44:47], v4 offset:11264
 v_mfma_f32_16x16x32_bf16 v[64:67], a[56:59], a[184:187], v[64:67]
 ds_read_b128 a[48:51], v4 offset:12288
 ds_read_b128 a[52:55], v4 offset:13312
 v_mfma_f32_16x16x32_bf16 v[104:107], a[56:59], a[188:191], v[104:107]
 ds_read_b128 a[56:59], v4 offset:14336
 v_mfma_f32_16x16x32_bf16 v[68:71], a[60:63], a[184:187], v[68:71]
 v_mfma_f32_16x16x32_bf16 v[108:111], a[60:63], a[188:191], v[108:111]
 ds_read_b128 a[60:63], v7 offset:10240
 s_waitcnt lgkmcnt(15) vmcnt(25)
 v_mfma_f32_16x16x32_bf16 v[72:75], a[0:3], a[196:199], v[72:75]
 ds_read_b128 a[0:3], v7 offset:11264
 s_waitcnt lgkmcnt(14)
 v_mfma_f32_16x16x32_bf16 v[76:79], a[4:7], a[196:199], v[76:79]
 v_mfma_f32_16x16x32_bf16 v[80:83], a[8:11], a[196:199], v[80:83]
 ds_read_b128 a[4:7], v7 offset:12288
 s_waitcnt lgkmcnt(11)
 v_mfma_f32_16x16x32_bf16 v[84:87], a[12:15], a[196:199], v[84:87]
 v_mfma_f32_16x16x32_bf16 v[88:91], a[16:19], a[196:199], v[88:91]
 ds_read_b128 a[8:11], v7 offset:13312
 v_mfma_f32_16x16x32_bf16 v[52:55], a[20:23], a[192:195], v[52:55]
 v_mfma_f32_16x16x32_bf16 v[92:95], a[20:23], a[196:199], v[92:95]
 ds_read_b128 a[12:15], v7 offset:14336
 v_mfma_f32_16x16x32_bf16 v[56:59], a[24:27], a[192:195], v[56:59]
 v_mfma_f32_16x16x32_bf16 v[96:99], a[24:27], a[196:199], v[96:99]
 ds_read_b128 a[16:19], v4 offset:20480
 s_waitcnt lgkmcnt(6)
 v_mfma_f32_16x16x32_bf16 v[60:63], a[28:31], a[192:195], v[60:63]
 ds_read_b128 a[20:23], v4 offset:21504
 v_mfma_f32_16x16x32_bf16 v[100:103], a[28:31], a[196:199], v[100:103]
 ds_read_b128 a[24:27], v4 offset:22528
 v_mfma_f32_16x16x32_bf16 v[64:67], a[32:35], a[192:195], v[64:67]
 ds_read_b128 a[28:31], v4 offset:23552
 v_mfma_f32_16x16x32_bf16 v[104:107], a[32:35], a[196:199], v[104:107]
 ds_read_b128 a[32:35], v4 offset:24576
 v_mfma_f32_16x16x32_bf16 v[68:71], a[36:39], a[192:195], v[68:71]
 v_mfma_f32_16x16x32_bf16 v[108:111], a[36:39], a[196:199], v[108:111]
 ds_read_b128 a[36:39], v7 offset:20480
 s_waitcnt vmcnt(22)
 v_mfma_f32_16x16x32_bf16 v[72:75], a[40:43], a[204:207], v[72:75]
 ds_read_b128 a[40:43], v7 offset:21504
 v_mfma_f32_16x16x32_bf16 v[76:79], a[44:47], a[204:207], v[76:79]
 v_mfma_f32_16x16x32_bf16 v[80:83], a[48:51], a[204:207], v[80:83]
 ds_read_b128 a[44:47], v7 offset:22528
 v_mfma_f32_16x16x32_bf16 v[84:87], a[52:55], a[204:207], v[84:87]
 v_mfma_f32_16x16x32_bf16 v[88:91], a[56:59], a[204:207], v[88:91]
 ds_read_b128 a[48:51], v7 offset:23552
 s_waitcnt lgkmcnt(7)
 v_mfma_f32_16x16x32_bf16 v[52:55], a[60:63], a[200:203], v[52:55]
 s_waitcnt vmcnt(16)
 ds_bpermute_b32 v112, v18, v112
 v_mfma_f32_16x16x32_bf16 v[92:95], a[60:63], a[204:207], v[92:95]
 ds_read_b128 a[52:55], v7 offset:24576
 ds_bpermute_b32 v113, v18, v113
 v_mfma_f32_16x16x32_bf16 v[56:59], a[0:3], a[200:203], v[56:59]
 s_waitcnt vmcnt(13)
 ds_bpermute_b32 v114, v18, v114
 v_mfma_f32_16x16x32_bf16 v[96:99], a[0:3], a[204:207], v[96:99]
 ds_read_b128 a[56:59], v4 offset:30720
 ds_bpermute_b32 v115, v18, v115
 v_mfma_f32_16x16x32_bf16 v[60:63], a[4:7], a[200:203], v[60:63]
 ds_read_b128 a[60:63], v4 offset:31744
 s_waitcnt vmcnt(10)
 ds_bpermute_b32 v116, v18, v116
 v_mfma_f32_16x16x32_bf16 v[100:103], a[4:7], a[204:207], v[100:103]
 ds_read_b128 a[0:3], v4 offset:32768
 ds_bpermute_b32 v117, v18, v117
 v_mfma_f32_16x16x32_bf16 v[64:67], a[8:11], a[200:203], v[64:67]
 ds_read_b128 a[4:7], v4 offset:33792
 s_waitcnt vmcnt(9)
 ds_bpermute_b32 v118, v18, v118
 v_mfma_f32_16x16x32_bf16 v[104:107], a[8:11], a[204:207], v[104:107]
 ds_read_b128 a[8:11], v4 offset:34816
 ds_bpermute_b32 v119, v18, v119
 v_mfma_f32_16x16x32_bf16 v[68:71], a[12:15], a[200:203], v[68:71]
 s_waitcnt vmcnt(8)
 ds_bpermute_b32 v120, v18, v120
 v_mfma_f32_16x16x32_bf16 v[108:111], a[12:15], a[204:207], v[108:111]
 ds_read_b128 a[12:15], v7 offset:30720
 ds_bpermute_b32 v121, v18, v121
 v_mfma_f32_16x16x32_bf16 v[72:75], a[16:19], a[212:215], v[72:75]
 ds_read_b128 a[16:19], v7 offset:31744
 v_mfma_f32_16x16x32_bf16 v[76:79], a[20:23], a[212:215], v[76:79]
 s_waitcnt lgkmcnt(15)
 v_mfma_f32_16x16x32_bf16 v[80:83], a[24:27], a[212:215], v[80:83]
 ds_read_b128 a[20:23], v7 offset:32768
 v_mfma_f32_16x16x32_bf16 v[84:87], a[28:31], a[212:215], v[84:87]
 v_mfma_f32_16x16x32_bf16 v[88:91], a[32:35], a[212:215], v[88:91]
 ds_read_b128 a[24:27], v7 offset:33792
 v_mfma_f32_16x16x32_bf16 v[52:55], a[36:39], a[208:211], v[52:55]
 v_mfma_f32_16x16x32_bf16 v[92:95], a[36:39], a[212:215], v[92:95]
 ds_read_b128 a[28:31], v7 offset:34816
 v_mfma_f32_16x16x32_bf16 v[56:59], a[40:43], a[208:211], v[56:59]
 v_mfma_f32_16x16x32_bf16 v[96:99], a[40:43], a[212:215], v[96:99]
 v_mfma_f32_16x16x32_bf16 v[60:63], a[44:47], a[208:211], v[60:63]
 v_mfma_f32_16x16x32_bf16 v[100:103], a[44:47], a[212:215], v[100:103]
 v_mfma_f32_16x16x32_bf16 v[64:67], a[48:51], a[208:211], v[64:67]
 v_mfma_f32_16x16x32_bf16 v[104:107], a[48:51], a[212:215], v[104:107]
 v_mfma_f32_16x16x32_bf16 v[68:71], a[52:55], a[208:211], v[68:71]
 v_mfma_f32_16x16x32_bf16 v[108:111], a[52:55], a[212:215], v[108:111]
 s_waitcnt lgkmcnt(1)
 v_mfma_f32_16x16x32_bf16 v[72:75], a[56:59], a[220:223], v[72:75]
 v_mfma_f32_16x16x32_bf16 v[76:79], a[60:63], a[220:223], v[76:79]
 v_mfma_f32_16x16x32_bf16 v[80:83], a[0:3], a[220:223], v[80:83]
 v_mfma_f32_16x16x32_bf16 v[84:87], a[4:7], a[220:223], v[84:87]
 s_waitcnt lgkmcnt(0)
 s_barrier
 v_mfma_f32_16x16x32_bf16 v[88:91], a[8:11], a[220:223], v[88:91]
 ds_read_b128 a[32:35], v4 offset:40960
 ds_read_b128 a[36:39], v4 offset:41984
 v_mfma_f32_16x16x32_bf16 v[52:55], a[12:15], a[216:219], v[52:55]
 ds_read_b128 a[40:43], v4 offset:43008
 ds_read_b128 a[44:47], v4 offset:44032
 v_mfma_f32_16x16x32_bf16 v[92:95], a[12:15], a[220:223], v[92:95]
 ds_read_b128 a[48:51], v4 offset:45056
 ds_read_b128 a[52:55], v7 offset:40960
 v_mfma_f32_16x16x32_bf16 v[56:59], a[16:19], a[216:219], v[56:59]
 ds_read_b128 a[56:59], v7 offset:41984
 ds_read_b128 a[60:63], v7 offset:43008
 v_mfma_f32_16x16x32_bf16 v[96:99], a[16:19], a[220:223], v[96:99]
 ds_read_b128 a[0:3], v7 offset:44032
 ds_read_b128 a[4:7], v7 offset:45056
 v_mfma_f32_16x16x32_bf16 v[60:63], a[20:23], a[216:219], v[60:63]
 ds_read_b128 a[8:11], v4 offset:51200
 ds_read_b128 a[12:15], v4 offset:52224
 v_mfma_f32_16x16x32_bf16 v[100:103], a[20:23], a[220:223], v[100:103]
 ds_read_b128 a[16:19], v4 offset:53248
 v_lshlrev_b32 v28, 16, v112
 v_mfma_f32_16x16x32_bf16 v[64:67], a[24:27], a[216:219], v[64:67]
 ds_read_b128 a[20:23], v4 offset:54272
 v_and_b32 v29, 0xffff0000, v112
 v_mfma_f32_16x16x32_bf16 v[104:107], a[24:27], a[220:223], v[104:107]
 ds_read_b128 a[24:27], v4 offset:55296
 v_add_f32 v172, v172, v28
 v_mfma_f32_16x16x32_bf16 v[68:71], a[28:31], a[216:219], v[68:71]
 v_add_f32 v173, v173, v29
 v_lshlrev_b32 v28, 16, v113
 v_mfma_f32_16x16x32_bf16 v[108:111], a[28:31], a[220:223], v[108:111]
 ds_read_b128 a[28:31], v7 offset:51200
 s_waitcnt lgkmcnt(15) vmcnt(6)
 v_mfma_f32_16x16x32_bf16 v[72:75], a[32:35], a[228:231], v[72:75]
 ds_read_b128 a[32:35], v7 offset:52224
 s_waitcnt lgkmcnt(14)
 v_mfma_f32_16x16x32_bf16 v[76:79], a[36:39], a[228:231], v[76:79]
 v_and_b32 v29, 0xffff0000, v113
 v_add_f32 v174, v174, v28
 v_mfma_f32_16x16x32_bf16 v[80:83], a[40:43], a[228:231], v[80:83]
 ds_read_b128 a[36:39], v7 offset:53248
 s_waitcnt lgkmcnt(11)
 v_mfma_f32_16x16x32_bf16 v[84:87], a[44:47], a[228:231], v[84:87]
 v_add_f32 v175, v175, v29
 v_lshlrev_b32 v28, 16, v114
 v_mfma_f32_16x16x32_bf16 v[88:91], a[48:51], a[228:231], v[88:91]
 ds_read_b128 a[40:43], v7 offset:54272
 v_and_b32 v29, 0xffff0000, v114
 v_mfma_f32_16x16x32_bf16 v[52:55], a[52:55], a[224:227], v[52:55]
 v_add_f32 v176, v176, v28
 v_mfma_f32_16x16x32_bf16 v[92:95], a[52:55], a[228:231], v[92:95]
 ds_read_b128 a[44:47], v7 offset:55296
 v_add_f32 v177, v177, v29
 v_mfma_f32_16x16x32_bf16 v[56:59], a[56:59], a[224:227], v[56:59]
 v_mfma_f32_16x16x32_bf16 v[96:99], a[56:59], a[228:231], v[96:99]
 ds_read_b128 a[48:51], v5 offset:0
 s_waitcnt lgkmcnt(6)
 v_mfma_f32_16x16x32_bf16 v[60:63], a[60:63], a[224:227], v[60:63]
 ds_read_b128 a[52:55], v5 offset:1024
 v_lshlrev_b32 v28, 16, v115
 v_mfma_f32_16x16x32_bf16 v[100:103], a[60:63], a[228:231], v[100:103]
 ds_read_b128 a[56:59], v5 offset:2048
 v_and_b32 v29, 0xffff0000, v115
 v_mfma_f32_16x16x32_bf16 v[64:67], a[0:3], a[224:227], v[64:67]
 ds_read_b128 a[60:63], v5 offset:3072
 v_add_f32 v178, v178, v28
 v_mfma_f32_16x16x32_bf16 v[104:107], a[0:3], a[228:231], v[104:107]
 ds_read_b128 a[0:3], v5 offset:4096
 v_add_f32 v179, v179, v29
 v_mfma_f32_16x16x32_bf16 v[68:71], a[4:7], a[224:227], v[68:71]
 v_mfma_f32_16x16x32_bf16 v[108:111], a[4:7], a[228:231], v[108:111]
 ds_read_b128 a[4:7], v8 offset:0
 s_waitcnt vmcnt(4)
 v_mfma_f32_16x16x32_bf16 v[72:75], a[8:11], a[236:239], v[72:75]
 ds_read_b128 a[8:11], v8 offset:1024
 v_lshlrev_b32 v28, 16, v116
 v_mfma_f32_16x16x32_bf16 v[76:79], a[12:15], a[236:239], v[76:79]
 v_and_b32 v29, 0xffff0000, v116
 v_mfma_f32_16x16x32_bf16 v[80:83], a[16:19], a[236:239], v[80:83]
 ds_read_b128 a[12:15], v8 offset:2048
 v_add_f32 v180, v180, v28
 v_mfma_f32_16x16x32_bf16 v[84:87], a[20:23], a[236:239], v[84:87]
 v_add_f32 v181, v181, v29
 v_mfma_f32_16x16x32_bf16 v[88:91], a[24:27], a[236:239], v[88:91]
 ds_read_b128 a[16:19], v8 offset:3072
 s_waitcnt lgkmcnt(7)
 v_mfma_f32_16x16x32_bf16 v[52:55], a[28:31], a[232:235], v[52:55]
 v_lshlrev_b32 v28, 16, v117
 v_mfma_f32_16x16x32_bf16 v[92:95], a[28:31], a[236:239], v[92:95]
 ds_read_b128 a[20:23], v8 offset:4096
 v_and_b32 v29, 0xffff0000, v117
 v_mfma_f32_16x16x32_bf16 v[56:59], a[32:35], a[232:235], v[56:59]
 v_mfma_f32_16x16x32_bf16 v[96:99], a[32:35], a[236:239], v[96:99]
 ds_read_b128 a[24:27], v5 offset:10240
 v_add_f32 v182, v182, v28
 v_mfma_f32_16x16x32_bf16 v[60:63], a[36:39], a[232:235], v[60:63]
 ds_read_b128 a[28:31], v5 offset:11264
 v_add_f32 v183, v183, v29
 v_mfma_f32_16x16x32_bf16 v[100:103], a[36:39], a[236:239], v[100:103]
 ds_read_b128 a[32:35], v5 offset:12288
 v_mfma_f32_16x16x32_bf16 v[64:67], a[40:43], a[232:235], v[64:67]
 ds_read_b128 a[36:39], v5 offset:13312
 v_lshlrev_b32 v28, 16, v118
 v_mfma_f32_16x16x32_bf16 v[104:107], a[40:43], a[236:239], v[104:107]
 ds_read_b128 a[40:43], v5 offset:14336
 v_and_b32 v29, 0xffff0000, v118
 v_mfma_f32_16x16x32_bf16 v[68:71], a[44:47], a[232:235], v[68:71]
 v_mfma_f32_16x16x32_bf16 v[108:111], a[44:47], a[236:239], v[108:111]
 ds_read_b128 a[44:47], v8 offset:10240
 s_waitcnt vmcnt(2)
 v_mfma_f32_16x16x32_bf16 v[72:75], a[48:51], a[244:247], v[72:75]
 ds_read_b128 a[48:51], v8 offset:11264
 v_add_f32 v184, v184, v28
 v_mfma_f32_16x16x32_bf16 v[76:79], a[52:55], a[244:247], v[76:79]
 v_add_f32 v185, v185, v29
 s_waitcnt lgkmcnt(7)
 v_mfma_f32_16x16x32_bf16 v[80:83], a[56:59], a[244:247], v[80:83]
 ds_read_b128 a[52:55], v8 offset:12288
 v_lshlrev_b32 v28, 16, v119
 v_mfma_f32_16x16x32_bf16 v[84:87], a[60:63], a[244:247], v[84:87]
 v_and_b32 v29, 0xffff0000, v119
 v_mfma_f32_16x16x32_bf16 v[88:91], a[0:3], a[244:247], v[88:91]
 ds_read_b128 a[56:59], v8 offset:13312
 v_mfma_f32_16x16x32_bf16 v[52:55], a[4:7], a[240:243], v[52:55]
 v_add_f32 v186, v186, v28
 v_mfma_f32_16x16x32_bf16 v[92:95], a[4:7], a[244:247], v[92:95]
 ds_read_b128 a[60:63], v8 offset:14336
 v_add_f32 v187, v187, v29
 v_mfma_f32_16x16x32_bf16 v[56:59], a[8:11], a[240:243], v[56:59]
 v_mfma_f32_16x16x32_bf16 v[96:99], a[8:11], a[244:247], v[96:99]
 ds_read_b128 a[0:3], v6 offset:20480
 v_lshlrev_b32 v28, 16, v120
 v_mfma_f32_16x16x32_bf16 v[60:63], a[12:15], a[240:243], v[60:63]
 ds_read_b128 a[4:7], v6 offset:21504
 v_and_b32 v29, 0xffff0000, v120
 v_mfma_f32_16x16x32_bf16 v[100:103], a[12:15], a[244:247], v[100:103]
 ds_read_b128 a[8:11], v6 offset:22528
 v_mfma_f32_16x16x32_bf16 v[64:67], a[16:19], a[240:243], v[64:67]
 ds_read_b128 a[12:15], v6 offset:23552
 v_add_f32 v188, v188, v28
 v_mfma_f32_16x16x32_bf16 v[104:107], a[16:19], a[244:247], v[104:107]
 ds_read_b128 a[16:19], v6 offset:24576
 v_add_f32 v189, v189, v29
 v_mfma_f32_16x16x32_bf16 v[68:71], a[20:23], a[240:243], v[68:71]
 v_mfma_f32_16x16x32_bf16 v[108:111], a[20:23], a[244:247], v[108:111]
 ds_read_b128 a[20:23], v6 offset:30720
 s_waitcnt lgkmcnt(7) vmcnt(0)
 v_mfma_f32_16x16x32_bf16 v[72:75], a[24:27], a[252:255], v[72:75]
 ds_read_b128 a[24:27], v6 offset:31744
 v_lshlrev_b32 v28, 16, v121
 v_mfma_f32_16x16x32_bf16 v[76:79], a[28:31], a[252:255], v[76:79]
 ds_read_b128 a[28:31], v6 offset:32768
 v_and_b32 v29, 0xffff0000, v121
 v_mfma_f32_16x16x32_bf16 v[80:83], a[32:35], a[252:255], v[80:83]
 ds_read_b128 a[32:35], v6 offset:33792
 v_add_f32 v190, v190, v28
 v_mfma_f32_16x16x32_bf16 v[84:87], a[36:39], a[252:255], v[84:87]
 ds_read_b128 a[36:39], v6 offset:34816
 v_add_f32 v191, v191, v29
 v_mfma_f32_16x16x32_bf16 v[88:91], a[40:43], a[252:255], v[88:91]
 ds_read_b128 a[40:43], v5 offset:20480
 v_mfma_f32_16x16x32_bf16 v[52:55], a[44:47], a[248:251], v[52:55]
 v_mfma_f32_16x16x32_bf16 v[92:95], a[44:47], a[252:255], v[92:95]
 ds_read_b128 a[44:47], v5 offset:21504
 v_mfma_f32_16x16x32_bf16 v[56:59], a[48:51], a[248:251], v[56:59]
 v_mfma_f32_16x16x32_bf16 v[96:99], a[48:51], a[252:255], v[96:99]
 ds_read_b128 a[48:51], v5 offset:22528
 v_mfma_f32_16x16x32_bf16 v[60:63], a[52:55], a[248:251], v[60:63]
 v_mfma_f32_16x16x32_bf16 v[100:103], a[52:55], a[252:255], v[100:103]
 ds_read_b128 a[52:55], v5 offset:23552
 v_mfma_f32_16x16x32_bf16 v[64:67], a[56:59], a[248:251], v[64:67]
 v_mfma_f32_16x16x32_bf16 v[104:107], a[56:59], a[252:255], v[104:107]
 ds_read_b128 a[56:59], v5 offset:24576
 s_waitcnt lgkmcnt(6)
 v_mfma_f32_16x16x32_bf16 v[68:71], a[60:63], a[248:251], v[68:71]
 v_mfma_f32_16x16x32_bf16 v[108:111], a[60:63], a[252:255], v[108:111]
 ds_read_b128 a[60:63], v5 offset:30720
 v_mfma_f32_16x16x32_bf16 v[32:35], a[0:3], a[64:67], v[32:35]
 ds_read_b128 a[0:3], v5 offset:31744
 v_mfma_f32_16x16x32_bf16 v[36:39], a[4:7], a[64:67], v[36:39]
 ds_read_b128 a[4:7], v5 offset:32768
 v_mfma_f32_16x16x32_bf16 v[40:43], a[8:11], a[64:67], v[40:43]
 ds_read_b128 a[8:11], v5 offset:33792
 v_mfma_f32_16x16x32_bf16 v[44:47], a[12:15], a[64:67], v[44:47]
 v_cvt_pk_bf16_f32 v92, v92, v93
 v_cvt_pk_bf16_f32 v93, v94, v95
 v_cvt_pk_bf16_f32 v94, v96, v97
 v_cvt_pk_bf16_f32 v95, v98, v99
 buffer_store_dwordx4 v[92:95], v14, s[4:7], s30 offen offset:0 sc1
 v_mfma_f32_16x16x32_bf16 v[48:51], a[16:19], a[64:67], v[48:51]
 v_cvt_pk_bf16_f32 v96, v100, v101
 v_cvt_pk_bf16_f32 v97, v102, v103
 v_cvt_pk_bf16_f32 v98, v104, v105
 v_cvt_pk_bf16_f32 v99, v106, v107
 buffer_store_dwordx4 v[96:99], v14, s[4:7], s30 offen offset:1024 sc1
 v_mfma_f32_16x16x32_bf16 v[32:35], a[20:23], a[68:71], v[32:35]
 v_cvt_pk_bf16_f32 v100, v108, v109
 v_cvt_pk_bf16_f32 v101, v110, v111
 v_add3_u32 v102, v27, v92, v93
 v_add3_u32 v102, v102, v94, v95
 v_add3_u32 v102, v102, v96, v97
 v_mfma_f32_16x16x32_bf16 v[36:39], a[24:27], a[68:71], v[36:39]
 v_add3_u32 v102, v102, v98, v99
 v_add3_u32 v102, v102, v100, v101
 buffer_store_dwordx4 v[100:103], v14, s[4:7], s30 offen offset:2048 sc1
 v_cvt_pk_bf16_f32 v72, v72, v73
 v_cvt_pk_bf16_f32 v73, v74, v75
 v_mfma_f32_16x16x32_bf16 v[40:43], a[28:31], a[68:71], v[40:43]
 v_cvt_pk_bf16_f32 v74, v76, v77
 v_cvt_pk_bf16_f32 v75, v78, v79
 buffer_store_dwordx4 v[72:75], v14, s[4:7], s29 offen offset:0 sc1
 v_cvt_pk_bf16_f32 v76, v80, v81
 v_cvt_pk_bf16_f32 v77, v82, v83
 v_mfma_f32_16x16x32_bf16 v[44:47], a[32:35], a[68:71], v[44:47]
 v_cvt_pk_bf16_f32 v78, v84, v85
 v_cvt_pk_bf16_f32 v79, v86, v87
 buffer_store_dwordx4 v[76:79], v14, s[4:7], s29 offen offset:1024 sc1
 v_cvt_pk_bf16_f32 v80, v88, v89
 v_cvt_pk_bf16_f32 v81, v90, v91
 s_waitcnt lgkmcnt(0)
 v_mfma_f32_16x16x32_bf16 v[48:51], a[36:39], a[68:71], v[48:51]
 v_add3_u32 v82, v27, v72, v73
 v_add3_u32 v82, v82, v74, v75
 v_add3_u32 v82, v82, v76, v77
 v_add3_u32 v82, v82, v78, v79
 v_add3_u32 v82, v82, v80, v81
 v_mfma_f32_16x16x32_bf16 v[32:35], a[40:43], a[72:75], v[32:35]
 buffer_store_dwordx4 v[80:83], v14, s[4:7], s29 offen offset:2048 sc1
 v_cvt_pk_bf16_f32 v52, v52, v53
 v_cvt_pk_bf16_f32 v53, v54, v55
 v_cvt_pk_bf16_f32 v54, v56, v57
 v_cvt_pk_bf16_f32 v55, v58, v59
 v_mfma_f32_16x16x32_bf16 v[36:39], a[44:47], a[72:75], v[36:39]
 buffer_store_dwordx4 v[52:55], v14, s[4:7], s28 offen offset:0 sc1
 v_cvt_pk_bf16_f32 v56, v60, v61
 v_cvt_pk_bf16_f32 v57, v62, v63
 v_cvt_pk_bf16_f32 v58, v64, v65
 v_cvt_pk_bf16_f32 v59, v66, v67
 v_mfma_f32_16x16x32_bf16 v[40:43], a[48:51], a[72:75], v[40:43]
 buffer_store_dwordx4 v[56:59], v14, s[4:7], s28 offen offset:1024 sc1
 v_cvt_pk_bf16_f32 v60, v68, v69
 v_cvt_pk_bf16_f32 v61, v70, v71
 v_add3_u32 v62, v27, v52, v53
 v_add3_u32 v62, v62, v54, v55
 ds_read_b128 a[12:15], v5 offset:34816
 v_mfma_f32_16x16x32_bf16 v[44:47], a[52:55], a[72:75], v[44:47]
 v_add3_u32 v62, v62, v56, v57
 v_add3_u32 v62, v62, v58, v59
 v_add3_u32 v62, v62, v60, v61
 buffer_store_dwordx4 v[60:63], v14, s[4:7], s28 offen offset:2048 sc1
 ds_read_b128 a[16:19], v5 offset:40960
 v_mfma_f32_16x16x32_bf16 v[48:51], a[56:59], a[72:75], v[48:51]
 ds_read_b128 a[20:23], v5 offset:41984
 ds_read_b128 a[24:27], v5 offset:43008
 v_mfma_f32_16x16x32_bf16 v[32:35], a[60:63], a[76:79], v[32:35]
 ds_read_b128 a[28:31], v5 offset:44032
 ds_read_b128 a[32:35], v5 offset:45056
 v_mfma_f32_16x16x32_bf16 v[36:39], a[0:3], a[76:79], v[36:39]
 ds_read_b128 a[36:39], v5 offset:51200
 ds_read_b128 a[40:43], v5 offset:52224
 v_mfma_f32_16x16x32_bf16 v[40:43], a[4:7], a[76:79], v[40:43]
 ds_read_b128 a[44:47], v5 offset:53248
 ds_read_b128 a[48:51], v5 offset:54272
 v_mfma_f32_16x16x32_bf16 v[44:47], a[8:11], a[76:79], v[44:47]
 ds_read_b128 a[52:55], v5 offset:55296
 s_waitcnt lgkmcnt(10)
 v_mfma_f32_16x16x32_bf16 v[48:51], a[12:15], a[76:79], v[48:51]
 ds_read_b128 a[56:59], v6 offset:0
 s_waitcnt lgkmcnt(10)
 v_mfma_f32_16x16x32_bf16 v[32:35], a[16:19], a[80:83], v[32:35]
 ds_read_b128 a[60:63], v6 offset:1024
 s_waitcnt lgkmcnt(10)
 v_mfma_f32_16x16x32_bf16 v[36:39], a[20:23], a[80:83], v[36:39]
 ds_read_b128 a[0:3], v6 offset:2048
 s_waitcnt lgkmcnt(10)
 v_mfma_f32_16x16x32_bf16 v[40:43], a[24:27], a[80:83], v[40:43]
 ds_read_b128 a[4:7], v6 offset:3072
 s_waitcnt lgkmcnt(10)
 v_mfma_f32_16x16x32_bf16 v[44:47], a[28:31], a[80:83], v[44:47]
 ds_read_b128 a[8:11], v6 offset:4096
 s_waitcnt lgkmcnt(10)
 v_mfma_f32_16x16x32_bf16 v[48:51], a[32:35], a[80:83], v[48:51]
 ds_read_b128 a[12:15], v6 offset:10240
 s_waitcnt lgkmcnt(10)
 v_mfma_f32_16x16x32_bf16 v[32:35], a[36:39], a[84:87], v[32:35]
 ds_read_b128 a[16:19], v6 offset:11264
 s_waitcnt lgkmcnt(10)
 v_mfma_f32_16x16x32_bf16 v[36:39], a[40:43], a[84:87], v[36:39]
 ds_read_b128 a[20:23], v6 offset:12288
 s_waitcnt lgkmcnt(10)
 v_mfma_f32_16x16x32_bf16 v[40:43], a[44:47], a[84:87], v[40:43]
 ds_read_b128 a[24:27], v6 offset:13312
 s_waitcnt lgkmcnt(10)
 v_mfma_f32_16x16x32_bf16 v[44:47], a[48:51], a[84:87], v[44:47]
 ds_read_b128 a[28:31], v6 offset:14336
 s_waitcnt lgkmcnt(10)
 v_mfma_f32_16x16x32_bf16 v[48:51], a[52:55], a[84:87], v[48:51]
 ds_read_b128 a[32:35], v4 offset:0
 s_waitcnt lgkmcnt(10)
 v_mfma_f32_16x16x32_bf16 v[32:35], a[56:59], a[176:179], v[32:35]
 ds_read_b128 a[36:39], v4 offset:1024
 s_waitcnt lgkmcnt(10)
 v_mfma_f32_16x16x32_bf16 v[36:39], a[60:63], a[176:179], v[36:39]
 ds_read_b128 a[40:43], v4 offset:2048
 s_waitcnt lgkmcnt(10)
 v_mfma_f32_16x16x32_bf16 v[40:43], a[0:3], a[176:179], v[40:43]
 ds_read_b128 a[44:47], v4 offset:3072
 s_waitcnt lgkmcnt(10)
 v_mfma_f32_16x16x32_bf16 v[44:47], a[4:7], a[176:179], v[44:47]
 ds_read_b128 a[48:51], v4 offset:4096
 s_waitcnt lgkmcnt(10)
 v_mfma_f32_16x16x32_bf16 v[48:51], a[8:11], a[176:179], v[48:51]
 ds_read_b128 a[52:55], v4 offset:10240
 s_waitcnt lgkmcnt(10)
 v_mfma_f32_16x16x32_bf16 v[32:35], a[12:15], a[184:187], v[32:35]
 ds_read_b128 a[56:59], v4 offset:11264
 s_waitcnt lgkmcnt(10)
 v_mfma_f32_16x16x32_bf16 v[36:39], a[16:19], a[184:187], v[36:39]
 ds_read_b128 a[60:63], v4 offset:12288
 s_waitcnt lgkmcnt(10)
 v_mfma_f32_16x16x32_bf16 v[40:43], a[20:23], a[184:187], v[40:43]
 ds_read_b128 a[0:3], v4 offset:13312
 s_waitcnt lgkmcnt(10)
 v_mfma_f32_16x16x32_bf16 v[44:47], a[24:27], a[184:187], v[44:47]
 ds_read_b128 a[4:7], v4 offset:14336
 s_waitcnt lgkmcnt(10)
 v_mfma_f32_16x16x32_bf16 v[48:51], a[28:31], a[184:187], v[48:51]
 ds_read_b128 a[8:11], v4 offset:20480
 s_waitcnt lgkmcnt(10)
 v_mfma_f32_16x16x32_bf16 v[32:35], a[32:35], a[192:195], v[32:35]
 ds_read_b128 a[12:15], v4 offset:21504
 s_waitcnt lgkmcnt(10)
 v_mfma_f32_16x16x32_bf16 v[36:39], a[36:39], a[192:195], v[36:39]
 ds_read_b128 a[16:19], v4 offset:22528
 s_waitcnt lgkmcnt(10)
 v_mfma_f32_16x16x32_bf16 v[40:43], a[40:43], a[192:195], v[40:43]
 ds_read_b128 a[20:23], v4 offset:23552
 s_waitcnt lgkmcnt(10)
 v_mfma_f32_16x16x32_bf16 v[44:47], a[44:47], a[192:195], v[44:47]
 ds_read_b128 a[24:27], v4 offset:24576
 s_waitcnt lgkmcnt(10)
 v_mfma_f32_16x16x32_bf16 v[48:51], a[48:51], a[192:195], v[48:51]
 ds_read_b128 a[28:31], v4 offset:30720
 s_waitcnt lgkmcnt(10)
 v_mfma_f32_16x16x32_bf16 v[32:35], a[52:55], a[200:203], v[32:35]
 ds_read_b128 a[32:35], v4 offset:31744
 s_waitcnt lgkmcnt(10)
 v_mfma_f32_16x16x32_bf16 v[36:39], a[56:59], a[200:203], v[36:39]
 ds_read_b128 a[36:39], v4 offset:32768
 s_waitcnt lgkmcnt(10)
 v_mfma_f32_16x16x32_bf16 v[40:43], a[60:63], a[200:203], v[40:43]
 ds_read_b128 a[40:43], v4 offset:33792
 s_waitcnt lgkmcnt(10)
 v_mfma_f32_16x16x32_bf16 v[44:47], a[0:3], a[200:203], v[44:47]
 ds_read_b128 a[44:47], v4 offset:34816
 s_waitcnt lgkmcnt(10)
 v_mfma_f32_16x16x32_bf16 v[48:51], a[4:7], a[200:203], v[48:51]
 ds_read_b128 a[48:51], v4 offset:40960
 s_waitcnt lgkmcnt(10)
 v_mfma_f32_16x16x32_bf16 v[32:35], a[8:11], a[208:211], v[32:35]
 ds_read_b128 a[52:55], v4 offset:41984
 s_waitcnt lgkmcnt(10)
 v_mfma_f32_16x16x32_bf16 v[36:39], a[12:15], a[208:211], v[36:39]
 ds_read_b128 a[56:59], v4 offset:43008
 s_waitcnt lgkmcnt(10)
 v_mfma_f32_16x16x32_bf16 v[40:43], a[16:19], a[208:211], v[40:43]
 ds_read_b128 a[60:63], v4 offset:44032
 s_waitcnt lgkmcnt(10)
 v_mfma_f32_16x16x32_bf16 v[44:47], a[20:23], a[208:211], v[44:47]
 ds_read_b128 a[0:3], v4 offset:45056
 s_waitcnt lgkmcnt(10)
 v_mfma_f32_16x16x32_bf16 v[48:51], a[24:27], a[208:211], v[48:51]
 ds_read_b128 a[4:7], v4 offset:51200
 s_waitcnt lgkmcnt(10)
 v_mfma_f32_16x16x32_bf16 v[32:35], a[28:31], a[216:219], v[32:35]
 ds_read_b128 a[8:11], v4 offset:52224
 s_waitcnt lgkmcnt(10)
 v_mfma_f32_16x16x32_bf16 v[36:39], a[32:35], a[216:219], v[36:39]
 ds_read_b128 a[12:15], v4 offset:53248
 s_waitcnt lgkmcnt(10)
 v_mfma_f32_16x16x32_bf16 v[40:43], a[36:39], a[216:219], v[40:43]
 ds_read_b128 a[16:19], v4 offset:54272
 s_waitcnt lgkmcnt(10)
 v_mfma_f32_16x16x32_bf16 v[44:47], a[40:43], a[216:219], v[44:47]
 ds_read_b128 a[20:23], v4 offset:55296
 s_waitcnt lgkmcnt(10)
 v_mfma_f32_16x16x32_bf16 v[48:51], a[44:47], a[216:219], v[48:51]
 ds_read_b128 a[24:27], v5 offset:0
 s_waitcnt lgkmcnt(10)
 v_mfma_f32_16x16x32_bf16 v[32:35], a[48:51], a[224:227], v[32:35]
 ds_read_b128 a[28:31], v5 offset:1024
 s_waitcnt lgkmcnt(10)
 v_mfma_f32_16x16x32_bf16 v[36:39], a[52:55], a[224:227], v[36:39]
 ds_read_b128 a[32:35], v5 offset:2048
 s_waitcnt lgkmcnt(10)
 v_mfma_f32_16x16x32_bf16 v[40:43], a[56:59], a[224:227], v[40:43]
 ds_read_b128 a[36:39], v5 offset:3072
 s_waitcnt lgkmcnt(10)
 v_mfma_f32_16x16x32_bf16 v[44:47], a[60:63], a[224:227], v[44:47]
 ds_read_b128 a[40:43], v5 offset:4096
 s_waitcnt lgkmcnt(10)
 v_mfma_f32_16x16x32_bf16 v[48:51], a[0:3], a[224:227], v[48:51]
 ds_read_b128 a[44:47], v5 offset:10240
 s_waitcnt lgkmcnt(10)
 v_mfma_f32_16x16x32_bf16 v[32:35], a[4:7], a[232:235], v[32:35]
 ds_read_b128 a[48:51], v5 offset:11264
 s_waitcnt lgkmcnt(10)
 v_mfma_f32_16x16x32_bf16 v[36:39], a[8:11], a[232:235], v[36:39]
 ds_read_b128 a[52:55], v5 offset:12288
 s_waitcnt lgkmcnt(10)
 v_mfma_f32_16x16x32_bf16 v[40:43], a[12:15], a[232:235], v[40:43]
 ds_read_b128 a[56:59], v5 offset:13312
 s_waitcnt lgkmcnt(10)
 v_mfma_f32_16x16x32_bf16 v[44:47], a[16:19], a[232:235], v[44:47]
 ds_read_b128 a[60:63], v5 offset:14336
 s_waitcnt lgkmcnt(10)
 v_mfma_f32_16x16x32_bf16 v[48:51], a[20:23], a[232:235], v[48:51]
 s_add_u32 s57, s31, 0
 s_waitcnt lgkmcnt(9)
 v_mfma_f32_16x16x32_bf16 v[32:35], a[24:27], a[240:243], v[32:35]
 s_waitcnt lgkmcnt(8)
 v_mfma_f32_16x16x32_bf16 v[36:39], a[28:31], a[240:243], v[36:39]
 s_waitcnt lgkmcnt(7)
 v_mfma_f32_16x16x32_bf16 v[40:43], a[32:35], a[240:243], v[40:43]
 s_waitcnt lgkmcnt(6)
 v_mfma_f32_16x16x32_bf16 v[44:47], a[36:39], a[240:243], v[44:47]
 s_waitcnt lgkmcnt(5)
 v_mfma_f32_16x16x32_bf16 v[48:51], a[40:43], a[240:243], v[48:51]
 s_waitcnt lgkmcnt(4)
 v_mfma_f32_16x16x32_bf16 v[32:35], a[44:47], a[248:251], v[32:35]
 s_waitcnt lgkmcnt(3)
 v_mfma_f32_16x16x32_bf16 v[36:39], a[48:51], a[248:251], v[36:39]
 s_waitcnt lgkmcnt(2)
 v_mfma_f32_16x16x32_bf16 v[40:43], a[52:55], a[248:251], v[40:43]
 s_waitcnt lgkmcnt(1)
 v_mfma_f32_16x16x32_bf16 v[44:47], a[56:59], a[248:251], v[44:47]
 s_waitcnt lgkmcnt(0)
 v_mfma_f32_16x16x32_bf16 v[48:51], a[60:63], a[248:251], v[48:51]
 buffer_load_dwordx4 v[136:139], v14, s[4:7], s57 offen offset:0 sc1
 buffer_load_dwordx4 v[140:143], v14, s[4:7], s57 offen offset:1024 sc1
 buffer_load_dwordx4 v[144:147], v14, s[4:7], s57 offen offset:2048 sc1
 s_add_u32 s57, s31, 12288
 buffer_load_dwordx4 v[148:151], v14, s[4:7], s57 offen offset:0 sc1
 buffer_load_dwordx4 v[152:155], v14, s[4:7], s57 offen offset:1024 sc1
 buffer_load_dwordx4 v[156:159], v14, s[4:7], s57 offen offset:2048 sc1
 s_add_u32 s57, s31, 24576
 buffer_load_dwordx4 v[160:163], v14, s[4:7], s57 offen offset:0 sc1
 buffer_load_dwordx4 v[164:167], v14, s[4:7], s57 offen offset:1024 sc1
 buffer_load_dwordx4 v[168:171], v14, s[4:7], s57 offen offset:2048 sc1
 s_branch L_Dj
L_Dodd:
 ds_read_b128 a[0:3], v6 offset:20480
 ds_read_b128 a[4:7], v6 offset:21504
 ds_read_b128 a[8:11], v6 offset:22528
 ds_read_b128 a[12:15], v6 offset:23552
 ds_read_b128 a[16:19], v6 offset:24576
 ds_read_b128 a[20:23], v9 offset:20480
 ds_read_b128 a[24:27], v9 offset:21504
 ds_read_b128 a[28:31], v9 offset:22528
 ds_read_b128 a[32:35], v9 offset:23552
 ds_read_b128 a[36:39], v9 offset:24576
 ds_read_b128 a[40:43], v6 offset:30720
 s_waitcnt lgkmcnt(10)
 v_mfma_f32_16x16x32_bf16 v[32:35], a[0:3], a[192:195], 0
 ds_read_b128 a[44:47], v6 offset:31744
 v_mfma_f32_16x16x32_bf16 v[72:75], a[0:3], a[196:199], 0
 s_waitcnt lgkmcnt(10)
 v_mfma_f32_16x16x32_bf16 v[36:39], a[4:7], a[192:195], 0
 ds_read_b128 a[48:51], v6 offset:32768
 s_add_u32 s79, s79, 32768
 v_mfma_f32_16x16x32_bf16 v[76:79], a[4:7], a[196:199], 0
 s_waitcnt lgkmcnt(10)
 v_mfma_f32_16x16x32_bf16 v[40:43], a[8:11], a[192:195], 0
 ds_read_b128 a[52:55], v6 offset:33792
 v_mfma_f32_16x16x32_bf16 v[80:83], a[8:11], a[196:199], 0
 s_waitcnt lgkmcnt(10)
 v_mfma_f32_16x16x32_bf16 v[44:47], a[12:15], a[192:195], 0
 ds_read_b128 a[56:59], v6 offset:34816
 v_mfma_f32_16x16x32_bf16 v[84:87], a[12:15], a[196:199], 0
 s_waitcnt lgkmcnt(10)
 v_mfma_f32_16x16x32_bf16 v[48:51], a[16:19], a[192:195], 0
 ds_read_b128 a[60:63], v9 offset:30720
 v_mfma_f32_16x16x32_bf16 v[88:91], a[16:19], a[196:199], 0
 s_waitcnt lgkmcnt(5)
 v_mfma_f32_16x16x32_bf16 v[52:55], a[20:23], a[192:195], 0
 ds_read_b128 a[0:3], v9 offset:31744
 v_mfma_f32_16x16x32_bf16 v[92:95], a[20:23], a[196:199], 0
 v_mfma_f32_16x16x32_bf16 v[56:59], a[24:27], a[192:195], 0
 ds_read_b128 a[4:7], v9 offset:32768
 v_mfma_f32_16x16x32_bf16 v[96:99], a[24:27], a[196:199], 0
 v_mfma_f32_16x16x32_bf16 v[60:63], a[28:31], a[192:195], 0
 ds_read_b128 a[8:11], v9 offset:33792
 v_mfma_f32_16x16x32_bf16 v[100:103], a[28:31], a[196:199], 0
 v_mfma_f32_16x16x32_bf16 v[64:67], a[32:35], a[192:195], 0
 ds_read_b128 a[12:15], v9 offset:34816
 s_add_u32 s78, s77, 512
 v_mfma_f32_16x16x32_bf16 v[104:107], a[32:35], a[196:199], 0
 v_mfma_f32_16x16x32_bf16 v[68:71], a[36:39], a[192:195], 0
 ds_read_b128 a[16:19], v5 offset:20480
 v_mfma_f32_16x16x32_bf16 v[108:111], a[36:39], a[196:199], 0
 v_mfma_f32_16x16x32_bf16 v[32:35], a[40:43], a[200:203], v[32:35]
 ds_read_b128 a[20:23], v5 offset:21504
 s_add_u32 s59, s71, 8192
 v_mfma_f32_16x16x32_bf16 v[72:75], a[40:43], a[204:207], v[72:75]
 s_add_u32 m0, s74, 0
 s_waitcnt lgkmcnt(5)
 v_mfma_f32_16x16x32_bf16 v[36:39], a[44:47], a[200:203], v[36:39]
 ds_read_b128 a[24:27], v5 offset:22528
 s_add_u32 s56, s69, 81920
 v_mfma_f32_16x16x32_bf16 v[76:79], a[44:47], a[204:207], v[76:79]
 v_mfma_f32_16x16x32_bf16 v[40:43], a[48:51], a[200:203], v[40:43]
 ds_read_b128 a[28:31], v5 offset:23552
 v_mfma_f32_16x16x32_bf16 v[80:83], a[48:51], a[204:207], v[80:83]
 buffer_load_dwordx4 a[176:179], v2, s[4:7], s59 offen offset:0 sc1
 v_mfma_f32_16x16x32_bf16 v[44:47], a[52:55], a[200:203], v[44:47]
 buffer_load_dwordx4 v14, s[4:7], s56 offen offset:0 sc1 lds
 v_mfma_f32_16x16x32_bf16 v[84:87], a[52:55], a[204:207], v[84:87]
 ds_read_b128 a[32:35], v5 offset:24576
 v_mfma_f32_16x16x32_bf16 v[48:51], a[56:59], a[200:203], v[48:51]
 buffer_load_dwordx4 v14, s[4:7], s56 offen offset:1024 sc1 lds
 v_mfma_f32_16x16x32_bf16 v[88:91], a[56:59], a[204:207], v[88:91]
 ds_read_b128 a[36:39], v8 offset:20480
 v_mfma_f32_16x16x32_bf16 v[52:55], a[60:63], a[200:203], v[52:55]
 buffer_load_dwordx4 a[180:183], v3, s[4:7], s59 offen offset:0 sc1
 v_mfma_f32_16x16x32_bf16 v[92:95], a[60:63], a[204:207], v[92:95]
 ds_read_b128 a[40:43], v8 offset:21504
 v_mfma_f32_16x16x32_bf16 v[56:59], a[0:3], a[200:203], v[56:59]
 buffer_load_dwordx4 v14, s[4:7], s56 offen offset:2048 sc1 lds
 v_mfma_f32_16x16x32_bf16 v[96:99], a[0:3], a[204:207], v[96:99]
 ds_read_b128 a[44:47], v8 offset:22528
 s_waitcnt lgkmcnt(5)
 v_mfma_f32_16x16x32_bf16 v[60:63], a[4:7], a[200:203], v[60:63]
 buffer_load_dwordx4 a[184:187], v2, s[4:7], s59 offen offset:1024 sc1
 v_mfma_f32_16x16x32_bf16 v[100:103], a[4:7], a[204:207], v[100:103]
 buffer_load_dwordx4 v14, s[4:7], s56 offen offset:3072 sc1 lds
 v_mfma_f32_16x16x32_bf16 v[64:67], a[8:11], a[200:203], v[64:67]
 ds_read_b128 a[48:51], v8 offset:23552
 s_add_u32 m0, s74, 4096
 v_mfma_f32_16x16x32_bf16 v[104:107], a[8:11], a[204:207], v[104:107]
 ds_read_b128 a[52:55], v8 offset:24576
 v_mfma_f32_16x16x32_bf16 v[68:71], a[12:15], a[200:203], v[68:71]
 buffer_load_dwordx4 a[188:191], v3, s[4:7], s59 offen offset:1024 sc1
 v_mfma_f32_16x16x32_bf16 v[108:111], a[12:15], a[204:207], v[108:111]
 s_add_u32 s56, s56, 4096
 ds_read_b128 a[56:59], v5 offset:30720
 v_mfma_f32_16x16x32_bf16 v[32:35], a[16:19], a[208:211], v[32:35]
 ds_read_b128 a[60:63], v5 offset:31744
 v_mfma_f32_16x16x32_bf16 v[72:75], a[16:19], a[212:215], v[72:75]
 buffer_load_dwordx4 v14, s[4:7], s56 offen sc1 lds
 v_mfma_f32_16x16x32_bf16 v[36:39], a[20:23], a[208:211], v[36:39]
 s_add_u32 s59, s71, 10240
 ds_read_b128 a[0:3], v5 offset:32768
 v_mfma_f32_16x16x32_bf16 v[76:79], a[20:23], a[212:215], v[76:79]
 s_add_u32 m0, s74, 20480
 v_mfma_f32_16x16x32_bf16 v[40:43], a[24:27], a[208:211], v[40:43]
 ds_read_b128 a[4:7], v5 offset:33792
 v_mfma_f32_16x16x32_bf16 v[80:83], a[24:27], a[212:215], v[80:83]
 s_add_u32 s56, s69, 102400
 s_waitcnt lgkmcnt(6)
 v_mfma_f32_16x16x32_bf16 v[44:47], a[28:31], a[208:211], v[44:47]
 ds_read_b128 a[8:11], v5 offset:34816
 v_mfma_f32_16x16x32_bf16 v[84:87], a[28:31], a[212:215], v[84:87]
 buffer_load_dwordx4 a[192:195], v2, s[4:7], s59 offen offset:0 sc1
 v_mfma_f32_16x16x32_bf16 v[48:51], a[32:35], a[208:211], v[48:51]
 ds_read_b128 a[12:15], v8 offset:30720
 v_mfma_f32_16x16x32_bf16 v[88:91], a[32:35], a[212:215], v[88:91]
 buffer_load_dwordx4 v14, s[4:7], s56 offen offset:0 sc1 lds
 v_mfma_f32_16x16x32_bf16 v[52:55], a[36:39], a[208:211], v[52:55]
 ds_read_b128 a[16:19], v8 offset:31744
 v_mfma_f32_16x16x32_bf16 v[92:95], a[36:39], a[212:215], v[92:95]
 buffer_load_dwordx4 v14, s[4:7], s56 offen offset:1024 sc1 lds
 v_mfma_f32_16x16x32_bf16 v[56:59], a[40:43], a[208:211], v[56:59]
 buffer_load_dwordx4 a[196:199], v3, s[4:7], s59 offen offset:0 sc1
 v_mfma_f32_16x16x32_bf16 v[96:99], a[40:43], a[212:215], v[96:99]
 ds_read_b128 a[20:23], v8 offset:32768
 v_mfma_f32_16x16x32_bf16 v[60:63], a[44:47], a[208:211], v[60:63]
 buffer_load_dwordx4 v14, s[4:7], s56 offen offset:2048 sc1 lds
 v_mfma_f32_16x16x32_bf16 v[100:103], a[44:47], a[212:215], v[100:103]
 ds_read_b128 a[24:27], v8 offset:33792
 s_waitcnt lgkmcnt(5)
 v_mfma_f32_16x16x32_bf16 v[64:67], a[48:51], a[208:211], v[64:67]
 buffer_load_dwordx4 v14, s[4:7], s56 offen offset:3072 sc1 lds
 v_mfma_f32_16x16x32_bf16 v[104:107], a[48:51], a[212:215], v[104:107]
 ds_read_b128 a[28:31], v8 offset:34816
 v_mfma_f32_16x16x32_bf16 v[68:71], a[52:55], a[208:211], v[68:71]
 buffer_load_dwordx4 a[200:203], v2, s[4:7], s59 offen offset:1024 sc1
 v_mfma_f32_16x16x32_bf16 v[108:111], a[52:55], a[212:215], v[108:111]
 s_add_u32 m0, s74, 24576
 v_mfma_f32_16x16x32_bf16 v[32:35], a[56:59], a[216:219], v[32:35]
 s_add_u32 s56, s56, 4096
 v_mfma_f32_16x16x32_bf16 v[72:75], a[56:59], a[220:223], v[72:75]
 v_mfma_f32_16x16x32_bf16 v[36:39], a[60:63], a[216:219], v[36:39]
 buffer_load_dwordx4 a[204:207], v3, s[4:7], s59 offen offset:1024 sc1
 v_mfma_f32_16x16x32_bf16 v[76:79], a[60:63], a[220:223], v[76:79]
 buffer_load_dwordx4 v14, s[4:7], s56 offen sc1 lds
 v_mfma_f32_16x16x32_bf16 v[40:43], a[0:3], a[216:219], v[40:43]
 v_mfma_f32_16x16x32_bf16 v[80:83], a[0:3], a[220:223], v[80:83]
 v_mfma_f32_16x16x32_bf16 v[44:47], a[4:7], a[216:219], v[44:47]
 v_mfma_f32_16x16x32_bf16 v[84:87], a[4:7], a[220:223], v[84:87]
 s_waitcnt lgkmcnt(0)
 v_mfma_f32_16x16x32_bf16 v[48:51], a[8:11], a[216:219], v[48:51]
 s_waitcnt vmcnt(31)
 s_waitcnt vmcnt(26)
 s_waitcnt lgkmcnt(0)
 s_barrier
 v_mfma_f32_16x16x32_bf16 v[88:91], a[8:11], a[220:223], v[88:91]
 ds_read_b128 a[32:35], v5 offset:40960
 ds_read_b128 a[36:39], v5 offset:41984
 v_mfma_f32_16x16x32_bf16 v[52:55], a[12:15], a[216:219], v[52:55]
 ds_read_b128 a[40:43], v5 offset:43008
 ds_read_b128 a[44:47], v5 offset:44032
 v_mfma_f32_16x16x32_bf16 v[92:95], a[12:15], a[220:223], v[92:95]
 s_add_u32 m0, s74, 40960
 ds_read_b128 a[48:51], v5 offset:45056
 v_mfma_f32_16x16x32_bf16 v[56:59], a[16:19], a[216:219], v[56:59]
 ds_read_b128 a[52:55], v8 offset:40960
 ds_read_b128 a[56:59], v8 offset:41984
 v_mfma_f32_16x16x32_bf16 v[96:99], a[16:19], a[220:223], v[96:99]
 ds_read_b128 a[60:63], v8 offset:43008
 s_add_u32 s56, s70, 0
 v_mfma_f32_16x16x32_bf16 v[60:63], a[20:23], a[216:219], v[60:63]
 ds_read_b128 a[0:3], v8 offset:44032
 v_mfma_f32_16x16x32_bf16 v[100:103], a[20:23], a[220:223], v[100:103]
 buffer_load_dwordx4 v14, s[4:7], s56 offen offset:0 sc1 lds
 v_mfma_f32_16x16x32_bf16 v[64:67], a[24:27], a[216:219], v[64:67]
 ds_read_b128 a[4:7], v8 offset:45056
 v_mfma_f32_16x16x32_bf16 v[104:107], a[24:27], a[220:223], v[104:107]
 v_mfma_f32_16x16x32_bf16 v[68:71], a[28:31], a[216:219], v[68:71]
 ds_read_b128 a[8:11], v5 offset:51200
 v_mfma_f32_16x16x32_bf16 v[108:111], a[28:31], a[220:223], v[108:111]
 s_waitcnt lgkmcnt(10)
 v_mfma_f32_16x16x32_bf16 v[32:35], a[32:35], a[224:227], v[32:35]
 buffer_load_dwordx4 v14, s[4:7], s56 offen offset:1024 sc1 lds
 v_mfma_f32_16x16x32_bf16 v[72:75], a[32:35], a[228:231], v[72:75]
 ds_read_b128 a[12:15], v5 offset:52224
 s_waitcnt lgkmcnt(8)
 v_mfma_f32_16x16x32_bf16 v[36:39], a[36:39], a[224:227], v[36:39]
 buffer_load_dwordx4 v14, s[4:7], s56 offen offset:2048 sc1 lds
 v_mfma_f32_16x16x32_bf16 v[76:79], a[36:39], a[228:231], v[76:79]
 ds_read_b128 a[16:19], v5 offset:53248
 v_mfma_f32_16x16x32_bf16 v[40:43], a[40:43], a[224:227], v[40:43]
 ds_read_b128 a[20:23], v5 offset:54272
 v_mfma_f32_16x16x32_bf16 v[80:83], a[40:43], a[228:231], v[80:83]
 buffer_load_dwordx4 v14, s[4:7], s56 offen offset:3072 sc1 lds
 v_mfma_f32_16x16x32_bf16 v[44:47], a[44:47], a[224:227], v[44:47]
 ds_read_b128 a[24:27], v5 offset:55296
 s_add_u32 m0, s74, 45056
 v_mfma_f32_16x16x32_bf16 v[84:87], a[44:47], a[228:231], v[84:87]
 s_waitcnt lgkmcnt(5)
 v_mfma_f32_16x16x32_bf16 v[48:51], a[48:51], a[224:227], v[48:51]
 ds_read_b128 a[28:31], v8 offset:51200
 v_mfma_f32_16x16x32_bf16 v[88:91], a[48:51], a[228:231], v[88:91]
 s_add_u32 s56, s56, 4096
 v_mfma_f32_16x16x32_bf16 v[52:55], a[52:55], a[224:227], v[52:55]
 ds_read_b128 a[32:35], v8 offset:52224
 v_mfma_f32_16x16x32_bf16 v[92:95], a[52:55], a[228:231], v[92:95]
 v_mfma_f32_16x16x32_bf16 v[56:59], a[56:59], a[224:227], v[56:59]
 ds_read_b128 a[36:39], v8 offset:53248
 v_mfma_f32_16x16x32_bf16 v[96:99], a[56:59], a[228:231], v[96:99]
 buffer_load_dwordx4 v14, s[4:7], s56 offen sc1 lds
 v_mfma_f32_16x16x32_bf16 v[60:63], a[60:63], a[224:227], v[60:63]
 ds_read_b128 a[40:43], v8 offset:54272
 v_mfma_f32_16x16x32_bf16 v[100:103], a[60:63], a[228:231], v[100:103]
 s_add_u32 m0, s74, 61440
 v_mfma_f32_16x16x32_bf16 v[64:67], a[0:3], a[224:227], v[64:67]
 ds_read_b128 a[44:47], v8 offset:55296
 v_mfma_f32_16x16x32_bf16 v[104:107], a[0:3], a[228:231], v[104:107]
 v_mfma_f32_16x16x32_bf16 v[68:71], a[4:7], a[224:227], v[68:71]
 ds_read_b128 a[48:51], v6 offset:0
 s_add_u32 s56, s70, 20480
 v_mfma_f32_16x16x32_bf16 v[108:111], a[4:7], a[228:231], v[108:111]
 s_waitcnt lgkmcnt(5)
 v_mfma_f32_16x16x32_bf16 v[32:35], a[8:11], a[232:235], v[32:35]
 ds_read_b128 a[52:55], v6 offset:1024
 s_waitcnt vmcnt(23)
 s_waitcnt lgkmcnt(0)
 s_barrier
 buffer_store_dword v27, v26, s[4:7], s79 offen sc1
 v_mfma_f32_16x16x32_bf16 v[72:75], a[8:11], a[236:239], v[72:75]
 buffer_load_dwordx4 v14, s[4:7], s56 offen offset:0 sc1 lds
 v_mfma_f32_16x16x32_bf16 v[36:39], a[12:15], a[232:235], v[36:39]
 ds_read_b128 a[56:59], v6 offset:2048
 v_mfma_f32_16x16x32_bf16 v[76:79], a[12:15], a[236:239], v[76:79]
 buffer_load_dwordx4 v14, s[4:7], s56 offen offset:1024 sc1 lds
 v_mfma_f32_16x16x32_bf16 v[40:43], a[16:19], a[232:235], v[40:43]
 ds_read_b128 a[60:63], v6 offset:3072
 v_lshrrev_b32 v28, 2, v0
 v_mfma_f32_16x16x32_bf16 v[80:83], a[16:19], a[236:239], v[80:83]
 v_and_b32 v29, 3, v0
 v_mfma_f32_16x16x32_bf16 v[44:47], a[20:23], a[232:235], v[44:47]
 ds_read_b128 a[0:3], v6 offset:4096
 v_mfma_f32_16x16x32_bf16 v[84:87], a[20:23], a[236:239], v[84:87]
 buffer_load_dwordx4 v14, s[4:7], s56 offen offset:2048 sc1 lds
 v_mfma_f32_16x16x32_bf16 v[48:51], a[24:27], a[232:235], v[48:51]
 ds_read_b128 a[4:7], v9 offset:0
 v_lshl_add_u32 v19, v29, 4, v28
 v_mfma_f32_16x16x32_bf16 v[88:91], a[24:27], a[236:239], v[88:91]
 buffer_load_dwordx4 v14, s[4:7], s56 offen offset:3072 sc1 lds
 v_mfma_f32_16x16x32_bf16 v[52:55], a[28:31], a[232:235], v[52:55]
 ds_read_b128 a[8:11], v9 offset:1024
 v_lshlrev_b32 v19, 2, v19
 v_mfma_f32_16x16x32_bf16 v[92:95], a[28:31], a[236:239], v[92:95]
 v_mul_u32_u24 v28, 1280, v28
 v_mfma_f32_16x16x32_bf16 v[56:59], a[32:35], a[232:235], v[56:59]
 ds_read_b128 a[12:15], v9 offset:2048
 s_add_u32 m0, s74, 65536
 v_mfma_f32_16x16x32_bf16 v[96:99], a[32:35], a[236:239], v[96:99]
 v_lshl_add_u32 v10, v29, 3, v28
 v_mfma_f32_16x16x32_bf16 v[60:63], a[36:39], a[232:235], v[60:63]
 ds_read_b128 a[16:19], v9 offset:3072
 v_lshrrev_b32 v29, 4, v0
 v_mfma_f32_16x16x32_bf16 v[100:103], a[36:39], a[236:239], v[100:103]
 buffer_load_dword v15, v13, s[4:7], s77 offen sc1
 v_mfma_f32_16x16x32_bf16 v[64:67], a[40:43], a[232:235], v[64:67]
 s_add_u32 s56, s56, 4096
 ds_read_b128 a[20:23], v9 offset:4096
 v_mfma_f32_16x16x32_bf16 v[104:107], a[40:43], a[236:239], v[104:107]
 buffer_load_dwordx4 v14, s[4:7], s56 offen sc1 lds
 v_mfma_f32_16x16x32_bf16 v[68:71], a[44:47], a[232:235], v[68:71]
 ds_read_b128 a[24:27], v6 offset:10240
 v_lshlrev_b32 v11, 3, v29
 v_mfma_f32_16x16x32_bf16 v[108:111], a[44:47], a[236:239], v[108:111]
 v_and_b32 v28, 15, v0
 v_lshl_add_u32 v18, v28, 2, v29
 v_mfma_f32_16x16x32_bf16 v[32:35], a[48:51], a[240:243], v[32:35]
 ds_read_b128 a[28:31], v6 offset:11264
 s_add_u32 m0, s74, 143360
 v_mfma_f32_16x16x32_bf16 v[72:75], a[48:51], a[244:247], v[72:75]
 v_lshlrev_b32 v18, 2, v18
 v_mfma_f32_16x16x32_bf16 v[36:39], a[52:55], a[240:243], v[36:39]
 ds_read_b128 a[32:35], v6 offset:12288
 s_lshl_b32 s58, s67, 3
 v_mfma_f32_16x16x32_bf16 v[76:79], a[52:55], a[244:247], v[76:79]
 s_add_u32 s56, s70, 40960
 s_waitcnt lgkmcnt(5)
 v_mfma_f32_16x16x32_bf16 v[40:43], a[56:59], a[240:243], v[40:43]
 ds_read_b128 a[36:39], v6 offset:13312
 s_lshl_b32 s76, s3, 1
 v_mfma_f32_16x16x32_bf16 v[80:83], a[56:59], a[244:247], v[80:83]
 v_mfma_f32_16x16x32_bf16 v[44:47], a[60:63], a[240:243], v[44:47]
 ds_read_b128 a[40:43], v6 offset:14336
 s_add_u32 s58, s58, s76
 v_mfma_f32_16x16x32_bf16 v[84:87], a[60:63], a[244:247], v[84:87]
 buffer_load_dwordx4 v14, s[4:7], s56 offen offset:0 sc1 lds
 v_mfma_f32_16x16x32_bf16 v[48:51], a[0:3], a[240:243], v[48:51]
 ds_read_b128 a[44:47], v9 offset:10240
 s_lshr_b32 s76, s66, 1
 v_mfma_f32_16x16x32_bf16 v[88:91], a[0:3], a[244:247], v[88:91]
 buffer_load_dwordx4 v14, s[4:7], s56 offen offset:1024 sc1 lds
 v_mfma_f32_16x16x32_bf16 v[52:55], a[4:7], a[240:243], v[52:55]
 ds_read_b128 a[48:51], v9 offset:11264
 s_add_u32 s58, s58, s76
 v_mfma_f32_16x16x32_bf16 v[92:95], a[4:7], a[244:247], v[92:95]
 buffer_load_dwordx4 v14, s[4:7], s56 offen offset:2048 sc1 lds
 v_mfma_f32_16x16x32_bf16 v[56:59], a[8:11], a[240:243], v[56:59]
 ds_read_b128 a[52:55], v9 offset:12288
 s_mul_i32 s73, s58, 20480
 v_mfma_f32_16x16x32_bf16 v[96:99], a[8:11], a[244:247], v[96:99]
 s_lshl_b32 s58, s68, 1
 v_mfma_f32_16x16x32_bf16 v[60:63], a[12:15], a[240:243], v[60:63]
 ds_read_b128 a[56:59], v9 offset:13312
 s_and_b32 s76, s66, 1
 v_mfma_f32_16x16x32_bf16 v[100:103], a[12:15], a[244:247], v[100:103]
 s_waitcnt lgkmcnt(5)
 v_mfma_f32_16x16x32_bf16 v[64:67], a[16:19], a[240:243], v[64:67]
 buffer_load_dwordx4 v14, s[4:7], s56 offen offset:3072 sc1 lds
 v_mfma_f32_16x16x32_bf16 v[104:107], a[16:19], a[244:247], v[104:107]
 ds_read_b128 a[60:63], v9 offset:14336
 s_add_u32 m0, s74, 147456
 v_mfma_f32_16x16x32_bf16 v[68:71], a[20:23], a[240:243], v[68:71]
 s_add_u32 s58, s58, s76
 s_mul_i32 s58, s58, 160
 v_mfma_f32_16x16x32_bf16 v[108:111], a[20:23], a[244:247], v[108:111]
 s_add_u32 s73, s73, s58
 v_mfma_f32_16x16x32_bf16 v[32:35], a[24:27], a[248:251], v[32:35]
 s_add_u32 s56, s56, 4096
 v_mfma_f32_16x16x32_bf16 v[72:75], a[24:27], a[252:255], v[72:75]
 buffer_load_dwordx2 v[122:123], v11, s[48:51], s58 offen offset:0
 v_mfma_f32_16x16x32_bf16 v[36:39], a[28:31], a[248:251], v[36:39]
 v_mfma_f32_16x16x32_bf16 v[76:79], a[28:31], a[252:255], v[76:79]
 buffer_load_dwordx4 v14, s[4:7], s56 offen sc1 lds
 v_mfma_f32_16x16x32_bf16 v[40:43], a[32:35], a[248:251], v[40:43]
 buffer_load_dwordx2 v[124:125], v11, s[48:51], s58 offen offset:32
 v_mfma_f32_16x16x32_bf16 v[80:83], a[32:35], a[252:255], v[80:83]
 buffer_load_dwordx2 v[126:127], v11, s[48:51], s58 offen offset:64
 v_mfma_f32_16x16x32_bf16 v[44:47], a[36:39], a[248:251], v[44:47]
 buffer_load_dwordx2 v[128:129], v11, s[48:51], s58 offen offset:96
 v_mfma_f32_16x16x32_bf16 v[84:87], a[36:39], a[252:255], v[84:87]
 s_waitcnt lgkmcnt(0)
 v_mfma_f32_16x16x32_bf16 v[48:51], a[40:43], a[248:251], v[48:51]
 s_waitcnt vmcnt(30)
 s_waitcnt vmcnt(21)
 s_waitcnt lgkmcnt(0)
 s_barrier
 v_mfma_f32_16x16x32_bf16 v[88:91], a[40:43], a[252:255], v[88:91]
 ds_read_b128 a[0:3], v4 offset:0
 ds_read_b128 a[4:7], v4 offset:1024
 v_mfma_f32_16x16x32_bf16 v[52:55], a[44:47], a[248:251], v[52:55]
 ds_read_b128 a[8:11], v4 offset:2048
 ds_read_b128 a[12:15], v4 offset:3072
 v_mfma_f32_16x16x32_bf16 v[92:95], a[44:47], a[252:255], v[92:95]
 s_add_u32 m0, s74, 81920
 ds_read_b128 a[16:19], v4 offset:4096
 v_mfma_f32_16x16x32_bf16 v[56:59], a[48:51], a[248:251], v[56:59]
 ds_read_b128 a[20:23], v7 offset:0
 ds_read_b128 a[24:27], v7 offset:1024
 v_mfma_f32_16x16x32_bf16 v[96:99], a[48:51], a[252:255], v[96:99]
 ds_read_b128 a[28:31], v7 offset:2048
 s_add_u32 s56, s70, 61440
 v_mfma_f32_16x16x32_bf16 v[60:63], a[52:55], a[248:251], v[60:63]
 ds_read_b128 a[32:35], v7 offset:3072
 v_mfma_f32_16x16x32_bf16 v[100:103], a[52:55], a[252:255], v[100:103]
 buffer_load_dwordx4 v14, s[4:7], s56 offen offset:0 sc1 lds
 v_mfma_f32_16x16x32_bf16 v[64:67], a[56:59], a[248:251], v[64:67]
 ds_read_b128 a[36:39], v7 offset:4096
 v_mfma_f32_16x16x32_bf16 v[104:107], a[56:59], a[252:255], v[104:107]
 buffer_load_dwordx2 v[130:131], v11, s[48:51], s58 offen offset:128
 v_mfma_f32_16x16x32_bf16 v[68:71], a[60:63], a[248:251], v[68:71]
 ds_read_b128 a[40:43], v4 offset:10240
 v_mfma_f32_16x16x32_bf16 v[108:111], a[60:63], a[252:255], v[108:111]
 s_waitcnt lgkmcnt(10)
 v_mfma_f32_16x16x32_bf16 v[32:35], a[0:3], a[176:179], v[32:35]
 buffer_load_dwordx4 v14, s[4:7], s56 offen offset:1024 sc1 lds
 v_mfma_f32_16x16x32_bf16 v[72:75], a[0:3], a[180:183], v[72:75]
 ds_read_b128 a[44:47], v4 offset:11264
 s_waitcnt lgkmcnt(8)
 v_mfma_f32_16x16x32_bf16 v[36:39], a[4:7], a[176:179], v[36:39]
 s_waitcnt vmcnt(13)
 v_cmp_ne_u32 vcc, s98, v15
 s_cbranch_vccnz P_parall_25
PB_parall_26:
 v_mfma_f32_16x16x32_bf16 v[76:79], a[4:7], a[180:183], v[76:79]
 s_add_u32 s59, s72, 0
 v_mfma_f32_16x16x32_bf16 v[40:43], a[8:11], a[176:179], v[40:43]
 buffer_load_dwordx4 v14, s[4:7], s56 offen offset:2048 sc1 lds
 v_mfma_f32_16x16x32_bf16 v[80:83], a[8:11], a[180:183], v[80:83]
 ds_read_b128 a[48:51], v4 offset:12288
 v_mfma_f32_16x16x32_bf16 v[44:47], a[12:15], a[176:179], v[44:47]
 buffer_load_dwordx4 a[208:211], v2, s[4:7], s59 offen offset:0 sc1
 v_mfma_f32_16x16x32_bf16 v[84:87], a[12:15], a[180:183], v[84:87]
 ds_read_b128 a[52:55], v4 offset:13312
 s_waitcnt lgkmcnt(3)
 v_mfma_f32_16x16x32_bf16 v[48:51], a[16:19], a[176:179], v[48:51]
 buffer_load_dwordx4 v14, s[4:7], s56 offen offset:3072 sc1 lds
 v_mfma_f32_16x16x32_bf16 v[88:91], a[16:19], a[180:183], v[88:91]
 buffer_load_dwordx4 a[212:215], v3, s[4:7], s59 offen offset:0 sc1
 v_mfma_f32_16x16x32_bf16 v[52:55], a[20:23], a[176:179], v[52:55]
 ds_read_b128 a[56:59], v4 offset:14336
 s_add_u32 m0, s74, 86016
 v_mfma_f32_16x16x32_bf16 v[92:95], a[20:23], a[180:183], v[92:95]
 buffer_load_dwordx4 a[216:219], v2, s[4:7], s59 offen offset:1024 sc1
 v_mfma_f32_16x16x32_bf16 v[56:59], a[24:27], a[176:179], v[56:59]
 ds_read_b128 a[60:63], v7 offset:10240
 s_add_u32 s56, s56, 4096
 v_mfma_f32_16x16x32_bf16 v[96:99], a[24:27], a[180:183], v[96:99]
 buffer_load_dwordx4 a[220:223], v3, s[4:7], s59 offen offset:1024 sc1
 v_mfma_f32_16x16x32_bf16 v[60:63], a[28:31], a[176:179], v[60:63]
 ds_read_b128 a[0:3], v7 offset:11264
 ds_read_b128 a[4:7], v7 offset:12288
 v_mfma_f32_16x16x32_bf16 v[100:103], a[28:31], a[180:183], v[100:103]
 buffer_load_dwordx4 v14, s[4:7], s56 offen sc1 lds
 v_mfma_f32_16x16x32_bf16 v[64:67], a[32:35], a[176:179], v[64:67]
 s_add_u32 s59, s72, 2048
 ds_read_b128 a[8:11], v7 offset:13312
 v_mfma_f32_16x16x32_bf16 v[104:107], a[32:35], a[180:183], v[104:107]
 buffer_load_dwordx4 a[224:227], v2, s[4:7], s59 offen offset:0 sc1
 v_mfma_f32_16x16x32_bf16 v[68:71], a[36:39], a[176:179], v[68:71]
 s_add_u32 m0, s74, 102400
 ds_read_b128 a[12:15], v7 offset:14336
 v_mfma_f32_16x16x32_bf16 v[108:111], a[36:39], a[180:183], v[108:111]
 buffer_load_dwordx4 a[228:231], v3, s[4:7], s59 offen offset:0 sc1
 v_mfma_f32_16x16x32_bf16 v[32:35], a[40:43], a[184:187], v[32:35]
 ds_read_b128 a[16:19], v4 offset:20480
 s_add_u32 s56, s70, 81920
 v_mfma_f32_16x16x32_bf16 v[72:75], a[40:43], a[188:191], v[72:75]
 s_waitcnt lgkmcnt(6)
 v_mfma_f32_16x16x32_bf16 v[36:39], a[44:47], a[184:187], v[36:39]
 buffer_load_dwordx4 a[232:235], v2, s[4:7], s59 offen offset:1024 sc1
 v_mfma_f32_16x16x32_bf16 v[76:79], a[44:47], a[188:191], v[76:79]
 ds_read_b128 a[20:23], v4 offset:21504
 v_mfma_f32_16x16x32_bf16 v[40:43], a[48:51], a[184:187], v[40:43]
 buffer_load_dwordx4 v14, s[4:7], s56 offen offset:0 sc1 lds
 v_mfma_f32_16x16x32_bf16 v[80:83], a[48:51], a[188:191], v[80:83]
 buffer_load_dwordx4 a[236:239], v3, s[4:7], s59 offen offset:1024 sc1
 v_mfma_f32_16x16x32_bf16 v[44:47], a[52:55], a[184:187], v[44:47]
 ds_read_b128 a[24:27], v4 offset:22528
 v_mfma_f32_16x16x32_bf16 v[84:87], a[52:55], a[188:191], v[84:87]
 buffer_load_dwordx4 v14, s[4:7], s56 offen offset:1024 sc1 lds
 v_mfma_f32_16x16x32_bf16 v[48:51], a[56:59], a[184:187], v[48:51]
 ds_read_b128 a[28:31], v4 offset:23552
 s_add_u32 s59, s72, 4096
 v_mfma_f32_16x16x32_bf16 v[88:91], a[56:59], a[188:191], v[88:91]
 ds_read_b128 a[32:35], v4 offset:24576
 s_waitcnt lgkmcnt(5)
 v_mfma_f32_16x16x32_bf16 v[52:55], a[60:63], a[184:187], v[52:55]
 buffer_load_dwordx4 v14, s[4:7], s56 offen offset:2048 sc1 lds
 v_mfma_f32_16x16x32_bf16 v[92:95], a[60:63], a[188:191], v[92:95]
 buffer_load_dwordx4 a[240:243], v2, s[4:7], s59 offen offset:0 sc1
 v_mfma_f32_16x16x32_bf16 v[56:59], a[0:3], a[184:187], v[56:59]
 ds_read_b128 a[36:39], v7 offset:20480
 v_mfma_f32_16x16x32_bf16 v[96:99], a[0:3], a[188:191], v[96:99]
 buffer_load_dwordx4 a[244:247], v3, s[4:7], s59 offen offset:0 sc1
 v_mfma_f32_16x16x32_bf16 v[60:63], a[4:7], a[184:187], v[60:63]
 buffer_load_dwordx4 v14, s[4:7], s56 offen offset:3072 sc1 lds
 v_mfma_f32_16x16x32_bf16 v[100:103], a[4:7], a[188:191], v[100:103]
 ds_read_b128 a[40:43], v7 offset:21504
 v_mfma_f32_16x16x32_bf16 v[64:67], a[8:11], a[184:187], v[64:67]
 buffer_load_dwordx4 a[248:251], v2, s[4:7], s59 offen offset:1024 sc1
 v_mfma_f32_16x16x32_bf16 v[104:107], a[8:11], a[188:191], v[104:107]
 ds_read_b128 a[44:47], v7 offset:22528
 s_add_u32 m0, s74, 106496
 v_mfma_f32_16x16x32_bf16 v[68:71], a[12:15], a[184:187], v[68:71]
 buffer_load_dwordx4 a[252:255], v3, s[4:7], s59 offen offset:1024 sc1
 v_mfma_f32_16x16x32_bf16 v[108:111], a[12:15], a[188:191], v[108:111]
 ds_read_b128 a[48:51], v7 offset:23552
 s_waitcnt lgkmcnt(4)
 v_mfma_f32_16x16x32_bf16 v[32:35], a[16:19], a[192:195], v[32:35]
 s_add_u32 s56, s56, 4096
 ds_read_b128 a[52:55], v7 offset:24576
 v_mfma_f32_16x16x32_bf16 v[72:75], a[16:19], a[196:199], v[72:75]
 buffer_load_dwordx4 v14, s[4:7], s56 offen sc1 lds
 v_mfma_f32_16x16x32_bf16 v[36:39], a[20:23], a[192:195], v[36:39]
 ds_read_b128 a[56:59], v4 offset:30720
 ds_read_b128 a[60:63], v4 offset:31744
 v_mfma_f32_16x16x32_bf16 v[76:79], a[20:23], a[196:199], v[76:79]
 s_add_u32 m0, s74, 122880
 s_add_u32 s59, s72, 6144
 v_mfma_f32_16x16x32_bf16 v[40:43], a[24:27], a[192:195], v[40:43]
 ds_read_b128 a[0:3], v4 offset:32768
 s_add_u32 s56, s70, 102400
 v_mfma_f32_16x16x32_bf16 v[80:83], a[24:27], a[196:199], v[80:83]
 ds_read_b128 a[4:7], v4 offset:33792
 v_mfma_f32_16x16x32_bf16 v[44:47], a[28:31], a[192:195], v[44:47]
 ds_read_b128 a[8:11], v4 offset:34816
 v_mfma_f32_16x16x32_bf16 v[84:87], a[28:31], a[196:199], v[84:87]
 buffer_load_dwordx4 v14, s[4:7], s56 offen offset:0 sc1 lds
 v_mfma_f32_16x16x32_bf16 v[48:51], a[32:35], a[192:195], v[48:51]
 buffer_load_dwordx4 a[176:179], v2, s[4:7], s59 offen offset:0 sc1
 v_mfma_f32_16x16x32_bf16 v[88:91], a[32:35], a[196:199], v[88:91]
 ds_read_b128 a[12:15], v7 offset:30720
 s_waitcnt lgkmcnt(7)
 v_mfma_f32_16x16x32_bf16 v[52:55], a[36:39], a[192:195], v[52:55]
 buffer_load_dwordx4 v14, s[4:7], s56 offen offset:1024 sc1 lds
 v_mfma_f32_16x16x32_bf16 v[92:95], a[36:39], a[196:199], v[92:95]
 ds_read_b128 a[16:19], v7 offset:31744
 v_mfma_f32_16x16x32_bf16 v[56:59], a[40:43], a[192:195], v[56:59]
 buffer_load_dwordx4 a[180:183], v3, s[4:7], s59 offen offset:0 sc1
 v_mfma_f32_16x16x32_bf16 v[96:99], a[40:43], a[196:199], v[96:99]
 buffer_load_dwordx4 v14, s[4:7], s56 offen offset:2048 sc1 lds
 v_mfma_f32_16x16x32_bf16 v[60:63], a[44:47], a[192:195], v[60:63]
 ds_read_b128 a[20:23], v7 offset:32768
 ds_read_b128 a[24:27], v7 offset:33792
 v_mfma_f32_16x16x32_bf16 v[100:103], a[44:47], a[196:199], v[100:103]
 buffer_load_dwordx4 v14, s[4:7], s56 offen offset:3072 sc1 lds
 v_mfma_f32_16x16x32_bf16 v[64:67], a[48:51], a[192:195], v[64:67]
 ds_read_b128 a[28:31], v7 offset:34816
 v_mfma_f32_16x16x32_bf16 v[104:107], a[48:51], a[196:199], v[104:107]
 s_waitcnt lgkmcnt(5)
 v_mfma_f32_16x16x32_bf16 v[68:71], a[52:55], a[192:195], v[68:71]
 buffer_load_dwordx4 a[184:187], v2, s[4:7], s59 offen offset:1024 sc1
 v_mfma_f32_16x16x32_bf16 v[108:111], a[52:55], a[196:199], v[108:111]
 s_add_u32 m0, s74, 126976
 v_mfma_f32_16x16x32_bf16 v[32:35], a[56:59], a[200:203], v[32:35]
 s_add_u32 s56, s56, 4096
 v_mfma_f32_16x16x32_bf16 v[72:75], a[56:59], a[204:207], v[72:75]
 v_mfma_f32_16x16x32_bf16 v[36:39], a[60:63], a[200:203], v[36:39]
 buffer_load_dwordx4 a[188:191], v3, s[4:7], s59 offen offset:1024 sc1
 v_mfma_f32_16x16x32_bf16 v[76:79], a[60:63], a[204:207], v[76:79]
 buffer_load_dwordx4 v14, s[4:7], s56 offen sc1 lds
 v_mfma_f32_16x16x32_bf16 v[40:43], a[0:3], a[200:203], v[40:43]
 v_mfma_f32_16x16x32_bf16 v[80:83], a[0:3], a[204:207], v[80:83]
 v_mfma_f32_16x16x32_bf16 v[44:47], a[4:7], a[200:203], v[44:47]
 v_mfma_f32_16x16x32_bf16 v[84:87], a[4:7], a[204:207], v[84:87]
 v_mfma_f32_16x16x32_bf16 v[48:51], a[8:11], a[200:203], v[48:51]
 s_waitcnt vmcnt(41)
 s_waitcnt lgkmcnt(0)
 s_barrier
 v_mfma_f32_16x16x32_bf16 v[88:91], a[8:11], a[204:207], v[88:91]
 ds_read_b128 a[32:35], v4 offset:40960
 ds_read_b128 a[36:39], v4 offset:41984
 v_mfma_f32_16x16x32_bf16 v[52:55], a[12:15], a[200:203], v[52:55]
 ds_read_b128 a[40:43], v4 offset:43008
 ds_read_b128 a[44:47], v4 offset:44032
 v_mfma_f32_16x16x32_bf16 v[92:95], a[12:15], a[204:207], v[92:95]
 s_add_u32 m0, s74, 0
 ds_read_b128 a[48:51], v4 offset:45056
 v_mfma_f32_16x16x32_bf16 v[56:59], a[16:19], a[200:203], v[56:59]
 ds_read_b128 a[52:55], v7 offset:40960
 ds_read_b128 a[56:59], v7 offset:41984
 v_mfma_f32_16x16x32_bf16 v[96:99], a[16:19], a[204:207], v[96:99]
 ds_read_b128 a[60:63], v7 offset:43008
 s_add_u32 s56, s70, 122880
 v_mfma_f32_16x16x32_bf16 v[60:63], a[20:23], a[200:203], v[60:63]
 ds_read_b128 a[0:3], v7 offset:44032
 v_mfma_f32_16x16x32_bf16 v[100:103], a[20:23], a[204:207], v[100:103]
 v_mfma_f32_16x16x32_bf16 v[64:67], a[24:27], a[200:203], v[64:67]
 ds_read_b128 a[4:7], v7 offset:45056
 v_mfma_f32_16x16x32_bf16 v[104:107], a[24:27], a[204:207], v[104:107]
 buffer_load_dwordx4 v14, s[4:7], s56 offen offset:0 sc1 lds
 v_mfma_f32_16x16x32_bf16 v[68:71], a[28:31], a[200:203], v[68:71]
 ds_read_b128 a[8:11], v4 offset:51200
 v_mfma_f32_16x16x32_bf16 v[108:111], a[28:31], a[204:207], v[108:111]
 s_waitcnt lgkmcnt(10) vmcnt(28)
 v_mfma_f32_16x16x32_bf16 v[32:35], a[32:35], a[208:211], v[32:35]
 ds_read_b128 a[12:15], v4 offset:52224
 s_waitcnt vmcnt(26)
 v_mfma_f32_16x16x32_bf16 v[72:75], a[32:35], a[212:215], v[72:75]
 s_add_u32 s59, s72, 8192
 s_waitcnt lgkmcnt(8)
 v_mfma_f32_16x16x32_bf16 v[36:39], a[36:39], a[208:211], v[36:39]
 buffer_load_dwordx4 v14, s[4:7], s56 offen offset:1024 sc1 lds
 v_mfma_f32_16x16x32_bf16 v[76:79], a[36:39], a[212:215], v[76:79]
 ds_read_b128 a[16:19], v4 offset:53248
 v_mfma_f32_16x16x32_bf16 v[40:43], a[40:43], a[208:211], v[40:43]
 ds_read_b128 a[20:23], v4 offset:54272
 v_mfma_f32_16x16x32_bf16 v[80:83], a[40:43], a[212:215], v[80:83]
 buffer_load_dwordx4 v14, s[4:7], s56 offen offset:2048 sc1 lds
 v_mfma_f32_16x16x32_bf16 v[44:47], a[44:47], a[208:211], v[44:47]
 ds_read_b128 a[24:27], v4 offset:55296
 v_mfma_f32_16x16x32_bf16 v[84:87], a[44:47], a[212:215], v[84:87]
 s_waitcnt lgkmcnt(5)
 v_mfma_f32_16x16x32_bf16 v[48:51], a[48:51], a[208:211], v[48:51]
 buffer_load_dwordx4 a[192:195], v2, s[4:7], s59 offen offset:0 sc1
 v_mfma_f32_16x16x32_bf16 v[88:91], a[48:51], a[212:215], v[88:91]
 ds_read_b128 a[28:31], v7 offset:51200
 v_mfma_f32_16x16x32_bf16 v[52:55], a[52:55], a[208:211], v[52:55]
 buffer_load_dwordx4 v14, s[4:7], s56 offen offset:3072 sc1 lds
 v_mfma_f32_16x16x32_bf16 v[92:95], a[52:55], a[212:215], v[92:95]
 ds_read_b128 a[32:35], v7 offset:52224
 v_mfma_f32_16x16x32_bf16 v[56:59], a[56:59], a[208:211], v[56:59]
 buffer_load_dwordx4 a[196:199], v3, s[4:7], s59 offen offset:0 sc1
 v_mfma_f32_16x16x32_bf16 v[96:99], a[56:59], a[212:215], v[96:99]
 ds_read_b128 a[36:39], v7 offset:53248
 s_add_u32 m0, s74, 4096
 v_mfma_f32_16x16x32_bf16 v[60:63], a[60:63], a[208:211], v[60:63]
 ds_read_b128 a[40:43], v7 offset:54272
 v_mfma_f32_16x16x32_bf16 v[100:103], a[60:63], a[212:215], v[100:103]
 v_mfma_f32_16x16x32_bf16 v[64:67], a[0:3], a[208:211], v[64:67]
 ds_read_b128 a[44:47], v7 offset:55296
 v_mfma_f32_16x16x32_bf16 v[104:107], a[0:3], a[212:215], v[104:107]
 buffer_load_dwordx4 a[200:203], v2, s[4:7], s59 offen offset:1024 sc1
 v_mfma_f32_16x16x32_bf16 v[68:71], a[4:7], a[208:211], v[68:71]
 s_add_u32 s56, s56, 4096
 ds_read_b128 a[48:51], v5 offset:0
 v_mfma_f32_16x16x32_bf16 v[108:111], a[4:7], a[212:215], v[108:111]
 s_waitcnt lgkmcnt(5) vmcnt(31)
 v_mfma_f32_16x16x32_bf16 v[32:35], a[8:11], a[216:219], v[32:35]
 ds_read_b128 a[52:55], v5 offset:1024
 s_waitcnt vmcnt(30)
 v_mfma_f32_16x16x32_bf16 v[72:75], a[8:11], a[220:223], v[72:75]
 buffer_load_dwordx4 v14, s[4:7], s56 offen sc1 lds
 v_mfma_f32_16x16x32_bf16 v[36:39], a[12:15], a[216:219], v[36:39]
 ds_read_b128 a[56:59], v5 offset:2048
 v_mfma_f32_16x16x32_bf16 v[76:79], a[12:15], a[220:223], v[76:79]
 buffer_load_dwordx4 a[204:207], v3, s[4:7], s59 offen offset:1024 sc1
 v_mfma_f32_16x16x32_bf16 v[40:43], a[16:19], a[216:219], v[40:43]
 ds_read_b128 a[60:63], v5 offset:3072
 v_mfma_f32_16x16x32_bf16 v[80:83], a[16:19], a[220:223], v[80:83]
 s_add_u32 m0, s74, 20480
 v_mfma_f32_16x16x32_bf16 v[44:47], a[20:23], a[216:219], v[44:47]
 ds_read_b128 a[0:3], v5 offset:4096
 v_mfma_f32_16x16x32_bf16 v[84:87], a[20:23], a[220:223], v[84:87]
 v_mfma_f32_16x16x32_bf16 v[48:51], a[24:27], a[216:219], v[48:51]
 ds_read_b128 a[4:7], v8 offset:0
 s_add_u32 s56, s70, 143360
 v_mfma_f32_16x16x32_bf16 v[88:91], a[24:27], a[220:223], v[88:91]
 v_mfma_f32_16x16x32_bf16 v[52:55], a[28:31], a[216:219], v[52:55]
 ds_read_b128 a[8:11], v8 offset:1024
 v_mfma_f32_16x16x32_bf16 v[92:95], a[28:31], a[220:223], v[92:95]
 s_waitcnt lgkmcnt(5)
 v_mfma_f32_16x16x32_bf16 v[56:59], a[32:35], a[216:219], v[56:59]
 ds_read_b128 a[12:15], v8 offset:2048
 v_mfma_f32_16x16x32_bf16 v[96:99], a[32:35], a[220:223], v[96:99]
 buffer_load_dwordx4 v14, s[4:7], s56 offen offset:0 sc1 lds
 v_mfma_f32_16x16x32_bf16 v[60:63], a[36:39], a[216:219], v[60:63]
 ds_read_b128 a[16:19], v8 offset:3072
 v_mfma_f32_16x16x32_bf16 v[100:103], a[36:39], a[220:223], v[100:103]
 v_mfma_f32_16x16x32_bf16 v[64:67], a[40:43], a[216:219], v[64:67]
 ds_read_b128 a[20:23], v8 offset:4096
 v_mfma_f32_16x16x32_bf16 v[104:107], a[40:43], a[220:223], v[104:107]
 buffer_load_dwordx4 v14, s[4:7], s56 offen offset:1024 sc1 lds
 v_mfma_f32_16x16x32_bf16 v[68:71], a[44:47], a[216:219], v[68:71]
 ds_read_b128 a[24:27], v5 offset:10240
 v_mfma_f32_16x16x32_bf16 v[108:111], a[44:47], a[220:223], v[108:111]
 s_waitcnt vmcnt(32)
 v_mfma_f32_16x16x32_bf16 v[32:35], a[48:51], a[224:227], v[32:35]
 ds_read_b128 a[28:31], v5 offset:11264
 s_waitcnt vmcnt(31)
 v_mfma_f32_16x16x32_bf16 v[72:75], a[48:51], a[228:231], v[72:75]
 buffer_load_dwordx4 v14, s[4:7], s56 offen offset:2048 sc1 lds
 v_mfma_f32_16x16x32_bf16 v[36:39], a[52:55], a[224:227], v[36:39]
 s_add_u32 s59, s72, 10240
 ds_read_b128 a[32:35], v5 offset:12288
 v_mfma_f32_16x16x32_bf16 v[76:79], a[52:55], a[228:231], v[76:79]
 s_waitcnt lgkmcnt(5)
 v_mfma_f32_16x16x32_bf16 v[40:43], a[56:59], a[224:227], v[40:43]
 ds_read_b128 a[36:39], v5 offset:13312
 v_mfma_f32_16x16x32_bf16 v[80:83], a[56:59], a[228:231], v[80:83]
 buffer_load_dwordx4 v14, s[4:7], s56 offen offset:3072 sc1 lds
 v_mfma_f32_16x16x32_bf16 v[44:47], a[60:63], a[224:227], v[44:47]
 ds_read_b128 a[40:43], v5 offset:14336
 v_mfma_f32_16x16x32_bf16 v[84:87], a[60:63], a[228:231], v[84:87]
 buffer_load_dwordx4 a[208:211], v2, s[4:7], s59 offen offset:0 sc1
 v_mfma_f32_16x16x32_bf16 v[48:51], a[0:3], a[224:227], v[48:51]
 ds_read_b128 a[44:47], v8 offset:10240
 s_add_u32 m0, s74, 24576
 v_mfma_f32_16x16x32_bf16 v[88:91], a[0:3], a[228:231], v[88:91]
 v_mfma_f32_16x16x32_bf16 v[52:55], a[4:7], a[224:227], v[52:55]
 ds_read_b128 a[48:51], v8 offset:11264
 v_mfma_f32_16x16x32_bf16 v[92:95], a[4:7], a[228:231], v[92:95]
 buffer_load_dwordx4 a[212:215], v3, s[4:7], s59 offen offset:0 sc1
 v_mfma_f32_16x16x32_bf16 v[56:59], a[8:11], a[224:227], v[56:59]
 ds_read_b128 a[52:55], v8 offset:12288
 s_add_u32 s56, s56, 4096
 v_mfma_f32_16x16x32_bf16 v[96:99], a[8:11], a[228:231], v[96:99]
 v_mfma_f32_16x16x32_bf16 v[60:63], a[12:15], a[224:227], v[60:63]
 ds_read_b128 a[56:59], v8 offset:13312
 v_mfma_f32_16x16x32_bf16 v[100:103], a[12:15], a[228:231], v[100:103]
 s_waitcnt lgkmcnt(5)
 v_mfma_f32_16x16x32_bf16 v[64:67], a[16:19], a[224:227], v[64:67]
 ds_read_b128 a[60:63], v8 offset:14336
 v_mfma_f32_16x16x32_bf16 v[104:107], a[16:19], a[228:231], v[104:107]
 buffer_load_dwordx4 v14, s[4:7], s56 offen sc1 lds
 v_mfma_f32_16x16x32_bf16 v[68:71], a[20:23], a[224:227], v[68:71]
 buffer_load_dwordx4 a[216:219], v2, s[4:7], s59 offen offset:1024 sc1
 v_mfma_f32_16x16x32_bf16 v[108:111], a[20:23], a[228:231], v[108:111]
 s_waitcnt vmcnt(36)
 v_mfma_f32_16x16x32_bf16 v[32:35], a[24:27], a[232:235], v[32:35]
 s_waitcnt vmcnt(34)
 v_mfma_f32_16x16x32_bf16 v[72:75], a[24:27], a[236:239], v[72:75]
 v_mfma_f32_16x16x32_bf16 v[36:39], a[28:31], a[232:235], v[36:39]
 buffer_load_dwordx4 a[220:223], v3, s[4:7], s59 offen offset:1024 sc1
 v_mfma_f32_16x16x32_bf16 v[76:79], a[28:31], a[236:239], v[76:79]
 v_mfma_f32_16x16x32_bf16 v[40:43], a[32:35], a[232:235], v[40:43]
 v_mfma_f32_16x16x32_bf16 v[80:83], a[32:35], a[236:239], v[80:83]
 v_mfma_f32_16x16x32_bf16 v[44:47], a[36:39], a[232:235], v[44:47]
 v_mfma_f32_16x16x32_bf16 v[84:87], a[36:39], a[236:239], v[84:87]
 s_waitcnt lgkmcnt(0)
 v_mfma_f32_16x16x32_bf16 v[48:51], a[40:43], a[232:235], v[48:51]
 s_waitcnt lgkmcnt(0)
 s_barrier
 v_mfma_f32_16x16x32_bf16 v[88:91], a[40:43], a[236:239], v[88:91]
 ds_read_b128 a[0:3], v6 offset:20480
 ds_read_b128 a[4:7], v6 offset:21504
 v_mfma_f32_16x16x32_bf16 v[52:55], a[44:47], a[232:235], v[52:55]
 ds_read_b128 a[8:11], v6 offset:22528
 ds_read_b128 a[12:15], v6 offset:23552
 v_mfma_f32_16x16x32_bf16 v[92:95], a[44:47], a[236:239], v[92:95]
 s_add_u32 m0, s74, 40960
 ds_read_b128 a[16:19], v6 offset:24576
 v_mfma_f32_16x16x32_bf16 v[56:59], a[48:51], a[232:235], v[56:59]
 ds_read_b128 a[20:23], v9 offset:20480
 ds_read_b128 a[24:27], v9 offset:21504
 v_mfma_f32_16x16x32_bf16 v[96:99], a[48:51], a[236:239], v[96:99]
 ds_read_b128 a[28:31], v9 offset:22528
 s_add_u32 s56, s70, 163840
 v_mfma_f32_16x16x32_bf16 v[60:63], a[52:55], a[232:235], v[60:63]
 ds_read_b128 a[32:35], v9 offset:23552
 v_mfma_f32_16x16x32_bf16 v[100:103], a[52:55], a[236:239], v[100:103]
 v_mfma_f32_16x16x32_bf16 v[64:67], a[56:59], a[232:235], v[64:67]
 ds_read_b128 a[36:39], v9 offset:24576
 v_mfma_f32_16x16x32_bf16 v[104:107], a[56:59], a[236:239], v[104:107]
 buffer_load_dwordx4 v14, s[4:7], s56 offen offset:0 sc1 lds
 v_mfma_f32_16x16x32_bf16 v[68:71], a[60:63], a[232:235], v[68:71]
 ds_read_b128 a[40:43], v6 offset:30720
 v_mfma_f32_16x16x32_bf16 v[108:111], a[60:63], a[236:239], v[108:111]
 s_waitcnt lgkmcnt(10) vmcnt(33)
 v_mfma_f32_16x16x32_bf16 v[32:35], a[0:3], a[240:243], v[32:35]
 ds_read_b128 a[44:47], v6 offset:31744
 s_waitcnt vmcnt(32)
 v_mfma_f32_16x16x32_bf16 v[72:75], a[0:3], a[244:247], v[72:75]
 s_add_u32 s59, s72, 12288
 s_waitcnt lgkmcnt(8)
 v_mfma_f32_16x16x32_bf16 v[36:39], a[4:7], a[240:243], v[36:39]
 buffer_load_dwordx4 v14, s[4:7], s56 offen offset:1024 sc1 lds
 v_mfma_f32_16x16x32_bf16 v[76:79], a[4:7], a[244:247], v[76:79]
 ds_read_b128 a[48:51], v6 offset:32768
 v_mfma_f32_16x16x32_bf16 v[40:43], a[8:11], a[240:243], v[40:43]
 ds_read_b128 a[52:55], v6 offset:33792
 v_mfma_f32_16x16x32_bf16 v[80:83], a[8:11], a[244:247], v[80:83]
 buffer_load_dwordx4 v14, s[4:7], s56 offen offset:2048 sc1 lds
 v_mfma_f32_16x16x32_bf16 v[44:47], a[12:15], a[240:243], v[44:47]
 ds_read_b128 a[56:59], v6 offset:34816
 v_mfma_f32_16x16x32_bf16 v[84:87], a[12:15], a[244:247], v[84:87]
 s_waitcnt lgkmcnt(5)
 v_mfma_f32_16x16x32_bf16 v[48:51], a[16:19], a[240:243], v[48:51]
 buffer_load_dwordx4 a[224:227], v2, s[4:7], s59 offen offset:0 sc1
 v_mfma_f32_16x16x32_bf16 v[88:91], a[16:19], a[244:247], v[88:91]
 ds_read_b128 a[60:63], v9 offset:30720
 v_mfma_f32_16x16x32_bf16 v[52:55], a[20:23], a[240:243], v[52:55]
 buffer_load_dwordx4 v14, s[4:7], s56 offen offset:3072 sc1 lds
 v_mfma_f32_16x16x32_bf16 v[92:95], a[20:23], a[244:247], v[92:95]
 ds_read_b128 a[0:3], v9 offset:31744
 v_mfma_f32_16x16x32_bf16 v[56:59], a[24:27], a[240:243], v[56:59]
 buffer_load_dwordx4 a[228:231], v3, s[4:7], s59 offen offset:0 sc1
 v_mfma_f32_16x16x32_bf16 v[96:99], a[24:27], a[244:247], v[96:99]
 ds_read_b128 a[4:7], v9 offset:32768
 s_add_u32 m0, s74, 45056
 v_mfma_f32_16x16x32_bf16 v[60:63], a[28:31], a[240:243], v[60:63]
 ds_read_b128 a[8:11], v9 offset:33792
 v_mfma_f32_16x16x32_bf16 v[100:103], a[28:31], a[244:247], v[100:103]
 v_mfma_f32_16x16x32_bf16 v[64:67], a[32:35], a[240:243], v[64:67]
 ds_read_b128 a[12:15], v9 offset:34816
 v_mfma_f32_16x16x32_bf16 v[104:107], a[32:35], a[244:247], v[104:107]
 buffer_load_dwordx4 a[232:235], v2, s[4:7], s59 offen offset:1024 sc1
 v_mfma_f32_16x16x32_bf16 v[68:71], a[36:39], a[240:243], v[68:71]
 s_add_u32 s56, s56, 4096
 ds_read_b128 a[16:19], v5 offset:20480
 v_mfma_f32_16x16x32_bf16 v[108:111], a[36:39], a[244:247], v[108:111]
 s_waitcnt lgkmcnt(5) vmcnt(36)
 v_mfma_f32_16x16x32_bf16 v[32:35], a[40:43], a[248:251], v[32:35]
 ds_read_b128 a[20:23], v5 offset:21504
 s_waitcnt vmcnt(35)
 v_mfma_f32_16x16x32_bf16 v[72:75], a[40:43], a[252:255], v[72:75]
 buffer_load_dwordx4 v14, s[4:7], s56 offen sc1 lds
 v_mfma_f32_16x16x32_bf16 v[36:39], a[44:47], a[248:251], v[36:39]
 ds_read_b128 a[24:27], v5 offset:22528
 v_mfma_f32_16x16x32_bf16 v[76:79], a[44:47], a[252:255], v[76:79]
 buffer_load_dwordx4 a[236:239], v3, s[4:7], s59 offen offset:1024 sc1
 v_mfma_f32_16x16x32_bf16 v[40:43], a[48:51], a[248:251], v[40:43]
 ds_read_b128 a[28:31], v5 offset:23552
 v_mfma_f32_16x16x32_bf16 v[80:83], a[48:51], a[252:255], v[80:83]
 s_add_u32 m0, s74, 61440
 v_mfma_f32_16x16x32_bf16 v[44:47], a[52:55], a[248:251], v[44:47]
 ds_read_b128 a[32:35], v5 offset:24576
 v_mfma_f32_16x16x32_bf16 v[84:87], a[52:55], a[252:255], v[84:87]
 v_mfma_f32_16x16x32_bf16 v[48:51], a[56:59], a[248:251], v[48:51]
 ds_read_b128 a[36:39], v8 offset:20480
 s_add_u32 s56, s70, 184320
 v_mfma_f32_16x16x32_bf16 v[88:91], a[56:59], a[252:255], v[88:91]
 v_mfma_f32_16x16x32_bf16 v[52:55], a[60:63], a[248:251], v[52:55]
 ds_read_b128 a[40:43], v8 offset:21504
 v_mfma_f32_16x16x32_bf16 v[92:95], a[60:63], a[252:255], v[92:95]
 s_waitcnt lgkmcnt(5)
 v_mfma_f32_16x16x32_bf16 v[56:59], a[0:3], a[248:251], v[56:59]
 ds_read_b128 a[44:47], v8 offset:22528
 v_mfma_f32_16x16x32_bf16 v[96:99], a[0:3], a[252:255], v[96:99]
 buffer_load_dwordx4 v14, s[4:7], s56 offen offset:0 sc1 lds
 v_mfma_f32_16x16x32_bf16 v[60:63], a[4:7], a[248:251], v[60:63]
 ds_read_b128 a[48:51], v8 offset:23552
 v_mfma_f32_16x16x32_bf16 v[100:103], a[4:7], a[252:255], v[100:103]
 v_mfma_f32_16x16x32_bf16 v[64:67], a[8:11], a[248:251], v[64:67]
 ds_read_b128 a[52:55], v8 offset:24576
 v_mfma_f32_16x16x32_bf16 v[104:107], a[8:11], a[252:255], v[104:107]
 buffer_load_dwordx4 v14, s[4:7], s56 offen offset:1024 sc1 lds
 v_mfma_f32_16x16x32_bf16 v[68:71], a[12:15], a[248:251], v[68:71]
 ds_read_b128 a[56:59], v5 offset:30720
 v_mfma_f32_16x16x32_bf16 v[108:111], a[12:15], a[252:255], v[108:111]
 s_waitcnt vmcnt(36)
 v_mfma_f32_16x16x32_bf16 v[32:35], a[16:19], a[176:179], v[32:35]
 ds_read_b128 a[60:63], v5 offset:31744
 s_waitcnt vmcnt(34)
 v_mfma_f32_16x16x32_bf16 v[72:75], a[16:19], a[180:183], v[72:75]
 buffer_load_dwordx4 v14, s[4:7], s56 offen offset:2048 sc1 lds
 v_mfma_f32_16x16x32_bf16 v[36:39], a[20:23], a[176:179], v[36:39]
 s_add_u32 s59, s72, 14336
 ds_read_b128 a[0:3], v5 offset:32768
 v_mfma_f32_16x16x32_bf16 v[76:79], a[20:23], a[180:183], v[76:79]
 v_lshlrev_b32 v172, 16, v122
 s_waitcnt lgkmcnt(5)
 v_mfma_f32_16x16x32_bf16 v[40:43], a[24:27], a[176:179], v[40:43]
 ds_read_b128 a[4:7], v5 offset:33792
 v_and_b32 v173, 0xffff0000, v122
 v_mfma_f32_16x16x32_bf16 v[80:83], a[24:27], a[180:183], v[80:83]
 buffer_load_dwordx4 v14, s[4:7], s56 offen offset:3072 sc1 lds
 v_mfma_f32_16x16x32_bf16 v[44:47], a[28:31], a[176:179], v[44:47]
 ds_read_b128 a[8:11], v5 offset:34816
 v_mfma_f32_16x16x32_bf16 v[84:87], a[28:31], a[180:183], v[84:87]
 buffer_load_dwordx4 a[240:243], v2, s[4:7], s59 offen offset:0 sc1
 v_mfma_f32_16x16x32_bf16 v[48:51], a[32:35], a[176:179], v[48:51]
 ds_read_b128 a[12:15], v8 offset:30720
 s_add_u32 m0, s74, 65536
 v_mfma_f32_16x16x32_bf16 v[88:91], a[32:35], a[180:183], v[88:91]
 v_lshlrev_b32 v174, 16, v123
 v_mfma_f32_16x16x32_bf16 v[52:55], a[36:39], a[176:179], v[52:55]
 ds_read_b128 a[16:19], v8 offset:31744
 v_mfma_f32_16x16x32_bf16 v[92:95], a[36:39], a[180:183], v[92:95]
 buffer_load_dwordx4 a[244:247], v3, s[4:7], s59 offen offset:0 sc1
 v_mfma_f32_16x16x32_bf16 v[56:59], a[40:43], a[176:179], v[56:59]
 ds_read_b128 a[20:23], v8 offset:32768
 s_add_u32 s56, s56, 4096
 v_mfma_f32_16x16x32_bf16 v[96:99], a[40:43], a[180:183], v[96:99]
 v_and_b32 v175, 0xffff0000, v123
 v_mfma_f32_16x16x32_bf16 v[60:63], a[44:47], a[176:179], v[60:63]
 ds_read_b128 a[24:27], v8 offset:33792
 v_lshlrev_b32 v176, 16, v124
 v_mfma_f32_16x16x32_bf16 v[100:103], a[44:47], a[180:183], v[100:103]
 s_waitcnt lgkmcnt(5)
 v_mfma_f32_16x16x32_bf16 v[64:67], a[48:51], a[176:179], v[64:67]
 ds_read_b128 a[28:31], v8 offset:34816
 v_mfma_f32_16x16x32_bf16 v[104:107], a[48:51], a[180:183], v[104:107]
 buffer_load_dwordx4 v14, s[4:7], s56 offen sc1 lds
 v_mfma_f32_16x16x32_bf16 v[68:71], a[52:55], a[176:179], v[68:71]
 buffer_load_dwordx4 a[248:251], v2, s[4:7], s59 offen offset:1024 sc1
 v_mfma_f32_16x16x32_bf16 v[108:111], a[52:55], a[180:183], v[108:111]
 v_and_b32 v177, 0xffff0000, v124
 s_waitcnt vmcnt(37)
 v_mfma_f32_16x16x32_bf16 v[32:35], a[56:59], a[184:187], v[32:35]
 s_waitcnt vmcnt(36)
 v_mfma_f32_16x16x32_bf16 v[72:75], a[56:59], a[188:191], v[72:75]
 v_mfma_f32_16x16x32_bf16 v[36:39], a[60:63], a[184:187], v[36:39]
 buffer_load_dwordx4 a[252:255], v3, s[4:7], s59 offen offset:1024 sc1
 v_mfma_f32_16x16x32_bf16 v[76:79], a[60:63], a[188:191], v[76:79]
 v_lshlrev_b32 v178, 16, v125
 v_mfma_f32_16x16x32_bf16 v[40:43], a[0:3], a[184:187], v[40:43]
 v_mfma_f32_16x16x32_bf16 v[80:83], a[0:3], a[188:191], v[80:83]
 v_mfma_f32_16x16x32_bf16 v[44:47], a[4:7], a[184:187], v[44:47]
 v_and_b32 v179, 0xffff0000, v125
 v_mfma_f32_16x16x32_bf16 v[84:87], a[4:7], a[188:191], v[84:87]
 s_waitcnt lgkmcnt(0)
 v_mfma_f32_16x16x32_bf16 v[48:51], a[8:11], a[184:187], v[48:51]
 s_waitcnt vmcnt(36)
 s_waitcnt lgkmcnt(0)
 s_barrier
 v_mfma_f32_16x16x32_bf16 v[88:91], a[8:11], a[188:191], v[88:91]
 ds_read_b128 a[32:35], v5 offset:40960
 ds_read_b128 a[36:39], v5 offset:41984
 v_mfma_f32_16x16x32_bf16 v[52:55], a[12:15], a[184:187], v[52:55]
 ds_read_b128 a[40:43], v5 offset:43008
 ds_read_b128 a[44:47], v5 offset:44032
 v_mfma_f32_16x16x32_bf16 v[92:95], a[12:15], a[188:191], v[92:95]
 s_add_u32 m0, s74, 143360
 ds_read_b128 a[48:51], v5 offset:45056
 v_mfma_f32_16x16x32_bf16 v[56:59], a[16:19], a[184:187], v[56:59]
 ds_read_b128 a[52:55], v8 offset:40960
 ds_read_b128 a[56:59], v8 offset:41984
 v_mfma_f32_16x16x32_bf16 v[96:99], a[16:19], a[188:191], v[96:99]
 ds_read_b128 a[60:63], v8 offset:43008
 s_add_u32 s56, s70, 204800
 v_mfma_f32_16x16x32_bf16 v[60:63], a[20:23], a[184:187], v[60:63]
 ds_read_b128 a[0:3], v8 offset:44032
 v_lshlrev_b32 v180, 16, v126
 v_mfma_f32_16x16x32_bf16 v[100:103], a[20:23], a[188:191], v[100:103]
 v_and_b32 v181, 0xffff0000, v126
 v_mfma_f32_16x16x32_bf16 v[64:67], a[24:27], a[184:187], v[64:67]
 ds_read_b128 a[4:7], v8 offset:45056
 v_mfma_f32_16x16x32_bf16 v[104:107], a[24:27], a[188:191], v[104:107]
 buffer_load_dwordx4 v14, s[4:7], s56 offen offset:0 sc1 lds
 v_mfma_f32_16x16x32_bf16 v[68:71], a[28:31], a[184:187], v[68:71]
 ds_read_b128 a[8:11], v5 offset:51200
 v_lshlrev_b32 v182, 16, v127
 v_mfma_f32_16x16x32_bf16 v[108:111], a[28:31], a[188:191], v[108:111]
 s_waitcnt lgkmcnt(10) vmcnt(33)
 v_mfma_f32_16x16x32_bf16 v[32:35], a[32:35], a[192:195], v[32:35]
 ds_read_b128 a[12:15], v5 offset:52224
 s_waitcnt vmcnt(31)
 v_mfma_f32_16x16x32_bf16 v[72:75], a[32:35], a[196:199], v[72:75]
 v_and_b32 v183, 0xffff0000, v127
 s_waitcnt lgkmcnt(8)
 v_mfma_f32_16x16x32_bf16 v[36:39], a[36:39], a[192:195], v[36:39]
 buffer_load_dwordx4 v14, s[4:7], s56 offen offset:1024 sc1 lds
 v_mfma_f32_16x16x32_bf16 v[76:79], a[36:39], a[196:199], v[76:79]
 ds_read_b128 a[16:19], v5 offset:53248
 v_mfma_f32_16x16x32_bf16 v[40:43], a[40:43], a[192:195], v[40:43]
 ds_read_b128 a[20:23], v5 offset:54272
 v_lshlrev_b32 v184, 16, v128
 v_mfma_f32_16x16x32_bf16 v[80:83], a[40:43], a[196:199], v[80:83]
 buffer_load_dwordx4 v14, s[4:7], s56 offen offset:2048 sc1 lds
 v_mfma_f32_16x16x32_bf16 v[44:47], a[44:47], a[192:195], v[44:47]
 ds_read_b128 a[24:27], v5 offset:55296
 v_mfma_f32_16x16x32_bf16 v[84:87], a[44:47], a[196:199], v[84:87]
 s_waitcnt lgkmcnt(5)
 v_mfma_f32_16x16x32_bf16 v[48:51], a[48:51], a[192:195], v[48:51]
 ds_read_b128 a[28:31], v8 offset:51200
 v_and_b32 v185, 0xffff0000, v128
 v_mfma_f32_16x16x32_bf16 v[88:91], a[48:51], a[196:199], v[88:91]
 buffer_load_dwordx4 v14, s[4:7], s56 offen offset:3072 sc1 lds
 v_mfma_f32_16x16x32_bf16 v[52:55], a[52:55], a[192:195], v[52:55]
 ds_read_b128 a[32:35], v8 offset:52224
 v_mfma_f32_16x16x32_bf16 v[92:95], a[52:55], a[196:199], v[92:95]
 v_mfma_f32_16x16x32_bf16 v[56:59], a[56:59], a[192:195], v[56:59]
 ds_read_b128 a[36:39], v8 offset:53248
 v_lshlrev_b32 v186, 16, v129
 v_mfma_f32_16x16x32_bf16 v[96:99], a[56:59], a[196:199], v[96:99]
 s_add_u32 m0, s74, 147456
 v_mfma_f32_16x16x32_bf16 v[60:63], a[60:63], a[192:195], v[60:63]
 ds_read_b128 a[40:43], v8 offset:54272
 v_mfma_f32_16x16x32_bf16 v[100:103], a[60:63], a[196:199], v[100:103]
 v_and_b32 v187, 0xffff0000, v129
 v_mfma_f32_16x16x32_bf16 v[64:67], a[0:3], a[192:195], v[64:67]
 ds_read_b128 a[44:47], v8 offset:55296
 v_mfma_f32_16x16x32_bf16 v[104:107], a[0:3], a[196:199], v[104:107]
 s_add_u32 s56, s56, 4096
 v_mfma_f32_16x16x32_bf16 v[68:71], a[4:7], a[192:195], v[68:71]
 ds_read_b128 a[48:51], v6 offset:0
 v_mfma_f32_16x16x32_bf16 v[108:111], a[4:7], a[196:199], v[108:111]
 v_lshlrev_b32 v188, 16, v130
 s_waitcnt lgkmcnt(5) vmcnt(33)
 v_mfma_f32_16x16x32_bf16 v[32:35], a[8:11], a[200:203], v[32:35]
 ds_read_b128 a[52:55], v6 offset:1024
 s_waitcnt vmcnt(31)
 v_mfma_f32_16x16x32_bf16 v[72:75], a[8:11], a[204:207], v[72:75]
 buffer_load_dwordx4 v14, s[4:7], s56 offen sc1 lds
 v_mfma_f32_16x16x32_bf16 v[36:39], a[12:15], a[200:203], v[36:39]
 ds_read_b128 a[56:59], v6 offset:2048
 v_mfma_f32_16x16x32_bf16 v[76:79], a[12:15], a[204:207], v[76:79]
 v_and_b32 v189, 0xffff0000, v130
 v_mfma_f32_16x16x32_bf16 v[40:43], a[16:19], a[200:203], v[40:43]
 ds_read_b128 a[60:63], v6 offset:3072
 v_mfma_f32_16x16x32_bf16 v[80:83], a[16:19], a[204:207], v[80:83]
 s_add_u32 m0, s74, 81920
 v_mfma_f32_16x16x32_bf16 v[44:47], a[20:23], a[200:203], v[44:47]
 ds_read_b128 a[0:3], v6 offset:4096
 v_lshlrev_b32 v190, 16, v131
 v_mfma_f32_16x16x32_bf16 v[84:87], a[20:23], a[204:207], v[84:87]
 v_mfma_f32_16x16x32_bf16 v[48:51], a[24:27], a[200:203], v[48:51]
 ds_read_b128 a[4:7], v9 offset:0
 s_add_u32 s56, s70, 225280
 v_mfma_f32_16x16x32_bf16 v[88:91], a[24:27], a[204:207], v[88:91]
 v_mfma_f32_16x16x32_bf16 v[52:55], a[28:31], a[200:203], v[52:55]
 ds_read_b128 a[8:11], v9 offset:1024
 v_and_b32 v191, 0xffff0000, v131
 v_mfma_f32_16x16x32_bf16 v[92:95], a[28:31], a[204:207], v[92:95]
 s_waitcnt lgkmcnt(5)
 v_mfma_f32_16x16x32_bf16 v[56:59], a[32:35], a[200:203], v[56:59]
 buffer_load_dword v15, v13, s[4:7], s78 offen sc1
 v_mfma_f32_16x16x32_bf16 v[96:99], a[32:35], a[204:207], v[96:99]
 ds_read_b128 a[12:15], v9 offset:2048
 v_mfma_f32_16x16x32_bf16 v[60:63], a[36:39], a[200:203], v[60:63]
 buffer_load_dwordx4 v14, s[4:7], s56 offen offset:0 sc1 lds
 v_mfma_f32_16x16x32_bf16 v[100:103], a[36:39], a[204:207], v[100:103]
 ds_read_b128 a[16:19], v9 offset:3072
 s_mul_i32 s58, s3, 3072
 v_mfma_f32_16x16x32_bf16 v[64:67], a[40:43], a[200:203], v[64:67]
 ds_read_b128 a[20:23], v9 offset:4096
 v_mfma_f32_16x16x32_bf16 v[104:107], a[40:43], a[204:207], v[104:107]
 buffer_load_dwordx4 v14, s[4:7], s56 offen offset:1024 sc1 lds
 v_mfma_f32_16x16x32_bf16 v[68:71], a[44:47], a[200:203], v[68:71]
 ds_read_b128 a[24:27], v6 offset:10240
 s_lshl_b32 s57, s75, 2
 v_mfma_f32_16x16x32_bf16 v[108:111], a[44:47], a[204:207], v[108:111]
 s_waitcnt vmcnt(30)
 v_mfma_f32_16x16x32_bf16 v[32:35], a[48:51], a[208:211], v[32:35]
 ds_read_b128 a[28:31], v6 offset:11264
 s_waitcnt vmcnt(29)
 v_mfma_f32_16x16x32_bf16 v[72:75], a[48:51], a[212:215], v[72:75]
 buffer_load_dwordx4 v14, s[4:7], s56 offen offset:2048 sc1 lds
 v_mfma_f32_16x16x32_bf16 v[36:39], a[52:55], a[208:211], v[36:39]
 ds_read_b128 a[32:35], v6 offset:12288
 s_xor_b32 s31, s66, 0
 v_mfma_f32_16x16x32_bf16 v[76:79], a[52:55], a[212:215], v[76:79]
 s_waitcnt lgkmcnt(5)
 v_mfma_f32_16x16x32_bf16 v[40:43], a[56:59], a[208:211], v[40:43]
 ds_read_b128 a[36:39], v6 offset:13312
 v_mfma_f32_16x16x32_bf16 v[80:83], a[56:59], a[212:215], v[80:83]
 buffer_load_dwordx4 v14, s[4:7], s56 offen offset:3072 sc1 lds
 v_mfma_f32_16x16x32_bf16 v[44:47], a[60:63], a[208:211], v[44:47]
 ds_read_b128 a[40:43], v6 offset:14336
 s_add_u32 s31, s31, s57
 v_mfma_f32_16x16x32_bf16 v[84:87], a[60:63], a[212:215], v[84:87]
 v_mfma_f32_16x16x32_bf16 v[48:51], a[0:3], a[208:211], v[48:51]
 ds_read_b128 a[44:47], v9 offset:10240
 s_add_u32 m0, s74, 86016
 v_mfma_f32_16x16x32_bf16 v[88:91], a[0:3], a[212:215], v[88:91]
 s_mul_i32 s31, s31, 36864
 v_mfma_f32_16x16x32_bf16 v[52:55], a[4:7], a[208:211], v[52:55]
 ds_read_b128 a[48:51], v9 offset:11264
 v_mfma_f32_16x16x32_bf16 v[92:95], a[4:7], a[212:215], v[92:95]
 v_mfma_f32_16x16x32_bf16 v[56:59], a[8:11], a[208:211], v[56:59]
 ds_read_b128 a[52:55], v9 offset:12288
 s_add_u32 s56, s56, 4096
 v_mfma_f32_16x16x32_bf16 v[96:99], a[8:11], a[212:215], v[96:99]
 s_add_u32 s31, s31, s58
 v_mfma_f32_16x16x32_bf16 v[60:63], a[12:15], a[208:211], v[60:63]
 ds_read_b128 a[56:59], v9 offset:13312
 v_mfma_f32_16x16x32_bf16 v[100:103], a[12:15], a[212:215], v[100:103]
 s_waitcnt lgkmcnt(5)
 v_mfma_f32_16x16x32_bf16 v[64:67], a[16:19], a[208:211], v[64:67]
 ds_read_b128 a[60:63], v9 offset:14336
 s_add_u32 s31, s31, 72351744
 v_mfma_f32_16x16x32_bf16 v[104:107], a[16:19], a[212:215], v[104:107]
 buffer_load_dwordx4 v14, s[4:7], s56 offen sc1 lds
 v_mfma_f32_16x16x32_bf16 v[68:71], a[20:23], a[208:211], v[68:71]
 v_mfma_f32_16x16x32_bf16 v[108:111], a[20:23], a[212:215], v[108:111]
 s_waitcnt vmcnt(30)
 v_mfma_f32_16x16x32_bf16 v[32:35], a[24:27], a[216:219], v[32:35]
 s_xor_b32 s28, s66, 1
 s_waitcnt vmcnt(29)
 v_mfma_f32_16x16x32_bf16 v[72:75], a[24:27], a[220:223], v[72:75]
 v_mfma_f32_16x16x32_bf16 v[36:39], a[28:31], a[216:219], v[36:39]
 v_mfma_f32_16x16x32_bf16 v[76:79], a[28:31], a[220:223], v[76:79]
 v_mfma_f32_16x16x32_bf16 v[40:43], a[32:35], a[216:219], v[40:43]
 s_add_u32 s28, s28, s57
 v_mfma_f32_16x16x32_bf16 v[80:83], a[32:35], a[220:223], v[80:83]
 v_mfma_f32_16x16x32_bf16 v[44:47], a[36:39], a[216:219], v[44:47]
 v_mfma_f32_16x16x32_bf16 v[84:87], a[36:39], a[220:223], v[84:87]
 s_mul_i32 s28, s28, 36864
 s_waitcnt lgkmcnt(0)
 v_mfma_f32_16x16x32_bf16 v[48:51], a[40:43], a[216:219], v[48:51]
 s_waitcnt lgkmcnt(0)
 s_barrier
 v_mfma_f32_16x16x32_bf16 v[88:91], a[40:43], a[220:223], v[88:91]
 ds_read_b128 a[0:3], v4 offset:0
 ds_read_b128 a[4:7], v4 offset:1024
 v_mfma_f32_16x16x32_bf16 v[52:55], a[44:47], a[216:219], v[52:55]
 ds_read_b128 a[8:11], v4 offset:2048
 ds_read_b128 a[12:15], v4 offset:3072
 v_mfma_f32_16x16x32_bf16 v[92:95], a[44:47], a[220:223], v[92:95]
 s_add_u32 m0, s74, 102400
 ds_read_b128 a[16:19], v4 offset:4096
 v_mfma_f32_16x16x32_bf16 v[56:59], a[48:51], a[216:219], v[56:59]
 ds_read_b128 a[20:23], v7 offset:0
 ds_read_b128 a[24:27], v7 offset:1024
 v_mfma_f32_16x16x32_bf16 v[96:99], a[48:51], a[220:223], v[96:99]
 ds_read_b128 a[28:31], v7 offset:2048
 s_add_u32 s56, s70, 245760
 v_mfma_f32_16x16x32_bf16 v[60:63], a[52:55], a[216:219], v[60:63]
 ds_read_b128 a[32:35], v7 offset:3072
 s_add_u32 s28, s28, s58
 v_mfma_f32_16x16x32_bf16 v[100:103], a[52:55], a[220:223], v[100:103]
 s_add_u32 s28, s28, 72351744
 v_mfma_f32_16x16x32_bf16 v[64:67], a[56:59], a[216:219], v[64:67]
 ds_read_b128 a[36:39], v7 offset:4096
 v_mfma_f32_16x16x32_bf16 v[104:107], a[56:59], a[220:223], v[104:107]
 buffer_load_dwordx4 v14, s[4:7], s56 offen offset:0 sc1 lds
 v_mfma_f32_16x16x32_bf16 v[68:71], a[60:63], a[216:219], v[68:71]
 ds_read_b128 a[40:43], v4 offset:10240
 v_mfma_f32_16x16x32_bf16 v[108:111], a[60:63], a[220:223], v[108:111]
 s_xor_b32 s29, s66, 2
 s_waitcnt lgkmcnt(10) vmcnt(26)
 v_mfma_f32_16x16x32_bf16 v[32:35], a[0:3], a[224:227], v[32:35]
 ds_read_b128 a[44:47], v4 offset:11264
 s_waitcnt vmcnt(24)
 v_mfma_f32_16x16x32_bf16 v[72:75], a[0:3], a[228:231], v[72:75]
 s_waitcnt vmcnt(6)
 v_cmp_ne_u32 vcc, s98, v15
 s_cbranch_vccnz P_parall_28
PB_parall_29:
 s_waitcnt lgkmcnt(4)
 v_mfma_f32_16x16x32_bf16 v[36:39], a[4:7], a[224:227], v[36:39]
 s_add_u32 s59, s72, 16384
 s_add_u32 s29, s29, s57
 v_mfma_f32_16x16x32_bf16 v[76:79], a[4:7], a[228:231], v[76:79]
 buffer_load_dwordx4 v14, s[4:7], s56 offen offset:1024 sc1 lds
 v_mfma_f32_16x16x32_bf16 v[40:43], a[8:11], a[224:227], v[40:43]
 ds_read_b128 a[48:51], v4 offset:12288
 v_mfma_f32_16x16x32_bf16 v[80:83], a[8:11], a[228:231], v[80:83]
 buffer_load_dwordx4 a[64:67], v2, s[4:7], s59 offen offset:0 sc1
 v_mfma_f32_16x16x32_bf16 v[44:47], a[12:15], a[224:227], v[44:47]
 ds_read_b128 a[52:55], v4 offset:13312
 s_mul_i32 s29, s29, 36864
 v_mfma_f32_16x16x32_bf16 v[84:87], a[12:15], a[228:231], v[84:87]
 buffer_load_dwordx4 a[180:183], v3, s[4:7], s59 offen offset:0 sc1
 v_mfma_f32_16x16x32_bf16 v[48:51], a[16:19], a[224:227], v[48:51]
 buffer_load_dwordx4 v14, s[4:7], s56 offen offset:2048 sc1 lds
 v_mfma_f32_16x16x32_bf16 v[88:91], a[16:19], a[228:231], v[88:91]
 ds_read_b128 a[56:59], v4 offset:14336
 v_mfma_f32_16x16x32_bf16 v[52:55], a[20:23], a[224:227], v[52:55]
 buffer_load_dwordx4 a[68:71], v2, s[4:7], s59 offen offset:1024 sc1
 v_mfma_f32_16x16x32_bf16 v[92:95], a[20:23], a[228:231], v[92:95]
 ds_read_b128 a[60:63], v7 offset:10240
 s_add_u32 s29, s29, s58
 v_mfma_f32_16x16x32_bf16 v[56:59], a[24:27], a[224:227], v[56:59]
 buffer_load_dwordx4 v14, s[4:7], s56 offen offset:3072 sc1 lds
 v_mfma_f32_16x16x32_bf16 v[96:99], a[24:27], a[228:231], v[96:99]
 buffer_load_dwordx4 a[188:191], v3, s[4:7], s59 offen offset:1024 sc1
 v_mfma_f32_16x16x32_bf16 v[60:63], a[28:31], a[224:227], v[60:63]
 ds_read_b128 a[0:3], v7 offset:11264
 ds_read_b128 a[4:7], v7 offset:12288
 v_mfma_f32_16x16x32_bf16 v[100:103], a[28:31], a[228:231], v[100:103]
 s_add_u32 s59, s72, 18432
 s_waitcnt lgkmcnt(5)
 v_mfma_f32_16x16x32_bf16 v[64:67], a[32:35], a[224:227], v[64:67]
 s_add_u32 m0, s74, 106496
 ds_read_b128 a[8:11], v7 offset:13312
 v_mfma_f32_16x16x32_bf16 v[104:107], a[32:35], a[228:231], v[104:107]
 buffer_load_dwordx4 a[72:75], v2, s[4:7], s59 offen offset:0 sc1
 v_mfma_f32_16x16x32_bf16 v[68:71], a[36:39], a[224:227], v[68:71]
 ds_read_b128 a[12:15], v7 offset:14336
 s_add_u32 s56, s56, 4096
 v_mfma_f32_16x16x32_bf16 v[108:111], a[36:39], a[228:231], v[108:111]
 buffer_load_dwordx4 a[196:199], v3, s[4:7], s59 offen offset:0 sc1
 v_mfma_f32_16x16x32_bf16 v[32:35], a[40:43], a[232:235], v[32:35]
 ds_read_b128 a[16:19], v4 offset:20480
 s_add_u32 s29, s29, 72364032
 v_mfma_f32_16x16x32_bf16 v[72:75], a[40:43], a[236:239], v[72:75]
 buffer_load_dwordx4 a[76:79], v2, s[4:7], s59 offen offset:1024 sc1
 v_mfma_f32_16x16x32_bf16 v[36:39], a[44:47], a[232:235], v[36:39]
 ds_read_b128 a[20:23], v4 offset:21504
 s_xor_b32 s30, s66, 3
 v_mfma_f32_16x16x32_bf16 v[76:79], a[44:47], a[236:239], v[76:79]
 buffer_load_dwordx4 v14, s[4:7], s56 offen sc1 lds
 v_mfma_f32_16x16x32_bf16 v[40:43], a[48:51], a[232:235], v[40:43]
 buffer_load_dwordx4 a[204:207], v3, s[4:7], s59 offen offset:1024 sc1
 v_mfma_f32_16x16x32_bf16 v[80:83], a[48:51], a[236:239], v[80:83]
 ds_read_b128 a[24:27], v4 offset:22528
 s_waitcnt lgkmcnt(5)
 v_mfma_f32_16x16x32_bf16 v[44:47], a[52:55], a[232:235], v[44:47]
 ds_read_b128 a[28:31], v4 offset:23552
 s_add_u32 m0, s74, 122880
 v_mfma_f32_16x16x32_bf16 v[84:87], a[52:55], a[236:239], v[84:87]
 s_add_u32 s59, s72, 20480
 ds_read_b128 a[32:35], v4 offset:24576
 v_mfma_f32_16x16x32_bf16 v[48:51], a[56:59], a[232:235], v[48:51]
 buffer_load_dwordx4 a[80:83], v2, s[4:7], s59 offen offset:0 sc1
 v_mfma_f32_16x16x32_bf16 v[88:91], a[56:59], a[236:239], v[88:91]
 ds_read_b128 a[36:39], v7 offset:20480
 s_add_u32 s56, s70, 266240
 v_mfma_f32_16x16x32_bf16 v[52:55], a[60:63], a[232:235], v[52:55]
 buffer_load_dwordx4 a[212:215], v3, s[4:7], s59 offen offset:0 sc1
 v_mfma_f32_16x16x32_bf16 v[92:95], a[60:63], a[236:239], v[92:95]
 ds_read_b128 a[40:43], v7 offset:21504
 s_add_u32 s30, s30, s57
 v_mfma_f32_16x16x32_bf16 v[56:59], a[0:3], a[232:235], v[56:59]
 buffer_load_dwordx4 a[84:87], v2, s[4:7], s59 offen offset:1024 sc1
 v_mfma_f32_16x16x32_bf16 v[96:99], a[0:3], a[236:239], v[96:99]
 ds_read_b128 a[44:47], v7 offset:22528
 s_mul_i32 s30, s30, 36864
 v_mfma_f32_16x16x32_bf16 v[60:63], a[4:7], a[232:235], v[60:63]
 buffer_load_dwordx4 v14, s[4:7], s56 offen offset:0 sc1 lds
 v_mfma_f32_16x16x32_bf16 v[100:103], a[4:7], a[236:239], v[100:103]
 s_add_u32 s30, s30, s58
 s_waitcnt lgkmcnt(5)
 v_mfma_f32_16x16x32_bf16 v[64:67], a[8:11], a[232:235], v[64:67]
 buffer_load_dwordx4 a[220:223], v3, s[4:7], s59 offen offset:1024 sc1
 v_mfma_f32_16x16x32_bf16 v[104:107], a[8:11], a[236:239], v[104:107]
 ds_read_b128 a[48:51], v7 offset:23552
 ds_read_b128 a[52:55], v7 offset:24576
 v_mfma_f32_16x16x32_bf16 v[68:71], a[12:15], a[232:235], v[68:71]
 buffer_load_dwordx4 v14, s[4:7], s56 offen offset:1024 sc1 lds
 v_mfma_f32_16x16x32_bf16 v[108:111], a[12:15], a[236:239], v[108:111]
 ds_read_b128 a[56:59], v4 offset:30720
 s_add_u32 s30, s30, 72376320
 v_mfma_f32_16x16x32_bf16 v[32:35], a[16:19], a[240:243], v[32:35]
 ds_read_b128 a[60:63], v4 offset:31744
 s_mov_b32 s76, 0
 v_mfma_f32_16x16x32_bf16 v[72:75], a[16:19], a[244:247], v[72:75]
 buffer_load_dwordx4 v14, s[4:7], s56 offen offset:2048 sc1 lds
 v_mfma_f32_16x16x32_bf16 v[36:39], a[20:23], a[240:243], v[36:39]
 s_add_u32 s59, s72, 22528
 ds_read_b128 a[0:3], v4 offset:32768
 v_mfma_f32_16x16x32_bf16 v[76:79], a[20:23], a[244:247], v[76:79]
 v_mfma_f32_16x16x32_bf16 v[40:43], a[24:27], a[240:243], v[40:43]
 ds_read_b128 a[4:7], v4 offset:33792
 v_mfma_f32_16x16x32_bf16 v[80:83], a[24:27], a[244:247], v[80:83]
 s_waitcnt lgkmcnt(6)
 v_mfma_f32_16x16x32_bf16 v[44:47], a[28:31], a[240:243], v[44:47]
 buffer_load_dwordx4 v14, s[4:7], s56 offen offset:3072 sc1 lds
 v_mfma_f32_16x16x32_bf16 v[84:87], a[28:31], a[244:247], v[84:87]
 ds_read_b128 a[8:11], v4 offset:34816
 v_mfma_f32_16x16x32_bf16 v[48:51], a[32:35], a[240:243], v[48:51]
 buffer_load_dwordx4 a[224:227], v2, s[4:7], s59 offen offset:0 sc1
 v_mfma_f32_16x16x32_bf16 v[88:91], a[32:35], a[244:247], v[88:91]
 ds_read_b128 a[12:15], v7 offset:30720
 s_add_u32 m0, s74, 126976
 v_mfma_f32_16x16x32_bf16 v[52:55], a[36:39], a[240:243], v[52:55]
 ds_read_b128 a[16:19], v7 offset:31744
 v_mfma_f32_16x16x32_bf16 v[92:95], a[36:39], a[244:247], v[92:95]
 buffer_load_dwordx4 a[228:231], v3, s[4:7], s59 offen offset:0 sc1
 v_mfma_f32_16x16x32_bf16 v[56:59], a[40:43], a[240:243], v[56:59]
 ds_read_b128 a[20:23], v7 offset:32768
 s_add_u32 s56, s56, 4096
 v_mfma_f32_16x16x32_bf16 v[96:99], a[40:43], a[244:247], v[96:99]
 v_mfma_f32_16x16x32_bf16 v[60:63], a[44:47], a[240:243], v[60:63]
 ds_read_b128 a[24:27], v7 offset:33792
 v_mfma_f32_16x16x32_bf16 v[100:103], a[44:47], a[244:247], v[100:103]
 s_waitcnt lgkmcnt(5)
 v_mfma_f32_16x16x32_bf16 v[64:67], a[48:51], a[240:243], v[64:67]
 ds_read_b128 a[28:31], v7 offset:34816
 v_mfma_f32_16x16x32_bf16 v[104:107], a[48:51], a[244:247], v[104:107]
 buffer_load_dwordx4 v14, s[4:7], s56 offen sc1 lds
 v_mfma_f32_16x16x32_bf16 v[68:71], a[52:55], a[240:243], v[68:71]
 buffer_load_dwordx4 a[232:235], v2, s[4:7], s59 offen offset:1024 sc1
 v_mfma_f32_16x16x32_bf16 v[108:111], a[52:55], a[244:247], v[108:111]
 v_mfma_f32_16x16x32_bf16 v[32:35], a[56:59], a[248:251], v[32:35]
 v_mfma_f32_16x16x32_bf16 v[72:75], a[56:59], a[252:255], v[72:75]
 v_mfma_f32_16x16x32_bf16 v[36:39], a[60:63], a[248:251], v[36:39]
 buffer_load_dwordx4 a[236:239], v3, s[4:7], s59 offen offset:1024 sc1
 v_mfma_f32_16x16x32_bf16 v[76:79], a[60:63], a[252:255], v[76:79]
 v_mfma_f32_16x16x32_bf16 v[40:43], a[0:3], a[248:251], v[40:43]
 v_mfma_f32_16x16x32_bf16 v[80:83], a[0:3], a[252:255], v[80:83]
 v_mfma_f32_16x16x32_bf16 v[44:47], a[4:7], a[248:251], v[44:47]
 v_mfma_f32_16x16x32_bf16 v[84:87], a[4:7], a[252:255], v[84:87]
 s_waitcnt lgkmcnt(0)
 v_mfma_f32_16x16x32_bf16 v[48:51], a[8:11], a[248:251], v[48:51]
 s_waitcnt lgkmcnt(0)
 s_barrier
 v_mfma_f32_16x16x32_bf16 v[88:91], a[8:11], a[252:255], v[88:91]
 ds_read_b128 a[32:35], v4 offset:40960
 ds_read_b128 a[36:39], v4 offset:41984
 v_mfma_f32_16x16x32_bf16 v[52:55], a[12:15], a[248:251], v[52:55]
 ds_read_b128 a[40:43], v4 offset:43008
 ds_read_b128 a[44:47], v4 offset:44032
 v_mfma_f32_16x16x32_bf16 v[92:95], a[12:15], a[252:255], v[92:95]
 s_add_u32 m0, s74, 0
 ds_read_b128 a[48:51], v4 offset:45056
 v_mfma_f32_16x16x32_bf16 v[56:59], a[16:19], a[248:251], v[56:59]
 ds_read_b128 a[52:55], v7 offset:40960
 ds_read_b128 a[56:59], v7 offset:41984
 v_mfma_f32_16x16x32_bf16 v[96:99], a[16:19], a[252:255], v[96:99]
 ds_read_b128 a[60:63], v7 offset:43008
 ds_read_b128 a[0:3], v7 offset:44032
 v_mfma_f32_16x16x32_bf16 v[60:63], a[20:23], a[248:251], v[60:63]
 ds_read_b128 a[4:7], v7 offset:45056
 s_add_u32 s56, s70, 286720
 v_mfma_f32_16x16x32_bf16 v[100:103], a[20:23], a[252:255], v[100:103]
 ds_read_b128 a[8:11], v4 offset:51200
 ds_read_b128 a[12:15], v4 offset:52224
 v_mfma_f32_16x16x32_bf16 v[64:67], a[24:27], a[248:251], v[64:67]
 ds_read_b128 a[16:19], v4 offset:53248
 ds_read_b128 a[20:23], v4 offset:54272
 v_mfma_f32_16x16x32_bf16 v[104:107], a[24:27], a[252:255], v[104:107]
 buffer_load_dwordx4 v14, s[4:7], s56 offen offset:0 sc1 lds
 v_mfma_f32_16x16x32_bf16 v[68:71], a[28:31], a[248:251], v[68:71]
 ds_read_b128 a[24:27], v4 offset:55296
 v_mfma_f32_16x16x32_bf16 v[108:111], a[28:31], a[252:255], v[108:111]
 ds_read_b128 a[28:31], v7 offset:51200
 s_waitcnt lgkmcnt(15) vmcnt(23)
 v_mfma_f32_16x16x32_bf16 v[72:75], a[32:35], a[180:183], v[72:75]
 s_waitcnt lgkmcnt(13)
 v_mfma_f32_16x16x32_bf16 v[76:79], a[36:39], a[180:183], v[76:79]
 buffer_load_dwordx4 v14, s[4:7], s56 offen offset:1024 sc1 lds
 v_mfma_f32_16x16x32_bf16 v[80:83], a[40:43], a[180:183], v[80:83]
 ds_read_b128 a[32:35], v7 offset:52224
 s_waitcnt lgkmcnt(11)
 v_mfma_f32_16x16x32_bf16 v[84:87], a[44:47], a[180:183], v[84:87]
 s_add_u32 s59, s72, 24576
 ds_read_b128 a[36:39], v7 offset:53248
 v_mfma_f32_16x16x32_bf16 v[88:91], a[48:51], a[180:183], v[88:91]
 buffer_load_dwordx4 v14, s[4:7], s56 offen offset:2048 sc1 lds
 v_mfma_f32_16x16x32_bf16 v[52:55], a[52:55], a[64:67], v[52:55]
 ds_read_b128 a[40:43], v7 offset:54272
 v_mfma_f32_16x16x32_bf16 v[92:95], a[52:55], a[180:183], v[92:95]
 s_waitcnt lgkmcnt(6)
 v_mfma_f32_16x16x32_bf16 v[56:59], a[56:59], a[64:67], v[56:59]
 buffer_load_dwordx4 v14, s[4:7], s56 offen offset:3072 sc1 lds
 v_mfma_f32_16x16x32_bf16 v[96:99], a[56:59], a[180:183], v[96:99]
 ds_read_b128 a[44:47], v7 offset:55296
 v_mfma_f32_16x16x32_bf16 v[60:63], a[60:63], a[64:67], v[60:63]
 buffer_load_dwordx4 a[240:243], v2, s[4:7], s59 offen offset:0 sc1
 v_mfma_f32_16x16x32_bf16 v[100:103], a[60:63], a[180:183], v[100:103]
 ds_read_b128 a[48:51], v5 offset:0
 s_add_u32 m0, s74, 4096
 v_mfma_f32_16x16x32_bf16 v[64:67], a[0:3], a[64:67], v[64:67]
 ds_read_b128 a[52:55], v5 offset:1024
 ds_read_b128 a[56:59], v5 offset:2048
 v_mfma_f32_16x16x32_bf16 v[104:107], a[0:3], a[180:183], v[104:107]
 ds_read_b128 a[60:63], v5 offset:3072
 s_add_u32 s56, s56, 4096
 v_mfma_f32_16x16x32_bf16 v[68:71], a[4:7], a[64:67], v[68:71]
 buffer_load_dwordx4 a[244:247], v3, s[4:7], s59 offen offset:0 sc1
 v_mfma_f32_16x16x32_bf16 v[108:111], a[4:7], a[180:183], v[108:111]
 ds_read_b128 a[0:3], v5 offset:4096
 s_waitcnt vmcnt(24)
 v_mfma_f32_16x16x32_bf16 v[72:75], a[8:11], a[188:191], v[72:75]
 ds_read_b128 a[4:7], v8 offset:0
 v_mfma_f32_16x16x32_bf16 v[76:79], a[12:15], a[188:191], v[76:79]
 buffer_load_dwordx4 v14, s[4:7], s56 offen sc1 lds
 v_mfma_f32_16x16x32_bf16 v[80:83], a[16:19], a[188:191], v[80:83]
 ds_read_b128 a[8:11], v8 offset:1024
 s_waitcnt lgkmcnt(8)
 v_mfma_f32_16x16x32_bf16 v[84:87], a[20:23], a[188:191], v[84:87]
 ds_read_b128 a[12:15], v8 offset:2048
 v_mfma_f32_16x16x32_bf16 v[88:91], a[24:27], a[188:191], v[88:91]
 buffer_load_dwordx4 a[248:251], v2, s[4:7], s59 offen offset:1024 sc1
 v_mfma_f32_16x16x32_bf16 v[52:55], a[28:31], a[68:71], v[52:55]
 s_add_u32 m0, s74, 20480
 ds_read_b128 a[16:19], v8 offset:3072
 v_mfma_f32_16x16x32_bf16 v[92:95], a[28:31], a[188:191], v[92:95]
 ds_read_b128 a[20:23], v8 offset:4096
 s_add_u32 s56, s70, 307200
 v_mfma_f32_16x16x32_bf16 v[56:59], a[32:35], a[68:71], v[56:59]
 buffer_load_dwordx4 a[252:255], v3, s[4:7], s59 offen offset:1024 sc1
 v_mfma_f32_16x16x32_bf16 v[96:99], a[32:35], a[188:191], v[96:99]
 ds_read_b128 a[24:27], v5 offset:10240
 v_mfma_f32_16x16x32_bf16 v[60:63], a[36:39], a[68:71], v[60:63]
 ds_read_b128 a[28:31], v5 offset:11264
 v_mfma_f32_16x16x32_bf16 v[100:103], a[36:39], a[188:191], v[100:103]
 buffer_load_dwordx4 v14, s[4:7], s56 offen offset:0 sc1 lds
 v_mfma_f32_16x16x32_bf16 v[64:67], a[40:43], a[68:71], v[64:67]
 ds_read_b128 a[32:35], v5 offset:12288
 ds_read_b128 a[36:39], v5 offset:13312
 v_mfma_f32_16x16x32_bf16 v[104:107], a[40:43], a[188:191], v[104:107]
 ds_read_b128 a[40:43], v5 offset:14336
 s_waitcnt lgkmcnt(8)
 v_mfma_f32_16x16x32_bf16 v[68:71], a[44:47], a[68:71], v[68:71]
 buffer_load_dwordx4 v14, s[4:7], s56 offen offset:1024 sc1 lds
 v_mfma_f32_16x16x32_bf16 v[108:111], a[44:47], a[188:191], v[108:111]
 ds_read_b128 a[44:47], v8 offset:10240
 s_waitcnt vmcnt(27)
 v_mfma_f32_16x16x32_bf16 v[72:75], a[48:51], a[196:199], v[72:75]
 ds_read_b128 a[48:51], v8 offset:11264
 v_mfma_f32_16x16x32_bf16 v[76:79], a[52:55], a[196:199], v[76:79]
 buffer_load_dwordx4 v14, s[4:7], s56 offen offset:2048 sc1 lds
 v_mfma_f32_16x16x32_bf16 v[80:83], a[56:59], a[196:199], v[80:83]
 s_add_u32 s59, s72, 26624
 ds_read_b128 a[52:55], v8 offset:12288
 v_mfma_f32_16x16x32_bf16 v[84:87], a[60:63], a[196:199], v[84:87]
 buffer_load_dwordx4 v14, s[4:7], s56 offen offset:3072 sc1 lds
 v_mfma_f32_16x16x32_bf16 v[88:91], a[0:3], a[196:199], v[88:91]
 ds_read_b128 a[56:59], v8 offset:13312
 v_mfma_f32_16x16x32_bf16 v[52:55], a[4:7], a[72:75], v[52:55]
 v_mfma_f32_16x16x32_bf16 v[92:95], a[4:7], a[196:199], v[92:95]
 ds_read_b128 a[60:63], v8 offset:14336
 s_add_u32 m0, s74, 24576
 v_mfma_f32_16x16x32_bf16 v[56:59], a[8:11], a[72:75], v[56:59]
 buffer_load_dwordx4 a[176:179], v2, s[4:7], s59 offen offset:0 sc1
 v_mfma_f32_16x16x32_bf16 v[96:99], a[8:11], a[196:199], v[96:99]
 s_waitcnt lgkmcnt(5)
 v_mfma_f32_16x16x32_bf16 v[60:63], a[12:15], a[72:75], v[60:63]
 s_add_u32 s56, s56, 4096
 v_mfma_f32_16x16x32_bf16 v[100:103], a[12:15], a[196:199], v[100:103]
 buffer_load_dwordx2 v[112:113], v10, s[24:27], s73 offen offset:0
 v_mfma_f32_16x16x32_bf16 v[64:67], a[16:19], a[72:75], v[64:67]
 buffer_load_dwordx4 a[180:183], v3, s[4:7], s59 offen offset:0 sc1
 v_mfma_f32_16x16x32_bf16 v[104:107], a[16:19], a[196:199], v[104:107]
 buffer_load_dwordx4 v14, s[4:7], s56 offen sc1 lds
 v_mfma_f32_16x16x32_bf16 v[68:71], a[20:23], a[72:75], v[68:71]
 v_mfma_f32_16x16x32_bf16 v[108:111], a[20:23], a[196:199], v[108:111]
 s_waitcnt vmcnt(30)
 v_mfma_f32_16x16x32_bf16 v[72:75], a[24:27], a[204:207], v[72:75]
 buffer_load_dwordx2 v[114:115], v10, s[24:27], s73 offen offset:32
 v_mfma_f32_16x16x32_bf16 v[76:79], a[28:31], a[204:207], v[76:79]
 v_mfma_f32_16x16x32_bf16 v[80:83], a[32:35], a[204:207], v[80:83]
 buffer_load_dwordx4 a[184:187], v2, s[4:7], s59 offen offset:1024 sc1
 v_mfma_f32_16x16x32_bf16 v[84:87], a[36:39], a[204:207], v[84:87]
 s_waitcnt lgkmcnt(0)
 s_barrier
 v_mfma_f32_16x16x32_bf16 v[88:91], a[40:43], a[204:207], v[88:91]
 ds_read_b128 a[0:3], v6 offset:20480
 ds_read_b128 a[4:7], v6 offset:21504
 v_mfma_f32_16x16x32_bf16 v[52:55], a[44:47], a[76:79], v[52:55]
 ds_read_b128 a[8:11], v6 offset:22528
 ds_read_b128 a[12:15], v6 offset:23552
 v_mfma_f32_16x16x32_bf16 v[92:95], a[44:47], a[204:207], v[92:95]
 ds_read_b128 a[16:19], v6 offset:24576
 ds_read_b128 a[20:23], v9 offset:20480
 v_mfma_f32_16x16x32_bf16 v[56:59], a[48:51], a[76:79], v[56:59]
 ds_read_b128 a[24:27], v9 offset:21504
 ds_read_b128 a[28:31], v9 offset:22528
 v_mfma_f32_16x16x32_bf16 v[96:99], a[48:51], a[204:207], v[96:99]
 buffer_load_dwordx4 a[188:191], v3, s[4:7], s59 offen offset:1024 sc1
 v_mfma_f32_16x16x32_bf16 v[60:63], a[52:55], a[76:79], v[60:63]
 ds_read_b128 a[32:35], v9 offset:23552
 ds_read_b128 a[36:39], v9 offset:24576
 v_mfma_f32_16x16x32_bf16 v[100:103], a[52:55], a[204:207], v[100:103]
 ds_read_b128 a[40:43], v6 offset:30720
 ds_read_b128 a[44:47], v6 offset:31744
 v_mfma_f32_16x16x32_bf16 v[64:67], a[56:59], a[76:79], v[64:67]
 ds_read_b128 a[48:51], v6 offset:32768
 ds_read_b128 a[52:55], v6 offset:33792
 v_mfma_f32_16x16x32_bf16 v[104:107], a[56:59], a[204:207], v[104:107]
 ds_read_b128 a[56:59], v6 offset:34816
 v_mfma_f32_16x16x32_bf16 v[68:71], a[60:63], a[76:79], v[68:71]
 buffer_load_dwordx2 v[116:117], v10, s[24:27], s73 offen offset:64
 v_mfma_f32_16x16x32_bf16 v[108:111], a[60:63], a[204:207], v[108:111]
 ds_read_b128 a[60:63], v9 offset:30720
 s_waitcnt lgkmcnt(15) vmcnt(32)
 v_mfma_f32_16x16x32_bf16 v[72:75], a[0:3], a[212:215], v[72:75]
 ds_read_b128 a[0:3], v9 offset:31744
 s_waitcnt lgkmcnt(14)
 v_mfma_f32_16x16x32_bf16 v[76:79], a[4:7], a[212:215], v[76:79]
 s_add_u32 s59, s72, 28672
 v_mfma_f32_16x16x32_bf16 v[80:83], a[8:11], a[212:215], v[80:83]
 ds_read_b128 a[4:7], v9 offset:32768
 s_waitcnt lgkmcnt(11)
 v_mfma_f32_16x16x32_bf16 v[84:87], a[12:15], a[212:215], v[84:87]
 buffer_load_dwordx2 v[118:119], v10, s[24:27], s73 offen offset:96
 v_mfma_f32_16x16x32_bf16 v[88:91], a[16:19], a[212:215], v[88:91]
 ds_read_b128 a[8:11], v9 offset:33792
 v_mfma_f32_16x16x32_bf16 v[52:55], a[20:23], a[80:83], v[52:55]
 buffer_load_dwordx2 v[120:121], v10, s[24:27], s73 offen offset:128
 v_mfma_f32_16x16x32_bf16 v[92:95], a[20:23], a[212:215], v[92:95]
 ds_read_b128 a[12:15], v9 offset:34816
 v_mfma_f32_16x16x32_bf16 v[56:59], a[24:27], a[80:83], v[56:59]
 buffer_load_dwordx4 a[192:195], v2, s[4:7], s59 offen offset:0 sc1
 v_mfma_f32_16x16x32_bf16 v[96:99], a[24:27], a[212:215], v[96:99]
 ds_read_b128 a[16:19], v5 offset:20480
 s_waitcnt lgkmcnt(6)
 v_mfma_f32_16x16x32_bf16 v[60:63], a[28:31], a[80:83], v[60:63]
 ds_read_b128 a[20:23], v5 offset:21504
 v_mfma_f32_16x16x32_bf16 v[100:103], a[28:31], a[212:215], v[100:103]
 ds_read_b128 a[24:27], v5 offset:22528
 v_mfma_f32_16x16x32_bf16 v[64:67], a[32:35], a[80:83], v[64:67]
 ds_read_b128 a[28:31], v5 offset:23552
 v_mfma_f32_16x16x32_bf16 v[104:107], a[32:35], a[212:215], v[104:107]
 buffer_load_dwordx4 a[196:199], v3, s[4:7], s59 offen offset:0 sc1
 v_mfma_f32_16x16x32_bf16 v[68:71], a[36:39], a[80:83], v[68:71]
 ds_read_b128 a[32:35], v5 offset:24576
 v_mfma_f32_16x16x32_bf16 v[108:111], a[36:39], a[212:215], v[108:111]
 ds_read_b128 a[36:39], v8 offset:20480
 s_waitcnt vmcnt(33)
 v_mfma_f32_16x16x32_bf16 v[72:75], a[40:43], a[220:223], v[72:75]
 ds_read_b128 a[40:43], v8 offset:21504
 v_mfma_f32_16x16x32_bf16 v[76:79], a[44:47], a[220:223], v[76:79]
 v_mfma_f32_16x16x32_bf16 v[80:83], a[48:51], a[220:223], v[80:83]
 ds_read_b128 a[44:47], v8 offset:22528
 v_mfma_f32_16x16x32_bf16 v[84:87], a[52:55], a[220:223], v[84:87]
 buffer_load_dwordx4 a[200:203], v2, s[4:7], s59 offen offset:1024 sc1
 v_mfma_f32_16x16x32_bf16 v[88:91], a[56:59], a[220:223], v[88:91]
 ds_read_b128 a[48:51], v8 offset:23552
 s_waitcnt lgkmcnt(7)
 v_mfma_f32_16x16x32_bf16 v[52:55], a[60:63], a[84:87], v[52:55]
 v_mfma_f32_16x16x32_bf16 v[92:95], a[60:63], a[220:223], v[92:95]
 ds_read_b128 a[52:55], v8 offset:24576
 v_mfma_f32_16x16x32_bf16 v[56:59], a[0:3], a[84:87], v[56:59]
 buffer_load_dwordx4 a[204:207], v3, s[4:7], s59 offen offset:1024 sc1
 v_mfma_f32_16x16x32_bf16 v[96:99], a[0:3], a[220:223], v[96:99]
 ds_read_b128 a[56:59], v5 offset:30720
 v_mfma_f32_16x16x32_bf16 v[60:63], a[4:7], a[84:87], v[60:63]
 ds_read_b128 a[60:63], v5 offset:31744
 v_mfma_f32_16x16x32_bf16 v[100:103], a[4:7], a[220:223], v[100:103]
 ds_read_b128 a[0:3], v5 offset:32768
 v_mfma_f32_16x16x32_bf16 v[64:67], a[8:11], a[84:87], v[64:67]
 ds_read_b128 a[4:7], v5 offset:33792
 v_mfma_f32_16x16x32_bf16 v[104:107], a[8:11], a[220:223], v[104:107]
 ds_read_b128 a[8:11], v5 offset:34816
 v_mfma_f32_16x16x32_bf16 v[68:71], a[12:15], a[84:87], v[68:71]
 v_mfma_f32_16x16x32_bf16 v[108:111], a[12:15], a[220:223], v[108:111]
 ds_read_b128 a[12:15], v8 offset:30720
 s_waitcnt vmcnt(30)
 v_mfma_f32_16x16x32_bf16 v[72:75], a[16:19], a[228:231], v[72:75]
 ds_read_b128 a[16:19], v8 offset:31744
 v_mfma_f32_16x16x32_bf16 v[76:79], a[20:23], a[228:231], v[76:79]
 s_add_u32 s59, s72, 30720
 s_waitcnt lgkmcnt(7)
 v_mfma_f32_16x16x32_bf16 v[80:83], a[24:27], a[228:231], v[80:83]
 ds_read_b128 a[20:23], v8 offset:32768
 v_mfma_f32_16x16x32_bf16 v[84:87], a[28:31], a[228:231], v[84:87]
 v_mfma_f32_16x16x32_bf16 v[88:91], a[32:35], a[228:231], v[88:91]
 ds_read_b128 a[24:27], v8 offset:33792
 v_mfma_f32_16x16x32_bf16 v[52:55], a[36:39], a[224:227], v[52:55]
 v_mfma_f32_16x16x32_bf16 v[92:95], a[36:39], a[228:231], v[92:95]
 ds_read_b128 a[28:31], v8 offset:34816
 v_mfma_f32_16x16x32_bf16 v[56:59], a[40:43], a[224:227], v[56:59]
 buffer_load_dwordx4 a[208:211], v2, s[4:7], s59 offen offset:0 sc1
 v_mfma_f32_16x16x32_bf16 v[96:99], a[40:43], a[228:231], v[96:99]
 v_mfma_f32_16x16x32_bf16 v[60:63], a[44:47], a[224:227], v[60:63]
 v_mfma_f32_16x16x32_bf16 v[100:103], a[44:47], a[228:231], v[100:103]
 v_mfma_f32_16x16x32_bf16 v[64:67], a[48:51], a[224:227], v[64:67]
 buffer_load_dwordx4 a[212:215], v3, s[4:7], s59 offen offset:0 sc1
 v_mfma_f32_16x16x32_bf16 v[104:107], a[48:51], a[228:231], v[104:107]
 v_mfma_f32_16x16x32_bf16 v[68:71], a[52:55], a[224:227], v[68:71]
 v_mfma_f32_16x16x32_bf16 v[108:111], a[52:55], a[228:231], v[108:111]
 s_waitcnt lgkmcnt(1) vmcnt(29)
 v_mfma_f32_16x16x32_bf16 v[72:75], a[56:59], a[236:239], v[72:75]
 v_mfma_f32_16x16x32_bf16 v[76:79], a[60:63], a[236:239], v[76:79]
 v_mfma_f32_16x16x32_bf16 v[80:83], a[0:3], a[236:239], v[80:83]
 buffer_load_dwordx4 a[216:219], v2, s[4:7], s59 offen offset:1024 sc1
 v_mfma_f32_16x16x32_bf16 v[84:87], a[4:7], a[236:239], v[84:87]
 s_waitcnt lgkmcnt(0)
 s_barrier
 v_mfma_f32_16x16x32_bf16 v[88:91], a[8:11], a[236:239], v[88:91]
 ds_read_b128 a[32:35], v5 offset:40960
 ds_read_b128 a[36:39], v5 offset:41984
 v_mfma_f32_16x16x32_bf16 v[52:55], a[12:15], a[232:235], v[52:55]
 ds_read_b128 a[40:43], v5 offset:43008
 ds_read_b128 a[44:47], v5 offset:44032
 v_mfma_f32_16x16x32_bf16 v[92:95], a[12:15], a[236:239], v[92:95]
 ds_read_b128 a[48:51], v5 offset:45056
 ds_read_b128 a[52:55], v8 offset:40960
 v_mfma_f32_16x16x32_bf16 v[56:59], a[16:19], a[232:235], v[56:59]
 ds_read_b128 a[56:59], v8 offset:41984
 ds_read_b128 a[60:63], v8 offset:43008
 v_mfma_f32_16x16x32_bf16 v[96:99], a[16:19], a[236:239], v[96:99]
 buffer_load_dwordx4 a[220:223], v3, s[4:7], s59 offen offset:1024 sc1
 v_mfma_f32_16x16x32_bf16 v[60:63], a[20:23], a[232:235], v[60:63]
 ds_read_b128 a[0:3], v8 offset:44032
 ds_read_b128 a[4:7], v8 offset:45056
 v_mfma_f32_16x16x32_bf16 v[100:103], a[20:23], a[236:239], v[100:103]
 ds_read_b128 a[8:11], v5 offset:51200
 ds_read_b128 a[12:15], v5 offset:52224
 v_mfma_f32_16x16x32_bf16 v[64:67], a[24:27], a[232:235], v[64:67]
 ds_read_b128 a[16:19], v5 offset:53248
 ds_read_b128 a[20:23], v5 offset:54272
 v_mfma_f32_16x16x32_bf16 v[104:107], a[24:27], a[236:239], v[104:107]
 ds_read_b128 a[24:27], v5 offset:55296
 v_mfma_f32_16x16x32_bf16 v[68:71], a[28:31], a[232:235], v[68:71]
 v_mfma_f32_16x16x32_bf16 v[108:111], a[28:31], a[236:239], v[108:111]
 ds_read_b128 a[28:31], v8 offset:51200
 s_waitcnt lgkmcnt(15) vmcnt(25)
 v_mfma_f32_16x16x32_bf16 v[72:75], a[32:35], a[244:247], v[72:75]
 ds_read_b128 a[32:35], v8 offset:52224
 s_waitcnt lgkmcnt(14)
 v_mfma_f32_16x16x32_bf16 v[76:79], a[36:39], a[244:247], v[76:79]
 v_mfma_f32_16x16x32_bf16 v[80:83], a[40:43], a[244:247], v[80:83]
 ds_read_b128 a[36:39], v8 offset:53248
 s_waitcnt lgkmcnt(11)
 v_mfma_f32_16x16x32_bf16 v[84:87], a[44:47], a[244:247], v[84:87]
 v_mfma_f32_16x16x32_bf16 v[88:91], a[48:51], a[244:247], v[88:91]
 ds_read_b128 a[40:43], v8 offset:54272
 v_mfma_f32_16x16x32_bf16 v[52:55], a[52:55], a[240:243], v[52:55]
 v_mfma_f32_16x16x32_bf16 v[92:95], a[52:55], a[244:247], v[92:95]
 ds_read_b128 a[44:47], v8 offset:55296
 v_mfma_f32_16x16x32_bf16 v[56:59], a[56:59], a[240:243], v[56:59]
 v_mfma_f32_16x16x32_bf16 v[96:99], a[56:59], a[244:247], v[96:99]
 ds_read_b128 a[48:51], v6 offset:0
 s_waitcnt lgkmcnt(6)
 v_mfma_f32_16x16x32_bf16 v[60:63], a[60:63], a[240:243], v[60:63]
 ds_read_b128 a[52:55], v6 offset:1024
 v_mfma_f32_16x16x32_bf16 v[100:103], a[60:63], a[244:247], v[100:103]
 ds_read_b128 a[56:59], v6 offset:2048
 v_mfma_f32_16x16x32_bf16 v[64:67], a[0:3], a[240:243], v[64:67]
 ds_read_b128 a[60:63], v6 offset:3072
 v_mfma_f32_16x16x32_bf16 v[104:107], a[0:3], a[244:247], v[104:107]
 ds_read_b128 a[0:3], v6 offset:4096
 v_mfma_f32_16x16x32_bf16 v[68:71], a[4:7], a[240:243], v[68:71]
 v_mfma_f32_16x16x32_bf16 v[108:111], a[4:7], a[244:247], v[108:111]
 ds_read_b128 a[4:7], v9 offset:0
 s_waitcnt vmcnt(22)
 v_mfma_f32_16x16x32_bf16 v[72:75], a[8:11], a[252:255], v[72:75]
 ds_read_b128 a[8:11], v9 offset:1024
 v_mfma_f32_16x16x32_bf16 v[76:79], a[12:15], a[252:255], v[76:79]
 v_mfma_f32_16x16x32_bf16 v[80:83], a[16:19], a[252:255], v[80:83]
 ds_read_b128 a[12:15], v9 offset:2048
 v_mfma_f32_16x16x32_bf16 v[84:87], a[20:23], a[252:255], v[84:87]
 v_mfma_f32_16x16x32_bf16 v[88:91], a[24:27], a[252:255], v[88:91]
 ds_read_b128 a[16:19], v9 offset:3072
 s_waitcnt lgkmcnt(7)
 v_mfma_f32_16x16x32_bf16 v[52:55], a[28:31], a[248:251], v[52:55]
 s_waitcnt vmcnt(16)
 ds_bpermute_b32 v112, v18, v112
 v_mfma_f32_16x16x32_bf16 v[92:95], a[28:31], a[252:255], v[92:95]
 ds_read_b128 a[20:23], v9 offset:4096
 ds_bpermute_b32 v113, v18, v113
 v_mfma_f32_16x16x32_bf16 v[56:59], a[32:35], a[248:251], v[56:59]
 s_waitcnt vmcnt(13)
 ds_bpermute_b32 v114, v18, v114
 v_mfma_f32_16x16x32_bf16 v[96:99], a[32:35], a[252:255], v[96:99]
 ds_read_b128 a[24:27], v6 offset:10240
 ds_bpermute_b32 v115, v18, v115
 v_mfma_f32_16x16x32_bf16 v[60:63], a[36:39], a[248:251], v[60:63]
 ds_read_b128 a[28:31], v6 offset:11264
 s_waitcnt vmcnt(10)
 ds_bpermute_b32 v116, v18, v116
 v_mfma_f32_16x16x32_bf16 v[100:103], a[36:39], a[252:255], v[100:103]
 ds_read_b128 a[32:35], v6 offset:12288
 ds_bpermute_b32 v117, v18, v117
 v_mfma_f32_16x16x32_bf16 v[64:67], a[40:43], a[248:251], v[64:67]
 ds_read_b128 a[36:39], v6 offset:13312
 s_waitcnt vmcnt(9)
 ds_bpermute_b32 v118, v18, v118
 v_mfma_f32_16x16x32_bf16 v[104:107], a[40:43], a[252:255], v[104:107]
 ds_read_b128 a[40:43], v6 offset:14336
 ds_bpermute_b32 v119, v18, v119
 v_mfma_f32_16x16x32_bf16 v[68:71], a[44:47], a[248:251], v[68:71]
 s_waitcnt vmcnt(8)
 ds_bpermute_b32 v120, v18, v120
 v_mfma_f32_16x16x32_bf16 v[108:111], a[44:47], a[252:255], v[108:111]
 ds_read_b128 a[44:47], v9 offset:10240
 ds_bpermute_b32 v121, v18, v121
 v_mfma_f32_16x16x32_bf16 v[72:75], a[48:51], a[180:183], v[72:75]
 ds_read_b128 a[48:51], v9 offset:11264
 v_mfma_f32_16x16x32_bf16 v[76:79], a[52:55], a[180:183], v[76:79]
 s_waitcnt lgkmcnt(15)
 v_mfma_f32_16x16x32_bf16 v[80:83], a[56:59], a[180:183], v[80:83]
 ds_read_b128 a[52:55], v9 offset:12288
 v_mfma_f32_16x16x32_bf16 v[84:87], a[60:63], a[180:183], v[84:87]
 v_mfma_f32_16x16x32_bf16 v[88:91], a[0:3], a[180:183], v[88:91]
 ds_read_b128 a[56:59], v9 offset:13312
 v_mfma_f32_16x16x32_bf16 v[52:55], a[4:7], a[176:179], v[52:55]
 v_mfma_f32_16x16x32_bf16 v[92:95], a[4:7], a[180:183], v[92:95]
 ds_read_b128 a[60:63], v9 offset:14336
 v_mfma_f32_16x16x32_bf16 v[56:59], a[8:11], a[176:179], v[56:59]
 v_mfma_f32_16x16x32_bf16 v[96:99], a[8:11], a[180:183], v[96:99]
 v_mfma_f32_16x16x32_bf16 v[60:63], a[12:15], a[176:179], v[60:63]
 v_mfma_f32_16x16x32_bf16 v[100:103], a[12:15], a[180:183], v[100:103]
 v_mfma_f32_16x16x32_bf16 v[64:67], a[16:19], a[176:179], v[64:67]
 v_mfma_f32_16x16x32_bf16 v[104:107], a[16:19], a[180:183], v[104:107]
 v_mfma_f32_16x16x32_bf16 v[68:71], a[20:23], a[176:179], v[68:71]
 v_mfma_f32_16x16x32_bf16 v[108:111], a[20:23], a[180:183], v[108:111]
 s_waitcnt lgkmcnt(1)
 v_mfma_f32_16x16x32_bf16 v[72:75], a[24:27], a[188:191], v[72:75]
 v_mfma_f32_16x16x32_bf16 v[76:79], a[28:31], a[188:191], v[76:79]
 v_mfma_f32_16x16x32_bf16 v[80:83], a[32:35], a[188:191], v[80:83]
 v_mfma_f32_16x16x32_bf16 v[84:87], a[36:39], a[188:191], v[84:87]
 s_waitcnt lgkmcnt(0)
 s_barrier
 v_mfma_f32_16x16x32_bf16 v[88:91], a[40:43], a[188:191], v[88:91]
 ds_read_b128 a[0:3], v4 offset:0
 ds_read_b128 a[4:7], v4 offset:1024
 v_mfma_f32_16x16x32_bf16 v[52:55], a[44:47], a[184:187], v[52:55]
 ds_read_b128 a[8:11], v4 offset:2048
 ds_read_b128 a[12:15], v4 offset:3072
 v_mfma_f32_16x16x32_bf16 v[92:95], a[44:47], a[188:191], v[92:95]
 ds_read_b128 a[16:19], v4 offset:4096
 ds_read_b128 a[20:23], v7 offset:0
 v_mfma_f32_16x16x32_bf16 v[56:59], a[48:51], a[184:187], v[56:59]
 ds_read_b128 a[24:27], v7 offset:1024
 ds_read_b128 a[28:31], v7 offset:2048
 v_mfma_f32_16x16x32_bf16 v[96:99], a[48:51], a[188:191], v[96:99]
 ds_read_b128 a[32:35], v7 offset:3072
 ds_read_b128 a[36:39], v7 offset:4096
 v_mfma_f32_16x16x32_bf16 v[60:63], a[52:55], a[184:187], v[60:63]
 ds_read_b128 a[40:43], v4 offset:10240
 ds_read_b128 a[44:47], v4 offset:11264
 v_mfma_f32_16x16x32_bf16 v[100:103], a[52:55], a[188:191], v[100:103]
 ds_read_b128 a[48:51], v4 offset:12288
 v_lshlrev_b32 v28, 16, v112
 v_mfma_f32_16x16x32_bf16 v[64:67], a[56:59], a[184:187], v[64:67]
 ds_read_b128 a[52:55], v4 offset:13312
 v_and_b32 v29, 0xffff0000, v112
 v_mfma_f32_16x16x32_bf16 v[104:107], a[56:59], a[188:191], v[104:107]
 ds_read_b128 a[56:59], v4 offset:14336
 v_add_f32 v172, v172, v28
 v_mfma_f32_16x16x32_bf16 v[68:71], a[60:63], a[184:187], v[68:71]
 v_add_f32 v173, v173, v29
 v_lshlrev_b32 v28, 16, v113
 v_mfma_f32_16x16x32_bf16 v[108:111], a[60:63], a[188:191], v[108:111]
 ds_read_b128 a[60:63], v7 offset:10240
 s_waitcnt lgkmcnt(15) vmcnt(6)
 v_mfma_f32_16x16x32_bf16 v[72:75], a[0:3], a[196:199], v[72:75]
 ds_read_b128 a[0:3], v7 offset:11264
 s_waitcnt lgkmcnt(14)
 v_mfma_f32_16x16x32_bf16 v[76:79], a[4:7], a[196:199], v[76:79]
 v_and_b32 v29, 0xffff0000, v113
 v_add_f32 v174, v174, v28
 v_mfma_f32_16x16x32_bf16 v[80:83], a[8:11], a[196:199], v[80:83]
 ds_read_b128 a[4:7], v7 offset:12288
 s_waitcnt lgkmcnt(11)
 v_mfma_f32_16x16x32_bf16 v[84:87], a[12:15], a[196:199], v[84:87]
 v_add_f32 v175, v175, v29
 v_lshlrev_b32 v28, 16, v114
 v_mfma_f32_16x16x32_bf16 v[88:91], a[16:19], a[196:199], v[88:91]
 ds_read_b128 a[8:11], v7 offset:13312
 v_and_b32 v29, 0xffff0000, v114
 v_mfma_f32_16x16x32_bf16 v[52:55], a[20:23], a[192:195], v[52:55]
 v_add_f32 v176, v176, v28
 v_mfma_f32_16x16x32_bf16 v[92:95], a[20:23], a[196:199], v[92:95]
 ds_read_b128 a[12:15], v7 offset:14336
 v_add_f32 v177, v177, v29
 v_mfma_f32_16x16x32_bf16 v[56:59], a[24:27], a[192:195], v[56:59]
 v_mfma_f32_16x16x32_bf16 v[96:99], a[24:27], a[196:199], v[96:99]
 ds_read_b128 a[16:19], v4 offset:20480
 s_waitcnt lgkmcnt(6)
 v_mfma_f32_16x16x32_bf16 v[60:63], a[28:31], a[192:195], v[60:63]
 ds_read_b128 a[20:23], v4 offset:21504
 v_lshlrev_b32 v28, 16, v115
 v_mfma_f32_16x16x32_bf16 v[100:103], a[28:31], a[196:199], v[100:103]
 ds_read_b128 a[24:27], v4 offset:22528
 v_and_b32 v29, 0xffff0000, v115
 v_mfma_f32_16x16x32_bf16 v[64:67], a[32:35], a[192:195], v[64:67]
 ds_read_b128 a[28:31], v4 offset:23552
 v_add_f32 v178, v178, v28
 v_mfma_f32_16x16x32_bf16 v[104:107], a[32:35], a[196:199], v[104:107]
 ds_read_b128 a[32:35], v4 offset:24576
 v_add_f32 v179, v179, v29
 v_mfma_f32_16x16x32_bf16 v[68:71], a[36:39], a[192:195], v[68:71]
 v_mfma_f32_16x16x32_bf16 v[108:111], a[36:39], a[196:199], v[108:111]
 ds_read_b128 a[36:39], v7 offset:20480
 s_waitcnt vmcnt(4)
 v_mfma_f32_16x16x32_bf16 v[72:75], a[40:43], a[204:207], v[72:75]
 ds_read_b128 a[40:43], v7 offset:21504
 v_lshlrev_b32 v28, 16, v116
 v_mfma_f32_16x16x32_bf16 v[76:79], a[44:47], a[204:207], v[76:79]
 v_and_b32 v29, 0xffff0000, v116
 v_mfma_f32_16x16x32_bf16 v[80:83], a[48:51], a[204:207], v[80:83]
 ds_read_b128 a[44:47], v7 offset:22528
 v_add_f32 v180, v180, v28
 v_mfma_f32_16x16x32_bf16 v[84:87], a[52:55], a[204:207], v[84:87]
 v_add_f32 v181, v181, v29
 v_mfma_f32_16x16x32_bf16 v[88:91], a[56:59], a[204:207], v[88:91]
 ds_read_b128 a[48:51], v7 offset:23552
 s_waitcnt lgkmcnt(7)
 v_mfma_f32_16x16x32_bf16 v[52:55], a[60:63], a[200:203], v[52:55]
 v_lshlrev_b32 v28, 16, v117
 v_mfma_f32_16x16x32_bf16 v[92:95], a[60:63], a[204:207], v[92:95]
 ds_read_b128 a[52:55], v7 offset:24576
 v_and_b32 v29, 0xffff0000, v117
 v_mfma_f32_16x16x32_bf16 v[56:59], a[0:3], a[200:203], v[56:59]
 v_mfma_f32_16x16x32_bf16 v[96:99], a[0:3], a[204:207], v[96:99]
 ds_read_b128 a[56:59], v4 offset:30720
 v_add_f32 v182, v182, v28
 v_mfma_f32_16x16x32_bf16 v[60:63], a[4:7], a[200:203], v[60:63]
 ds_read_b128 a[60:63], v4 offset:31744
 v_add_f32 v183, v183, v29
 v_mfma_f32_16x16x32_bf16 v[100:103], a[4:7], a[204:207], v[100:103]
 ds_read_b128 a[0:3], v4 offset:32768
 v_mfma_f32_16x16x32_bf16 v[64:67], a[8:11], a[200:203], v[64:67]
 ds_read_b128 a[4:7], v4 offset:33792
 v_lshlrev_b32 v28, 16, v118
 v_mfma_f32_16x16x32_bf16 v[104:107], a[8:11], a[204:207], v[104:107]
 ds_read_b128 a[8:11], v4 offset:34816
 v_and_b32 v29, 0xffff0000, v118
 v_mfma_f32_16x16x32_bf16 v[68:71], a[12:15], a[200:203], v[68:71]
 v_mfma_f32_16x16x32_bf16 v[108:111], a[12:15], a[204:207], v[108:111]
 ds_read_b128 a[12:15], v7 offset:30720
 s_waitcnt vmcnt(2)
 v_mfma_f32_16x16x32_bf16 v[72:75], a[16:19], a[212:215], v[72:75]
 ds_read_b128 a[16:19], v7 offset:31744
 v_add_f32 v184, v184, v28
 v_mfma_f32_16x16x32_bf16 v[76:79], a[20:23], a[212:215], v[76:79]
 v_add_f32 v185, v185, v29
 s_waitcnt lgkmcnt(7)
 v_mfma_f32_16x16x32_bf16 v[80:83], a[24:27], a[212:215], v[80:83]
 ds_read_b128 a[20:23], v7 offset:32768
 v_lshlrev_b32 v28, 16, v119
 v_mfma_f32_16x16x32_bf16 v[84:87], a[28:31], a[212:215], v[84:87]
 v_and_b32 v29, 0xffff0000, v119
 v_mfma_f32_16x16x32_bf16 v[88:91], a[32:35], a[212:215], v[88:91]
 ds_read_b128 a[24:27], v7 offset:33792
 v_mfma_f32_16x16x32_bf16 v[52:55], a[36:39], a[208:211], v[52:55]
 v_add_f32 v186, v186, v28
 v_mfma_f32_16x16x32_bf16 v[92:95], a[36:39], a[212:215], v[92:95]
 ds_read_b128 a[28:31], v7 offset:34816
 v_add_f32 v187, v187, v29
 v_mfma_f32_16x16x32_bf16 v[56:59], a[40:43], a[208:211], v[56:59]
 v_mfma_f32_16x16x32_bf16 v[96:99], a[40:43], a[212:215], v[96:99]
 ds_read_b128 a[32:35], v4 offset:40960
 v_lshlrev_b32 v28, 16, v120
 v_mfma_f32_16x16x32_bf16 v[60:63], a[44:47], a[208:211], v[60:63]
 ds_read_b128 a[36:39], v4 offset:41984
 v_and_b32 v29, 0xffff0000, v120
 v_mfma_f32_16x16x32_bf16 v[100:103], a[44:47], a[212:215], v[100:103]
 ds_read_b128 a[40:43], v4 offset:43008
 v_mfma_f32_16x16x32_bf16 v[64:67], a[48:51], a[208:211], v[64:67]
 ds_read_b128 a[44:47], v4 offset:44032
 v_add_f32 v188, v188, v28
 v_mfma_f32_16x16x32_bf16 v[104:107], a[48:51], a[212:215], v[104:107]
 ds_read_b128 a[48:51], v4 offset:45056
 v_add_f32 v189, v189, v29
 v_mfma_f32_16x16x32_bf16 v[68:71], a[52:55], a[208:211], v[68:71]
 v_mfma_f32_16x16x32_bf16 v[108:111], a[52:55], a[212:215], v[108:111]
 ds_read_b128 a[52:55], v4 offset:51200
 s_waitcnt lgkmcnt(7) vmcnt(0)
 v_mfma_f32_16x16x32_bf16 v[72:75], a[56:59], a[220:223], v[72:75]
 ds_read_b128 a[56:59], v4 offset:52224
 v_lshlrev_b32 v28, 16, v121
 v_mfma_f32_16x16x32_bf16 v[76:79], a[60:63], a[220:223], v[76:79]
 ds_read_b128 a[60:63], v4 offset:53248
 v_and_b32 v29, 0xffff0000, v121
 v_mfma_f32_16x16x32_bf16 v[80:83], a[0:3], a[220:223], v[80:83]
 ds_read_b128 a[0:3], v4 offset:54272
 v_add_f32 v190, v190, v28
 v_mfma_f32_16x16x32_bf16 v[84:87], a[4:7], a[220:223], v[84:87]
 ds_read_b128 a[4:7], v4 offset:55296
 v_add_f32 v191, v191, v29
 v_mfma_f32_16x16x32_bf16 v[88:91], a[8:11], a[220:223], v[88:91]
 ds_read_b128 a[8:11], v5 offset:0
 v_mfma_f32_16x16x32_bf16 v[52:55], a[12:15], a[216:219], v[52:55]
 v_mfma_f32_16x16x32_bf16 v[92:95], a[12:15], a[220:223], v[92:95]
 ds_read_b128 a[12:15], v5 offset:1024
 v_mfma_f32_16x16x32_bf16 v[56:59], a[16:19], a[216:219], v[56:59]
 v_mfma_f32_16x16x32_bf16 v[96:99], a[16:19], a[220:223], v[96:99]
 ds_read_b128 a[16:19], v5 offset:2048
 v_mfma_f32_16x16x32_bf16 v[60:63], a[20:23], a[216:219], v[60:63]
 v_mfma_f32_16x16x32_bf16 v[100:103], a[20:23], a[220:223], v[100:103]
 ds_read_b128 a[20:23], v5 offset:3072
 v_mfma_f32_16x16x32_bf16 v[64:67], a[24:27], a[216:219], v[64:67]
 v_mfma_f32_16x16x32_bf16 v[104:107], a[24:27], a[220:223], v[104:107]
 ds_read_b128 a[24:27], v5 offset:4096
 s_waitcnt lgkmcnt(6)
 v_mfma_f32_16x16x32_bf16 v[68:71], a[28:31], a[216:219], v[68:71]
 v_mfma_f32_16x16x32_bf16 v[108:111], a[28:31], a[220:223], v[108:111]
 ds_read_b128 a[28:31], v5 offset:10240
 v_mfma_f32_16x16x32_bf16 v[32:35], a[32:35], a[64:67], v[32:35]
 ds_read_b128 a[32:35], v5 offset:11264
 v_mfma_f32_16x16x32_bf16 v[36:39], a[36:39], a[64:67], v[36:39]
 ds_read_b128 a[36:39], v5 offset:12288
 v_mfma_f32_16x16x32_bf16 v[40:43], a[40:43], a[64:67], v[40:43]
 ds_read_b128 a[40:43], v5 offset:13312
 v_mfma_f32_16x16x32_bf16 v[44:47], a[44:47], a[64:67], v[44:47]
 v_cvt_pk_bf16_f32 v92, v92, v93
 v_cvt_pk_bf16_f32 v93, v94, v95
 v_cvt_pk_bf16_f32 v94, v96, v97
 v_cvt_pk_bf16_f32 v95, v98, v99
 buffer_store_dwordx4 v[92:95], v14, s[4:7], s30 offen offset:0 sc1
 v_mfma_f32_16x16x32_bf16 v[48:51], a[48:51], a[64:67], v[48:51]
 v_cvt_pk_bf16_f32 v96, v100, v101
 v_cvt_pk_bf16_f32 v97, v102, v103
 v_cvt_pk_bf16_f32 v98, v104, v105
 v_cvt_pk_bf16_f32 v99, v106, v107
 buffer_store_dwordx4 v[96:99], v14, s[4:7], s30 offen offset:1024 sc1
 v_mfma_f32_16x16x32_bf16 v[32:35], a[52:55], a[68:71], v[32:35]
 v_cvt_pk_bf16_f32 v100, v108, v109
 v_cvt_pk_bf16_f32 v101, v110, v111
 v_add3_u32 v102, v27, v92, v93
 v_add3_u32 v102, v102, v94, v95
 v_add3_u32 v102, v102, v96, v97
 v_mfma_f32_16x16x32_bf16 v[36:39], a[56:59], a[68:71], v[36:39]
 v_add3_u32 v102, v102, v98, v99
 v_add3_u32 v102, v102, v100, v101
 buffer_store_dwordx4 v[100:103], v14, s[4:7], s30 offen offset:2048 sc1
 v_cvt_pk_bf16_f32 v72, v72, v73
 v_cvt_pk_bf16_f32 v73, v74, v75
 v_mfma_f32_16x16x32_bf16 v[40:43], a[60:63], a[68:71], v[40:43]
 v_cvt_pk_bf16_f32 v74, v76, v77
 v_cvt_pk_bf16_f32 v75, v78, v79
 buffer_store_dwordx4 v[72:75], v14, s[4:7], s29 offen offset:0 sc1
 v_cvt_pk_bf16_f32 v76, v80, v81
 v_cvt_pk_bf16_f32 v77, v82, v83
 v_mfma_f32_16x16x32_bf16 v[44:47], a[0:3], a[68:71], v[44:47]
 v_cvt_pk_bf16_f32 v78, v84, v85
 v_cvt_pk_bf16_f32 v79, v86, v87
 buffer_store_dwordx4 v[76:79], v14, s[4:7], s29 offen offset:1024 sc1
 v_cvt_pk_bf16_f32 v80, v88, v89
 v_cvt_pk_bf16_f32 v81, v90, v91
 s_waitcnt lgkmcnt(0)
 v_mfma_f32_16x16x32_bf16 v[48:51], a[4:7], a[68:71], v[48:51]
 v_add3_u32 v82, v27, v72, v73
 v_add3_u32 v82, v82, v74, v75
 v_add3_u32 v82, v82, v76, v77
 v_add3_u32 v82, v82, v78, v79
 v_add3_u32 v82, v82, v80, v81
 v_mfma_f32_16x16x32_bf16 v[32:35], a[8:11], a[72:75], v[32:35]
 buffer_store_dwordx4 v[80:83], v14, s[4:7], s29 offen offset:2048 sc1
 v_cvt_pk_bf16_f32 v52, v52, v53
 v_cvt_pk_bf16_f32 v53, v54, v55
 v_cvt_pk_bf16_f32 v54, v56, v57
 v_cvt_pk_bf16_f32 v55, v58, v59
 v_mfma_f32_16x16x32_bf16 v[36:39], a[12:15], a[72:75], v[36:39]
 buffer_store_dwordx4 v[52:55], v14, s[4:7], s28 offen offset:0 sc1
 v_cvt_pk_bf16_f32 v56, v60, v61
 v_cvt_pk_bf16_f32 v57, v62, v63
 v_cvt_pk_bf16_f32 v58, v64, v65
 v_cvt_pk_bf16_f32 v59, v66, v67
 v_mfma_f32_16x16x32_bf16 v[40:43], a[16:19], a[72:75], v[40:43]
 buffer_store_dwordx4 v[56:59], v14, s[4:7], s28 offen offset:1024 sc1
 v_cvt_pk_bf16_f32 v60, v68, v69
 v_cvt_pk_bf16_f32 v61, v70, v71
 v_add3_u32 v62, v27, v52, v53
 v_add3_u32 v62, v62, v54, v55
 ds_read_b128 a[44:47], v5 offset:14336
 v_mfma_f32_16x16x32_bf16 v[44:47], a[20:23], a[72:75], v[44:47]
 v_add3_u32 v62, v62, v56, v57
 v_add3_u32 v62, v62, v58, v59
 v_add3_u32 v62, v62, v60, v61
 buffer_store_dwordx4 v[60:63], v14, s[4:7], s28 offen offset:2048 sc1
 ds_read_b128 a[48:51], v6 offset:20480
 v_mfma_f32_16x16x32_bf16 v[48:51], a[24:27], a[72:75], v[48:51]
 ds_read_b128 a[52:55], v6 offset:21504
 ds_read_b128 a[56:59], v6 offset:22528
 v_mfma_f32_16x16x32_bf16 v[32:35], a[28:31], a[76:79], v[32:35]
 ds_read_b128 a[60:63], v6 offset:23552
 ds_read_b128 a[0:3], v6 offset:24576
 v_mfma_f32_16x16x32_bf16 v[36:39], a[32:35], a[76:79], v[36:39]
 ds_read_b128 a[4:7], v6 offset:30720
 ds_read_b128 a[8:11], v6 offset:31744
 v_mfma_f32_16x16x32_bf16 v[40:43], a[36:39], a[76:79], v[40:43]
 ds_read_b128 a[12:15], v6 offset:32768
 ds_read_b128 a[16:19], v6 offset:33792
 v_mfma_f32_16x16x32_bf16 v[44:47], a[40:43], a[76:79], v[44:47]
 ds_read_b128 a[20:23], v6 offset:34816
 s_waitcnt lgkmcnt(10)
 v_mfma_f32_16x16x32_bf16 v[48:51], a[44:47], a[76:79], v[48:51]
 ds_read_b128 a[24:27], v5 offset:20480
 s_waitcnt lgkmcnt(10)
 v_mfma_f32_16x16x32_bf16 v[32:35], a[48:51], a[80:83], v[32:35]
 ds_read_b128 a[28:31], v5 offset:21504
 s_waitcnt lgkmcnt(10)
 v_mfma_f32_16x16x32_bf16 v[36:39], a[52:55], a[80:83], v[36:39]
 ds_read_b128 a[32:35], v5 offset:22528
 s_waitcnt lgkmcnt(10)
 v_mfma_f32_16x16x32_bf16 v[40:43], a[56:59], a[80:83], v[40:43]
 ds_read_b128 a[36:39], v5 offset:23552
 s_waitcnt lgkmcnt(10)
 v_mfma_f32_16x16x32_bf16 v[44:47], a[60:63], a[80:83], v[44:47]
 ds_read_b128 a[40:43], v5 offset:24576
 s_waitcnt lgkmcnt(10)
 v_mfma_f32_16x16x32_bf16 v[48:51], a[0:3], a[80:83], v[48:51]
 ds_read_b128 a[44:47], v5 offset:30720
 s_waitcnt lgkmcnt(10)
 v_mfma_f32_16x16x32_bf16 v[32:35], a[4:7], a[84:87], v[32:35]
 ds_read_b128 a[48:51], v5 offset:31744
 s_waitcnt lgkmcnt(10)
 v_mfma_f32_16x16x32_bf16 v[36:39], a[8:11], a[84:87], v[36:39]
 ds_read_b128 a[52:55], v5 offset:32768
 s_waitcnt lgkmcnt(10)
 v_mfma_f32_16x16x32_bf16 v[40:43], a[12:15], a[84:87], v[40:43]
 ds_read_b128 a[56:59], v5 offset:33792
 s_waitcnt lgkmcnt(10)
 v_mfma_f32_16x16x32_bf16 v[44:47], a[16:19], a[84:87], v[44:47]
 ds_read_b128 a[60:63], v5 offset:34816
 s_waitcnt lgkmcnt(10)
 v_mfma_f32_16x16x32_bf16 v[48:51], a[20:23], a[84:87], v[48:51]
 ds_read_b128 a[0:3], v5 offset:40960
 s_waitcnt lgkmcnt(10)
 v_mfma_f32_16x16x32_bf16 v[32:35], a[24:27], a[224:227], v[32:35]
 ds_read_b128 a[4:7], v5 offset:41984
 s_waitcnt lgkmcnt(10)
 v_mfma_f32_16x16x32_bf16 v[36:39], a[28:31], a[224:227], v[36:39]
 ds_read_b128 a[8:11], v5 offset:43008
 s_waitcnt lgkmcnt(10)
 v_mfma_f32_16x16x32_bf16 v[40:43], a[32:35], a[224:227], v[40:43]
 ds_read_b128 a[12:15], v5 offset:44032
 s_waitcnt lgkmcnt(10)
 v_mfma_f32_16x16x32_bf16 v[44:47], a[36:39], a[224:227], v[44:47]
 ds_read_b128 a[16:19], v5 offset:45056
 s_waitcnt lgkmcnt(10)
 v_mfma_f32_16x16x32_bf16 v[48:51], a[40:43], a[224:227], v[48:51]
 ds_read_b128 a[20:23], v5 offset:51200
 s_waitcnt lgkmcnt(10)
 v_mfma_f32_16x16x32_bf16 v[32:35], a[44:47], a[232:235], v[32:35]
 ds_read_b128 a[24:27], v5 offset:52224
 s_waitcnt lgkmcnt(10)
 v_mfma_f32_16x16x32_bf16 v[36:39], a[48:51], a[232:235], v[36:39]
 ds_read_b128 a[28:31], v5 offset:53248
 s_waitcnt lgkmcnt(10)
 v_mfma_f32_16x16x32_bf16 v[40:43], a[52:55], a[232:235], v[40:43]
 ds_read_b128 a[32:35], v5 offset:54272
 s_waitcnt lgkmcnt(10)
 v_mfma_f32_16x16x32_bf16 v[44:47], a[56:59], a[232:235], v[44:47]
 ds_read_b128 a[36:39], v5 offset:55296
 s_waitcnt lgkmcnt(10)
 v_mfma_f32_16x16x32_bf16 v[48:51], a[60:63], a[232:235], v[48:51]
 ds_read_b128 a[40:43], v6 offset:0
 s_waitcnt lgkmcnt(10)
 v_mfma_f32_16x16x32_bf16 v[32:35], a[0:3], a[240:243], v[32:35]
 ds_read_b128 a[44:47], v6 offset:1024
 s_waitcnt lgkmcnt(10)
 v_mfma_f32_16x16x32_bf16 v[36:39], a[4:7], a[240:243], v[36:39]
 ds_read_b128 a[48:51], v6 offset:2048
 s_waitcnt lgkmcnt(10)
 v_mfma_f32_16x16x32_bf16 v[40:43], a[8:11], a[240:243], v[40:43]
 ds_read_b128 a[52:55], v6 offset:3072
 s_waitcnt lgkmcnt(10)
 v_mfma_f32_16x16x32_bf16 v[44:47], a[12:15], a[240:243], v[44:47]
 ds_read_b128 a[56:59], v6 offset:4096
 s_waitcnt lgkmcnt(10)
 v_mfma_f32_16x16x32_bf16 v[48:51], a[16:19], a[240:243], v[48:51]
 ds_read_b128 a[60:63], v6 offset:10240
 s_waitcnt lgkmcnt(10)
 v_mfma_f32_16x16x32_bf16 v[32:35], a[20:23], a[248:251], v[32:35]
 ds_read_b128 a[0:3], v6 offset:11264
 s_waitcnt lgkmcnt(10)
 v_mfma_f32_16x16x32_bf16 v[36:39], a[24:27], a[248:251], v[36:39]
 ds_read_b128 a[4:7], v6 offset:12288
 s_waitcnt lgkmcnt(10)
 v_mfma_f32_16x16x32_bf16 v[40:43], a[28:31], a[248:251], v[40:43]
 ds_read_b128 a[8:11], v6 offset:13312
 s_waitcnt lgkmcnt(10)
 v_mfma_f32_16x16x32_bf16 v[44:47], a[32:35], a[248:251], v[44:47]
 ds_read_b128 a[12:15], v6 offset:14336
 s_waitcnt lgkmcnt(10)
 v_mfma_f32_16x16x32_bf16 v[48:51], a[36:39], a[248:251], v[48:51]
 ds_read_b128 a[16:19], v4 offset:0
 s_waitcnt lgkmcnt(10)
 v_mfma_f32_16x16x32_bf16 v[32:35], a[40:43], a[176:179], v[32:35]
 ds_read_b128 a[20:23], v4 offset:1024
 s_waitcnt lgkmcnt(10)
 v_mfma_f32_16x16x32_bf16 v[36:39], a[44:47], a[176:179], v[36:39]
 ds_read_b128 a[24:27], v4 offset:2048
 s_waitcnt lgkmcnt(10)
 v_mfma_f32_16x16x32_bf16 v[40:43], a[48:51], a[176:179], v[40:43]
 ds_read_b128 a[28:31], v4 offset:3072
 s_waitcnt lgkmcnt(10)
 v_mfma_f32_16x16x32_bf16 v[44:47], a[52:55], a[176:179], v[44:47]
 ds_read_b128 a[32:35], v4 offset:4096
 s_waitcnt lgkmcnt(10)
 v_mfma_f32_16x16x32_bf16 v[48:51], a[56:59], a[176:179], v[48:51]
 ds_read_b128 a[36:39], v4 offset:10240
 s_waitcnt lgkmcnt(10)
 v_mfma_f32_16x16x32_bf16 v[32:35], a[60:63], a[184:187], v[32:35]
 ds_read_b128 a[40:43], v4 offset:11264
 s_waitcnt lgkmcnt(10)
 v_mfma_f32_16x16x32_bf16 v[36:39], a[0:3], a[184:187], v[36:39]
 ds_read_b128 a[44:47], v4 offset:12288
 s_waitcnt lgkmcnt(10)
 v_mfma_f32_16x16x32_bf16 v[40:43], a[4:7], a[184:187], v[40:43]
 ds_read_b128 a[48:51], v4 offset:13312
 s_waitcnt lgkmcnt(10)
 v_mfma_f32_16x16x32_bf16 v[44:47], a[8:11], a[184:187], v[44:47]
 ds_read_b128 a[52:55], v4 offset:14336
 s_waitcnt lgkmcnt(10)
 v_mfma_f32_16x16x32_bf16 v[48:51], a[12:15], a[184:187], v[48:51]
 ds_read_b128 a[56:59], v4 offset:20480
 s_waitcnt lgkmcnt(10)
 v_mfma_f32_16x16x32_bf16 v[32:35], a[16:19], a[192:195], v[32:35]
 ds_read_b128 a[60:63], v4 offset:21504
 s_waitcnt lgkmcnt(10)
 v_mfma_f32_16x16x32_bf16 v[36:39], a[20:23], a[192:195], v[36:39]
 ds_read_b128 a[0:3], v4 offset:22528
 s_waitcnt lgkmcnt(10)
 v_mfma_f32_16x16x32_bf16 v[40:43], a[24:27], a[192:195], v[40:43]
 ds_read_b128 a[4:7], v4 offset:23552
 s_waitcnt lgkmcnt(10)
 v_mfma_f32_16x16x32_bf16 v[44:47], a[28:31], a[192:195], v[44:47]
 ds_read_b128 a[8:11], v4 offset:24576
 s_waitcnt lgkmcnt(10)
 v_mfma_f32_16x16x32_bf16 v[48:51], a[32:35], a[192:195], v[48:51]
 ds_read_b128 a[12:15], v4 offset:30720
 s_waitcnt lgkmcnt(10)
 v_mfma_f32_16x16x32_bf16 v[32:35], a[36:39], a[200:203], v[32:35]
 ds_read_b128 a[16:19], v4 offset:31744
 s_waitcnt lgkmcnt(10)
 v_mfma_f32_16x16x32_bf16 v[36:39], a[40:43], a[200:203], v[36:39]
 ds_read_b128 a[20:23], v4 offset:32768
 s_waitcnt lgkmcnt(10)
 v_mfma_f32_16x16x32_bf16 v[40:43], a[44:47], a[200:203], v[40:43]
 ds_read_b128 a[24:27], v4 offset:33792
 s_waitcnt lgkmcnt(10)
 v_mfma_f32_16x16x32_bf16 v[44:47], a[48:51], a[200:203], v[44:47]
 ds_read_b128 a[28:31], v4 offset:34816
 s_waitcnt lgkmcnt(10)
 v_mfma_f32_16x16x32_bf16 v[48:51], a[52:55], a[200:203], v[48:51]
 s_add_u32 s57, s31, 0
 s_waitcnt lgkmcnt(9)
 v_mfma_f32_16x16x32_bf16 v[32:35], a[56:59], a[208:211], v[32:35]
 s_waitcnt lgkmcnt(8)
 v_mfma_f32_16x16x32_bf16 v[36:39], a[60:63], a[208:211], v[36:39]
 s_waitcnt lgkmcnt(7)
 v_mfma_f32_16x16x32_bf16 v[40:43], a[0:3], a[208:211], v[40:43]
 s_waitcnt lgkmcnt(6)
 v_mfma_f32_16x16x32_bf16 v[44:47], a[4:7], a[208:211], v[44:47]
 s_waitcnt lgkmcnt(5)
 v_mfma_f32_16x16x32_bf16 v[48:51], a[8:11], a[208:211], v[48:51]
 s_waitcnt lgkmcnt(4)
 v_mfma_f32_16x16x32_bf16 v[32:35], a[12:15], a[216:219], v[32:35]
 s_waitcnt lgkmcnt(3)
 v_mfma_f32_16x16x32_bf16 v[36:39], a[16:19], a[216:219], v[36:39]
 s_waitcnt lgkmcnt(2)
 v_mfma_f32_16x16x32_bf16 v[40:43], a[20:23], a[216:219], v[40:43]
 s_waitcnt lgkmcnt(1)
 v_mfma_f32_16x16x32_bf16 v[44:47], a[24:27], a[216:219], v[44:47]
 s_waitcnt lgkmcnt(0)
 v_mfma_f32_16x16x32_bf16 v[48:51], a[28:31], a[216:219], v[48:51]
 buffer_load_dwordx4 v[136:139], v14, s[4:7], s57 offen offset:0 sc1
 buffer_load_dwordx4 v[140:143], v14, s[4:7], s57 offen offset:1024 sc1
 buffer_load_dwordx4 v[144:147], v14, s[4:7], s57 offen offset:2048 sc1
 s_add_u32 s57, s31, 12288
 buffer_load_dwordx4 v[148:151], v14, s[4:7], s57 offen offset:0 sc1
 buffer_load_dwordx4 v[152:155], v14, s[4:7], s57 offen offset:1024 sc1
 buffer_load_dwordx4 v[156:159], v14, s[4:7], s57 offen offset:2048 sc1
 s_add_u32 s57, s31, 24576
 buffer_load_dwordx4 v[160:163], v14, s[4:7], s57 offen offset:0 sc1
 buffer_load_dwordx4 v[164:167], v14, s[4:7], s57 offen offset:1024 sc1
 buffer_load_dwordx4 v[168:171], v14, s[4:7], s57 offen offset:2048 sc1
L_Dj:
 s_nop 7
 v_pk_add_f32 v[32:33], v[32:33], v[172:173]
 v_pk_add_f32 v[34:35], v[34:35], v[174:175]
 v_pk_add_f32 v[36:37], v[36:37], v[176:177]
 v_pk_add_f32 v[38:39], v[38:39], v[178:179]
 v_pk_add_f32 v[40:41], v[40:41], v[180:181]
 v_pk_add_f32 v[42:43], v[42:43], v[182:183]
 v_pk_add_f32 v[44:45], v[44:45], v[184:185]
 v_pk_add_f32 v[46:47], v[46:47], v[186:187]
 v_pk_add_f32 v[48:49], v[48:49], v[188:189]
 v_pk_add_f32 v[50:51], v[50:51], v[190:191]
 s_waitcnt vmcnt(6)
 v_mov_b32 v29, v147
L_parall_31:
 v_add3_u32 v28, v27, v136, v137
 v_add3_u32 v28, v28, v138, v139
 v_add3_u32 v28, v28, v140, v141
 v_add3_u32 v28, v28, v142, v143
 v_add3_u32 v28, v28, v144, v145
 v_cmp_ne_u32 vcc, v146, v28
 s_cbranch_vccz L_parall_32
 s_add_u32 s76, s76, 1
 s_cmp_gt_u32 s76, 0x40000
 s_cbranch_scc1 L_parall_32
 s_add_u32 s57, s31, 0
 buffer_load_dwordx4 v[136:139], v14, s[4:7], s57 offen offset:0 sc1
 buffer_load_dwordx4 v[140:143], v14, s[4:7], s57 offen offset:1024 sc1
 buffer_load_dwordx4 v[144:147], v14, s[4:7], s57 offen offset:2048 sc1
 s_waitcnt vmcnt(0)
 s_branch L_parall_31
L_parall_32:
 v_lshlrev_b32 v28, 16, v136
 v_and_b32 v29, 0xffff0000, v136
 v_pk_add_f32 v[32:33], v[32:33], v[28:29]
 v_lshlrev_b32 v28, 16, v137
 v_and_b32 v29, 0xffff0000, v137
 v_pk_add_f32 v[34:35], v[34:35], v[28:29]
 v_lshlrev_b32 v28, 16, v138
 v_and_b32 v29, 0xffff0000, v138
 v_pk_add_f32 v[36:37], v[36:37], v[28:29]
 v_lshlrev_b32 v28, 16, v139
 v_and_b32 v29, 0xffff0000, v139
 v_pk_add_f32 v[38:39], v[38:39], v[28:29]
 v_lshlrev_b32 v28, 16, v140
 v_and_b32 v29, 0xffff0000, v140
 v_pk_add_f32 v[40:41], v[40:41], v[28:29]
 v_lshlrev_b32 v28, 16, v141
 v_and_b32 v29, 0xffff0000, v141
 v_pk_add_f32 v[42:43], v[42:43], v[28:29]
 v_lshlrev_b32 v28, 16, v142
 v_and_b32 v29, 0xffff0000, v142
 v_pk_add_f32 v[44:45], v[44:45], v[28:29]
 v_lshlrev_b32 v28, 16, v143
 v_and_b32 v29, 0xffff0000, v143
 v_pk_add_f32 v[46:47], v[46:47], v[28:29]
 v_lshlrev_b32 v28, 16, v144
 v_and_b32 v29, 0xffff0000, v144
 v_pk_add_f32 v[48:49], v[48:49], v[28:29]
 v_lshlrev_b32 v28, 16, v145
 v_and_b32 v29, 0xffff0000, v145
 v_pk_add_f32 v[50:51], v[50:51], v[28:29]
 s_waitcnt vmcnt(3)
 v_mov_b32 v29, v159
L_parall_33:
 v_add3_u32 v28, v27, v148, v149
 v_add3_u32 v28, v28, v150, v151
 v_add3_u32 v28, v28, v152, v153
 v_add3_u32 v28, v28, v154, v155
 v_add3_u32 v28, v28, v156, v157
 v_cmp_ne_u32 vcc, v158, v28
 s_cbranch_vccz L_parall_34
 s_add_u32 s76, s76, 1
 s_cmp_gt_u32 s76, 0x40000
 s_cbranch_scc1 L_parall_34
 s_add_u32 s57, s31, 12288
 buffer_load_dwordx4 v[148:151], v14, s[4:7], s57 offen offset:0 sc1
 buffer_load_dwordx4 v[152:155], v14, s[4:7], s57 offen offset:1024 sc1
 buffer_load_dwordx4 v[156:159], v14, s[4:7], s57 offen offset:2048 sc1
 s_waitcnt vmcnt(0)
 s_branch L_parall_33
L_parall_34:
 v_lshlrev_b32 v28, 16, v148
 v_and_b32 v29, 0xffff0000, v148
 v_pk_add_f32 v[32:33], v[32:33], v[28:29]
 v_lshlrev_b32 v28, 16, v149
 v_and_b32 v29, 0xffff0000, v149
 v_pk_add_f32 v[34:35], v[34:35], v[28:29]
 v_lshlrev_b32 v28, 16, v150
 v_and_b32 v29, 0xffff0000, v150
 v_pk_add_f32 v[36:37], v[36:37], v[28:29]
 v_lshlrev_b32 v28, 16, v151
 v_and_b32 v29, 0xffff0000, v151
 v_pk_add_f32 v[38:39], v[38:39], v[28:29]
 v_lshlrev_b32 v28, 16, v152
 v_and_b32 v29, 0xffff0000, v152
 v_pk_add_f32 v[40:41], v[40:41], v[28:29]
 v_lshlrev_b32 v28, 16, v153
 v_and_b32 v29, 0xffff0000, v153
 v_pk_add_f32 v[42:43], v[42:43], v[28:29]
 v_lshlrev_b32 v28, 16, v154
 v_and_b32 v29, 0xffff0000, v154
 v_pk_add_f32 v[44:45], v[44:45], v[28:29]
 v_lshlrev_b32 v28, 16, v155
 v_and_b32 v29, 0xffff0000, v155
 v_pk_add_f32 v[46:47], v[46:47], v[28:29]
 v_lshlrev_b32 v28, 16, v156
 v_and_b32 v29, 0xffff0000, v156
 v_pk_add_f32 v[48:49], v[48:49], v[28:29]
 v_lshlrev_b32 v28, 16, v157
 v_and_b32 v29, 0xffff0000, v157
 v_pk_add_f32 v[50:51], v[50:51], v[28:29]
 s_waitcnt vmcnt(0)
 v_mov_b32 v29, v171
L_parall_35:
 v_add3_u32 v28, v27, v160, v161
 v_add3_u32 v28, v28, v162, v163
 v_add3_u32 v28, v28, v164, v165
 v_add3_u32 v28, v28, v166, v167
 v_add3_u32 v28, v28, v168, v169
 v_cmp_ne_u32 vcc, v170, v28
 s_cbranch_vccz L_parall_36
 s_add_u32 s76, s76, 1
 s_cmp_gt_u32 s76, 0x40000
 s_cbranch_scc1 L_parall_36
 s_add_u32 s57, s31, 24576
 buffer_load_dwordx4 v[160:163], v14, s[4:7], s57 offen offset:0 sc1
 buffer_load_dwordx4 v[164:167], v14, s[4:7], s57 offen offset:1024 sc1
 buffer_load_dwordx4 v[168:171], v14, s[4:7], s57 offen offset:2048 sc1
 s_waitcnt vmcnt(0)
 s_branch L_parall_35
L_parall_36:
 v_lshlrev_b32 v28, 16, v160
 v_and_b32 v29, 0xffff0000, v160
 v_pk_add_f32 v[32:33], v[32:33], v[28:29]
 v_lshlrev_b32 v28, 16, v161
 v_and_b32 v29, 0xffff0000, v161
 v_pk_add_f32 v[34:35], v[34:35], v[28:29]
 v_lshlrev_b32 v28, 16, v162
 v_and_b32 v29, 0xffff0000, v162
 v_pk_add_f32 v[36:37], v[36:37], v[28:29]
 v_lshlrev_b32 v28, 16, v163
 v_and_b32 v29, 0xffff0000, v163
 v_pk_add_f32 v[38:39], v[38:39], v[28:29]
 v_lshlrev_b32 v28, 16, v164
 v_and_b32 v29, 0xffff0000, v164
 v_pk_add_f32 v[40:41], v[40:41], v[28:29]
 v_lshlrev_b32 v28, 16, v165
 v_and_b32 v29, 0xffff0000, v165
 v_pk_add_f32 v[42:43], v[42:43], v[28:29]
 v_lshlrev_b32 v28, 16, v166
 v_and_b32 v29, 0xffff0000, v166
 v_pk_add_f32 v[44:45], v[44:45], v[28:29]
 v_lshlrev_b32 v28, 16, v167
 v_and_b32 v29, 0xffff0000, v167
 v_pk_add_f32 v[46:47], v[46:47], v[28:29]
 v_lshlrev_b32 v28, 16, v168
 v_and_b32 v29, 0xffff0000, v168
 v_pk_add_f32 v[48:49], v[48:49], v[28:29]
 v_lshlrev_b32 v28, 16, v169
 v_and_b32 v29, 0xffff0000, v169
 v_pk_add_f32 v[50:51], v[50:51], v[28:29]
 v_cvt_pk_bf16_f32 v32, v32, v33
 ds_bpermute_b32 v112, v19, v32
 v_cvt_pk_bf16_f32 v33, v34, v35
 ds_bpermute_b32 v113, v19, v33
 v_cvt_pk_bf16_f32 v34, v36, v37
 ds_bpermute_b32 v114, v19, v34
 v_cvt_pk_bf16_f32 v35, v38, v39
 ds_bpermute_b32 v115, v19, v35
 v_cvt_pk_bf16_f32 v36, v40, v41
 ds_bpermute_b32 v116, v19, v36
 v_cvt_pk_bf16_f32 v37, v42, v43
 ds_bpermute_b32 v117, v19, v37
 v_cvt_pk_bf16_f32 v38, v44, v45
 ds_bpermute_b32 v118, v19, v38
 v_cvt_pk_bf16_f32 v39, v46, v47
 ds_bpermute_b32 v119, v19, v39
 v_cvt_pk_bf16_f32 v40, v48, v49
 ds_bpermute_b32 v120, v19, v40
 v_cvt_pk_bf16_f32 v41, v50, v51
 ds_bpermute_b32 v121, v19, v41
 s_waitcnt lgkmcnt(8)
 buffer_store_dwordx2 v[112:113], v10, s[52:55], s73 offen offset:0
 s_waitcnt lgkmcnt(6)
 buffer_store_dwordx2 v[114:115], v10, s[52:55], s73 offen offset:32
 s_waitcnt lgkmcnt(4)
 buffer_store_dwordx2 v[116:117], v10, s[52:55], s73 offen offset:64
 s_waitcnt lgkmcnt(2)
 buffer_store_dwordx2 v[118:119], v10, s[52:55], s73 offen offset:96
 s_waitcnt lgkmcnt(0)
 buffer_store_dwordx2 v[120:121], v10, s[52:55], s73 offen offset:128
L_end:
 s_endpgm
P_parall_1:
 s_mov_b32 s99, 0
PL_parall_3:
 s_sleep 1
 buffer_load_dword v31, v30, s[4:7], 0 offen sc1
 s_add_u32 s99, s99, 1
 s_waitcnt vmcnt(0)
 v_cmp_ne_u32 vcc, s98, v31
 s_cbranch_vccz PB_parall_2
 s_cmp_lt_u32 s99, 0x40000
 s_cbranch_scc1 PL_parall_3
 s_branch PB_parall_2
P_parall_4:
 s_mov_b32 s99, 0
PL_parall_6:
 s_sleep 1
 buffer_load_dword v31, v30, s[4:7], s81 offen sc1
 s_add_u32 s99, s99, 1
 s_waitcnt vmcnt(0)
 v_cmp_ne_u32 vcc, s98, v31
 s_cbranch_vccz PB_parall_5
 s_cmp_lt_u32 s99, 0x40000
 s_cbranch_scc1 PL_parall_6
 s_branch PB_parall_5
M_parall_9:
 s_nop 7
 s_lshl_b32 s19, s18, 1
 s_add_u32 s19, s19, 0
 s_cmp_eq_u32 s19, s93
 s_cselect_b32 s12, s15, 0
 s_cmp_gt_u32 s19, s93
 s_cselect_b32 s13, s15, 0
 v_fma_f32 v96, v240, s12, v96
 v_fma_f32 v97, v241, s12, v97
 v_fma_f32 v98, v242, s12, v98
 v_fma_f32 v99, v243, s12, v99
 v_fma_f32 v100, v244, s12, v100
 v_fma_f32 v101, v245, s12, v101
 v_fma_f32 v102, v246, s12, v102
 v_fma_f32 v103, v247, s12, v103
 v_fma_f32 v104, v248, s12, v104
 v_fma_f32 v105, v249, s12, v105
 v_fma_f32 v106, v250, s12, v106
 v_fma_f32 v107, v251, s12, v107
 v_fma_f32 v108, v252, s12, v108
 v_fma_f32 v109, v253, s12, v109
 v_fma_f32 v110, v254, s12, v110
 v_fma_f32 v111, v255, s12, v111
 v_add_f32 v96, s13, v96
 v_add_f32 v97, s13, v97
 v_add_f32 v98, s13, v98
 v_add_f32 v99, s13, v99
 v_add_f32 v100, s13, v100
 v_add_f32 v101, s13, v101
 v_add_f32 v102, s13, v102
 v_add_f32 v103, s13, v103
 v_add_f32 v104, s13, v104
 v_add_f32 v105, s13, v105
 v_add_f32 v106, s13, v106
 v_add_f32 v107, s13, v107
 v_add_f32 v108, s13, v108
 v_add_f32 v109, s13, v109
 v_add_f32 v110, s13, v110
 v_add_f32 v111, s13, v111
 s_nop 1
 s_branch MB_parall_10
M_parall_11:
 s_nop 7
 s_lshl_b32 s19, s18, 1
 s_add_u32 s19, s19, 1
 s_cmp_eq_u32 s19, s93
 s_cselect_b32 s12, s15, 0
 s_cmp_gt_u32 s19, s93
 s_cselect_b32 s13, s15, 0
 v_fma_f32 v128, v240, s12, v128
 v_fma_f32 v129, v241, s12, v129
 v_fma_f32 v130, v242, s12, v130
 v_fma_f32 v131, v243, s12, v131
 v_fma_f32 v132, v244, s12, v132
 v_fma_f32 v133, v245, s12, v133
 v_fma_f32 v134, v246, s12, v134
 v_fma_f32 v135, v247, s12, v135
 v_fma_f32 v136, v248, s12, v136
 v_fma_f32 v137, v249, s12, v137
 v_fma_f32 v138, v250, s12, v138
 v_fma_f32 v139, v251, s12, v139
 v_fma_f32 v140, v252, s12, v140
 v_fma_f32 v141, v253, s12, v141
 v_fma_f32 v142, v254, s12, v142
 v_fma_f32 v143, v255, s12, v143
 v_add_f32 v128, s13, v128
 v_add_f32 v129, s13, v129
 v_add_f32 v130, s13, v130
 v_add_f32 v131, s13, v131
 v_add_f32 v132, s13, v132
 v_add_f32 v133, s13, v133
 v_add_f32 v134, s13, v134
 v_add_f32 v135, s13, v135
 v_add_f32 v136, s13, v136
 v_add_f32 v137, s13, v137
 v_add_f32 v138, s13, v138
 v_add_f32 v139, s13, v139
 v_add_f32 v140, s13, v140
 v_add_f32 v141, s13, v141
 v_add_f32 v142, s13, v142
 v_add_f32 v143, s13, v143
 s_nop 1
 s_branch MB_parall_12
P_parall_13:
 s_mov_b32 s99, 0
PL_parall_15:
 s_sleep 1
 buffer_load_dword v15, v12, s[4:7], 0 offen sc1
 s_add_u32 s99, s99, 1
 s_waitcnt vmcnt(0)
 v_cmp_ne_u32 vcc, s98, v15
 s_cbranch_vccz PB_parall_14
 s_cmp_lt_u32 s99, 0x40000
 s_cbranch_scc1 PL_parall_15
 s_branch PB_parall_14
P_parall_16:
 s_mov_b32 s99, 0
PL_parall_18:
 s_sleep 1
 buffer_load_dword v15, v12, s[4:7], 0 offen sc1
 s_add_u32 s99, s99, 1
 s_waitcnt vmcnt(0)
 v_cmp_ne_u32 vcc, s98, v15
 s_cbranch_vccz PB_parall_17
 s_cmp_lt_u32 s99, 0x40000
 s_cbranch_scc1 PL_parall_18
 s_branch PB_parall_17
P_parall_19:
 s_mov_b32 s99, 0
PL_parall_21:
 s_sleep 1
 buffer_load_dword v15, v13, s[4:7], s77 offen sc1
 s_add_u32 s99, s99, 1
 s_waitcnt vmcnt(0)
 v_cmp_ne_u32 vcc, s98, v15
 s_cbranch_vccz PB_parall_20
 s_cmp_lt_u32 s99, 0x40000
 s_cbranch_scc1 PL_parall_21
 s_branch PB_parall_20
P_parall_22:
 s_mov_b32 s99, 0
PL_parall_24:
 s_sleep 1
 buffer_load_dword v15, v13, s[4:7], s78 offen sc1
 s_add_u32 s99, s99, 1
 s_waitcnt vmcnt(0)
 v_cmp_ne_u32 vcc, s98, v15
 s_cbranch_vccz PB_parall_23
 s_cmp_lt_u32 s99, 0x40000
 s_cbranch_scc1 PL_parall_24
 s_branch PB_parall_23
P_parall_25:
 s_mov_b32 s99, 0
PL_parall_27:
 s_sleep 1
 buffer_load_dword v15, v13, s[4:7], s77 offen sc1
 s_add_u32 s99, s99, 1
 s_waitcnt vmcnt(0)
 v_cmp_ne_u32 vcc, s98, v15
 s_cbranch_vccz PB_parall_26
 s_cmp_lt_u32 s99, 0x40000
 s_cbranch_scc1 PL_parall_27
 s_branch PB_parall_26
P_parall_28:
 s_mov_b32 s99, 0
PL_parall_30:
 s_sleep 1
 buffer_load_dword v15, v13, s[4:7], s78 offen sc1
 s_add_u32 s99, s99, 1
 s_waitcnt vmcnt(0)
 v_cmp_ne_u32 vcc, s98, v15
 s_cbranch_vccz PB_parall_29
 s_cmp_lt_u32 s99, 0x40000
 s_cbranch_scc1 PL_parall_30
 s_branch PB_parall_29
L_safe:
 s_waitcnt vmcnt(0)
 s_barrier
 s_add_u32 m0, s65, 65536
 s_add_u32 s56, s92, 0
 buffer_load_dwordx4 v14, s[4:7], s56 offen offset:0 sc1 lds
 buffer_load_dwordx4 v14, s[4:7], s56 offen offset:1024 sc1 lds
 buffer_load_dwordx4 v14, s[4:7], s56 offen offset:2048 sc1 lds
 buffer_load_dwordx4 v14, s[4:7], s56 offen offset:3072 sc1 lds
 s_add_u32 m0, s65, 81920
 s_add_u32 s56, s92, 32768
 buffer_load_dwordx4 v14, s[4:7], s56 offen offset:0 sc1 lds
 buffer_load_dwordx4 v14, s[4:7], s56 offen offset:1024 sc1 lds
 buffer_load_dwordx4 v14, s[4:7], s56 offen offset:2048 sc1 lds
 buffer_load_dwordx4 v14, s[4:7], s56 offen offset:3072 sc1 lds
 s_add_u32 m0, s65, 49152
 s_add_u32 s56, s92, 16384
 buffer_load_dwordx4 v14, s[4:7], s56 offen offset:0 sc1 lds
 buffer_load_dwordx4 v14, s[4:7], s56 offen offset:1024 sc1 lds
 buffer_load_dwordx4 v14, s[4:7], s56 offen offset:2048 sc1 lds
 buffer_load_dwordx4 v14, s[4:7], s56 offen offset:3072 sc1 lds
 v_accvgpr_write_b32 a0, 0
 v_accvgpr_write_b32 a1, 0
 v_accvgpr_write_b32 a2, 0
 v_accvgpr_write_b32 a3, 0
 v_accvgpr_write_b32 a4, 0
 v_accvgpr_write_b32 a5, 0
 v_accvgpr_write_b32 a6, 0
 v_accvgpr_write_b32 a7, 0
 v_accvgpr_write_b32 a8, 0
 v_accvgpr_write_b32 a9, 0
 v_accvgpr_write_b32 a10, 0
 v_accvgpr_write_b32 a11, 0
 v_accvgpr_write_b32 a12, 0
 v_accvgpr_write_b32 a13, 0
 v_accvgpr_write_b32 a14, 0
 v_accvgpr_write_b32 a15, 0
 v_accvgpr_write_b32 a16, 0
 v_accvgpr_write_b32 a17, 0
 v_accvgpr_write_b32 a18, 0
 v_accvgpr_write_b32 a19, 0
 v_accvgpr_write_b32 a20, 0
 v_accvgpr_write_b32 a21, 0
 v_accvgpr_write_b32 a22, 0
 v_accvgpr_write_b32 a23, 0
 v_accvgpr_write_b32 a24, 0
 v_accvgpr_write_b32 a25, 0
 v_accvgpr_write_b32 a26, 0
 v_accvgpr_write_b32 a27, 0
 v_accvgpr_write_b32 a28, 0
 v_accvgpr_write_b32 a29, 0
 v_accvgpr_write_b32 a30, 0
 v_accvgpr_write_b32 a31, 0
 v_accvgpr_write_b32 a32, 0
 v_accvgpr_write_b32 a33, 0
 v_accvgpr_write_b32 a34, 0
 v_accvgpr_write_b32 a35, 0
 v_accvgpr_write_b32 a36, 0
 v_accvgpr_write_b32 a37, 0
 v_accvgpr_write_b32 a38, 0
 v_accvgpr_write_b32 a39, 0
 v_accvgpr_write_b32 a40, 0
 v_accvgpr_write_b32 a41, 0
 v_accvgpr_write_b32 a42, 0
 v_accvgpr_write_b32 a43, 0
 v_accvgpr_write_b32 a44, 0
 v_accvgpr_write_b32 a45, 0
 v_accvgpr_write_b32 a46, 0
 v_accvgpr_write_b32 a47, 0
 v_accvgpr_write_b32 a48, 0
 v_accvgpr_write_b32 a49, 0
 v_accvgpr_write_b32 a50, 0
 v_accvgpr_write_b32 a51, 0
 v_accvgpr_write_b32 a52, 0
 v_accvgpr_write_b32 a53, 0
 v_accvgpr_write_b32 a54, 0
 v_accvgpr_write_b32 a55, 0
 v_accvgpr_write_b32 a56, 0
 v_accvgpr_write_b32 a57, 0
 v_accvgpr_write_b32 a58, 0
 v_accvgpr_write_b32 a59, 0
 v_accvgpr_write_b32 a60, 0
 v_accvgpr_write_b32 a61, 0
 v_accvgpr_write_b32 a62, 0
 v_accvgpr_write_b32 a63, 0
 v_accvgpr_write_b32 a64, 0
 v_accvgpr_write_b32 a65, 0
 v_accvgpr_write_b32 a66, 0
 v_accvgpr_write_b32 a67, 0
 v_accvgpr_write_b32 a68, 0
 v_accvgpr_write_b32 a69, 0
 v_accvgpr_write_b32 a70, 0
 v_accvgpr_write_b32 a71, 0
 v_accvgpr_write_b32 a72, 0
 v_accvgpr_write_b32 a73, 0
 v_accvgpr_write_b32 a74, 0
 v_accvgpr_write_b32 a75, 0
 v_accvgpr_write_b32 a76, 0
 v_accvgpr_write_b32 a77, 0
 v_accvgpr_write_b32 a78, 0
 v_accvgpr_write_b32 a79, 0
 v_accvgpr_write_b32 a80, 0
 v_accvgpr_write_b32 a81, 0
 v_accvgpr_write_b32 a82, 0
 v_accvgpr_write_b32 a83, 0
 v_accvgpr_write_b32 a84, 0
 v_accvgpr_write_b32 a85, 0
 v_accvgpr_write_b32 a86, 0
 v_accvgpr_write_b32 a87, 0
 v_accvgpr_write_b32 a88, 0
 v_accvgpr_write_b32 a89, 0
 v_accvgpr_write_b32 a90, 0
 v_accvgpr_write_b32 a91, 0
 v_accvgpr_write_b32 a92, 0
 v_accvgpr_write_b32 a93, 0
 v_accvgpr_write_b32 a94, 0
 v_accvgpr_write_b32 a95, 0
 v_accvgpr_write_b32 a96, 0
 v_accvgpr_write_b32 a97, 0
 v_accvgpr_write_b32 a98, 0
 v_accvgpr_write_b32 a99, 0
 v_accvgpr_write_b32 a100, 0
 v_accvgpr_write_b32 a101, 0
 v_accvgpr_write_b32 a102, 0
 v_accvgpr_write_b32 a103, 0
 v_accvgpr_write_b32 a104, 0
 v_accvgpr_write_b32 a105, 0
 v_accvgpr_write_b32 a106, 0
 v_accvgpr_write_b32 a107, 0
 v_accvgpr_write_b32 a108, 0
 v_accvgpr_write_b32 a109, 0
 v_accvgpr_write_b32 a110, 0
 v_accvgpr_write_b32 a111, 0
 v_accvgpr_write_b32 a112, 0
 v_accvgpr_write_b32 a113, 0
 v_accvgpr_write_b32 a114, 0
 v_accvgpr_write_b32 a115, 0
 v_accvgpr_write_b32 a116, 0
 v_accvgpr_write_b32 a117, 0
 v_accvgpr_write_b32 a118, 0
 v_accvgpr_write_b32 a119, 0
 v_accvgpr_write_b32 a120, 0
 v_accvgpr_write_b32 a121, 0
 v_accvgpr_write_b32 a122, 0
 v_accvgpr_write_b32 a123, 0
 v_accvgpr_write_b32 a124, 0
 v_accvgpr_write_b32 a125, 0
 v_accvgpr_write_b32 a126, 0
 v_accvgpr_write_b32 a127, 0
 s_waitcnt vmcnt(0)
 s_barrier
 s_mov_b32 s18, 0
 v_add_u32 v23, 65536, v14
 s_add_u32 s90, s92, 65536
 s_add_u32 s91, s65, 32768
 s_add_u32 s87, s65, 16384
 ds_read_b128 a[128:131], v23 offset:0
 ds_read_b128 a[132:135], v23 offset:1024
 ds_read_b128 a[136:139], v23 offset:2048
 ds_read_b128 a[140:143], v23 offset:3072
 ds_read_b128 a[144:147], v23 offset:4096
 s_waitcnt lgkmcnt(4)
 v_mfma_f32_32x32x16_bf16 v[96:111], a[128:131], v[32:35], 0
 ds_read_b128 a[148:151], v23 offset:5120
 v_mfma_f32_32x32x16_bf16 v[112:127], a[128:131], v[64:67], 0
 s_or_b32 m0, s91, 0x10000
 s_waitcnt lgkmcnt(4)
 v_mfma_f32_32x32x16_bf16 v[96:111], a[132:135], v[48:51], v[96:111]
 ds_read_b128 a[152:155], v23 offset:6144
 buffer_load_dwordx4 v14, s[32:35], s90 offen offset:0 sc1 lds
 v_mfma_f32_32x32x16_bf16 v[112:127], a[132:135], v[80:83], v[112:127]
 buffer_load_dwordx4 v14, s[32:35], s90 offen offset:1024 sc1 lds
 s_waitcnt lgkmcnt(4)
 v_mfma_f32_32x32x16_bf16 v[96:111], a[136:139], v[36:39], v[96:111]
 ds_read_b128 a[156:159], v23 offset:7168
 buffer_load_dwordx4 v14, s[32:35], s90 offen offset:2048 sc1 lds
 v_mfma_f32_32x32x16_bf16 v[112:127], a[136:139], v[68:71], v[112:127]
 s_waitcnt lgkmcnt(2)
 v_mfma_f32_32x32x16_bf16 v[96:111], a[140:143], v[52:55], v[96:111]
 ds_read_b128 a[160:163], v23 offset:8192
 buffer_load_dwordx4 v14, s[32:35], s90 offen offset:3072 sc1 lds
 v_mfma_f32_32x32x16_bf16 v[112:127], a[140:143], v[84:87], v[112:127]
 s_xor_b32 m0, s87, 0xc000
 v_mfma_f32_32x32x16_bf16 v[96:111], a[144:147], v[40:43], v[96:111]
 ds_read_b128 a[164:167], v23 offset:9216
 s_add_u32 s56, s90, 4294950912
 v_mfma_f32_32x32x16_bf16 v[112:127], a[144:147], v[72:75], v[112:127]
 buffer_load_dwordx4 v14, s[32:35], s56 offen offset:0 sc1 lds
 v_mfma_f32_32x32x16_bf16 v[96:111], a[148:151], v[56:59], v[96:111]
 ds_read_b128 a[168:171], v23 offset:10240
 v_mfma_f32_32x32x16_bf16 v[112:127], a[148:151], v[88:91], v[112:127]
 buffer_load_dwordx4 v14, s[32:35], s56 offen offset:1024 sc1 lds
 s_waitcnt lgkmcnt(2)
 v_mfma_f32_32x32x16_bf16 v[96:111], a[152:155], v[44:47], v[96:111]
 ds_read_b128 a[172:175], v23 offset:11264
 buffer_load_dwordx4 v14, s[32:35], s56 offen offset:2048 sc1 lds
 v_mfma_f32_32x32x16_bf16 v[112:127], a[152:155], v[76:79], v[112:127]
 buffer_load_dwordx4 v14, s[32:35], s56 offen offset:3072 sc1 lds
 v_mfma_f32_32x32x16_bf16 v[96:111], a[156:159], v[60:63], v[96:111]
 ds_read_b128 a[176:179], v23 offset:12288
 v_mfma_f32_32x32x16_bf16 v[112:127], a[156:159], v[92:95], v[112:127]
 v_mfma_f32_32x32x16_bf16 v[128:143], a[160:163], v[32:35], 0
 ds_read_b128 a[180:183], v23 offset:13312
 v_mfma_f32_32x32x16_bf16 v[144:159], a[160:163], v[64:67], 0
 s_waitcnt lgkmcnt(2)
 v_mfma_f32_32x32x16_bf16 v[128:143], a[164:167], v[48:51], v[128:143]
 ds_read_b128 a[184:187], v23 offset:14336
 v_mfma_f32_32x32x16_bf16 v[144:159], a[164:167], v[80:83], v[144:159]
 s_lshl_b32 s19, s18, 1
 s_add_u32 s19, s19, 0
 s_cmp_ge_u32 s19, s93
 s_cbranch_scc1 M_parall_37
MB_parall_38:
 v_mfma_f32_32x32x16_bf16 v[128:143], a[168:171], v[36:39], v[128:143]
 v_max3_f32 v232, v96, v97, v98
 v_max3_f32 v232, v232, v99, v100
 v_max3_f32 v232, v232, v101, v102
 v_max3_f32 v232, v232, v103, v104
 v_max3_f32 v232, v232, v105, v106
 ds_read_b128 a[188:191], v23 offset:15360
 v_mfma_f32_32x32x16_bf16 v[144:159], a[168:171], v[68:71], v[144:159]
 v_max3_f32 v232, v232, v107, v108
 v_max3_f32 v232, v232, v109, v110
 v_max_f32 v232, v232, v111
 v_mov_b32 v235, v232
 s_nop 1
 v_permlane32_swap_b32 v232, v235
 v_mfma_f32_32x32x16_bf16 v[128:143], a[172:175], v[52:55], v[128:143]
 v_max_f32 v232, v232, v235
 v_max3_f32 v233, v112, v113, v114
 v_max3_f32 v233, v233, v115, v116
 v_max3_f32 v233, v233, v117, v118
 v_max3_f32 v233, v233, v119, v120
 v_max3_f32 v233, v233, v121, v122
 v_mfma_f32_32x32x16_bf16 v[144:159], a[172:175], v[84:87], v[144:159]
 v_max3_f32 v233, v233, v123, v124
 v_max3_f32 v233, v233, v125, v126
 v_max_f32 v233, v233, v127
 v_mov_b32 v235, v233
 s_nop 1
 v_permlane32_swap_b32 v233, v235
 s_waitcnt lgkmcnt(1)
 v_mfma_f32_32x32x16_bf16 v[128:143], a[176:179], v[40:43], v[128:143]
 v_max_f32 v233, v233, v235
 v_sub_f32 v96, v96, v232
 v_sub_f32 v97, v97, v232
 v_sub_f32 v98, v98, v232
 v_sub_f32 v99, v99, v232
 v_sub_f32 v100, v100, v232
 v_mfma_f32_32x32x16_bf16 v[144:159], a[176:179], v[72:75], v[144:159]
 v_sub_f32 v101, v101, v232
 v_sub_f32 v102, v102, v232
 v_sub_f32 v103, v103, v232
 v_sub_f32 v104, v104, v232
 v_sub_f32 v105, v105, v232
 v_sub_f32 v106, v106, v232
 v_mfma_f32_32x32x16_bf16 v[128:143], a[180:183], v[56:59], v[128:143]
 v_sub_f32 v107, v107, v232
 v_sub_f32 v108, v108, v232
 v_sub_f32 v109, v109, v232
 v_sub_f32 v110, v110, v232
 v_sub_f32 v111, v111, v232
 v_sub_f32 v112, v112, v233
 v_mfma_f32_32x32x16_bf16 v[144:159], a[180:183], v[88:91], v[144:159]
 v_sub_f32 v113, v113, v233
 v_sub_f32 v114, v114, v233
 v_sub_f32 v115, v115, v233
 v_sub_f32 v116, v116, v233
 v_sub_f32 v117, v117, v233
 v_sub_f32 v118, v118, v233
 v_mfma_f32_32x32x16_bf16 v[128:143], a[184:187], v[44:47], v[128:143]
 v_sub_f32 v119, v119, v233
 v_sub_f32 v120, v120, v233
 v_sub_f32 v121, v121, v233
 v_sub_f32 v122, v122, v233
 v_sub_f32 v123, v123, v233
 v_sub_f32 v124, v124, v233
 v_mfma_f32_32x32x16_bf16 v[144:159], a[184:187], v[76:79], v[144:159]
 v_sub_f32 v125, v125, v233
 v_sub_f32 v126, v126, v233
 v_sub_f32 v127, v127, v233
 v_sub_f32 v192, 0, v232
 v_sub_f32 v193, 0, v232
 s_waitcnt lgkmcnt(0)
 v_mfma_f32_32x32x16_bf16 v[128:143], a[188:191], v[60:63], v[128:143]
 v_sub_f32 v194, 0, v232
 v_sub_f32 v195, 0, v232
 v_sub_f32 v196, 0, v232
 v_sub_f32 v197, 0, v232
 v_sub_f32 v198, 0, v232
 v_sub_f32 v199, 0, v232
 v_mfma_f32_32x32x16_bf16 v[144:159], a[188:191], v[92:95], v[144:159]
 v_sub_f32 v200, 0, v232
 v_sub_f32 v201, 0, v232
 v_sub_f32 v202, 0, v232
 v_sub_f32 v203, 0, v232
 v_sub_f32 v204, 0, v232
 v_sub_f32 v205, 0, v232
 v_sub_f32 v206, 0, v232
 v_sub_f32 v207, 0, v232
 v_sub_f32 v208, 0, v233
 v_sub_f32 v209, 0, v233
 v_sub_f32 v210, 0, v233
 v_sub_f32 v211, 0, v233
 v_sub_f32 v212, 0, v233
 v_sub_f32 v213, 0, v233
 v_sub_f32 v214, 0, v233
 v_sub_f32 v215, 0, v233
 v_sub_f32 v216, 0, v233
 v_sub_f32 v217, 0, v233
 v_sub_f32 v218, 0, v233
 v_sub_f32 v219, 0, v233
 v_sub_f32 v220, 0, v233
 v_sub_f32 v221, 0, v233
 v_sub_f32 v222, 0, v233
 v_sub_f32 v223, 0, v233
 s_lshl_b32 s19, s18, 1
 s_add_u32 s19, s19, 1
 s_cmp_ge_u32 s19, s93
 s_cbranch_scc1 M_parall_39
MB_parall_40:
 v_xor_b32 v24, 0x1c000, v23
 v_add_u32 v23, s87, v236
 s_mov_b32 s87, s91
 s_add_u32 s91, s91, 16384
 s_and_b32 s91, s91, 0xffff
 s_add_u32 s90, s90, 32768
 s_add_u32 s18, s18, 1
 v_exp_f32 v224, v96
 v_exp_f32 v225, v97
 v_exp_f32 v226, v98
 v_exp_f32 v227, v99
 v_add_f32 v228, v224, v225
 v_cvt_pk_bf16_f32 v160, v224, v225
 v_exp_f32 v224, v100
 v_exp_f32 v225, v101
 v_add_f32 v228, v228, v226
 v_cvt_pk_bf16_f32 v161, v226, v227
 v_add_f32 v228, v228, v227
 v_exp_f32 v226, v102
 v_exp_f32 v227, v103
 v_add_f32 v228, v228, v224
 v_cvt_pk_bf16_f32 v162, v224, v225
 v_add_f32 v228, v228, v225
 v_exp_f32 v224, v104
 v_exp_f32 v225, v105
 v_add_f32 v228, v228, v226
 v_cvt_pk_bf16_f32 v163, v226, v227
 v_add_f32 v228, v228, v227
 v_exp_f32 v226, v106
 v_exp_f32 v227, v107
 v_add_f32 v228, v228, v224
 v_cvt_pk_bf16_f32 v164, v224, v225
 v_add_f32 v228, v228, v225
 v_exp_f32 v224, v108
 v_exp_f32 v225, v109
 v_add_f32 v228, v228, v226
 v_cvt_pk_bf16_f32 v165, v226, v227
 v_add_f32 v228, v228, v227
 v_exp_f32 v226, v110
 v_exp_f32 v227, v111
 v_add_f32 v228, v228, v224
 v_cvt_pk_bf16_f32 v166, v224, v225
 v_add_f32 v228, v228, v225
 v_exp_f32 v224, v112
 v_exp_f32 v225, v113
 v_add_f32 v228, v228, v226
 v_cvt_pk_bf16_f32 v167, v226, v227
 v_sub_f32 v128, v128, v232
 v_sub_f32 v129, v129, v232
 v_sub_f32 v130, v130, v232
 v_sub_f32 v131, v131, v232
 v_sub_f32 v132, v132, v232
 v_sub_f32 v133, v133, v232
 v_sub_f32 v134, v134, v232
 v_sub_f32 v135, v135, v232
 v_sub_f32 v136, v136, v232
 v_sub_f32 v137, v137, v232
 v_sub_f32 v138, v138, v232
 v_sub_f32 v139, v139, v232
 v_sub_f32 v140, v140, v232
 v_sub_f32 v141, v141, v232
 v_sub_f32 v142, v142, v232
 v_sub_f32 v143, v143, v232
 v_sub_f32 v144, v144, v233
 v_sub_f32 v145, v145, v233
 v_sub_f32 v146, v146, v233
 v_sub_f32 v147, v147, v233
 v_sub_f32 v148, v148, v233
 v_sub_f32 v149, v149, v233
 v_sub_f32 v150, v150, v233
 v_sub_f32 v151, v151, v233
 v_sub_f32 v152, v152, v233
 v_sub_f32 v153, v153, v233
 v_sub_f32 v154, v154, v233
 v_sub_f32 v155, v155, v233
 v_sub_f32 v156, v156, v233
 v_sub_f32 v157, v157, v233
 v_sub_f32 v158, v158, v233
 v_sub_f32 v159, v159, v233
 s_or_b32 m0, s91, 0x10000
 s_nop 0
 buffer_load_dwordx4 v14, s[32:35], s90 offen offset:0 sc1 lds
 buffer_load_dwordx4 v14, s[32:35], s90 offen offset:1024 sc1 lds
 buffer_load_dwordx4 v14, s[32:35], s90 offen offset:2048 sc1 lds
 buffer_load_dwordx4 v14, s[32:35], s90 offen offset:3072 sc1 lds
 ds_read_b128 a[128:131], v23 offset:0
 ds_read_b128 a[132:135], v23 offset:1024
 ds_read_b128 a[136:139], v23 offset:2048
 ds_read_b128 a[140:143], v23 offset:3072
 ds_read_b128 a[144:147], v23 offset:4096
 ds_read_b128 a[148:151], v23 offset:5120
 v_add_f32 v228, v228, v227
 v_exp_f32 v226, v114
 v_exp_f32 v227, v115
 v_add_f32 v229, v224, v225
 v_cvt_pk_bf16_f32 v168, v224, v225
 v_exp_f32 v224, v116
 v_exp_f32 v225, v117
 v_add_f32 v229, v229, v226
 v_cvt_pk_bf16_f32 v169, v226, v227
 v_add_f32 v229, v229, v227
 v_exp_f32 v226, v118
 v_exp_f32 v227, v119
 v_add_f32 v229, v229, v224
 v_cvt_pk_bf16_f32 v170, v224, v225
 v_add_f32 v229, v229, v225
 v_exp_f32 v224, v120
 v_exp_f32 v225, v121
 v_add_f32 v229, v229, v226
 v_cvt_pk_bf16_f32 v171, v226, v227
 v_add_f32 v229, v229, v227
 v_exp_f32 v226, v122
 v_exp_f32 v227, v123
 v_add_f32 v229, v229, v224
 v_cvt_pk_bf16_f32 v172, v224, v225
 v_add_f32 v229, v229, v225
 v_exp_f32 v224, v124
 v_exp_f32 v225, v125
 v_add_f32 v229, v229, v226
 v_cvt_pk_bf16_f32 v173, v226, v227
 v_add_f32 v229, v229, v227
 v_exp_f32 v226, v126
 v_exp_f32 v227, v127
 v_add_f32 v229, v229, v224
 v_cvt_pk_bf16_f32 v174, v224, v225
 v_add_f32 v229, v229, v225
 v_add_f32 v229, v229, v226
 v_cvt_pk_bf16_f32 v175, v226, v227
 v_add_f32 v229, v229, v227
L_dual_s:
 s_waitcnt lgkmcnt(5)
 v_mfma_f32_32x32x16_bf16 v[96:111], a[128:131], v[32:35], v[192:207]
 v_exp_f32 v224, v128
 v_exp_f32 v225, v129
 v_mfma_f32_32x32x16_bf16 v[112:127], a[128:131], v[64:67], v[208:223]
 ds_read_b128 a[152:155], v23 offset:6144
 v_exp_f32 v226, v130
 v_exp_f32 v227, v131
 s_waitcnt lgkmcnt(5)
 v_mfma_f32_32x32x16_bf16 v[96:111], a[132:135], v[48:51], v[96:111]
 v_add_f32 v230, v228, v224
 v_cvt_pk_bf16_f32 v176, v224, v225
 v_add_f32 v230, v230, v225
 v_exp_f32 v224, v132
 v_mfma_f32_32x32x16_bf16 v[112:127], a[132:135], v[80:83], v[112:127]
 ds_read_b128 a[156:159], v23 offset:7168
 v_exp_f32 v225, v133
 s_waitcnt lgkmcnt(5)
 v_mfma_f32_32x32x16_bf16 v[96:111], a[136:139], v[36:39], v[96:111]
 v_add_f32 v230, v230, v226
 v_cvt_pk_bf16_f32 v177, v226, v227
 v_add_f32 v230, v230, v227
 v_exp_f32 v226, v134
 v_mfma_f32_32x32x16_bf16 v[112:127], a[136:139], v[68:71], v[112:127]
 ds_read_b128 a[160:163], v24 offset:0
 v_exp_f32 v227, v135
 v_add_f32 v230, v230, v224
 s_waitcnt lgkmcnt(3)
 v_mfma_f32_32x32x16_bf16 v[96:111], a[140:143], v[52:55], v[96:111]
 v_cvt_pk_bf16_f32 v178, v224, v225
 v_add_f32 v230, v230, v225
 v_exp_f32 v224, v136
 v_mfma_f32_32x32x16_bf16 v[112:127], a[140:143], v[84:87], v[112:127]
 ds_read_b128 a[164:167], v24 offset:1024
 v_exp_f32 v225, v137
 v_add_f32 v230, v230, v226
 v_mfma_f32_32x32x16_bf16 v[96:111], a[144:147], v[40:43], v[96:111]
 s_xor_b32 m0, s87, 0xc000
 v_cvt_pk_bf16_f32 v179, v226, v227
 v_add_f32 v230, v230, v227
 v_exp_f32 v226, v138
 v_mfma_f32_32x32x16_bf16 v[112:127], a[144:147], v[72:75], v[112:127]
 ds_read_b128 a[168:171], v24 offset:2048
 v_exp_f32 v227, v139
 v_add_f32 v230, v230, v224
 v_mfma_f32_32x32x16_bf16 v[96:111], a[148:151], v[56:59], v[96:111]
 v_cvt_pk_bf16_f32 v180, v224, v225
 v_add_f32 v230, v230, v225
 v_exp_f32 v224, v140
 v_mfma_f32_32x32x16_bf16 v[112:127], a[148:151], v[88:91], v[112:127]
 ds_read_b128 a[172:175], v24 offset:3072
 v_exp_f32 v225, v141
 v_add_f32 v230, v230, v226
 v_cvt_pk_bf16_f32 v181, v226, v227
 s_waitcnt lgkmcnt(3)
 v_mfma_f32_32x32x16_bf16 v[96:111], a[152:155], v[44:47], v[96:111]
 v_add_f32 v230, v230, v227
 v_exp_f32 v226, v142
 v_mfma_f32_32x32x16_bf16 v[112:127], a[152:155], v[76:79], v[112:127]
 ds_read_b128 a[176:179], v24 offset:4096
 s_add_u32 s56, s90, 4294950912
 v_exp_f32 v227, v143
 v_add_f32 v230, v230, v224
 v_cvt_pk_bf16_f32 v182, v224, v225
 v_mfma_f32_32x32x16_bf16 v[96:111], a[156:159], v[60:63], v[96:111]
 v_add_f32 v230, v230, v225
 v_exp_f32 v224, v144
 v_exp_f32 v225, v145
 v_mfma_f32_32x32x16_bf16 v[112:127], a[156:159], v[92:95], v[112:127]
 ds_read_b128 a[180:183], v24 offset:5120
 v_add_f32 v230, v230, v226
 v_cvt_pk_bf16_f32 v183, v226, v227
 v_mfma_f32_32x32x16_bf16 a[0:15], a[160:163], v[160:163], a[0:15]
 v_add_f32 v230, v230, v227
 v_exp_f32 v226, v146
 v_exp_f32 v227, v147
 v_mfma_f32_32x32x16_bf16 a[64:79], a[160:163], v[168:171], a[64:79]
 ds_read_b128 a[184:187], v24 offset:6144
 v_add_f32 v231, v229, v224
 v_cvt_pk_bf16_f32 v184, v224, v225
 v_add_f32 v231, v231, v225
 s_waitcnt lgkmcnt(3)
 v_mfma_f32_32x32x16_bf16 a[16:31], a[164:167], v[160:163], a[16:31]
 buffer_load_dwordx4 v14, s[32:35], s56 offen offset:0 sc1 lds
 v_exp_f32 v224, v148
 v_exp_f32 v225, v149
 v_mfma_f32_32x32x16_bf16 a[80:95], a[164:167], v[168:171], a[80:95]
 ds_read_b128 a[188:191], v24 offset:7168
 v_add_f32 v231, v231, v226
 v_cvt_pk_bf16_f32 v185, v226, v227
 v_add_f32 v231, v231, v227
 v_mfma_f32_32x32x16_bf16 a[32:47], a[168:171], v[160:163], a[32:47]
 s_lshl_b32 s19, s18, 1
 s_add_u32 s19, s19, 0
 s_cmp_ge_u32 s19, s93
 s_cbranch_scc1 M_parall_41
MB_parall_42:
 v_mfma_f32_32x32x16_bf16 a[96:111], a[168:171], v[168:171], a[96:111]
 ds_read_b128 a[128:131], v23 offset:8192
 v_exp_f32 v226, v150
 v_exp_f32 v227, v151
 v_add_f32 v231, v231, v224
 v_mfma_f32_32x32x16_bf16 a[48:63], a[172:175], v[160:163], a[48:63]
 v_cvt_pk_bf16_f32 v186, v224, v225
 v_add_f32 v231, v231, v225
 v_exp_f32 v224, v152
 v_exp_f32 v225, v153
 v_mfma_f32_32x32x16_bf16 a[112:127], a[172:175], v[168:171], a[112:127]
 ds_read_b128 a[132:135], v23 offset:9216
 v_add_f32 v231, v231, v226
 v_cvt_pk_bf16_f32 v187, v226, v227
 v_add_f32 v231, v231, v227
 s_waitcnt lgkmcnt(3)
 v_mfma_f32_32x32x16_bf16 a[0:15], a[176:179], v[164:167], a[0:15]
 buffer_load_dwordx4 v14, s[32:35], s56 offen offset:1024 sc1 lds
 v_exp_f32 v226, v154
 v_exp_f32 v227, v155
 v_mfma_f32_32x32x16_bf16 a[64:79], a[176:179], v[172:175], a[64:79]
 ds_read_b128 a[136:139], v23 offset:10240
 v_add_f32 v231, v231, v224
 v_cvt_pk_bf16_f32 v188, v224, v225
 v_add_f32 v231, v231, v225
 v_exp_f32 v224, v156
 v_mfma_f32_32x32x16_bf16 a[16:31], a[180:183], v[164:167], a[16:31]
 v_exp_f32 v225, v157
 v_add_f32 v231, v231, v226
 v_mfma_f32_32x32x16_bf16 a[80:95], a[180:183], v[172:175], a[80:95]
 ds_read_b128 a[140:143], v23 offset:11264
 v_cvt_pk_bf16_f32 v189, v226, v227
 v_add_f32 v231, v231, v227
 v_exp_f32 v226, v158
 v_mfma_f32_32x32x16_bf16 a[32:47], a[184:187], v[164:167], a[32:47]
 v_exp_f32 v227, v159
 v_add_f32 v231, v231, v224
 v_mfma_f32_32x32x16_bf16 a[96:111], a[184:187], v[172:175], a[96:111]
 ds_read_b128 a[144:147], v23 offset:12288
 buffer_load_dwordx4 v14, s[32:35], s56 offen offset:2048 sc1 lds
 v_cvt_pk_bf16_f32 v190, v224, v225
 v_add_f32 v231, v231, v225
 s_waitcnt lgkmcnt(3)
 v_mfma_f32_32x32x16_bf16 a[48:63], a[188:191], v[164:167], a[48:63]
 v_add_f32 v231, v231, v226
 v_cvt_pk_bf16_f32 v191, v226, v227
 v_add_f32 v231, v231, v227
 v_mfma_f32_32x32x16_bf16 a[112:127], a[188:191], v[172:175], a[112:127]
 v_max_f32 v232, v230, v231
 v_cmp_lt_f32 vcc, s14, v232
 s_cbranch_vccnz C_parall_43
CB_parall_44:
 v_mfma_f32_32x32x16_bf16 v[128:143], a[128:131], v[32:35], v[192:207]
 ds_read_b128 a[148:151], v23 offset:13312
 v_exp_f32 v224, v96
 v_exp_f32 v225, v97
 v_mfma_f32_32x32x16_bf16 v[144:159], a[128:131], v[64:67], v[208:223]
 ds_read_b128 a[152:155], v23 offset:14336
 v_exp_f32 v226, v98
 v_exp_f32 v227, v99
 v_mfma_f32_32x32x16_bf16 v[128:143], a[132:135], v[48:51], v[128:143]
 buffer_load_dwordx4 v14, s[32:35], s56 offen offset:3072 sc1 lds
 v_add_f32 v228, v230, v224
 v_cvt_pk_bf16_f32 v160, v224, v225
 v_add_f32 v228, v228, v225
 v_mfma_f32_32x32x16_bf16 v[144:159], a[132:135], v[80:83], v[144:159]
 ds_read_b128 a[156:159], v23 offset:15360
 v_exp_f32 v224, v100
 v_exp_f32 v225, v101
 s_waitcnt lgkmcnt(3)
 v_mfma_f32_32x32x16_bf16 v[128:143], a[136:139], v[36:39], v[128:143]
 v_add_f32 v228, v228, v226
 v_cvt_pk_bf16_f32 v161, v226, v227
 v_add_f32 v228, v228, v227
 v_exp_f32 v226, v102
 v_mfma_f32_32x32x16_bf16 v[144:159], a[136:139], v[68:71], v[144:159]
 ds_read_b128 a[160:163], v24 offset:8192
 v_exp_f32 v227, v103
 v_add_f32 v228, v228, v224
 v_mfma_f32_32x32x16_bf16 v[128:143], a[140:143], v[52:55], v[128:143]
 v_cvt_pk_bf16_f32 v162, v224, v225
 v_add_f32 v228, v228, v225
 v_exp_f32 v224, v104
 v_mfma_f32_32x32x16_bf16 v[144:159], a[140:143], v[84:87], v[144:159]
 ds_read_b128 a[164:167], v24 offset:9216
 v_exp_f32 v225, v105
 v_add_f32 v228, v228, v226
 v_mfma_f32_32x32x16_bf16 v[128:143], a[144:147], v[40:43], v[128:143]
 v_cvt_pk_bf16_f32 v163, v226, v227
 v_add_f32 v228, v228, v227
 v_exp_f32 v226, v106
 v_mfma_f32_32x32x16_bf16 v[144:159], a[144:147], v[72:75], v[144:159]
 ds_read_b128 a[168:171], v24 offset:10240
 v_exp_f32 v227, v107
 v_add_f32 v228, v228, v224
 s_waitcnt lgkmcnt(3)
 v_mfma_f32_32x32x16_bf16 v[128:143], a[148:151], v[56:59], v[128:143]
 v_cvt_pk_bf16_f32 v164, v224, v225
 v_add_f32 v228, v228, v225
 v_exp_f32 v224, v108
 v_mfma_f32_32x32x16_bf16 v[144:159], a[148:151], v[88:91], v[144:159]
 ds_read_b128 a[172:175], v24 offset:11264
 v_exp_f32 v225, v109
 v_add_f32 v228, v228, v226
 v_cvt_pk_bf16_f32 v165, v226, v227
 v_mfma_f32_32x32x16_bf16 v[128:143], a[152:155], v[44:47], v[128:143]
 v_add_f32 v228, v228, v227
 v_exp_f32 v226, v110
 v_mfma_f32_32x32x16_bf16 v[144:159], a[152:155], v[76:79], v[144:159]
 ds_read_b128 a[176:179], v24 offset:12288
 v_exp_f32 v227, v111
 v_add_f32 v228, v228, v224
 v_cvt_pk_bf16_f32 v166, v224, v225
 v_mfma_f32_32x32x16_bf16 v[128:143], a[156:159], v[60:63], v[128:143]
 v_add_f32 v228, v228, v225
 v_exp_f32 v224, v112
 v_exp_f32 v225, v113
 v_mfma_f32_32x32x16_bf16 v[144:159], a[156:159], v[92:95], v[144:159]
 ds_read_b128 a[180:183], v24 offset:13312
 v_add_f32 v228, v228, v226
 v_cvt_pk_bf16_f32 v167, v226, v227
 s_waitcnt lgkmcnt(3)
 v_mfma_f32_32x32x16_bf16 a[0:15], a[160:163], v[176:179], a[0:15]
 v_add_f32 v228, v228, v227
 v_exp_f32 v226, v114
 v_exp_f32 v227, v115
 v_mfma_f32_32x32x16_bf16 a[64:79], a[160:163], v[184:187], a[64:79]
 ds_read_b128 a[184:187], v24 offset:14336
 v_add_f32 v229, v231, v224
 v_cvt_pk_bf16_f32 v168, v224, v225
 v_add_f32 v229, v229, v225
 v_mfma_f32_32x32x16_bf16 a[16:31], a[164:167], v[176:179], a[16:31]
 ds_read_b128 a[188:191], v24 offset:15360
 v_exp_f32 v224, v116
 v_exp_f32 v225, v117
 v_mfma_f32_32x32x16_bf16 a[80:95], a[164:167], v[184:187], a[80:95]
 s_lshl_b32 s19, s18, 1
 s_add_u32 s19, s19, 1
 s_cmp_ge_u32 s19, s93
 s_cbranch_scc1 M_parall_45
MB_parall_46:
 v_mfma_f32_32x32x16_bf16 a[32:47], a[168:171], v[176:179], a[32:47]
 v_xor_b32 v24, 0x1c000, v23
 v_add_u32 v23, s87, v236
 v_add_f32 v229, v229, v226
 v_cvt_pk_bf16_f32 v169, v226, v227
 v_add_f32 v229, v229, v227
 v_mfma_f32_32x32x16_bf16 a[96:111], a[168:171], v[184:187], a[96:111]
 v_exp_f32 v226, v118
 v_exp_f32 v227, v119
 v_add_f32 v229, v229, v224
 s_waitcnt lgkmcnt(2)
 v_mfma_f32_32x32x16_bf16 a[48:63], a[172:175], v[176:179], a[48:63]
 s_waitcnt vmcnt(8) lgkmcnt(0)
 s_barrier
 ds_read_b128 a[128:131], v23 offset:0
 s_mov_b32 s87, s91
 ds_read_b128 a[132:135], v23 offset:1024
 v_cvt_pk_bf16_f32 v170, v224, v225
 v_mfma_f32_32x32x16_bf16 a[112:127], a[172:175], v[184:187], a[112:127]
 ds_read_b128 a[136:139], v23 offset:2048
 s_add_u32 s91, s91, 16384
 v_add_f32 v229, v229, v225
 v_exp_f32 v224, v120
 v_mfma_f32_32x32x16_bf16 a[0:15], a[176:179], v[180:183], a[0:15]
 ds_read_b128 a[140:143], v23 offset:3072
 s_and_b32 s91, s91, 0xffff
 v_exp_f32 v225, v121
 v_add_f32 v229, v229, v226
 v_cvt_pk_bf16_f32 v171, v226, v227
 v_mfma_f32_32x32x16_bf16 a[64:79], a[176:179], v[188:191], a[64:79]
 ds_read_b128 a[144:147], v23 offset:4096
 s_add_u32 s90, s90, 32768
 v_add_f32 v229, v229, v227
 v_exp_f32 v226, v122
 v_mfma_f32_32x32x16_bf16 a[16:31], a[180:183], v[180:183], a[16:31]
 ds_read_b128 a[148:151], v23 offset:5120
 s_add_u32 s18, s18, 1
 v_exp_f32 v227, v123
 v_add_f32 v229, v229, v224
 v_cvt_pk_bf16_f32 v172, v224, v225
 v_mfma_f32_32x32x16_bf16 a[80:95], a[180:183], v[188:191], a[80:95]
 s_or_b32 m0, s91, 0x10000
 s_nop 0
 buffer_load_dwordx4 v14, s[32:35], s90 offen offset:0 sc1 lds
 v_add_f32 v229, v229, v225
 v_mfma_f32_32x32x16_bf16 a[32:47], a[184:187], v[180:183], a[32:47]
 buffer_load_dwordx4 v14, s[32:35], s90 offen offset:1024 sc1 lds
 v_exp_f32 v224, v124
 v_exp_f32 v225, v125
 v_mfma_f32_32x32x16_bf16 a[96:111], a[184:187], v[188:191], a[96:111]
 buffer_load_dwordx4 v14, s[32:35], s90 offen offset:2048 sc1 lds
 v_add_f32 v229, v229, v226
 v_cvt_pk_bf16_f32 v173, v226, v227
 v_add_f32 v229, v229, v227
 v_mfma_f32_32x32x16_bf16 a[48:63], a[188:191], v[180:183], a[48:63]
 buffer_load_dwordx4 v14, s[32:35], s90 offen offset:3072 sc1 lds
 v_exp_f32 v226, v126
 v_exp_f32 v227, v127
 v_mfma_f32_32x32x16_bf16 a[112:127], a[188:191], v[188:191], a[112:127]
 v_add_f32 v229, v229, v224
 v_cvt_pk_bf16_f32 v174, v224, v225
 v_add_f32 v229, v229, v225
 v_add_f32 v229, v229, v226
 v_cvt_pk_bf16_f32 v175, v226, v227
 v_add_f32 v229, v229, v227
 v_max_f32 v232, v228, v229
 v_cmp_lt_f32 vcc, s14, v232
 s_cbranch_vccnz C_parall_47
CB_parall_48:
 s_cmp_lt_u32 s18, s16
 s_cbranch_scc1 L_dual_s
 s_waitcnt lgkmcnt(5)
 v_mfma_f32_32x32x16_bf16 v[96:111], a[128:131], v[64:67], v[208:223]
 ds_read_b128 a[152:155], v23 offset:6144
 ds_read_b128 a[156:159], v23 offset:7168
 ds_read_b128 a[160:163], v23 offset:8192
 v_exp_f32 v224, v128
 s_waitcnt lgkmcnt(7)
 v_mfma_f32_32x32x16_bf16 v[96:111], a[132:135], v[80:83], v[96:111]
 s_add_u32 m0, s91, 0x14000
 ds_read_b128 a[164:167], v23 offset:9216
 ds_read_b128 a[168:171], v23 offset:10240
 ds_read_b128 a[172:175], v23 offset:11264
 s_waitcnt lgkmcnt(9)
 v_mfma_f32_32x32x16_bf16 v[96:111], a[136:139], v[68:71], v[96:111]
 ds_read_b128 a[176:179], v23 offset:12288
 ds_read_b128 a[180:183], v23 offset:13312
 v_exp_f32 v225, v129
 s_waitcnt lgkmcnt(10)
 v_mfma_f32_32x32x16_bf16 v[96:111], a[140:143], v[84:87], v[96:111]
 ds_read_b128 a[184:187], v23 offset:14336
 s_add_u32 s56, s90, 32768
 v_exp_f32 v226, v130
 s_waitcnt lgkmcnt(10)
 v_mfma_f32_32x32x16_bf16 v[96:111], a[144:147], v[72:75], v[96:111]
 ds_read_b128 a[188:191], v23 offset:15360
 v_exp_f32 v227, v131
 v_add_f32 v230, v228, v224
 v_cvt_pk_bf16_f32 v176, v224, v225
 s_waitcnt lgkmcnt(10)
 v_mfma_f32_32x32x16_bf16 v[96:111], a[148:151], v[88:91], v[96:111]
 ds_read_b128 a[128:131], v24 offset:0
 v_add_f32 v230, v230, v225
 v_exp_f32 v224, v132
 s_waitcnt lgkmcnt(8)
 v_mfma_f32_32x32x16_bf16 v[96:111], a[152:155], v[76:79], v[96:111]
 buffer_load_dwordx4 v14, s[32:35], s56 offen offset:0 sc1 lds
 v_exp_f32 v225, v133
 v_add_f32 v230, v230, v226
 v_cvt_pk_bf16_f32 v177, v226, v227
 v_mfma_f32_32x32x16_bf16 v[96:111], a[156:159], v[92:95], v[96:111]
 ds_read_b128 a[132:135], v24 offset:1024
 v_add_f32 v230, v230, v227
 v_exp_f32 v226, v134
 v_exp_f32 v227, v135
 v_mfma_f32_32x32x16_bf16 v[112:127], a[160:163], v[64:67], v[208:223]
 v_add_f32 v230, v230, v224
 v_cvt_pk_bf16_f32 v178, v224, v225
 v_add_f32 v230, v230, v225
 v_exp_f32 v224, v136
 s_waitcnt lgkmcnt(3)
 v_mfma_f32_32x32x16_bf16 v[112:127], a[164:167], v[80:83], v[112:127]
 ds_read_b128 a[136:139], v24 offset:2048
 buffer_load_dwordx4 v14, s[32:35], s56 offen offset:1024 sc1 lds
 v_exp_f32 v225, v137
 v_add_f32 v230, v230, v226
 v_mfma_f32_32x32x16_bf16 v[112:127], a[168:171], v[68:71], v[112:127]
 v_cvt_pk_bf16_f32 v179, v226, v227
 v_add_f32 v230, v230, v227
 v_exp_f32 v226, v138
 v_exp_f32 v227, v139
 v_mfma_f32_32x32x16_bf16 v[112:127], a[172:175], v[84:87], v[112:127]
 ds_read_b128 a[140:143], v24 offset:3072
 v_add_f32 v230, v230, v224
 v_cvt_pk_bf16_f32 v180, v224, v225
 v_add_f32 v230, v230, v225
 v_exp_f32 v224, v140
 v_mfma_f32_32x32x16_bf16 v[112:127], a[176:179], v[72:75], v[112:127]
 buffer_load_dwordx4 v14, s[32:35], s56 offen offset:2048 sc1 lds
 v_exp_f32 v225, v141
 v_add_f32 v230, v230, v226
 v_cvt_pk_bf16_f32 v181, v226, v227
 v_mfma_f32_32x32x16_bf16 v[112:127], a[180:183], v[88:91], v[112:127]
 ds_read_b128 a[144:147], v24 offset:4096
 v_add_f32 v230, v230, v227
 v_exp_f32 v226, v142
 v_exp_f32 v227, v143
 v_mfma_f32_32x32x16_bf16 v[112:127], a[184:187], v[76:79], v[112:127]
 v_add_f32 v230, v230, v224
 v_cvt_pk_bf16_f32 v182, v224, v225
 v_add_f32 v230, v230, v225
 v_exp_f32 v224, v144
 s_waitcnt lgkmcnt(2)
 v_mfma_f32_32x32x16_bf16 v[112:127], a[188:191], v[92:95], v[112:127]
 ds_read_b128 a[148:151], v24 offset:5120
 buffer_load_dwordx4 v14, s[32:35], s56 offen offset:3072 sc1 lds
 v_exp_f32 v225, v145
 v_add_f32 v230, v230, v226
 v_mfma_f32_32x32x16_bf16 a[0:15], a[128:131], v[160:163], a[0:15]
 v_cvt_pk_bf16_f32 v183, v226, v227
 v_add_f32 v230, v230, v227
 v_exp_f32 v226, v146
 v_exp_f32 v227, v147
 v_mfma_f32_32x32x16_bf16 a[64:79], a[128:131], v[168:171], a[64:79]
 ds_read_b128 a[152:155], v24 offset:6144
 v_add_f32 v231, v229, v224
 v_cvt_pk_bf16_f32 v184, v224, v225
 v_add_f32 v231, v231, v225
 v_mfma_f32_32x32x16_bf16 a[16:31], a[132:135], v[160:163], a[16:31]
 s_mov_b32 m0, s91
 v_exp_f32 v224, v148
 v_exp_f32 v225, v149
 v_mfma_f32_32x32x16_bf16 a[80:95], a[132:135], v[168:171], a[80:95]
 ds_read_b128 a[156:159], v24 offset:7168
 v_add_f32 v231, v231, v226
 v_cvt_pk_bf16_f32 v185, v226, v227
 v_add_f32 v231, v231, v227
 v_mfma_f32_32x32x16_bf16 a[32:47], a[136:139], v[160:163], a[32:47]
 s_lshl_b32 s19, s18, 1
 s_add_u32 s19, s19, 1
 s_cmp_ge_u32 s19, s94
 s_cbranch_scc1 M_parall_49
MB_parall_50:
 s_waitcnt vmcnt(12)
 s_barrier
 v_mfma_f32_32x32x16_bf16 a[96:111], a[136:139], v[168:171], a[96:111]
 ds_read_b128 a[160:163], v23 offset:16384
 s_add_u32 s56, s90, 4294950912
 v_exp_f32 v226, v150
 s_waitcnt lgkmcnt(3)
 v_mfma_f32_32x32x16_bf16 a[48:63], a[140:143], v[160:163], a[48:63]
 ds_read_b128 a[164:167], v23 offset:17408
 v_exp_f32 v227, v151
 v_add_f32 v231, v231, v224
 v_cvt_pk_bf16_f32 v186, v224, v225
 v_add_f32 v231, v231, v225
 v_mfma_f32_32x32x16_bf16 a[112:127], a[140:143], v[168:171], a[112:127]
 ds_read_b128 a[168:171], v23 offset:18432
 v_exp_f32 v224, v152
 v_exp_f32 v225, v153
 v_add_f32 v231, v231, v226
 v_mfma_f32_32x32x16_bf16 a[0:15], a[144:147], v[164:167], a[0:15]
 ds_read_b128 a[172:175], v23 offset:19456
 buffer_load_dwordx4 v14, s[32:35], s56 offen offset:0 sc1 lds
 v_cvt_pk_bf16_f32 v187, v226, v227
 v_add_f32 v231, v231, v227
 v_mfma_f32_32x32x16_bf16 a[64:79], a[144:147], v[172:175], a[64:79]
 ds_read_b128 a[176:179], v23 offset:20480
 v_exp_f32 v226, v154
 v_exp_f32 v227, v155
 v_add_f32 v231, v231, v224
 v_mfma_f32_32x32x16_bf16 a[16:31], a[148:151], v[164:167], a[16:31]
 ds_read_b128 a[180:183], v23 offset:21504
 v_cvt_pk_bf16_f32 v188, v224, v225
 v_add_f32 v231, v231, v225
 v_exp_f32 v224, v156
 v_mfma_f32_32x32x16_bf16 a[80:95], a[148:151], v[172:175], a[80:95]
 ds_read_b128 a[184:187], v23 offset:22528
 buffer_load_dwordx4 v14, s[32:35], s56 offen offset:1024 sc1 lds
 v_exp_f32 v225, v157
 s_waitcnt lgkmcnt(5)
 v_mfma_f32_32x32x16_bf16 a[32:47], a[152:155], v[164:167], a[32:47]
 ds_read_b128 a[188:191], v23 offset:23552
 v_add_f32 v231, v231, v226
 v_cvt_pk_bf16_f32 v189, v226, v227
 v_add_f32 v231, v231, v227
 v_exp_f32 v226, v158
 v_mfma_f32_32x32x16_bf16 a[96:111], a[152:155], v[172:175], a[96:111]
 ds_read_b128 a[128:131], v23 offset:24576
 v_exp_f32 v227, v159
 v_add_f32 v231, v231, v224
 v_cvt_pk_bf16_f32 v190, v224, v225
 v_add_f32 v231, v231, v225
 v_mfma_f32_32x32x16_bf16 a[48:63], a[156:159], v[164:167], a[48:63]
 ds_read_b128 a[132:135], v23 offset:25600
 buffer_load_dwordx4 v14, s[32:35], s56 offen offset:2048 sc1 lds
 v_add_f32 v231, v231, v226
 v_cvt_pk_bf16_f32 v191, v226, v227
 v_add_f32 v231, v231, v227
 v_mfma_f32_32x32x16_bf16 a[112:127], a[156:159], v[172:175], a[112:127]
 v_max_f32 v232, v230, v231
 v_cmp_lt_f32 vcc, s14, v232
 s_cbranch_vccnz C_parall_51
CB_parall_52:
 v_mfma_f32_32x32x16_bf16 v[128:143], a[160:163], v[64:67], v[208:223]
 ds_read_b128 a[136:139], v23 offset:26624
 ds_read_b128 a[140:143], v23 offset:27648
 v_exp_f32 v224, v96
 v_exp_f32 v225, v97
 v_mfma_f32_32x32x16_bf16 v[128:143], a[164:167], v[80:83], v[128:143]
 ds_read_b128 a[144:147], v23 offset:28672
 buffer_load_dwordx4 v14, s[32:35], s56 offen offset:3072 sc1 lds
 v_exp_f32 v226, v98
 s_waitcnt lgkmcnt(5)
 v_mfma_f32_32x32x16_bf16 v[128:143], a[168:171], v[68:71], v[128:143]
 ds_read_b128 a[148:151], v23 offset:29696
 v_exp_f32 v227, v99
 v_add_f32 v229, v231, v224
 v_cvt_pk_bf16_f32 v160, v224, v225
 v_add_f32 v229, v229, v225
 v_mfma_f32_32x32x16_bf16 v[128:143], a[172:175], v[84:87], v[128:143]
 ds_read_b128 a[152:155], v23 offset:30720
 v_exp_f32 v224, v100
 v_exp_f32 v225, v101
 v_mfma_f32_32x32x16_bf16 v[128:143], a[176:179], v[72:75], v[128:143]
 ds_read_b128 a[156:159], v23 offset:31744
 v_add_f32 v229, v229, v226
 v_cvt_pk_bf16_f32 v161, v226, v227
 v_add_f32 v229, v229, v227
 v_exp_f32 v226, v102
 v_mfma_f32_32x32x16_bf16 v[128:143], a[180:183], v[88:91], v[128:143]
 ds_read_b128 a[160:163], v24 offset:8192
 v_exp_f32 v227, v103
 v_add_f32 v229, v229, v224
 v_mfma_f32_32x32x16_bf16 v[128:143], a[184:187], v[76:79], v[128:143]
 v_cvt_pk_bf16_f32 v162, v224, v225
 v_add_f32 v229, v229, v225
 v_exp_f32 v224, v104
 v_mfma_f32_32x32x16_bf16 v[128:143], a[188:191], v[92:95], v[128:143]
 ds_read_b128 a[164:167], v24 offset:9216
 v_exp_f32 v225, v105
 v_add_f32 v229, v229, v226
 s_waitcnt lgkmcnt(4)
 v_mfma_f32_32x32x16_bf16 v[144:159], a[128:131], v[64:67], v[208:223]
 v_cvt_pk_bf16_f32 v163, v226, v227
 v_add_f32 v229, v229, v227
 v_exp_f32 v226, v106
 v_mfma_f32_32x32x16_bf16 v[144:159], a[132:135], v[80:83], v[144:159]
 ds_read_b128 a[168:171], v24 offset:10240
 v_exp_f32 v227, v107
 v_add_f32 v229, v229, v224
 v_mfma_f32_32x32x16_bf16 v[144:159], a[136:139], v[68:71], v[144:159]
 v_cvt_pk_bf16_f32 v164, v224, v225
 v_add_f32 v229, v229, v225
 v_exp_f32 v224, v108
 v_mfma_f32_32x32x16_bf16 v[144:159], a[140:143], v[84:87], v[144:159]
 ds_read_b128 a[172:175], v24 offset:11264
 v_exp_f32 v225, v109
 v_add_f32 v229, v229, v226
 v_cvt_pk_bf16_f32 v165, v226, v227
 v_mfma_f32_32x32x16_bf16 v[144:159], a[144:147], v[72:75], v[144:159]
 v_add_f32 v229, v229, v227
 v_exp_f32 v226, v110
 v_mfma_f32_32x32x16_bf16 v[144:159], a[148:151], v[88:91], v[144:159]
 ds_read_b128 a[176:179], v24 offset:12288
 v_exp_f32 v227, v111
 v_add_f32 v229, v229, v224
 v_cvt_pk_bf16_f32 v166, v224, v225
 s_waitcnt lgkmcnt(3)
 v_mfma_f32_32x32x16_bf16 v[144:159], a[152:155], v[76:79], v[144:159]
 v_add_f32 v229, v229, v225
 v_exp_f32 v224, v112
 v_exp_f32 v225, v113
 v_mfma_f32_32x32x16_bf16 v[144:159], a[156:159], v[92:95], v[144:159]
 ds_read_b128 a[180:183], v24 offset:13312
 v_add_f32 v229, v229, v226
 v_cvt_pk_bf16_f32 v167, v226, v227
 v_mfma_f32_32x32x16_bf16 a[0:15], a[160:163], v[176:179], a[0:15]
 v_add_f32 v229, v229, v227
 v_exp_f32 v226, v114
 v_exp_f32 v227, v115
 v_mfma_f32_32x32x16_bf16 a[64:79], a[160:163], v[184:187], a[64:79]
 ds_read_b128 a[184:187], v24 offset:14336
 v_add_f32 v229, v229, v224
 v_cvt_pk_bf16_f32 v168, v224, v225
 v_add_f32 v229, v229, v225
 v_mfma_f32_32x32x16_bf16 a[16:31], a[164:167], v[176:179], a[16:31]
 ds_read_b128 a[188:191], v24 offset:15360
 v_exp_f32 v224, v116
 v_exp_f32 v225, v117
 v_mfma_f32_32x32x16_bf16 a[80:95], a[164:167], v[184:187], a[80:95]
 v_add_f32 v229, v229, v226
 v_cvt_pk_bf16_f32 v169, v226, v227
 v_add_f32 v229, v229, v227
 s_waitcnt lgkmcnt(3)
 v_mfma_f32_32x32x16_bf16 a[32:47], a[168:171], v[176:179], a[32:47]
 s_lshl_b32 s19, s18, 1
 s_add_u32 s19, s19, 3
 s_cmp_ge_u32 s19, s94
 s_cbranch_scc1 M_parall_53
MB_parall_54:
 v_mfma_f32_32x32x16_bf16 a[96:111], a[168:171], v[184:187], a[96:111]
 v_xor_b32 v24, 0x18000, v23
 v_xor_b32 v23, 0x8000, v23
 v_exp_f32 v226, v118
 v_exp_f32 v227, v119
 v_mfma_f32_32x32x16_bf16 a[48:63], a[172:175], v[176:179], a[48:63]
 s_waitcnt vmcnt(0) lgkmcnt(0)
 s_barrier
 ds_read_b128 a[128:131], v23 offset:0
 s_xor_b32 s91, s91, 0x8000
 ds_read_b128 a[132:135], v23 offset:1024
 v_add_f32 v229, v229, v224
 v_mfma_f32_32x32x16_bf16 a[112:127], a[172:175], v[184:187], a[112:127]
 ds_read_b128 a[136:139], v23 offset:2048
 s_add_u32 s90, s90, 65536
 v_cvt_pk_bf16_f32 v170, v224, v225
 v_add_f32 v229, v229, v225
 v_exp_f32 v224, v120
 v_mfma_f32_32x32x16_bf16 a[0:15], a[176:179], v[180:183], a[0:15]
 ds_read_b128 a[140:143], v23 offset:3072
 s_add_u32 s18, s18, 2
 v_exp_f32 v225, v121
 v_add_f32 v229, v229, v226
 v_cvt_pk_bf16_f32 v171, v226, v227
 v_mfma_f32_32x32x16_bf16 a[64:79], a[176:179], v[188:191], a[64:79]
 ds_read_b128 a[144:147], v23 offset:4096
 s_or_b32 m0, s91, 0x10000
 v_add_f32 v229, v229, v227
 v_exp_f32 v226, v122
 v_mfma_f32_32x32x16_bf16 a[16:31], a[180:183], v[180:183], a[16:31]
 ds_read_b128 a[148:151], v23 offset:5120
 v_exp_f32 v227, v123
 v_add_f32 v229, v229, v224
 v_cvt_pk_bf16_f32 v172, v224, v225
 v_add_f32 v229, v229, v225
 v_mfma_f32_32x32x16_bf16 a[80:95], a[180:183], v[188:191], a[80:95]
 buffer_load_dwordx4 v14, s[32:35], s90 offen offset:0 sc1 lds
 v_exp_f32 v224, v124
 v_exp_f32 v225, v125
 v_mfma_f32_32x32x16_bf16 a[32:47], a[184:187], v[180:183], a[32:47]
 buffer_load_dwordx4 v14, s[32:35], s90 offen offset:1024 sc1 lds
 v_add_f32 v229, v229, v226
 v_cvt_pk_bf16_f32 v173, v226, v227
 v_add_f32 v229, v229, v227
 v_mfma_f32_32x32x16_bf16 a[96:111], a[184:187], v[188:191], a[96:111]
 buffer_load_dwordx4 v14, s[32:35], s90 offen offset:2048 sc1 lds
 v_exp_f32 v226, v126
 v_exp_f32 v227, v127
 v_mfma_f32_32x32x16_bf16 a[48:63], a[188:191], v[180:183], a[48:63]
 buffer_load_dwordx4 v14, s[32:35], s90 offen offset:3072 sc1 lds
 v_add_f32 v229, v229, v224
 v_cvt_pk_bf16_f32 v174, v224, v225
 v_add_f32 v229, v229, v225
 v_add_f32 v229, v229, v226
 v_mfma_f32_32x32x16_bf16 a[112:127], a[188:191], v[188:191], a[112:127]
 v_cvt_pk_bf16_f32 v175, v226, v227
 v_add_f32 v229, v229, v227
 v_cmp_lt_f32 vcc, s14, v229
 s_cbranch_vccnz C_parall_55
CB_parall_56:
 s_cmp_gt_u32 s18, s95
 s_cbranch_scc1 L_drain_s
L_single_s:
 s_waitcnt lgkmcnt(5)
 v_mfma_f32_32x32x16_bf16 v[96:111], a[128:131], v[64:67], v[208:223]
 ds_read_b128 a[152:155], v23 offset:6144
 ds_read_b128 a[156:159], v23 offset:7168
 ds_read_b128 a[160:163], v23 offset:8192
 v_exp_f32 v224, v128
 s_waitcnt lgkmcnt(7)
 v_mfma_f32_32x32x16_bf16 v[96:111], a[132:135], v[80:83], v[96:111]
 s_add_u32 m0, s91, 0x14000
 ds_read_b128 a[164:167], v23 offset:9216
 ds_read_b128 a[168:171], v23 offset:10240
 ds_read_b128 a[172:175], v23 offset:11264
 s_waitcnt lgkmcnt(9)
 v_mfma_f32_32x32x16_bf16 v[96:111], a[136:139], v[68:71], v[96:111]
 ds_read_b128 a[176:179], v23 offset:12288
 ds_read_b128 a[180:183], v23 offset:13312
 s_add_u32 s56, s90, 32768
 v_exp_f32 v225, v129
 s_waitcnt lgkmcnt(10)
 v_mfma_f32_32x32x16_bf16 v[96:111], a[140:143], v[84:87], v[96:111]
 ds_read_b128 a[184:187], v23 offset:14336
 v_exp_f32 v226, v130
 v_exp_f32 v227, v131
 s_waitcnt lgkmcnt(10)
 v_mfma_f32_32x32x16_bf16 v[96:111], a[144:147], v[72:75], v[96:111]
 ds_read_b128 a[188:191], v23 offset:15360
 buffer_load_dwordx4 v14, s[32:35], s56 offen offset:0 sc1 lds
 v_add_f32 v231, v229, v224
 v_cvt_pk_bf16_f32 v176, v224, v225
 s_waitcnt lgkmcnt(10)
 v_mfma_f32_32x32x16_bf16 v[96:111], a[148:151], v[88:91], v[96:111]
 ds_read_b128 a[128:131], v24 offset:16384
 v_add_f32 v231, v231, v225
 v_exp_f32 v224, v132
 s_waitcnt lgkmcnt(8)
 v_mfma_f32_32x32x16_bf16 v[96:111], a[152:155], v[76:79], v[96:111]
 ds_read_b128 a[132:135], v24 offset:17408
 buffer_load_dwordx4 v14, s[32:35], s56 offen offset:1024 sc1 lds
 v_exp_f32 v225, v133
 v_add_f32 v231, v231, v226
 v_mfma_f32_32x32x16_bf16 v[96:111], a[156:159], v[92:95], v[96:111]
 ds_read_b128 a[136:139], v24 offset:18432
 v_cvt_pk_bf16_f32 v177, v226, v227
 v_add_f32 v231, v231, v227
 v_exp_f32 v226, v134
 v_mfma_f32_32x32x16_bf16 v[112:127], a[160:163], v[64:67], v[208:223]
 ds_read_b128 a[140:143], v24 offset:19456
 buffer_load_dwordx4 v14, s[32:35], s56 offen offset:2048 sc1 lds
 v_exp_f32 v227, v135
 s_waitcnt lgkmcnt(5)
 v_mfma_f32_32x32x16_bf16 v[112:127], a[164:167], v[80:83], v[112:127]
 ds_read_b128 a[144:147], v24 offset:20480
 v_add_f32 v231, v231, v224
 v_cvt_pk_bf16_f32 v178, v224, v225
 v_add_f32 v231, v231, v225
 v_exp_f32 v224, v136
 v_mfma_f32_32x32x16_bf16 v[112:127], a[168:171], v[68:71], v[112:127]
 ds_read_b128 a[148:151], v24 offset:21504
 buffer_load_dwordx4 v14, s[32:35], s56 offen offset:3072 sc1 lds
 v_exp_f32 v225, v137
 v_add_f32 v231, v231, v226
 v_mfma_f32_32x32x16_bf16 v[112:127], a[172:175], v[84:87], v[112:127]
 ds_read_b128 a[152:155], v24 offset:22528
 v_cvt_pk_bf16_f32 v179, v226, v227
 v_add_f32 v231, v231, v227
 v_exp_f32 v226, v138
 v_mfma_f32_32x32x16_bf16 v[112:127], a[176:179], v[72:75], v[112:127]
 ds_read_b128 a[156:159], v24 offset:23552
 s_xor_b32 m0, s91, 0x4000
 v_exp_f32 v227, v139
 v_add_f32 v231, v231, v224
 v_cvt_pk_bf16_f32 v180, v224, v225
 v_mfma_f32_32x32x16_bf16 v[112:127], a[180:183], v[88:91], v[112:127]
 ds_read_b128 a[160:163], v24 offset:24576
 v_add_f32 v231, v231, v225
 v_exp_f32 v224, v140
 v_exp_f32 v225, v141
 v_mfma_f32_32x32x16_bf16 v[112:127], a[184:187], v[76:79], v[112:127]
 ds_read_b128 a[164:167], v24 offset:25600
 s_add_u32 s56, s90, 4294918144
 v_add_f32 v231, v231, v226
 v_cvt_pk_bf16_f32 v181, v226, v227
 v_add_f32 v231, v231, v227
 s_waitcnt lgkmcnt(5)
 v_mfma_f32_32x32x16_bf16 v[112:127], a[188:191], v[92:95], v[112:127]
 ds_read_b128 a[168:171], v24 offset:26624
 v_exp_f32 v226, v142
 v_exp_f32 v227, v143
 v_add_f32 v231, v231, v224
 v_mfma_f32_32x32x16_bf16 a[64:79], a[128:131], v[160:163], a[64:79]
 ds_read_b128 a[172:175], v24 offset:27648
 buffer_load_dwordx4 v14, s[32:35], s56 offen offset:0 sc1 lds
 v_cvt_pk_bf16_f32 v182, v224, v225
 v_add_f32 v231, v231, v225
 v_mfma_f32_32x32x16_bf16 a[80:95], a[132:135], v[160:163], a[80:95]
 ds_read_b128 a[176:179], v24 offset:28672
 v_exp_f32 v224, v144
 v_exp_f32 v225, v145
 v_add_f32 v231, v231, v226
 v_mfma_f32_32x32x16_bf16 a[96:111], a[136:139], v[160:163], a[96:111]
 ds_read_b128 a[180:183], v24 offset:29696
 buffer_load_dwordx4 v14, s[32:35], s56 offen offset:1024 sc1 lds
 v_cvt_pk_bf16_f32 v183, v226, v227
 v_add_f32 v231, v231, v227
 v_mfma_f32_32x32x16_bf16 a[112:127], a[140:143], v[160:163], a[112:127]
 ds_read_b128 a[184:187], v24 offset:30720
 v_exp_f32 v226, v146
 v_exp_f32 v227, v147
 v_add_f32 v231, v231, v224
 v_mfma_f32_32x32x16_bf16 a[64:79], a[144:147], v[164:167], a[64:79]
 v_cvt_pk_bf16_f32 v184, v224, v225
 v_add_f32 v231, v231, v225
 v_exp_f32 v224, v148
 s_waitcnt lgkmcnt(4)
 v_mfma_f32_32x32x16_bf16 a[80:95], a[148:151], v[164:167], a[80:95]
 s_lshl_b32 s19, s18, 1
 s_add_u32 s19, s19, 1
 s_cmp_ge_u32 s19, s94
 s_cbranch_scc1 M_parall_57
MB_parall_58:
 v_mfma_f32_32x32x16_bf16 a[96:111], a[152:155], v[164:167], a[96:111]
 ds_read_b128 a[188:191], v24 offset:31744
 buffer_load_dwordx4 v14, s[32:35], s56 offen offset:2048 sc1 lds
 ds_read_b128 a[128:131], v23 offset:16384
 ds_read_b128 a[132:135], v23 offset:17408
 v_mfma_f32_32x32x16_bf16 a[112:127], a[156:159], v[164:167], a[112:127]
 buffer_load_dwordx4 v14, s[32:35], s56 offen offset:3072 sc1 lds
 ds_read_b128 a[136:139], v23 offset:18432
 v_exp_f32 v225, v149
 v_add_f32 v231, v231, v226
 v_mfma_f32_32x32x16_bf16 a[64:79], a[160:163], v[168:171], a[64:79]
 ds_read_b128 a[140:143], v23 offset:19456
 s_mov_b32 m0, s91
 v_cvt_pk_bf16_f32 v185, v226, v227
 v_add_f32 v231, v231, v227
 v_exp_f32 v226, v150
 v_mfma_f32_32x32x16_bf16 a[80:95], a[164:167], v[168:171], a[80:95]
 ds_read_b128 a[144:147], v23 offset:20480
 v_exp_f32 v227, v151
 v_add_f32 v231, v231, v224
 v_cvt_pk_bf16_f32 v186, v224, v225
 v_add_f32 v231, v231, v225
 v_mfma_f32_32x32x16_bf16 a[96:111], a[168:171], v[168:171], a[96:111]
 ds_read_b128 a[148:151], v23 offset:21504
 s_add_u32 s56, s90, 4294950912
 v_exp_f32 v224, v152
 s_waitcnt lgkmcnt(7)
 v_mfma_f32_32x32x16_bf16 a[112:127], a[172:175], v[168:171], a[112:127]
 ds_read_b128 a[152:155], v23 offset:22528
 v_exp_f32 v225, v153
 v_add_f32 v231, v231, v226
 v_cvt_pk_bf16_f32 v187, v226, v227
 v_add_f32 v231, v231, v227
 v_mfma_f32_32x32x16_bf16 a[64:79], a[176:179], v[172:175], a[64:79]
 ds_read_b128 a[156:159], v23 offset:23552
 buffer_load_dwordx4 v14, s[32:35], s56 offen offset:0 sc1 lds
 v_exp_f32 v226, v154
 v_mfma_f32_32x32x16_bf16 a[80:95], a[180:183], v[172:175], a[80:95]
 ds_read_b128 a[160:163], v23 offset:24576
 v_exp_f32 v227, v155
 v_add_f32 v231, v231, v224
 v_cvt_pk_bf16_f32 v188, v224, v225
 v_add_f32 v231, v231, v225
 v_mfma_f32_32x32x16_bf16 a[96:111], a[184:187], v[172:175], a[96:111]
 ds_read_b128 a[164:167], v23 offset:25600
 buffer_load_dwordx4 v14, s[32:35], s56 offen offset:1024 sc1 lds
 v_exp_f32 v224, v156
 s_waitcnt lgkmcnt(5)
 v_mfma_f32_32x32x16_bf16 a[112:127], a[188:191], v[172:175], a[112:127]
 v_exp_f32 v225, v157
 v_add_f32 v231, v231, v226
 v_cvt_pk_bf16_f32 v189, v226, v227
 v_add_f32 v231, v231, v227
 v_exp_f32 v226, v158
 v_exp_f32 v227, v159
 v_add_f32 v231, v231, v224
 v_cvt_pk_bf16_f32 v190, v224, v225
 v_add_f32 v231, v231, v225
 v_add_f32 v231, v231, v226
 v_cvt_pk_bf16_f32 v191, v226, v227
 v_add_f32 v231, v231, v227
 v_cmp_lt_f32 vcc, s14, v231
 s_cbranch_vccnz C_parall_59
CB_parall_60:
 v_mfma_f32_32x32x16_bf16 v[128:143], a[128:131], v[64:67], v[208:223]
 ds_read_b128 a[168:171], v23 offset:26624
 ds_read_b128 a[172:175], v23 offset:27648
 buffer_load_dwordx4 v14, s[32:35], s56 offen offset:2048 sc1 lds
 v_exp_f32 v224, v96
 v_mfma_f32_32x32x16_bf16 v[128:143], a[132:135], v[80:83], v[128:143]
 ds_read_b128 a[176:179], v23 offset:28672
 v_exp_f32 v225, v97
 v_exp_f32 v226, v98
 v_mfma_f32_32x32x16_bf16 v[128:143], a[136:139], v[68:71], v[128:143]
 ds_read_b128 a[180:183], v23 offset:29696
 buffer_load_dwordx4 v14, s[32:35], s56 offen offset:3072 sc1 lds
 v_exp_f32 v227, v99
 v_add_f32 v229, v231, v224
 v_mfma_f32_32x32x16_bf16 v[128:143], a[140:143], v[84:87], v[128:143]
 ds_read_b128 a[184:187], v23 offset:30720
 v_cvt_pk_bf16_f32 v160, v224, v225
 v_add_f32 v229, v229, v225
 v_exp_f32 v224, v100
 v_mfma_f32_32x32x16_bf16 v[128:143], a[144:147], v[72:75], v[128:143]
 ds_read_b128 a[188:191], v23 offset:31744
 v_exp_f32 v225, v101
 v_add_f32 v229, v229, v226
 v_cvt_pk_bf16_f32 v161, v226, v227
 s_waitcnt lgkmcnt(6)
 v_mfma_f32_32x32x16_bf16 v[128:143], a[148:151], v[88:91], v[128:143]
 ds_read_b128 a[128:131], v24 offset:0
 v_add_f32 v229, v229, v227
 v_exp_f32 v226, v102
 v_exp_f32 v227, v103
 v_mfma_f32_32x32x16_bf16 v[128:143], a[152:155], v[76:79], v[128:143]
 ds_read_b128 a[132:135], v24 offset:1024
 v_add_f32 v229, v229, v224
 v_cvt_pk_bf16_f32 v162, v224, v225
 v_add_f32 v229, v229, v225
 v_exp_f32 v224, v104
 v_mfma_f32_32x32x16_bf16 v[128:143], a[156:159], v[92:95], v[128:143]
 ds_read_b128 a[136:139], v24 offset:2048
 v_exp_f32 v225, v105
 v_add_f32 v229, v229, v226
 v_mfma_f32_32x32x16_bf16 v[144:159], a[160:163], v[64:67], v[208:223]
 ds_read_b128 a[140:143], v24 offset:3072
 v_cvt_pk_bf16_f32 v163, v226, v227
 v_add_f32 v229, v229, v227
 v_exp_f32 v226, v106
 v_mfma_f32_32x32x16_bf16 v[144:159], a[164:167], v[80:83], v[144:159]
 ds_read_b128 a[144:147], v24 offset:4096
 v_exp_f32 v227, v107
 v_add_f32 v229, v229, v224
 s_waitcnt lgkmcnt(5)
 v_mfma_f32_32x32x16_bf16 v[144:159], a[168:171], v[68:71], v[144:159]
 ds_read_b128 a[148:151], v24 offset:5120
 v_cvt_pk_bf16_f32 v164, v224, v225
 v_add_f32 v229, v229, v225
 v_exp_f32 v224, v108
 v_mfma_f32_32x32x16_bf16 v[144:159], a[172:175], v[84:87], v[144:159]
 ds_read_b128 a[152:155], v24 offset:6144
 v_exp_f32 v225, v109
 v_add_f32 v229, v229, v226
 v_cvt_pk_bf16_f32 v165, v226, v227
 v_mfma_f32_32x32x16_bf16 v[144:159], a[176:179], v[72:75], v[144:159]
 ds_read_b128 a[156:159], v24 offset:7168
 v_add_f32 v229, v229, v227
 v_exp_f32 v226, v110
 v_mfma_f32_32x32x16_bf16 v[144:159], a[180:183], v[88:91], v[144:159]
 ds_read_b128 a[160:163], v24 offset:8192
 v_exp_f32 v227, v111
 v_add_f32 v229, v229, v224
 v_cvt_pk_bf16_f32 v166, v224, v225
 v_mfma_f32_32x32x16_bf16 v[144:159], a[184:187], v[76:79], v[144:159]
 ds_read_b128 a[164:167], v24 offset:9216
 v_add_f32 v229, v229, v225
 v_exp_f32 v224, v112
 v_exp_f32 v225, v113
 v_mfma_f32_32x32x16_bf16 v[144:159], a[188:191], v[92:95], v[144:159]
 ds_read_b128 a[168:171], v24 offset:10240
 v_add_f32 v229, v229, v226
 v_cvt_pk_bf16_f32 v167, v226, v227
 s_waitcnt lgkmcnt(5)
 v_mfma_f32_32x32x16_bf16 a[64:79], a[128:131], v[176:179], a[64:79]
 ds_read_b128 a[172:175], v24 offset:11264
 v_add_f32 v229, v229, v227
 v_exp_f32 v226, v114
 v_exp_f32 v227, v115
 v_mfma_f32_32x32x16_bf16 a[80:95], a[132:135], v[176:179], a[80:95]
 ds_read_b128 a[176:179], v24 offset:12288
 v_add_f32 v229, v229, v224
 v_cvt_pk_bf16_f32 v168, v224, v225
 v_add_f32 v229, v229, v225
 v_mfma_f32_32x32x16_bf16 a[96:111], a[136:139], v[176:179], a[96:111]
 ds_read_b128 a[180:183], v24 offset:13312
 ds_read_b128 a[184:187], v24 offset:14336
 ds_read_b128 a[188:191], v24 offset:15360
 v_exp_f32 v224, v116
 v_mfma_f32_32x32x16_bf16 a[112:127], a[140:143], v[176:179], a[112:127]
 s_lshl_b32 s19, s18, 1
 s_add_u32 s19, s19, 3
 s_cmp_ge_u32 s19, s94
 s_cbranch_scc1 M_parall_61
MB_parall_62:
 v_mfma_f32_32x32x16_bf16 a[64:79], a[144:147], v[180:183], a[64:79]
 v_xor_b32 v24, 0x18000, v23
 v_xor_b32 v23, 0x8000, v23
 v_exp_f32 v225, v117
 v_add_f32 v229, v229, v226
 v_cvt_pk_bf16_f32 v169, v226, v227
 v_mfma_f32_32x32x16_bf16 a[80:95], a[148:151], v[180:183], a[80:95]
 v_add_f32 v229, v229, v227
 v_exp_f32 v226, v118
 v_exp_f32 v227, v119
 s_waitcnt lgkmcnt(4)
 v_mfma_f32_32x32x16_bf16 a[96:111], a[152:155], v[180:183], a[96:111]
 s_waitcnt vmcnt(0) lgkmcnt(0)
 s_barrier
 ds_read_b128 a[128:131], v23 offset:0
 s_xor_b32 s91, s91, 0x8000
 ds_read_b128 a[132:135], v23 offset:1024
 v_add_f32 v229, v229, v224
 v_mfma_f32_32x32x16_bf16 a[112:127], a[156:159], v[180:183], a[112:127]
 ds_read_b128 a[136:139], v23 offset:2048
 s_add_u32 s90, s90, 65536
 v_cvt_pk_bf16_f32 v170, v224, v225
 v_add_f32 v229, v229, v225
 v_exp_f32 v224, v120
 v_mfma_f32_32x32x16_bf16 a[64:79], a[160:163], v[184:187], a[64:79]
 ds_read_b128 a[140:143], v23 offset:3072
 s_add_u32 s18, s18, 2
 v_exp_f32 v225, v121
 v_add_f32 v229, v229, v226
 v_cvt_pk_bf16_f32 v171, v226, v227
 v_mfma_f32_32x32x16_bf16 a[80:95], a[164:167], v[184:187], a[80:95]
 ds_read_b128 a[144:147], v23 offset:4096
 s_or_b32 m0, s91, 0x10000
 v_add_f32 v229, v229, v227
 v_exp_f32 v226, v122
 v_mfma_f32_32x32x16_bf16 a[96:111], a[168:171], v[184:187], a[96:111]
 ds_read_b128 a[148:151], v23 offset:5120
 v_exp_f32 v227, v123
 v_add_f32 v229, v229, v224
 v_cvt_pk_bf16_f32 v172, v224, v225
 v_add_f32 v229, v229, v225
 v_mfma_f32_32x32x16_bf16 a[112:127], a[172:175], v[184:187], a[112:127]
 buffer_load_dwordx4 v14, s[32:35], s90 offen offset:0 sc1 lds
 v_exp_f32 v224, v124
 v_exp_f32 v225, v125
 v_mfma_f32_32x32x16_bf16 a[64:79], a[176:179], v[188:191], a[64:79]
 buffer_load_dwordx4 v14, s[32:35], s90 offen offset:1024 sc1 lds
 v_add_f32 v229, v229, v226
 v_cvt_pk_bf16_f32 v173, v226, v227
 v_add_f32 v229, v229, v227
 v_mfma_f32_32x32x16_bf16 a[80:95], a[180:183], v[188:191], a[80:95]
 buffer_load_dwordx4 v14, s[32:35], s90 offen offset:2048 sc1 lds
 v_exp_f32 v226, v126
 v_exp_f32 v227, v127
 v_mfma_f32_32x32x16_bf16 a[96:111], a[184:187], v[188:191], a[96:111]
 buffer_load_dwordx4 v14, s[32:35], s90 offen offset:3072 sc1 lds
 v_add_f32 v229, v229, v224
 v_cvt_pk_bf16_f32 v174, v224, v225
 v_add_f32 v229, v229, v225
 v_add_f32 v229, v229, v226
 v_mfma_f32_32x32x16_bf16 a[112:127], a[188:191], v[188:191], a[112:127]
 v_cvt_pk_bf16_f32 v175, v226, v227
 v_add_f32 v229, v229, v227
 v_cmp_lt_f32 vcc, s14, v229
 s_cbranch_vccnz C_parall_63
CB_parall_64:
 s_cmp_le_u32 s18, s95
 s_cbranch_scc1 L_single_s
L_drain_s:
 s_waitcnt vmcnt(0)
 s_barrier
 ds_read_b128 a[160:163], v24 offset:16384
 ds_read_b128 a[164:167], v24 offset:17408
 ds_read_b128 a[168:171], v24 offset:18432
 ds_read_b128 a[172:175], v24 offset:19456
 ds_read_b128 a[176:179], v24 offset:20480
 ds_read_b128 a[180:183], v24 offset:21504
 ds_read_b128 a[184:187], v24 offset:22528
 ds_read_b128 a[188:191], v24 offset:23552
 v_exp_f32 v224, v128
 v_exp_f32 v225, v129
 v_exp_f32 v226, v130
 v_exp_f32 v227, v131
 v_add_f32 v231, v229, v224
 v_cvt_pk_bf16_f32 v176, v224, v225
 v_add_f32 v231, v231, v225
 v_exp_f32 v224, v132
 v_exp_f32 v225, v133
 v_add_f32 v231, v231, v226
 v_cvt_pk_bf16_f32 v177, v226, v227
 v_add_f32 v231, v231, v227
 s_waitcnt lgkmcnt(7)
 v_mfma_f32_32x32x16_bf16 a[64:79], a[160:163], v[160:163], a[64:79]
 ds_read_b128 a[128:131], v24 offset:24576
 v_exp_f32 v226, v134
 v_exp_f32 v227, v135
 s_waitcnt lgkmcnt(7)
 v_mfma_f32_32x32x16_bf16 a[80:95], a[164:167], v[160:163], a[80:95]
 ds_read_b128 a[132:135], v24 offset:25600
 v_add_f32 v231, v231, v224
 v_cvt_pk_bf16_f32 v178, v224, v225
 v_add_f32 v231, v231, v225
 s_waitcnt lgkmcnt(7)
 v_mfma_f32_32x32x16_bf16 a[96:111], a[168:171], v[160:163], a[96:111]
 ds_read_b128 a[136:139], v24 offset:26624
 v_exp_f32 v224, v136
 v_exp_f32 v225, v137
 s_waitcnt lgkmcnt(3)
 v_mfma_f32_32x32x16_bf16 a[112:127], a[172:175], v[160:163], a[112:127]
 ds_read_b128 a[140:143], v24 offset:27648
 v_add_f32 v231, v231, v226
 v_cvt_pk_bf16_f32 v179, v226, v227
 v_add_f32 v231, v231, v227
 v_exp_f32 v226, v138
 v_mfma_f32_32x32x16_bf16 a[64:79], a[176:179], v[164:167], a[64:79]
 ds_read_b128 a[144:147], v24 offset:28672
 v_exp_f32 v227, v139
 v_add_f32 v231, v231, v224
 v_cvt_pk_bf16_f32 v180, v224, v225
 v_add_f32 v231, v231, v225
 v_mfma_f32_32x32x16_bf16 a[80:95], a[180:183], v[164:167], a[80:95]
 ds_read_b128 a[148:151], v24 offset:29696
 v_exp_f32 v224, v140
 v_exp_f32 v225, v141
 v_add_f32 v231, v231, v226
 v_mfma_f32_32x32x16_bf16 a[96:111], a[184:187], v[164:167], a[96:111]
 ds_read_b128 a[152:155], v24 offset:30720
 v_cvt_pk_bf16_f32 v181, v226, v227
 v_add_f32 v231, v231, v227
 v_exp_f32 v226, v142
 v_mfma_f32_32x32x16_bf16 a[112:127], a[188:191], v[164:167], a[112:127]
 ds_read_b128 a[156:159], v24 offset:31744
 v_exp_f32 v227, v143
 v_add_f32 v231, v231, v224
 v_cvt_pk_bf16_f32 v182, v224, v225
 s_waitcnt lgkmcnt(5)
 v_mfma_f32_32x32x16_bf16 a[64:79], a[128:131], v[168:171], a[64:79]
 ds_read_b128 a[160:163], v24 offset:0
 v_add_f32 v231, v231, v225
 v_exp_f32 v224, v144
 v_exp_f32 v225, v145
 v_mfma_f32_32x32x16_bf16 a[80:95], a[132:135], v[168:171], a[80:95]
 ds_read_b128 a[164:167], v24 offset:4096
 v_add_f32 v231, v231, v226
 v_cvt_pk_bf16_f32 v183, v226, v227
 v_add_f32 v231, v231, v227
 v_exp_f32 v226, v146
 v_mfma_f32_32x32x16_bf16 a[96:111], a[136:139], v[168:171], a[96:111]
 ds_read_b128 a[168:171], v24 offset:8192
 v_exp_f32 v227, v147
 v_add_f32 v231, v231, v224
 v_cvt_pk_bf16_f32 v184, v224, v225
 s_waitcnt lgkmcnt(5)
 v_mfma_f32_32x32x16_bf16 a[112:127], a[140:143], v[168:171], a[112:127]
 ds_read_b128 a[172:175], v24 offset:12288
 v_add_f32 v231, v231, v225
 v_exp_f32 v224, v148
 v_exp_f32 v225, v149
 v_mfma_f32_32x32x16_bf16 a[64:79], a[144:147], v[172:175], a[64:79]
 ds_read_b128 a[176:179], v24 offset:1024
 v_add_f32 v231, v231, v226
 v_cvt_pk_bf16_f32 v185, v226, v227
 v_add_f32 v231, v231, v227
 v_exp_f32 v226, v150
 v_mfma_f32_32x32x16_bf16 a[80:95], a[148:151], v[172:175], a[80:95]
 ds_read_b128 a[180:183], v24 offset:5120
 v_exp_f32 v227, v151
 v_add_f32 v231, v231, v224
 v_cvt_pk_bf16_f32 v186, v224, v225
 s_waitcnt lgkmcnt(5)
 v_mfma_f32_32x32x16_bf16 a[96:111], a[152:155], v[172:175], a[96:111]
 ds_read_b128 a[184:187], v24 offset:9216
 v_add_f32 v231, v231, v225
 v_exp_f32 v224, v152
 v_exp_f32 v225, v153
 v_mfma_f32_32x32x16_bf16 a[112:127], a[156:159], v[172:175], a[112:127]
 v_add_f32 v231, v231, v226
 v_cvt_pk_bf16_f32 v187, v226, v227
 v_add_f32 v231, v231, v227
 v_exp_f32 v226, v154
 v_exp_f32 v227, v155
 v_add_f32 v231, v231, v224
 v_cvt_pk_bf16_f32 v188, v224, v225
 v_add_f32 v231, v231, v225
 v_exp_f32 v224, v156
 v_exp_f32 v225, v157
 v_add_f32 v231, v231, v226
 v_cvt_pk_bf16_f32 v189, v226, v227
 v_add_f32 v231, v231, v227
 v_exp_f32 v226, v158
 v_exp_f32 v227, v159
 v_add_f32 v231, v231, v224
 v_cvt_pk_bf16_f32 v190, v224, v225
 v_add_f32 v231, v231, v225
 v_add_f32 v231, v231, v226
 v_cvt_pk_bf16_f32 v191, v226, v227
 v_add_f32 v231, v231, v227
 v_cmp_lt_f32 vcc, s14, v231
 s_cbranch_vccnz C_parall_65
CB_parall_66:
 v_mfma_f32_32x32x16_bf16 a[64:79], a[160:163], v[176:179], a[64:79]
 ds_read_b128 a[188:191], v24 offset:13312
 ds_read_b128 a[128:131], v24 offset:2048
 v_mov_b32 v235, v230
 s_nop 1
 v_permlane32_swap_b32 v230, v235
 s_waitcnt lgkmcnt(2)
 v_mfma_f32_32x32x16_bf16 a[64:79], a[164:167], v[180:183], a[64:79]
 ds_read_b128 a[132:135], v24 offset:6144
 v_add_f32 v230, v230, v235
 v_rcp_f32 v232, v230
 s_mul_i32 s57, s93, 372736
 s_lshl_b32 s58, s84, 12
 v_mfma_f32_32x32x16_bf16 a[64:79], a[168:171], v[184:187], a[64:79]
 ds_read_b128 a[136:139], v24 offset:10240
 s_add_u32 s57, s57, s58
 s_add_u32 s57, s57, 39845888
 v_accvgpr_read_b32 v96, a0
 v_accvgpr_read_b32 v97, a1
 v_accvgpr_read_b32 v98, a2
 v_mfma_f32_32x32x16_bf16 a[64:79], a[172:175], v[188:191], a[64:79]
 ds_read_b128 a[140:143], v24 offset:14336
 v_accvgpr_read_b32 v99, a3
 v_accvgpr_read_b32 v100, a4
 v_accvgpr_read_b32 v101, a5
 v_accvgpr_read_b32 v102, a6
 v_accvgpr_read_b32 v103, a7
 v_mfma_f32_32x32x16_bf16 a[80:95], a[176:179], v[176:179], a[80:95]
 ds_read_b128 a[144:147], v24 offset:3072
 v_accvgpr_read_b32 v104, a8
 v_accvgpr_read_b32 v105, a9
 v_accvgpr_read_b32 v106, a10
 v_accvgpr_read_b32 v107, a11
 v_accvgpr_read_b32 v108, a12
 v_mfma_f32_32x32x16_bf16 a[80:95], a[180:183], v[180:183], a[80:95]
 ds_read_b128 a[148:151], v24 offset:7168
 v_accvgpr_read_b32 v109, a13
 v_accvgpr_read_b32 v110, a14
 v_accvgpr_read_b32 v111, a15
 v_mul_f32 v96, v96, v232
 v_mul_f32 v97, v97, v232
 v_mfma_f32_32x32x16_bf16 a[80:95], a[184:187], v[184:187], a[80:95]
 ds_read_b128 a[152:155], v24 offset:11264
 v_mul_f32 v98, v98, v232
 v_mul_f32 v99, v99, v232
 v_mul_f32 v100, v100, v232
 v_mul_f32 v101, v101, v232
 s_waitcnt lgkmcnt(5)
 v_mfma_f32_32x32x16_bf16 a[80:95], a[188:191], v[188:191], a[80:95]
 ds_read_b128 a[156:159], v24 offset:15360
 v_mul_f32 v102, v102, v232
 v_mul_f32 v103, v103, v232
 v_mul_f32 v104, v104, v232
 v_mul_f32 v105, v105, v232
 v_mul_f32 v106, v106, v232
 v_mfma_f32_32x32x16_bf16 a[96:111], a[128:131], v[176:179], a[96:111]
 v_mul_f32 v107, v107, v232
 v_mul_f32 v108, v108, v232
 v_mul_f32 v109, v109, v232
 v_mul_f32 v110, v110, v232
 v_mul_f32 v111, v111, v232
 v_cvt_pk_bf16_f32 v96, v96, v97
 v_mfma_f32_32x32x16_bf16 a[96:111], a[132:135], v[180:183], a[96:111]
 v_cvt_pk_bf16_f32 v97, v98, v99
 v_cvt_pk_bf16_f32 v98, v100, v101
 v_cvt_pk_bf16_f32 v99, v102, v103
 buffer_store_dwordx4 v[96:99], v25, s[4:7], s57 offen offset:0 sc1
 s_waitcnt lgkmcnt(3)
 v_mfma_f32_32x32x16_bf16 a[96:111], a[136:139], v[184:187], a[96:111]
 v_cvt_pk_bf16_f32 v104, v104, v105
 v_cvt_pk_bf16_f32 v105, v106, v107
 v_cvt_pk_bf16_f32 v106, v108, v109
 v_cvt_pk_bf16_f32 v107, v110, v111
 buffer_store_dwordx4 v[104:107], v25, s[4:7], s57 offen offset:512 sc1
 v_mfma_f32_32x32x16_bf16 a[96:111], a[140:143], v[188:191], a[96:111]
 v_accvgpr_read_b32 v112, a16
 v_accvgpr_read_b32 v113, a17
 v_accvgpr_read_b32 v114, a18
 v_accvgpr_read_b32 v115, a19
 v_accvgpr_read_b32 v116, a20
 v_accvgpr_read_b32 v117, a21
 v_mfma_f32_32x32x16_bf16 a[112:127], a[144:147], v[176:179], a[112:127]
 v_accvgpr_read_b32 v118, a22
 v_accvgpr_read_b32 v119, a23
 v_accvgpr_read_b32 v120, a24
 v_accvgpr_read_b32 v121, a25
 v_accvgpr_read_b32 v122, a26
 s_waitcnt lgkmcnt(0)
 v_mfma_f32_32x32x16_bf16 a[112:127], a[148:151], v[180:183], a[112:127]
 v_accvgpr_read_b32 v123, a27
 v_accvgpr_read_b32 v124, a28
 v_accvgpr_read_b32 v125, a29
 v_accvgpr_read_b32 v126, a30
 v_accvgpr_read_b32 v127, a31
 v_mul_f32 v112, v112, v232
 v_mfma_f32_32x32x16_bf16 a[112:127], a[152:155], v[184:187], a[112:127]
 v_mul_f32 v113, v113, v232
 v_mul_f32 v114, v114, v232
 v_mul_f32 v115, v115, v232
 v_mul_f32 v116, v116, v232
 v_mul_f32 v117, v117, v232
 v_mul_f32 v118, v118, v232
 v_mfma_f32_32x32x16_bf16 a[112:127], a[156:159], v[188:191], a[112:127]
 v_mul_f32 v119, v119, v232
 v_mul_f32 v120, v120, v232
 v_mul_f32 v121, v121, v232
 v_mul_f32 v122, v122, v232
 v_mul_f32 v123, v123, v232
 v_mul_f32 v124, v124, v232
 v_mul_f32 v125, v125, v232
 v_mul_f32 v126, v126, v232
 v_mul_f32 v127, v127, v232
 v_cvt_pk_bf16_f32 v112, v112, v113
 v_cvt_pk_bf16_f32 v113, v114, v115
 v_cvt_pk_bf16_f32 v114, v116, v117
 v_cvt_pk_bf16_f32 v115, v118, v119
 buffer_store_dwordx4 v[112:115], v25, s[4:7], s57 offen offset:1024 sc1
 v_cvt_pk_bf16_f32 v120, v120, v121
 v_cvt_pk_bf16_f32 v121, v122, v123
 v_cvt_pk_bf16_f32 v122, v124, v125
 v_cvt_pk_bf16_f32 v123, v126, v127
 buffer_store_dwordx4 v[120:123], v25, s[4:7], s57 offen offset:1536 sc1
 v_accvgpr_read_b32 v96, a32
 v_accvgpr_read_b32 v97, a33
 v_accvgpr_read_b32 v98, a34
 v_accvgpr_read_b32 v99, a35
 v_accvgpr_read_b32 v100, a36
 v_accvgpr_read_b32 v101, a37
 v_accvgpr_read_b32 v102, a38
 v_accvgpr_read_b32 v103, a39
 v_accvgpr_read_b32 v104, a40
 v_accvgpr_read_b32 v105, a41
 v_accvgpr_read_b32 v106, a42
 v_accvgpr_read_b32 v107, a43
 v_accvgpr_read_b32 v108, a44
 v_accvgpr_read_b32 v109, a45
 v_accvgpr_read_b32 v110, a46
 v_accvgpr_read_b32 v111, a47
 v_mul_f32 v96, v96, v232
 v_mul_f32 v97, v97, v232
 v_mul_f32 v98, v98, v232
 v_mul_f32 v99, v99, v232
 v_mul_f32 v100, v100, v232
 v_mul_f32 v101, v101, v232
 v_mul_f32 v102, v102, v232
 v_mul_f32 v103, v103, v232
 v_mul_f32 v104, v104, v232
 v_mul_f32 v105, v105, v232
 v_mul_f32 v106, v106, v232
 v_mul_f32 v107, v107, v232
 v_mul_f32 v108, v108, v232
 v_mul_f32 v109, v109, v232
 v_mul_f32 v110, v110, v232
 v_mul_f32 v111, v111, v232
 v_cvt_pk_bf16_f32 v96, v96, v97
 v_cvt_pk_bf16_f32 v97, v98, v99
 v_cvt_pk_bf16_f32 v98, v100, v101
 v_cvt_pk_bf16_f32 v99, v102, v103
 buffer_store_dwordx4 v[96:99], v25, s[4:7], s57 offen offset:2048 sc1
 v_cvt_pk_bf16_f32 v104, v104, v105
 v_cvt_pk_bf16_f32 v105, v106, v107
 v_cvt_pk_bf16_f32 v106, v108, v109
 v_cvt_pk_bf16_f32 v107, v110, v111
 buffer_store_dwordx4 v[104:107], v25, s[4:7], s57 offen offset:2560 sc1
 v_accvgpr_read_b32 v112, a48
 v_accvgpr_read_b32 v113, a49
 v_accvgpr_read_b32 v114, a50
 v_accvgpr_read_b32 v115, a51
 v_accvgpr_read_b32 v116, a52
 v_accvgpr_read_b32 v117, a53
 v_accvgpr_read_b32 v118, a54
 v_accvgpr_read_b32 v119, a55
 v_accvgpr_read_b32 v120, a56
 v_accvgpr_read_b32 v121, a57
 v_accvgpr_read_b32 v122, a58
 v_accvgpr_read_b32 v123, a59
 v_accvgpr_read_b32 v124, a60
 v_accvgpr_read_b32 v125, a61
 v_accvgpr_read_b32 v126, a62
 v_accvgpr_read_b32 v127, a63
 v_mul_f32 v112, v112, v232
 v_mul_f32 v113, v113, v232
 v_mul_f32 v114, v114, v232
 v_mul_f32 v115, v115, v232
 v_mul_f32 v116, v116, v232
 v_mul_f32 v117, v117, v232
 v_mul_f32 v118, v118, v232
 v_mul_f32 v119, v119, v232
 v_mul_f32 v120, v120, v232
 v_mul_f32 v121, v121, v232
 v_mul_f32 v122, v122, v232
 v_mul_f32 v123, v123, v232
 v_mul_f32 v124, v124, v232
 v_mul_f32 v125, v125, v232
 v_mul_f32 v126, v126, v232
 v_mul_f32 v127, v127, v232
 v_cvt_pk_bf16_f32 v112, v112, v113
 v_cvt_pk_bf16_f32 v113, v114, v115
 v_cvt_pk_bf16_f32 v114, v116, v117
 v_cvt_pk_bf16_f32 v115, v118, v119
 buffer_store_dwordx4 v[112:115], v25, s[4:7], s57 offen offset:3072 sc1
 v_cvt_pk_bf16_f32 v120, v120, v121
 v_cvt_pk_bf16_f32 v121, v122, v123
 v_cvt_pk_bf16_f32 v122, v124, v125
 v_cvt_pk_bf16_f32 v123, v126, v127
 buffer_store_dwordx4 v[120:123], v25, s[4:7], s57 offen offset:3584 sc1
 s_add_u32 m0, s74, 143360
 s_add_u32 s56, s69, 0
 buffer_load_dwordx4 v14, s[4:7], s56 offen offset:0 sc1 lds
 buffer_load_dwordx4 v14, s[4:7], s56 offen offset:1024 sc1 lds
 buffer_load_dwordx4 v14, s[4:7], s56 offen offset:2048 sc1 lds
 buffer_load_dwordx4 v14, s[4:7], s56 offen offset:3072 sc1 lds
 s_add_u32 m0, s74, 147456
 s_add_u32 s56, s56, 4096
 buffer_load_dwordx4 v14, s[4:7], s56 offen sc1 lds
 s_add_u32 s59, s71, 0
 buffer_load_dwordx4 a[192:195], v2, s[4:7], s73 offen offset:0 sc1
 buffer_load_dwordx4 a[196:199], v3, s[4:7], s73 offen offset:0 sc1
 buffer_load_dwordx4 a[200:203], v2, s[4:7], s59 offen offset:1024 sc1
 buffer_load_dwordx4 a[204:207], v3, s[4:7], s59 offen offset:1024 sc1
 s_add_u32 m0, s74, 81920
 s_add_u32 s56, s69, 20480
 buffer_load_dwordx4 v14, s[4:7], s56 offen offset:0 sc1 lds
 buffer_load_dwordx4 v14, s[4:7], s56 offen offset:1024 sc1 lds
 buffer_load_dwordx4 v14, s[4:7], s56 offen offset:2048 sc1 lds
 buffer_load_dwordx4 v14, s[4:7], s56 offen offset:3072 sc1 lds
 s_add_u32 m0, s74, 86016
 s_add_u32 s56, s56, 4096
 buffer_load_dwordx4 v14, s[4:7], s56 offen sc1 lds
 s_add_u32 s59, s71, 2048
 buffer_load_dwordx4 a[208:211], v2, s[4:7], s59 offen offset:0 sc1
 buffer_load_dwordx4 a[212:215], v3, s[4:7], s59 offen offset:0 sc1
 buffer_load_dwordx4 a[216:219], v2, s[4:7], s59 offen offset:1024 sc1
 buffer_load_dwordx4 a[220:223], v3, s[4:7], s59 offen offset:1024 sc1
 s_add_u32 s59, s71, 4096
 buffer_load_dwordx4 a[224:227], v2, s[4:7], s59 offen offset:0 sc1
 buffer_load_dwordx4 a[228:231], v3, s[4:7], s59 offen offset:0 sc1
 buffer_load_dwordx4 a[232:235], v2, s[4:7], s59 offen offset:1024 sc1
 buffer_load_dwordx4 a[236:239], v3, s[4:7], s59 offen offset:1024 sc1
 s_add_u32 s59, s71, 6144
 buffer_load_dwordx4 a[240:243], v2, s[4:7], s59 offen offset:0 sc1
 buffer_load_dwordx4 a[244:247], v3, s[4:7], s59 offen offset:0 sc1
 buffer_load_dwordx4 a[248:251], v2, s[4:7], s59 offen offset:1024 sc1
 buffer_load_dwordx4 a[252:255], v3, s[4:7], s59 offen offset:1024 sc1
 s_add_u32 m0, s74, 102400
 s_add_u32 s56, s69, 40960
 buffer_load_dwordx4 v14, s[4:7], s56 offen offset:0 sc1 lds
 buffer_load_dwordx4 v14, s[4:7], s56 offen offset:1024 sc1 lds
 buffer_load_dwordx4 v14, s[4:7], s56 offen offset:2048 sc1 lds
 buffer_load_dwordx4 v14, s[4:7], s56 offen offset:3072 sc1 lds
 s_add_u32 m0, s74, 106496
 s_add_u32 s56, s56, 4096
 buffer_load_dwordx4 v14, s[4:7], s56 offen sc1 lds
 s_add_u32 m0, s74, 122880
 s_add_u32 s56, s69, 61440
 buffer_load_dwordx4 v14, s[4:7], s56 offen offset:0 sc1 lds
 buffer_load_dwordx4 v14, s[4:7], s56 offen offset:1024 sc1 lds
 buffer_load_dwordx4 v14, s[4:7], s56 offen offset:2048 sc1 lds
 buffer_load_dwordx4 v14, s[4:7], s56 offen offset:3072 sc1 lds
 s_add_u32 m0, s74, 126976
 s_add_u32 s56, s56, 4096
 buffer_load_dwordx4 v14, s[4:7], s56 offen sc1 lds
 v_mov_b32 v235, v231
 s_nop 1
 v_permlane32_swap_b32 v231, v235
 v_add_f32 v231, v231, v235
 v_rcp_f32 v232, v231
 s_mul_i32 s57, s94, 372736
 s_lshl_b32 s58, s84, 12
 s_add_u32 s57, s57, s58
 s_add_u32 s57, s57, 39845888
 v_accvgpr_read_b32 v128, a64
 v_accvgpr_read_b32 v129, a65
 v_accvgpr_read_b32 v130, a66
 v_accvgpr_read_b32 v131, a67
 v_accvgpr_read_b32 v132, a68
 v_accvgpr_read_b32 v133, a69
 v_accvgpr_read_b32 v134, a70
 v_accvgpr_read_b32 v135, a71
 v_accvgpr_read_b32 v136, a72
 v_accvgpr_read_b32 v137, a73
 v_accvgpr_read_b32 v138, a74
 v_accvgpr_read_b32 v139, a75
 v_accvgpr_read_b32 v140, a76
 v_accvgpr_read_b32 v141, a77
 v_accvgpr_read_b32 v142, a78
 v_accvgpr_read_b32 v143, a79
 v_mul_f32 v128, v128, v232
 v_mul_f32 v129, v129, v232
 v_mul_f32 v130, v130, v232
 v_mul_f32 v131, v131, v232
 v_mul_f32 v132, v132, v232
 v_mul_f32 v133, v133, v232
 v_mul_f32 v134, v134, v232
 v_mul_f32 v135, v135, v232
 v_mul_f32 v136, v136, v232
 v_mul_f32 v137, v137, v232
 v_mul_f32 v138, v138, v232
 v_mul_f32 v139, v139, v232
 v_mul_f32 v140, v140, v232
 v_mul_f32 v141, v141, v232
 v_mul_f32 v142, v142, v232
 v_mul_f32 v143, v143, v232
 v_cvt_pk_bf16_f32 v128, v128, v129
 v_cvt_pk_bf16_f32 v129, v130, v131
 v_cvt_pk_bf16_f32 v130, v132, v133
 v_cvt_pk_bf16_f32 v131, v134, v135
 buffer_store_dwordx4 v[128:131], v25, s[4:7], s57 offen offset:0 sc1
 v_cvt_pk_bf16_f32 v136, v136, v137
 v_cvt_pk_bf16_f32 v137, v138, v139
 v_cvt_pk_bf16_f32 v138, v140, v141
 v_cvt_pk_bf16_f32 v139, v142, v143
 buffer_store_dwordx4 v[136:139], v25, s[4:7], s57 offen offset:512 sc1
 v_accvgpr_read_b32 v144, a80
 v_accvgpr_read_b32 v145, a81
 v_accvgpr_read_b32 v146, a82
 v_accvgpr_read_b32 v147, a83
 v_accvgpr_read_b32 v148, a84
 v_accvgpr_read_b32 v149, a85
 v_accvgpr_read_b32 v150, a86
 v_accvgpr_read_b32 v151, a87
 v_accvgpr_read_b32 v152, a88
 v_accvgpr_read_b32 v153, a89
 v_accvgpr_read_b32 v154, a90
 v_accvgpr_read_b32 v155, a91
 v_accvgpr_read_b32 v156, a92
 v_accvgpr_read_b32 v157, a93
 v_accvgpr_read_b32 v158, a94
 v_accvgpr_read_b32 v159, a95
 v_pk_mul_f32 v[144:145], v[144:145], v[232:233] op_sel_hi:[1,0]
 v_pk_mul_f32 v[146:147], v[146:147], v[232:233] op_sel_hi:[1,0]
 v_pk_mul_f32 v[148:149], v[148:149], v[232:233] op_sel_hi:[1,0]
 v_pk_mul_f32 v[150:151], v[150:151], v[232:233] op_sel_hi:[1,0]
 v_pk_mul_f32 v[152:153], v[152:153], v[232:233] op_sel_hi:[1,0]
 v_pk_mul_f32 v[154:155], v[154:155], v[232:233] op_sel_hi:[1,0]
 v_pk_mul_f32 v[156:157], v[156:157], v[232:233] op_sel_hi:[1,0]
 v_pk_mul_f32 v[158:159], v[158:159], v[232:233] op_sel_hi:[1,0]
 v_cvt_pk_bf16_f32 v144, v144, v145
 v_cvt_pk_bf16_f32 v145, v146, v147
 v_cvt_pk_bf16_f32 v146, v148, v149
 v_cvt_pk_bf16_f32 v147, v150, v151
 buffer_store_dwordx4 v[144:147], v25, s[4:7], s57 offen offset:1024 sc1
 v_cvt_pk_bf16_f32 v152, v152, v153
 v_cvt_pk_bf16_f32 v153, v154, v155
 v_cvt_pk_bf16_f32 v154, v156, v157
 v_cvt_pk_bf16_f32 v155, v158, v159
 buffer_store_dwordx4 v[152:155], v25, s[4:7], s57 offen offset:1536 sc1
 v_accvgpr_read_b32 v128, a96
 v_accvgpr_read_b32 v129, a97
 v_accvgpr_read_b32 v130, a98
 v_accvgpr_read_b32 v131, a99
 v_accvgpr_read_b32 v132, a100
 v_accvgpr_read_b32 v133, a101
 v_accvgpr_read_b32 v134, a102
 v_accvgpr_read_b32 v135, a103
 v_accvgpr_read_b32 v136, a104
 v_accvgpr_read_b32 v137, a105
 v_accvgpr_read_b32 v138, a106
 v_accvgpr_read_b32 v139, a107
 v_accvgpr_read_b32 v140, a108
 v_accvgpr_read_b32 v141, a109
 v_accvgpr_read_b32 v142, a110
 v_accvgpr_read_b32 v143, a111
 v_pk_mul_f32 v[128:129], v[128:129], v[232:233] op_sel_hi:[1,0]
 v_pk_mul_f32 v[130:131], v[130:131], v[232:233] op_sel_hi:[1,0]
 v_pk_mul_f32 v[132:133], v[132:133], v[232:233] op_sel_hi:[1,0]
 v_pk_mul_f32 v[134:135], v[134:135], v[232:233] op_sel_hi:[1,0]
 v_pk_mul_f32 v[136:137], v[136:137], v[232:233] op_sel_hi:[1,0]
 v_pk_mul_f32 v[138:139], v[138:139], v[232:233] op_sel_hi:[1,0]
 v_pk_mul_f32 v[140:141], v[140:141], v[232:233] op_sel_hi:[1,0]
 v_pk_mul_f32 v[142:143], v[142:143], v[232:233] op_sel_hi:[1,0]
 v_cvt_pk_bf16_f32 v128, v128, v129
 v_cvt_pk_bf16_f32 v129, v130, v131
 v_cvt_pk_bf16_f32 v130, v132, v133
 v_cvt_pk_bf16_f32 v131, v134, v135
 buffer_store_dwordx4 v[128:131], v25, s[4:7], s57 offen offset:2048 sc1
 v_cvt_pk_bf16_f32 v136, v136, v137
 v_cvt_pk_bf16_f32 v137, v138, v139
 v_cvt_pk_bf16_f32 v138, v140, v141
 v_cvt_pk_bf16_f32 v139, v142, v143
 buffer_store_dwordx4 v[136:139], v25, s[4:7], s57 offen offset:2560 sc1
 v_accvgpr_read_b32 v144, a112
 v_accvgpr_read_b32 v145, a113
 v_accvgpr_read_b32 v146, a114
 v_accvgpr_read_b32 v147, a115
 v_accvgpr_read_b32 v148, a116
 v_accvgpr_read_b32 v149, a117
 v_accvgpr_read_b32 v150, a118
 v_accvgpr_read_b32 v151, a119
 v_accvgpr_read_b32 v152, a120
 v_accvgpr_read_b32 v153, a121
 v_accvgpr_read_b32 v154, a122
 v_accvgpr_read_b32 v155, a123
 v_accvgpr_read_b32 v156, a124
 v_accvgpr_read_b32 v157, a125
 v_accvgpr_read_b32 v158, a126
 v_accvgpr_read_b32 v159, a127
 v_pk_mul_f32 v[144:145], v[144:145], v[232:233] op_sel_hi:[1,0]
 v_pk_mul_f32 v[146:147], v[146:147], v[232:233] op_sel_hi:[1,0]
 v_pk_mul_f32 v[148:149], v[148:149], v[232:233] op_sel_hi:[1,0]
 v_pk_mul_f32 v[150:151], v[150:151], v[232:233] op_sel_hi:[1,0]
 v_pk_mul_f32 v[152:153], v[152:153], v[232:233] op_sel_hi:[1,0]
 v_pk_mul_f32 v[154:155], v[154:155], v[232:233] op_sel_hi:[1,0]
 v_pk_mul_f32 v[156:157], v[156:157], v[232:233] op_sel_hi:[1,0]
 v_pk_mul_f32 v[158:159], v[158:159], v[232:233] op_sel_hi:[1,0]
 v_cvt_pk_bf16_f32 v144, v144, v145
 v_cvt_pk_bf16_f32 v145, v146, v147
 v_cvt_pk_bf16_f32 v146, v148, v149
 v_cvt_pk_bf16_f32 v147, v150, v151
 buffer_store_dwordx4 v[144:147], v25, s[4:7], s57 offen offset:3072 sc1
 v_cvt_pk_bf16_f32 v152, v152, v153
 v_cvt_pk_bf16_f32 v153, v154, v155
 v_cvt_pk_bf16_f32 v154, v156, v157
 v_cvt_pk_bf16_f32 v155, v158, v159
 buffer_store_dwordx4 v[152:155], v25, s[4:7], s57 offen offset:3584 sc1
 s_waitcnt vmcnt(0) lgkmcnt(0)
 s_barrier
 s_branch L_D
M_parall_37:
 s_nop 7
 s_lshl_b32 s19, s18, 1
 s_add_u32 s19, s19, 0
 s_cmp_eq_u32 s19, s93
 s_cselect_b32 s12, s15, 0
 s_cmp_gt_u32 s19, s93
 s_cselect_b32 s13, s15, 0
 v_fma_f32 v96, v240, s12, v96
 v_fma_f32 v97, v241, s12, v97
 v_fma_f32 v98, v242, s12, v98
 v_fma_f32 v99, v243, s12, v99
 v_fma_f32 v100, v244, s12, v100
 v_fma_f32 v101, v245, s12, v101
 v_fma_f32 v102, v246, s12, v102
 v_fma_f32 v103, v247, s12, v103
 v_fma_f32 v104, v248, s12, v104
 v_fma_f32 v105, v249, s12, v105
 v_fma_f32 v106, v250, s12, v106
 v_fma_f32 v107, v251, s12, v107
 v_fma_f32 v108, v252, s12, v108
 v_fma_f32 v109, v253, s12, v109
 v_fma_f32 v110, v254, s12, v110
 v_fma_f32 v111, v255, s12, v111
 v_add_f32 v96, s13, v96
 v_add_f32 v97, s13, v97
 v_add_f32 v98, s13, v98
 v_add_f32 v99, s13, v99
 v_add_f32 v100, s13, v100
 v_add_f32 v101, s13, v101
 v_add_f32 v102, s13, v102
 v_add_f32 v103, s13, v103
 v_add_f32 v104, s13, v104
 v_add_f32 v105, s13, v105
 v_add_f32 v106, s13, v106
 v_add_f32 v107, s13, v107
 v_add_f32 v108, s13, v108
 v_add_f32 v109, s13, v109
 v_add_f32 v110, s13, v110
 v_add_f32 v111, s13, v111
 s_nop 1
 s_branch MB_parall_38
M_parall_39:
 s_nop 7
 s_lshl_b32 s19, s18, 1
 s_add_u32 s19, s19, 1
 s_cmp_eq_u32 s19, s93
 s_cselect_b32 s12, s15, 0
 s_cmp_gt_u32 s19, s93
 s_cselect_b32 s13, s15, 0
 v_fma_f32 v128, v240, s12, v128
 v_fma_f32 v129, v241, s12, v129
 v_fma_f32 v130, v242, s12, v130
 v_fma_f32 v131, v243, s12, v131
 v_fma_f32 v132, v244, s12, v132
 v_fma_f32 v133, v245, s12, v133
 v_fma_f32 v134, v246, s12, v134
 v_fma_f32 v135, v247, s12, v135
 v_fma_f32 v136, v248, s12, v136
 v_fma_f32 v137, v249, s12, v137
 v_fma_f32 v138, v250, s12, v138
 v_fma_f32 v139, v251, s12, v139
 v_fma_f32 v140, v252, s12, v140
 v_fma_f32 v141, v253, s12, v141
 v_fma_f32 v142, v254, s12, v142
 v_fma_f32 v143, v255, s12, v143
 v_add_f32 v128, s13, v128
 v_add_f32 v129, s13, v129
 v_add_f32 v130, s13, v130
 v_add_f32 v131, s13, v131
 v_add_f32 v132, s13, v132
 v_add_f32 v133, s13, v133
 v_add_f32 v134, s13, v134
 v_add_f32 v135, s13, v135
 v_add_f32 v136, s13, v136
 v_add_f32 v137, s13, v137
 v_add_f32 v138, s13, v138
 v_add_f32 v139, s13, v139
 v_add_f32 v140, s13, v140
 v_add_f32 v141, s13, v141
 v_add_f32 v142, s13, v142
 v_add_f32 v143, s13, v143
 s_nop 1
 s_branch MB_parall_40
M_parall_41:
 s_nop 7
 s_lshl_b32 s19, s18, 1
 s_add_u32 s19, s19, 0
 s_cmp_eq_u32 s19, s93
 s_cselect_b32 s12, s15, 0
 s_cmp_gt_u32 s19, s93
 s_cselect_b32 s13, s15, 0
 v_fma_f32 v96, v240, s12, v96
 v_fma_f32 v97, v241, s12, v97
 v_fma_f32 v98, v242, s12, v98
 v_fma_f32 v99, v243, s12, v99
 v_fma_f32 v100, v244, s12, v100
 v_fma_f32 v101, v245, s12, v101
 v_fma_f32 v102, v246, s12, v102
 v_fma_f32 v103, v247, s12, v103
 v_fma_f32 v104, v248, s12, v104
 v_fma_f32 v105, v249, s12, v105
 v_fma_f32 v106, v250, s12, v106
 v_fma_f32 v107, v251, s12, v107
 v_fma_f32 v108, v252, s12, v108
 v_fma_f32 v109, v253, s12, v109
 v_fma_f32 v110, v254, s12, v110
 v_fma_f32 v111, v255, s12, v111
 v_add_f32 v96, s13, v96
 v_add_f32 v97, s13, v97
 v_add_f32 v98, s13, v98
 v_add_f32 v99, s13, v99
 v_add_f32 v100, s13, v100
 v_add_f32 v101, s13, v101
 v_add_f32 v102, s13, v102
 v_add_f32 v103, s13, v103
 v_add_f32 v104, s13, v104
 v_add_f32 v105, s13, v105
 v_add_f32 v106, s13, v106
 v_add_f32 v107, s13, v107
 v_add_f32 v108, s13, v108
 v_add_f32 v109, s13, v109
 v_add_f32 v110, s13, v110
 v_add_f32 v111, s13, v111
 s_nop 1
 s_branch MB_parall_42
C_parall_43:
 s_call_b64 s[20:21], L_slow_0DD
 s_branch CB_parall_44
M_parall_45:
 s_nop 7
 s_lshl_b32 s19, s18, 1
 s_add_u32 s19, s19, 1
 s_cmp_eq_u32 s19, s93
 s_cselect_b32 s12, s15, 0
 s_cmp_gt_u32 s19, s93
 s_cselect_b32 s13, s15, 0
 v_fma_f32 v128, v240, s12, v128
 v_fma_f32 v129, v241, s12, v129
 v_fma_f32 v130, v242, s12, v130
 v_fma_f32 v131, v243, s12, v131
 v_fma_f32 v132, v244, s12, v132
 v_fma_f32 v133, v245, s12, v133
 v_fma_f32 v134, v246, s12, v134
 v_fma_f32 v135, v247, s12, v135
 v_fma_f32 v136, v248, s12, v136
 v_fma_f32 v137, v249, s12, v137
 v_fma_f32 v138, v250, s12, v138
 v_fma_f32 v139, v251, s12, v139
 v_fma_f32 v140, v252, s12, v140
 v_fma_f32 v141, v253, s12, v141
 v_fma_f32 v142, v254, s12, v142
 v_fma_f32 v143, v255, s12, v143
 v_add_f32 v128, s13, v128
 v_add_f32 v129, s13, v129
 v_add_f32 v130, s13, v130
 v_add_f32 v131, s13, v131
 v_add_f32 v132, s13, v132
 v_add_f32 v133, s13, v133
 v_add_f32 v134, s13, v134
 v_add_f32 v135, s13, v135
 v_add_f32 v136, s13, v136
 v_add_f32 v137, s13, v137
 v_add_f32 v138, s13, v138
 v_add_f32 v139, s13, v139
 v_add_f32 v140, s13, v140
 v_add_f32 v141, s13, v141
 v_add_f32 v142, s13, v142
 v_add_f32 v143, s13, v143
 s_nop 1
 s_branch MB_parall_46
C_parall_47:
 s_call_b64 s[20:21], L_slow_1DD
 s_branch CB_parall_48
M_parall_49:
 s_nop 7
 s_lshl_b32 s19, s18, 1
 s_add_u32 s19, s19, 0
 s_cmp_eq_u32 s19, s94
 s_cselect_b32 s12, s15, 0
 s_cmp_gt_u32 s19, s94
 s_cselect_b32 s13, s15, 0
 v_fma_f32 v96, v240, s12, v96
 v_fma_f32 v97, v241, s12, v97
 v_fma_f32 v98, v242, s12, v98
 v_fma_f32 v99, v243, s12, v99
 v_fma_f32 v100, v244, s12, v100
 v_fma_f32 v101, v245, s12, v101
 v_fma_f32 v102, v246, s12, v102
 v_fma_f32 v103, v247, s12, v103
 v_fma_f32 v104, v248, s12, v104
 v_fma_f32 v105, v249, s12, v105
 v_fma_f32 v106, v250, s12, v106
 v_fma_f32 v107, v251, s12, v107
 v_fma_f32 v108, v252, s12, v108
 v_fma_f32 v109, v253, s12, v109
 v_fma_f32 v110, v254, s12, v110
 v_fma_f32 v111, v255, s12, v111
 v_add_f32 v96, s13, v96
 v_add_f32 v97, s13, v97
 v_add_f32 v98, s13, v98
 v_add_f32 v99, s13, v99
 v_add_f32 v100, s13, v100
 v_add_f32 v101, s13, v101
 v_add_f32 v102, s13, v102
 v_add_f32 v103, s13, v103
 v_add_f32 v104, s13, v104
 v_add_f32 v105, s13, v105
 v_add_f32 v106, s13, v106
 v_add_f32 v107, s13, v107
 v_add_f32 v108, s13, v108
 v_add_f32 v109, s13, v109
 v_add_f32 v110, s13, v110
 v_add_f32 v111, s13, v111
 s_lshl_b32 s19, s18, 1
 s_add_u32 s19, s19, 1
 s_cmp_eq_u32 s19, s94
 s_cselect_b32 s12, s15, 0
 s_cmp_gt_u32 s19, s94
 s_cselect_b32 s13, s15, 0
 v_fma_f32 v112, v240, s12, v112
 v_fma_f32 v113, v241, s12, v113
 v_fma_f32 v114, v242, s12, v114
 v_fma_f32 v115, v243, s12, v115
 v_fma_f32 v116, v244, s12, v116
 v_fma_f32 v117, v245, s12, v117
 v_fma_f32 v118, v246, s12, v118
 v_fma_f32 v119, v247, s12, v119
 v_fma_f32 v120, v248, s12, v120
 v_fma_f32 v121, v249, s12, v121
 v_fma_f32 v122, v250, s12, v122
 v_fma_f32 v123, v251, s12, v123
 v_fma_f32 v124, v252, s12, v124
 v_fma_f32 v125, v253, s12, v125
 v_fma_f32 v126, v254, s12, v126
 v_fma_f32 v127, v255, s12, v127
 v_add_f32 v112, s13, v112
 v_add_f32 v113, s13, v113
 v_add_f32 v114, s13, v114
 v_add_f32 v115, s13, v115
 v_add_f32 v116, s13, v116
 v_add_f32 v117, s13, v117
 v_add_f32 v118, s13, v118
 v_add_f32 v119, s13, v119
 v_add_f32 v120, s13, v120
 v_add_f32 v121, s13, v121
 v_add_f32 v122, s13, v122
 v_add_f32 v123, s13, v123
 v_add_f32 v124, s13, v124
 v_add_f32 v125, s13, v125
 v_add_f32 v126, s13, v126
 v_add_f32 v127, s13, v127
 s_nop 1
 s_branch MB_parall_50
C_parall_51:
 s_call_b64 s[20:21], L_slow_0DS
 s_branch CB_parall_52
M_parall_53:
 s_nop 7
 s_lshl_b32 s19, s18, 1
 s_add_u32 s19, s19, 2
 s_cmp_eq_u32 s19, s94
 s_cselect_b32 s12, s15, 0
 s_cmp_gt_u32 s19, s94
 s_cselect_b32 s13, s15, 0
 v_fma_f32 v128, v240, s12, v128
 v_fma_f32 v129, v241, s12, v129
 v_fma_f32 v130, v242, s12, v130
 v_fma_f32 v131, v243, s12, v131
 v_fma_f32 v132, v244, s12, v132
 v_fma_f32 v133, v245, s12, v133
 v_fma_f32 v134, v246, s12, v134
 v_fma_f32 v135, v247, s12, v135
 v_fma_f32 v136, v248, s12, v136
 v_fma_f32 v137, v249, s12, v137
 v_fma_f32 v138, v250, s12, v138
 v_fma_f32 v139, v251, s12, v139
 v_fma_f32 v140, v252, s12, v140
 v_fma_f32 v141, v253, s12, v141
 v_fma_f32 v142, v254, s12, v142
 v_fma_f32 v143, v255, s12, v143
 v_add_f32 v128, s13, v128
 v_add_f32 v129, s13, v129
 v_add_f32 v130, s13, v130
 v_add_f32 v131, s13, v131
 v_add_f32 v132, s13, v132
 v_add_f32 v133, s13, v133
 v_add_f32 v134, s13, v134
 v_add_f32 v135, s13, v135
 v_add_f32 v136, s13, v136
 v_add_f32 v137, s13, v137
 v_add_f32 v138, s13, v138
 v_add_f32 v139, s13, v139
 v_add_f32 v140, s13, v140
 v_add_f32 v141, s13, v141
 v_add_f32 v142, s13, v142
 v_add_f32 v143, s13, v143
 s_lshl_b32 s19, s18, 1
 s_add_u32 s19, s19, 3
 s_cmp_eq_u32 s19, s94
 s_cselect_b32 s12, s15, 0
 s_cmp_gt_u32 s19, s94
 s_cselect_b32 s13, s15, 0
 v_fma_f32 v144, v240, s12, v144
 v_fma_f32 v145, v241, s12, v145
 v_fma_f32 v146, v242, s12, v146
 v_fma_f32 v147, v243, s12, v147
 v_fma_f32 v148, v244, s12, v148
 v_fma_f32 v149, v245, s12, v149
 v_fma_f32 v150, v246, s12, v150
 v_fma_f32 v151, v247, s12, v151
 v_fma_f32 v152, v248, s12, v152
 v_fma_f32 v153, v249, s12, v153
 v_fma_f32 v154, v250, s12, v154
 v_fma_f32 v155, v251, s12, v155
 v_fma_f32 v156, v252, s12, v156
 v_fma_f32 v157, v253, s12, v157
 v_fma_f32 v158, v254, s12, v158
 v_fma_f32 v159, v255, s12, v159
 v_add_f32 v144, s13, v144
 v_add_f32 v145, s13, v145
 v_add_f32 v146, s13, v146
 v_add_f32 v147, s13, v147
 v_add_f32 v148, s13, v148
 v_add_f32 v149, s13, v149
 v_add_f32 v150, s13, v150
 v_add_f32 v151, s13, v151
 v_add_f32 v152, s13, v152
 v_add_f32 v153, s13, v153
 v_add_f32 v154, s13, v154
 v_add_f32 v155, s13, v155
 v_add_f32 v156, s13, v156
 v_add_f32 v157, s13, v157
 v_add_f32 v158, s13, v158
 v_add_f32 v159, s13, v159
 s_nop 1
 s_branch MB_parall_54
C_parall_55:
 s_call_b64 s[20:21], L_slow_1SS
 s_branch CB_parall_56
M_parall_57:
 s_nop 7
 s_lshl_b32 s19, s18, 1
 s_add_u32 s19, s19, 0
 s_cmp_eq_u32 s19, s94
 s_cselect_b32 s12, s15, 0
 s_cmp_gt_u32 s19, s94
 s_cselect_b32 s13, s15, 0
 v_fma_f32 v96, v240, s12, v96
 v_fma_f32 v97, v241, s12, v97
 v_fma_f32 v98, v242, s12, v98
 v_fma_f32 v99, v243, s12, v99
 v_fma_f32 v100, v244, s12, v100
 v_fma_f32 v101, v245, s12, v101
 v_fma_f32 v102, v246, s12, v102
 v_fma_f32 v103, v247, s12, v103
 v_fma_f32 v104, v248, s12, v104
 v_fma_f32 v105, v249, s12, v105
 v_fma_f32 v106, v250, s12, v106
 v_fma_f32 v107, v251, s12, v107
 v_fma_f32 v108, v252, s12, v108
 v_fma_f32 v109, v253, s12, v109
 v_fma_f32 v110, v254, s12, v110
 v_fma_f32 v111, v255, s12, v111
 v_add_f32 v96, s13, v96
 v_add_f32 v97, s13, v97
 v_add_f32 v98, s13, v98
 v_add_f32 v99, s13, v99
 v_add_f32 v100, s13, v100
 v_add_f32 v101, s13, v101
 v_add_f32 v102, s13, v102
 v_add_f32 v103, s13, v103
 v_add_f32 v104, s13, v104
 v_add_f32 v105, s13, v105
 v_add_f32 v106, s13, v106
 v_add_f32 v107, s13, v107
 v_add_f32 v108, s13, v108
 v_add_f32 v109, s13, v109
 v_add_f32 v110, s13, v110
 v_add_f32 v111, s13, v111
 s_lshl_b32 s19, s18, 1
 s_add_u32 s19, s19, 1
 s_cmp_eq_u32 s19, s94
 s_cselect_b32 s12, s15, 0
 s_cmp_gt_u32 s19, s94
 s_cselect_b32 s13, s15, 0
 v_fma_f32 v112, v240, s12, v112
 v_fma_f32 v113, v241, s12, v113
 v_fma_f32 v114, v242, s12, v114
 v_fma_f32 v115, v243, s12, v115
 v_fma_f32 v116, v244, s12, v116
 v_fma_f32 v117, v245, s12, v117
 v_fma_f32 v118, v246, s12, v118
 v_fma_f32 v119, v247, s12, v119
 v_fma_f32 v120, v248, s12, v120
 v_fma_f32 v121, v249, s12, v121
 v_fma_f32 v122, v250, s12, v122
 v_fma_f32 v123, v251, s12, v123
 v_fma_f32 v124, v252, s12, v124
 v_fma_f32 v125, v253, s12, v125
 v_fma_f32 v126, v254, s12, v126
 v_fma_f32 v127, v255, s12, v127
 v_add_f32 v112, s13, v112
 v_add_f32 v113, s13, v113
 v_add_f32 v114, s13, v114
 v_add_f32 v115, s13, v115
 v_add_f32 v116, s13, v116
 v_add_f32 v117, s13, v117
 v_add_f32 v118, s13, v118
 v_add_f32 v119, s13, v119
 v_add_f32 v120, s13, v120
 v_add_f32 v121, s13, v121
 v_add_f32 v122, s13, v122
 v_add_f32 v123, s13, v123
 v_add_f32 v124, s13, v124
 v_add_f32 v125, s13, v125
 v_add_f32 v126, s13, v126
 v_add_f32 v127, s13, v127
 s_nop 1
 s_branch MB_parall_58
C_parall_59:
 s_call_b64 s[20:21], L_slow_0SS
 s_branch CB_parall_60
M_parall_61:
 s_nop 7
 s_lshl_b32 s19, s18, 1
 s_add_u32 s19, s19, 2
 s_cmp_eq_u32 s19, s94
 s_cselect_b32 s12, s15, 0
 s_cmp_gt_u32 s19, s94
 s_cselect_b32 s13, s15, 0
 v_fma_f32 v128, v240, s12, v128
 v_fma_f32 v129, v241, s12, v129
 v_fma_f32 v130, v242, s12, v130
 v_fma_f32 v131, v243, s12, v131
 v_fma_f32 v132, v244, s12, v132
 v_fma_f32 v133, v245, s12, v133
 v_fma_f32 v134, v246, s12, v134
 v_fma_f32 v135, v247, s12, v135
 v_fma_f32 v136, v248, s12, v136
 v_fma_f32 v137, v249, s12, v137
 v_fma_f32 v138, v250, s12, v138
 v_fma_f32 v139, v251, s12, v139
 v_fma_f32 v140, v252, s12, v140
 v_fma_f32 v141, v253, s12, v141
 v_fma_f32 v142, v254, s12, v142
 v_fma_f32 v143, v255, s12, v143
 v_add_f32 v128, s13, v128
 v_add_f32 v129, s13, v129
 v_add_f32 v130, s13, v130
 v_add_f32 v131, s13, v131
 v_add_f32 v132, s13, v132
 v_add_f32 v133, s13, v133
 v_add_f32 v134, s13, v134
 v_add_f32 v135, s13, v135
 v_add_f32 v136, s13, v136
 v_add_f32 v137, s13, v137
 v_add_f32 v138, s13, v138
 v_add_f32 v139, s13, v139
 v_add_f32 v140, s13, v140
 v_add_f32 v141, s13, v141
 v_add_f32 v142, s13, v142
 v_add_f32 v143, s13, v143
 s_lshl_b32 s19, s18, 1
 s_add_u32 s19, s19, 3
 s_cmp_eq_u32 s19, s94
 s_cselect_b32 s12, s15, 0
 s_cmp_gt_u32 s19, s94
 s_cselect_b32 s13, s15, 0
 v_fma_f32 v144, v240, s12, v144
 v_fma_f32 v145, v241, s12, v145
 v_fma_f32 v146, v242, s12, v146
 v_fma_f32 v147, v243, s12, v147
 v_fma_f32 v148, v244, s12, v148
 v_fma_f32 v149, v245, s12, v149
 v_fma_f32 v150, v246, s12, v150
 v_fma_f32 v151, v247, s12, v151
 v_fma_f32 v152, v248, s12, v152
 v_fma_f32 v153, v249, s12, v153
 v_fma_f32 v154, v250, s12, v154
 v_fma_f32 v155, v251, s12, v155
 v_fma_f32 v156, v252, s12, v156
 v_fma_f32 v157, v253, s12, v157
 v_fma_f32 v158, v254, s12, v158
 v_fma_f32 v159, v255, s12, v159
 v_add_f32 v144, s13, v144
 v_add_f32 v145, s13, v145
 v_add_f32 v146, s13, v146
 v_add_f32 v147, s13, v147
 v_add_f32 v148, s13, v148
 v_add_f32 v149, s13, v149
 v_add_f32 v150, s13, v150
 v_add_f32 v151, s13, v151
 v_add_f32 v152, s13, v152
 v_add_f32 v153, s13, v153
 v_add_f32 v154, s13, v154
 v_add_f32 v155, s13, v155
 v_add_f32 v156, s13, v156
 v_add_f32 v157, s13, v157
 v_add_f32 v158, s13, v158
 v_add_f32 v159, s13, v159
 s_nop 1
 s_branch MB_parall_62
C_parall_63:
 s_call_b64 s[20:21], L_slow_1SS
 s_branch CB_parall_64
C_parall_65:
 s_call_b64 s[20:21], L_slow_0SS
 s_branch CB_parall_66
L_slow_0DD:
 s_nop 15
 v_max3_f32 v232, v128, v129, v130
 v_max3_f32 v232, v232, v131, v132
 v_max3_f32 v232, v232, v133, v134
 v_max3_f32 v232, v232, v135, v136
 v_max3_f32 v232, v232, v137, v138
 v_max3_f32 v232, v232, v139, v140
 v_max3_f32 v232, v232, v141, v142
 v_max_f32 v232, v232, v143
 v_mov_b32 v235, v232
 s_nop 1
 v_permlane32_swap_b32 v232, v235
 v_max_f32 v232, v232, v235
 v_max_f32 v232, 0, v232
 v_sub_f32 v128, v128, v232
 v_sub_f32 v129, v129, v232
 v_sub_f32 v130, v130, v232
 v_sub_f32 v131, v131, v232
 v_sub_f32 v132, v132, v232
 v_sub_f32 v133, v133, v232
 v_sub_f32 v134, v134, v232
 v_sub_f32 v135, v135, v232
 v_sub_f32 v136, v136, v232
 v_sub_f32 v137, v137, v232
 v_sub_f32 v138, v138, v232
 v_sub_f32 v139, v139, v232
 v_sub_f32 v140, v140, v232
 v_sub_f32 v141, v141, v232
 v_sub_f32 v142, v142, v232
 v_sub_f32 v143, v143, v232
 v_sub_f32 v96, v96, v232
 v_sub_f32 v97, v97, v232
 v_sub_f32 v98, v98, v232
 v_sub_f32 v99, v99, v232
 v_sub_f32 v100, v100, v232
 v_sub_f32 v101, v101, v232
 v_sub_f32 v102, v102, v232
 v_sub_f32 v103, v103, v232
 v_sub_f32 v104, v104, v232
 v_sub_f32 v105, v105, v232
 v_sub_f32 v106, v106, v232
 v_sub_f32 v107, v107, v232
 v_sub_f32 v108, v108, v232
 v_sub_f32 v109, v109, v232
 v_sub_f32 v110, v110, v232
 v_sub_f32 v111, v111, v232
 v_sub_f32 v192, v192, v232
 v_sub_f32 v193, v193, v232
 v_sub_f32 v194, v194, v232
 v_sub_f32 v195, v195, v232
 v_sub_f32 v196, v196, v232
 v_sub_f32 v197, v197, v232
 v_sub_f32 v198, v198, v232
 v_sub_f32 v199, v199, v232
 v_sub_f32 v200, v200, v232
 v_sub_f32 v201, v201, v232
 v_sub_f32 v202, v202, v232
 v_sub_f32 v203, v203, v232
 v_sub_f32 v204, v204, v232
 v_sub_f32 v205, v205, v232
 v_sub_f32 v206, v206, v232
 v_sub_f32 v207, v207, v232
 v_exp_f32 v234, -v232
 s_nop 0
 v_mul_f32 v228, v228, v234
 v_accvgpr_read_b32 v235, a0
 v_mul_f32 v235, v235, v234
 v_accvgpr_write_b32 a0, v235
 v_accvgpr_read_b32 v235, a1
 v_mul_f32 v235, v235, v234
 v_accvgpr_write_b32 a1, v235
 v_accvgpr_read_b32 v235, a2
 v_mul_f32 v235, v235, v234
 v_accvgpr_write_b32 a2, v235
 v_accvgpr_read_b32 v235, a3
 v_mul_f32 v235, v235, v234
 v_accvgpr_write_b32 a3, v235
 v_accvgpr_read_b32 v235, a4
 v_mul_f32 v235, v235, v234
 v_accvgpr_write_b32 a4, v235
 v_accvgpr_read_b32 v235, a5
 v_mul_f32 v235, v235, v234
 v_accvgpr_write_b32 a5, v235
 v_accvgpr_read_b32 v235, a6
 v_mul_f32 v235, v235, v234
 v_accvgpr_write_b32 a6, v235
 v_accvgpr_read_b32 v235, a7
 v_mul_f32 v235, v235, v234
 v_accvgpr_write_b32 a7, v235
 v_accvgpr_read_b32 v235, a8
 v_mul_f32 v235, v235, v234
 v_accvgpr_write_b32 a8, v235
 v_accvgpr_read_b32 v235, a9
 v_mul_f32 v235, v235, v234
 v_accvgpr_write_b32 a9, v235
 v_accvgpr_read_b32 v235, a10
 v_mul_f32 v235, v235, v234
 v_accvgpr_write_b32 a10, v235
 v_accvgpr_read_b32 v235, a11
 v_mul_f32 v235, v235, v234
 v_accvgpr_write_b32 a11, v235
 v_accvgpr_read_b32 v235, a12
 v_mul_f32 v235, v235, v234
 v_accvgpr_write_b32 a12, v235
 v_accvgpr_read_b32 v235, a13
 v_mul_f32 v235, v235, v234
 v_accvgpr_write_b32 a13, v235
 v_accvgpr_read_b32 v235, a14
 v_mul_f32 v235, v235, v234
 v_accvgpr_write_b32 a14, v235
 v_accvgpr_read_b32 v235, a15
 v_mul_f32 v235, v235, v234
 v_accvgpr_write_b32 a15, v235
 v_accvgpr_read_b32 v235, a16
 v_mul_f32 v235, v235, v234
 v_accvgpr_write_b32 a16, v235
 v_accvgpr_read_b32 v235, a17
 v_mul_f32 v235, v235, v234
 v_accvgpr_write_b32 a17, v235
 v_accvgpr_read_b32 v235, a18
 v_mul_f32 v235, v235, v234
 v_accvgpr_write_b32 a18, v235
 v_accvgpr_read_b32 v235, a19
 v_mul_f32 v235, v235, v234
 v_accvgpr_write_b32 a19, v235
 v_accvgpr_read_b32 v235, a20
 v_mul_f32 v235, v235, v234
 v_accvgpr_write_b32 a20, v235
 v_accvgpr_read_b32 v235, a21
 v_mul_f32 v235, v235, v234
 v_accvgpr_write_b32 a21, v235
 v_accvgpr_read_b32 v235, a22
 v_mul_f32 v235, v235, v234
 v_accvgpr_write_b32 a22, v235
 v_accvgpr_read_b32 v235, a23
 v_mul_f32 v235, v235, v234
 v_accvgpr_write_b32 a23, v235
 v_accvgpr_read_b32 v235, a24
 v_mul_f32 v235, v235, v234
 v_accvgpr_write_b32 a24, v235
 v_accvgpr_read_b32 v235, a25
 v_mul_f32 v235, v235, v234
 v_accvgpr_write_b32 a25, v235
 v_accvgpr_read_b32 v235, a26
 v_mul_f32 v235, v235, v234
 v_accvgpr_write_b32 a26, v235
 v_accvgpr_read_b32 v235, a27
 v_mul_f32 v235, v235, v234
 v_accvgpr_write_b32 a27, v235
 v_accvgpr_read_b32 v235, a28
 v_mul_f32 v235, v235, v234
 v_accvgpr_write_b32 a28, v235
 v_accvgpr_read_b32 v235, a29
 v_mul_f32 v235, v235, v234
 v_accvgpr_write_b32 a29, v235
 v_accvgpr_read_b32 v235, a30
 v_mul_f32 v235, v235, v234
 v_accvgpr_write_b32 a30, v235
 v_accvgpr_read_b32 v235, a31
 v_mul_f32 v235, v235, v234
 v_accvgpr_write_b32 a31, v235
 v_accvgpr_read_b32 v235, a32
 v_mul_f32 v235, v235, v234
 v_accvgpr_write_b32 a32, v235
 v_accvgpr_read_b32 v235, a33
 v_mul_f32 v235, v235, v234
 v_accvgpr_write_b32 a33, v235
 v_accvgpr_read_b32 v235, a34
 v_mul_f32 v235, v235, v234
 v_accvgpr_write_b32 a34, v235
 v_accvgpr_read_b32 v235, a35
 v_mul_f32 v235, v235, v234
 v_accvgpr_write_b32 a35, v235
 v_accvgpr_read_b32 v235, a36
 v_mul_f32 v235, v235, v234
 v_accvgpr_write_b32 a36, v235
 v_accvgpr_read_b32 v235, a37
 v_mul_f32 v235, v235, v234
 v_accvgpr_write_b32 a37, v235
 v_accvgpr_read_b32 v235, a38
 v_mul_f32 v235, v235, v234
 v_accvgpr_write_b32 a38, v235
 v_accvgpr_read_b32 v235, a39
 v_mul_f32 v235, v235, v234
 v_accvgpr_write_b32 a39, v235
 v_accvgpr_read_b32 v235, a40
 v_mul_f32 v235, v235, v234
 v_accvgpr_write_b32 a40, v235
 v_accvgpr_read_b32 v235, a41
 v_mul_f32 v235, v235, v234
 v_accvgpr_write_b32 a41, v235
 v_accvgpr_read_b32 v235, a42
 v_mul_f32 v235, v235, v234
 v_accvgpr_write_b32 a42, v235
 v_accvgpr_read_b32 v235, a43
 v_mul_f32 v235, v235, v234
 v_accvgpr_write_b32 a43, v235
 v_accvgpr_read_b32 v235, a44
 v_mul_f32 v235, v235, v234
 v_accvgpr_write_b32 a44, v235
 v_accvgpr_read_b32 v235, a45
 v_mul_f32 v235, v235, v234
 v_accvgpr_write_b32 a45, v235
 v_accvgpr_read_b32 v235, a46
 v_mul_f32 v235, v235, v234
 v_accvgpr_write_b32 a46, v235
 v_accvgpr_read_b32 v235, a47
 v_mul_f32 v235, v235, v234
 v_accvgpr_write_b32 a47, v235
 v_accvgpr_read_b32 v235, a48
 v_mul_f32 v235, v235, v234
 v_accvgpr_write_b32 a48, v235
 v_accvgpr_read_b32 v235, a49
 v_mul_f32 v235, v235, v234
 v_accvgpr_write_b32 a49, v235
 v_accvgpr_read_b32 v235, a50
 v_mul_f32 v235, v235, v234
 v_accvgpr_write_b32 a50, v235
 v_accvgpr_read_b32 v235, a51
 v_mul_f32 v235, v235, v234
 v_accvgpr_write_b32 a51, v235
 v_accvgpr_read_b32 v235, a52
 v_mul_f32 v235, v235, v234
 v_accvgpr_write_b32 a52, v235
 v_accvgpr_read_b32 v235, a53
 v_mul_f32 v235, v235, v234
 v_accvgpr_write_b32 a53, v235
 v_accvgpr_read_b32 v235, a54
 v_mul_f32 v235, v235, v234
 v_accvgpr_write_b32 a54, v235
 v_accvgpr_read_b32 v235, a55
 v_mul_f32 v235, v235, v234
 v_accvgpr_write_b32 a55, v235
 v_accvgpr_read_b32 v235, a56
 v_mul_f32 v235, v235, v234
 v_accvgpr_write_b32 a56, v235
 v_accvgpr_read_b32 v235, a57
 v_mul_f32 v235, v235, v234
 v_accvgpr_write_b32 a57, v235
 v_accvgpr_read_b32 v235, a58
 v_mul_f32 v235, v235, v234
 v_accvgpr_write_b32 a58, v235
 v_accvgpr_read_b32 v235, a59
 v_mul_f32 v235, v235, v234
 v_accvgpr_write_b32 a59, v235
 v_accvgpr_read_b32 v235, a60
 v_mul_f32 v235, v235, v234
 v_accvgpr_write_b32 a60, v235
 v_accvgpr_read_b32 v235, a61
 v_mul_f32 v235, v235, v234
 v_accvgpr_write_b32 a61, v235
 v_accvgpr_read_b32 v235, a62
 v_mul_f32 v235, v235, v234
 v_accvgpr_write_b32 a62, v235
 v_accvgpr_read_b32 v235, a63
 v_mul_f32 v235, v235, v234
 v_accvgpr_write_b32 a63, v235
 v_max3_f32 v233, v144, v145, v146
 v_max3_f32 v233, v233, v147, v148
 v_max3_f32 v233, v233, v149, v150
 v_max3_f32 v233, v233, v151, v152
 v_max3_f32 v233, v233, v153, v154
 v_max3_f32 v233, v233, v155, v156
 v_max3_f32 v233, v233, v157, v158
 v_max_f32 v233, v233, v159
 v_mov_b32 v235, v233
 s_nop 1
 v_permlane32_swap_b32 v233, v235
 v_max_f32 v233, v233, v235
 v_max_f32 v233, 0, v233
 v_sub_f32 v144, v144, v233
 v_sub_f32 v145, v145, v233
 v_sub_f32 v146, v146, v233
 v_sub_f32 v147, v147, v233
 v_sub_f32 v148, v148, v233
 v_sub_f32 v149, v149, v233
 v_sub_f32 v150, v150, v233
 v_sub_f32 v151, v151, v233
 v_sub_f32 v152, v152, v233
 v_sub_f32 v153, v153, v233
 v_sub_f32 v154, v154, v233
 v_sub_f32 v155, v155, v233
 v_sub_f32 v156, v156, v233
 v_sub_f32 v157, v157, v233
 v_sub_f32 v158, v158, v233
 v_sub_f32 v159, v159, v233
 v_sub_f32 v112, v112, v233
 v_sub_f32 v113, v113, v233
 v_sub_f32 v114, v114, v233
 v_sub_f32 v115, v115, v233
 v_sub_f32 v116, v116, v233
 v_sub_f32 v117, v117, v233
 v_sub_f32 v118, v118, v233
 v_sub_f32 v119, v119, v233
 v_sub_f32 v120, v120, v233
 v_sub_f32 v121, v121, v233
 v_sub_f32 v122, v122, v233
 v_sub_f32 v123, v123, v233
 v_sub_f32 v124, v124, v233
 v_sub_f32 v125, v125, v233
 v_sub_f32 v126, v126, v233
 v_sub_f32 v127, v127, v233
 v_sub_f32 v208, v208, v233
 v_sub_f32 v209, v209, v233
 v_sub_f32 v210, v210, v233
 v_sub_f32 v211, v211, v233
 v_sub_f32 v212, v212, v233
 v_sub_f32 v213, v213, v233
 v_sub_f32 v214, v214, v233
 v_sub_f32 v215, v215, v233
 v_sub_f32 v216, v216, v233
 v_sub_f32 v217, v217, v233
 v_sub_f32 v218, v218, v233
 v_sub_f32 v219, v219, v233
 v_sub_f32 v220, v220, v233
 v_sub_f32 v221, v221, v233
 v_sub_f32 v222, v222, v233
 v_sub_f32 v223, v223, v233
 v_exp_f32 v234, -v233
 s_nop 0
 v_mul_f32 v229, v229, v234
 v_accvgpr_read_b32 v235, a64
 v_mul_f32 v235, v235, v234
 v_accvgpr_write_b32 a64, v235
 v_accvgpr_read_b32 v235, a65
 v_mul_f32 v235, v235, v234
 v_accvgpr_write_b32 a65, v235
 v_accvgpr_read_b32 v235, a66
 v_mul_f32 v235, v235, v234
 v_accvgpr_write_b32 a66, v235
 v_accvgpr_read_b32 v235, a67
 v_mul_f32 v235, v235, v234
 v_accvgpr_write_b32 a67, v235
 v_accvgpr_read_b32 v235, a68
 v_mul_f32 v235, v235, v234
 v_accvgpr_write_b32 a68, v235
 v_accvgpr_read_b32 v235, a69
 v_mul_f32 v235, v235, v234
 v_accvgpr_write_b32 a69, v235
 v_accvgpr_read_b32 v235, a70
 v_mul_f32 v235, v235, v234
 v_accvgpr_write_b32 a70, v235
 v_accvgpr_read_b32 v235, a71
 v_mul_f32 v235, v235, v234
 v_accvgpr_write_b32 a71, v235
 v_accvgpr_read_b32 v235, a72
 v_mul_f32 v235, v235, v234
 v_accvgpr_write_b32 a72, v235
 v_accvgpr_read_b32 v235, a73
 v_mul_f32 v235, v235, v234
 v_accvgpr_write_b32 a73, v235
 v_accvgpr_read_b32 v235, a74
 v_mul_f32 v235, v235, v234
 v_accvgpr_write_b32 a74, v235
 v_accvgpr_read_b32 v235, a75
 v_mul_f32 v235, v235, v234
 v_accvgpr_write_b32 a75, v235
 v_accvgpr_read_b32 v235, a76
 v_mul_f32 v235, v235, v234
 v_accvgpr_write_b32 a76, v235
 v_accvgpr_read_b32 v235, a77
 v_mul_f32 v235, v235, v234
 v_accvgpr_write_b32 a77, v235
 v_accvgpr_read_b32 v235, a78
 v_mul_f32 v235, v235, v234
 v_accvgpr_write_b32 a78, v235
 v_accvgpr_read_b32 v235, a79
 v_mul_f32 v235, v235, v234
 v_accvgpr_write_b32 a79, v235
 v_accvgpr_read_b32 v235, a80
 v_mul_f32 v235, v235, v234
 v_accvgpr_write_b32 a80, v235
 v_accvgpr_read_b32 v235, a81
 v_mul_f32 v235, v235, v234
 v_accvgpr_write_b32 a81, v235
 v_accvgpr_read_b32 v235, a82
 v_mul_f32 v235, v235, v234
 v_accvgpr_write_b32 a82, v235
 v_accvgpr_read_b32 v235, a83
 v_mul_f32 v235, v235, v234
 v_accvgpr_write_b32 a83, v235
 v_accvgpr_read_b32 v235, a84
 v_mul_f32 v235, v235, v234
 v_accvgpr_write_b32 a84, v235
 v_accvgpr_read_b32 v235, a85
 v_mul_f32 v235, v235, v234
 v_accvgpr_write_b32 a85, v235
 v_accvgpr_read_b32 v235, a86
 v_mul_f32 v235, v235, v234
 v_accvgpr_write_b32 a86, v235
 v_accvgpr_read_b32 v235, a87
 v_mul_f32 v235, v235, v234
 v_accvgpr_write_b32 a87, v235
 v_accvgpr_read_b32 v235, a88
 v_mul_f32 v235, v235, v234
 v_accvgpr_write_b32 a88, v235
 v_accvgpr_read_b32 v235, a89
 v_mul_f32 v235, v235, v234
 v_accvgpr_write_b32 a89, v235
 v_accvgpr_read_b32 v235, a90
 v_mul_f32 v235, v235, v234
 v_accvgpr_write_b32 a90, v235
 v_accvgpr_read_b32 v235, a91
 v_mul_f32 v235, v235, v234
 v_accvgpr_write_b32 a91, v235
 v_accvgpr_read_b32 v235, a92
 v_mul_f32 v235, v235, v234
 v_accvgpr_write_b32 a92, v235
 v_accvgpr_read_b32 v235, a93
 v_mul_f32 v235, v235, v234
 v_accvgpr_write_b32 a93, v235
 v_accvgpr_read_b32 v235, a94
 v_mul_f32 v235, v235, v234
 v_accvgpr_write_b32 a94, v235
 v_accvgpr_read_b32 v235, a95
 v_mul_f32 v235, v235, v234
 v_accvgpr_write_b32 a95, v235
 v_accvgpr_read_b32 v235, a96
 v_mul_f32 v235, v235, v234
 v_accvgpr_write_b32 a96, v235
 v_accvgpr_read_b32 v235, a97
 v_mul_f32 v235, v235, v234
 v_accvgpr_write_b32 a97, v235
 v_accvgpr_read_b32 v235, a98
 v_mul_f32 v235, v235, v234
 v_accvgpr_write_b32 a98, v235
 v_accvgpr_read_b32 v235, a99
 v_mul_f32 v235, v235, v234
 v_accvgpr_write_b32 a99, v235
 v_accvgpr_read_b32 v235, a100
 v_mul_f32 v235, v235, v234
 v_accvgpr_write_b32 a100, v235
 v_accvgpr_read_b32 v235, a101
 v_mul_f32 v235, v235, v234
 v_accvgpr_write_b32 a101, v235
 v_accvgpr_read_b32 v235, a102
 v_mul_f32 v235, v235, v234
 v_accvgpr_write_b32 a102, v235
 v_accvgpr_read_b32 v235, a103
 v_mul_f32 v235, v235, v234
 v_accvgpr_write_b32 a103, v235
 v_accvgpr_read_b32 v235, a104
 v_mul_f32 v235, v235, v234
 v_accvgpr_write_b32 a104, v235
 v_accvgpr_read_b32 v235, a105
 v_mul_f32 v235, v235, v234
 v_accvgpr_write_b32 a105, v235
 v_accvgpr_read_b32 v235, a106
 v_mul_f32 v235, v235, v234
 v_accvgpr_write_b32 a106, v235
 v_accvgpr_read_b32 v235, a107
 v_mul_f32 v235, v235, v234
 v_accvgpr_write_b32 a107, v235
 v_accvgpr_read_b32 v235, a108
 v_mul_f32 v235, v235, v234
 v_accvgpr_write_b32 a108, v235
 v_accvgpr_read_b32 v235, a109
 v_mul_f32 v235, v235, v234
 v_accvgpr_write_b32 a109, v235
 v_accvgpr_read_b32 v235, a110
 v_mul_f32 v235, v235, v234
 v_accvgpr_write_b32 a110, v235
 v_accvgpr_read_b32 v235, a111
 v_mul_f32 v235, v235, v234
 v_accvgpr_write_b32 a111, v235
 v_accvgpr_read_b32 v235, a112
 v_mul_f32 v235, v235, v234
 v_accvgpr_write_b32 a112, v235
 v_accvgpr_read_b32 v235, a113
 v_mul_f32 v235, v235, v234
 v_accvgpr_write_b32 a113, v235
 v_accvgpr_read_b32 v235, a114
 v_mul_f32 v235, v235, v234
 v_accvgpr_write_b32 a114, v235
 v_accvgpr_read_b32 v235, a115
 v_mul_f32 v235, v235, v234
 v_accvgpr_write_b32 a115, v235
 v_accvgpr_read_b32 v235, a116
 v_mul_f32 v235, v235, v234
 v_accvgpr_write_b32 a116, v235
 v_accvgpr_read_b32 v235, a117
 v_mul_f32 v235, v235, v234
 v_accvgpr_write_b32 a117, v235
 v_accvgpr_read_b32 v235, a118
 v_mul_f32 v235, v235, v234
 v_accvgpr_write_b32 a118, v235
 v_accvgpr_read_b32 v235, a119
 v_mul_f32 v235, v235, v234
 v_accvgpr_write_b32 a119, v235
 v_accvgpr_read_b32 v235, a120
 v_mul_f32 v235, v235, v234
 v_accvgpr_write_b32 a120, v235
 v_accvgpr_read_b32 v235, a121
 v_mul_f32 v235, v235, v234
 v_accvgpr_write_b32 a121, v235
 v_accvgpr_read_b32 v235, a122
 v_mul_f32 v235, v235, v234
 v_accvgpr_write_b32 a122, v235
 v_accvgpr_read_b32 v235, a123
 v_mul_f32 v235, v235, v234
 v_accvgpr_write_b32 a123, v235
 v_accvgpr_read_b32 v235, a124
 v_mul_f32 v235, v235, v234
 v_accvgpr_write_b32 a124, v235
 v_accvgpr_read_b32 v235, a125
 v_mul_f32 v235, v235, v234
 v_accvgpr_write_b32 a125, v235
 v_accvgpr_read_b32 v235, a126
 v_mul_f32 v235, v235, v234
 v_accvgpr_write_b32 a126, v235
 v_accvgpr_read_b32 v235, a127
 v_mul_f32 v235, v235, v234
 v_accvgpr_write_b32 a127, v235
 v_exp_f32 v224, v128
 v_exp_f32 v225, v129
 v_exp_f32 v226, v130
 v_exp_f32 v227, v131
 v_add_f32 v230, v228, v224
 v_cvt_pk_bf16_f32 v176, v224, v225
 v_add_f32 v230, v230, v225
 v_exp_f32 v224, v132
 v_exp_f32 v225, v133
 v_add_f32 v230, v230, v226
 v_cvt_pk_bf16_f32 v177, v226, v227
 v_add_f32 v230, v230, v227
 v_exp_f32 v226, v134
 v_exp_f32 v227, v135
 v_add_f32 v230, v230, v224
 v_cvt_pk_bf16_f32 v178, v224, v225
 v_add_f32 v230, v230, v225
 v_exp_f32 v224, v136
 v_exp_f32 v225, v137
 v_add_f32 v230, v230, v226
 v_cvt_pk_bf16_f32 v179, v226, v227
 v_add_f32 v230, v230, v227
 v_exp_f32 v226, v138
 v_exp_f32 v227, v139
 v_add_f32 v230, v230, v224
 v_cvt_pk_bf16_f32 v180, v224, v225
 v_add_f32 v230, v230, v225
 v_exp_f32 v224, v140
 v_exp_f32 v225, v141
 v_add_f32 v230, v230, v226
 v_cvt_pk_bf16_f32 v181, v226, v227
 v_add_f32 v230, v230, v227
 v_exp_f32 v226, v142
 v_exp_f32 v227, v143
 v_add_f32 v230, v230, v224
 v_cvt_pk_bf16_f32 v182, v224, v225
 v_add_f32 v230, v230, v225
 v_exp_f32 v224, v144
 v_exp_f32 v225, v145
 v_add_f32 v230, v230, v226
 v_cvt_pk_bf16_f32 v183, v226, v227
 v_add_f32 v230, v230, v227
 v_exp_f32 v226, v146
 v_exp_f32 v227, v147
 v_add_f32 v231, v229, v224
 v_cvt_pk_bf16_f32 v184, v224, v225
 v_add_f32 v231, v231, v225
 v_exp_f32 v224, v148
 v_exp_f32 v225, v149
 v_add_f32 v231, v231, v226
 v_cvt_pk_bf16_f32 v185, v226, v227
 v_add_f32 v231, v231, v227
 v_exp_f32 v226, v150
 v_exp_f32 v227, v151
 v_add_f32 v231, v231, v224
 v_cvt_pk_bf16_f32 v186, v224, v225
 v_add_f32 v231, v231, v225
 v_exp_f32 v224, v152
 v_exp_f32 v225, v153
 v_add_f32 v231, v231, v226
 v_cvt_pk_bf16_f32 v187, v226, v227
 v_add_f32 v231, v231, v227
 v_exp_f32 v226, v154
 v_exp_f32 v227, v155
 v_add_f32 v231, v231, v224
 v_cvt_pk_bf16_f32 v188, v224, v225
 v_add_f32 v231, v231, v225
 v_exp_f32 v224, v156
 v_exp_f32 v225, v157
 v_add_f32 v231, v231, v226
 v_cvt_pk_bf16_f32 v189, v226, v227
 v_add_f32 v231, v231, v227
 v_exp_f32 v226, v158
 v_exp_f32 v227, v159
 v_add_f32 v231, v231, v224
 v_cvt_pk_bf16_f32 v190, v224, v225
 v_add_f32 v231, v231, v225
 v_add_f32 v231, v231, v226
 v_cvt_pk_bf16_f32 v191, v226, v227
 v_add_f32 v231, v231, v227
 s_nop 3
 s_setpc_b64 s[20:21]
L_slow_0DS:
 s_nop 15
 v_max3_f32 v232, v128, v129, v130
 v_max3_f32 v232, v232, v131, v132
 v_max3_f32 v232, v232, v133, v134
 v_max3_f32 v232, v232, v135, v136
 v_max3_f32 v232, v232, v137, v138
 v_max3_f32 v232, v232, v139, v140
 v_max3_f32 v232, v232, v141, v142
 v_max_f32 v232, v232, v143
 v_mov_b32 v235, v232
 s_nop 1
 v_permlane32_swap_b32 v232, v235
 v_max_f32 v232, v232, v235
 v_max_f32 v232, 0, v232
 v_sub_f32 v128, v128, v232
 v_sub_f32 v129, v129, v232
 v_sub_f32 v130, v130, v232
 v_sub_f32 v131, v131, v232
 v_sub_f32 v132, v132, v232
 v_sub_f32 v133, v133, v232
 v_sub_f32 v134, v134, v232
 v_sub_f32 v135, v135, v232
 v_sub_f32 v136, v136, v232
 v_sub_f32 v137, v137, v232
 v_sub_f32 v138, v138, v232
 v_sub_f32 v139, v139, v232
 v_sub_f32 v140, v140, v232
 v_sub_f32 v141, v141, v232
 v_sub_f32 v142, v142, v232
 v_sub_f32 v143, v143, v232
 v_sub_f32 v192, v192, v232
 v_sub_f32 v193, v193, v232
 v_sub_f32 v194, v194, v232
 v_sub_f32 v195, v195, v232
 v_sub_f32 v196, v196, v232
 v_sub_f32 v197, v197, v232
 v_sub_f32 v198, v198, v232
 v_sub_f32 v199, v199, v232
 v_sub_f32 v200, v200, v232
 v_sub_f32 v201, v201, v232
 v_sub_f32 v202, v202, v232
 v_sub_f32 v203, v203, v232
 v_sub_f32 v204, v204, v232
 v_sub_f32 v205, v205, v232
 v_sub_f32 v206, v206, v232
 v_sub_f32 v207, v207, v232
 v_exp_f32 v234, -v232
 s_nop 0
 v_mul_f32 v228, v228, v234
 v_accvgpr_read_b32 v235, a0
 v_mul_f32 v235, v235, v234
 v_accvgpr_write_b32 a0, v235
 v_accvgpr_read_b32 v235, a1
 v_mul_f32 v235, v235, v234
 v_accvgpr_write_b32 a1, v235
 v_accvgpr_read_b32 v235, a2
 v_mul_f32 v235, v235, v234
 v_accvgpr_write_b32 a2, v235
 v_accvgpr_read_b32 v235, a3
 v_mul_f32 v235, v235, v234
 v_accvgpr_write_b32 a3, v235
 v_accvgpr_read_b32 v235, a4
 v_mul_f32 v235, v235, v234
 v_accvgpr_write_b32 a4, v235
 v_accvgpr_read_b32 v235, a5
 v_mul_f32 v235, v235, v234
 v_accvgpr_write_b32 a5, v235
 v_accvgpr_read_b32 v235, a6
 v_mul_f32 v235, v235, v234
 v_accvgpr_write_b32 a6, v235
 v_accvgpr_read_b32 v235, a7
 v_mul_f32 v235, v235, v234
 v_accvgpr_write_b32 a7, v235
 v_accvgpr_read_b32 v235, a8
 v_mul_f32 v235, v235, v234
 v_accvgpr_write_b32 a8, v235
 v_accvgpr_read_b32 v235, a9
 v_mul_f32 v235, v235, v234
 v_accvgpr_write_b32 a9, v235
 v_accvgpr_read_b32 v235, a10
 v_mul_f32 v235, v235, v234
 v_accvgpr_write_b32 a10, v235
 v_accvgpr_read_b32 v235, a11
 v_mul_f32 v235, v235, v234
 v_accvgpr_write_b32 a11, v235
 v_accvgpr_read_b32 v235, a12
 v_mul_f32 v235, v235, v234
 v_accvgpr_write_b32 a12, v235
 v_accvgpr_read_b32 v235, a13
 v_mul_f32 v235, v235, v234
 v_accvgpr_write_b32 a13, v235
 v_accvgpr_read_b32 v235, a14
 v_mul_f32 v235, v235, v234
 v_accvgpr_write_b32 a14, v235
 v_accvgpr_read_b32 v235, a15
 v_mul_f32 v235, v235, v234
 v_accvgpr_write_b32 a15, v235
 v_accvgpr_read_b32 v235, a16
 v_mul_f32 v235, v235, v234
 v_accvgpr_write_b32 a16, v235
 v_accvgpr_read_b32 v235, a17
 v_mul_f32 v235, v235, v234
 v_accvgpr_write_b32 a17, v235
 v_accvgpr_read_b32 v235, a18
 v_mul_f32 v235, v235, v234
 v_accvgpr_write_b32 a18, v235
 v_accvgpr_read_b32 v235, a19
 v_mul_f32 v235, v235, v234
 v_accvgpr_write_b32 a19, v235
 v_accvgpr_read_b32 v235, a20
 v_mul_f32 v235, v235, v234
 v_accvgpr_write_b32 a20, v235
 v_accvgpr_read_b32 v235, a21
 v_mul_f32 v235, v235, v234
 v_accvgpr_write_b32 a21, v235
 v_accvgpr_read_b32 v235, a22
 v_mul_f32 v235, v235, v234
 v_accvgpr_write_b32 a22, v235
 v_accvgpr_read_b32 v235, a23
 v_mul_f32 v235, v235, v234
 v_accvgpr_write_b32 a23, v235
 v_accvgpr_read_b32 v235, a24
 v_mul_f32 v235, v235, v234
 v_accvgpr_write_b32 a24, v235
 v_accvgpr_read_b32 v235, a25
 v_mul_f32 v235, v235, v234
 v_accvgpr_write_b32 a25, v235
 v_accvgpr_read_b32 v235, a26
 v_mul_f32 v235, v235, v234
 v_accvgpr_write_b32 a26, v235
 v_accvgpr_read_b32 v235, a27
 v_mul_f32 v235, v235, v234
 v_accvgpr_write_b32 a27, v235
 v_accvgpr_read_b32 v235, a28
 v_mul_f32 v235, v235, v234
 v_accvgpr_write_b32 a28, v235
 v_accvgpr_read_b32 v235, a29
 v_mul_f32 v235, v235, v234
 v_accvgpr_write_b32 a29, v235
 v_accvgpr_read_b32 v235, a30
 v_mul_f32 v235, v235, v234
 v_accvgpr_write_b32 a30, v235
 v_accvgpr_read_b32 v235, a31
 v_mul_f32 v235, v235, v234
 v_accvgpr_write_b32 a31, v235
 v_accvgpr_read_b32 v235, a32
 v_mul_f32 v235, v235, v234
 v_accvgpr_write_b32 a32, v235
 v_accvgpr_read_b32 v235, a33
 v_mul_f32 v235, v235, v234
 v_accvgpr_write_b32 a33, v235
 v_accvgpr_read_b32 v235, a34
 v_mul_f32 v235, v235, v234
 v_accvgpr_write_b32 a34, v235
 v_accvgpr_read_b32 v235, a35
 v_mul_f32 v235, v235, v234
 v_accvgpr_write_b32 a35, v235
 v_accvgpr_read_b32 v235, a36
 v_mul_f32 v235, v235, v234
 v_accvgpr_write_b32 a36, v235
 v_accvgpr_read_b32 v235, a37
 v_mul_f32 v235, v235, v234
 v_accvgpr_write_b32 a37, v235
 v_accvgpr_read_b32 v235, a38
 v_mul_f32 v235, v235, v234
 v_accvgpr_write_b32 a38, v235
 v_accvgpr_read_b32 v235, a39
 v_mul_f32 v235, v235, v234
 v_accvgpr_write_b32 a39, v235
 v_accvgpr_read_b32 v235, a40
 v_mul_f32 v235, v235, v234
 v_accvgpr_write_b32 a40, v235
 v_accvgpr_read_b32 v235, a41
 v_mul_f32 v235, v235, v234
 v_accvgpr_write_b32 a41, v235
 v_accvgpr_read_b32 v235, a42
 v_mul_f32 v235, v235, v234
 v_accvgpr_write_b32 a42, v235
 v_accvgpr_read_b32 v235, a43
 v_mul_f32 v235, v235, v234
 v_accvgpr_write_b32 a43, v235
 v_accvgpr_read_b32 v235, a44
 v_mul_f32 v235, v235, v234
 v_accvgpr_write_b32 a44, v235
 v_accvgpr_read_b32 v235, a45
 v_mul_f32 v235, v235, v234
 v_accvgpr_write_b32 a45, v235
 v_accvgpr_read_b32 v235, a46
 v_mul_f32 v235, v235, v234
 v_accvgpr_write_b32 a46, v235
 v_accvgpr_read_b32 v235, a47
 v_mul_f32 v235, v235, v234
 v_accvgpr_write_b32 a47, v235
 v_accvgpr_read_b32 v235, a48
 v_mul_f32 v235, v235, v234
 v_accvgpr_write_b32 a48, v235
 v_accvgpr_read_b32 v235, a49
 v_mul_f32 v235, v235, v234
 v_accvgpr_write_b32 a49, v235
 v_accvgpr_read_b32 v235, a50
 v_mul_f32 v235, v235, v234
 v_accvgpr_write_b32 a50, v235
 v_accvgpr_read_b32 v235, a51
 v_mul_f32 v235, v235, v234
 v_accvgpr_write_b32 a51, v235
 v_accvgpr_read_b32 v235, a52
 v_mul_f32 v235, v235, v234
 v_accvgpr_write_b32 a52, v235
 v_accvgpr_read_b32 v235, a53
 v_mul_f32 v235, v235, v234
 v_accvgpr_write_b32 a53, v235
 v_accvgpr_read_b32 v235, a54
 v_mul_f32 v235, v235, v234
 v_accvgpr_write_b32 a54, v235
 v_accvgpr_read_b32 v235, a55
 v_mul_f32 v235, v235, v234
 v_accvgpr_write_b32 a55, v235
 v_accvgpr_read_b32 v235, a56
 v_mul_f32 v235, v235, v234
 v_accvgpr_write_b32 a56, v235
 v_accvgpr_read_b32 v235, a57
 v_mul_f32 v235, v235, v234
 v_accvgpr_write_b32 a57, v235
 v_accvgpr_read_b32 v235, a58
 v_mul_f32 v235, v235, v234
 v_accvgpr_write_b32 a58, v235
 v_accvgpr_read_b32 v235, a59
 v_mul_f32 v235, v235, v234
 v_accvgpr_write_b32 a59, v235
 v_accvgpr_read_b32 v235, a60
 v_mul_f32 v235, v235, v234
 v_accvgpr_write_b32 a60, v235
 v_accvgpr_read_b32 v235, a61
 v_mul_f32 v235, v235, v234
 v_accvgpr_write_b32 a61, v235
 v_accvgpr_read_b32 v235, a62
 v_mul_f32 v235, v235, v234
 v_accvgpr_write_b32 a62, v235
 v_accvgpr_read_b32 v235, a63
 v_mul_f32 v235, v235, v234
 v_accvgpr_write_b32 a63, v235
 v_max3_f32 v233, v144, v145, v146
 v_max3_f32 v233, v233, v147, v148
 v_max3_f32 v233, v233, v149, v150
 v_max3_f32 v233, v233, v151, v152
 v_max3_f32 v233, v233, v153, v154
 v_max3_f32 v233, v233, v155, v156
 v_max3_f32 v233, v233, v157, v158
 v_max_f32 v233, v233, v159
 v_mov_b32 v235, v233
 s_nop 1
 v_permlane32_swap_b32 v233, v235
 v_max_f32 v233, v233, v235
 v_max_f32 v233, 0, v233
 v_sub_f32 v144, v144, v233
 v_sub_f32 v145, v145, v233
 v_sub_f32 v146, v146, v233
 v_sub_f32 v147, v147, v233
 v_sub_f32 v148, v148, v233
 v_sub_f32 v149, v149, v233
 v_sub_f32 v150, v150, v233
 v_sub_f32 v151, v151, v233
 v_sub_f32 v152, v152, v233
 v_sub_f32 v153, v153, v233
 v_sub_f32 v154, v154, v233
 v_sub_f32 v155, v155, v233
 v_sub_f32 v156, v156, v233
 v_sub_f32 v157, v157, v233
 v_sub_f32 v158, v158, v233
 v_sub_f32 v159, v159, v233
 v_sub_f32 v96, v96, v233
 v_sub_f32 v97, v97, v233
 v_sub_f32 v98, v98, v233
 v_sub_f32 v99, v99, v233
 v_sub_f32 v100, v100, v233
 v_sub_f32 v101, v101, v233
 v_sub_f32 v102, v102, v233
 v_sub_f32 v103, v103, v233
 v_sub_f32 v104, v104, v233
 v_sub_f32 v105, v105, v233
 v_sub_f32 v106, v106, v233
 v_sub_f32 v107, v107, v233
 v_sub_f32 v108, v108, v233
 v_sub_f32 v109, v109, v233
 v_sub_f32 v110, v110, v233
 v_sub_f32 v111, v111, v233
 v_sub_f32 v112, v112, v233
 v_sub_f32 v113, v113, v233
 v_sub_f32 v114, v114, v233
 v_sub_f32 v115, v115, v233
 v_sub_f32 v116, v116, v233
 v_sub_f32 v117, v117, v233
 v_sub_f32 v118, v118, v233
 v_sub_f32 v119, v119, v233
 v_sub_f32 v120, v120, v233
 v_sub_f32 v121, v121, v233
 v_sub_f32 v122, v122, v233
 v_sub_f32 v123, v123, v233
 v_sub_f32 v124, v124, v233
 v_sub_f32 v125, v125, v233
 v_sub_f32 v126, v126, v233
 v_sub_f32 v127, v127, v233
 v_sub_f32 v208, v208, v233
 v_sub_f32 v209, v209, v233
 v_sub_f32 v210, v210, v233
 v_sub_f32 v211, v211, v233
 v_sub_f32 v212, v212, v233
 v_sub_f32 v213, v213, v233
 v_sub_f32 v214, v214, v233
 v_sub_f32 v215, v215, v233
 v_sub_f32 v216, v216, v233
 v_sub_f32 v217, v217, v233
 v_sub_f32 v218, v218, v233
 v_sub_f32 v219, v219, v233
 v_sub_f32 v220, v220, v233
 v_sub_f32 v221, v221, v233
 v_sub_f32 v222, v222, v233
 v_sub_f32 v223, v223, v233
 v_exp_f32 v234, -v233
 s_nop 0
 v_mul_f32 v229, v229, v234
 v_accvgpr_read_b32 v235, a64
 v_mul_f32 v235, v235, v234
 v_accvgpr_write_b32 a64, v235
 v_accvgpr_read_b32 v235, a65
 v_mul_f32 v235, v235, v234
 v_accvgpr_write_b32 a65, v235
 v_accvgpr_read_b32 v235, a66
 v_mul_f32 v235, v235, v234
 v_accvgpr_write_b32 a66, v235
 v_accvgpr_read_b32 v235, a67
 v_mul_f32 v235, v235, v234
 v_accvgpr_write_b32 a67, v235
 v_accvgpr_read_b32 v235, a68
 v_mul_f32 v235, v235, v234
 v_accvgpr_write_b32 a68, v235
 v_accvgpr_read_b32 v235, a69
 v_mul_f32 v235, v235, v234
 v_accvgpr_write_b32 a69, v235
 v_accvgpr_read_b32 v235, a70
 v_mul_f32 v235, v235, v234
 v_accvgpr_write_b32 a70, v235
 v_accvgpr_read_b32 v235, a71
 v_mul_f32 v235, v235, v234
 v_accvgpr_write_b32 a71, v235
 v_accvgpr_read_b32 v235, a72
 v_mul_f32 v235, v235, v234
 v_accvgpr_write_b32 a72, v235
 v_accvgpr_read_b32 v235, a73
 v_mul_f32 v235, v235, v234
 v_accvgpr_write_b32 a73, v235
 v_accvgpr_read_b32 v235, a74
 v_mul_f32 v235, v235, v234
 v_accvgpr_write_b32 a74, v235
 v_accvgpr_read_b32 v235, a75
 v_mul_f32 v235, v235, v234
 v_accvgpr_write_b32 a75, v235
 v_accvgpr_read_b32 v235, a76
 v_mul_f32 v235, v235, v234
 v_accvgpr_write_b32 a76, v235
 v_accvgpr_read_b32 v235, a77
 v_mul_f32 v235, v235, v234
 v_accvgpr_write_b32 a77, v235
 v_accvgpr_read_b32 v235, a78
 v_mul_f32 v235, v235, v234
 v_accvgpr_write_b32 a78, v235
 v_accvgpr_read_b32 v235, a79
 v_mul_f32 v235, v235, v234
 v_accvgpr_write_b32 a79, v235
 v_accvgpr_read_b32 v235, a80
 v_mul_f32 v235, v235, v234
 v_accvgpr_write_b32 a80, v235
 v_accvgpr_read_b32 v235, a81
 v_mul_f32 v235, v235, v234
 v_accvgpr_write_b32 a81, v235
 v_accvgpr_read_b32 v235, a82
 v_mul_f32 v235, v235, v234
 v_accvgpr_write_b32 a82, v235
 v_accvgpr_read_b32 v235, a83
 v_mul_f32 v235, v235, v234
 v_accvgpr_write_b32 a83, v235
 v_accvgpr_read_b32 v235, a84
 v_mul_f32 v235, v235, v234
 v_accvgpr_write_b32 a84, v235
 v_accvgpr_read_b32 v235, a85
 v_mul_f32 v235, v235, v234
 v_accvgpr_write_b32 a85, v235
 v_accvgpr_read_b32 v235, a86
 v_mul_f32 v235, v235, v234
 v_accvgpr_write_b32 a86, v235
 v_accvgpr_read_b32 v235, a87
 v_mul_f32 v235, v235, v234
 v_accvgpr_write_b32 a87, v235
 v_accvgpr_read_b32 v235, a88
 v_mul_f32 v235, v235, v234
 v_accvgpr_write_b32 a88, v235
 v_accvgpr_read_b32 v235, a89
 v_mul_f32 v235, v235, v234
 v_accvgpr_write_b32 a89, v235
 v_accvgpr_read_b32 v235, a90
 v_mul_f32 v235, v235, v234
 v_accvgpr_write_b32 a90, v235
 v_accvgpr_read_b32 v235, a91
 v_mul_f32 v235, v235, v234
 v_accvgpr_write_b32 a91, v235
 v_accvgpr_read_b32 v235, a92
 v_mul_f32 v235, v235, v234
 v_accvgpr_write_b32 a92, v235
 v_accvgpr_read_b32 v235, a93
 v_mul_f32 v235, v235, v234
 v_accvgpr_write_b32 a93, v235
 v_accvgpr_read_b32 v235, a94
 v_mul_f32 v235, v235, v234
 v_accvgpr_write_b32 a94, v235
 v_accvgpr_read_b32 v235, a95
 v_mul_f32 v235, v235, v234
 v_accvgpr_write_b32 a95, v235
 v_accvgpr_read_b32 v235, a96
 v_mul_f32 v235, v235, v234
 v_accvgpr_write_b32 a96, v235
 v_accvgpr_read_b32 v235, a97
 v_mul_f32 v235, v235, v234
 v_accvgpr_write_b32 a97, v235
 v_accvgpr_read_b32 v235, a98
 v_mul_f32 v235, v235, v234
 v_accvgpr_write_b32 a98, v235
 v_accvgpr_read_b32 v235, a99
 v_mul_f32 v235, v235, v234
 v_accvgpr_write_b32 a99, v235
 v_accvgpr_read_b32 v235, a100
 v_mul_f32 v235, v235, v234
 v_accvgpr_write_b32 a100, v235
 v_accvgpr_read_b32 v235, a101
 v_mul_f32 v235, v235, v234
 v_accvgpr_write_b32 a101, v235
 v_accvgpr_read_b32 v235, a102
 v_mul_f32 v235, v235, v234
 v_accvgpr_write_b32 a102, v235
 v_accvgpr_read_b32 v235, a103
 v_mul_f32 v235, v235, v234
 v_accvgpr_write_b32 a103, v235
 v_accvgpr_read_b32 v235, a104
 v_mul_f32 v235, v235, v234
 v_accvgpr_write_b32 a104, v235
 v_accvgpr_read_b32 v235, a105
 v_mul_f32 v235, v235, v234
 v_accvgpr_write_b32 a105, v235
 v_accvgpr_read_b32 v235, a106
 v_mul_f32 v235, v235, v234
 v_accvgpr_write_b32 a106, v235
 v_accvgpr_read_b32 v235, a107
 v_mul_f32 v235, v235, v234
 v_accvgpr_write_b32 a107, v235
 v_accvgpr_read_b32 v235, a108
 v_mul_f32 v235, v235, v234
 v_accvgpr_write_b32 a108, v235
 v_accvgpr_read_b32 v235, a109
 v_mul_f32 v235, v235, v234
 v_accvgpr_write_b32 a109, v235
 v_accvgpr_read_b32 v235, a110
 v_mul_f32 v235, v235, v234
 v_accvgpr_write_b32 a110, v235
 v_accvgpr_read_b32 v235, a111
 v_mul_f32 v235, v235, v234
 v_accvgpr_write_b32 a111, v235
 v_accvgpr_read_b32 v235, a112
 v_mul_f32 v235, v235, v234
 v_accvgpr_write_b32 a112, v235
 v_accvgpr_read_b32 v235, a113
 v_mul_f32 v235, v235, v234
 v_accvgpr_write_b32 a113, v235
 v_accvgpr_read_b32 v235, a114
 v_mul_f32 v235, v235, v234
 v_accvgpr_write_b32 a114, v235
 v_accvgpr_read_b32 v235, a115
 v_mul_f32 v235, v235, v234
 v_accvgpr_write_b32 a115, v235
 v_accvgpr_read_b32 v235, a116
 v_mul_f32 v235, v235, v234
 v_accvgpr_write_b32 a116, v235
 v_accvgpr_read_b32 v235, a117
 v_mul_f32 v235, v235, v234
 v_accvgpr_write_b32 a117, v235
 v_accvgpr_read_b32 v235, a118
 v_mul_f32 v235, v235, v234
 v_accvgpr_write_b32 a118, v235
 v_accvgpr_read_b32 v235, a119
 v_mul_f32 v235, v235, v234
 v_accvgpr_write_b32 a119, v235
 v_accvgpr_read_b32 v235, a120
 v_mul_f32 v235, v235, v234
 v_accvgpr_write_b32 a120, v235
 v_accvgpr_read_b32 v235, a121
 v_mul_f32 v235, v235, v234
 v_accvgpr_write_b32 a121, v235
 v_accvgpr_read_b32 v235, a122
 v_mul_f32 v235, v235, v234
 v_accvgpr_write_b32 a122, v235
 v_accvgpr_read_b32 v235, a123
 v_mul_f32 v235, v235, v234
 v_accvgpr_write_b32 a123, v235
 v_accvgpr_read_b32 v235, a124
 v_mul_f32 v235, v235, v234
 v_accvgpr_write_b32 a124, v235
 v_accvgpr_read_b32 v235, a125
 v_mul_f32 v235, v235, v234
 v_accvgpr_write_b32 a125, v235
 v_accvgpr_read_b32 v235, a126
 v_mul_f32 v235, v235, v234
 v_accvgpr_write_b32 a126, v235
 v_accvgpr_read_b32 v235, a127
 v_mul_f32 v235, v235, v234
 v_accvgpr_write_b32 a127, v235
 v_exp_f32 v224, v128
 v_exp_f32 v225, v129
 v_exp_f32 v226, v130
 v_exp_f32 v227, v131
 v_add_f32 v230, v228, v224
 v_cvt_pk_bf16_f32 v176, v224, v225
 v_add_f32 v230, v230, v225
 v_exp_f32 v224, v132
 v_exp_f32 v225, v133
 v_add_f32 v230, v230, v226
 v_cvt_pk_bf16_f32 v177, v226, v227
 v_add_f32 v230, v230, v227
 v_exp_f32 v226, v134
 v_exp_f32 v227, v135
 v_add_f32 v230, v230, v224
 v_cvt_pk_bf16_f32 v178, v224, v225
 v_add_f32 v230, v230, v225
 v_exp_f32 v224, v136
 v_exp_f32 v225, v137
 v_add_f32 v230, v230, v226
 v_cvt_pk_bf16_f32 v179, v226, v227
 v_add_f32 v230, v230, v227
 v_exp_f32 v226, v138
 v_exp_f32 v227, v139
 v_add_f32 v230, v230, v224
 v_cvt_pk_bf16_f32 v180, v224, v225
 v_add_f32 v230, v230, v225
 v_exp_f32 v224, v140
 v_exp_f32 v225, v141
 v_add_f32 v230, v230, v226
 v_cvt_pk_bf16_f32 v181, v226, v227
 v_add_f32 v230, v230, v227
 v_exp_f32 v226, v142
 v_exp_f32 v227, v143
 v_add_f32 v230, v230, v224
 v_cvt_pk_bf16_f32 v182, v224, v225
 v_add_f32 v230, v230, v225
 v_exp_f32 v224, v144
 v_exp_f32 v225, v145
 v_add_f32 v230, v230, v226
 v_cvt_pk_bf16_f32 v183, v226, v227
 v_add_f32 v230, v230, v227
 v_exp_f32 v226, v146
 v_exp_f32 v227, v147
 v_add_f32 v231, v229, v224
 v_cvt_pk_bf16_f32 v184, v224, v225
 v_add_f32 v231, v231, v225
 v_exp_f32 v224, v148
 v_exp_f32 v225, v149
 v_add_f32 v231, v231, v226
 v_cvt_pk_bf16_f32 v185, v226, v227
 v_add_f32 v231, v231, v227
 v_exp_f32 v226, v150
 v_exp_f32 v227, v151
 v_add_f32 v231, v231, v224
 v_cvt_pk_bf16_f32 v186, v224, v225
 v_add_f32 v231, v231, v225
 v_exp_f32 v224, v152
 v_exp_f32 v225, v153
 v_add_f32 v231, v231, v226
 v_cvt_pk_bf16_f32 v187, v226, v227
 v_add_f32 v231, v231, v227
 v_exp_f32 v226, v154
 v_exp_f32 v227, v155
 v_add_f32 v231, v231, v224
 v_cvt_pk_bf16_f32 v188, v224, v225
 v_add_f32 v231, v231, v225
 v_exp_f32 v224, v156
 v_exp_f32 v225, v157
 v_add_f32 v231, v231, v226
 v_cvt_pk_bf16_f32 v189, v226, v227
 v_add_f32 v231, v231, v227
 v_exp_f32 v226, v158
 v_exp_f32 v227, v159
 v_add_f32 v231, v231, v224
 v_cvt_pk_bf16_f32 v190, v224, v225
 v_add_f32 v231, v231, v225
 v_add_f32 v231, v231, v226
 v_cvt_pk_bf16_f32 v191, v226, v227
 v_add_f32 v231, v231, v227
 s_nop 3
 s_setpc_b64 s[20:21]
L_slow_0SS:
 s_nop 15
 v_max3_f32 v233, v128, v129, v130
 v_max3_f32 v233, v233, v131, v132
 v_max3_f32 v233, v233, v133, v134
 v_max3_f32 v233, v233, v135, v136
 v_max3_f32 v233, v233, v137, v138
 v_max3_f32 v233, v233, v139, v140
 v_max3_f32 v233, v233, v141, v142
 v_max3_f32 v233, v233, v143, v144
 v_max3_f32 v233, v233, v145, v146
 v_max3_f32 v233, v233, v147, v148
 v_max3_f32 v233, v233, v149, v150
 v_max3_f32 v233, v233, v151, v152
 v_max3_f32 v233, v233, v153, v154
 v_max3_f32 v233, v233, v155, v156
 v_max3_f32 v233, v233, v157, v158
 v_max_f32 v233, v233, v159
 v_mov_b32 v235, v233
 s_nop 1
 v_permlane32_swap_b32 v233, v235
 v_max_f32 v233, v233, v235
 v_max_f32 v233, 0, v233
 v_sub_f32 v128, v128, v233
 v_sub_f32 v129, v129, v233
 v_sub_f32 v130, v130, v233
 v_sub_f32 v131, v131, v233
 v_sub_f32 v132, v132, v233
 v_sub_f32 v133, v133, v233
 v_sub_f32 v134, v134, v233
 v_sub_f32 v135, v135, v233
 v_sub_f32 v136, v136, v233
 v_sub_f32 v137, v137, v233
 v_sub_f32 v138, v138, v233
 v_sub_f32 v139, v139, v233
 v_sub_f32 v140, v140, v233
 v_sub_f32 v141, v141, v233
 v_sub_f32 v142, v142, v233
 v_sub_f32 v143, v143, v233
 v_sub_f32 v144, v144, v233
 v_sub_f32 v145, v145, v233
 v_sub_f32 v146, v146, v233
 v_sub_f32 v147, v147, v233
 v_sub_f32 v148, v148, v233
 v_sub_f32 v149, v149, v233
 v_sub_f32 v150, v150, v233
 v_sub_f32 v151, v151, v233
 v_sub_f32 v152, v152, v233
 v_sub_f32 v153, v153, v233
 v_sub_f32 v154, v154, v233
 v_sub_f32 v155, v155, v233
 v_sub_f32 v156, v156, v233
 v_sub_f32 v157, v157, v233
 v_sub_f32 v158, v158, v233
 v_sub_f32 v159, v159, v233
 v_sub_f32 v96, v96, v233
 v_sub_f32 v97, v97, v233
 v_sub_f32 v98, v98, v233
 v_sub_f32 v99, v99, v233
 v_sub_f32 v100, v100, v233
 v_sub_f32 v101, v101, v233
 v_sub_f32 v102, v102, v233
 v_sub_f32 v103, v103, v233
 v_sub_f32 v104, v104, v233
 v_sub_f32 v105, v105, v233
 v_sub_f32 v106, v106, v233
 v_sub_f32 v107, v107, v233
 v_sub_f32 v108, v108, v233
 v_sub_f32 v109, v109, v233
 v_sub_f32 v110, v110, v233
 v_sub_f32 v111, v111, v233
 v_sub_f32 v112, v112, v233
 v_sub_f32 v113, v113, v233
 v_sub_f32 v114, v114, v233
 v_sub_f32 v115, v115, v233
 v_sub_f32 v116, v116, v233
 v_sub_f32 v117, v117, v233
 v_sub_f32 v118, v118, v233
 v_sub_f32 v119, v119, v233
 v_sub_f32 v120, v120, v233
 v_sub_f32 v121, v121, v233
 v_sub_f32 v122, v122, v233
 v_sub_f32 v123, v123, v233
 v_sub_f32 v124, v124, v233
 v_sub_f32 v125, v125, v233
 v_sub_f32 v126, v126, v233
 v_sub_f32 v127, v127, v233
 v_sub_f32 v208, v208, v233
 v_sub_f32 v209, v209, v233
 v_sub_f32 v210, v210, v233
 v_sub_f32 v211, v211, v233
 v_sub_f32 v212, v212, v233
 v_sub_f32 v213, v213, v233
 v_sub_f32 v214, v214, v233
 v_sub_f32 v215, v215, v233
 v_sub_f32 v216, v216, v233
 v_sub_f32 v217, v217, v233
 v_sub_f32 v218, v218, v233
 v_sub_f32 v219, v219, v233
 v_sub_f32 v220, v220, v233
 v_sub_f32 v221, v221, v233
 v_sub_f32 v222, v222, v233
 v_sub_f32 v223, v223, v233
 v_exp_f32 v234, -v233
 s_nop 0
 v_mul_f32 v229, v229, v234
 v_accvgpr_read_b32 v235, a64
 v_mul_f32 v235, v235, v234
 v_accvgpr_write_b32 a64, v235
 v_accvgpr_read_b32 v235, a65
 v_mul_f32 v235, v235, v234
 v_accvgpr_write_b32 a65, v235
 v_accvgpr_read_b32 v235, a66
 v_mul_f32 v235, v235, v234
 v_accvgpr_write_b32 a66, v235
 v_accvgpr_read_b32 v235, a67
 v_mul_f32 v235, v235, v234
 v_accvgpr_write_b32 a67, v235
 v_accvgpr_read_b32 v235, a68
 v_mul_f32 v235, v235, v234
 v_accvgpr_write_b32 a68, v235
 v_accvgpr_read_b32 v235, a69
 v_mul_f32 v235, v235, v234
 v_accvgpr_write_b32 a69, v235
 v_accvgpr_read_b32 v235, a70
 v_mul_f32 v235, v235, v234
 v_accvgpr_write_b32 a70, v235
 v_accvgpr_read_b32 v235, a71
 v_mul_f32 v235, v235, v234
 v_accvgpr_write_b32 a71, v235
 v_accvgpr_read_b32 v235, a72
 v_mul_f32 v235, v235, v234
 v_accvgpr_write_b32 a72, v235
 v_accvgpr_read_b32 v235, a73
 v_mul_f32 v235, v235, v234
 v_accvgpr_write_b32 a73, v235
 v_accvgpr_read_b32 v235, a74
 v_mul_f32 v235, v235, v234
 v_accvgpr_write_b32 a74, v235
 v_accvgpr_read_b32 v235, a75
 v_mul_f32 v235, v235, v234
 v_accvgpr_write_b32 a75, v235
 v_accvgpr_read_b32 v235, a76
 v_mul_f32 v235, v235, v234
 v_accvgpr_write_b32 a76, v235
 v_accvgpr_read_b32 v235, a77
 v_mul_f32 v235, v235, v234
 v_accvgpr_write_b32 a77, v235
 v_accvgpr_read_b32 v235, a78
 v_mul_f32 v235, v235, v234
 v_accvgpr_write_b32 a78, v235
 v_accvgpr_read_b32 v235, a79
 v_mul_f32 v235, v235, v234
 v_accvgpr_write_b32 a79, v235
 v_accvgpr_read_b32 v235, a80
 v_mul_f32 v235, v235, v234
 v_accvgpr_write_b32 a80, v235
 v_accvgpr_read_b32 v235, a81
 v_mul_f32 v235, v235, v234
 v_accvgpr_write_b32 a81, v235
 v_accvgpr_read_b32 v235, a82
 v_mul_f32 v235, v235, v234
 v_accvgpr_write_b32 a82, v235
 v_accvgpr_read_b32 v235, a83
 v_mul_f32 v235, v235, v234
 v_accvgpr_write_b32 a83, v235
 v_accvgpr_read_b32 v235, a84
 v_mul_f32 v235, v235, v234
 v_accvgpr_write_b32 a84, v235
 v_accvgpr_read_b32 v235, a85
 v_mul_f32 v235, v235, v234
 v_accvgpr_write_b32 a85, v235
 v_accvgpr_read_b32 v235, a86
 v_mul_f32 v235, v235, v234
 v_accvgpr_write_b32 a86, v235
 v_accvgpr_read_b32 v235, a87
 v_mul_f32 v235, v235, v234
 v_accvgpr_write_b32 a87, v235
 v_accvgpr_read_b32 v235, a88
 v_mul_f32 v235, v235, v234
 v_accvgpr_write_b32 a88, v235
 v_accvgpr_read_b32 v235, a89
 v_mul_f32 v235, v235, v234
 v_accvgpr_write_b32 a89, v235
 v_accvgpr_read_b32 v235, a90
 v_mul_f32 v235, v235, v234
 v_accvgpr_write_b32 a90, v235
 v_accvgpr_read_b32 v235, a91
 v_mul_f32 v235, v235, v234
 v_accvgpr_write_b32 a91, v235
 v_accvgpr_read_b32 v235, a92
 v_mul_f32 v235, v235, v234
 v_accvgpr_write_b32 a92, v235
 v_accvgpr_read_b32 v235, a93
 v_mul_f32 v235, v235, v234
 v_accvgpr_write_b32 a93, v235
 v_accvgpr_read_b32 v235, a94
 v_mul_f32 v235, v235, v234
 v_accvgpr_write_b32 a94, v235
 v_accvgpr_read_b32 v235, a95
 v_mul_f32 v235, v235, v234
 v_accvgpr_write_b32 a95, v235
 v_accvgpr_read_b32 v235, a96
 v_mul_f32 v235, v235, v234
 v_accvgpr_write_b32 a96, v235
 v_accvgpr_read_b32 v235, a97
 v_mul_f32 v235, v235, v234
 v_accvgpr_write_b32 a97, v235
 v_accvgpr_read_b32 v235, a98
 v_mul_f32 v235, v235, v234
 v_accvgpr_write_b32 a98, v235
 v_accvgpr_read_b32 v235, a99
 v_mul_f32 v235, v235, v234
 v_accvgpr_write_b32 a99, v235
 v_accvgpr_read_b32 v235, a100
 v_mul_f32 v235, v235, v234
 v_accvgpr_write_b32 a100, v235
 v_accvgpr_read_b32 v235, a101
 v_mul_f32 v235, v235, v234
 v_accvgpr_write_b32 a101, v235
 v_accvgpr_read_b32 v235, a102
 v_mul_f32 v235, v235, v234
 v_accvgpr_write_b32 a102, v235
 v_accvgpr_read_b32 v235, a103
 v_mul_f32 v235, v235, v234
 v_accvgpr_write_b32 a103, v235
 v_accvgpr_read_b32 v235, a104
 v_mul_f32 v235, v235, v234
 v_accvgpr_write_b32 a104, v235
 v_accvgpr_read_b32 v235, a105
 v_mul_f32 v235, v235, v234
 v_accvgpr_write_b32 a105, v235
 v_accvgpr_read_b32 v235, a106
 v_mul_f32 v235, v235, v234
 v_accvgpr_write_b32 a106, v235
 v_accvgpr_read_b32 v235, a107
 v_mul_f32 v235, v235, v234
 v_accvgpr_write_b32 a107, v235
 v_accvgpr_read_b32 v235, a108
 v_mul_f32 v235, v235, v234
 v_accvgpr_write_b32 a108, v235
 v_accvgpr_read_b32 v235, a109
 v_mul_f32 v235, v235, v234
 v_accvgpr_write_b32 a109, v235
 v_accvgpr_read_b32 v235, a110
 v_mul_f32 v235, v235, v234
 v_accvgpr_write_b32 a110, v235
 v_accvgpr_read_b32 v235, a111
 v_mul_f32 v235, v235, v234
 v_accvgpr_write_b32 a111, v235
 v_accvgpr_read_b32 v235, a112
 v_mul_f32 v235, v235, v234
 v_accvgpr_write_b32 a112, v235
 v_accvgpr_read_b32 v235, a113
 v_mul_f32 v235, v235, v234
 v_accvgpr_write_b32 a113, v235
 v_accvgpr_read_b32 v235, a114
 v_mul_f32 v235, v235, v234
 v_accvgpr_write_b32 a114, v235
 v_accvgpr_read_b32 v235, a115
 v_mul_f32 v235, v235, v234
 v_accvgpr_write_b32 a115, v235
 v_accvgpr_read_b32 v235, a116
 v_mul_f32 v235, v235, v234
 v_accvgpr_write_b32 a116, v235
 v_accvgpr_read_b32 v235, a117
 v_mul_f32 v235, v235, v234
 v_accvgpr_write_b32 a117, v235
 v_accvgpr_read_b32 v235, a118
 v_mul_f32 v235, v235, v234
 v_accvgpr_write_b32 a118, v235
 v_accvgpr_read_b32 v235, a119
 v_mul_f32 v235, v235, v234
 v_accvgpr_write_b32 a119, v235
 v_accvgpr_read_b32 v235, a120
 v_mul_f32 v235, v235, v234
 v_accvgpr_write_b32 a120, v235
 v_accvgpr_read_b32 v235, a121
 v_mul_f32 v235, v235, v234
 v_accvgpr_write_b32 a121, v235
 v_accvgpr_read_b32 v235, a122
 v_mul_f32 v235, v235, v234
 v_accvgpr_write_b32 a122, v235
 v_accvgpr_read_b32 v235, a123
 v_mul_f32 v235, v235, v234
 v_accvgpr_write_b32 a123, v235
 v_accvgpr_read_b32 v235, a124
 v_mul_f32 v235, v235, v234
 v_accvgpr_write_b32 a124, v235
 v_accvgpr_read_b32 v235, a125
 v_mul_f32 v235, v235, v234
 v_accvgpr_write_b32 a125, v235
 v_accvgpr_read_b32 v235, a126
 v_mul_f32 v235, v235, v234
 v_accvgpr_write_b32 a126, v235
 v_accvgpr_read_b32 v235, a127
 v_mul_f32 v235, v235, v234
 v_accvgpr_write_b32 a127, v235
 v_exp_f32 v224, v128
 v_exp_f32 v225, v129
 v_exp_f32 v226, v130
 v_exp_f32 v227, v131
 v_add_f32 v231, v229, v224
 v_cvt_pk_bf16_f32 v176, v224, v225
 v_add_f32 v231, v231, v225
 v_exp_f32 v224, v132
 v_exp_f32 v225, v133
 v_add_f32 v231, v231, v226
 v_cvt_pk_bf16_f32 v177, v226, v227
 v_add_f32 v231, v231, v227
 v_exp_f32 v226, v134
 v_exp_f32 v227, v135
 v_add_f32 v231, v231, v224
 v_cvt_pk_bf16_f32 v178, v224, v225
 v_add_f32 v231, v231, v225
 v_exp_f32 v224, v136
 v_exp_f32 v225, v137
 v_add_f32 v231, v231, v226
 v_cvt_pk_bf16_f32 v179, v226, v227
 v_add_f32 v231, v231, v227
 v_exp_f32 v226, v138
 v_exp_f32 v227, v139
 v_add_f32 v231, v231, v224
 v_cvt_pk_bf16_f32 v180, v224, v225
 v_add_f32 v231, v231, v225
 v_exp_f32 v224, v140
 v_exp_f32 v225, v141
 v_add_f32 v231, v231, v226
 v_cvt_pk_bf16_f32 v181, v226, v227
 v_add_f32 v231, v231, v227
 v_exp_f32 v226, v142
 v_exp_f32 v227, v143
 v_add_f32 v231, v231, v224
 v_cvt_pk_bf16_f32 v182, v224, v225
 v_add_f32 v231, v231, v225
 v_exp_f32 v224, v144
 v_exp_f32 v225, v145
 v_add_f32 v231, v231, v226
 v_cvt_pk_bf16_f32 v183, v226, v227
 v_add_f32 v231, v231, v227
 v_exp_f32 v226, v146
 v_exp_f32 v227, v147
 v_add_f32 v231, v231, v224
 v_cvt_pk_bf16_f32 v184, v224, v225
 v_add_f32 v231, v231, v225
 v_exp_f32 v224, v148
 v_exp_f32 v225, v149
 v_add_f32 v231, v231, v226
 v_cvt_pk_bf16_f32 v185, v226, v227
 v_add_f32 v231, v231, v227
 v_exp_f32 v226, v150
 v_exp_f32 v227, v151
 v_add_f32 v231, v231, v224
 v_cvt_pk_bf16_f32 v186, v224, v225
 v_add_f32 v231, v231, v225
 v_exp_f32 v224, v152
 v_exp_f32 v225, v153
 v_add_f32 v231, v231, v226
 v_cvt_pk_bf16_f32 v187, v226, v227
 v_add_f32 v231, v231, v227
 v_exp_f32 v226, v154
 v_exp_f32 v227, v155
 v_add_f32 v231, v231, v224
 v_cvt_pk_bf16_f32 v188, v224, v225
 v_add_f32 v231, v231, v225
 v_exp_f32 v224, v156
 v_exp_f32 v225, v157
 v_add_f32 v231, v231, v226
 v_cvt_pk_bf16_f32 v189, v226, v227
 v_add_f32 v231, v231, v227
 v_exp_f32 v226, v158
 v_exp_f32 v227, v159
 v_add_f32 v231, v231, v224
 v_cvt_pk_bf16_f32 v190, v224, v225
 v_add_f32 v231, v231, v225
 v_add_f32 v231, v231, v226
 v_cvt_pk_bf16_f32 v191, v226, v227
 v_add_f32 v231, v231, v227
 s_nop 3
 s_setpc_b64 s[20:21]
L_slow_1DD:
 s_nop 15
 v_max3_f32 v232, v96, v97, v98
 v_max3_f32 v232, v232, v99, v100
 v_max3_f32 v232, v232, v101, v102
 v_max3_f32 v232, v232, v103, v104
 v_max3_f32 v232, v232, v105, v106
 v_max3_f32 v232, v232, v107, v108
 v_max3_f32 v232, v232, v109, v110
 v_max_f32 v232, v232, v111
 v_mov_b32 v235, v232
 s_nop 1
 v_permlane32_swap_b32 v232, v235
 v_max_f32 v232, v232, v235
 v_max_f32 v232, 0, v232
 v_sub_f32 v96, v96, v232
 v_sub_f32 v97, v97, v232
 v_sub_f32 v98, v98, v232
 v_sub_f32 v99, v99, v232
 v_sub_f32 v100, v100, v232
 v_sub_f32 v101, v101, v232
 v_sub_f32 v102, v102, v232
 v_sub_f32 v103, v103, v232
 v_sub_f32 v104, v104, v232
 v_sub_f32 v105, v105, v232
 v_sub_f32 v106, v106, v232
 v_sub_f32 v107, v107, v232
 v_sub_f32 v108, v108, v232
 v_sub_f32 v109, v109, v232
 v_sub_f32 v110, v110, v232
 v_sub_f32 v111, v111, v232
 v_sub_f32 v128, v128, v232
 v_sub_f32 v129, v129, v232
 v_sub_f32 v130, v130, v232
 v_sub_f32 v131, v131, v232
 v_sub_f32 v132, v132, v232
 v_sub_f32 v133, v133, v232
 v_sub_f32 v134, v134, v232
 v_sub_f32 v135, v135, v232
 v_sub_f32 v136, v136, v232
 v_sub_f32 v137, v137, v232
 v_sub_f32 v138, v138, v232
 v_sub_f32 v139, v139, v232
 v_sub_f32 v140, v140, v232
 v_sub_f32 v141, v141, v232
 v_sub_f32 v142, v142, v232
 v_sub_f32 v143, v143, v232
 v_sub_f32 v192, v192, v232
 v_sub_f32 v193, v193, v232
 v_sub_f32 v194, v194, v232
 v_sub_f32 v195, v195, v232
 v_sub_f32 v196, v196, v232
 v_sub_f32 v197, v197, v232
 v_sub_f32 v198, v198, v232
 v_sub_f32 v199, v199, v232
 v_sub_f32 v200, v200, v232
 v_sub_f32 v201, v201, v232
 v_sub_f32 v202, v202, v232
 v_sub_f32 v203, v203, v232
 v_sub_f32 v204, v204, v232
 v_sub_f32 v205, v205, v232
 v_sub_f32 v206, v206, v232
 v_sub_f32 v207, v207, v232
 v_exp_f32 v234, -v232
 s_nop 0
 v_mul_f32 v230, v230, v234
 v_accvgpr_read_b32 v235, a0
 v_mul_f32 v235, v235, v234
 v_accvgpr_write_b32 a0, v235
 v_accvgpr_read_b32 v235, a1
 v_mul_f32 v235, v235, v234
 v_accvgpr_write_b32 a1, v235
 v_accvgpr_read_b32 v235, a2
 v_mul_f32 v235, v235, v234
 v_accvgpr_write_b32 a2, v235
 v_accvgpr_read_b32 v235, a3
 v_mul_f32 v235, v235, v234
 v_accvgpr_write_b32 a3, v235
 v_accvgpr_read_b32 v235, a4
 v_mul_f32 v235, v235, v234
 v_accvgpr_write_b32 a4, v235
 v_accvgpr_read_b32 v235, a5
 v_mul_f32 v235, v235, v234
 v_accvgpr_write_b32 a5, v235
 v_accvgpr_read_b32 v235, a6
 v_mul_f32 v235, v235, v234
 v_accvgpr_write_b32 a6, v235
 v_accvgpr_read_b32 v235, a7
 v_mul_f32 v235, v235, v234
 v_accvgpr_write_b32 a7, v235
 v_accvgpr_read_b32 v235, a8
 v_mul_f32 v235, v235, v234
 v_accvgpr_write_b32 a8, v235
 v_accvgpr_read_b32 v235, a9
 v_mul_f32 v235, v235, v234
 v_accvgpr_write_b32 a9, v235
 v_accvgpr_read_b32 v235, a10
 v_mul_f32 v235, v235, v234
 v_accvgpr_write_b32 a10, v235
 v_accvgpr_read_b32 v235, a11
 v_mul_f32 v235, v235, v234
 v_accvgpr_write_b32 a11, v235
 v_accvgpr_read_b32 v235, a12
 v_mul_f32 v235, v235, v234
 v_accvgpr_write_b32 a12, v235
 v_accvgpr_read_b32 v235, a13
 v_mul_f32 v235, v235, v234
 v_accvgpr_write_b32 a13, v235
 v_accvgpr_read_b32 v235, a14
 v_mul_f32 v235, v235, v234
 v_accvgpr_write_b32 a14, v235
 v_accvgpr_read_b32 v235, a15
 v_mul_f32 v235, v235, v234
 v_accvgpr_write_b32 a15, v235
 v_accvgpr_read_b32 v235, a16
 v_mul_f32 v235, v235, v234
 v_accvgpr_write_b32 a16, v235
 v_accvgpr_read_b32 v235, a17
 v_mul_f32 v235, v235, v234
 v_accvgpr_write_b32 a17, v235
 v_accvgpr_read_b32 v235, a18
 v_mul_f32 v235, v235, v234
 v_accvgpr_write_b32 a18, v235
 v_accvgpr_read_b32 v235, a19
 v_mul_f32 v235, v235, v234
 v_accvgpr_write_b32 a19, v235
 v_accvgpr_read_b32 v235, a20
 v_mul_f32 v235, v235, v234
 v_accvgpr_write_b32 a20, v235
 v_accvgpr_read_b32 v235, a21
 v_mul_f32 v235, v235, v234
 v_accvgpr_write_b32 a21, v235
 v_accvgpr_read_b32 v235, a22
 v_mul_f32 v235, v235, v234
 v_accvgpr_write_b32 a22, v235
 v_accvgpr_read_b32 v235, a23
 v_mul_f32 v235, v235, v234
 v_accvgpr_write_b32 a23, v235
 v_accvgpr_read_b32 v235, a24
 v_mul_f32 v235, v235, v234
 v_accvgpr_write_b32 a24, v235
 v_accvgpr_read_b32 v235, a25
 v_mul_f32 v235, v235, v234
 v_accvgpr_write_b32 a25, v235
 v_accvgpr_read_b32 v235, a26
 v_mul_f32 v235, v235, v234
 v_accvgpr_write_b32 a26, v235
 v_accvgpr_read_b32 v235, a27
 v_mul_f32 v235, v235, v234
 v_accvgpr_write_b32 a27, v235
 v_accvgpr_read_b32 v235, a28
 v_mul_f32 v235, v235, v234
 v_accvgpr_write_b32 a28, v235
 v_accvgpr_read_b32 v235, a29
 v_mul_f32 v235, v235, v234
 v_accvgpr_write_b32 a29, v235
 v_accvgpr_read_b32 v235, a30
 v_mul_f32 v235, v235, v234
 v_accvgpr_write_b32 a30, v235
 v_accvgpr_read_b32 v235, a31
 v_mul_f32 v235, v235, v234
 v_accvgpr_write_b32 a31, v235
 v_accvgpr_read_b32 v235, a32
 v_mul_f32 v235, v235, v234
 v_accvgpr_write_b32 a32, v235
 v_accvgpr_read_b32 v235, a33
 v_mul_f32 v235, v235, v234
 v_accvgpr_write_b32 a33, v235
 v_accvgpr_read_b32 v235, a34
 v_mul_f32 v235, v235, v234
 v_accvgpr_write_b32 a34, v235
 v_accvgpr_read_b32 v235, a35
 v_mul_f32 v235, v235, v234
 v_accvgpr_write_b32 a35, v235
 v_accvgpr_read_b32 v235, a36
 v_mul_f32 v235, v235, v234
 v_accvgpr_write_b32 a36, v235
 v_accvgpr_read_b32 v235, a37
 v_mul_f32 v235, v235, v234
 v_accvgpr_write_b32 a37, v235
 v_accvgpr_read_b32 v235, a38
 v_mul_f32 v235, v235, v234
 v_accvgpr_write_b32 a38, v235
 v_accvgpr_read_b32 v235, a39
 v_mul_f32 v235, v235, v234
 v_accvgpr_write_b32 a39, v235
 v_accvgpr_read_b32 v235, a40
 v_mul_f32 v235, v235, v234
 v_accvgpr_write_b32 a40, v235
 v_accvgpr_read_b32 v235, a41
 v_mul_f32 v235, v235, v234
 v_accvgpr_write_b32 a41, v235
 v_accvgpr_read_b32 v235, a42
 v_mul_f32 v235, v235, v234
 v_accvgpr_write_b32 a42, v235
 v_accvgpr_read_b32 v235, a43
 v_mul_f32 v235, v235, v234
 v_accvgpr_write_b32 a43, v235
 v_accvgpr_read_b32 v235, a44
 v_mul_f32 v235, v235, v234
 v_accvgpr_write_b32 a44, v235
 v_accvgpr_read_b32 v235, a45
 v_mul_f32 v235, v235, v234
 v_accvgpr_write_b32 a45, v235
 v_accvgpr_read_b32 v235, a46
 v_mul_f32 v235, v235, v234
 v_accvgpr_write_b32 a46, v235
 v_accvgpr_read_b32 v235, a47
 v_mul_f32 v235, v235, v234
 v_accvgpr_write_b32 a47, v235
 v_accvgpr_read_b32 v235, a48
 v_mul_f32 v235, v235, v234
 v_accvgpr_write_b32 a48, v235
 v_accvgpr_read_b32 v235, a49
 v_mul_f32 v235, v235, v234
 v_accvgpr_write_b32 a49, v235
 v_accvgpr_read_b32 v235, a50
 v_mul_f32 v235, v235, v234
 v_accvgpr_write_b32 a50, v235
 v_accvgpr_read_b32 v235, a51
 v_mul_f32 v235, v235, v234
 v_accvgpr_write_b32 a51, v235
 v_accvgpr_read_b32 v235, a52
 v_mul_f32 v235, v235, v234
 v_accvgpr_write_b32 a52, v235
 v_accvgpr_read_b32 v235, a53
 v_mul_f32 v235, v235, v234
 v_accvgpr_write_b32 a53, v235
 v_accvgpr_read_b32 v235, a54
 v_mul_f32 v235, v235, v234
 v_accvgpr_write_b32 a54, v235
 v_accvgpr_read_b32 v235, a55
 v_mul_f32 v235, v235, v234
 v_accvgpr_write_b32 a55, v235
 v_accvgpr_read_b32 v235, a56
 v_mul_f32 v235, v235, v234
 v_accvgpr_write_b32 a56, v235
 v_accvgpr_read_b32 v235, a57
 v_mul_f32 v235, v235, v234
 v_accvgpr_write_b32 a57, v235
 v_accvgpr_read_b32 v235, a58
 v_mul_f32 v235, v235, v234
 v_accvgpr_write_b32 a58, v235
 v_accvgpr_read_b32 v235, a59
 v_mul_f32 v235, v235, v234
 v_accvgpr_write_b32 a59, v235
 v_accvgpr_read_b32 v235, a60
 v_mul_f32 v235, v235, v234
 v_accvgpr_write_b32 a60, v235
 v_accvgpr_read_b32 v235, a61
 v_mul_f32 v235, v235, v234
 v_accvgpr_write_b32 a61, v235
 v_accvgpr_read_b32 v235, a62
 v_mul_f32 v235, v235, v234
 v_accvgpr_write_b32 a62, v235
 v_accvgpr_read_b32 v235, a63
 v_mul_f32 v235, v235, v234
 v_accvgpr_write_b32 a63, v235
 v_max3_f32 v233, v112, v113, v114
 v_max3_f32 v233, v233, v115, v116
 v_max3_f32 v233, v233, v117, v118
 v_max3_f32 v233, v233, v119, v120
 v_max3_f32 v233, v233, v121, v122
 v_max3_f32 v233, v233, v123, v124
 v_max3_f32 v233, v233, v125, v126
 v_max_f32 v233, v233, v127
 v_mov_b32 v235, v233
 s_nop 1
 v_permlane32_swap_b32 v233, v235
 v_max_f32 v233, v233, v235
 v_max_f32 v233, 0, v233
 v_sub_f32 v112, v112, v233
 v_sub_f32 v113, v113, v233
 v_sub_f32 v114, v114, v233
 v_sub_f32 v115, v115, v233
 v_sub_f32 v116, v116, v233
 v_sub_f32 v117, v117, v233
 v_sub_f32 v118, v118, v233
 v_sub_f32 v119, v119, v233
 v_sub_f32 v120, v120, v233
 v_sub_f32 v121, v121, v233
 v_sub_f32 v122, v122, v233
 v_sub_f32 v123, v123, v233
 v_sub_f32 v124, v124, v233
 v_sub_f32 v125, v125, v233
 v_sub_f32 v126, v126, v233
 v_sub_f32 v127, v127, v233
 v_sub_f32 v144, v144, v233
 v_sub_f32 v145, v145, v233
 v_sub_f32 v146, v146, v233
 v_sub_f32 v147, v147, v233
 v_sub_f32 v148, v148, v233
 v_sub_f32 v149, v149, v233
 v_sub_f32 v150, v150, v233
 v_sub_f32 v151, v151, v233
 v_sub_f32 v152, v152, v233
 v_sub_f32 v153, v153, v233
 v_sub_f32 v154, v154, v233
 v_sub_f32 v155, v155, v233
 v_sub_f32 v156, v156, v233
 v_sub_f32 v157, v157, v233
 v_sub_f32 v158, v158, v233
 v_sub_f32 v159, v159, v233
 v_sub_f32 v208, v208, v233
 v_sub_f32 v209, v209, v233
 v_sub_f32 v210, v210, v233
 v_sub_f32 v211, v211, v233
 v_sub_f32 v212, v212, v233
 v_sub_f32 v213, v213, v233
 v_sub_f32 v214, v214, v233
 v_sub_f32 v215, v215, v233
 v_sub_f32 v216, v216, v233
 v_sub_f32 v217, v217, v233
 v_sub_f32 v218, v218, v233
 v_sub_f32 v219, v219, v233
 v_sub_f32 v220, v220, v233
 v_sub_f32 v221, v221, v233
 v_sub_f32 v222, v222, v233
 v_sub_f32 v223, v223, v233
 v_exp_f32 v234, -v233
 s_nop 0
 v_mul_f32 v231, v231, v234
 v_accvgpr_read_b32 v235, a64
 v_mul_f32 v235, v235, v234
 v_accvgpr_write_b32 a64, v235
 v_accvgpr_read_b32 v235, a65
 v_mul_f32 v235, v235, v234
 v_accvgpr_write_b32 a65, v235
 v_accvgpr_read_b32 v235, a66
 v_mul_f32 v235, v235, v234
 v_accvgpr_write_b32 a66, v235
 v_accvgpr_read_b32 v235, a67
 v_mul_f32 v235, v235, v234
 v_accvgpr_write_b32 a67, v235
 v_accvgpr_read_b32 v235, a68
 v_mul_f32 v235, v235, v234
 v_accvgpr_write_b32 a68, v235
 v_accvgpr_read_b32 v235, a69
 v_mul_f32 v235, v235, v234
 v_accvgpr_write_b32 a69, v235
 v_accvgpr_read_b32 v235, a70
 v_mul_f32 v235, v235, v234
 v_accvgpr_write_b32 a70, v235
 v_accvgpr_read_b32 v235, a71
 v_mul_f32 v235, v235, v234
 v_accvgpr_write_b32 a71, v235
 v_accvgpr_read_b32 v235, a72
 v_mul_f32 v235, v235, v234
 v_accvgpr_write_b32 a72, v235
 v_accvgpr_read_b32 v235, a73
 v_mul_f32 v235, v235, v234
 v_accvgpr_write_b32 a73, v235
 v_accvgpr_read_b32 v235, a74
 v_mul_f32 v235, v235, v234
 v_accvgpr_write_b32 a74, v235
 v_accvgpr_read_b32 v235, a75
 v_mul_f32 v235, v235, v234
 v_accvgpr_write_b32 a75, v235
 v_accvgpr_read_b32 v235, a76
 v_mul_f32 v235, v235, v234
 v_accvgpr_write_b32 a76, v235
 v_accvgpr_read_b32 v235, a77
 v_mul_f32 v235, v235, v234
 v_accvgpr_write_b32 a77, v235
 v_accvgpr_read_b32 v235, a78
 v_mul_f32 v235, v235, v234
 v_accvgpr_write_b32 a78, v235
 v_accvgpr_read_b32 v235, a79
 v_mul_f32 v235, v235, v234
 v_accvgpr_write_b32 a79, v235
 v_accvgpr_read_b32 v235, a80
 v_mul_f32 v235, v235, v234
 v_accvgpr_write_b32 a80, v235
 v_accvgpr_read_b32 v235, a81
 v_mul_f32 v235, v235, v234
 v_accvgpr_write_b32 a81, v235
 v_accvgpr_read_b32 v235, a82
 v_mul_f32 v235, v235, v234
 v_accvgpr_write_b32 a82, v235
 v_accvgpr_read_b32 v235, a83
 v_mul_f32 v235, v235, v234
 v_accvgpr_write_b32 a83, v235
 v_accvgpr_read_b32 v235, a84
 v_mul_f32 v235, v235, v234
 v_accvgpr_write_b32 a84, v235
 v_accvgpr_read_b32 v235, a85
 v_mul_f32 v235, v235, v234
 v_accvgpr_write_b32 a85, v235
 v_accvgpr_read_b32 v235, a86
 v_mul_f32 v235, v235, v234
 v_accvgpr_write_b32 a86, v235
 v_accvgpr_read_b32 v235, a87
 v_mul_f32 v235, v235, v234
 v_accvgpr_write_b32 a87, v235
 v_accvgpr_read_b32 v235, a88
 v_mul_f32 v235, v235, v234
 v_accvgpr_write_b32 a88, v235
 v_accvgpr_read_b32 v235, a89
 v_mul_f32 v235, v235, v234
 v_accvgpr_write_b32 a89, v235
 v_accvgpr_read_b32 v235, a90
 v_mul_f32 v235, v235, v234
 v_accvgpr_write_b32 a90, v235
 v_accvgpr_read_b32 v235, a91
 v_mul_f32 v235, v235, v234
 v_accvgpr_write_b32 a91, v235
 v_accvgpr_read_b32 v235, a92
 v_mul_f32 v235, v235, v234
 v_accvgpr_write_b32 a92, v235
 v_accvgpr_read_b32 v235, a93
 v_mul_f32 v235, v235, v234
 v_accvgpr_write_b32 a93, v235
 v_accvgpr_read_b32 v235, a94
 v_mul_f32 v235, v235, v234
 v_accvgpr_write_b32 a94, v235
 v_accvgpr_read_b32 v235, a95
 v_mul_f32 v235, v235, v234
 v_accvgpr_write_b32 a95, v235
 v_accvgpr_read_b32 v235, a96
 v_mul_f32 v235, v235, v234
 v_accvgpr_write_b32 a96, v235
 v_accvgpr_read_b32 v235, a97
 v_mul_f32 v235, v235, v234
 v_accvgpr_write_b32 a97, v235
 v_accvgpr_read_b32 v235, a98
 v_mul_f32 v235, v235, v234
 v_accvgpr_write_b32 a98, v235
 v_accvgpr_read_b32 v235, a99
 v_mul_f32 v235, v235, v234
 v_accvgpr_write_b32 a99, v235
 v_accvgpr_read_b32 v235, a100
 v_mul_f32 v235, v235, v234
 v_accvgpr_write_b32 a100, v235
 v_accvgpr_read_b32 v235, a101
 v_mul_f32 v235, v235, v234
 v_accvgpr_write_b32 a101, v235
 v_accvgpr_read_b32 v235, a102
 v_mul_f32 v235, v235, v234
 v_accvgpr_write_b32 a102, v235
 v_accvgpr_read_b32 v235, a103
 v_mul_f32 v235, v235, v234
 v_accvgpr_write_b32 a103, v235
 v_accvgpr_read_b32 v235, a104
 v_mul_f32 v235, v235, v234
 v_accvgpr_write_b32 a104, v235
 v_accvgpr_read_b32 v235, a105
 v_mul_f32 v235, v235, v234
 v_accvgpr_write_b32 a105, v235
 v_accvgpr_read_b32 v235, a106
 v_mul_f32 v235, v235, v234
 v_accvgpr_write_b32 a106, v235
 v_accvgpr_read_b32 v235, a107
 v_mul_f32 v235, v235, v234
 v_accvgpr_write_b32 a107, v235
 v_accvgpr_read_b32 v235, a108
 v_mul_f32 v235, v235, v234
 v_accvgpr_write_b32 a108, v235
 v_accvgpr_read_b32 v235, a109
 v_mul_f32 v235, v235, v234
 v_accvgpr_write_b32 a109, v235
 v_accvgpr_read_b32 v235, a110
 v_mul_f32 v235, v235, v234
 v_accvgpr_write_b32 a110, v235
 v_accvgpr_read_b32 v235, a111
 v_mul_f32 v235, v235, v234
 v_accvgpr_write_b32 a111, v235
 v_accvgpr_read_b32 v235, a112
 v_mul_f32 v235, v235, v234
 v_accvgpr_write_b32 a112, v235
 v_accvgpr_read_b32 v235, a113
 v_mul_f32 v235, v235, v234
 v_accvgpr_write_b32 a113, v235
 v_accvgpr_read_b32 v235, a114
 v_mul_f32 v235, v235, v234
 v_accvgpr_write_b32 a114, v235
 v_accvgpr_read_b32 v235, a115
 v_mul_f32 v235, v235, v234
 v_accvgpr_write_b32 a115, v235
 v_accvgpr_read_b32 v235, a116
 v_mul_f32 v235, v235, v234
 v_accvgpr_write_b32 a116, v235
 v_accvgpr_read_b32 v235, a117
 v_mul_f32 v235, v235, v234
 v_accvgpr_write_b32 a117, v235
 v_accvgpr_read_b32 v235, a118
 v_mul_f32 v235, v235, v234
 v_accvgpr_write_b32 a118, v235
 v_accvgpr_read_b32 v235, a119
 v_mul_f32 v235, v235, v234
 v_accvgpr_write_b32 a119, v235
 v_accvgpr_read_b32 v235, a120
 v_mul_f32 v235, v235, v234
 v_accvgpr_write_b32 a120, v235
 v_accvgpr_read_b32 v235, a121
 v_mul_f32 v235, v235, v234
 v_accvgpr_write_b32 a121, v235
 v_accvgpr_read_b32 v235, a122
 v_mul_f32 v235, v235, v234
 v_accvgpr_write_b32 a122, v235
 v_accvgpr_read_b32 v235, a123
 v_mul_f32 v235, v235, v234
 v_accvgpr_write_b32 a123, v235
 v_accvgpr_read_b32 v235, a124
 v_mul_f32 v235, v235, v234
 v_accvgpr_write_b32 a124, v235
 v_accvgpr_read_b32 v235, a125
 v_mul_f32 v235, v235, v234
 v_accvgpr_write_b32 a125, v235
 v_accvgpr_read_b32 v235, a126
 v_mul_f32 v235, v235, v234
 v_accvgpr_write_b32 a126, v235
 v_accvgpr_read_b32 v235, a127
 v_mul_f32 v235, v235, v234
 v_accvgpr_write_b32 a127, v235
 v_exp_f32 v224, v96
 v_exp_f32 v225, v97
 v_exp_f32 v226, v98
 v_exp_f32 v227, v99
 v_add_f32 v228, v230, v224
 v_cvt_pk_bf16_f32 v160, v224, v225
 v_add_f32 v228, v228, v225
 v_exp_f32 v224, v100
 v_exp_f32 v225, v101
 v_add_f32 v228, v228, v226
 v_cvt_pk_bf16_f32 v161, v226, v227
 v_add_f32 v228, v228, v227
 v_exp_f32 v226, v102
 v_exp_f32 v227, v103
 v_add_f32 v228, v228, v224
 v_cvt_pk_bf16_f32 v162, v224, v225
 v_add_f32 v228, v228, v225
 v_exp_f32 v224, v104
 v_exp_f32 v225, v105
 v_add_f32 v228, v228, v226
 v_cvt_pk_bf16_f32 v163, v226, v227
 v_add_f32 v228, v228, v227
 v_exp_f32 v226, v106
 v_exp_f32 v227, v107
 v_add_f32 v228, v228, v224
 v_cvt_pk_bf16_f32 v164, v224, v225
 v_add_f32 v228, v228, v225
 v_exp_f32 v224, v108
 v_exp_f32 v225, v109
 v_add_f32 v228, v228, v226
 v_cvt_pk_bf16_f32 v165, v226, v227
 v_add_f32 v228, v228, v227
 v_exp_f32 v226, v110
 v_exp_f32 v227, v111
 v_add_f32 v228, v228, v224
 v_cvt_pk_bf16_f32 v166, v224, v225
 v_add_f32 v228, v228, v225
 v_exp_f32 v224, v112
 v_exp_f32 v225, v113
 v_add_f32 v228, v228, v226
 v_cvt_pk_bf16_f32 v167, v226, v227
 v_add_f32 v228, v228, v227
 v_exp_f32 v226, v114
 v_exp_f32 v227, v115
 v_add_f32 v229, v231, v224
 v_cvt_pk_bf16_f32 v168, v224, v225
 v_add_f32 v229, v229, v225
 v_exp_f32 v224, v116
 v_exp_f32 v225, v117
 v_add_f32 v229, v229, v226
 v_cvt_pk_bf16_f32 v169, v226, v227
 v_add_f32 v229, v229, v227
 v_exp_f32 v226, v118
 v_exp_f32 v227, v119
 v_add_f32 v229, v229, v224
 v_cvt_pk_bf16_f32 v170, v224, v225
 v_add_f32 v229, v229, v225
 v_exp_f32 v224, v120
 v_exp_f32 v225, v121
 v_add_f32 v229, v229, v226
 v_cvt_pk_bf16_f32 v171, v226, v227
 v_add_f32 v229, v229, v227
 v_exp_f32 v226, v122
 v_exp_f32 v227, v123
 v_add_f32 v229, v229, v224
 v_cvt_pk_bf16_f32 v172, v224, v225
 v_add_f32 v229, v229, v225
 v_exp_f32 v224, v124
 v_exp_f32 v225, v125
 v_add_f32 v229, v229, v226
 v_cvt_pk_bf16_f32 v173, v226, v227
 v_add_f32 v229, v229, v227
 v_exp_f32 v226, v126
 v_exp_f32 v227, v127
 v_add_f32 v229, v229, v224
 v_cvt_pk_bf16_f32 v174, v224, v225
 v_add_f32 v229, v229, v225
 v_add_f32 v229, v229, v226
 v_cvt_pk_bf16_f32 v175, v226, v227
 v_add_f32 v229, v229, v227
 s_nop 3
 s_setpc_b64 s[20:21]
L_slow_1SS:
 s_nop 15
 v_max3_f32 v233, v96, v97, v98
 v_max3_f32 v233, v233, v99, v100
 v_max3_f32 v233, v233, v101, v102
 v_max3_f32 v233, v233, v103, v104
 v_max3_f32 v233, v233, v105, v106
 v_max3_f32 v233, v233, v107, v108
 v_max3_f32 v233, v233, v109, v110
 v_max3_f32 v233, v233, v111, v112
 v_max3_f32 v233, v233, v113, v114
 v_max3_f32 v233, v233, v115, v116
 v_max3_f32 v233, v233, v117, v118
 v_max3_f32 v233, v233, v119, v120
 v_max3_f32 v233, v233, v121, v122
 v_max3_f32 v233, v233, v123, v124
 v_max3_f32 v233, v233, v125, v126
 v_max_f32 v233, v233, v127
 v_mov_b32 v235, v233
 s_nop 1
 v_permlane32_swap_b32 v233, v235
 v_max_f32 v233, v233, v235
 v_max_f32 v233, 0, v233
 v_sub_f32 v96, v96, v233
 v_sub_f32 v97, v97, v233
 v_sub_f32 v98, v98, v233
 v_sub_f32 v99, v99, v233
 v_sub_f32 v100, v100, v233
 v_sub_f32 v101, v101, v233
 v_sub_f32 v102, v102, v233
 v_sub_f32 v103, v103, v233
 v_sub_f32 v104, v104, v233
 v_sub_f32 v105, v105, v233
 v_sub_f32 v106, v106, v233
 v_sub_f32 v107, v107, v233
 v_sub_f32 v108, v108, v233
 v_sub_f32 v109, v109, v233
 v_sub_f32 v110, v110, v233
 v_sub_f32 v111, v111, v233
 v_sub_f32 v112, v112, v233
 v_sub_f32 v113, v113, v233
 v_sub_f32 v114, v114, v233
 v_sub_f32 v115, v115, v233
 v_sub_f32 v116, v116, v233
 v_sub_f32 v117, v117, v233
 v_sub_f32 v118, v118, v233
 v_sub_f32 v119, v119, v233
 v_sub_f32 v120, v120, v233
 v_sub_f32 v121, v121, v233
 v_sub_f32 v122, v122, v233
 v_sub_f32 v123, v123, v233
 v_sub_f32 v124, v124, v233
 v_sub_f32 v125, v125, v233
 v_sub_f32 v126, v126, v233
 v_sub_f32 v127, v127, v233
 v_sub_f32 v128, v128, v233
 v_sub_f32 v129, v129, v233
 v_sub_f32 v130, v130, v233
 v_sub_f32 v131, v131, v233
 v_sub_f32 v132, v132, v233
 v_sub_f32 v133, v133, v233
 v_sub_f32 v134, v134, v233
 v_sub_f32 v135, v135, v233
 v_sub_f32 v136, v136, v233
 v_sub_f32 v137, v137, v233
 v_sub_f32 v138, v138, v233
 v_sub_f32 v139, v139, v233
 v_sub_f32 v140, v140, v233
 v_sub_f32 v141, v141, v233
 v_sub_f32 v142, v142, v233
 v_sub_f32 v143, v143, v233
 v_sub_f32 v144, v144, v233
 v_sub_f32 v145, v145, v233
 v_sub_f32 v146, v146, v233
 v_sub_f32 v147, v147, v233
 v_sub_f32 v148, v148, v233
 v_sub_f32 v149, v149, v233
 v_sub_f32 v150, v150, v233
 v_sub_f32 v151, v151, v233
 v_sub_f32 v152, v152, v233
 v_sub_f32 v153, v153, v233
 v_sub_f32 v154, v154, v233
 v_sub_f32 v155, v155, v233
 v_sub_f32 v156, v156, v233
 v_sub_f32 v157, v157, v233
 v_sub_f32 v158, v158, v233
 v_sub_f32 v159, v159, v233
 v_sub_f32 v208, v208, v233
 v_sub_f32 v209, v209, v233
 v_sub_f32 v210, v210, v233
 v_sub_f32 v211, v211, v233
 v_sub_f32 v212, v212, v233
 v_sub_f32 v213, v213, v233
 v_sub_f32 v214, v214, v233
 v_sub_f32 v215, v215, v233
 v_sub_f32 v216, v216, v233
 v_sub_f32 v217, v217, v233
 v_sub_f32 v218, v218, v233
 v_sub_f32 v219, v219, v233
 v_sub_f32 v220, v220, v233
 v_sub_f32 v221, v221, v233
 v_sub_f32 v222, v222, v233
 v_sub_f32 v223, v223, v233
 v_exp_f32 v234, -v233
 s_nop 0
 v_mul_f32 v231, v231, v234
 v_accvgpr_read_b32 v235, a64
 v_mul_f32 v235, v235, v234
 v_accvgpr_write_b32 a64, v235
 v_accvgpr_read_b32 v235, a65
 v_mul_f32 v235, v235, v234
 v_accvgpr_write_b32 a65, v235
 v_accvgpr_read_b32 v235, a66
 v_mul_f32 v235, v235, v234
 v_accvgpr_write_b32 a66, v235
 v_accvgpr_read_b32 v235, a67
 v_mul_f32 v235, v235, v234
 v_accvgpr_write_b32 a67, v235
 v_accvgpr_read_b32 v235, a68
 v_mul_f32 v235, v235, v234
 v_accvgpr_write_b32 a68, v235
 v_accvgpr_read_b32 v235, a69
 v_mul_f32 v235, v235, v234
 v_accvgpr_write_b32 a69, v235
 v_accvgpr_read_b32 v235, a70
 v_mul_f32 v235, v235, v234
 v_accvgpr_write_b32 a70, v235
 v_accvgpr_read_b32 v235, a71
 v_mul_f32 v235, v235, v234
 v_accvgpr_write_b32 a71, v235
 v_accvgpr_read_b32 v235, a72
 v_mul_f32 v235, v235, v234
 v_accvgpr_write_b32 a72, v235
 v_accvgpr_read_b32 v235, a73
 v_mul_f32 v235, v235, v234
 v_accvgpr_write_b32 a73, v235
 v_accvgpr_read_b32 v235, a74
 v_mul_f32 v235, v235, v234
 v_accvgpr_write_b32 a74, v235
 v_accvgpr_read_b32 v235, a75
 v_mul_f32 v235, v235, v234
 v_accvgpr_write_b32 a75, v235
 v_accvgpr_read_b32 v235, a76
 v_mul_f32 v235, v235, v234
 v_accvgpr_write_b32 a76, v235
 v_accvgpr_read_b32 v235, a77
 v_mul_f32 v235, v235, v234
 v_accvgpr_write_b32 a77, v235
 v_accvgpr_read_b32 v235, a78
 v_mul_f32 v235, v235, v234
 v_accvgpr_write_b32 a78, v235
 v_accvgpr_read_b32 v235, a79
 v_mul_f32 v235, v235, v234
 v_accvgpr_write_b32 a79, v235
 v_accvgpr_read_b32 v235, a80
 v_mul_f32 v235, v235, v234
 v_accvgpr_write_b32 a80, v235
 v_accvgpr_read_b32 v235, a81
 v_mul_f32 v235, v235, v234
 v_accvgpr_write_b32 a81, v235
 v_accvgpr_read_b32 v235, a82
 v_mul_f32 v235, v235, v234
 v_accvgpr_write_b32 a82, v235
 v_accvgpr_read_b32 v235, a83
 v_mul_f32 v235, v235, v234
 v_accvgpr_write_b32 a83, v235
 v_accvgpr_read_b32 v235, a84
 v_mul_f32 v235, v235, v234
 v_accvgpr_write_b32 a84, v235
 v_accvgpr_read_b32 v235, a85
 v_mul_f32 v235, v235, v234
 v_accvgpr_write_b32 a85, v235
 v_accvgpr_read_b32 v235, a86
 v_mul_f32 v235, v235, v234
 v_accvgpr_write_b32 a86, v235
 v_accvgpr_read_b32 v235, a87
 v_mul_f32 v235, v235, v234
 v_accvgpr_write_b32 a87, v235
 v_accvgpr_read_b32 v235, a88
 v_mul_f32 v235, v235, v234
 v_accvgpr_write_b32 a88, v235
 v_accvgpr_read_b32 v235, a89
 v_mul_f32 v235, v235, v234
 v_accvgpr_write_b32 a89, v235
 v_accvgpr_read_b32 v235, a90
 v_mul_f32 v235, v235, v234
 v_accvgpr_write_b32 a90, v235
 v_accvgpr_read_b32 v235, a91
 v_mul_f32 v235, v235, v234
 v_accvgpr_write_b32 a91, v235
 v_accvgpr_read_b32 v235, a92
 v_mul_f32 v235, v235, v234
 v_accvgpr_write_b32 a92, v235
 v_accvgpr_read_b32 v235, a93
 v_mul_f32 v235, v235, v234
 v_accvgpr_write_b32 a93, v235
 v_accvgpr_read_b32 v235, a94
 v_mul_f32 v235, v235, v234
 v_accvgpr_write_b32 a94, v235
 v_accvgpr_read_b32 v235, a95
 v_mul_f32 v235, v235, v234
 v_accvgpr_write_b32 a95, v235
 v_accvgpr_read_b32 v235, a96
 v_mul_f32 v235, v235, v234
 v_accvgpr_write_b32 a96, v235
 v_accvgpr_read_b32 v235, a97
 v_mul_f32 v235, v235, v234
 v_accvgpr_write_b32 a97, v235
 v_accvgpr_read_b32 v235, a98
 v_mul_f32 v235, v235, v234
 v_accvgpr_write_b32 a98, v235
 v_accvgpr_read_b32 v235, a99
 v_mul_f32 v235, v235, v234
 v_accvgpr_write_b32 a99, v235
 v_accvgpr_read_b32 v235, a100
 v_mul_f32 v235, v235, v234
 v_accvgpr_write_b32 a100, v235
 v_accvgpr_read_b32 v235, a101
 v_mul_f32 v235, v235, v234
 v_accvgpr_write_b32 a101, v235
 v_accvgpr_read_b32 v235, a102
 v_mul_f32 v235, v235, v234
 v_accvgpr_write_b32 a102, v235
 v_accvgpr_read_b32 v235, a103
 v_mul_f32 v235, v235, v234
 v_accvgpr_write_b32 a103, v235
 v_accvgpr_read_b32 v235, a104
 v_mul_f32 v235, v235, v234
 v_accvgpr_write_b32 a104, v235
 v_accvgpr_read_b32 v235, a105
 v_mul_f32 v235, v235, v234
 v_accvgpr_write_b32 a105, v235
 v_accvgpr_read_b32 v235, a106
 v_mul_f32 v235, v235, v234
 v_accvgpr_write_b32 a106, v235
 v_accvgpr_read_b32 v235, a107
 v_mul_f32 v235, v235, v234
 v_accvgpr_write_b32 a107, v235
 v_accvgpr_read_b32 v235, a108
 v_mul_f32 v235, v235, v234
 v_accvgpr_write_b32 a108, v235
 v_accvgpr_read_b32 v235, a109
 v_mul_f32 v235, v235, v234
 v_accvgpr_write_b32 a109, v235
 v_accvgpr_read_b32 v235, a110
 v_mul_f32 v235, v235, v234
 v_accvgpr_write_b32 a110, v235
 v_accvgpr_read_b32 v235, a111
 v_mul_f32 v235, v235, v234
 v_accvgpr_write_b32 a111, v235
 v_accvgpr_read_b32 v235, a112
 v_mul_f32 v235, v235, v234
 v_accvgpr_write_b32 a112, v235
 v_accvgpr_read_b32 v235, a113
 v_mul_f32 v235, v235, v234
 v_accvgpr_write_b32 a113, v235
 v_accvgpr_read_b32 v235, a114
 v_mul_f32 v235, v235, v234
 v_accvgpr_write_b32 a114, v235
 v_accvgpr_read_b32 v235, a115
 v_mul_f32 v235, v235, v234
 v_accvgpr_write_b32 a115, v235
 v_accvgpr_read_b32 v235, a116
 v_mul_f32 v235, v235, v234
 v_accvgpr_write_b32 a116, v235
 v_accvgpr_read_b32 v235, a117
 v_mul_f32 v235, v235, v234
 v_accvgpr_write_b32 a117, v235
 v_accvgpr_read_b32 v235, a118
 v_mul_f32 v235, v235, v234
 v_accvgpr_write_b32 a118, v235
 v_accvgpr_read_b32 v235, a119
 v_mul_f32 v235, v235, v234
 v_accvgpr_write_b32 a119, v235
 v_accvgpr_read_b32 v235, a120
 v_mul_f32 v235, v235, v234
 v_accvgpr_write_b32 a120, v235
 v_accvgpr_read_b32 v235, a121
 v_mul_f32 v235, v235, v234
 v_accvgpr_write_b32 a121, v235
 v_accvgpr_read_b32 v235, a122
 v_mul_f32 v235, v235, v234
 v_accvgpr_write_b32 a122, v235
 v_accvgpr_read_b32 v235, a123
 v_mul_f32 v235, v235, v234
 v_accvgpr_write_b32 a123, v235
 v_accvgpr_read_b32 v235, a124
 v_mul_f32 v235, v235, v234
 v_accvgpr_write_b32 a124, v235
 v_accvgpr_read_b32 v235, a125
 v_mul_f32 v235, v235, v234
 v_accvgpr_write_b32 a125, v235
 v_accvgpr_read_b32 v235, a126
 v_mul_f32 v235, v235, v234
 v_accvgpr_write_b32 a126, v235
 v_accvgpr_read_b32 v235, a127
 v_mul_f32 v235, v235, v234
 v_accvgpr_write_b32 a127, v235
 v_exp_f32 v224, v96
 v_exp_f32 v225, v97
 v_exp_f32 v226, v98
 v_exp_f32 v227, v99
 v_add_f32 v229, v231, v224
 v_cvt_pk_bf16_f32 v160, v224, v225
 v_add_f32 v229, v229, v225
 v_exp_f32 v224, v100
 v_exp_f32 v225, v101
 v_add_f32 v229, v229, v226
 v_cvt_pk_bf16_f32 v161, v226, v227
 v_add_f32 v229, v229, v227
 v_exp_f32 v226, v102
 v_exp_f32 v227, v103
 v_add_f32 v229, v229, v224
 v_cvt_pk_bf16_f32 v162, v224, v225
 v_add_f32 v229, v229, v225
 v_exp_f32 v224, v104
 v_exp_f32 v225, v105
 v_add_f32 v229, v229, v226
 v_cvt_pk_bf16_f32 v163, v226, v227
 v_add_f32 v229, v229, v227
 v_exp_f32 v226, v106
 v_exp_f32 v227, v107
 v_add_f32 v229, v229, v224
 v_cvt_pk_bf16_f32 v164, v224, v225
 v_add_f32 v229, v229, v225
 v_exp_f32 v224, v108
 v_exp_f32 v225, v109
 v_add_f32 v229, v229, v226
 v_cvt_pk_bf16_f32 v165, v226, v227
 v_add_f32 v229, v229, v227
 v_exp_f32 v226, v110
 v_exp_f32 v227, v111
 v_add_f32 v229, v229, v224
 v_cvt_pk_bf16_f32 v166, v224, v225
 v_add_f32 v229, v229, v225
 v_exp_f32 v224, v112
 v_exp_f32 v225, v113
 v_add_f32 v229, v229, v226
 v_cvt_pk_bf16_f32 v167, v226, v227
 v_add_f32 v229, v229, v227
 v_exp_f32 v226, v114
 v_exp_f32 v227, v115
 v_add_f32 v229, v229, v224
 v_cvt_pk_bf16_f32 v168, v224, v225
 v_add_f32 v229, v229, v225
 v_exp_f32 v224, v116
 v_exp_f32 v225, v117
 v_add_f32 v229, v229, v226
 v_cvt_pk_bf16_f32 v169, v226, v227
 v_add_f32 v229, v229, v227
 v_exp_f32 v226, v118
 v_exp_f32 v227, v119
 v_add_f32 v229, v229, v224
 v_cvt_pk_bf16_f32 v170, v224, v225
 v_add_f32 v229, v229, v225
 v_exp_f32 v224, v120
 v_exp_f32 v225, v121
 v_add_f32 v229, v229, v226
 v_cvt_pk_bf16_f32 v171, v226, v227
 v_add_f32 v229, v229, v227
 v_exp_f32 v226, v122
 v_exp_f32 v227, v123
 v_add_f32 v229, v229, v224
 v_cvt_pk_bf16_f32 v172, v224, v225
 v_add_f32 v229, v229, v225
 v_exp_f32 v224, v124
 v_exp_f32 v225, v125
 v_add_f32 v229, v229, v226
 v_cvt_pk_bf16_f32 v173, v226, v227
 v_add_f32 v229, v229, v227
 v_exp_f32 v226, v126
 v_exp_f32 v227, v127
 v_add_f32 v229, v229, v224
 v_cvt_pk_bf16_f32 v174, v224, v225
 v_add_f32 v229, v229, v225
 v_add_f32 v229, v229, v226
 v_cvt_pk_bf16_f32 v175, v226, v227
 v_add_f32 v229, v229, v227
 s_nop 3
 s_setpc_b64 s[20:21]
.section .rodata,"a"
.p2align 6
.amdhsa_kernel parallel_sum__compressed_kv_cla__mixer_channel_mlp__prompt_kernel
  .amdhsa_next_free_vgpr 512
  .amdhsa_next_free_sgpr 102
  .amdhsa_accum_offset 256
  .amdhsa_group_segment_fixed_size 0
  .amdhsa_kernarg_size 112
  .amdhsa_user_sgpr_count 2
  .amdhsa_user_sgpr_kernarg_segment_ptr 1
  .amdhsa_system_sgpr_workgroup_id_x 1
.end_amdhsa_kernel
```
